```python
import torch

def _softmax(x, axis=-1):
    return torch.softmax(x, dim=axis)
def _gelu(x):
    return torch.nn.functional.gelu(x, approximate="tanh")
def _silu(x):
    return torch.nn.functional.silu(x)
def _sigmoid(x):
    return torch.sigmoid(x)
def _layernorm(x, axis=-1, eps=1e-5):
    m = x.mean(dim=axis, keepdim=True)
    v = x.var(dim=axis, keepdim=True, unbiased=False)
    return (x - m) / torch.sqrt(v + eps)
def _scatter_add(tgt, idx, src, axis=0):
    return tgt.clone().index_add_(axis, idx, src)
def _segment_sum(src, seg, n):
    out = torch.zeros((n,) + src.shape[1:], dtype=src.dtype)
    return out.index_add_(0, seg, src)
def _pad(x, pw):
    flat = tuple(v for pair in reversed(pw) for v in pair)
    return torch.nn.functional.pad(x, flat)

kernel_name = 'concat_heads__mha_block_cached__mha_block_cached__near_ridge'

def setup_inputs():

    _w = (lambda a: (lambda t: t.to(torch.bfloat16) if t.is_floating_point() else t)(torch.as_tensor(a)))
    def _A_setup():
        B, Sq, D = 16, 240, 448
        H, Sk, Dh = 16, 512, 256
        return {
            "x": _w((lambda *s: torch.randn(*s, dtype=torch.bfloat16) * 0.8)(B, Sq, D)),
            "k_cache": _w((lambda *s: torch.randn(*s, dtype=torch.bfloat16) * 0.8)(B, H, Sk, Dh)),
            "v_cache": _w((lambda *s: torch.randn(*s, dtype=torch.bfloat16) * 0.05)(B, H, Sk, Dh)),
            "wq": _w((lambda *s: torch.randn(*s, dtype=torch.bfloat16) * 0.8)(D, H * Dh) * (D ** -0.5)),
            "wo": _w((lambda *s: torch.randn(*s, dtype=torch.bfloat16) * 0.05)(H * Dh, D) * ((H * Dh) ** -0.5)),
        }
    _A_in = _A_setup()

    def _B_setup():
        B, Sq, D = 16, 240, 448
        H, Sk, Dh = 16, 512, 256
        return {
            "x": _w((lambda *s: torch.randn(*s, dtype=torch.bfloat16) * 0.8)(B, Sq, D)),
            "k_cache": _w((lambda *s: torch.randn(*s, dtype=torch.bfloat16) * 0.8)(B, H, Sk, Dh)),
            "v_cache": _w((lambda *s: torch.randn(*s, dtype=torch.bfloat16) * 0.05)(B, H, Sk, Dh)),
            "wq": _w((lambda *s: torch.randn(*s, dtype=torch.bfloat16) * 0.8)(D, H * Dh) * (D ** -0.5)),
            "wo": _w((lambda *s: torch.randn(*s, dtype=torch.bfloat16) * 0.05)(H * Dh, D) * ((H * Dh) ** -0.5)),
        }
    _B_in = _B_setup()

    return {
        "A_x": _A_in["x"],
        "A_k_cache": _A_in["k_cache"],
        "A_v_cache": _A_in["v_cache"],
        "A_wq": _A_in["wq"],
        "A_wo": _A_in["wo"],
        "B_x": _B_in["x"],
        "B_k_cache": _B_in["k_cache"],
        "B_v_cache": _B_in["v_cache"],
        "B_wq": _B_in["wq"],
        "B_wo": _B_in["wo"],
    }

def reference(A_x, A_k_cache, A_v_cache, A_wq, A_wo, B_x, B_k_cache, B_v_cache, B_wq, B_wo):
    def _A_ref(x, k_cache, v_cache, wq, wo):
        B, Sq, D = x.shape
        H, Dh = 16, 256
        q = (lambda x, *d: x.permute(*d))((x @ wq).reshape(B, Sq, H, Dh), 0, 2, 1, 3)
        scores = torch.einsum("bhqd,bhkd->bhqk", q, k_cache) * (Dh ** -0.5)
        p = _softmax(scores, axis=-1)
        o = torch.einsum("bhqk,bhkd->bhqd", p, v_cache)
        return (lambda x, *d: x.permute(*d))(o, 0, 2, 1, 3).reshape(B, Sq, H * Dh) @ wo

    def _B_ref(x, k_cache, v_cache, wq, wo):
        B, Sq, D = x.shape
        H, Dh = 16, 256
        q = (lambda x, *d: x.permute(*d))((x @ wq).reshape(B, Sq, H, Dh), 0, 2, 1, 3)
        scores = torch.einsum("bhqd,bhkd->bhqk", q, k_cache) * (Dh ** -0.5)
        p = _softmax(scores, axis=-1)
        o = torch.einsum("bhqk,bhkd->bhqd", p, v_cache)
        return (lambda x, *d: x.permute(*d))(o, 0, 2, 1, 3).reshape(B, Sq, H * Dh) @ wo

    a = _A_ref(A_x, A_k_cache, A_v_cache, A_wq, A_wo)
    b = _B_ref(B_x, B_k_cache, B_v_cache, B_wq, B_wo)
    return torch.concatenate([a, b], axis=-1)
```

```asm
; @launch grid=(256,1,1) block=(256,1,1) lds=163840
.amdgcn_target "amdgcn-amd-amdhsa--gfx950"
.text
.globl concat_heads__mha_block_cached__mha_block_cached__near_ridge_kernel
.p2align 8
.type concat_heads__mha_block_cached__mha_block_cached__near_ridge_kernel,@function
concat_heads__mha_block_cached__mha_block_cached__near_ridge_kernel:
s_cmp_ge_u32 s2,256
s_cbranch_scc1 L_end
s_load_dwordx16 s[72:87],s[0:1],0
s_load_dwordx4 s[88:91],s[0:1],64
s_load_dwordx4 s[52:55],s[0:1],80
s_load_dwordx2 s[56:57],s[0:1],96
v_lshrrev_b32 v1,6,v0
s_mov_b32 s69,s2
v_readfirstlane_b32 s28,v1
s_mov_b32 s27,0x20000
s_mov_b32 m0,135168
s_getpc_b64 s[24:25]
L_pc:
s_mov_b32 s26,M_end-L_pc
s_bfe_u32 s59,s69,196611
s_lshl_b32 s59,s59,2
s_add_u32 s59,s59,s28
s_mul_i32 s38,s59,5120
v_mbcnt_lo_u32_b32 v200,-1,0
v_mbcnt_hi_u32_b32 v200,-1,v200
v_min_u32 v200,39,v200
v_lshlrev_b32 v200,7,v200
buffer_load_dword v200,s[24:27],s38 offen offset:0 lds
s_bfe_u32 s41,s2,65538
s_bfe_u32 s40,s2,196613
s_bfe_u32 s58,s2,65536
s_lshl_b32 s58,s58,3
s_add_u32 s40,s40,s58
s_bfe_u32 s39,s2,131075
s_bfe_u32 s58,s2,65537
s_lshl_b32 s58,s58,2
s_add_u32 s39,s39,s58
s_mul_i32 s29,s28,4224
s_mov_b32 s61,0x3db8aa3b
s_mov_b32 s37,0
s_lshr_b32 s58,s39,1
s_add_u32 s59,s58,s28
s_cmp_eq_u32 s59,6
s_cselect_b32 s66,0,0x40000000
s_cselect_b32 s58,0,s58
s_mov_b32 s59,s58
s_mul_i32 s62,s59,14336
s_mov_b32 s68,s62
s_add_u32 s93,s62,7168
s_cmp_eq_u32 s58,1
s_cselect_b32 s59,0,1
s_mul_i32 s63,s59,14336
s_mov_b32 s94,s63
s_add_u32 s95,s63,7168
s_cmp_eq_u32 s58,2
s_cselect_b32 s59,0,2
s_mul_i32 s64,s59,14336
s_mov_b32 s96,s64
s_add_u32 s97,s64,7168
s_cmp_eq_u32 s58,3
s_cselect_b32 s59,0,3
s_mul_i32 s65,s59,14336
s_mov_b32 s98,s65
s_add_u32 s99,s65,7168
s_mov_b32 s7,0x20000
s_mov_b32 s11,0x20000
s_mov_b32 s15,0x20000
s_mov_b32 s19,0x20000
s_mov_b32 s23,0x20000
s_mov_b32 s27,0x20000
s_mov_b32 s6,215040
s_mov_b32 s10,262144
s_mov_b32 s14,262144
s_mov_b32 s22,0
v_mbcnt_lo_u32_b32 v254,-1,0
v_mbcnt_hi_u32_b32 v254,-1,v254
v_lshrrev_b32 v248,5,v254
v_and_b32 v254,31,v254
v_lshlrev_b32 v248,15,v248
v_lshl_add_u32 v254,v254,4,v248
v_mbcnt_lo_u32_b32 v255,-1,0
v_mbcnt_hi_u32_b32 v255,-1,v255
v_lshrrev_b32 v248,3,v255
v_and_b32 v249,6,v248
v_xor_b32 v255,v255,v249
v_and_b32 v255,7,v255
s_lshl_b32 s60,s28,6
v_add_u32 v248,s60,v248
v_mul_u32_u24 v248,896,v248
v_lshl_add_u32 v255,v255,4,v248
s_waitcnt lgkmcnt(0)
s_cmp_eq_u32 s41,0
s_cselect_b64 s[44:45],s[78:79],s[88:89]
s_cselect_b64 s[46:47],s[80:81],s[90:91]
s_cselect_b64 s[48:49],s[74:75],s[84:85]
s_cselect_b64 s[50:51],s[76:77],s[86:87]
s_cselect_b64 s[4:5],s[72:73],s[82:83]
s_lshl_b32 s0,s28,16
s_add_u32 s1,s0,8192
s_add_u32 s2,s0,16384
s_add_u32 s3,s0,24576
s_lshl_b32 s58,s39,10
s_add_u32 s58,s58,512
s_add_u32 s16,s44,s58
s_addc_u32 s17,s45,0
s_sub_u32 s18,3670016,s58
s_mul_i32 s59,s40,215040
s_add_u32 s4,s4,s59
s_addc_u32 s5,s5,0
s_add_u32 m0,s29,16896
v_mbcnt_lo_u32_b32 v200,-1,0
v_mbcnt_hi_u32_b32 v200,-1,v200
s_and_b32 s59,s39,3
s_lshl_b32 s59,s59,2
buffer_load_dwordx4 v254,s[16:19],s0 offen lds
s_add_u32 m0,m0,0x00000428
s_add_u32 s59,s59,s28
s_mul_i32 s59,s59,15
v_add_u32 v195,s59,v200
v_mul_u32_u24 v195,896,v195
buffer_load_dwordx4 v254,s[16:19],s1 offen lds
s_add_u32 m0,m0,0x00000418
v_cmp_gt_u32 vcc,15,v200
s_and_b32 s59,s40,7
s_lshl_b32 s59,s59,2
s_add_u32 s59,s59,s28
buffer_load_dwordx4 v254,s[16:19],s2 offen lds
s_add_u32 m0,m0,0x00000428
v_cndmask_b32 v195,-1,v195,vcc
s_mul_i32 s59,s59,2
v_lshrrev_b32 v197,2,v200
v_add_u32 v197,s59,v197
buffer_load_dwordx4 v254,s[16:19],s3 offen lds
s_add_u32 s16,s16,262144
s_addc_u32 s17,s17,0
s_sub_u32 s18,s18,262144
s_add_u32 m0,s29,67584
v_cmp_gt_u32 vcc,8,v200
v_and_b32 v200,3,v200
v_lshlrev_b32 v200,7,v200
v_lshl_add_u32 v197,v197,13,v200
buffer_load_dwordx4 v255,s[4:7],s68 offen offset:0 lds
s_add_u32 m0,m0,0x00000400
v_cndmask_b32 v197,-1,v197,vcc
s_lshl_b32 s67,s40,4
s_lshl_b32 s36,s39,1
s_add_u32 s67,s67,s36
buffer_load_dwordx4 v255,s[4:7],s93 offen offset:0 lds
s_add_u32 m0,m0,0x00000400
s_add_u32 s67,s67,1
s_lshl_b32 s67,s67,18
s_add_u32 s8,s48,s67
s_addc_u32 s9,s49,0
buffer_load_dwordx4 v255,s[4:7],s94 offen offset:0 lds
s_add_u32 m0,m0,0x00000400
s_add_u32 s12,s50,s67
s_addc_u32 s13,s51,0
s_lshl_b32 s30,s28,11
s_mov_b32 s31,s30
buffer_load_dwordx4 v255,s[4:7],s95 offen offset:0 lds
s_add_u32 m0,s29,84480
s_lshl_b32 s58,s41,4
s_add_u32 s58,s58,s40
s_lshl_b32 s58,s58,3
s_add_u32 s58,s58,s39
buffer_load_dwordx4 v255,s[4:7],s96 offen offset:0 lds
s_add_u32 m0,m0,0x00000400
s_lshl_b32 s58,s58,2
s_add_u32 s58,s58,s28
s_mul_i32 s58,s58,57344
s_add_u32 s20,s56,s58
s_addc_u32 s21,s57,0
buffer_load_dwordx4 v255,s[4:7],s97 offen offset:0 lds
s_add_u32 m0,m0,0x00000400
v_mbcnt_lo_u32_b32 v252,-1,0
v_mbcnt_hi_u32_b32 v252,-1,v252
v_lshrrev_b32 v248,2,v252
v_mul_u32_u24 v248,1056,v248
buffer_load_dwordx4 v255,s[4:7],s98 offen offset:0 lds
s_add_u32 m0,m0,0x00000400
v_and_b32 v252,3,v252
v_lshl_add_u32 v252,v252,4,v248
v_mbcnt_lo_u32_b32 v248,-1,0
v_mbcnt_hi_u32_b32 v248,-1,v248
buffer_load_dwordx4 v255,s[4:7],s99 offen offset:0 lds
s_add_u32 m0,s29,0
v_bfe_u32 v248,v248,2,1
v_lshl_add_u32 v252,v248,3,v252
v_mbcnt_lo_u32_b32 v253,-1,0
v_mbcnt_hi_u32_b32 v253,-1,v253
buffer_load_dwordx4 v254,s[16:19],s0 offen lds
s_add_u32 m0,m0,0x00000428
v_and_b32 v248,15,v253
v_add_u32 v249,4,v248
v_lshrrev_b32 v250,3,v249
v_and_b32 v250,1,v250
buffer_load_dwordx4 v254,s[16:19],s1 offen lds
s_add_u32 m0,m0,0x00000418
v_lshrrev_b32 v249,4,v249
v_lshlrev_b32 v249,3,v249
v_sub_u32 v249,v248,v249
v_lshl_add_u32 v249,v250,2,v249
buffer_load_dwordx4 v254,s[16:19],s2 offen lds
s_add_u32 m0,m0,0x00000428
v_lshrrev_b32 v253,4,v253
v_and_b32 v248,6,v249
v_xor_b32 v253,v253,v248
v_lshlrev_b32 v253,4,v253
buffer_load_dwordx4 v254,s[16:19],s3 offen lds
s_add_u32 s16,s16,262144
s_addc_u32 s17,s17,0
s_sub_u32 s18,s18,262144
s_mov_b32 m0,135168
v_lshl_add_u32 v253,v249,7,v253
s_add_u32 s60,s29,67584
v_add_u32 v253,s60,v253
v_mbcnt_lo_u32_b32 v248,-1,0
buffer_load_dword v197,s[16:19],0 offen offset:0 lds
s_add_u32 m0,s29,101248
v_mbcnt_hi_u32_b32 v248,-1,v248
v_lshlrev_b32 v248,4,v248
buffer_load_dwordx4 v255,s[4:7],s68 offen offset:128 lds
s_add_u32 m0,m0,0x00000400
s_nop 0
buffer_load_dwordx4 v255,s[4:7],s93 offen offset:128 lds
s_add_u32 m0,m0,0x00000400
s_nop 0
buffer_load_dwordx4 v255,s[4:7],s94 offen offset:128 lds
s_add_u32 m0,m0,0x00000400
s_nop 0
buffer_load_dwordx4 v255,s[4:7],s95 offen offset:128 lds
s_add_u32 m0,s29,118144
s_nop 0
buffer_load_dwordx4 v255,s[4:7],s96 offen offset:128 lds
s_add_u32 m0,m0,0x00000400
s_nop 0
buffer_load_dwordx4 v255,s[4:7],s97 offen offset:128 lds
s_add_u32 m0,m0,0x00000400
s_nop 0
buffer_load_dwordx4 v255,s[4:7],s98 offen offset:128 lds
s_add_u32 m0,m0,0x00000400
s_nop 0
buffer_load_dwordx4 v255,s[4:7],s99 offen offset:128 lds
s_mov_b32 m0,135168
s_nop 0
buffer_load_dword v195,s[4:7],0 offen offset:256 lds
s_mov_b32 s69,524288
buffer_load_dword v197,s[16:19],s69 offen offset:0 lds
s_cmp_eq_u32 s28,3
s_cbranch_scc1 M_start
L_start:
s_waitcnt vmcnt(15)
s_barrier
ds_read_b64_tr_b16 v[208:209],v252 offset:16896
ds_read_b64_tr_b16 v[210:211],v252 offset:17408
ds_read_b64_tr_b16 v[212:213],v252 offset:16904
ds_read_b64_tr_b16 v[214:215],v252 offset:17416
ds_read_b64_tr_b16 v[216:217],v252 offset:16960
ds_read_b64_tr_b16 v[218:219],v252 offset:17472
ds_read_b64_tr_b16 v[220:221],v252 offset:16968
ds_read_b64_tr_b16 v[222:223],v252 offset:17480
ds_read_b128 a[64:67],v253 offset:0
ds_read_b128 a[68:71],v253 offset:2048
ds_read_b128 a[72:75],v253 offset:16896
ds_read_b128 a[76:79],v253 offset:18944
v_xor_b32 v253,64,v253
ds_read_b128 a[80:83],v253 offset:0
ds_read_b128 a[84:87],v253 offset:2048
ds_read_b128 a[88:91],v253 offset:16896
ds_read_b128 a[92:95],v253 offset:18944
v_xor_b32 v253,64,v253
.p2alignl 6, 0xbf800000
L_item:
s_waitcnt lgkmcnt(4)
v_mfma_f32_16x16x32_bf16 v[0:3],v[208:211],a[64:67],0
ds_read_b64_tr_b16 v[224:225],v252 offset:17024
s_add_u32 m0,s29,33792
v_mfma_f32_16x16x32_bf16 v[4:7],v[208:211],a[68:71],0
ds_read_b64_tr_b16 v[226:227],v252 offset:17536
buffer_load_dwordx4 v254,s[16:19],s0 offen lds
v_mfma_f32_16x16x32_bf16 v[8:11],v[208:211],a[72:75],0
ds_read_b64_tr_b16 v[228:229],v252 offset:17032
s_add_u32 m0,m0,0x00000428
v_mfma_f32_16x16x32_bf16 v[12:15],v[208:211],a[76:79],0
ds_read_b64_tr_b16 v[230:231],v252 offset:17544
v_accvgpr_read_b32 v200,a96
v_mfma_f32_16x16x32_bf16 v[128:131],v[212:215],a[64:67],0
buffer_load_dwordx4 v254,s[16:19],s1 offen lds
s_add_u32 m0,m0,0x00000418
v_mfma_f32_16x16x32_bf16 v[132:135],v[212:215],a[68:71],0
v_accvgpr_read_b32 v201,a97
v_accvgpr_read_b32 v202,a98
v_mfma_f32_16x16x32_bf16 v[136:139],v[212:215],a[72:75],0
v_accvgpr_read_b32 v203,a99
v_accvgpr_read_b32 v204,a112
v_mfma_f32_16x16x32_bf16 v[140:143],v[212:215],a[76:79],0
buffer_load_dwordx4 v254,s[16:19],s2 offen lds
s_waitcnt lgkmcnt(15)
v_mfma_f32_16x16x32_bf16 v[16:19],v[216:219],a[64:67],0
ds_read_b64_tr_b16 v[232:233],v252 offset:17088
s_add_u32 m0,m0,0x00000428
v_mfma_f32_16x16x32_bf16 v[20:23],v[216:219],a[68:71],0
ds_read_b64_tr_b16 v[234:235],v252 offset:17600
v_accvgpr_read_b32 v205,a113
v_mfma_f32_16x16x32_bf16 v[24:27],v[216:219],a[72:75],0
ds_read_b64_tr_b16 v[236:237],v252 offset:17096
buffer_load_dwordx4 v254,s[16:19],s3 offen lds
v_mfma_f32_16x16x32_bf16 v[28:31],v[216:219],a[76:79],0
ds_read_b64_tr_b16 v[238:239],v252 offset:17608
v_accvgpr_read_b32 v206,a114
v_mfma_f32_16x16x32_bf16 v[144:147],v[220:223],a[64:67],0
s_add_u32 s16,s16,262144
s_addc_u32 s17,s17,0
v_mfma_f32_16x16x32_bf16 v[148:151],v[220:223],a[68:71],0
s_sub_u32 s18,s18,262144
s_add_u32 m0,s29,50688
v_mfma_f32_16x16x32_bf16 v[152:155],v[220:223],a[72:75],0
buffer_load_dwordx4 v254,s[16:19],s0 offen lds
s_add_u32 m0,m0,0x00000428
v_mfma_f32_16x16x32_bf16 v[156:159],v[220:223],a[76:79],0
v_accvgpr_read_b32 v207,a115
s_waitcnt lgkmcnt(4)
v_mfma_f32_16x16x32_bf16 v[32:35],v[224:227],a[64:67],0
ds_read_b64_tr_b16 v[208:209],v252 offset:17152
buffer_load_dwordx4 v254,s[16:19],s1 offen lds
v_mfma_f32_16x16x32_bf16 v[36:39],v[224:227],a[68:71],0
ds_read_b64_tr_b16 v[210:211],v252 offset:17664
s_add_u32 m0,m0,0x00000418
v_mfma_f32_16x16x32_bf16 v[40:43],v[224:227],a[72:75],0
ds_read_b64_tr_b16 v[212:213],v252 offset:17160
v_mul_f32 v200,v192,v200
v_mfma_f32_16x16x32_bf16 v[44:47],v[224:227],a[76:79],0
ds_read_b64_tr_b16 v[214:215],v252 offset:17672
buffer_load_dwordx4 v254,s[16:19],s2 offen lds
v_mfma_f32_16x16x32_bf16 v[160:163],v[228:231],a[64:67],0
s_add_u32 m0,m0,0x00000428
v_mul_f32 v201,v192,v201
v_mfma_f32_16x16x32_bf16 v[164:167],v[228:231],a[68:71],0
v_mul_f32 v202,v192,v202
v_mul_f32 v203,v192,v203
v_mfma_f32_16x16x32_bf16 v[168:171],v[228:231],a[72:75],0
buffer_load_dwordx4 v254,s[16:19],s3 offen lds
v_mul_f32 v204,v192,v204
v_mfma_f32_16x16x32_bf16 v[172:175],v[228:231],a[76:79],0
v_mul_f32 v205,v192,v205
s_waitcnt lgkmcnt(4)
v_mfma_f32_16x16x32_bf16 v[48:51],v[232:235],a[64:67],0
ds_read_b64_tr_b16 v[216:217],v252 offset:17216
v_mul_f32 v206,v192,v206
v_mfma_f32_16x16x32_bf16 v[52:55],v[232:235],a[68:71],0
ds_read_b64_tr_b16 v[218:219],v252 offset:17728
v_mul_f32 v207,v192,v207
v_mfma_f32_16x16x32_bf16 v[56:59],v[232:235],a[72:75],0
ds_read_b64_tr_b16 v[220:221],v252 offset:17224
v_cvt_pk_bf16_f32 v240,v200,v201
v_mfma_f32_16x16x32_bf16 v[60:63],v[232:235],a[76:79],0
ds_read_b64_tr_b16 v[222:223],v252 offset:17736
v_cvt_pk_bf16_f32 v241,v202,v203
v_mfma_f32_16x16x32_bf16 v[176:179],v[236:239],a[64:67],0
s_add_u32 s16,s16,262144
s_addc_u32 s17,s17,0
v_mfma_f32_16x16x32_bf16 v[180:183],v[236:239],a[68:71],0
s_sub_u32 s18,s18,262144
v_mbcnt_lo_u32_b32 v251,-1,0
v_mfma_f32_16x16x32_bf16 v[184:187],v[236:239],a[72:75],0
v_mbcnt_hi_u32_b32 v251,-1,v251
v_lshrrev_b32 v250,5,v251
v_mfma_f32_16x16x32_bf16 v[188:191],v[236:239],a[76:79],0
v_and_b32 v251,31,v251
s_waitcnt lgkmcnt(4)
v_mfma_f32_16x16x32_bf16 v[64:67],v[208:211],a[64:67],0
ds_read_b64_tr_b16 v[224:225],v252 offset:17280
v_lshlrev_b32 v250,13,v250
v_mfma_f32_16x16x32_bf16 v[68:71],v[208:211],a[68:71],0
ds_read_b64_tr_b16 v[226:227],v252 offset:17792
v_lshl_add_u32 v251,v251,4,v250
v_mfma_f32_16x16x32_bf16 v[72:75],v[208:211],a[72:75],0
ds_read_b64_tr_b16 v[228:229],v252 offset:17288
v_cvt_pk_bf16_f32 v242,v204,v205
v_mfma_f32_16x16x32_bf16 v[76:79],v[208:211],a[76:79],0
ds_read_b64_tr_b16 v[230:231],v252 offset:17800
v_cvt_pk_bf16_f32 v243,v206,v207
v_mfma_f32_16x16x32_bf16 a[0:3],v[212:215],a[64:67],0
buffer_store_dwordx4 v[240:243],v248,s[20:23],s62 offen offset:3072 sc1
v_accvgpr_read_b32 v200,a100
v_mfma_f32_16x16x32_bf16 a[4:7],v[212:215],a[68:71],0
v_accvgpr_read_b32 v201,a101
v_accvgpr_read_b32 v202,a102
v_mfma_f32_16x16x32_bf16 a[8:11],v[212:215],a[72:75],0
v_accvgpr_read_b32 v203,a103
v_accvgpr_read_b32 v204,a116
v_mfma_f32_16x16x32_bf16 a[12:15],v[212:215],a[76:79],0
v_accvgpr_read_b32 v205,a117
s_waitcnt lgkmcnt(4)
v_mfma_f32_16x16x32_bf16 v[80:83],v[216:219],a[64:67],0
ds_read_b64_tr_b16 v[232:233],v252 offset:17344
v_accvgpr_read_b32 v206,a118
v_mfma_f32_16x16x32_bf16 v[84:87],v[216:219],a[68:71],0
ds_read_b64_tr_b16 v[234:235],v252 offset:17856
v_accvgpr_read_b32 v207,a119
v_mfma_f32_16x16x32_bf16 v[88:91],v[216:219],a[72:75],0
ds_read_b64_tr_b16 v[236:237],v252 offset:17352
v_mul_f32 v200,v194,v200
v_mfma_f32_16x16x32_bf16 v[92:95],v[216:219],a[76:79],0
ds_read_b64_tr_b16 v[238:239],v252 offset:17864
v_mul_f32 v201,v194,v201
v_mfma_f32_16x16x32_bf16 a[16:19],v[220:223],a[64:67],0
v_mul_f32 v202,v194,v202
v_mul_f32 v203,v194,v203
v_mfma_f32_16x16x32_bf16 a[20:23],v[220:223],a[68:71],0
v_mul_f32 v204,v194,v204
v_mul_f32 v205,v194,v205
v_mfma_f32_16x16x32_bf16 a[24:27],v[220:223],a[72:75],0
v_mul_f32 v206,v194,v206
v_mul_f32 v207,v194,v207
v_mfma_f32_16x16x32_bf16 a[28:31],v[220:223],a[76:79],0
v_cvt_pk_bf16_f32 v244,v200,v201
s_waitcnt lgkmcnt(4)
v_mfma_f32_16x16x32_bf16 v[96:99],v[224:227],a[64:67],0
v_cvt_pk_bf16_f32 v245,v202,v203
v_cvt_pk_bf16_f32 v246,v204,v205
v_mfma_f32_16x16x32_bf16 v[100:103],v[224:227],a[68:71],0
s_waitcnt vmcnt(20) lgkmcnt(0)
s_barrier
v_mfma_f32_16x16x32_bf16 v[104:107],v[224:227],a[72:75],0
ds_read_b64_tr_b16 v[208:209],v252 offset:0
v_cvt_pk_bf16_f32 v247,v206,v207
v_mfma_f32_16x16x32_bf16 v[108:111],v[224:227],a[76:79],0
ds_read_b64_tr_b16 v[210:211],v252 offset:512
buffer_store_dwordx4 v[244:247],v248,s[20:23],s63 offen offset:3072 sc1
v_mfma_f32_16x16x32_bf16 a[32:35],v[228:231],a[64:67],0
ds_read_b64_tr_b16 v[212:213],v252 offset:8
v_accvgpr_read_b32 v200,a104
v_mfma_f32_16x16x32_bf16 a[36:39],v[228:231],a[68:71],0
ds_read_b64_tr_b16 v[214:215],v252 offset:520
v_accvgpr_read_b32 v201,a105
v_mfma_f32_16x16x32_bf16 a[40:43],v[228:231],a[72:75],0
v_accvgpr_read_b32 v202,a106
v_accvgpr_read_b32 v203,a107
v_mfma_f32_16x16x32_bf16 a[44:47],v[228:231],a[76:79],0
v_accvgpr_read_b32 v204,a120
v_accvgpr_read_b32 v205,a121
v_mfma_f32_16x16x32_bf16 v[112:115],v[232:235],a[64:67],0
ds_read_b64_tr_b16 v[216:217],v252 offset:64
v_accvgpr_read_b32 v206,a122
v_mfma_f32_16x16x32_bf16 v[116:119],v[232:235],a[68:71],0
ds_read_b64_tr_b16 v[218:219],v252 offset:576
v_accvgpr_read_b32 v207,a123
v_mfma_f32_16x16x32_bf16 v[120:123],v[232:235],a[72:75],0
ds_read_b64_tr_b16 v[220:221],v252 offset:72
v_mul_f32 v200,v196,v200
v_mfma_f32_16x16x32_bf16 v[124:127],v[232:235],a[76:79],0
ds_read_b64_tr_b16 v[222:223],v252 offset:584
v_mul_f32 v201,v196,v201
v_mfma_f32_16x16x32_bf16 a[48:51],v[236:239],a[64:67],0
v_mul_f32 v202,v196,v202
v_mul_f32 v203,v196,v203
v_mfma_f32_16x16x32_bf16 a[52:55],v[236:239],a[68:71],0
v_mul_f32 v204,v196,v204
v_mul_f32 v205,v196,v205
v_mfma_f32_16x16x32_bf16 a[56:59],v[236:239],a[72:75],0
v_mul_f32 v206,v196,v206
v_mul_f32 v207,v196,v207
v_mfma_f32_16x16x32_bf16 a[60:63],v[236:239],a[76:79],0
v_cvt_pk_bf16_f32 v240,v200,v201
s_waitcnt lgkmcnt(4)
v_mfma_f32_16x16x32_bf16 v[0:3],v[208:211],a[80:83],v[0:3]
ds_read_b64_tr_b16 v[224:225],v252 offset:128
v_cvt_pk_bf16_f32 v241,v202,v203
v_mfma_f32_16x16x32_bf16 v[4:7],v[208:211],a[84:87],v[4:7]
ds_read_b64_tr_b16 v[226:227],v252 offset:640
v_cvt_pk_bf16_f32 v242,v204,v205
v_mfma_f32_16x16x32_bf16 v[8:11],v[208:211],a[88:91],v[8:11]
ds_read_b64_tr_b16 v[228:229],v252 offset:136
v_cvt_pk_bf16_f32 v243,v206,v207
v_mfma_f32_16x16x32_bf16 v[12:15],v[208:211],a[92:95],v[12:15]
s_waitcnt vmcnt(12)
ds_read_b64_tr_b16 v[230:231],v252 offset:648
v_mfma_f32_16x16x32_bf16 v[128:131],v[212:215],a[80:83],v[128:131]
ds_read_b128 a[64:67],v253 offset:33792
buffer_store_dwordx4 v[240:243],v248,s[20:23],s64 offen offset:3072 sc1
v_mfma_f32_16x16x32_bf16 v[132:135],v[212:215],a[84:87],v[132:135]
ds_read_b128 a[68:71],v253 offset:35840
v_accvgpr_read_b32 v200,a108
v_mfma_f32_16x16x32_bf16 v[136:139],v[212:215],a[88:91],v[136:139]
ds_read_b128 a[72:75],v253 offset:50688
v_accvgpr_read_b32 v201,a109
v_mfma_f32_16x16x32_bf16 v[140:143],v[212:215],a[92:95],v[140:143]
v_accvgpr_read_b32 v202,a110
s_waitcnt lgkmcnt(7)
v_mfma_f32_16x16x32_bf16 v[16:19],v[216:219],a[80:83],v[16:19]
ds_read_b64_tr_b16 v[232:233],v252 offset:192
v_accvgpr_read_b32 v203,a111
v_mfma_f32_16x16x32_bf16 v[20:23],v[216:219],a[84:87],v[20:23]
ds_read_b64_tr_b16 v[234:235],v252 offset:704
v_accvgpr_read_b32 v204,a124
v_accvgpr_read_b32 v205,a125
v_accvgpr_read_b32 v206,a126
v_accvgpr_read_b32 v207,a127
v_mul_f32 v200,v198,v200
v_mul_f32 v201,v198,v201
v_mul_f32 v202,v198,v202
v_mul_f32 v203,v198,v203
v_mul_f32 v204,v198,v204
v_mul_f32 v205,v198,v205
v_mul_f32 v206,v198,v206
v_mul_f32 v207,v198,v207
v_cvt_pk_bf16_f32 v244,v200,v201
v_cvt_pk_bf16_f32 v245,v202,v203
v_cvt_pk_bf16_f32 v246,v204,v205
v_cvt_pk_bf16_f32 v247,v206,v207
buffer_store_dwordx4 v[244:247],v248,s[20:23],s65 offen offset:3072 sc1
v_mfma_f32_16x16x32_bf16 v[24:27],v[216:219],a[88:91],v[24:27]
ds_read_b64_tr_b16 v[236:237],v252 offset:200
v_mfma_f32_16x16x32_bf16 v[28:31],v[216:219],a[92:95],v[28:31]
ds_read_b64_tr_b16 v[238:239],v252 offset:712
v_mfma_f32_16x16x32_bf16 v[144:147],v[220:223],a[80:83],v[144:147]
ds_read_b128 a[76:79],v253 offset:52736
v_xor_b32 v253,64,v253
v_mfma_f32_16x16x32_bf16 v[148:151],v[220:223],a[84:87],v[148:151]
ds_read_b128 a[96:99],v253 offset:33792
v_mfma_f32_16x16x32_bf16 v[152:155],v[220:223],a[88:91],v[152:155]
ds_read_b128 a[100:103],v253 offset:35840
v_mfma_f32_16x16x32_bf16 v[156:159],v[220:223],a[92:95],v[156:159]
s_waitcnt lgkmcnt(10)
v_mfma_f32_16x16x32_bf16 v[32:35],v[224:227],a[80:83],v[32:35]
ds_read_b64_tr_b16 v[208:209],v252 offset:256
v_mfma_f32_16x16x32_bf16 v[36:39],v[224:227],a[84:87],v[36:39]
ds_read_b64_tr_b16 v[210:211],v252 offset:768
v_mfma_f32_16x16x32_bf16 v[40:43],v[224:227],a[88:91],v[40:43]
ds_read_b64_tr_b16 v[212:213],v252 offset:264
v_mfma_f32_16x16x32_bf16 v[44:47],v[224:227],a[92:95],v[44:47]
ds_read_b64_tr_b16 v[214:215],v252 offset:776
v_mfma_f32_16x16x32_bf16 v[160:163],v[228:231],a[80:83],v[160:163]
ds_read_b128 a[104:107],v253 offset:50688
v_mfma_f32_16x16x32_bf16 v[164:167],v[228:231],a[84:87],v[164:167]
ds_read_b128 a[108:111],v253 offset:52736
v_xor_b32 v253,64,v253
v_mfma_f32_16x16x32_bf16 v[168:171],v[228:231],a[88:91],v[168:171]
v_mfma_f32_16x16x32_bf16 v[172:175],v[228:231],a[92:95],v[172:175]
s_waitcnt lgkmcnt(9)
v_mfma_f32_16x16x32_bf16 v[48:51],v[232:235],a[80:83],v[48:51]
ds_read_b64_tr_b16 v[216:217],v252 offset:320
v_accvgpr_read_b32 v200,a128
v_mfma_f32_16x16x32_bf16 v[52:55],v[232:235],a[84:87],v[52:55]
ds_read_b64_tr_b16 v[218:219],v252 offset:832
v_accvgpr_read_b32 v201,a129
v_mfma_f32_16x16x32_bf16 v[56:59],v[232:235],a[88:91],v[56:59]
ds_read_b64_tr_b16 v[220:221],v252 offset:328
v_accvgpr_read_b32 v202,a130
v_mfma_f32_16x16x32_bf16 v[60:63],v[232:235],a[92:95],v[60:63]
ds_read_b64_tr_b16 v[222:223],v252 offset:840
v_accvgpr_read_b32 v203,a131
v_mfma_f32_16x16x32_bf16 v[176:179],v[236:239],a[80:83],v[176:179]
v_accvgpr_read_b32 v204,a144
v_accvgpr_read_b32 v205,a145
v_mfma_f32_16x16x32_bf16 v[180:183],v[236:239],a[84:87],v[180:183]
v_accvgpr_read_b32 v206,a146
v_accvgpr_read_b32 v207,a147
v_mfma_f32_16x16x32_bf16 v[184:187],v[236:239],a[88:91],v[184:187]
v_mul_f32 v200,v192,v200
v_mul_f32 v201,v192,v201
v_mfma_f32_16x16x32_bf16 v[188:191],v[236:239],a[92:95],v[188:191]
v_mul_f32 v202,v192,v202
s_waitcnt lgkmcnt(6)
v_mfma_f32_16x16x32_bf16 v[64:67],v[208:211],a[80:83],v[64:67]
ds_read_b64_tr_b16 v[224:225],v252 offset:384
v_mul_f32 v203,v192,v203
v_mfma_f32_16x16x32_bf16 v[68:71],v[208:211],a[84:87],v[68:71]
ds_read_b64_tr_b16 v[226:227],v252 offset:896
v_mul_f32 v204,v192,v204
v_mfma_f32_16x16x32_bf16 v[72:75],v[208:211],a[88:91],v[72:75]
ds_read_b64_tr_b16 v[228:229],v252 offset:392
v_mul_f32 v205,v192,v205
v_mfma_f32_16x16x32_bf16 v[76:79],v[208:211],a[92:95],v[76:79]
ds_read_b64_tr_b16 v[230:231],v252 offset:904
v_mul_f32 v206,v192,v206
v_mfma_f32_16x16x32_bf16 a[0:3],v[212:215],a[80:83],a[0:3]
v_mul_f32 v207,v192,v207
v_cvt_pk_bf16_f32 v240,v200,v201
v_mfma_f32_16x16x32_bf16 a[4:7],v[212:215],a[84:87],a[4:7]
v_cvt_pk_bf16_f32 v241,v202,v203
v_cvt_pk_bf16_f32 v242,v204,v205
v_mfma_f32_16x16x32_bf16 a[8:11],v[212:215],a[88:91],a[8:11]
v_cvt_pk_bf16_f32 v243,v206,v207
s_add_u32 s60,s62,4096
v_mfma_f32_16x16x32_bf16 a[12:15],v[212:215],a[92:95],a[12:15]
s_add_u32 m0,s29,84224
s_waitcnt lgkmcnt(4)
v_mfma_f32_16x16x32_bf16 v[80:83],v[216:219],a[80:83],v[80:83]
ds_read_b64_tr_b16 v[232:233],v252 offset:448
buffer_load_dwordx4 v255,s[4:7],s68 offen offset:256 lds
v_mfma_f32_16x16x32_bf16 v[84:87],v[216:219],a[84:87],v[84:87]
ds_read_b64_tr_b16 v[234:235],v252 offset:960
s_add_u32 m0,m0,0x00000400
v_mfma_f32_16x16x32_bf16 v[88:91],v[216:219],a[88:91],v[88:91]
ds_read_b64_tr_b16 v[236:237],v252 offset:456
buffer_store_dwordx4 v[240:243],v248,s[20:23],s60 offen offset:0 sc1
v_mfma_f32_16x16x32_bf16 v[92:95],v[216:219],a[92:95],v[92:95]
ds_read_b64_tr_b16 v[238:239],v252 offset:968
buffer_load_dwordx4 v255,s[4:7],s93 offen offset:256 lds
v_mfma_f32_16x16x32_bf16 a[16:19],v[220:223],a[80:83],a[16:19]
s_add_u32 m0,m0,0x00000400
v_mfma_f32_16x16x32_bf16 a[20:23],v[220:223],a[84:87],a[20:23]
v_mfma_f32_16x16x32_bf16 a[24:27],v[220:223],a[88:91],a[24:27]
buffer_load_dwordx4 v255,s[4:7],s94 offen offset:256 lds
s_add_u32 m0,m0,0x00000400
v_mfma_f32_16x16x32_bf16 a[28:31],v[220:223],a[92:95],a[28:31]
s_waitcnt lgkmcnt(4)
v_mfma_f32_16x16x32_bf16 v[96:99],v[224:227],a[80:83],v[96:99]
v_mfma_f32_16x16x32_bf16 v[100:103],v[224:227],a[84:87],v[100:103]
s_waitcnt vmcnt(8) lgkmcnt(0)
s_barrier
v_mfma_f32_16x16x32_bf16 v[104:107],v[224:227],a[88:91],v[104:107]
ds_read_b64_tr_b16 v[208:209],v252 offset:33792
buffer_load_dwordx4 v255,s[4:7],s95 offen offset:256 lds
v_mfma_f32_16x16x32_bf16 v[108:111],v[224:227],a[92:95],v[108:111]
ds_read_b64_tr_b16 v[210:211],v252 offset:34304
s_add_u32 m0,s29,101120
v_mfma_f32_16x16x32_bf16 a[32:35],v[228:231],a[80:83],a[32:35]
ds_read_b64_tr_b16 v[212:213],v252 offset:33800
buffer_load_dwordx4 v255,s[4:7],s96 offen offset:256 lds
v_mfma_f32_16x16x32_bf16 a[36:39],v[228:231],a[84:87],a[36:39]
ds_read_b64_tr_b16 v[214:215],v252 offset:34312
s_add_u32 m0,m0,0x00000400
v_mfma_f32_16x16x32_bf16 a[40:43],v[228:231],a[88:91],a[40:43]
v_mfma_f32_16x16x32_bf16 a[44:47],v[228:231],a[92:95],a[44:47]
buffer_load_dwordx4 v255,s[4:7],s97 offen offset:256 lds
s_add_u32 m0,m0,0x00000400
v_mfma_f32_16x16x32_bf16 v[112:115],v[232:235],a[80:83],v[112:115]
ds_read_b64_tr_b16 v[216:217],v252 offset:33856
v_mfma_f32_16x16x32_bf16 v[116:119],v[232:235],a[84:87],v[116:119]
ds_read_b64_tr_b16 v[218:219],v252 offset:34368
v_mfma_f32_16x16x32_bf16 v[120:123],v[232:235],a[88:91],v[120:123]
ds_read_b64_tr_b16 v[220:221],v252 offset:33864
buffer_load_dwordx4 v255,s[4:7],s98 offen offset:256 lds
v_mfma_f32_16x16x32_bf16 v[124:127],v[232:235],a[92:95],v[124:127]
ds_read_b64_tr_b16 v[222:223],v252 offset:34376
s_add_u32 m0,m0,0x00000400
v_mfma_f32_16x16x32_bf16 a[48:51],v[236:239],a[80:83],a[48:51]
v_mfma_f32_16x16x32_bf16 a[52:55],v[236:239],a[84:87],a[52:55]
buffer_load_dwordx4 v255,s[4:7],s99 offen offset:256 lds
v_mfma_f32_16x16x32_bf16 a[56:59],v[236:239],a[88:91],a[56:59]
v_mfma_f32_16x16x32_bf16 a[60:63],v[236:239],a[92:95],a[60:63]
s_add_u32 m0,s29,16896
s_waitcnt lgkmcnt(4)
v_mfma_f32_16x16x32_bf16 v[0:3],v[208:211],a[64:67],v[0:3]
ds_read_b64_tr_b16 v[224:225],v252 offset:33920
buffer_load_dwordx4 v254,s[16:19],s0 offen lds
v_mfma_f32_16x16x32_bf16 v[4:7],v[208:211],a[68:71],v[4:7]
ds_read_b64_tr_b16 v[226:227],v252 offset:34432
s_add_u32 m0,m0,0x00000428
v_mfma_f32_16x16x32_bf16 v[8:11],v[208:211],a[72:75],v[8:11]
ds_read_b64_tr_b16 v[228:229],v252 offset:33928
v_accvgpr_read_b32 v200,a132
v_mfma_f32_16x16x32_bf16 v[12:15],v[208:211],a[76:79],v[12:15]
ds_read_b64_tr_b16 v[230:231],v252 offset:34440
buffer_load_dwordx4 v254,s[16:19],s1 offen lds
v_mfma_f32_16x16x32_bf16 v[128:131],v[212:215],a[64:67],v[128:131]
s_add_u32 m0,m0,0x00000418
v_accvgpr_read_b32 v201,a133
v_mfma_f32_16x16x32_bf16 v[132:135],v[212:215],a[68:71],v[132:135]
v_accvgpr_read_b32 v202,a134
v_accvgpr_read_b32 v203,a135
v_mfma_f32_16x16x32_bf16 v[136:139],v[212:215],a[72:75],v[136:139]
buffer_load_dwordx4 v254,s[16:19],s2 offen lds
s_add_u32 m0,m0,0x00000428
v_mfma_f32_16x16x32_bf16 v[140:143],v[212:215],a[76:79],v[140:143]
v_accvgpr_read_b32 v204,a148
s_waitcnt lgkmcnt(4)
v_mfma_f32_16x16x32_bf16 v[16:19],v[216:219],a[64:67],v[16:19]
ds_read_b64_tr_b16 v[232:233],v252 offset:33984
v_accvgpr_read_b32 v205,a149
v_mfma_f32_16x16x32_bf16 v[20:23],v[216:219],a[68:71],v[20:23]
ds_read_b64_tr_b16 v[234:235],v252 offset:34496
buffer_load_dwordx4 v254,s[16:19],s3 offen lds
v_mfma_f32_16x16x32_bf16 v[24:27],v[216:219],a[72:75],v[24:27]
ds_read_b64_tr_b16 v[236:237],v252 offset:33992
v_accvgpr_read_b32 v206,a150
v_mfma_f32_16x16x32_bf16 v[28:31],v[216:219],a[76:79],v[28:31]
ds_read_b64_tr_b16 v[238:239],v252 offset:34504
v_accvgpr_read_b32 v207,a151
v_mfma_f32_16x16x32_bf16 v[144:147],v[220:223],a[64:67],v[144:147]
s_add_u32 s16,s16,262144
s_addc_u32 s17,s17,0
v_mfma_f32_16x16x32_bf16 v[148:151],v[220:223],a[68:71],v[148:151]
s_sub_u32 s18,s18,262144
s_add_u32 m0,s29,0
v_mfma_f32_16x16x32_bf16 v[152:155],v[220:223],a[72:75],v[152:155]
buffer_load_dwordx4 v254,s[16:19],s0 offen lds
s_add_u32 m0,m0,0x00000428
v_mfma_f32_16x16x32_bf16 v[156:159],v[220:223],a[76:79],v[156:159]
buffer_load_dwordx4 v254,s[16:19],s1 offen lds
s_waitcnt lgkmcnt(4)
v_mfma_f32_16x16x32_bf16 v[32:35],v[224:227],a[64:67],v[32:35]
ds_read_b64_tr_b16 v[208:209],v252 offset:34048
s_add_u32 m0,m0,0x00000418
v_mfma_f32_16x16x32_bf16 v[36:39],v[224:227],a[68:71],v[36:39]
ds_read_b64_tr_b16 v[210:211],v252 offset:34560
v_mul_f32 v200,v194,v200
v_mfma_f32_16x16x32_bf16 v[40:43],v[224:227],a[72:75],v[40:43]
ds_read_b64_tr_b16 v[212:213],v252 offset:34056
buffer_load_dwordx4 v254,s[16:19],s2 offen lds
v_mfma_f32_16x16x32_bf16 v[44:47],v[224:227],a[76:79],v[44:47]
ds_read_b64_tr_b16 v[214:215],v252 offset:34568
s_add_u32 m0,m0,0x00000428
v_mfma_f32_16x16x32_bf16 v[160:163],v[228:231],a[64:67],v[160:163]
v_mul_f32 v201,v194,v201
v_mul_f32 v202,v194,v202
v_mfma_f32_16x16x32_bf16 v[164:167],v[228:231],a[68:71],v[164:167]
buffer_load_dwordx4 v254,s[16:19],s3 offen lds
v_mul_f32 v203,v194,v203
v_mfma_f32_16x16x32_bf16 v[168:171],v[228:231],a[72:75],v[168:171]
s_add_u32 s16,s16,262144
s_addc_u32 s17,s17,0
v_mfma_f32_16x16x32_bf16 v[172:175],v[228:231],a[76:79],v[172:175]
s_sub_u32 s18,s18,262144
s_waitcnt lgkmcnt(4)
v_mfma_f32_16x16x32_bf16 v[48:51],v[232:235],a[64:67],v[48:51]
ds_read_b64_tr_b16 v[216:217],v252 offset:34112
s_add_u32 m0,s29,118272
v_mfma_f32_16x16x32_bf16 v[52:55],v[232:235],a[68:71],v[52:55]
ds_read_b64_tr_b16 v[218:219],v252 offset:34624
buffer_load_dword v195,s[4:7],0 offen offset:384 lds
v_mfma_f32_16x16x32_bf16 v[56:59],v[232:235],a[72:75],v[56:59]
ds_read_b64_tr_b16 v[220:221],v252 offset:34120
buffer_load_dword v197,s[16:19],0 offen offset:0 lds
v_mfma_f32_16x16x32_bf16 v[60:63],v[232:235],a[76:79],v[60:63]
ds_read_b64_tr_b16 v[222:223],v252 offset:34632
v_mul_f32 v204,v194,v204
v_mfma_f32_16x16x32_bf16 v[176:179],v[236:239],a[64:67],v[176:179]
v_mul_f32 v205,v194,v205
v_mul_f32 v206,v194,v206
v_mfma_f32_16x16x32_bf16 v[180:183],v[236:239],a[68:71],v[180:183]
v_mul_f32 v207,v194,v207
v_cvt_pk_bf16_f32 v244,v200,v201
v_mfma_f32_16x16x32_bf16 v[184:187],v[236:239],a[72:75],v[184:187]
v_cvt_pk_bf16_f32 v245,v202,v203
v_cvt_pk_bf16_f32 v246,v204,v205
v_mfma_f32_16x16x32_bf16 v[188:191],v[236:239],a[76:79],v[188:191]
v_cvt_pk_bf16_f32 v247,v206,v207
s_waitcnt lgkmcnt(4)
v_mfma_f32_16x16x32_bf16 v[64:67],v[208:211],a[64:67],v[64:67]
ds_read_b64_tr_b16 v[224:225],v252 offset:34176
s_add_u32 s60,s63,4096
v_mfma_f32_16x16x32_bf16 v[68:71],v[208:211],a[68:71],v[68:71]
ds_read_b64_tr_b16 v[226:227],v252 offset:34688
buffer_store_dwordx4 v[244:247],v248,s[20:23],s60 offen offset:0 sc1
v_mfma_f32_16x16x32_bf16 v[72:75],v[208:211],a[72:75],v[72:75]
ds_read_b64_tr_b16 v[228:229],v252 offset:34184
v_mfma_f32_16x16x32_bf16 v[76:79],v[208:211],a[76:79],v[76:79]
ds_read_b64_tr_b16 v[230:231],v252 offset:34696
v_mfma_f32_16x16x32_bf16 a[0:3],v[212:215],a[64:67],a[0:3]
v_mfma_f32_16x16x32_bf16 a[4:7],v[212:215],a[68:71],a[4:7]
v_mfma_f32_16x16x32_bf16 a[8:11],v[212:215],a[72:75],a[8:11]
v_mfma_f32_16x16x32_bf16 a[12:15],v[212:215],a[76:79],a[12:15]
s_waitcnt lgkmcnt(4)
v_mfma_f32_16x16x32_bf16 v[80:83],v[216:219],a[64:67],v[80:83]
ds_read_b64_tr_b16 v[232:233],v252 offset:34240
v_mfma_f32_16x16x32_bf16 v[84:87],v[216:219],a[68:71],v[84:87]
ds_read_b64_tr_b16 v[234:235],v252 offset:34752
v_mfma_f32_16x16x32_bf16 v[88:91],v[216:219],a[72:75],v[88:91]
ds_read_b64_tr_b16 v[236:237],v252 offset:34248
v_accvgpr_read_b32 v200,a136
v_mfma_f32_16x16x32_bf16 v[92:95],v[216:219],a[76:79],v[92:95]
ds_read_b64_tr_b16 v[238:239],v252 offset:34760
v_accvgpr_read_b32 v201,a137
v_mfma_f32_16x16x32_bf16 a[16:19],v[220:223],a[64:67],a[16:19]
v_accvgpr_read_b32 v202,a138
v_accvgpr_read_b32 v203,a139
v_mfma_f32_16x16x32_bf16 a[20:23],v[220:223],a[68:71],a[20:23]
v_accvgpr_read_b32 v204,a152
v_accvgpr_read_b32 v205,a153
v_mfma_f32_16x16x32_bf16 a[24:27],v[220:223],a[72:75],a[24:27]
v_accvgpr_read_b32 v206,a154
v_accvgpr_read_b32 v207,a155
v_mfma_f32_16x16x32_bf16 a[28:31],v[220:223],a[76:79],a[28:31]
v_mul_f32 v200,v196,v200
s_waitcnt lgkmcnt(4)
v_mfma_f32_16x16x32_bf16 v[96:99],v[224:227],a[64:67],v[96:99]
ds_read_b64_tr_b16 v[208:209],v252 offset:50688
v_mul_f32 v201,v196,v201
v_mfma_f32_16x16x32_bf16 v[100:103],v[224:227],a[68:71],v[100:103]
ds_read_b64_tr_b16 v[210:211],v252 offset:51200
v_mul_f32 v202,v196,v202
v_mfma_f32_16x16x32_bf16 v[104:107],v[224:227],a[72:75],v[104:107]
ds_read_b64_tr_b16 v[212:213],v252 offset:50696
v_mul_f32 v203,v196,v203
v_mfma_f32_16x16x32_bf16 v[108:111],v[224:227],a[76:79],v[108:111]
ds_read_b64_tr_b16 v[214:215],v252 offset:51208
v_mul_f32 v204,v196,v204
v_mfma_f32_16x16x32_bf16 a[32:35],v[228:231],a[64:67],a[32:35]
v_mul_f32 v205,v196,v205
v_mul_f32 v206,v196,v206
v_mfma_f32_16x16x32_bf16 a[36:39],v[228:231],a[68:71],a[36:39]
v_mul_f32 v207,v196,v207
v_cvt_pk_bf16_f32 v240,v200,v201
v_mfma_f32_16x16x32_bf16 a[40:43],v[228:231],a[72:75],a[40:43]
v_cvt_pk_bf16_f32 v241,v202,v203
v_cvt_pk_bf16_f32 v242,v204,v205
v_mfma_f32_16x16x32_bf16 a[44:47],v[228:231],a[76:79],a[44:47]
v_cvt_pk_bf16_f32 v243,v206,v207
s_waitcnt lgkmcnt(4)
v_mfma_f32_16x16x32_bf16 v[112:115],v[232:235],a[64:67],v[112:115]
ds_read_b64_tr_b16 v[216:217],v252 offset:50752
s_add_u32 s60,s64,4096
v_mfma_f32_16x16x32_bf16 v[116:119],v[232:235],a[68:71],v[116:119]
ds_read_b64_tr_b16 v[218:219],v252 offset:51264
buffer_store_dwordx4 v[240:243],v248,s[20:23],s60 offen offset:0 sc1
v_mfma_f32_16x16x32_bf16 v[120:123],v[232:235],a[72:75],v[120:123]
ds_read_b64_tr_b16 v[220:221],v252 offset:50760
v_mfma_f32_16x16x32_bf16 v[124:127],v[232:235],a[76:79],v[124:127]
ds_read_b64_tr_b16 v[222:223],v252 offset:51272
v_mfma_f32_16x16x32_bf16 a[48:51],v[236:239],a[64:67],a[48:51]
v_mfma_f32_16x16x32_bf16 a[52:55],v[236:239],a[68:71],a[52:55]
v_mfma_f32_16x16x32_bf16 a[56:59],v[236:239],a[72:75],a[56:59]
v_mfma_f32_16x16x32_bf16 a[60:63],v[236:239],a[76:79],a[60:63]
s_waitcnt lgkmcnt(4)
v_mfma_f32_16x16x32_bf16 v[0:3],v[208:211],a[96:99],v[0:3]
ds_read_b64_tr_b16 v[224:225],v252 offset:50816
v_mfma_f32_16x16x32_bf16 v[4:7],v[208:211],a[100:103],v[4:7]
ds_read_b64_tr_b16 v[226:227],v252 offset:51328
v_mfma_f32_16x16x32_bf16 v[8:11],v[208:211],a[104:107],v[8:11]
ds_read_b64_tr_b16 v[228:229],v252 offset:50824
v_mfma_f32_16x16x32_bf16 v[12:15],v[208:211],a[108:111],v[12:15]
s_waitcnt vmcnt(12)
ds_read_b64_tr_b16 v[230:231],v252 offset:51336
v_mfma_f32_16x16x32_bf16 v[128:131],v[212:215],a[96:99],v[128:131]
ds_read_b128 a[64:67],v253 offset:16896
v_mfma_f32_16x16x32_bf16 v[132:135],v[212:215],a[100:103],v[132:135]
ds_read_b128 a[68:71],v253 offset:18944
v_mfma_f32_16x16x32_bf16 v[136:139],v[212:215],a[104:107],v[136:139]
ds_read_b128 a[72:75],v253 offset:33792
v_mfma_f32_16x16x32_bf16 v[140:143],v[212:215],a[108:111],v[140:143]
s_waitcnt lgkmcnt(7)
v_mfma_f32_16x16x32_bf16 v[16:19],v[216:219],a[96:99],v[16:19]
ds_read_b64_tr_b16 v[232:233],v252 offset:50880
v_mfma_f32_16x16x32_bf16 v[20:23],v[216:219],a[100:103],v[20:23]
ds_read_b64_tr_b16 v[234:235],v252 offset:51392
v_mfma_f32_16x16x32_bf16 v[24:27],v[216:219],a[104:107],v[24:27]
ds_read_b64_tr_b16 v[236:237],v252 offset:50888
v_mfma_f32_16x16x32_bf16 v[28:31],v[216:219],a[108:111],v[28:31]
ds_read_b64_tr_b16 v[238:239],v252 offset:51400
v_mfma_f32_16x16x32_bf16 v[144:147],v[220:223],a[96:99],v[144:147]
ds_read_b128 a[76:79],v253 offset:35840
v_xor_b32 v253,64,v253
v_mfma_f32_16x16x32_bf16 v[148:151],v[220:223],a[100:103],v[148:151]
ds_read_b128 a[80:83],v253 offset:16896
v_mfma_f32_16x16x32_bf16 v[152:155],v[220:223],a[104:107],v[152:155]
ds_read_b128 a[84:87],v253 offset:18944
v_mfma_f32_16x16x32_bf16 v[156:159],v[220:223],a[108:111],v[156:159]
s_waitcnt lgkmcnt(10)
v_mfma_f32_16x16x32_bf16 v[32:35],v[224:227],a[96:99],v[32:35]
ds_read_b64_tr_b16 v[208:209],v252 offset:50944
v_mfma_f32_16x16x32_bf16 v[36:39],v[224:227],a[100:103],v[36:39]
ds_read_b64_tr_b16 v[210:211],v252 offset:51456
v_mfma_f32_16x16x32_bf16 v[40:43],v[224:227],a[104:107],v[40:43]
ds_read_b64_tr_b16 v[212:213],v252 offset:50952
v_mfma_f32_16x16x32_bf16 v[44:47],v[224:227],a[108:111],v[44:47]
ds_read_b64_tr_b16 v[214:215],v252 offset:51464
v_accvgpr_read_b32 v200,a140
v_mfma_f32_16x16x32_bf16 v[160:163],v[228:231],a[96:99],v[160:163]
ds_read_b128 a[88:91],v253 offset:33792
v_accvgpr_read_b32 v201,a141
v_mfma_f32_16x16x32_bf16 v[164:167],v[228:231],a[100:103],v[164:167]
ds_read_b128 a[92:95],v253 offset:35840
v_xor_b32 v253,64,v253
v_mfma_f32_16x16x32_bf16 v[168:171],v[228:231],a[104:107],v[168:171]
v_accvgpr_read_b32 v202,a142
v_accvgpr_read_b32 v203,a143
v_mfma_f32_16x16x32_bf16 v[172:175],v[228:231],a[108:111],v[172:175]
v_accvgpr_read_b32 v204,a156
s_waitcnt lgkmcnt(9)
v_mfma_f32_16x16x32_bf16 v[48:51],v[232:235],a[96:99],v[48:51]
ds_read_b64_tr_b16 v[216:217],v252 offset:51008
v_accvgpr_read_b32 v205,a157
v_mfma_f32_16x16x32_bf16 v[52:55],v[232:235],a[100:103],v[52:55]
ds_read_b64_tr_b16 v[218:219],v252 offset:51520
v_accvgpr_read_b32 v206,a158
v_mfma_f32_16x16x32_bf16 v[56:59],v[232:235],a[104:107],v[56:59]
ds_read_b64_tr_b16 v[220:221],v252 offset:51016
v_accvgpr_read_b32 v207,a159
v_mfma_f32_16x16x32_bf16 v[60:63],v[232:235],a[108:111],v[60:63]
ds_read_b64_tr_b16 v[222:223],v252 offset:51528
v_mul_f32 v200,v198,v200
v_mfma_f32_16x16x32_bf16 v[176:179],v[236:239],a[96:99],v[176:179]
v_mul_f32 v201,v198,v201
v_mul_f32 v202,v198,v202
v_mfma_f32_16x16x32_bf16 v[180:183],v[236:239],a[100:103],v[180:183]
v_mul_f32 v203,v198,v203
v_mul_f32 v204,v198,v204
v_mfma_f32_16x16x32_bf16 v[184:187],v[236:239],a[104:107],v[184:187]
v_mul_f32 v205,v198,v205
v_mul_f32 v206,v198,v206
v_mfma_f32_16x16x32_bf16 v[188:191],v[236:239],a[108:111],v[188:191]
v_mul_f32 v207,v198,v207
s_waitcnt lgkmcnt(6)
v_mfma_f32_16x16x32_bf16 v[64:67],v[208:211],a[96:99],v[64:67]
ds_read_b64_tr_b16 v[224:225],v252 offset:51072
v_cvt_pk_bf16_f32 v244,v200,v201
v_mfma_f32_16x16x32_bf16 v[68:71],v[208:211],a[100:103],v[68:71]
ds_read_b64_tr_b16 v[226:227],v252 offset:51584
v_cvt_pk_bf16_f32 v245,v202,v203
v_mfma_f32_16x16x32_bf16 v[72:75],v[208:211],a[104:107],v[72:75]
ds_read_b64_tr_b16 v[228:229],v252 offset:51080
v_cvt_pk_bf16_f32 v246,v204,v205
v_mfma_f32_16x16x32_bf16 v[76:79],v[208:211],a[108:111],v[76:79]
ds_read_b64_tr_b16 v[230:231],v252 offset:51592
v_cvt_pk_bf16_f32 v247,v206,v207
v_mfma_f32_16x16x32_bf16 a[0:3],v[212:215],a[96:99],a[0:3]
s_add_u32 s60,s65,4096
buffer_store_dwordx4 v[244:247],v248,s[20:23],s60 offen offset:0 sc1
v_mfma_f32_16x16x32_bf16 a[4:7],v[212:215],a[100:103],a[4:7]
v_mfma_f32_16x16x32_bf16 a[8:11],v[212:215],a[104:107],a[8:11]
v_mfma_f32_16x16x32_bf16 a[12:15],v[212:215],a[108:111],a[12:15]
s_add_u32 m0,s29,84096
s_waitcnt lgkmcnt(4)
v_mfma_f32_16x16x32_bf16 v[80:83],v[216:219],a[96:99],v[80:83]
ds_read_b64_tr_b16 v[232:233],v252 offset:51136
buffer_load_dwordx4 v255,s[4:7],s68 offen offset:384 lds
v_mfma_f32_16x16x32_bf16 v[84:87],v[216:219],a[100:103],v[84:87]
ds_read_b64_tr_b16 v[234:235],v252 offset:51648
s_add_u32 m0,m0,0x00000400
v_mfma_f32_16x16x32_bf16 v[88:91],v[216:219],a[104:107],v[88:91]
ds_read_b64_tr_b16 v[236:237],v252 offset:51144
v_mfma_f32_16x16x32_bf16 v[92:95],v[216:219],a[108:111],v[92:95]
ds_read_b64_tr_b16 v[238:239],v252 offset:51656
buffer_load_dwordx4 v255,s[4:7],s93 offen offset:384 lds
v_mfma_f32_16x16x32_bf16 a[16:19],v[220:223],a[96:99],a[16:19]
s_add_u32 m0,m0,0x00000400
v_mfma_f32_16x16x32_bf16 a[20:23],v[220:223],a[100:103],a[20:23]
v_mfma_f32_16x16x32_bf16 a[24:27],v[220:223],a[104:107],a[24:27]
buffer_load_dwordx4 v255,s[4:7],s94 offen offset:384 lds
s_add_u32 m0,m0,0x00000400
v_mfma_f32_16x16x32_bf16 a[28:31],v[220:223],a[108:111],a[28:31]
s_waitcnt lgkmcnt(4)
v_mfma_f32_16x16x32_bf16 v[96:99],v[224:227],a[96:99],v[96:99]
v_mfma_f32_16x16x32_bf16 v[100:103],v[224:227],a[100:103],v[100:103]
s_waitcnt vmcnt(8) lgkmcnt(0)
s_barrier
v_mfma_f32_16x16x32_bf16 v[104:107],v[224:227],a[104:107],v[104:107]
ds_read_b64_tr_b16 v[208:209],v252 offset:16896
buffer_load_dwordx4 v255,s[4:7],s95 offen offset:384 lds
v_mfma_f32_16x16x32_bf16 v[108:111],v[224:227],a[108:111],v[108:111]
ds_read_b64_tr_b16 v[210:211],v252 offset:17408
s_add_u32 m0,s29,100992
v_mfma_f32_16x16x32_bf16 a[32:35],v[228:231],a[96:99],a[32:35]
ds_read_b64_tr_b16 v[212:213],v252 offset:16904
buffer_load_dwordx4 v255,s[4:7],s96 offen offset:384 lds
v_mfma_f32_16x16x32_bf16 a[36:39],v[228:231],a[100:103],a[36:39]
ds_read_b64_tr_b16 v[214:215],v252 offset:17416
s_add_u32 m0,m0,0x00000400
v_mfma_f32_16x16x32_bf16 a[40:43],v[228:231],a[104:107],a[40:43]
v_mfma_f32_16x16x32_bf16 a[44:47],v[228:231],a[108:111],a[44:47]
buffer_load_dwordx4 v255,s[4:7],s97 offen offset:384 lds
s_add_u32 m0,m0,0x00000400
v_mfma_f32_16x16x32_bf16 v[112:115],v[232:235],a[96:99],v[112:115]
ds_read_b64_tr_b16 v[216:217],v252 offset:16960
v_mfma_f32_16x16x32_bf16 v[116:119],v[232:235],a[100:103],v[116:119]
ds_read_b64_tr_b16 v[218:219],v252 offset:17472
v_mfma_f32_16x16x32_bf16 v[120:123],v[232:235],a[104:107],v[120:123]
ds_read_b64_tr_b16 v[220:221],v252 offset:16968
buffer_load_dwordx4 v255,s[4:7],s98 offen offset:384 lds
v_mfma_f32_16x16x32_bf16 v[124:127],v[232:235],a[108:111],v[124:127]
ds_read_b64_tr_b16 v[222:223],v252 offset:17480
s_add_u32 m0,m0,0x00000400
v_mfma_f32_16x16x32_bf16 a[48:51],v[236:239],a[96:99],a[48:51]
v_accvgpr_read_b32 v200,a160
v_accvgpr_read_b32 v201,a161
v_mfma_f32_16x16x32_bf16 a[52:55],v[236:239],a[100:103],a[52:55]
buffer_load_dwordx4 v255,s[4:7],s99 offen offset:384 lds
v_accvgpr_read_b32 v202,a162
v_mfma_f32_16x16x32_bf16 a[56:59],v[236:239],a[104:107],a[56:59]
v_accvgpr_read_b32 v203,a163
v_accvgpr_read_b32 v204,a176
v_mfma_f32_16x16x32_bf16 a[60:63],v[236:239],a[108:111],a[60:63]
s_add_u32 m0,s29,33792
s_waitcnt lgkmcnt(4)
v_mfma_f32_16x16x32_bf16 v[0:3],v[208:211],a[64:67],v[0:3]
ds_read_b64_tr_b16 v[224:225],v252 offset:17024
buffer_load_dwordx4 v254,s[16:19],s0 offen lds
v_mfma_f32_16x16x32_bf16 v[4:7],v[208:211],a[68:71],v[4:7]
ds_read_b64_tr_b16 v[226:227],v252 offset:17536
s_add_u32 m0,m0,0x00000428
v_mfma_f32_16x16x32_bf16 v[8:11],v[208:211],a[72:75],v[8:11]
ds_read_b64_tr_b16 v[228:229],v252 offset:17032
v_accvgpr_read_b32 v205,a177
v_mfma_f32_16x16x32_bf16 v[12:15],v[208:211],a[76:79],v[12:15]
ds_read_b64_tr_b16 v[230:231],v252 offset:17544
buffer_load_dwordx4 v254,s[16:19],s1 offen lds
v_mfma_f32_16x16x32_bf16 v[128:131],v[212:215],a[64:67],v[128:131]
s_add_u32 m0,m0,0x00000418
v_accvgpr_read_b32 v206,a178
v_mfma_f32_16x16x32_bf16 v[132:135],v[212:215],a[68:71],v[132:135]
v_accvgpr_read_b32 v207,a179
v_mul_f32 v200,v192,v200
v_mfma_f32_16x16x32_bf16 v[136:139],v[212:215],a[72:75],v[136:139]
buffer_load_dwordx4 v254,s[16:19],s2 offen lds
s_add_u32 m0,m0,0x00000428
v_mfma_f32_16x16x32_bf16 v[140:143],v[212:215],a[76:79],v[140:143]
v_mul_f32 v201,v192,v201
s_waitcnt lgkmcnt(4)
v_mfma_f32_16x16x32_bf16 v[16:19],v[216:219],a[64:67],v[16:19]
ds_read_b64_tr_b16 v[232:233],v252 offset:17088
v_mul_f32 v202,v192,v202
v_mfma_f32_16x16x32_bf16 v[20:23],v[216:219],a[68:71],v[20:23]
ds_read_b64_tr_b16 v[234:235],v252 offset:17600
buffer_load_dwordx4 v254,s[16:19],s3 offen lds
v_mfma_f32_16x16x32_bf16 v[24:27],v[216:219],a[72:75],v[24:27]
ds_read_b64_tr_b16 v[236:237],v252 offset:17096
v_mul_f32 v203,v192,v203
v_mfma_f32_16x16x32_bf16 v[28:31],v[216:219],a[76:79],v[28:31]
ds_read_b64_tr_b16 v[238:239],v252 offset:17608
v_mul_f32 v204,v192,v204
v_mfma_f32_16x16x32_bf16 v[144:147],v[220:223],a[64:67],v[144:147]
s_add_u32 s16,s16,262144
s_addc_u32 s17,s17,0
v_mfma_f32_16x16x32_bf16 v[148:151],v[220:223],a[68:71],v[148:151]
s_sub_u32 s18,s18,262144
s_add_u32 m0,s29,50688
v_mfma_f32_16x16x32_bf16 v[152:155],v[220:223],a[72:75],v[152:155]
buffer_load_dwordx4 v254,s[16:19],s0 offen lds
s_add_u32 m0,m0,0x00000428
v_mfma_f32_16x16x32_bf16 v[156:159],v[220:223],a[76:79],v[156:159]
buffer_load_dwordx4 v254,s[16:19],s1 offen lds
s_waitcnt lgkmcnt(4)
v_mfma_f32_16x16x32_bf16 v[32:35],v[224:227],a[64:67],v[32:35]
ds_read_b64_tr_b16 v[208:209],v252 offset:17152
s_add_u32 m0,m0,0x00000418
v_mfma_f32_16x16x32_bf16 v[36:39],v[224:227],a[68:71],v[36:39]
ds_read_b64_tr_b16 v[210:211],v252 offset:17664
v_mul_f32 v205,v192,v205
v_mfma_f32_16x16x32_bf16 v[40:43],v[224:227],a[72:75],v[40:43]
ds_read_b64_tr_b16 v[212:213],v252 offset:17160
buffer_load_dwordx4 v254,s[16:19],s2 offen lds
v_mfma_f32_16x16x32_bf16 v[44:47],v[224:227],a[76:79],v[44:47]
ds_read_b64_tr_b16 v[214:215],v252 offset:17672
s_add_u32 m0,m0,0x00000428
v_mfma_f32_16x16x32_bf16 v[160:163],v[228:231],a[64:67],v[160:163]
v_mul_f32 v206,v192,v206
v_mul_f32 v207,v192,v207
v_mfma_f32_16x16x32_bf16 v[164:167],v[228:231],a[68:71],v[164:167]
buffer_load_dwordx4 v254,s[16:19],s3 offen lds
v_cvt_pk_bf16_f32 v240,v200,v201
v_mfma_f32_16x16x32_bf16 v[168:171],v[228:231],a[72:75],v[168:171]
s_add_u32 s16,s16,262144
s_addc_u32 s17,s17,0
v_mfma_f32_16x16x32_bf16 v[172:175],v[228:231],a[76:79],v[172:175]
s_sub_u32 s18,s18,262144
s_waitcnt lgkmcnt(4)
v_mfma_f32_16x16x32_bf16 v[48:51],v[232:235],a[64:67],v[48:51]
ds_read_b64_tr_b16 v[216:217],v252 offset:17216
s_add_u32 m0,s29,118272
v_mfma_f32_16x16x32_bf16 v[52:55],v[232:235],a[68:71],v[52:55]
ds_read_b64_tr_b16 v[218:219],v252 offset:17728
buffer_load_dword v195,s[4:7],0 offen offset:512 lds
v_mfma_f32_16x16x32_bf16 v[56:59],v[232:235],a[72:75],v[56:59]
ds_read_b64_tr_b16 v[220:221],v252 offset:17224
buffer_load_dword v197,s[16:19],0 offen offset:0 lds
v_mfma_f32_16x16x32_bf16 v[60:63],v[232:235],a[76:79],v[60:63]
ds_read_b64_tr_b16 v[222:223],v252 offset:17736
v_cvt_pk_bf16_f32 v241,v202,v203
v_mfma_f32_16x16x32_bf16 v[176:179],v[236:239],a[64:67],v[176:179]
v_cvt_pk_bf16_f32 v242,v204,v205
v_cvt_pk_bf16_f32 v243,v206,v207
v_mfma_f32_16x16x32_bf16 v[180:183],v[236:239],a[68:71],v[180:183]
s_add_u32 s60,s62,4096
buffer_store_dwordx4 v[240:243],v248,s[20:23],s60 offen offset:1024 sc1
v_mfma_f32_16x16x32_bf16 v[184:187],v[236:239],a[72:75],v[184:187]
v_mfma_f32_16x16x32_bf16 v[188:191],v[236:239],a[76:79],v[188:191]
s_waitcnt lgkmcnt(4)
v_mfma_f32_16x16x32_bf16 v[64:67],v[208:211],a[64:67],v[64:67]
ds_read_b64_tr_b16 v[224:225],v252 offset:17280
v_mfma_f32_16x16x32_bf16 v[68:71],v[208:211],a[68:71],v[68:71]
ds_read_b64_tr_b16 v[226:227],v252 offset:17792
v_mfma_f32_16x16x32_bf16 v[72:75],v[208:211],a[72:75],v[72:75]
ds_read_b64_tr_b16 v[228:229],v252 offset:17288
v_mfma_f32_16x16x32_bf16 v[76:79],v[208:211],a[76:79],v[76:79]
ds_read_b64_tr_b16 v[230:231],v252 offset:17800
v_mfma_f32_16x16x32_bf16 a[0:3],v[212:215],a[64:67],a[0:3]
v_mfma_f32_16x16x32_bf16 a[4:7],v[212:215],a[68:71],a[4:7]
v_accvgpr_read_b32 v200,a164
v_accvgpr_read_b32 v201,a165
v_mfma_f32_16x16x32_bf16 a[8:11],v[212:215],a[72:75],a[8:11]
v_accvgpr_read_b32 v202,a166
v_accvgpr_read_b32 v203,a167
v_mfma_f32_16x16x32_bf16 a[12:15],v[212:215],a[76:79],a[12:15]
v_accvgpr_read_b32 v204,a180
s_waitcnt lgkmcnt(4)
v_mfma_f32_16x16x32_bf16 v[80:83],v[216:219],a[64:67],v[80:83]
ds_read_b64_tr_b16 v[232:233],v252 offset:17344
v_accvgpr_read_b32 v205,a181
v_mfma_f32_16x16x32_bf16 v[84:87],v[216:219],a[68:71],v[84:87]
ds_read_b64_tr_b16 v[234:235],v252 offset:17856
v_accvgpr_read_b32 v206,a182
v_mfma_f32_16x16x32_bf16 v[88:91],v[216:219],a[72:75],v[88:91]
ds_read_b64_tr_b16 v[236:237],v252 offset:17352
v_accvgpr_read_b32 v207,a183
v_mfma_f32_16x16x32_bf16 v[92:95],v[216:219],a[76:79],v[92:95]
ds_read_b64_tr_b16 v[238:239],v252 offset:17864
v_mul_f32 v200,v194,v200
v_mfma_f32_16x16x32_bf16 a[16:19],v[220:223],a[64:67],a[16:19]
v_mul_f32 v201,v194,v201
v_mul_f32 v202,v194,v202
v_mfma_f32_16x16x32_bf16 a[20:23],v[220:223],a[68:71],a[20:23]
v_mul_f32 v203,v194,v203
v_mul_f32 v204,v194,v204
v_mfma_f32_16x16x32_bf16 a[24:27],v[220:223],a[72:75],a[24:27]
v_mul_f32 v205,v194,v205
v_mul_f32 v206,v194,v206
v_mfma_f32_16x16x32_bf16 a[28:31],v[220:223],a[76:79],a[28:31]
v_mul_f32 v207,v194,v207
s_waitcnt lgkmcnt(4)
v_mfma_f32_16x16x32_bf16 v[96:99],v[224:227],a[64:67],v[96:99]
ds_read_b64_tr_b16 v[208:209],v252 offset:0
v_cvt_pk_bf16_f32 v244,v200,v201
v_mfma_f32_16x16x32_bf16 v[100:103],v[224:227],a[68:71],v[100:103]
ds_read_b64_tr_b16 v[210:211],v252 offset:512
v_cvt_pk_bf16_f32 v245,v202,v203
v_mfma_f32_16x16x32_bf16 v[104:107],v[224:227],a[72:75],v[104:107]
ds_read_b64_tr_b16 v[212:213],v252 offset:8
v_cvt_pk_bf16_f32 v246,v204,v205
v_mfma_f32_16x16x32_bf16 v[108:111],v[224:227],a[76:79],v[108:111]
ds_read_b64_tr_b16 v[214:215],v252 offset:520
v_cvt_pk_bf16_f32 v247,v206,v207
v_mfma_f32_16x16x32_bf16 a[32:35],v[228:231],a[64:67],a[32:35]
s_add_u32 s60,s63,4096
buffer_store_dwordx4 v[244:247],v248,s[20:23],s60 offen offset:1024 sc1
v_mfma_f32_16x16x32_bf16 a[36:39],v[228:231],a[68:71],a[36:39]
v_mfma_f32_16x16x32_bf16 a[40:43],v[228:231],a[72:75],a[40:43]
v_mfma_f32_16x16x32_bf16 a[44:47],v[228:231],a[76:79],a[44:47]
s_waitcnt lgkmcnt(4)
v_mfma_f32_16x16x32_bf16 v[112:115],v[232:235],a[64:67],v[112:115]
ds_read_b64_tr_b16 v[216:217],v252 offset:64
v_mfma_f32_16x16x32_bf16 v[116:119],v[232:235],a[68:71],v[116:119]
ds_read_b64_tr_b16 v[218:219],v252 offset:576
v_mfma_f32_16x16x32_bf16 v[120:123],v[232:235],a[72:75],v[120:123]
ds_read_b64_tr_b16 v[220:221],v252 offset:72
v_mfma_f32_16x16x32_bf16 v[124:127],v[232:235],a[76:79],v[124:127]
ds_read_b64_tr_b16 v[222:223],v252 offset:584
v_mfma_f32_16x16x32_bf16 a[48:51],v[236:239],a[64:67],a[48:51]
v_mfma_f32_16x16x32_bf16 a[52:55],v[236:239],a[68:71],a[52:55]
v_mfma_f32_16x16x32_bf16 a[56:59],v[236:239],a[72:75],a[56:59]
v_mfma_f32_16x16x32_bf16 a[60:63],v[236:239],a[76:79],a[60:63]
s_waitcnt lgkmcnt(4)
v_mfma_f32_16x16x32_bf16 v[0:3],v[208:211],a[80:83],v[0:3]
ds_read_b64_tr_b16 v[224:225],v252 offset:128
v_mfma_f32_16x16x32_bf16 v[4:7],v[208:211],a[84:87],v[4:7]
ds_read_b64_tr_b16 v[226:227],v252 offset:640
v_mfma_f32_16x16x32_bf16 v[8:11],v[208:211],a[88:91],v[8:11]
ds_read_b64_tr_b16 v[228:229],v252 offset:136
v_mfma_f32_16x16x32_bf16 v[12:15],v[208:211],a[92:95],v[12:15]
s_waitcnt vmcnt(12)
ds_read_b64_tr_b16 v[230:231],v252 offset:648
v_mfma_f32_16x16x32_bf16 v[128:131],v[212:215],a[80:83],v[128:131]
ds_read_b128 a[64:67],v253 offset:16896
v_mfma_f32_16x16x32_bf16 v[132:135],v[212:215],a[84:87],v[132:135]
ds_read_b128 a[68:71],v253 offset:18944
v_mfma_f32_16x16x32_bf16 v[136:139],v[212:215],a[88:91],v[136:139]
ds_read_b128 a[72:75],v253 offset:33792
v_mfma_f32_16x16x32_bf16 v[140:143],v[212:215],a[92:95],v[140:143]
s_waitcnt lgkmcnt(7)
v_mfma_f32_16x16x32_bf16 v[16:19],v[216:219],a[80:83],v[16:19]
ds_read_b64_tr_b16 v[232:233],v252 offset:192
v_mfma_f32_16x16x32_bf16 v[20:23],v[216:219],a[84:87],v[20:23]
ds_read_b64_tr_b16 v[234:235],v252 offset:704
v_mfma_f32_16x16x32_bf16 v[24:27],v[216:219],a[88:91],v[24:27]
ds_read_b64_tr_b16 v[236:237],v252 offset:200
v_mfma_f32_16x16x32_bf16 v[28:31],v[216:219],a[92:95],v[28:31]
ds_read_b64_tr_b16 v[238:239],v252 offset:712
v_mfma_f32_16x16x32_bf16 v[144:147],v[220:223],a[80:83],v[144:147]
ds_read_b128 a[76:79],v253 offset:35840
v_xor_b32 v253,64,v253
v_mfma_f32_16x16x32_bf16 v[148:151],v[220:223],a[84:87],v[148:151]
ds_read_b128 a[96:99],v253 offset:16896
v_mfma_f32_16x16x32_bf16 v[152:155],v[220:223],a[88:91],v[152:155]
ds_read_b128 a[100:103],v253 offset:18944
v_accvgpr_read_b32 v200,a168
v_mfma_f32_16x16x32_bf16 v[156:159],v[220:223],a[92:95],v[156:159]
v_accvgpr_read_b32 v201,a169
s_waitcnt lgkmcnt(10)
v_mfma_f32_16x16x32_bf16 v[32:35],v[224:227],a[80:83],v[32:35]
ds_read_b64_tr_b16 v[208:209],v252 offset:256
v_accvgpr_read_b32 v202,a170
v_mfma_f32_16x16x32_bf16 v[36:39],v[224:227],a[84:87],v[36:39]
ds_read_b64_tr_b16 v[210:211],v252 offset:768
v_accvgpr_read_b32 v203,a171
v_mfma_f32_16x16x32_bf16 v[40:43],v[224:227],a[88:91],v[40:43]
ds_read_b64_tr_b16 v[212:213],v252 offset:264
v_accvgpr_read_b32 v204,a184
v_mfma_f32_16x16x32_bf16 v[44:47],v[224:227],a[92:95],v[44:47]
ds_read_b64_tr_b16 v[214:215],v252 offset:776
v_accvgpr_read_b32 v205,a185
v_mfma_f32_16x16x32_bf16 v[160:163],v[228:231],a[80:83],v[160:163]
ds_read_b128 a[104:107],v253 offset:33792
v_accvgpr_read_b32 v206,a186
v_mfma_f32_16x16x32_bf16 v[164:167],v[228:231],a[84:87],v[164:167]
ds_read_b128 a[108:111],v253 offset:35840
v_xor_b32 v253,64,v253
v_mfma_f32_16x16x32_bf16 v[168:171],v[228:231],a[88:91],v[168:171]
v_accvgpr_read_b32 v207,a187
v_mul_f32 v200,v196,v200
v_mfma_f32_16x16x32_bf16 v[172:175],v[228:231],a[92:95],v[172:175]
v_mul_f32 v201,v196,v201
s_waitcnt lgkmcnt(9)
v_mfma_f32_16x16x32_bf16 v[48:51],v[232:235],a[80:83],v[48:51]
ds_read_b64_tr_b16 v[216:217],v252 offset:320
v_mul_f32 v202,v196,v202
v_mfma_f32_16x16x32_bf16 v[52:55],v[232:235],a[84:87],v[52:55]
ds_read_b64_tr_b16 v[218:219],v252 offset:832
v_mul_f32 v203,v196,v203
v_mfma_f32_16x16x32_bf16 v[56:59],v[232:235],a[88:91],v[56:59]
ds_read_b64_tr_b16 v[220:221],v252 offset:328
v_mul_f32 v204,v196,v204
v_mfma_f32_16x16x32_bf16 v[60:63],v[232:235],a[92:95],v[60:63]
ds_read_b64_tr_b16 v[222:223],v252 offset:840
v_mul_f32 v205,v196,v205
v_mfma_f32_16x16x32_bf16 v[176:179],v[236:239],a[80:83],v[176:179]
v_mul_f32 v206,v196,v206
v_mul_f32 v207,v196,v207
v_mfma_f32_16x16x32_bf16 v[180:183],v[236:239],a[84:87],v[180:183]
v_cvt_pk_bf16_f32 v240,v200,v201
v_cvt_pk_bf16_f32 v241,v202,v203
v_mfma_f32_16x16x32_bf16 v[184:187],v[236:239],a[88:91],v[184:187]
v_cvt_pk_bf16_f32 v242,v204,v205
v_cvt_pk_bf16_f32 v243,v206,v207
v_mfma_f32_16x16x32_bf16 v[188:191],v[236:239],a[92:95],v[188:191]
s_add_u32 s60,s64,4096
s_waitcnt lgkmcnt(6)
v_mfma_f32_16x16x32_bf16 v[64:67],v[208:211],a[80:83],v[64:67]
ds_read_b64_tr_b16 v[224:225],v252 offset:384
buffer_store_dwordx4 v[240:243],v248,s[20:23],s60 offen offset:1024 sc1
v_mfma_f32_16x16x32_bf16 v[68:71],v[208:211],a[84:87],v[68:71]
ds_read_b64_tr_b16 v[226:227],v252 offset:896
v_mfma_f32_16x16x32_bf16 v[72:75],v[208:211],a[88:91],v[72:75]
ds_read_b64_tr_b16 v[228:229],v252 offset:392
v_mfma_f32_16x16x32_bf16 v[76:79],v[208:211],a[92:95],v[76:79]
ds_read_b64_tr_b16 v[230:231],v252 offset:904
v_mfma_f32_16x16x32_bf16 a[0:3],v[212:215],a[80:83],a[0:3]
v_mfma_f32_16x16x32_bf16 a[4:7],v[212:215],a[84:87],a[4:7]
v_mfma_f32_16x16x32_bf16 a[8:11],v[212:215],a[88:91],a[8:11]
v_mfma_f32_16x16x32_bf16 a[12:15],v[212:215],a[92:95],a[12:15]
s_add_u32 m0,s29,83968
s_waitcnt lgkmcnt(4)
v_mfma_f32_16x16x32_bf16 v[80:83],v[216:219],a[80:83],v[80:83]
ds_read_b64_tr_b16 v[232:233],v252 offset:448
buffer_load_dwordx4 v255,s[4:7],s68 offen offset:512 lds
v_mfma_f32_16x16x32_bf16 v[84:87],v[216:219],a[84:87],v[84:87]
ds_read_b64_tr_b16 v[234:235],v252 offset:960
s_add_u32 m0,m0,0x00000400
v_mfma_f32_16x16x32_bf16 v[88:91],v[216:219],a[88:91],v[88:91]
ds_read_b64_tr_b16 v[236:237],v252 offset:456
v_mfma_f32_16x16x32_bf16 v[92:95],v[216:219],a[92:95],v[92:95]
ds_read_b64_tr_b16 v[238:239],v252 offset:968
buffer_load_dwordx4 v255,s[4:7],s93 offen offset:512 lds
v_mfma_f32_16x16x32_bf16 a[16:19],v[220:223],a[80:83],a[16:19]
s_add_u32 m0,m0,0x00000400
v_mfma_f32_16x16x32_bf16 a[20:23],v[220:223],a[84:87],a[20:23]
v_mfma_f32_16x16x32_bf16 a[24:27],v[220:223],a[88:91],a[24:27]
buffer_load_dwordx4 v255,s[4:7],s94 offen offset:512 lds
s_add_u32 m0,m0,0x00000400
v_mfma_f32_16x16x32_bf16 a[28:31],v[220:223],a[92:95],a[28:31]
s_waitcnt lgkmcnt(4)
v_mfma_f32_16x16x32_bf16 v[96:99],v[224:227],a[80:83],v[96:99]
v_mfma_f32_16x16x32_bf16 v[100:103],v[224:227],a[84:87],v[100:103]
s_waitcnt vmcnt(8) lgkmcnt(0)
s_barrier
v_mfma_f32_16x16x32_bf16 v[104:107],v[224:227],a[88:91],v[104:107]
ds_read_b64_tr_b16 v[208:209],v252 offset:33792
buffer_load_dwordx4 v255,s[4:7],s95 offen offset:512 lds
v_mfma_f32_16x16x32_bf16 v[108:111],v[224:227],a[92:95],v[108:111]
ds_read_b64_tr_b16 v[210:211],v252 offset:34304
s_add_u32 m0,s29,100864
v_mfma_f32_16x16x32_bf16 a[32:35],v[228:231],a[80:83],a[32:35]
ds_read_b64_tr_b16 v[212:213],v252 offset:33800
buffer_load_dwordx4 v255,s[4:7],s96 offen offset:512 lds
v_mfma_f32_16x16x32_bf16 a[36:39],v[228:231],a[84:87],a[36:39]
ds_read_b64_tr_b16 v[214:215],v252 offset:34312
s_add_u32 m0,m0,0x00000400
v_mfma_f32_16x16x32_bf16 a[40:43],v[228:231],a[88:91],a[40:43]
v_mfma_f32_16x16x32_bf16 a[44:47],v[228:231],a[92:95],a[44:47]
buffer_load_dwordx4 v255,s[4:7],s97 offen offset:512 lds
s_add_u32 m0,m0,0x00000400
v_mfma_f32_16x16x32_bf16 v[112:115],v[232:235],a[80:83],v[112:115]
ds_read_b64_tr_b16 v[216:217],v252 offset:33856
v_accvgpr_read_b32 v200,a172
v_mfma_f32_16x16x32_bf16 v[116:119],v[232:235],a[84:87],v[116:119]
ds_read_b64_tr_b16 v[218:219],v252 offset:34368
v_accvgpr_read_b32 v201,a173
v_mfma_f32_16x16x32_bf16 v[120:123],v[232:235],a[88:91],v[120:123]
ds_read_b64_tr_b16 v[220:221],v252 offset:33864
buffer_load_dwordx4 v255,s[4:7],s98 offen offset:512 lds
v_mfma_f32_16x16x32_bf16 v[124:127],v[232:235],a[92:95],v[124:127]
ds_read_b64_tr_b16 v[222:223],v252 offset:34376
s_add_u32 m0,m0,0x00000400
v_mfma_f32_16x16x32_bf16 a[48:51],v[236:239],a[80:83],a[48:51]
v_accvgpr_read_b32 v202,a174
v_accvgpr_read_b32 v203,a175
v_mfma_f32_16x16x32_bf16 a[52:55],v[236:239],a[84:87],a[52:55]
buffer_load_dwordx4 v255,s[4:7],s99 offen offset:512 lds
v_accvgpr_read_b32 v204,a188
v_mfma_f32_16x16x32_bf16 a[56:59],v[236:239],a[88:91],a[56:59]
v_accvgpr_read_b32 v205,a189
v_accvgpr_read_b32 v206,a190
v_mfma_f32_16x16x32_bf16 a[60:63],v[236:239],a[92:95],a[60:63]
s_add_u32 m0,s29,16896
s_waitcnt lgkmcnt(4)
v_mfma_f32_16x16x32_bf16 v[0:3],v[208:211],a[64:67],v[0:3]
ds_read_b64_tr_b16 v[224:225],v252 offset:33920
buffer_load_dwordx4 v254,s[16:19],s0 offen lds
v_mfma_f32_16x16x32_bf16 v[4:7],v[208:211],a[68:71],v[4:7]
ds_read_b64_tr_b16 v[226:227],v252 offset:34432
s_add_u32 m0,m0,0x00000428
v_mfma_f32_16x16x32_bf16 v[8:11],v[208:211],a[72:75],v[8:11]
ds_read_b64_tr_b16 v[228:229],v252 offset:33928
v_accvgpr_read_b32 v207,a191
v_mfma_f32_16x16x32_bf16 v[12:15],v[208:211],a[76:79],v[12:15]
ds_read_b64_tr_b16 v[230:231],v252 offset:34440
buffer_load_dwordx4 v254,s[16:19],s1 offen lds
v_mfma_f32_16x16x32_bf16 v[128:131],v[212:215],a[64:67],v[128:131]
s_add_u32 m0,m0,0x00000418
v_mul_f32 v200,v198,v200
v_mfma_f32_16x16x32_bf16 v[132:135],v[212:215],a[68:71],v[132:135]
v_mul_f32 v201,v198,v201
v_mul_f32 v202,v198,v202
v_mfma_f32_16x16x32_bf16 v[136:139],v[212:215],a[72:75],v[136:139]
buffer_load_dwordx4 v254,s[16:19],s2 offen lds
s_add_u32 m0,m0,0x00000428
v_mfma_f32_16x16x32_bf16 v[140:143],v[212:215],a[76:79],v[140:143]
v_mul_f32 v203,v198,v203
s_waitcnt lgkmcnt(4)
v_mfma_f32_16x16x32_bf16 v[16:19],v[216:219],a[64:67],v[16:19]
ds_read_b64_tr_b16 v[232:233],v252 offset:33984
v_mul_f32 v204,v198,v204
v_mfma_f32_16x16x32_bf16 v[20:23],v[216:219],a[68:71],v[20:23]
ds_read_b64_tr_b16 v[234:235],v252 offset:34496
buffer_load_dwordx4 v254,s[16:19],s3 offen lds
v_mfma_f32_16x16x32_bf16 v[24:27],v[216:219],a[72:75],v[24:27]
ds_read_b64_tr_b16 v[236:237],v252 offset:33992
v_mul_f32 v205,v198,v205
v_mfma_f32_16x16x32_bf16 v[28:31],v[216:219],a[76:79],v[28:31]
ds_read_b64_tr_b16 v[238:239],v252 offset:34504
v_mul_f32 v206,v198,v206
v_mfma_f32_16x16x32_bf16 v[144:147],v[220:223],a[64:67],v[144:147]
s_add_u32 s16,s16,262144
s_addc_u32 s17,s17,0
v_mfma_f32_16x16x32_bf16 v[148:151],v[220:223],a[68:71],v[148:151]
s_sub_u32 s18,s18,262144
s_add_u32 m0,s29,0
v_mfma_f32_16x16x32_bf16 v[152:155],v[220:223],a[72:75],v[152:155]
buffer_load_dwordx4 v254,s[16:19],s0 offen lds
s_add_u32 m0,m0,0x00000428
v_mfma_f32_16x16x32_bf16 v[156:159],v[220:223],a[76:79],v[156:159]
buffer_load_dwordx4 v254,s[16:19],s1 offen lds
s_waitcnt lgkmcnt(4)
v_mfma_f32_16x16x32_bf16 v[32:35],v[224:227],a[64:67],v[32:35]
ds_read_b64_tr_b16 v[208:209],v252 offset:34048
s_add_u32 m0,m0,0x00000418
v_mfma_f32_16x16x32_bf16 v[36:39],v[224:227],a[68:71],v[36:39]
ds_read_b64_tr_b16 v[210:211],v252 offset:34560
v_mul_f32 v207,v198,v207
v_mfma_f32_16x16x32_bf16 v[40:43],v[224:227],a[72:75],v[40:43]
ds_read_b64_tr_b16 v[212:213],v252 offset:34056
buffer_load_dwordx4 v254,s[16:19],s2 offen lds
v_mfma_f32_16x16x32_bf16 v[44:47],v[224:227],a[76:79],v[44:47]
ds_read_b64_tr_b16 v[214:215],v252 offset:34568
s_add_u32 m0,m0,0x00000428
v_mfma_f32_16x16x32_bf16 v[160:163],v[228:231],a[64:67],v[160:163]
v_cvt_pk_bf16_f32 v244,v200,v201
v_cvt_pk_bf16_f32 v245,v202,v203
v_mfma_f32_16x16x32_bf16 v[164:167],v[228:231],a[68:71],v[164:167]
buffer_load_dwordx4 v254,s[16:19],s3 offen lds
v_cvt_pk_bf16_f32 v246,v204,v205
v_mfma_f32_16x16x32_bf16 v[168:171],v[228:231],a[72:75],v[168:171]
s_add_u32 s16,s16,262144
s_addc_u32 s17,s17,0
v_mfma_f32_16x16x32_bf16 v[172:175],v[228:231],a[76:79],v[172:175]
s_sub_u32 s18,s18,262144
s_waitcnt lgkmcnt(4)
v_mfma_f32_16x16x32_bf16 v[48:51],v[232:235],a[64:67],v[48:51]
ds_read_b64_tr_b16 v[216:217],v252 offset:34112
s_add_u32 m0,s29,118272
v_mfma_f32_16x16x32_bf16 v[52:55],v[232:235],a[68:71],v[52:55]
ds_read_b64_tr_b16 v[218:219],v252 offset:34624
buffer_load_dword v195,s[4:7],0 offen offset:640 lds
v_mfma_f32_16x16x32_bf16 v[56:59],v[232:235],a[72:75],v[56:59]
ds_read_b64_tr_b16 v[220:221],v252 offset:34120
buffer_load_dword v197,s[16:19],0 offen offset:0 lds
v_mfma_f32_16x16x32_bf16 v[60:63],v[232:235],a[76:79],v[60:63]
ds_read_b64_tr_b16 v[222:223],v252 offset:34632
v_cvt_pk_bf16_f32 v247,v206,v207
v_mfma_f32_16x16x32_bf16 v[176:179],v[236:239],a[64:67],v[176:179]
s_add_u32 s60,s65,4096
buffer_store_dwordx4 v[244:247],v248,s[20:23],s60 offen offset:1024 sc1
v_mfma_f32_16x16x32_bf16 v[180:183],v[236:239],a[68:71],v[180:183]
v_mfma_f32_16x16x32_bf16 v[184:187],v[236:239],a[72:75],v[184:187]
v_mfma_f32_16x16x32_bf16 v[188:191],v[236:239],a[76:79],v[188:191]
s_waitcnt lgkmcnt(4)
v_mfma_f32_16x16x32_bf16 v[64:67],v[208:211],a[64:67],v[64:67]
ds_read_b64_tr_b16 v[224:225],v252 offset:34176
v_accvgpr_read_b32 v200,a192
v_mfma_f32_16x16x32_bf16 v[68:71],v[208:211],a[68:71],v[68:71]
ds_read_b64_tr_b16 v[226:227],v252 offset:34688
v_accvgpr_read_b32 v201,a193
v_mfma_f32_16x16x32_bf16 v[72:75],v[208:211],a[72:75],v[72:75]
ds_read_b64_tr_b16 v[228:229],v252 offset:34184
v_accvgpr_read_b32 v202,a194
v_mfma_f32_16x16x32_bf16 v[76:79],v[208:211],a[76:79],v[76:79]
ds_read_b64_tr_b16 v[230:231],v252 offset:34696
v_accvgpr_read_b32 v203,a195
v_mfma_f32_16x16x32_bf16 a[0:3],v[212:215],a[64:67],a[0:3]
v_accvgpr_read_b32 v204,a208
v_accvgpr_read_b32 v205,a209
v_mfma_f32_16x16x32_bf16 a[4:7],v[212:215],a[68:71],a[4:7]
v_accvgpr_read_b32 v206,a210
v_accvgpr_read_b32 v207,a211
v_mfma_f32_16x16x32_bf16 a[8:11],v[212:215],a[72:75],a[8:11]
v_mul_f32 v200,v192,v200
v_mul_f32 v201,v192,v201
v_mfma_f32_16x16x32_bf16 a[12:15],v[212:215],a[76:79],a[12:15]
v_mul_f32 v202,v192,v202
s_waitcnt lgkmcnt(4)
v_mfma_f32_16x16x32_bf16 v[80:83],v[216:219],a[64:67],v[80:83]
ds_read_b64_tr_b16 v[232:233],v252 offset:34240
v_mul_f32 v203,v192,v203
v_mfma_f32_16x16x32_bf16 v[84:87],v[216:219],a[68:71],v[84:87]
ds_read_b64_tr_b16 v[234:235],v252 offset:34752
v_mul_f32 v204,v192,v204
v_mfma_f32_16x16x32_bf16 v[88:91],v[216:219],a[72:75],v[88:91]
ds_read_b64_tr_b16 v[236:237],v252 offset:34248
v_mul_f32 v205,v192,v205
v_mfma_f32_16x16x32_bf16 v[92:95],v[216:219],a[76:79],v[92:95]
ds_read_b64_tr_b16 v[238:239],v252 offset:34760
v_mul_f32 v206,v192,v206
v_mfma_f32_16x16x32_bf16 a[16:19],v[220:223],a[64:67],a[16:19]
v_mul_f32 v207,v192,v207
v_cvt_pk_bf16_f32 v240,v200,v201
v_mfma_f32_16x16x32_bf16 a[20:23],v[220:223],a[68:71],a[20:23]
v_cvt_pk_bf16_f32 v241,v202,v203
v_cvt_pk_bf16_f32 v242,v204,v205
v_mfma_f32_16x16x32_bf16 a[24:27],v[220:223],a[72:75],a[24:27]
v_cvt_pk_bf16_f32 v243,v206,v207
s_add_u32 s60,s62,4096
v_mfma_f32_16x16x32_bf16 a[28:31],v[220:223],a[76:79],a[28:31]
buffer_store_dwordx4 v[240:243],v248,s[20:23],s60 offen offset:2048 sc1
s_waitcnt lgkmcnt(4)
v_mfma_f32_16x16x32_bf16 v[96:99],v[224:227],a[64:67],v[96:99]
ds_read_b64_tr_b16 v[208:209],v252 offset:50688
v_mfma_f32_16x16x32_bf16 v[100:103],v[224:227],a[68:71],v[100:103]
ds_read_b64_tr_b16 v[210:211],v252 offset:51200
v_mfma_f32_16x16x32_bf16 v[104:107],v[224:227],a[72:75],v[104:107]
ds_read_b64_tr_b16 v[212:213],v252 offset:50696
v_mfma_f32_16x16x32_bf16 v[108:111],v[224:227],a[76:79],v[108:111]
ds_read_b64_tr_b16 v[214:215],v252 offset:51208
v_mfma_f32_16x16x32_bf16 a[32:35],v[228:231],a[64:67],a[32:35]
v_mfma_f32_16x16x32_bf16 a[36:39],v[228:231],a[68:71],a[36:39]
v_mfma_f32_16x16x32_bf16 a[40:43],v[228:231],a[72:75],a[40:43]
v_mfma_f32_16x16x32_bf16 a[44:47],v[228:231],a[76:79],a[44:47]
s_waitcnt lgkmcnt(4)
v_mfma_f32_16x16x32_bf16 v[112:115],v[232:235],a[64:67],v[112:115]
ds_read_b64_tr_b16 v[216:217],v252 offset:50752
v_mfma_f32_16x16x32_bf16 v[116:119],v[232:235],a[68:71],v[116:119]
ds_read_b64_tr_b16 v[218:219],v252 offset:51264
v_mfma_f32_16x16x32_bf16 v[120:123],v[232:235],a[72:75],v[120:123]
ds_read_b64_tr_b16 v[220:221],v252 offset:50760
v_mfma_f32_16x16x32_bf16 v[124:127],v[232:235],a[76:79],v[124:127]
ds_read_b64_tr_b16 v[222:223],v252 offset:51272
v_mfma_f32_16x16x32_bf16 a[48:51],v[236:239],a[64:67],a[48:51]
v_mfma_f32_16x16x32_bf16 a[52:55],v[236:239],a[68:71],a[52:55]
v_mfma_f32_16x16x32_bf16 a[56:59],v[236:239],a[72:75],a[56:59]
v_mfma_f32_16x16x32_bf16 a[60:63],v[236:239],a[76:79],a[60:63]
s_waitcnt lgkmcnt(4)
v_mfma_f32_16x16x32_bf16 v[0:3],v[208:211],a[96:99],v[0:3]
ds_read_b64_tr_b16 v[224:225],v252 offset:50816
v_mfma_f32_16x16x32_bf16 v[4:7],v[208:211],a[100:103],v[4:7]
ds_read_b64_tr_b16 v[226:227],v252 offset:51328
v_mfma_f32_16x16x32_bf16 v[8:11],v[208:211],a[104:107],v[8:11]
ds_read_b64_tr_b16 v[228:229],v252 offset:50824
v_mfma_f32_16x16x32_bf16 v[12:15],v[208:211],a[108:111],v[12:15]
s_waitcnt vmcnt(12)
ds_read_b64_tr_b16 v[230:231],v252 offset:51336
v_mfma_f32_16x16x32_bf16 v[128:131],v[212:215],a[96:99],v[128:131]
ds_read_b128 a[64:67],v253 offset:16896
v_mfma_f32_16x16x32_bf16 v[132:135],v[212:215],a[100:103],v[132:135]
ds_read_b128 a[68:71],v253 offset:18944
v_mfma_f32_16x16x32_bf16 v[136:139],v[212:215],a[104:107],v[136:139]
ds_read_b128 a[72:75],v253 offset:33792
v_mfma_f32_16x16x32_bf16 v[140:143],v[212:215],a[108:111],v[140:143]
s_waitcnt lgkmcnt(7)
v_mfma_f32_16x16x32_bf16 v[16:19],v[216:219],a[96:99],v[16:19]
ds_read_b64_tr_b16 v[232:233],v252 offset:50880
v_mfma_f32_16x16x32_bf16 v[20:23],v[216:219],a[100:103],v[20:23]
ds_read_b64_tr_b16 v[234:235],v252 offset:51392
v_accvgpr_read_b32 v200,a196
v_mfma_f32_16x16x32_bf16 v[24:27],v[216:219],a[104:107],v[24:27]
ds_read_b64_tr_b16 v[236:237],v252 offset:50888
v_accvgpr_read_b32 v201,a197
v_mfma_f32_16x16x32_bf16 v[28:31],v[216:219],a[108:111],v[28:31]
ds_read_b64_tr_b16 v[238:239],v252 offset:51400
v_accvgpr_read_b32 v202,a198
v_mfma_f32_16x16x32_bf16 v[144:147],v[220:223],a[96:99],v[144:147]
ds_read_b128 a[76:79],v253 offset:35840
v_xor_b32 v253,64,v253
v_mfma_f32_16x16x32_bf16 v[148:151],v[220:223],a[100:103],v[148:151]
ds_read_b128 a[80:83],v253 offset:16896
v_accvgpr_read_b32 v203,a199
v_mfma_f32_16x16x32_bf16 v[152:155],v[220:223],a[104:107],v[152:155]
ds_read_b128 a[84:87],v253 offset:18944
v_accvgpr_read_b32 v204,a212
v_mfma_f32_16x16x32_bf16 v[156:159],v[220:223],a[108:111],v[156:159]
v_accvgpr_read_b32 v205,a213
s_waitcnt lgkmcnt(10)
v_mfma_f32_16x16x32_bf16 v[32:35],v[224:227],a[96:99],v[32:35]
ds_read_b64_tr_b16 v[208:209],v252 offset:50944
v_accvgpr_read_b32 v206,a214
v_mfma_f32_16x16x32_bf16 v[36:39],v[224:227],a[100:103],v[36:39]
ds_read_b64_tr_b16 v[210:211],v252 offset:51456
v_accvgpr_read_b32 v207,a215
v_mfma_f32_16x16x32_bf16 v[40:43],v[224:227],a[104:107],v[40:43]
ds_read_b64_tr_b16 v[212:213],v252 offset:50952
v_mul_f32 v200,v194,v200
v_mfma_f32_16x16x32_bf16 v[44:47],v[224:227],a[108:111],v[44:47]
ds_read_b64_tr_b16 v[214:215],v252 offset:51464
v_mul_f32 v201,v194,v201
v_mfma_f32_16x16x32_bf16 v[160:163],v[228:231],a[96:99],v[160:163]
ds_read_b128 a[88:91],v253 offset:33792
v_mul_f32 v202,v194,v202
v_mfma_f32_16x16x32_bf16 v[164:167],v[228:231],a[100:103],v[164:167]
ds_read_b128 a[92:95],v253 offset:35840
v_xor_b32 v253,64,v253
v_mfma_f32_16x16x32_bf16 v[168:171],v[228:231],a[104:107],v[168:171]
v_mul_f32 v203,v194,v203
v_mul_f32 v204,v194,v204
v_mfma_f32_16x16x32_bf16 v[172:175],v[228:231],a[108:111],v[172:175]
v_mul_f32 v205,v194,v205
s_waitcnt lgkmcnt(9)
v_mfma_f32_16x16x32_bf16 v[48:51],v[232:235],a[96:99],v[48:51]
ds_read_b64_tr_b16 v[216:217],v252 offset:51008
v_mul_f32 v206,v194,v206
v_mfma_f32_16x16x32_bf16 v[52:55],v[232:235],a[100:103],v[52:55]
ds_read_b64_tr_b16 v[218:219],v252 offset:51520
v_mul_f32 v207,v194,v207
v_mfma_f32_16x16x32_bf16 v[56:59],v[232:235],a[104:107],v[56:59]
ds_read_b64_tr_b16 v[220:221],v252 offset:51016
v_cvt_pk_bf16_f32 v244,v200,v201
v_mfma_f32_16x16x32_bf16 v[60:63],v[232:235],a[108:111],v[60:63]
ds_read_b64_tr_b16 v[222:223],v252 offset:51528
v_cvt_pk_bf16_f32 v245,v202,v203
v_mfma_f32_16x16x32_bf16 v[176:179],v[236:239],a[96:99],v[176:179]
v_cvt_pk_bf16_f32 v246,v204,v205
v_cvt_pk_bf16_f32 v247,v206,v207
v_mfma_f32_16x16x32_bf16 v[180:183],v[236:239],a[100:103],v[180:183]
s_add_u32 s60,s63,4096
buffer_store_dwordx4 v[244:247],v248,s[20:23],s60 offen offset:2048 sc1
v_mfma_f32_16x16x32_bf16 v[184:187],v[236:239],a[104:107],v[184:187]
v_mfma_f32_16x16x32_bf16 v[188:191],v[236:239],a[108:111],v[188:191]
s_waitcnt lgkmcnt(6)
v_mfma_f32_16x16x32_bf16 v[64:67],v[208:211],a[96:99],v[64:67]
ds_read_b64_tr_b16 v[224:225],v252 offset:51072
v_mfma_f32_16x16x32_bf16 v[68:71],v[208:211],a[100:103],v[68:71]
ds_read_b64_tr_b16 v[226:227],v252 offset:51584
v_mfma_f32_16x16x32_bf16 v[72:75],v[208:211],a[104:107],v[72:75]
ds_read_b64_tr_b16 v[228:229],v252 offset:51080
v_mfma_f32_16x16x32_bf16 v[76:79],v[208:211],a[108:111],v[76:79]
ds_read_b64_tr_b16 v[230:231],v252 offset:51592
v_mfma_f32_16x16x32_bf16 a[0:3],v[212:215],a[96:99],a[0:3]
v_mfma_f32_16x16x32_bf16 a[4:7],v[212:215],a[100:103],a[4:7]
v_mfma_f32_16x16x32_bf16 a[8:11],v[212:215],a[104:107],a[8:11]
v_mfma_f32_16x16x32_bf16 a[12:15],v[212:215],a[108:111],a[12:15]
s_add_u32 m0,s29,83840
s_waitcnt lgkmcnt(4)
v_mfma_f32_16x16x32_bf16 v[80:83],v[216:219],a[96:99],v[80:83]
ds_read_b64_tr_b16 v[232:233],v252 offset:51136
buffer_load_dwordx4 v255,s[4:7],s68 offen offset:640 lds
v_mfma_f32_16x16x32_bf16 v[84:87],v[216:219],a[100:103],v[84:87]
ds_read_b64_tr_b16 v[234:235],v252 offset:51648
s_add_u32 m0,m0,0x00000400
v_mfma_f32_16x16x32_bf16 v[88:91],v[216:219],a[104:107],v[88:91]
ds_read_b64_tr_b16 v[236:237],v252 offset:51144
v_mfma_f32_16x16x32_bf16 v[92:95],v[216:219],a[108:111],v[92:95]
ds_read_b64_tr_b16 v[238:239],v252 offset:51656
buffer_load_dwordx4 v255,s[4:7],s93 offen offset:640 lds
v_mfma_f32_16x16x32_bf16 a[16:19],v[220:223],a[96:99],a[16:19]
s_add_u32 m0,m0,0x00000400
v_mfma_f32_16x16x32_bf16 a[20:23],v[220:223],a[100:103],a[20:23]
v_mfma_f32_16x16x32_bf16 a[24:27],v[220:223],a[104:107],a[24:27]
buffer_load_dwordx4 v255,s[4:7],s94 offen offset:640 lds
s_add_u32 m0,m0,0x00000400
v_mfma_f32_16x16x32_bf16 a[28:31],v[220:223],a[108:111],a[28:31]
s_waitcnt lgkmcnt(4)
v_mfma_f32_16x16x32_bf16 v[96:99],v[224:227],a[96:99],v[96:99]
v_mfma_f32_16x16x32_bf16 v[100:103],v[224:227],a[100:103],v[100:103]
s_waitcnt vmcnt(8) lgkmcnt(0)
s_barrier
v_mfma_f32_16x16x32_bf16 v[104:107],v[224:227],a[104:107],v[104:107]
ds_read_b64_tr_b16 v[208:209],v252 offset:16896
buffer_load_dwordx4 v255,s[4:7],s95 offen offset:640 lds
v_mfma_f32_16x16x32_bf16 v[108:111],v[224:227],a[108:111],v[108:111]
ds_read_b64_tr_b16 v[210:211],v252 offset:17408
s_add_u32 m0,s29,100736
v_mfma_f32_16x16x32_bf16 a[32:35],v[228:231],a[96:99],a[32:35]
ds_read_b64_tr_b16 v[212:213],v252 offset:16904
buffer_load_dwordx4 v255,s[4:7],s96 offen offset:640 lds
v_mfma_f32_16x16x32_bf16 a[36:39],v[228:231],a[100:103],a[36:39]
ds_read_b64_tr_b16 v[214:215],v252 offset:17416
s_add_u32 m0,m0,0x00000400
v_mfma_f32_16x16x32_bf16 a[40:43],v[228:231],a[104:107],a[40:43]
v_accvgpr_read_b32 v200,a200
v_accvgpr_read_b32 v201,a201
v_mfma_f32_16x16x32_bf16 a[44:47],v[228:231],a[108:111],a[44:47]
buffer_load_dwordx4 v255,s[4:7],s97 offen offset:640 lds
s_add_u32 m0,m0,0x00000400
v_mfma_f32_16x16x32_bf16 v[112:115],v[232:235],a[96:99],v[112:115]
ds_read_b64_tr_b16 v[216:217],v252 offset:16960
v_accvgpr_read_b32 v202,a202
v_mfma_f32_16x16x32_bf16 v[116:119],v[232:235],a[100:103],v[116:119]
ds_read_b64_tr_b16 v[218:219],v252 offset:17472
v_accvgpr_read_b32 v203,a203
v_mfma_f32_16x16x32_bf16 v[120:123],v[232:235],a[104:107],v[120:123]
ds_read_b64_tr_b16 v[220:221],v252 offset:16968
buffer_load_dwordx4 v255,s[4:7],s98 offen offset:640 lds
v_mfma_f32_16x16x32_bf16 v[124:127],v[232:235],a[108:111],v[124:127]
ds_read_b64_tr_b16 v[222:223],v252 offset:17480
s_add_u32 m0,m0,0x00000400
v_mfma_f32_16x16x32_bf16 a[48:51],v[236:239],a[96:99],a[48:51]
v_accvgpr_read_b32 v204,a216
v_accvgpr_read_b32 v205,a217
v_mfma_f32_16x16x32_bf16 a[52:55],v[236:239],a[100:103],a[52:55]
buffer_load_dwordx4 v255,s[4:7],s99 offen offset:640 lds
v_accvgpr_read_b32 v206,a218
v_mfma_f32_16x16x32_bf16 a[56:59],v[236:239],a[104:107],a[56:59]
v_accvgpr_read_b32 v207,a219
v_mul_f32 v200,v196,v200
v_mfma_f32_16x16x32_bf16 a[60:63],v[236:239],a[108:111],a[60:63]
s_add_u32 m0,s29,33792
s_waitcnt lgkmcnt(4)
v_mfma_f32_16x16x32_bf16 v[0:3],v[208:211],a[64:67],v[0:3]
ds_read_b64_tr_b16 v[224:225],v252 offset:17024
buffer_load_dwordx4 v254,s[16:19],s0 offen lds
v_mfma_f32_16x16x32_bf16 v[4:7],v[208:211],a[68:71],v[4:7]
ds_read_b64_tr_b16 v[226:227],v252 offset:17536
s_add_u32 m0,m0,0x00000428
v_mfma_f32_16x16x32_bf16 v[8:11],v[208:211],a[72:75],v[8:11]
ds_read_b64_tr_b16 v[228:229],v252 offset:17032
v_mul_f32 v201,v196,v201
v_mfma_f32_16x16x32_bf16 v[12:15],v[208:211],a[76:79],v[12:15]
ds_read_b64_tr_b16 v[230:231],v252 offset:17544
buffer_load_dwordx4 v254,s[16:19],s1 offen lds
v_mfma_f32_16x16x32_bf16 v[128:131],v[212:215],a[64:67],v[128:131]
s_add_u32 m0,m0,0x00000418
v_mul_f32 v202,v196,v202
v_mfma_f32_16x16x32_bf16 v[132:135],v[212:215],a[68:71],v[132:135]
v_mul_f32 v203,v196,v203
v_mul_f32 v204,v196,v204
v_mfma_f32_16x16x32_bf16 v[136:139],v[212:215],a[72:75],v[136:139]
buffer_load_dwordx4 v254,s[16:19],s2 offen lds
s_add_u32 m0,m0,0x00000428
v_mfma_f32_16x16x32_bf16 v[140:143],v[212:215],a[76:79],v[140:143]
v_mul_f32 v205,v196,v205
s_waitcnt lgkmcnt(4)
v_mfma_f32_16x16x32_bf16 v[16:19],v[216:219],a[64:67],v[16:19]
ds_read_b64_tr_b16 v[232:233],v252 offset:17088
v_mul_f32 v206,v196,v206
v_mfma_f32_16x16x32_bf16 v[20:23],v[216:219],a[68:71],v[20:23]
ds_read_b64_tr_b16 v[234:235],v252 offset:17600
buffer_load_dwordx4 v254,s[16:19],s3 offen lds
v_mfma_f32_16x16x32_bf16 v[24:27],v[216:219],a[72:75],v[24:27]
ds_read_b64_tr_b16 v[236:237],v252 offset:17096
v_mul_f32 v207,v196,v207
v_mfma_f32_16x16x32_bf16 v[28:31],v[216:219],a[76:79],v[28:31]
ds_read_b64_tr_b16 v[238:239],v252 offset:17608
v_cvt_pk_bf16_f32 v240,v200,v201
v_mfma_f32_16x16x32_bf16 v[144:147],v[220:223],a[64:67],v[144:147]
s_add_u32 s16,s16,262144
s_addc_u32 s17,s17,0
v_mfma_f32_16x16x32_bf16 v[148:151],v[220:223],a[68:71],v[148:151]
s_sub_u32 s18,s18,262144
s_add_u32 m0,s29,50688
v_mfma_f32_16x16x32_bf16 v[152:155],v[220:223],a[72:75],v[152:155]
buffer_load_dwordx4 v254,s[16:19],s0 offen lds
s_add_u32 m0,m0,0x00000428
v_mfma_f32_16x16x32_bf16 v[156:159],v[220:223],a[76:79],v[156:159]
buffer_load_dwordx4 v254,s[16:19],s1 offen lds
s_waitcnt lgkmcnt(4)
v_mfma_f32_16x16x32_bf16 v[32:35],v[224:227],a[64:67],v[32:35]
ds_read_b64_tr_b16 v[208:209],v252 offset:17152
s_add_u32 m0,m0,0x00000418
v_mfma_f32_16x16x32_bf16 v[36:39],v[224:227],a[68:71],v[36:39]
ds_read_b64_tr_b16 v[210:211],v252 offset:17664
v_cvt_pk_bf16_f32 v241,v202,v203
v_mfma_f32_16x16x32_bf16 v[40:43],v[224:227],a[72:75],v[40:43]
ds_read_b64_tr_b16 v[212:213],v252 offset:17160
buffer_load_dwordx4 v254,s[16:19],s2 offen lds
v_mfma_f32_16x16x32_bf16 v[44:47],v[224:227],a[76:79],v[44:47]
ds_read_b64_tr_b16 v[214:215],v252 offset:17672
s_add_u32 m0,m0,0x00000428
v_mfma_f32_16x16x32_bf16 v[160:163],v[228:231],a[64:67],v[160:163]
v_cvt_pk_bf16_f32 v242,v204,v205
v_cvt_pk_bf16_f32 v243,v206,v207
v_mfma_f32_16x16x32_bf16 v[164:167],v[228:231],a[68:71],v[164:167]
buffer_load_dwordx4 v254,s[16:19],s3 offen lds
s_add_u32 s60,s64,4096
v_mfma_f32_16x16x32_bf16 v[168:171],v[228:231],a[72:75],v[168:171]
s_add_u32 s16,s16,262144
s_addc_u32 s17,s17,0
v_mfma_f32_16x16x32_bf16 v[172:175],v[228:231],a[76:79],v[172:175]
s_sub_u32 s18,s18,262144
s_waitcnt lgkmcnt(4)
v_mfma_f32_16x16x32_bf16 v[48:51],v[232:235],a[64:67],v[48:51]
ds_read_b64_tr_b16 v[216:217],v252 offset:17216
s_add_u32 m0,s29,118272
v_mfma_f32_16x16x32_bf16 v[52:55],v[232:235],a[68:71],v[52:55]
ds_read_b64_tr_b16 v[218:219],v252 offset:17728
buffer_load_dword v195,s[4:7],0 offen offset:768 lds
v_mfma_f32_16x16x32_bf16 v[56:59],v[232:235],a[72:75],v[56:59]
ds_read_b64_tr_b16 v[220:221],v252 offset:17224
buffer_load_dword v197,s[16:19],0 offen offset:0 lds
v_mfma_f32_16x16x32_bf16 v[60:63],v[232:235],a[76:79],v[60:63]
ds_read_b64_tr_b16 v[222:223],v252 offset:17736
s_add_u32 m0,s29,118272
v_mfma_f32_16x16x32_bf16 v[176:179],v[236:239],a[64:67],v[176:179]
buffer_load_dwordx4 v251,s[8:11],s30 offen offset:0 nt lds
s_add_u32 m0,s29,118816
v_mfma_f32_16x16x32_bf16 v[180:183],v[236:239],a[68:71],v[180:183]
buffer_load_dwordx4 v251,s[8:11],s30 offen offset:512 nt lds
s_add_u32 m0,s29,119360
v_mfma_f32_16x16x32_bf16 v[184:187],v[236:239],a[72:75],v[184:187]
buffer_load_dwordx4 v251,s[8:11],s30 offen offset:1024 nt lds
s_add_u32 m0,s29,119904
v_mfma_f32_16x16x32_bf16 v[188:191],v[236:239],a[76:79],v[188:191]
buffer_load_dwordx4 v251,s[8:11],s30 offen offset:1536 nt lds
s_waitcnt lgkmcnt(4)
v_mfma_f32_16x16x32_bf16 v[64:67],v[208:211],a[64:67],v[64:67]
ds_read_b64_tr_b16 v[224:225],v252 offset:17280
s_add_u32 s30,s30,16384
v_mfma_f32_16x16x32_bf16 v[68:71],v[208:211],a[68:71],v[68:71]
ds_read_b64_tr_b16 v[226:227],v252 offset:17792
buffer_store_dwordx4 v[240:243],v248,s[20:23],s60 offen offset:2048 sc1
v_mfma_f32_16x16x32_bf16 v[72:75],v[208:211],a[72:75],v[72:75]
ds_read_b64_tr_b16 v[228:229],v252 offset:17288
v_accvgpr_read_b32 v200,a204
v_mfma_f32_16x16x32_bf16 v[76:79],v[208:211],a[76:79],v[76:79]
ds_read_b64_tr_b16 v[230:231],v252 offset:17800
v_accvgpr_read_b32 v201,a205
v_mfma_f32_16x16x32_bf16 a[0:3],v[212:215],a[64:67],a[0:3]
v_accvgpr_read_b32 v202,a206
v_accvgpr_read_b32 v203,a207
v_mfma_f32_16x16x32_bf16 a[4:7],v[212:215],a[68:71],a[4:7]
v_accvgpr_read_b32 v204,a220
v_accvgpr_read_b32 v205,a221
v_mfma_f32_16x16x32_bf16 a[8:11],v[212:215],a[72:75],a[8:11]
v_accvgpr_read_b32 v206,a222
v_accvgpr_read_b32 v207,a223
v_mfma_f32_16x16x32_bf16 a[12:15],v[212:215],a[76:79],a[12:15]
v_mul_f32 v200,v198,v200
s_waitcnt lgkmcnt(4)
v_mfma_f32_16x16x32_bf16 v[80:83],v[216:219],a[64:67],v[80:83]
ds_read_b64_tr_b16 v[232:233],v252 offset:17344
v_mul_f32 v201,v198,v201
v_mfma_f32_16x16x32_bf16 v[84:87],v[216:219],a[68:71],v[84:87]
ds_read_b64_tr_b16 v[234:235],v252 offset:17856
v_mul_f32 v202,v198,v202
v_mfma_f32_16x16x32_bf16 v[88:91],v[216:219],a[72:75],v[88:91]
ds_read_b64_tr_b16 v[236:237],v252 offset:17352
v_mul_f32 v203,v198,v203
v_mfma_f32_16x16x32_bf16 v[92:95],v[216:219],a[76:79],v[92:95]
ds_read_b64_tr_b16 v[238:239],v252 offset:17864
v_mul_f32 v204,v198,v204
v_mfma_f32_16x16x32_bf16 a[16:19],v[220:223],a[64:67],a[16:19]
v_mul_f32 v205,v198,v205
v_mul_f32 v206,v198,v206
v_mfma_f32_16x16x32_bf16 a[20:23],v[220:223],a[68:71],a[20:23]
v_mul_f32 v207,v198,v207
v_cvt_pk_bf16_f32 v244,v200,v201
v_mfma_f32_16x16x32_bf16 a[24:27],v[220:223],a[72:75],a[24:27]
v_cvt_pk_bf16_f32 v245,v202,v203
v_cvt_pk_bf16_f32 v246,v204,v205
v_mfma_f32_16x16x32_bf16 a[28:31],v[220:223],a[76:79],a[28:31]
v_cvt_pk_bf16_f32 v247,v206,v207
s_waitcnt lgkmcnt(4)
v_mfma_f32_16x16x32_bf16 v[96:99],v[224:227],a[64:67],v[96:99]
ds_read_b64_tr_b16 v[208:209],v252 offset:0
s_add_u32 s60,s65,4096
v_mfma_f32_16x16x32_bf16 v[100:103],v[224:227],a[68:71],v[100:103]
ds_read_b64_tr_b16 v[210:211],v252 offset:512
buffer_store_dwordx4 v[244:247],v248,s[20:23],s60 offen offset:2048 sc1
v_mfma_f32_16x16x32_bf16 v[104:107],v[224:227],a[72:75],v[104:107]
ds_read_b64_tr_b16 v[212:213],v252 offset:8
v_mfma_f32_16x16x32_bf16 v[108:111],v[224:227],a[76:79],v[108:111]
ds_read_b64_tr_b16 v[214:215],v252 offset:520
v_mfma_f32_16x16x32_bf16 a[32:35],v[228:231],a[64:67],a[32:35]
v_mfma_f32_16x16x32_bf16 a[36:39],v[228:231],a[68:71],a[36:39]
v_mfma_f32_16x16x32_bf16 a[40:43],v[228:231],a[72:75],a[40:43]
v_mfma_f32_16x16x32_bf16 a[44:47],v[228:231],a[76:79],a[44:47]
s_waitcnt lgkmcnt(4)
v_mfma_f32_16x16x32_bf16 v[112:115],v[232:235],a[64:67],v[112:115]
ds_read_b64_tr_b16 v[216:217],v252 offset:64
v_mfma_f32_16x16x32_bf16 v[116:119],v[232:235],a[68:71],v[116:119]
ds_read_b64_tr_b16 v[218:219],v252 offset:576
v_mfma_f32_16x16x32_bf16 v[120:123],v[232:235],a[72:75],v[120:123]
ds_read_b64_tr_b16 v[220:221],v252 offset:72
v_mfma_f32_16x16x32_bf16 v[124:127],v[232:235],a[76:79],v[124:127]
ds_read_b64_tr_b16 v[222:223],v252 offset:584
v_mfma_f32_16x16x32_bf16 a[48:51],v[236:239],a[64:67],a[48:51]
v_mfma_f32_16x16x32_bf16 a[52:55],v[236:239],a[68:71],a[52:55]
v_mfma_f32_16x16x32_bf16 a[56:59],v[236:239],a[72:75],a[56:59]
v_mfma_f32_16x16x32_bf16 a[60:63],v[236:239],a[76:79],a[60:63]
s_waitcnt lgkmcnt(4)
v_mfma_f32_16x16x32_bf16 v[0:3],v[208:211],a[80:83],v[0:3]
ds_read_b64_tr_b16 v[224:225],v252 offset:128
v_mfma_f32_16x16x32_bf16 v[4:7],v[208:211],a[84:87],v[4:7]
ds_read_b64_tr_b16 v[226:227],v252 offset:640
v_mfma_f32_16x16x32_bf16 v[8:11],v[208:211],a[88:91],v[8:11]
ds_read_b64_tr_b16 v[228:229],v252 offset:136
v_mfma_f32_16x16x32_bf16 v[12:15],v[208:211],a[92:95],v[12:15]
s_waitcnt vmcnt(16)
ds_read_b64_tr_b16 v[230:231],v252 offset:648
v_mfma_f32_16x16x32_bf16 v[128:131],v[212:215],a[80:83],v[128:131]
ds_read_b128 a[64:67],v253 offset:16896
v_accvgpr_read_b32 v200,a224
v_mfma_f32_16x16x32_bf16 v[132:135],v[212:215],a[84:87],v[132:135]
ds_read_b128 a[68:71],v253 offset:18944
v_accvgpr_read_b32 v201,a225
v_mfma_f32_16x16x32_bf16 v[136:139],v[212:215],a[88:91],v[136:139]
ds_read_b128 a[72:75],v253 offset:33792
v_accvgpr_read_b32 v202,a226
v_mfma_f32_16x16x32_bf16 v[140:143],v[212:215],a[92:95],v[140:143]
v_accvgpr_read_b32 v203,a227
s_waitcnt lgkmcnt(7)
v_mfma_f32_16x16x32_bf16 v[16:19],v[216:219],a[80:83],v[16:19]
ds_read_b64_tr_b16 v[232:233],v252 offset:192
v_accvgpr_read_b32 v204,a240
v_mfma_f32_16x16x32_bf16 v[20:23],v[216:219],a[84:87],v[20:23]
ds_read_b64_tr_b16 v[234:235],v252 offset:704
v_accvgpr_read_b32 v205,a241
v_mfma_f32_16x16x32_bf16 v[24:27],v[216:219],a[88:91],v[24:27]
ds_read_b64_tr_b16 v[236:237],v252 offset:200
v_accvgpr_read_b32 v206,a242
v_mfma_f32_16x16x32_bf16 v[28:31],v[216:219],a[92:95],v[28:31]
ds_read_b64_tr_b16 v[238:239],v252 offset:712
v_accvgpr_read_b32 v207,a243
v_mfma_f32_16x16x32_bf16 v[144:147],v[220:223],a[80:83],v[144:147]
ds_read_b128 a[76:79],v253 offset:35840
v_xor_b32 v253,64,v253
v_mfma_f32_16x16x32_bf16 v[148:151],v[220:223],a[84:87],v[148:151]
ds_read_b128 a[96:99],v253 offset:16896
v_mul_f32 v200,v192,v200
v_mfma_f32_16x16x32_bf16 v[152:155],v[220:223],a[88:91],v[152:155]
ds_read_b128 a[100:103],v253 offset:18944
v_mul_f32 v201,v192,v201
v_mfma_f32_16x16x32_bf16 v[156:159],v[220:223],a[92:95],v[156:159]
v_mul_f32 v202,v192,v202
s_waitcnt lgkmcnt(10)
v_mfma_f32_16x16x32_bf16 v[32:35],v[224:227],a[80:83],v[32:35]
ds_read_b64_tr_b16 v[208:209],v252 offset:256
v_mul_f32 v203,v192,v203
v_mfma_f32_16x16x32_bf16 v[36:39],v[224:227],a[84:87],v[36:39]
ds_read_b64_tr_b16 v[210:211],v252 offset:768
v_mul_f32 v204,v192,v204
v_mfma_f32_16x16x32_bf16 v[40:43],v[224:227],a[88:91],v[40:43]
ds_read_b64_tr_b16 v[212:213],v252 offset:264
v_mul_f32 v205,v192,v205
v_mfma_f32_16x16x32_bf16 v[44:47],v[224:227],a[92:95],v[44:47]
ds_read_b64_tr_b16 v[214:215],v252 offset:776
v_mul_f32 v206,v192,v206
v_mfma_f32_16x16x32_bf16 v[160:163],v[228:231],a[80:83],v[160:163]
ds_read_b128 a[104:107],v253 offset:33792
v_mul_f32 v207,v192,v207
v_mfma_f32_16x16x32_bf16 v[164:167],v[228:231],a[84:87],v[164:167]
ds_read_b128 a[108:111],v253 offset:35840
v_xor_b32 v253,64,v253
v_mfma_f32_16x16x32_bf16 v[168:171],v[228:231],a[88:91],v[168:171]
v_cvt_pk_bf16_f32 v240,v200,v201
v_cvt_pk_bf16_f32 v241,v202,v203
v_mfma_f32_16x16x32_bf16 v[172:175],v[228:231],a[92:95],v[172:175]
v_cvt_pk_bf16_f32 v242,v204,v205
s_waitcnt lgkmcnt(9)
v_mfma_f32_16x16x32_bf16 v[48:51],v[232:235],a[80:83],v[48:51]
ds_read_b64_tr_b16 v[216:217],v252 offset:320
v_cvt_pk_bf16_f32 v243,v206,v207
v_mfma_f32_16x16x32_bf16 v[52:55],v[232:235],a[84:87],v[52:55]
ds_read_b64_tr_b16 v[218:219],v252 offset:832
s_add_u32 s60,s62,4096
v_mfma_f32_16x16x32_bf16 v[56:59],v[232:235],a[88:91],v[56:59]
ds_read_b64_tr_b16 v[220:221],v252 offset:328
buffer_store_dwordx4 v[240:243],v248,s[20:23],s60 offen offset:3072 sc1
v_mfma_f32_16x16x32_bf16 v[60:63],v[232:235],a[92:95],v[60:63]
ds_read_b64_tr_b16 v[222:223],v252 offset:840
v_mfma_f32_16x16x32_bf16 v[176:179],v[236:239],a[80:83],v[176:179]
v_mfma_f32_16x16x32_bf16 v[180:183],v[236:239],a[84:87],v[180:183]
v_mfma_f32_16x16x32_bf16 v[184:187],v[236:239],a[88:91],v[184:187]
v_mfma_f32_16x16x32_bf16 v[188:191],v[236:239],a[92:95],v[188:191]
s_waitcnt lgkmcnt(6)
v_mfma_f32_16x16x32_bf16 v[64:67],v[208:211],a[80:83],v[64:67]
ds_read_b64_tr_b16 v[224:225],v252 offset:384
v_mfma_f32_16x16x32_bf16 v[68:71],v[208:211],a[84:87],v[68:71]
ds_read_b64_tr_b16 v[226:227],v252 offset:896
v_mfma_f32_16x16x32_bf16 v[72:75],v[208:211],a[88:91],v[72:75]
ds_read_b64_tr_b16 v[228:229],v252 offset:392
v_mfma_f32_16x16x32_bf16 v[76:79],v[208:211],a[92:95],v[76:79]
ds_read_b64_tr_b16 v[230:231],v252 offset:904
v_mfma_f32_16x16x32_bf16 a[0:3],v[212:215],a[80:83],a[0:3]
v_mfma_f32_16x16x32_bf16 a[4:7],v[212:215],a[84:87],a[4:7]
v_mfma_f32_16x16x32_bf16 a[8:11],v[212:215],a[88:91],a[8:11]
v_mfma_f32_16x16x32_bf16 a[12:15],v[212:215],a[92:95],a[12:15]
s_add_u32 m0,s29,83712
s_waitcnt lgkmcnt(4)
v_mfma_f32_16x16x32_bf16 v[80:83],v[216:219],a[80:83],v[80:83]
ds_read_b64_tr_b16 v[232:233],v252 offset:448
buffer_load_dwordx4 v255,s[4:7],s68 offen offset:768 lds
v_mfma_f32_16x16x32_bf16 v[84:87],v[216:219],a[84:87],v[84:87]
ds_read_b64_tr_b16 v[234:235],v252 offset:960
s_add_u32 m0,m0,0x00000400
v_mfma_f32_16x16x32_bf16 v[88:91],v[216:219],a[88:91],v[88:91]
ds_read_b64_tr_b16 v[236:237],v252 offset:456
v_mfma_f32_16x16x32_bf16 v[92:95],v[216:219],a[92:95],v[92:95]
ds_read_b64_tr_b16 v[238:239],v252 offset:968
buffer_load_dwordx4 v255,s[4:7],s93 offen offset:768 lds
v_mfma_f32_16x16x32_bf16 a[16:19],v[220:223],a[80:83],a[16:19]
s_add_u32 m0,m0,0x00000400
v_mfma_f32_16x16x32_bf16 a[20:23],v[220:223],a[84:87],a[20:23]
v_accvgpr_read_b32 v200,a228
v_accvgpr_read_b32 v201,a229
v_mfma_f32_16x16x32_bf16 a[24:27],v[220:223],a[88:91],a[24:27]
buffer_load_dwordx4 v255,s[4:7],s94 offen offset:768 lds
s_add_u32 m0,m0,0x00000400
v_mfma_f32_16x16x32_bf16 a[28:31],v[220:223],a[92:95],a[28:31]
v_accvgpr_read_b32 v202,a230
s_waitcnt lgkmcnt(4)
v_mfma_f32_16x16x32_bf16 v[96:99],v[224:227],a[80:83],v[96:99]
v_accvgpr_read_b32 v203,a231
v_accvgpr_read_b32 v204,a244
v_mfma_f32_16x16x32_bf16 v[100:103],v[224:227],a[84:87],v[100:103]
s_waitcnt vmcnt(12) lgkmcnt(0)
s_barrier
v_mfma_f32_16x16x32_bf16 v[104:107],v[224:227],a[88:91],v[104:107]
ds_read_b64_tr_b16 v[208:209],v252 offset:33792
buffer_load_dwordx4 v255,s[4:7],s95 offen offset:768 lds
v_mfma_f32_16x16x32_bf16 v[108:111],v[224:227],a[92:95],v[108:111]
ds_read_b64_tr_b16 v[210:211],v252 offset:34304
s_add_u32 m0,s29,100608
v_mfma_f32_16x16x32_bf16 a[32:35],v[228:231],a[80:83],a[32:35]
ds_read_b64_tr_b16 v[212:213],v252 offset:33800
buffer_load_dwordx4 v255,s[4:7],s96 offen offset:768 lds
v_mfma_f32_16x16x32_bf16 a[36:39],v[228:231],a[84:87],a[36:39]
ds_read_b64_tr_b16 v[214:215],v252 offset:34312
s_add_u32 m0,m0,0x00000400
v_mfma_f32_16x16x32_bf16 a[40:43],v[228:231],a[88:91],a[40:43]
v_accvgpr_read_b32 v205,a245
v_accvgpr_read_b32 v206,a246
v_mfma_f32_16x16x32_bf16 a[44:47],v[228:231],a[92:95],a[44:47]
buffer_load_dwordx4 v255,s[4:7],s97 offen offset:768 lds
s_add_u32 m0,m0,0x00000400
v_mfma_f32_16x16x32_bf16 v[112:115],v[232:235],a[80:83],v[112:115]
ds_read_b64_tr_b16 v[216:217],v252 offset:33856
v_accvgpr_read_b32 v207,a247
v_mfma_f32_16x16x32_bf16 v[116:119],v[232:235],a[84:87],v[116:119]
ds_read_b64_tr_b16 v[218:219],v252 offset:34368
v_mul_f32 v200,v194,v200
v_mfma_f32_16x16x32_bf16 v[120:123],v[232:235],a[88:91],v[120:123]
ds_read_b64_tr_b16 v[220:221],v252 offset:33864
buffer_load_dwordx4 v255,s[4:7],s98 offen offset:768 lds
v_mfma_f32_16x16x32_bf16 v[124:127],v[232:235],a[92:95],v[124:127]
ds_read_b64_tr_b16 v[222:223],v252 offset:34376
s_add_u32 m0,m0,0x00000400
v_mfma_f32_16x16x32_bf16 a[48:51],v[236:239],a[80:83],a[48:51]
v_mul_f32 v201,v194,v201
v_mul_f32 v202,v194,v202
v_mfma_f32_16x16x32_bf16 a[52:55],v[236:239],a[84:87],a[52:55]
buffer_load_dwordx4 v255,s[4:7],s99 offen offset:768 lds
v_mul_f32 v203,v194,v203
v_mfma_f32_16x16x32_bf16 a[56:59],v[236:239],a[88:91],a[56:59]
v_mul_f32 v204,v194,v204
v_mul_f32 v205,v194,v205
v_mfma_f32_16x16x32_bf16 a[60:63],v[236:239],a[92:95],a[60:63]
s_add_u32 m0,s29,16896
s_waitcnt lgkmcnt(4)
v_mfma_f32_16x16x32_bf16 v[0:3],v[208:211],a[64:67],v[0:3]
ds_read_b64_tr_b16 v[224:225],v252 offset:33920
buffer_load_dwordx4 v254,s[16:19],s0 offen lds
v_mfma_f32_16x16x32_bf16 v[4:7],v[208:211],a[68:71],v[4:7]
ds_read_b64_tr_b16 v[226:227],v252 offset:34432
s_add_u32 m0,m0,0x00000428
v_mfma_f32_16x16x32_bf16 v[8:11],v[208:211],a[72:75],v[8:11]
ds_read_b64_tr_b16 v[228:229],v252 offset:33928
v_mul_f32 v206,v194,v206
v_mfma_f32_16x16x32_bf16 v[12:15],v[208:211],a[76:79],v[12:15]
ds_read_b64_tr_b16 v[230:231],v252 offset:34440
buffer_load_dwordx4 v254,s[16:19],s1 offen lds
v_mfma_f32_16x16x32_bf16 v[128:131],v[212:215],a[64:67],v[128:131]
s_add_u32 m0,m0,0x00000418
v_mul_f32 v207,v194,v207
v_mfma_f32_16x16x32_bf16 v[132:135],v[212:215],a[68:71],v[132:135]
v_cvt_pk_bf16_f32 v244,v200,v201
v_cvt_pk_bf16_f32 v245,v202,v203
v_mfma_f32_16x16x32_bf16 v[136:139],v[212:215],a[72:75],v[136:139]
buffer_load_dwordx4 v254,s[16:19],s2 offen lds
s_add_u32 m0,m0,0x00000428
v_mfma_f32_16x16x32_bf16 v[140:143],v[212:215],a[76:79],v[140:143]
v_cvt_pk_bf16_f32 v246,v204,v205
s_waitcnt lgkmcnt(4)
v_mfma_f32_16x16x32_bf16 v[16:19],v[216:219],a[64:67],v[16:19]
ds_read_b64_tr_b16 v[232:233],v252 offset:33984
v_cvt_pk_bf16_f32 v247,v206,v207
v_mfma_f32_16x16x32_bf16 v[20:23],v[216:219],a[68:71],v[20:23]
ds_read_b64_tr_b16 v[234:235],v252 offset:34496
buffer_load_dwordx4 v254,s[16:19],s3 offen lds
v_mfma_f32_16x16x32_bf16 v[24:27],v[216:219],a[72:75],v[24:27]
ds_read_b64_tr_b16 v[236:237],v252 offset:33992
s_add_u32 s60,s63,4096
v_mfma_f32_16x16x32_bf16 v[28:31],v[216:219],a[76:79],v[28:31]
ds_read_b64_tr_b16 v[238:239],v252 offset:34504
buffer_store_dwordx4 v[244:247],v248,s[20:23],s60 offen offset:3072 sc1
v_mfma_f32_16x16x32_bf16 v[144:147],v[220:223],a[64:67],v[144:147]
s_add_u32 s16,s16,262144
s_addc_u32 s17,s17,0
v_mfma_f32_16x16x32_bf16 v[148:151],v[220:223],a[68:71],v[148:151]
s_sub_u32 s18,s18,262144
s_add_u32 m0,s29,0
v_mfma_f32_16x16x32_bf16 v[152:155],v[220:223],a[72:75],v[152:155]
buffer_load_dwordx4 v254,s[16:19],s0 offen lds
s_add_u32 m0,m0,0x00000428
v_mfma_f32_16x16x32_bf16 v[156:159],v[220:223],a[76:79],v[156:159]
buffer_load_dwordx4 v254,s[16:19],s1 offen lds
s_waitcnt lgkmcnt(4)
v_mfma_f32_16x16x32_bf16 v[32:35],v[224:227],a[64:67],v[32:35]
ds_read_b64_tr_b16 v[208:209],v252 offset:34048
s_add_u32 m0,m0,0x00000418
v_mfma_f32_16x16x32_bf16 v[36:39],v[224:227],a[68:71],v[36:39]
ds_read_b64_tr_b16 v[210:211],v252 offset:34560
v_mfma_f32_16x16x32_bf16 v[40:43],v[224:227],a[72:75],v[40:43]
ds_read_b64_tr_b16 v[212:213],v252 offset:34056
buffer_load_dwordx4 v254,s[16:19],s2 offen lds
v_mfma_f32_16x16x32_bf16 v[44:47],v[224:227],a[76:79],v[44:47]
ds_read_b64_tr_b16 v[214:215],v252 offset:34568
s_add_u32 m0,m0,0x00000428
v_mfma_f32_16x16x32_bf16 v[160:163],v[228:231],a[64:67],v[160:163]
v_mfma_f32_16x16x32_bf16 v[164:167],v[228:231],a[68:71],v[164:167]
buffer_load_dwordx4 v254,s[16:19],s3 offen lds
v_mfma_f32_16x16x32_bf16 v[168:171],v[228:231],a[72:75],v[168:171]
s_add_u32 s16,s16,262144
s_addc_u32 s17,s17,0
v_mfma_f32_16x16x32_bf16 v[172:175],v[228:231],a[76:79],v[172:175]
s_sub_u32 s18,s18,262144
s_waitcnt lgkmcnt(4)
v_mfma_f32_16x16x32_bf16 v[48:51],v[232:235],a[64:67],v[48:51]
ds_read_b64_tr_b16 v[216:217],v252 offset:34112
s_add_u32 m0,s29,67584
v_mfma_f32_16x16x32_bf16 v[52:55],v[232:235],a[68:71],v[52:55]
ds_read_b64_tr_b16 v[218:219],v252 offset:34624
buffer_load_dwordx4 v251,s[12:15],s31 offen offset:0 nt lds
v_mfma_f32_16x16x32_bf16 v[56:59],v[232:235],a[72:75],v[56:59]
ds_read_b64_tr_b16 v[220:221],v252 offset:34120
s_add_u32 m0,s29,68128
v_mfma_f32_16x16x32_bf16 v[60:63],v[232:235],a[76:79],v[60:63]
ds_read_b64_tr_b16 v[222:223],v252 offset:34632
buffer_load_dwordx4 v251,s[12:15],s31 offen offset:512 nt lds
v_mfma_f32_16x16x32_bf16 v[176:179],v[236:239],a[64:67],v[176:179]
s_add_u32 m0,s29,68672
v_accvgpr_read_b32 v200,a232
v_mfma_f32_16x16x32_bf16 v[180:183],v[236:239],a[68:71],v[180:183]
buffer_load_dwordx4 v251,s[12:15],s31 offen offset:1024 nt lds
s_add_u32 m0,s29,69216
v_mfma_f32_16x16x32_bf16 v[184:187],v[236:239],a[72:75],v[184:187]
buffer_load_dwordx4 v251,s[12:15],s31 offen offset:1536 nt lds
s_add_u32 s31,s31,16384
v_mfma_f32_16x16x32_bf16 v[188:191],v[236:239],a[76:79],v[188:191]
v_accvgpr_read_b32 v201,a233
s_waitcnt lgkmcnt(4)
v_mfma_f32_16x16x32_bf16 v[64:67],v[208:211],a[64:67],v[64:67]
ds_read_b64_tr_b16 v[224:225],v252 offset:34176
v_accvgpr_read_b32 v202,a234
v_mfma_f32_16x16x32_bf16 v[68:71],v[208:211],a[68:71],v[68:71]
ds_read_b64_tr_b16 v[226:227],v252 offset:34688
v_accvgpr_read_b32 v203,a235
v_mfma_f32_16x16x32_bf16 v[72:75],v[208:211],a[72:75],v[72:75]
ds_read_b64_tr_b16 v[228:229],v252 offset:34184
v_accvgpr_read_b32 v204,a248
v_mfma_f32_16x16x32_bf16 v[76:79],v[208:211],a[76:79],v[76:79]
ds_read_b64_tr_b16 v[230:231],v252 offset:34696
v_accvgpr_read_b32 v205,a249
v_mfma_f32_16x16x32_bf16 a[0:3],v[212:215],a[64:67],a[0:3]
v_accvgpr_read_b32 v206,a250
v_accvgpr_read_b32 v207,a251
v_mfma_f32_16x16x32_bf16 a[4:7],v[212:215],a[68:71],a[4:7]
v_mul_f32 v200,v196,v200
v_mul_f32 v201,v196,v201
v_mfma_f32_16x16x32_bf16 a[8:11],v[212:215],a[72:75],a[8:11]
v_mul_f32 v202,v196,v202
v_mul_f32 v203,v196,v203
v_mfma_f32_16x16x32_bf16 a[12:15],v[212:215],a[76:79],a[12:15]
v_mul_f32 v204,v196,v204
s_waitcnt lgkmcnt(4)
v_mfma_f32_16x16x32_bf16 v[80:83],v[216:219],a[64:67],v[80:83]
ds_read_b64_tr_b16 v[232:233],v252 offset:34240
v_mov_b32 v254,v251
v_mfma_f32_16x16x32_bf16 v[84:87],v[216:219],a[68:71],v[84:87]
ds_read_b64_tr_b16 v[234:235],v252 offset:34752
v_mul_f32 v205,v196,v205
v_mfma_f32_16x16x32_bf16 v[88:91],v[216:219],a[72:75],v[88:91]
ds_read_b64_tr_b16 v[236:237],v252 offset:34248
v_mul_f32 v206,v196,v206
v_mfma_f32_16x16x32_bf16 v[92:95],v[216:219],a[76:79],v[92:95]
ds_read_b64_tr_b16 v[238:239],v252 offset:34760
v_mul_f32 v207,v196,v207
v_mfma_f32_16x16x32_bf16 a[16:19],v[220:223],a[64:67],a[16:19]
v_cvt_pk_bf16_f32 v240,v200,v201
v_cvt_pk_bf16_f32 v241,v202,v203
v_mfma_f32_16x16x32_bf16 a[20:23],v[220:223],a[68:71],a[20:23]
v_cvt_pk_bf16_f32 v242,v204,v205
v_cvt_pk_bf16_f32 v243,v206,v207
v_mfma_f32_16x16x32_bf16 a[24:27],v[220:223],a[72:75],a[24:27]
s_add_u32 s60,s64,4096
buffer_store_dwordx4 v[240:243],v248,s[20:23],s60 offen offset:3072 sc1
v_mfma_f32_16x16x32_bf16 a[28:31],v[220:223],a[76:79],a[28:31]
s_waitcnt lgkmcnt(4)
v_mfma_f32_16x16x32_bf16 v[96:99],v[224:227],a[64:67],v[96:99]
ds_read_b64_tr_b16 v[208:209],v252 offset:50688
v_mfma_f32_16x16x32_bf16 v[100:103],v[224:227],a[68:71],v[100:103]
ds_read_b64_tr_b16 v[210:211],v252 offset:51200
v_mfma_f32_16x16x32_bf16 v[104:107],v[224:227],a[72:75],v[104:107]
ds_read_b64_tr_b16 v[212:213],v252 offset:50696
v_mfma_f32_16x16x32_bf16 v[108:111],v[224:227],a[76:79],v[108:111]
ds_read_b64_tr_b16 v[214:215],v252 offset:51208
v_mfma_f32_16x16x32_bf16 a[32:35],v[228:231],a[64:67],a[32:35]
v_mfma_f32_16x16x32_bf16 a[36:39],v[228:231],a[68:71],a[36:39]
v_mfma_f32_16x16x32_bf16 a[40:43],v[228:231],a[72:75],a[40:43]
v_mfma_f32_16x16x32_bf16 a[44:47],v[228:231],a[76:79],a[44:47]
s_waitcnt lgkmcnt(4)
v_mfma_f32_16x16x32_bf16 v[112:115],v[232:235],a[64:67],v[112:115]
ds_read_b64_tr_b16 v[216:217],v252 offset:50752
v_mfma_f32_16x16x32_bf16 v[116:119],v[232:235],a[68:71],v[116:119]
ds_read_b64_tr_b16 v[218:219],v252 offset:51264
v_mfma_f32_16x16x32_bf16 v[120:123],v[232:235],a[72:75],v[120:123]
ds_read_b64_tr_b16 v[220:221],v252 offset:50760
v_mfma_f32_16x16x32_bf16 v[124:127],v[232:235],a[76:79],v[124:127]
ds_read_b64_tr_b16 v[222:223],v252 offset:51272
v_mfma_f32_16x16x32_bf16 a[48:51],v[236:239],a[64:67],a[48:51]
v_mbcnt_lo_u32_b32 v250,-1,0
v_mbcnt_hi_u32_b32 v250,-1,v250
v_mfma_f32_16x16x32_bf16 a[52:55],v[236:239],a[68:71],a[52:55]
v_and_b32 v249,15,v250
v_mul_u32_u24 v249,1056,v249
v_mfma_f32_16x16x32_bf16 a[56:59],v[236:239],a[72:75],a[56:59]
v_lshrrev_b32 v250,4,v250
v_lshl_add_u32 v250,v250,4,v249
v_mfma_f32_16x16x32_bf16 a[60:63],v[236:239],a[76:79],a[60:63]
v_accvgpr_read_b32 v200,a236
s_waitcnt lgkmcnt(4)
v_mfma_f32_16x16x32_bf16 v[0:3],v[208:211],a[96:99],v[0:3]
ds_read_b64_tr_b16 v[224:225],v252 offset:50816
v_accvgpr_read_b32 v201,a237
v_mfma_f32_16x16x32_bf16 v[4:7],v[208:211],a[100:103],v[4:7]
ds_read_b64_tr_b16 v[226:227],v252 offset:51328
v_accvgpr_read_b32 v202,a238
v_mfma_f32_16x16x32_bf16 v[8:11],v[208:211],a[104:107],v[8:11]
ds_read_b64_tr_b16 v[228:229],v252 offset:50824
v_accvgpr_read_b32 v203,a239
v_mfma_f32_16x16x32_bf16 v[12:15],v[208:211],a[108:111],v[12:15]
s_waitcnt vmcnt(14)
ds_read_b64_tr_b16 v[230:231],v252 offset:51336
v_mfma_f32_16x16x32_bf16 v[128:131],v[212:215],a[96:99],v[128:131]
ds_read_b128 a[64:67],v253 offset:16896
v_accvgpr_read_b32 v204,a252
v_mfma_f32_16x16x32_bf16 v[132:135],v[212:215],a[100:103],v[132:135]
ds_read_b128 a[68:71],v253 offset:18944
v_accvgpr_read_b32 v205,a253
v_mfma_f32_16x16x32_bf16 v[136:139],v[212:215],a[104:107],v[136:139]
ds_read_b128 a[72:75],v253 offset:33792
v_accvgpr_read_b32 v206,a254
v_mfma_f32_16x16x32_bf16 v[140:143],v[212:215],a[108:111],v[140:143]
v_accvgpr_read_b32 v207,a255
s_waitcnt lgkmcnt(7)
v_mfma_f32_16x16x32_bf16 v[16:19],v[216:219],a[96:99],v[16:19]
ds_read_b64_tr_b16 v[232:233],v252 offset:50880
v_mul_f32 v200,v198,v200
v_mfma_f32_16x16x32_bf16 v[20:23],v[216:219],a[100:103],v[20:23]
ds_read_b64_tr_b16 v[234:235],v252 offset:51392
v_mul_f32 v201,v198,v201
v_mfma_f32_16x16x32_bf16 v[24:27],v[216:219],a[104:107],v[24:27]
ds_read_b64_tr_b16 v[236:237],v252 offset:50888
v_mul_f32 v202,v198,v202
v_mfma_f32_16x16x32_bf16 v[28:31],v[216:219],a[108:111],v[28:31]
ds_read_b64_tr_b16 v[238:239],v252 offset:51400
v_mul_f32 v203,v198,v203
v_mfma_f32_16x16x32_bf16 v[144:147],v[220:223],a[96:99],v[144:147]
ds_read_b128 a[76:79],v253 offset:35840
v_xor_b32 v253,64,v253
v_mfma_f32_16x16x32_bf16 v[148:151],v[220:223],a[100:103],v[148:151]
ds_read_b128 a[80:83],v253 offset:16896
v_mul_f32 v204,v198,v204
v_mfma_f32_16x16x32_bf16 v[152:155],v[220:223],a[104:107],v[152:155]
ds_read_b128 a[84:87],v253 offset:18944
v_mul_f32 v205,v198,v205
v_mfma_f32_16x16x32_bf16 v[156:159],v[220:223],a[108:111],v[156:159]
v_mul_f32 v206,v198,v206
s_waitcnt lgkmcnt(10)
v_mfma_f32_16x16x32_bf16 v[32:35],v[224:227],a[96:99],v[32:35]
ds_read_b64_tr_b16 v[208:209],v252 offset:50944
v_mul_f32 v207,v198,v207
v_mfma_f32_16x16x32_bf16 v[36:39],v[224:227],a[100:103],v[36:39]
ds_read_b64_tr_b16 v[210:211],v252 offset:51456
v_cvt_pk_bf16_f32 v244,v200,v201
v_mfma_f32_16x16x32_bf16 v[40:43],v[224:227],a[104:107],v[40:43]
ds_read_b64_tr_b16 v[212:213],v252 offset:50952
v_cvt_pk_bf16_f32 v245,v202,v203
v_mfma_f32_16x16x32_bf16 v[44:47],v[224:227],a[108:111],v[44:47]
ds_read_b64_tr_b16 v[214:215],v252 offset:51464
v_cvt_pk_bf16_f32 v246,v204,v205
v_mfma_f32_16x16x32_bf16 v[160:163],v[228:231],a[96:99],v[160:163]
ds_read_b128 a[88:91],v253 offset:33792
v_cvt_pk_bf16_f32 v247,v206,v207
v_mfma_f32_16x16x32_bf16 v[164:167],v[228:231],a[100:103],v[164:167]
ds_read_b128 a[92:95],v253 offset:35840
v_xor_b32 v253,64,v253
v_mfma_f32_16x16x32_bf16 v[168:171],v[228:231],a[104:107],v[168:171]
s_add_u32 s60,s65,4096
buffer_store_dwordx4 v[244:247],v248,s[20:23],s60 offen offset:3072 sc1
v_mfma_f32_16x16x32_bf16 v[172:175],v[228:231],a[108:111],v[172:175]
v_add_u32 v250,118272,v250
s_waitcnt lgkmcnt(9)
v_mfma_f32_16x16x32_bf16 v[48:51],v[232:235],a[96:99],v[48:51]
ds_read_b64_tr_b16 v[216:217],v252 offset:51008
v_mfma_f32_16x16x32_bf16 v[52:55],v[232:235],a[100:103],v[52:55]
ds_read_b64_tr_b16 v[218:219],v252 offset:51520
v_mfma_f32_16x16x32_bf16 v[56:59],v[232:235],a[104:107],v[56:59]
ds_read_b64_tr_b16 v[220:221],v252 offset:51016
v_mfma_f32_16x16x32_bf16 v[60:63],v[232:235],a[108:111],v[60:63]
ds_read_b64_tr_b16 v[222:223],v252 offset:51528
v_mfma_f32_16x16x32_bf16 v[176:179],v[236:239],a[96:99],v[176:179]
v_mfma_f32_16x16x32_bf16 v[180:183],v[236:239],a[100:103],v[180:183]
v_mfma_f32_16x16x32_bf16 v[184:187],v[236:239],a[104:107],v[184:187]
v_mfma_f32_16x16x32_bf16 v[188:191],v[236:239],a[108:111],v[188:191]
s_waitcnt lgkmcnt(6)
v_mfma_f32_16x16x32_bf16 v[64:67],v[208:211],a[96:99],v[64:67]
ds_read_b64_tr_b16 v[224:225],v252 offset:51072
v_mfma_f32_16x16x32_bf16 v[68:71],v[208:211],a[100:103],v[68:71]
ds_read_b64_tr_b16 v[226:227],v252 offset:51584
v_mfma_f32_16x16x32_bf16 v[72:75],v[208:211],a[104:107],v[72:75]
ds_read_b64_tr_b16 v[228:229],v252 offset:51080
v_mfma_f32_16x16x32_bf16 v[76:79],v[208:211],a[108:111],v[76:79]
ds_read_b64_tr_b16 v[230:231],v252 offset:51592
v_mfma_f32_16x16x32_bf16 a[0:3],v[212:215],a[96:99],a[0:3]
v_mfma_f32_16x16x32_bf16 a[4:7],v[212:215],a[100:103],a[4:7]
v_mfma_f32_16x16x32_bf16 a[8:11],v[212:215],a[104:107],a[8:11]
v_mfma_f32_16x16x32_bf16 a[12:15],v[212:215],a[108:111],a[12:15]
s_add_u32 m0,s29,84480
s_waitcnt lgkmcnt(4)
v_mfma_f32_16x16x32_bf16 v[80:83],v[216:219],a[96:99],v[80:83]
ds_read_b64_tr_b16 v[232:233],v252 offset:51136
buffer_load_dwordx4 v254,s[12:15],s31 offen offset:0 nt lds
v_mfma_f32_16x16x32_bf16 v[84:87],v[216:219],a[100:103],v[84:87]
ds_read_b64_tr_b16 v[234:235],v252 offset:51648
s_add_u32 m0,m0,0x00000220
v_mfma_f32_16x16x32_bf16 v[88:91],v[216:219],a[104:107],v[88:91]
ds_read_b64_tr_b16 v[236:237],v252 offset:51144
v_mfma_f32_16x16x32_bf16 v[92:95],v[216:219],a[108:111],v[92:95]
ds_read_b64_tr_b16 v[238:239],v252 offset:51656
v_mfma_f32_16x16x32_bf16 a[16:19],v[220:223],a[96:99],a[16:19]
v_mfma_f32_16x16x32_bf16 a[20:23],v[220:223],a[100:103],a[20:23]
buffer_load_dwordx4 v254,s[12:15],s31 offen offset:512 nt lds
v_mfma_f32_16x16x32_bf16 a[24:27],v[220:223],a[104:107],a[24:27]
v_mfma_f32_16x16x32_bf16 a[28:31],v[220:223],a[108:111],a[28:31]
s_waitcnt lgkmcnt(4)
v_mfma_f32_16x16x32_bf16 v[96:99],v[224:227],a[96:99],v[96:99]
v_mfma_f32_16x16x32_bf16 v[100:103],v[224:227],a[100:103],v[100:103]
s_waitcnt vmcnt(8) lgkmcnt(0)
s_barrier
v_mfma_f32_16x16x32_bf16 v[104:107],v[224:227],a[104:107],v[104:107]
ds_read_b64_tr_b16 v[208:209],v252 offset:16896
s_add_u32 m0,m0,0x00000220
v_mfma_f32_16x16x32_bf16 v[108:111],v[224:227],a[108:111],v[108:111]
ds_read_b64_tr_b16 v[210:211],v252 offset:17408
buffer_load_dwordx4 v254,s[12:15],s31 offen offset:1024 nt lds
v_mfma_f32_16x16x32_bf16 a[32:35],v[228:231],a[96:99],a[32:35]
ds_read_b64_tr_b16 v[212:213],v252 offset:0
s_add_u32 m0,m0,0x00000220
v_mfma_f32_16x16x32_bf16 a[36:39],v[228:231],a[100:103],a[36:39]
ds_read_b64_tr_b16 v[214:215],v252 offset:512
v_mfma_f32_16x16x32_bf16 a[40:43],v[228:231],a[104:107],a[40:43]
v_mfma_f32_16x16x32_bf16 a[44:47],v[228:231],a[108:111],a[44:47]
v_mfma_f32_16x16x32_bf16 v[112:115],v[232:235],a[96:99],v[112:115]
ds_read_b64_tr_b16 v[216:217],v252 offset:16904
v_mfma_f32_16x16x32_bf16 v[116:119],v[232:235],a[100:103],v[116:119]
ds_read_b64_tr_b16 v[218:219],v252 offset:17416
v_mfma_f32_16x16x32_bf16 v[120:123],v[232:235],a[104:107],v[120:123]
ds_read_b64_tr_b16 v[220:221],v252 offset:8
v_mfma_f32_16x16x32_bf16 v[124:127],v[232:235],a[108:111],v[124:127]
ds_read_b64_tr_b16 v[222:223],v252 offset:520
v_mfma_f32_16x16x32_bf16 a[48:51],v[236:239],a[96:99],a[48:51]
v_mfma_f32_16x16x32_bf16 a[52:55],v[236:239],a[100:103],a[52:55]
v_mfma_f32_16x16x32_bf16 a[56:59],v[236:239],a[104:107],a[56:59]
buffer_load_dwordx4 v254,s[12:15],s31 offen offset:1536 nt lds
s_add_u32 s31,s31,16384
v_mfma_f32_16x16x32_bf16 a[60:63],v[236:239],a[108:111],a[60:63]
s_add_u32 m0,s29,33792
s_waitcnt lgkmcnt(4)
v_mfma_f32_16x16x32_bf16 v[0:3],v[208:211],a[64:67],v[0:3]
ds_read_b64_tr_b16 v[224:225],v252 offset:16960
v_mfma_f32_16x16x32_bf16 v[4:7],v[208:211],a[68:71],v[4:7]
ds_read_b64_tr_b16 v[226:227],v252 offset:17472
v_mfma_f32_16x16x32_bf16 v[8:11],v[208:211],a[72:75],v[8:11]
ds_read_b64_tr_b16 v[228:229],v252 offset:64
v_mfma_f32_16x16x32_bf16 v[12:15],v[208:211],a[76:79],v[12:15]
ds_read_b64_tr_b16 v[230:231],v252 offset:576
v_mov_b32 v192,s61
v_mfma_f32_16x16x32_bf16 v[0:3],v[212:215],a[80:83],v[0:3]
v_mfma_f32_16x16x32_bf16 v[4:7],v[212:215],a[84:87],v[4:7]
v_mfma_f32_16x16x32_bf16 v[8:11],v[212:215],a[88:91],v[8:11]
v_mfma_f32_16x16x32_bf16 v[12:15],v[212:215],a[92:95],v[12:15]
s_waitcnt lgkmcnt(4)
v_mfma_f32_16x16x32_bf16 v[128:131],v[216:219],a[64:67],v[128:131]
ds_read_b64_tr_b16 v[232:233],v252 offset:16968
v_mfma_f32_16x16x32_bf16 v[132:135],v[216:219],a[68:71],v[132:135]
ds_read_b64_tr_b16 v[234:235],v252 offset:17480
buffer_load_dwordx4 v254,s[8:11],s30 offen offset:0 nt lds
v_mfma_f32_16x16x32_bf16 v[136:139],v[216:219],a[72:75],v[136:139]
ds_read_b64_tr_b16 v[236:237],v252 offset:72
s_add_u32 m0,m0,0x00000220
v_mfma_f32_16x16x32_bf16 v[140:143],v[216:219],a[76:79],v[140:143]
ds_read_b64_tr_b16 v[238:239],v252 offset:584
v_mfma_f32_16x16x32_bf16 v[128:131],v[220:223],a[80:83],v[128:131]
v_mfma_f32_16x16x32_bf16 v[132:135],v[220:223],a[84:87],v[132:135]
v_mfma_f32_16x16x32_bf16 v[136:139],v[220:223],a[88:91],v[136:139]
v_mfma_f32_16x16x32_bf16 v[140:143],v[220:223],a[92:95],v[140:143]
s_waitcnt lgkmcnt(4)
v_mfma_f32_16x16x32_bf16 v[16:19],v[224:227],a[64:67],v[16:19]
ds_read_b64_tr_b16 v[208:209],v252 offset:17024
v_mfma_f32_16x16x32_bf16 v[20:23],v[224:227],a[68:71],v[20:23]
ds_read_b64_tr_b16 v[210:211],v252 offset:17536
v_mul_f32 v0,s61,v0
v_mfma_f32_16x16x32_bf16 v[24:27],v[224:227],a[72:75],v[24:27]
ds_read_b64_tr_b16 v[212:213],v252 offset:128
v_mul_f32 v1,s61,v1
v_mfma_f32_16x16x32_bf16 v[28:31],v[224:227],a[76:79],v[28:31]
ds_read_b64_tr_b16 v[214:215],v252 offset:640
v_mul_f32 v2,s61,v2
v_mfma_f32_16x16x32_bf16 v[16:19],v[228:231],a[80:83],v[16:19]
buffer_load_dwordx4 v254,s[8:11],s30 offen offset:512 nt lds
s_add_u32 m0,m0,0x00000220
v_mfma_f32_16x16x32_bf16 v[20:23],v[228:231],a[84:87],v[20:23]
v_mul_f32 v3,s61,v3
v_cvt_pk_bf16_f32 v0,v0,v1
v_mfma_f32_16x16x32_bf16 v[24:27],v[228:231],a[88:91],v[24:27]
v_cvt_pk_bf16_f32 v1,v2,v3
v_mul_f32 v128,s61,v128
v_mfma_f32_16x16x32_bf16 v[28:31],v[228:231],a[92:95],v[28:31]
v_mul_f32 v129,s61,v129
s_waitcnt lgkmcnt(4)
v_mfma_f32_16x16x32_bf16 v[144:147],v[232:235],a[64:67],v[144:147]
ds_read_b64_tr_b16 v[216:217],v252 offset:17032
v_mul_f32 v130,s61,v130
v_mfma_f32_16x16x32_bf16 v[148:151],v[232:235],a[68:71],v[148:151]
ds_read_b64_tr_b16 v[218:219],v252 offset:17544
v_mul_f32 v131,s61,v131
v_mfma_f32_16x16x32_bf16 v[152:155],v[232:235],a[72:75],v[152:155]
ds_read_b64_tr_b16 v[220:221],v252 offset:136
v_cvt_pk_bf16_f32 v2,v128,v129
v_mfma_f32_16x16x32_bf16 v[156:159],v[232:235],a[76:79],v[156:159]
ds_read_b64_tr_b16 v[222:223],v252 offset:648
v_cvt_pk_bf16_f32 v3,v130,v131
v_mfma_f32_16x16x32_bf16 v[144:147],v[236:239],a[80:83],v[144:147]
v_mul_f32 v4,s61,v4
v_mul_f32 v5,s61,v5
v_mfma_f32_16x16x32_bf16 v[148:151],v[236:239],a[84:87],v[148:151]
v_mul_f32 v6,s61,v6
v_mul_f32 v7,s61,v7
v_mfma_f32_16x16x32_bf16 v[152:155],v[236:239],a[88:91],v[152:155]
v_cvt_pk_bf16_f32 v4,v4,v5
v_cvt_pk_bf16_f32 v5,v6,v7
v_mfma_f32_16x16x32_bf16 v[156:159],v[236:239],a[92:95],v[156:159]
buffer_load_dwordx4 v254,s[8:11],s30 offen offset:1024 nt lds
s_waitcnt lgkmcnt(4)
v_mfma_f32_16x16x32_bf16 v[32:35],v[208:211],a[64:67],v[32:35]
ds_read_b64_tr_b16 v[224:225],v252 offset:17088
s_add_u32 m0,m0,0x00000220
v_mfma_f32_16x16x32_bf16 v[36:39],v[208:211],a[68:71],v[36:39]
ds_read_b64_tr_b16 v[226:227],v252 offset:17600
v_mul_f32 v132,s61,v132
v_mfma_f32_16x16x32_bf16 v[40:43],v[208:211],a[72:75],v[40:43]
ds_read_b64_tr_b16 v[228:229],v252 offset:192
v_mul_f32 v133,s61,v133
v_mfma_f32_16x16x32_bf16 v[44:47],v[208:211],a[76:79],v[44:47]
ds_read_b64_tr_b16 v[230:231],v252 offset:704
v_mul_f32 v134,s61,v134
v_mfma_f32_16x16x32_bf16 v[32:35],v[212:215],a[80:83],v[32:35]
v_mul_f32 v135,s61,v135
v_cvt_pk_bf16_f32 v6,v132,v133
v_mfma_f32_16x16x32_bf16 v[36:39],v[212:215],a[84:87],v[36:39]
v_cvt_pk_bf16_f32 v7,v134,v135
v_mul_f32 v8,s61,v8
v_mfma_f32_16x16x32_bf16 v[40:43],v[212:215],a[88:91],v[40:43]
v_mul_f32 v9,s61,v9
v_mul_f32 v10,s61,v10
v_mfma_f32_16x16x32_bf16 v[44:47],v[212:215],a[92:95],v[44:47]
v_mul_f32 v11,s61,v11
s_waitcnt lgkmcnt(4)
v_mfma_f32_16x16x32_bf16 v[160:163],v[216:219],a[64:67],v[160:163]
ds_read_b64_tr_b16 v[232:233],v252 offset:17096
v_cvt_pk_bf16_f32 v8,v8,v9
v_mfma_f32_16x16x32_bf16 v[164:167],v[216:219],a[68:71],v[164:167]
ds_read_b64_tr_b16 v[234:235],v252 offset:17608
v_cvt_pk_bf16_f32 v9,v10,v11
v_mfma_f32_16x16x32_bf16 v[168:171],v[216:219],a[72:75],v[168:171]
ds_read_b64_tr_b16 v[236:237],v252 offset:200
buffer_load_dwordx4 v254,s[8:11],s30 offen offset:1536 nt lds
v_mfma_f32_16x16x32_bf16 v[172:175],v[216:219],a[76:79],v[172:175]
ds_read_b64_tr_b16 v[238:239],v252 offset:712
s_add_u32 s30,s30,16384
v_mfma_f32_16x16x32_bf16 v[160:163],v[220:223],a[80:83],v[160:163]
s_add_u32 m0,s29,50688
v_mul_f32 v136,s61,v136
v_mfma_f32_16x16x32_bf16 v[164:167],v[220:223],a[84:87],v[164:167]
v_mul_f32 v137,s61,v137
v_mul_f32 v138,s61,v138
v_mfma_f32_16x16x32_bf16 v[168:171],v[220:223],a[88:91],v[168:171]
v_mul_f32 v139,s61,v139
v_cvt_pk_bf16_f32 v10,v136,v137
v_mfma_f32_16x16x32_bf16 v[172:175],v[220:223],a[92:95],v[172:175]
v_cvt_pk_bf16_f32 v11,v138,v139
s_waitcnt lgkmcnt(4)
v_mfma_f32_16x16x32_bf16 v[48:51],v[224:227],a[64:67],v[48:51]
ds_read_b64_tr_b16 v[208:209],v252 offset:17152
v_mul_f32 v12,s61,v12
v_mfma_f32_16x16x32_bf16 v[52:55],v[224:227],a[68:71],v[52:55]
ds_read_b64_tr_b16 v[210:211],v252 offset:17664
v_mul_f32 v13,s61,v13
v_mfma_f32_16x16x32_bf16 v[56:59],v[224:227],a[72:75],v[56:59]
ds_read_b64_tr_b16 v[212:213],v252 offset:256
v_mul_f32 v14,s61,v14
v_mfma_f32_16x16x32_bf16 v[60:63],v[224:227],a[76:79],v[60:63]
ds_read_b64_tr_b16 v[214:215],v252 offset:768
v_mul_f32 v15,s61,v15
v_mfma_f32_16x16x32_bf16 v[48:51],v[228:231],a[80:83],v[48:51]
v_cvt_pk_bf16_f32 v12,v12,v13
v_cvt_pk_bf16_f32 v13,v14,v15
v_mfma_f32_16x16x32_bf16 v[52:55],v[228:231],a[84:87],v[52:55]
buffer_load_dwordx4 v254,s[8:11],s30 offen offset:0 nt lds
s_add_u32 m0,m0,0x00000220
v_mfma_f32_16x16x32_bf16 v[56:59],v[228:231],a[88:91],v[56:59]
v_mul_f32 v140,s61,v140
v_mul_f32 v141,s61,v141
v_mfma_f32_16x16x32_bf16 v[60:63],v[228:231],a[92:95],v[60:63]
v_mul_f32 v142,s61,v142
s_waitcnt lgkmcnt(4)
v_mfma_f32_16x16x32_bf16 v[176:179],v[232:235],a[64:67],v[176:179]
ds_read_b64_tr_b16 v[216:217],v252 offset:17160
v_mul_f32 v143,s61,v143
v_mfma_f32_16x16x32_bf16 v[180:183],v[232:235],a[68:71],v[180:183]
ds_read_b64_tr_b16 v[218:219],v252 offset:17672
v_cvt_pk_bf16_f32 v14,v140,v141
v_mfma_f32_16x16x32_bf16 v[184:187],v[232:235],a[72:75],v[184:187]
ds_read_b64_tr_b16 v[220:221],v252 offset:264
v_cvt_pk_bf16_f32 v15,v142,v143
v_mfma_f32_16x16x32_bf16 v[188:191],v[232:235],a[76:79],v[188:191]
ds_read_b64_tr_b16 v[222:223],v252 offset:776
v_mul_f32 v16,s61,v16
v_mfma_f32_16x16x32_bf16 v[176:179],v[236:239],a[80:83],v[176:179]
v_mul_f32 v17,s61,v17
v_mul_f32 v18,s61,v18
v_mfma_f32_16x16x32_bf16 v[180:183],v[236:239],a[84:87],v[180:183]
v_mul_f32 v19,s61,v19
v_cvt_pk_bf16_f32 v16,v16,v17
v_mfma_f32_16x16x32_bf16 v[184:187],v[236:239],a[88:91],v[184:187]
v_cvt_pk_bf16_f32 v17,v18,v19
v_mul_f32 v144,s61,v144
v_mfma_f32_16x16x32_bf16 v[188:191],v[236:239],a[92:95],v[188:191]
v_mul_f32 v145,s61,v145
s_waitcnt lgkmcnt(4)
v_mfma_f32_16x16x32_bf16 v[64:67],v[208:211],a[64:67],v[64:67]
ds_read_b64_tr_b16 v[224:225],v252 offset:17216
buffer_load_dwordx4 v254,s[8:11],s30 offen offset:512 nt lds
v_mfma_f32_16x16x32_bf16 v[68:71],v[208:211],a[68:71],v[68:71]
ds_read_b64_tr_b16 v[226:227],v252 offset:17728
s_add_u32 m0,m0,0x00000220
v_mfma_f32_16x16x32_bf16 v[72:75],v[208:211],a[72:75],v[72:75]
ds_read_b64_tr_b16 v[228:229],v252 offset:320
v_mul_f32 v146,s61,v146
v_mfma_f32_16x16x32_bf16 v[76:79],v[208:211],a[76:79],v[76:79]
ds_read_b64_tr_b16 v[230:231],v252 offset:832
v_mul_f32 v147,s61,v147
v_mfma_f32_16x16x32_bf16 v[64:67],v[212:215],a[80:83],v[64:67]
v_cvt_pk_bf16_f32 v18,v144,v145
v_cvt_pk_bf16_f32 v19,v146,v147
v_mfma_f32_16x16x32_bf16 v[68:71],v[212:215],a[84:87],v[68:71]
v_mul_f32 v20,s61,v20
v_mul_f32 v21,s61,v21
v_mfma_f32_16x16x32_bf16 v[72:75],v[212:215],a[88:91],v[72:75]
v_mul_f32 v22,s61,v22
v_mul_f32 v23,s61,v23
v_mfma_f32_16x16x32_bf16 v[76:79],v[212:215],a[92:95],v[76:79]
v_cvt_pk_bf16_f32 v20,v20,v21
s_waitcnt lgkmcnt(4)
v_mfma_f32_16x16x32_bf16 a[0:3],v[216:219],a[64:67],a[0:3]
ds_read_b64_tr_b16 v[232:233],v252 offset:17224
v_cvt_pk_bf16_f32 v21,v22,v23
v_mfma_f32_16x16x32_bf16 a[4:7],v[216:219],a[68:71],a[4:7]
ds_read_b64_tr_b16 v[234:235],v252 offset:17736
v_mul_f32 v148,s61,v148
v_mfma_f32_16x16x32_bf16 a[8:11],v[216:219],a[72:75],a[8:11]
ds_read_b64_tr_b16 v[236:237],v252 offset:328
v_mul_f32 v149,s61,v149
v_mfma_f32_16x16x32_bf16 a[12:15],v[216:219],a[76:79],a[12:15]
ds_read_b64_tr_b16 v[238:239],v252 offset:840
buffer_load_dwordx4 v254,s[8:11],s30 offen offset:1024 nt lds
v_mfma_f32_16x16x32_bf16 a[0:3],v[220:223],a[80:83],a[0:3]
s_add_u32 m0,m0,0x00000220
v_mul_f32 v150,s61,v150
v_mfma_f32_16x16x32_bf16 a[4:7],v[220:223],a[84:87],a[4:7]
v_mul_f32 v151,s61,v151
v_cvt_pk_bf16_f32 v22,v148,v149
v_mfma_f32_16x16x32_bf16 a[8:11],v[220:223],a[88:91],a[8:11]
v_cvt_pk_bf16_f32 v23,v150,v151
v_mul_f32 v24,s61,v24
v_mfma_f32_16x16x32_bf16 a[12:15],v[220:223],a[92:95],a[12:15]
v_mul_f32 v25,s61,v25
s_waitcnt lgkmcnt(4)
v_mfma_f32_16x16x32_bf16 v[80:83],v[224:227],a[64:67],v[80:83]
ds_read_b64_tr_b16 v[208:209],v252 offset:17280
v_mul_f32 v26,s61,v26
v_mfma_f32_16x16x32_bf16 v[84:87],v[224:227],a[68:71],v[84:87]
ds_read_b64_tr_b16 v[210:211],v252 offset:17792
v_mul_f32 v27,s61,v27
v_mfma_f32_16x16x32_bf16 v[88:91],v[224:227],a[72:75],v[88:91]
ds_read_b64_tr_b16 v[212:213],v252 offset:384
v_cvt_pk_bf16_f32 v24,v24,v25
v_mfma_f32_16x16x32_bf16 v[92:95],v[224:227],a[76:79],v[92:95]
ds_read_b64_tr_b16 v[214:215],v252 offset:896
v_cvt_pk_bf16_f32 v25,v26,v27
v_mfma_f32_16x16x32_bf16 v[80:83],v[228:231],a[80:83],v[80:83]
v_mul_f32 v152,s61,v152
v_mul_f32 v153,s61,v153
v_mfma_f32_16x16x32_bf16 v[84:87],v[228:231],a[84:87],v[84:87]
v_mul_f32 v154,s61,v154
v_mul_f32 v155,s61,v155
v_mfma_f32_16x16x32_bf16 v[88:91],v[228:231],a[88:91],v[88:91]
buffer_load_dwordx4 v254,s[8:11],s30 offen offset:1536 nt lds
s_add_u32 s30,s30,16384
v_mfma_f32_16x16x32_bf16 v[92:95],v[228:231],a[92:95],v[92:95]
s_add_u32 m0,s29,101376
s_waitcnt lgkmcnt(4)
v_mfma_f32_16x16x32_bf16 a[16:19],v[232:235],a[64:67],a[16:19]
ds_read_b64_tr_b16 v[216:217],v252 offset:17288
v_cvt_pk_bf16_f32 v26,v152,v153
v_mfma_f32_16x16x32_bf16 a[20:23],v[232:235],a[68:71],a[20:23]
ds_read_b64_tr_b16 v[218:219],v252 offset:17800
v_cvt_pk_bf16_f32 v27,v154,v155
v_mfma_f32_16x16x32_bf16 a[24:27],v[232:235],a[72:75],a[24:27]
ds_read_b64_tr_b16 v[220:221],v252 offset:392
v_mul_f32 v28,s61,v28
v_mfma_f32_16x16x32_bf16 a[28:31],v[232:235],a[76:79],a[28:31]
ds_read_b64_tr_b16 v[222:223],v252 offset:904
v_mul_f32 v29,s61,v29
v_mfma_f32_16x16x32_bf16 a[16:19],v[236:239],a[80:83],a[16:19]
v_mul_f32 v30,s61,v30
v_mul_f32 v31,s61,v31
v_mfma_f32_16x16x32_bf16 a[20:23],v[236:239],a[84:87],a[20:23]
v_cvt_pk_bf16_f32 v28,v28,v29
v_cvt_pk_bf16_f32 v29,v30,v31
v_mfma_f32_16x16x32_bf16 a[24:27],v[236:239],a[88:91],a[24:27]
v_mul_f32 v156,s61,v156
v_mul_f32 v157,s61,v157
v_mfma_f32_16x16x32_bf16 a[28:31],v[236:239],a[92:95],a[28:31]
v_mul_f32 v158,s61,v158
s_waitcnt lgkmcnt(4)
v_mfma_f32_16x16x32_bf16 v[96:99],v[208:211],a[64:67],v[96:99]
ds_read_b64_tr_b16 v[224:225],v252 offset:17344
v_mul_f32 v159,s61,v159
v_mfma_f32_16x16x32_bf16 v[100:103],v[208:211],a[68:71],v[100:103]
ds_read_b64_tr_b16 v[226:227],v252 offset:17856
buffer_load_dwordx4 v254,s[12:15],s31 offen offset:0 nt lds
v_mfma_f32_16x16x32_bf16 v[104:107],v[208:211],a[72:75],v[104:107]
ds_read_b64_tr_b16 v[228:229],v252 offset:448
s_add_u32 m0,m0,0x00000220
v_mfma_f32_16x16x32_bf16 v[108:111],v[208:211],a[76:79],v[108:111]
ds_read_b64_tr_b16 v[230:231],v252 offset:960
v_cvt_pk_bf16_f32 v30,v156,v157
v_mfma_f32_16x16x32_bf16 v[96:99],v[212:215],a[80:83],v[96:99]
v_cvt_pk_bf16_f32 v31,v158,v159
v_mul_f32 v32,s61,v32
v_mfma_f32_16x16x32_bf16 v[100:103],v[212:215],a[84:87],v[100:103]
v_mul_f32 v33,s61,v33
v_mul_f32 v34,s61,v34
v_mfma_f32_16x16x32_bf16 v[104:107],v[212:215],a[88:91],v[104:107]
v_mul_f32 v35,s61,v35
v_cvt_pk_bf16_f32 v32,v32,v33
v_mfma_f32_16x16x32_bf16 v[108:111],v[212:215],a[92:95],v[108:111]
v_cvt_pk_bf16_f32 v33,v34,v35
s_waitcnt lgkmcnt(4)
v_mfma_f32_16x16x32_bf16 a[32:35],v[216:219],a[64:67],a[32:35]
ds_read_b64_tr_b16 v[232:233],v252 offset:17352
v_mul_f32 v160,s61,v160
v_mfma_f32_16x16x32_bf16 a[36:39],v[216:219],a[68:71],a[36:39]
ds_read_b64_tr_b16 v[234:235],v252 offset:17864
v_mul_f32 v161,s61,v161
v_mfma_f32_16x16x32_bf16 a[40:43],v[216:219],a[72:75],a[40:43]
ds_read_b64_tr_b16 v[236:237],v252 offset:456
v_mul_f32 v162,s61,v162
v_mfma_f32_16x16x32_bf16 a[44:47],v[216:219],a[76:79],a[44:47]
ds_read_b64_tr_b16 v[238:239],v252 offset:968
v_mul_f32 v163,s61,v163
v_mfma_f32_16x16x32_bf16 a[32:35],v[220:223],a[80:83],a[32:35]
v_mov_b32 v252,v250
buffer_load_dwordx4 v254,s[12:15],s31 offen offset:512 nt lds
v_mfma_f32_16x16x32_bf16 a[36:39],v[220:223],a[84:87],a[36:39]
s_add_u32 m0,m0,0x00000220
v_cvt_pk_bf16_f32 v34,v160,v161
v_mfma_f32_16x16x32_bf16 a[40:43],v[220:223],a[88:91],a[40:43]
v_cvt_pk_bf16_f32 v35,v162,v163
v_mul_f32 v36,s61,v36
v_mfma_f32_16x16x32_bf16 a[44:47],v[220:223],a[92:95],a[44:47]
v_mul_f32 v37,s61,v37
s_waitcnt lgkmcnt(4)
v_mfma_f32_16x16x32_bf16 v[112:115],v[224:227],a[64:67],v[112:115]
v_mul_f32 v38,s61,v38
v_mul_f32 v39,s61,v39
v_mfma_f32_16x16x32_bf16 v[116:119],v[224:227],a[68:71],v[116:119]
s_waitcnt vmcnt(63) lgkmcnt(0)
s_barrier
v_mfma_f32_16x16x32_bf16 v[120:123],v[224:227],a[72:75],v[120:123]
ds_read_b128 v[208:211],v252 offset:0
v_cvt_pk_bf16_f32 v36,v36,v37
v_mfma_f32_16x16x32_bf16 v[124:127],v[224:227],a[76:79],v[124:127]
v_cvt_pk_bf16_f32 v37,v38,v39
v_mul_f32 v164,s61,v164
v_mfma_f32_16x16x32_bf16 v[112:115],v[228:231],a[80:83],v[112:115]
ds_read_b128 v[212:215],v252 offset:512
v_mul_f32 v165,s61,v165
v_mfma_f32_16x16x32_bf16 v[116:119],v[228:231],a[84:87],v[116:119]
v_mul_f32 v166,s61,v166
v_mul_f32 v167,s61,v167
v_mfma_f32_16x16x32_bf16 v[120:123],v[228:231],a[88:91],v[120:123]
v_cvt_pk_bf16_f32 v38,v164,v165
v_cvt_pk_bf16_f32 v39,v166,v167
v_mfma_f32_16x16x32_bf16 v[124:127],v[228:231],a[92:95],v[124:127]
buffer_load_dwordx4 v254,s[12:15],s31 offen offset:1024 nt lds
s_add_u32 m0,m0,0x00000220
v_mfma_f32_16x16x32_bf16 a[48:51],v[232:235],a[64:67],a[48:51]
ds_read_b128 v[216:219],v252 offset:64
v_mul_f32 v40,s61,v40
v_mfma_f32_16x16x32_bf16 a[52:55],v[232:235],a[68:71],a[52:55]
v_mul_f32 v41,s61,v41
v_mul_f32 v42,s61,v42
v_mfma_f32_16x16x32_bf16 a[56:59],v[232:235],a[72:75],a[56:59]
ds_read_b128 v[220:223],v252 offset:576
v_mul_f32 v43,s61,v43
v_mfma_f32_16x16x32_bf16 a[60:63],v[232:235],a[76:79],a[60:63]
v_cvt_pk_bf16_f32 v40,v40,v41
v_cvt_pk_bf16_f32 v41,v42,v43
v_mfma_f32_16x16x32_bf16 a[48:51],v[236:239],a[80:83],a[48:51]
v_mul_f32 v168,s61,v168
v_mul_f32 v169,s61,v169
v_mfma_f32_16x16x32_bf16 a[52:55],v[236:239],a[84:87],a[52:55]
v_mul_f32 v170,s61,v170
v_mul_f32 v171,s61,v171
v_mfma_f32_16x16x32_bf16 a[56:59],v[236:239],a[88:91],a[56:59]
v_cvt_pk_bf16_f32 v42,v168,v169
v_cvt_pk_bf16_f32 v43,v170,v171
v_mfma_f32_16x16x32_bf16 a[60:63],v[236:239],a[92:95],a[60:63]
v_mul_f32 v44,s61,v44
s_waitcnt lgkmcnt(2)
v_mul_f32 v45,s61,v45
v_mul_f32 v46,s61,v46
v_mul_f32 v47,s61,v47
v_cvt_pk_bf16_f32 v44,v44,v45
v_cvt_pk_bf16_f32 v45,v46,v47
v_mul_f32 v172,s61,v172
v_mul_f32 v173,s61,v173
v_mul_f32 v174,s61,v174
v_mul_f32 v175,s61,v175
v_cvt_pk_bf16_f32 v46,v172,v173
v_cvt_pk_bf16_f32 v47,v174,v175
v_pk_mul_f32 v[48:49],v[48:49],v[192:193] op_sel_hi:[1,0]
v_pk_mul_f32 v[50:51],v[50:51],v[192:193] op_sel_hi:[1,0]
v_cvt_pk_bf16_f32 v48,v48,v49
v_cvt_pk_bf16_f32 v49,v50,v51
v_pk_mul_f32 v[176:177],v[176:177],v[192:193] op_sel_hi:[1,0]
v_pk_mul_f32 v[178:179],v[178:179],v[192:193] op_sel_hi:[1,0]
v_cvt_pk_bf16_f32 v50,v176,v177
v_cvt_pk_bf16_f32 v51,v178,v179
v_pk_mul_f32 v[52:53],v[52:53],v[192:193] op_sel_hi:[1,0]
v_pk_mul_f32 v[54:55],v[54:55],v[192:193] op_sel_hi:[1,0]
v_cvt_pk_bf16_f32 v52,v52,v53
v_cvt_pk_bf16_f32 v53,v54,v55
v_pk_mul_f32 v[180:181],v[180:181],v[192:193] op_sel_hi:[1,0]
v_pk_mul_f32 v[182:183],v[182:183],v[192:193] op_sel_hi:[1,0]
v_cvt_pk_bf16_f32 v54,v180,v181
v_cvt_pk_bf16_f32 v55,v182,v183
v_pk_mul_f32 v[56:57],v[56:57],v[192:193] op_sel_hi:[1,0]
v_pk_mul_f32 v[58:59],v[58:59],v[192:193] op_sel_hi:[1,0]
v_cvt_pk_bf16_f32 v56,v56,v57
v_cvt_pk_bf16_f32 v57,v58,v59
v_pk_mul_f32 v[184:185],v[184:185],v[192:193] op_sel_hi:[1,0]
v_pk_mul_f32 v[186:187],v[186:187],v[192:193] op_sel_hi:[1,0]
v_cvt_pk_bf16_f32 v58,v184,v185
v_cvt_pk_bf16_f32 v59,v186,v187
v_pk_mul_f32 v[60:61],v[60:61],v[192:193] op_sel_hi:[1,0]
v_pk_mul_f32 v[62:63],v[62:63],v[192:193] op_sel_hi:[1,0]
v_cvt_pk_bf16_f32 v60,v60,v61
v_cvt_pk_bf16_f32 v61,v62,v63
v_pk_mul_f32 v[188:189],v[188:189],v[192:193] op_sel_hi:[1,0]
v_pk_mul_f32 v[190:191],v[190:191],v[192:193] op_sel_hi:[1,0]
v_cvt_pk_bf16_f32 v62,v188,v189
v_cvt_pk_bf16_f32 v63,v190,v191
v_pk_mul_f32 v[64:65],v[64:65],v[192:193] op_sel_hi:[1,0]
v_pk_mul_f32 v[66:67],v[66:67],v[192:193] op_sel_hi:[1,0]
v_cvt_pk_bf16_f32 v64,v64,v65
v_cvt_pk_bf16_f32 v65,v66,v67
v_accvgpr_read_b32 v200,a0
v_accvgpr_read_b32 v201,a1
v_accvgpr_read_b32 v202,a2
v_accvgpr_read_b32 v203,a3
v_pk_mul_f32 v[200:201],v[200:201],v[192:193] op_sel_hi:[1,0]
v_pk_mul_f32 v[202:203],v[202:203],v[192:193] op_sel_hi:[1,0]
v_cvt_pk_bf16_f32 v66,v200,v201
v_cvt_pk_bf16_f32 v67,v202,v203
v_pk_mul_f32 v[68:69],v[68:69],v[192:193] op_sel_hi:[1,0]
v_pk_mul_f32 v[70:71],v[70:71],v[192:193] op_sel_hi:[1,0]
v_cvt_pk_bf16_f32 v68,v68,v69
v_cvt_pk_bf16_f32 v69,v70,v71
v_accvgpr_read_b32 v204,a4
v_accvgpr_read_b32 v205,a5
v_accvgpr_read_b32 v206,a6
v_accvgpr_read_b32 v207,a7
v_pk_mul_f32 v[204:205],v[204:205],v[192:193] op_sel_hi:[1,0]
v_pk_mul_f32 v[206:207],v[206:207],v[192:193] op_sel_hi:[1,0]
v_cvt_pk_bf16_f32 v70,v204,v205
v_cvt_pk_bf16_f32 v71,v206,v207
v_pk_mul_f32 v[72:73],v[72:73],v[192:193] op_sel_hi:[1,0]
v_pk_mul_f32 v[74:75],v[74:75],v[192:193] op_sel_hi:[1,0]
v_cvt_pk_bf16_f32 v72,v72,v73
v_cvt_pk_bf16_f32 v73,v74,v75
v_accvgpr_read_b32 v200,a8
v_accvgpr_read_b32 v201,a9
v_accvgpr_read_b32 v202,a10
v_accvgpr_read_b32 v203,a11
v_pk_mul_f32 v[200:201],v[200:201],v[192:193] op_sel_hi:[1,0]
v_pk_mul_f32 v[202:203],v[202:203],v[192:193] op_sel_hi:[1,0]
v_cvt_pk_bf16_f32 v74,v200,v201
v_cvt_pk_bf16_f32 v75,v202,v203
v_pk_mul_f32 v[76:77],v[76:77],v[192:193] op_sel_hi:[1,0]
v_pk_mul_f32 v[78:79],v[78:79],v[192:193] op_sel_hi:[1,0]
v_cvt_pk_bf16_f32 v76,v76,v77
v_cvt_pk_bf16_f32 v77,v78,v79
v_accvgpr_read_b32 v204,a12
v_accvgpr_read_b32 v205,a13
v_accvgpr_read_b32 v206,a14
v_accvgpr_read_b32 v207,a15
v_pk_mul_f32 v[204:205],v[204:205],v[192:193] op_sel_hi:[1,0]
v_pk_mul_f32 v[206:207],v[206:207],v[192:193] op_sel_hi:[1,0]
v_cvt_pk_bf16_f32 v78,v204,v205
v_cvt_pk_bf16_f32 v79,v206,v207
v_pk_mul_f32 v[80:81],v[80:81],v[192:193] op_sel_hi:[1,0]
v_pk_mul_f32 v[82:83],v[82:83],v[192:193] op_sel_hi:[1,0]
v_cvt_pk_bf16_f32 v80,v80,v81
v_cvt_pk_bf16_f32 v81,v82,v83
v_accvgpr_read_b32 v200,a16
v_accvgpr_read_b32 v201,a17
v_accvgpr_read_b32 v202,a18
v_accvgpr_read_b32 v203,a19
v_pk_mul_f32 v[200:201],v[200:201],v[192:193] op_sel_hi:[1,0]
v_pk_mul_f32 v[202:203],v[202:203],v[192:193] op_sel_hi:[1,0]
v_cvt_pk_bf16_f32 v82,v200,v201
v_cvt_pk_bf16_f32 v83,v202,v203
v_pk_mul_f32 v[84:85],v[84:85],v[192:193] op_sel_hi:[1,0]
v_pk_mul_f32 v[86:87],v[86:87],v[192:193] op_sel_hi:[1,0]
v_cvt_pk_bf16_f32 v84,v84,v85
v_cvt_pk_bf16_f32 v85,v86,v87
v_accvgpr_read_b32 v204,a20
v_accvgpr_read_b32 v205,a21
v_accvgpr_read_b32 v206,a22
v_accvgpr_read_b32 v207,a23
v_pk_mul_f32 v[204:205],v[204:205],v[192:193] op_sel_hi:[1,0]
v_pk_mul_f32 v[206:207],v[206:207],v[192:193] op_sel_hi:[1,0]
v_cvt_pk_bf16_f32 v86,v204,v205
v_cvt_pk_bf16_f32 v87,v206,v207
v_pk_mul_f32 v[88:89],v[88:89],v[192:193] op_sel_hi:[1,0]
v_pk_mul_f32 v[90:91],v[90:91],v[192:193] op_sel_hi:[1,0]
v_cvt_pk_bf16_f32 v88,v88,v89
v_cvt_pk_bf16_f32 v89,v90,v91
v_accvgpr_read_b32 v200,a24
v_accvgpr_read_b32 v201,a25
v_accvgpr_read_b32 v202,a26
v_accvgpr_read_b32 v203,a27
v_pk_mul_f32 v[200:201],v[200:201],v[192:193] op_sel_hi:[1,0]
v_pk_mul_f32 v[202:203],v[202:203],v[192:193] op_sel_hi:[1,0]
v_cvt_pk_bf16_f32 v90,v200,v201
v_cvt_pk_bf16_f32 v91,v202,v203
v_pk_mul_f32 v[92:93],v[92:93],v[192:193] op_sel_hi:[1,0]
v_pk_mul_f32 v[94:95],v[94:95],v[192:193] op_sel_hi:[1,0]
v_cvt_pk_bf16_f32 v92,v92,v93
v_cvt_pk_bf16_f32 v93,v94,v95
v_accvgpr_read_b32 v204,a28
v_accvgpr_read_b32 v205,a29
v_accvgpr_read_b32 v206,a30
v_accvgpr_read_b32 v207,a31
v_pk_mul_f32 v[204:205],v[204:205],v[192:193] op_sel_hi:[1,0]
v_pk_mul_f32 v[206:207],v[206:207],v[192:193] op_sel_hi:[1,0]
v_cvt_pk_bf16_f32 v94,v204,v205
v_cvt_pk_bf16_f32 v95,v206,v207
v_mfma_f32_16x16x32_bf16 v[128:131],v[208:211],v[0:3],0
ds_read_b128 v[224:227],v252 offset:128
v_mul_f32 v96,s61,v96
v_mfma_f32_16x16x32_bf16 v[132:135],v[208:211],v[4:7],0
v_mul_f32 v97,s61,v97
v_mul_f32 v98,s61,v98
v_mfma_f32_16x16x32_bf16 v[136:139],v[208:211],v[8:11],0
ds_read_b128 v[228:231],v252 offset:640
buffer_load_dwordx4 v254,s[12:15],s31 offen offset:1536 nt lds
v_mfma_f32_16x16x32_bf16 v[140:143],v[208:211],v[12:15],0
s_add_u32 s31,s31,16384
v_mul_f32 v99,s61,v99
v_mfma_f32_16x16x32_bf16 v[144:147],v[212:215],v[0:3],0
v_cvt_pk_bf16_f32 v96,v96,v97
v_cvt_pk_bf16_f32 v97,v98,v99
v_mfma_f32_16x16x32_bf16 v[148:151],v[212:215],v[4:7],0
v_accvgpr_read_b32 v200,a32
v_accvgpr_read_b32 v201,a33
v_mfma_f32_16x16x32_bf16 v[152:155],v[212:215],v[8:11],0
v_accvgpr_read_b32 v202,a34
v_accvgpr_read_b32 v203,a35
v_mfma_f32_16x16x32_bf16 v[156:159],v[212:215],v[12:15],0
v_mul_f32 v200,s61,v200
s_waitcnt lgkmcnt(2)
v_mfma_f32_16x16x32_bf16 v[128:131],v[216:219],v[16:19],v[128:131]
ds_read_b128 v[232:235],v252 offset:192
v_mul_f32 v201,s61,v201
v_mfma_f32_16x16x32_bf16 v[132:135],v[216:219],v[20:23],v[132:135]
v_mul_f32 v202,s61,v202
v_mul_f32 v203,s61,v203
v_mfma_f32_16x16x32_bf16 v[136:139],v[216:219],v[24:27],v[136:139]
ds_read_b128 v[236:239],v252 offset:704
v_cvt_pk_bf16_f32 v98,v200,v201
v_mfma_f32_16x16x32_bf16 v[140:143],v[216:219],v[28:31],v[140:143]
v_cvt_pk_bf16_f32 v99,v202,v203
v_mul_f32 v100,s61,v100
v_mfma_f32_16x16x32_bf16 v[144:147],v[220:223],v[16:19],v[144:147]
s_add_u32 m0,s29,0
v_mul_f32 v101,s61,v101
v_mfma_f32_16x16x32_bf16 v[148:151],v[220:223],v[20:23],v[148:151]
buffer_load_dwordx4 v254,s[8:11],s30 offen offset:0 nt lds
s_add_u32 m0,m0,0x00000220
v_mfma_f32_16x16x32_bf16 v[152:155],v[220:223],v[24:27],v[152:155]
v_mul_f32 v102,s61,v102
v_mul_f32 v103,s61,v103
v_mfma_f32_16x16x32_bf16 v[156:159],v[220:223],v[28:31],v[156:159]
v_cvt_pk_bf16_f32 v100,v100,v101
s_waitcnt lgkmcnt(2)
v_mfma_f32_16x16x32_bf16 v[128:131],v[224:227],v[32:35],v[128:131]
ds_read_b128 v[208:211],v252 offset:256
v_cvt_pk_bf16_f32 v101,v102,v103
v_mfma_f32_16x16x32_bf16 v[132:135],v[224:227],v[36:39],v[132:135]
v_accvgpr_read_b32 v204,a36
v_accvgpr_read_b32 v205,a37
v_mfma_f32_16x16x32_bf16 v[136:139],v[224:227],v[40:43],v[136:139]
ds_read_b128 v[212:215],v252 offset:768
v_accvgpr_read_b32 v206,a38
v_mfma_f32_16x16x32_bf16 v[140:143],v[224:227],v[44:47],v[140:143]
v_accvgpr_read_b32 v207,a39
v_mul_f32 v204,s61,v204
v_mfma_f32_16x16x32_bf16 v[144:147],v[228:231],v[32:35],v[144:147]
v_mul_f32 v205,s61,v205
v_mul_f32 v206,s61,v206
v_mfma_f32_16x16x32_bf16 v[148:151],v[228:231],v[36:39],v[148:151]
v_mul_f32 v207,s61,v207
v_cvt_pk_bf16_f32 v102,v204,v205
v_mfma_f32_16x16x32_bf16 v[152:155],v[228:231],v[40:43],v[152:155]
v_cvt_pk_bf16_f32 v103,v206,v207
v_mul_f32 v104,s61,v104
v_mfma_f32_16x16x32_bf16 v[156:159],v[228:231],v[44:47],v[156:159]
v_mul_f32 v105,s61,v105
s_waitcnt lgkmcnt(2)
v_mfma_f32_16x16x32_bf16 v[128:131],v[232:235],v[48:51],v[128:131]
ds_read_b128 v[216:219],v252 offset:320
buffer_load_dwordx4 v254,s[8:11],s30 offen offset:512 nt lds
v_mfma_f32_16x16x32_bf16 v[132:135],v[232:235],v[52:55],v[132:135]
s_add_u32 m0,m0,0x00000220
v_mul_f32 v106,s61,v106
v_mfma_f32_16x16x32_bf16 v[136:139],v[232:235],v[56:59],v[136:139]
ds_read_b128 v[220:223],v252 offset:832
v_mul_f32 v107,s61,v107
v_mfma_f32_16x16x32_bf16 v[140:143],v[232:235],v[60:63],v[140:143]
v_cvt_pk_bf16_f32 v104,v104,v105
v_cvt_pk_bf16_f32 v105,v106,v107
v_mfma_f32_16x16x32_bf16 v[144:147],v[236:239],v[48:51],v[144:147]
v_accvgpr_read_b32 v200,a40
v_accvgpr_read_b32 v201,a41
v_mfma_f32_16x16x32_bf16 v[148:151],v[236:239],v[52:55],v[148:151]
v_accvgpr_read_b32 v202,a42
v_accvgpr_read_b32 v203,a43
v_mfma_f32_16x16x32_bf16 v[152:155],v[236:239],v[56:59],v[152:155]
v_mul_f32 v200,s61,v200
v_mul_f32 v201,s61,v201
v_mfma_f32_16x16x32_bf16 v[156:159],v[236:239],v[60:63],v[156:159]
v_mul_f32 v202,s61,v202
s_waitcnt lgkmcnt(2)
v_mfma_f32_16x16x32_bf16 v[128:131],v[208:211],v[64:67],v[128:131]
ds_read_b128 v[224:227],v252 offset:384
v_mul_f32 v203,s61,v203
v_mfma_f32_16x16x32_bf16 v[132:135],v[208:211],v[68:71],v[132:135]
v_cvt_pk_bf16_f32 v106,v200,v201
v_cvt_pk_bf16_f32 v107,v202,v203
v_mfma_f32_16x16x32_bf16 v[136:139],v[208:211],v[72:75],v[136:139]
ds_read_b128 v[228:231],v252 offset:896
v_mul_f32 v108,s61,v108
v_mfma_f32_16x16x32_bf16 v[140:143],v[208:211],v[76:79],v[140:143]
buffer_load_dwordx4 v254,s[8:11],s30 offen offset:1024 nt lds
s_add_u32 m0,m0,0x00000220
v_mfma_f32_16x16x32_bf16 v[144:147],v[212:215],v[64:67],v[144:147]
v_mul_f32 v109,s61,v109
v_mul_f32 v110,s61,v110
v_mfma_f32_16x16x32_bf16 v[148:151],v[212:215],v[68:71],v[148:151]
v_mul_f32 v111,s61,v111
v_cvt_pk_bf16_f32 v108,v108,v109
v_mfma_f32_16x16x32_bf16 v[152:155],v[212:215],v[72:75],v[152:155]
v_cvt_pk_bf16_f32 v109,v110,v111
v_accvgpr_read_b32 v204,a44
v_mfma_f32_16x16x32_bf16 v[156:159],v[212:215],v[76:79],v[156:159]
v_accvgpr_read_b32 v205,a45
s_waitcnt lgkmcnt(2)
v_mfma_f32_16x16x32_bf16 v[128:131],v[216:219],v[80:83],v[128:131]
ds_read_b128 v[232:235],v252 offset:448
v_accvgpr_read_b32 v206,a46
v_mfma_f32_16x16x32_bf16 v[132:135],v[216:219],v[84:87],v[132:135]
v_accvgpr_read_b32 v207,a47
v_mul_f32 v204,s61,v204
v_mfma_f32_16x16x32_bf16 v[136:139],v[216:219],v[88:91],v[136:139]
ds_read_b128 v[236:239],v252 offset:960
v_mul_f32 v205,s61,v205
v_mfma_f32_16x16x32_bf16 v[140:143],v[216:219],v[92:95],v[140:143]
v_mul_f32 v206,s61,v206
v_mul_f32 v207,s61,v207
v_mfma_f32_16x16x32_bf16 v[144:147],v[220:223],v[80:83],v[144:147]
v_cvt_pk_bf16_f32 v110,v204,v205
v_cvt_pk_bf16_f32 v111,v206,v207
v_mfma_f32_16x16x32_bf16 v[148:151],v[220:223],v[84:87],v[148:151]
v_subrev_u32 v252,84480,v252
v_mul_f32 v112,s61,v112
v_mfma_f32_16x16x32_bf16 v[152:155],v[220:223],v[88:91],v[152:155]
buffer_load_dwordx4 v254,s[8:11],s30 offen offset:1536 nt lds
s_add_u32 s30,s30,16384
v_mfma_f32_16x16x32_bf16 v[156:159],v[220:223],v[92:95],v[156:159]
v_mul_f32 v113,s61,v113
s_waitcnt lgkmcnt(2)
v_mfma_f32_16x16x32_bf16 v[128:131],v[224:227],v[96:99],v[128:131]
v_mul_f32 v114,s61,v114
v_mul_f32 v115,s61,v115
v_mfma_f32_16x16x32_bf16 v[132:135],v[224:227],v[100:103],v[132:135]
s_waitcnt vmcnt(12) lgkmcnt(0)
s_barrier
v_mfma_f32_16x16x32_bf16 v[136:139],v[224:227],v[104:107],v[136:139]
ds_read_b128 v[208:211],v252 offset:0
v_cvt_pk_bf16_f32 v112,v112,v113
v_mfma_f32_16x16x32_bf16 v[140:143],v[224:227],v[108:111],v[140:143]
v_cvt_pk_bf16_f32 v113,v114,v115
v_accvgpr_read_b32 v200,a48
v_mfma_f32_16x16x32_bf16 v[144:147],v[228:231],v[96:99],v[144:147]
ds_read_b128 v[212:215],v252 offset:64
v_accvgpr_read_b32 v201,a49
v_mfma_f32_16x16x32_bf16 v[148:151],v[228:231],v[100:103],v[148:151]
v_accvgpr_read_b32 v202,a50
v_accvgpr_read_b32 v203,a51
v_mfma_f32_16x16x32_bf16 v[152:155],v[228:231],v[104:107],v[152:155]
v_mul_f32 v200,s61,v200
v_mul_f32 v201,s61,v201
v_mul_f32 v202,s61,v202
v_mul_f32 v203,s61,v203
v_cvt_pk_bf16_f32 v114,v200,v201
v_cvt_pk_bf16_f32 v115,v202,v203
v_mfma_f32_16x16x32_bf16 v[156:159],v[228:231],v[108:111],v[156:159]
v_mul_f32 v116,s61,v116
v_mul_f32 v117,s61,v117
v_mul_f32 v118,s61,v118
v_mul_f32 v119,s61,v119
v_cvt_pk_bf16_f32 v116,v116,v117
v_cvt_pk_bf16_f32 v117,v118,v119
v_accvgpr_read_b32 v204,a52
v_accvgpr_read_b32 v205,a53
v_accvgpr_read_b32 v206,a54
v_accvgpr_read_b32 v207,a55
v_mul_f32 v204,s61,v204
v_mul_f32 v205,s61,v205
v_mul_f32 v206,s61,v206
v_mul_f32 v207,s61,v207
v_cvt_pk_bf16_f32 v118,v204,v205
v_cvt_pk_bf16_f32 v119,v206,v207
v_mfma_f32_16x16x32_bf16 v[128:131],v[232:235],v[112:115],v[128:131]
ds_read_b128 v[216:219],v252 offset:128
v_mul_f32 v120,s61,v120
v_mul_f32 v121,s61,v121
v_mul_f32 v122,s61,v122
v_mul_f32 v123,s61,v123
v_cvt_pk_bf16_f32 v120,v120,v121
v_cvt_pk_bf16_f32 v121,v122,v123
v_accvgpr_read_b32 v200,a56
v_accvgpr_read_b32 v201,a57
v_accvgpr_read_b32 v202,a58
v_accvgpr_read_b32 v203,a59
v_mul_f32 v200,s61,v200
v_mul_f32 v201,s61,v201
v_mul_f32 v202,s61,v202
v_mul_f32 v203,s61,v203
v_cvt_pk_bf16_f32 v122,v200,v201
v_cvt_pk_bf16_f32 v123,v202,v203
v_mfma_f32_16x16x32_bf16 v[132:135],v[232:235],v[116:119],v[132:135]
v_mul_f32 v124,s61,v124
v_mul_f32 v125,s61,v125
v_mul_f32 v126,s61,v126
v_mul_f32 v127,s61,v127
v_cvt_pk_bf16_f32 v124,v124,v125
v_cvt_pk_bf16_f32 v125,v126,v127
v_accvgpr_read_b32 v204,a60
v_accvgpr_read_b32 v205,a61
v_accvgpr_read_b32 v206,a62
v_accvgpr_read_b32 v207,a63
v_mul_f32 v204,s61,v204
v_mul_f32 v205,s61,v205
v_mul_f32 v206,s61,v206
v_mul_f32 v207,s61,v207
v_cvt_pk_bf16_f32 v126,v204,v205
v_cvt_pk_bf16_f32 v127,v206,v207
v_mfma_f32_16x16x32_bf16 v[136:139],v[232:235],v[120:123],v[136:139]
ds_read_b128 v[220:223],v252 offset:192
v_mbcnt_lo_u32_b32 v253,-1,0
v_mfma_f32_16x16x32_bf16 v[140:143],v[232:235],v[124:127],v[140:143]
v_mbcnt_hi_u32_b32 v253,-1,v253
v_lshrrev_b32 v249,2,v253
v_mul_u32_u24 v249,1056,v249
v_and_b32 v253,3,v253
v_lshl_add_u32 v253,v253,3,v249
v_add_u32 v253,67584,v253
s_mov_b32 s34,s29
s_mov_b32 s35,s29
s_mov_b32 s33,33792
s_add_u32 s70,s29,67584
s_mov_b32 s36,5
v_mfma_f32_16x16x32_bf16 v[144:147],v[236:239],v[112:115],v[144:147]
v_mfma_f32_16x16x32_bf16 v[148:151],v[236:239],v[116:119],v[148:151]
v_mfma_f32_16x16x32_bf16 v[152:155],v[236:239],v[120:123],v[152:155]
v_mfma_f32_16x16x32_bf16 v[156:159],v[236:239],v[124:127],v[156:159]
v_mov_b32 v240,0
v_mov_b32 v241,0
v_mov_b32 v242,0
v_mov_b32 v243,0
s_nop 3
v_max3_f32 v248,v128,v129,v130
v_max3_f32 v248,v248,v131,v144
v_max3_f32 v248,v248,v145,v146
v_max_f32 v248,v248,v147
v_max3_f32 v249,v132,v133,v134
v_max3_f32 v249,v249,v135,v148
v_max3_f32 v249,v249,v149,v150
v_max_f32 v249,v249,v151
v_max3_f32 v250,v136,v137,v138
v_max3_f32 v250,v250,v139,v152
v_max3_f32 v250,v250,v153,v154
v_max_f32 v250,v250,v155
v_max3_f32 v251,v140,v141,v142
v_max3_f32 v251,v251,v143,v156
v_max3_f32 v251,v251,v157,v158
v_max_f32 v251,v251,v159
v_mov_b32 v244,v248
v_mov_b32 v245,v249
v_mov_b32 v246,v250
v_mov_b32 v247,v251
v_permlane32_swap_b32 v244,v248
v_permlane32_swap_b32 v245,v249
v_permlane32_swap_b32 v246,v250
v_permlane32_swap_b32 v247,v251
v_max_f32 v248,v244,v248
v_max_f32 v249,v245,v249
v_max_f32 v250,v246,v250
v_max_f32 v251,v247,v251
v_mov_b32 v244,v248
v_mov_b32 v245,v249
v_mov_b32 v246,v250
v_mov_b32 v247,v251
v_permlane16_swap_b32 v244,v248
v_permlane16_swap_b32 v245,v249
v_permlane16_swap_b32 v246,v250
v_permlane16_swap_b32 v247,v251
v_max_f32 v248,v244,v248
v_max_f32 v249,v245,v249
v_max_f32 v250,v246,v250
v_max_f32 v251,v247,v251
v_sub_f32 v192,0,v248
v_sub_f32 v193,0,v248
v_sub_f32 v196,0,v249
v_sub_f32 v197,0,v249
v_sub_f32 v200,0,v250
v_sub_f32 v201,0,v250
v_sub_f32 v204,0,v251
v_sub_f32 v205,0,v251
v_pk_mul_f32 v[194:195],v[192:193],1.0 op_sel_hi:[1,0]
v_pk_add_f32 v[128:129],v[128:129],v[192:193]
v_pk_add_f32 v[130:131],v[130:131],v[192:193]
v_pk_add_f32 v[144:145],v[144:145],v[192:193]
v_pk_add_f32 v[146:147],v[146:147],v[192:193]
v_pk_mul_f32 v[198:199],v[196:197],1.0 op_sel_hi:[1,0]
v_pk_add_f32 v[132:133],v[132:133],v[196:197]
v_pk_add_f32 v[134:135],v[134:135],v[196:197]
v_pk_add_f32 v[148:149],v[148:149],v[196:197]
v_pk_add_f32 v[150:151],v[150:151],v[196:197]
v_pk_mul_f32 v[202:203],v[200:201],1.0 op_sel_hi:[1,0]
v_pk_add_f32 v[136:137],v[136:137],v[200:201]
v_pk_add_f32 v[138:139],v[138:139],v[200:201]
v_pk_add_f32 v[152:153],v[152:153],v[200:201]
v_pk_add_f32 v[154:155],v[154:155],v[200:201]
v_pk_mul_f32 v[206:207],v[204:205],1.0 op_sel_hi:[1,0]
v_pk_add_f32 v[140:141],v[140:141],v[204:205]
v_pk_add_f32 v[142:143],v[142:143],v[204:205]
v_pk_add_f32 v[156:157],v[156:157],v[204:205]
v_pk_add_f32 v[158:159],v[158:159],v[204:205]
v_exp_f32 v128,v128
v_exp_f32 v129,v129
v_exp_f32 v130,v130
v_exp_f32 v131,v131
v_exp_f32 v144,v144
v_exp_f32 v145,v145
v_exp_f32 v146,v146
v_exp_f32 v147,v147
v_cvt_pk_bf16_f32 v160,v128,v129
v_cvt_pk_bf16_f32 v161,v130,v131
v_cvt_pk_bf16_f32 v162,v144,v145
v_cvt_pk_bf16_f32 v163,v146,v147
v_pk_add_f32 v[128:129],v[128:129],v[130:131]
v_pk_add_f32 v[144:145],v[144:145],v[146:147]
v_pk_add_f32 v[128:129],v[128:129],v[144:145]
v_add_f32 v244,v128,v129
v_exp_f32 v132,v132
v_exp_f32 v133,v133
v_exp_f32 v134,v134
v_exp_f32 v135,v135
v_exp_f32 v148,v148
v_exp_f32 v149,v149
v_exp_f32 v150,v150
v_exp_f32 v151,v151
v_cvt_pk_bf16_f32 v164,v132,v133
v_cvt_pk_bf16_f32 v165,v134,v135
v_cvt_pk_bf16_f32 v166,v148,v149
v_cvt_pk_bf16_f32 v167,v150,v151
v_pk_add_f32 v[132:133],v[132:133],v[134:135]
v_pk_add_f32 v[148:149],v[148:149],v[150:151]
v_pk_add_f32 v[132:133],v[132:133],v[148:149]
v_add_f32 v245,v132,v133
v_exp_f32 v136,v136
v_exp_f32 v137,v137
v_exp_f32 v138,v138
v_exp_f32 v139,v139
v_exp_f32 v152,v152
v_exp_f32 v153,v153
v_exp_f32 v154,v154
v_exp_f32 v155,v155
v_cvt_pk_bf16_f32 v168,v136,v137
v_cvt_pk_bf16_f32 v169,v138,v139
v_cvt_pk_bf16_f32 v170,v152,v153
v_cvt_pk_bf16_f32 v171,v154,v155
v_pk_add_f32 v[136:137],v[136:137],v[138:139]
v_pk_add_f32 v[152:153],v[152:153],v[154:155]
v_pk_add_f32 v[136:137],v[136:137],v[152:153]
v_add_f32 v246,v136,v137
v_exp_f32 v140,v140
v_exp_f32 v141,v141
v_exp_f32 v142,v142
v_exp_f32 v143,v143
v_exp_f32 v156,v156
v_exp_f32 v157,v157
v_exp_f32 v158,v158
v_exp_f32 v159,v159
v_cvt_pk_bf16_f32 v172,v140,v141
v_cvt_pk_bf16_f32 v173,v142,v143
v_cvt_pk_bf16_f32 v174,v156,v157
v_cvt_pk_bf16_f32 v175,v158,v159
v_pk_add_f32 v[140:141],v[140:141],v[142:143]
v_pk_add_f32 v[156:157],v[156:157],v[158:159]
v_pk_add_f32 v[140:141],v[140:141],v[156:157]
v_add_f32 v247,v140,v141
s_waitcnt lgkmcnt(2)
v_mfma_f32_16x16x32_bf16 v[128:131],v[208:211],v[0:3],v[192:195]
ds_read_b128 v[224:227],v252 offset:256
s_add_u32 m0,s34,16896
v_mfma_f32_16x16x32_bf16 v[132:135],v[208:211],v[4:7],v[196:199]
buffer_load_dwordx4 v254,s[8:11],s30 offen offset:0 nt lds
s_add_u32 m0,m0,0x00000220
v_mfma_f32_16x16x32_bf16 v[136:139],v[208:211],v[8:11],v[200:203]
ds_read_b128 v[228:231],v252 offset:320
v_add_f32 v240,v240,v244
v_mfma_f32_16x16x32_bf16 v[140:143],v[208:211],v[12:15],v[204:207]
v_add_f32 v241,v241,v245
v_add_f32 v242,v242,v246
v_mfma_f32_16x16x32_bf16 v[128:131],v[212:215],v[16:19],v[128:131]
v_add_f32 v243,v243,v247
v_mfma_f32_16x16x32_bf16 v[132:135],v[212:215],v[20:23],v[132:135]
buffer_load_dwordx4 v254,s[8:11],s30 offen offset:512 nt lds
s_add_u32 m0,m0,0x00000220
v_mfma_f32_16x16x32_bf16 v[136:139],v[212:215],v[24:27],v[136:139]
v_mfma_f32_16x16x32_bf16 v[140:143],v[212:215],v[28:31],v[140:143]
s_waitcnt lgkmcnt(2)
v_mfma_f32_16x16x32_bf16 v[128:131],v[216:219],v[32:35],v[128:131]
ds_read_b128 v[232:235],v252 offset:384
v_mfma_f32_16x16x32_bf16 v[132:135],v[216:219],v[36:39],v[132:135]
buffer_load_dwordx4 v254,s[8:11],s30 offen offset:1024 nt lds
s_add_u32 m0,m0,0x00000220
v_mfma_f32_16x16x32_bf16 v[136:139],v[216:219],v[40:43],v[136:139]
ds_read_b128 v[236:239],v252 offset:448
v_mfma_f32_16x16x32_bf16 v[140:143],v[216:219],v[44:47],v[140:143]
v_mfma_f32_16x16x32_bf16 v[128:131],v[220:223],v[48:51],v[128:131]
v_mfma_f32_16x16x32_bf16 v[132:135],v[220:223],v[52:55],v[132:135]
buffer_load_dwordx4 v254,s[8:11],s30 offen offset:1536 nt lds
s_add_u32 s30,s30,16384
v_mfma_f32_16x16x32_bf16 v[136:139],v[220:223],v[56:59],v[136:139]
s_add_u32 m0,s35,118272
v_mfma_f32_16x16x32_bf16 v[140:143],v[220:223],v[60:63],v[140:143]
s_waitcnt lgkmcnt(2)
v_mfma_f32_16x16x32_bf16 v[128:131],v[224:227],v[64:67],v[128:131]
ds_read_b128 v[208:211],v252 offset:512
v_mfma_f32_16x16x32_bf16 v[132:135],v[224:227],v[68:71],v[132:135]
buffer_load_dwordx4 v254,s[12:15],s31 offen offset:0 nt lds
s_add_u32 m0,m0,0x00000220
v_mfma_f32_16x16x32_bf16 v[136:139],v[224:227],v[72:75],v[136:139]
ds_read_b128 v[212:215],v252 offset:576
v_mfma_f32_16x16x32_bf16 v[140:143],v[224:227],v[76:79],v[140:143]
v_mfma_f32_16x16x32_bf16 v[128:131],v[228:231],v[80:83],v[128:131]
v_mfma_f32_16x16x32_bf16 v[132:135],v[228:231],v[84:87],v[132:135]
buffer_load_dwordx4 v254,s[12:15],s31 offen offset:512 nt lds
s_add_u32 m0,m0,0x00000220
v_mfma_f32_16x16x32_bf16 v[136:139],v[228:231],v[88:91],v[136:139]
v_mfma_f32_16x16x32_bf16 v[140:143],v[228:231],v[92:95],v[140:143]
s_waitcnt lgkmcnt(2)
v_mfma_f32_16x16x32_bf16 v[128:131],v[232:235],v[96:99],v[128:131]
ds_read_b128 v[216:219],v252 offset:640
v_mfma_f32_16x16x32_bf16 v[132:135],v[232:235],v[100:103],v[132:135]
buffer_load_dwordx4 v254,s[12:15],s31 offen offset:1024 nt lds
s_add_u32 m0,m0,0x00000220
v_mfma_f32_16x16x32_bf16 v[136:139],v[232:235],v[104:107],v[136:139]
ds_read_b128 v[220:223],v252 offset:704
v_mfma_f32_16x16x32_bf16 v[140:143],v[232:235],v[108:111],v[140:143]
v_mfma_f32_16x16x32_bf16 v[128:131],v[236:239],v[112:115],v[128:131]
v_mfma_f32_16x16x32_bf16 v[132:135],v[236:239],v[116:119],v[132:135]
buffer_load_dwordx4 v254,s[12:15],s31 offen offset:1536 nt lds
s_add_u32 s31,s31,16384
v_mfma_f32_16x16x32_bf16 v[136:139],v[236:239],v[120:123],v[136:139]
v_mfma_f32_16x16x32_bf16 v[140:143],v[236:239],v[124:127],v[140:143]
s_waitcnt lgkmcnt(2)
v_mfma_f32_16x16x32_bf16 v[144:147],v[208:211],v[0:3],v[192:195]
ds_read_b128 v[224:227],v252 offset:768
v_mfma_f32_16x16x32_bf16 v[148:151],v[208:211],v[4:7],v[196:199]
v_mfma_f32_16x16x32_bf16 v[152:155],v[208:211],v[8:11],v[200:203]
ds_read_b128 v[228:231],v252 offset:832
v_mfma_f32_16x16x32_bf16 v[156:159],v[208:211],v[12:15],v[204:207]
v_exp_f32 v248,v128
v_mfma_f32_16x16x32_bf16 v[144:147],v[212:215],v[16:19],v[144:147]
v_exp_f32 v249,v129
v_mfma_f32_16x16x32_bf16 v[148:151],v[212:215],v[20:23],v[148:151]
v_exp_f32 v250,v130
v_mfma_f32_16x16x32_bf16 v[152:155],v[212:215],v[24:27],v[152:155]
v_exp_f32 v251,v131
v_mfma_f32_16x16x32_bf16 v[156:159],v[212:215],v[28:31],v[156:159]
v_add_f32 v244,v248,v249
s_waitcnt lgkmcnt(2)
v_mfma_f32_16x16x32_bf16 v[144:147],v[216:219],v[32:35],v[144:147]
ds_read_b128 v[232:235],v252 offset:896
v_cvt_pk_bf16_f32 v176,v248,v249
v_mfma_f32_16x16x32_bf16 v[148:151],v[216:219],v[36:39],v[148:151]
v_exp_f32 v248,v132
v_mfma_f32_16x16x32_bf16 v[152:155],v[216:219],v[40:43],v[152:155]
ds_read_b128 v[236:239],v252 offset:960
v_add_f32 v244,v244,v250
v_mfma_f32_16x16x32_bf16 v[156:159],v[216:219],v[44:47],v[156:159]
v_exp_f32 v249,v133
v_mfma_f32_16x16x32_bf16 v[144:147],v[220:223],v[48:51],v[144:147]
v_add_f32 v244,v244,v251
v_cvt_pk_bf16_f32 v177,v250,v251
v_mfma_f32_16x16x32_bf16 v[148:151],v[220:223],v[52:55],v[148:151]
v_exp_f32 v250,v134
v_mfma_f32_16x16x32_bf16 v[152:155],v[220:223],v[56:59],v[152:155]
v_exp_f32 v251,v135
v_mfma_f32_16x16x32_bf16 v[156:159],v[220:223],v[60:63],v[156:159]
v_add_f32 v245,v248,v249
s_waitcnt lgkmcnt(2)
v_mfma_f32_16x16x32_bf16 v[144:147],v[224:227],v[64:67],v[144:147]
ds_read_b64_tr_b16 v[208:209],v253 offset:0
v_cvt_pk_bf16_f32 v180,v248,v249
v_mfma_f32_16x16x32_bf16 v[148:151],v[224:227],v[68:71],v[148:151]
ds_read_b64_tr_b16 v[210:211],v253 offset:512
v_add_f32 v245,v245,v250
v_mfma_f32_16x16x32_bf16 v[152:155],v[224:227],v[72:75],v[152:155]
ds_read_b64_tr_b16 v[212:213],v253 offset:32
v_add_f32 v245,v245,v251
v_mfma_f32_16x16x32_bf16 v[156:159],v[224:227],v[76:79],v[156:159]
ds_read_b64_tr_b16 v[214:215],v253 offset:544
v_cvt_pk_bf16_f32 v181,v250,v251
v_mfma_f32_16x16x32_bf16 v[144:147],v[228:231],v[80:83],v[144:147]
v_exp_f32 v248,v136
v_mfma_f32_16x16x32_bf16 v[148:151],v[228:231],v[84:87],v[148:151]
v_exp_f32 v249,v137
v_mfma_f32_16x16x32_bf16 v[152:155],v[228:231],v[88:91],v[152:155]
v_exp_f32 v250,v138
v_mfma_f32_16x16x32_bf16 v[156:159],v[228:231],v[92:95],v[156:159]
v_add_f32 v246,v248,v249
s_waitcnt lgkmcnt(4)
v_mfma_f32_16x16x32_bf16 v[144:147],v[232:235],v[96:99],v[144:147]
ds_read_b64_tr_b16 v[216:217],v253 offset:64
v_cvt_pk_bf16_f32 v184,v248,v249
v_mfma_f32_16x16x32_bf16 v[148:151],v[232:235],v[100:103],v[148:151]
ds_read_b64_tr_b16 v[218:219],v253 offset:576
v_mfma_f32_16x16x32_bf16 v[152:155],v[232:235],v[104:107],v[152:155]
ds_read_b64_tr_b16 v[220:221],v253 offset:96
v_mfma_f32_16x16x32_bf16 v[156:159],v[232:235],v[108:111],v[156:159]
ds_read_b64_tr_b16 v[222:223],v253 offset:608
v_mfma_f32_16x16x32_bf16 v[144:147],v[236:239],v[112:115],v[144:147]
v_exp_f32 v251,v139
v_mfma_f32_16x16x32_bf16 v[148:151],v[236:239],v[116:119],v[148:151]
v_exp_f32 v248,v140
v_mfma_f32_16x16x32_bf16 v[152:155],v[236:239],v[120:123],v[152:155]
v_exp_f32 v249,v141
v_mfma_f32_16x16x32_bf16 v[156:159],v[236:239],v[124:127],v[156:159]
v_add_f32 v246,v246,v250
s_waitcnt lgkmcnt(4)
v_mfma_f32_16x16x32_bf16 a[0:3],v[208:211],v[160:163],0
ds_read_b64_tr_b16 v[224:225],v253 offset:128
v_add_f32 v246,v246,v251
v_mfma_f32_16x16x32_bf16 a[4:7],v[208:211],v[164:167],0
ds_read_b64_tr_b16 v[226:227],v253 offset:640
v_cvt_pk_bf16_f32 v185,v250,v251
v_mfma_f32_16x16x32_bf16 a[8:11],v[208:211],v[168:171],0
ds_read_b64_tr_b16 v[228:229],v253 offset:160
v_add_f32 v247,v248,v249
v_mfma_f32_16x16x32_bf16 a[12:15],v[208:211],v[172:175],0
ds_read_b64_tr_b16 v[230:231],v253 offset:672
v_cvt_pk_bf16_f32 v188,v248,v249
v_mfma_f32_16x16x32_bf16 a[16:19],v[212:215],v[160:163],0
v_exp_f32 v250,v142
v_mfma_f32_16x16x32_bf16 a[20:23],v[212:215],v[164:167],0
v_exp_f32 v251,v143
v_mfma_f32_16x16x32_bf16 a[24:27],v[212:215],v[168:171],0
v_exp_f32 v248,v144
v_mfma_f32_16x16x32_bf16 a[28:31],v[212:215],v[172:175],0
v_add_f32 v247,v247,v250
s_waitcnt lgkmcnt(4)
v_mfma_f32_16x16x32_bf16 a[32:35],v[216:219],v[160:163],0
ds_read_b64_tr_b16 v[232:233],v253 offset:192
v_add_f32 v247,v247,v251
v_mfma_f32_16x16x32_bf16 a[36:39],v[216:219],v[164:167],0
ds_read_b64_tr_b16 v[234:235],v253 offset:704
v_cvt_pk_bf16_f32 v189,v250,v251
v_mfma_f32_16x16x32_bf16 a[40:43],v[216:219],v[168:171],0
ds_read_b64_tr_b16 v[236:237],v253 offset:224
v_mfma_f32_16x16x32_bf16 a[44:47],v[216:219],v[172:175],0
ds_read_b64_tr_b16 v[238:239],v253 offset:736
v_mfma_f32_16x16x32_bf16 a[48:51],v[220:223],v[160:163],0
v_exp_f32 v249,v145
v_mfma_f32_16x16x32_bf16 a[52:55],v[220:223],v[164:167],0
v_exp_f32 v250,v146
v_mfma_f32_16x16x32_bf16 a[56:59],v[220:223],v[168:171],0
v_exp_f32 v251,v147
v_mfma_f32_16x16x32_bf16 a[60:63],v[220:223],v[172:175],0
v_add_f32 v244,v244,v248
s_waitcnt lgkmcnt(4)
v_mfma_f32_16x16x32_bf16 a[64:67],v[224:227],v[160:163],0
ds_read_b64_tr_b16 v[208:209],v253 offset:256
v_add_f32 v244,v244,v249
v_mfma_f32_16x16x32_bf16 a[68:71],v[224:227],v[164:167],0
ds_read_b64_tr_b16 v[210:211],v253 offset:768
v_cvt_pk_bf16_f32 v178,v248,v249
v_mfma_f32_16x16x32_bf16 a[72:75],v[224:227],v[168:171],0
ds_read_b64_tr_b16 v[212:213],v253 offset:288
v_add_f32 v244,v244,v250
v_mfma_f32_16x16x32_bf16 a[76:79],v[224:227],v[172:175],0
ds_read_b64_tr_b16 v[214:215],v253 offset:800
v_add_f32 v244,v244,v251
v_mfma_f32_16x16x32_bf16 a[80:83],v[228:231],v[160:163],0
v_exp_f32 v248,v148
v_mfma_f32_16x16x32_bf16 a[84:87],v[228:231],v[164:167],0
v_exp_f32 v249,v149
v_mfma_f32_16x16x32_bf16 a[88:91],v[228:231],v[168:171],0
v_cvt_pk_bf16_f32 v179,v250,v251
v_mfma_f32_16x16x32_bf16 a[92:95],v[228:231],v[172:175],0
v_add_f32 v245,v245,v248
s_waitcnt lgkmcnt(4)
v_mfma_f32_16x16x32_bf16 a[96:99],v[232:235],v[160:163],0
ds_read_b64_tr_b16 v[216:217],v253 offset:320
v_add_f32 v245,v245,v249
v_mfma_f32_16x16x32_bf16 a[100:103],v[232:235],v[164:167],0
ds_read_b64_tr_b16 v[218:219],v253 offset:832
v_cvt_pk_bf16_f32 v182,v248,v249
v_mfma_f32_16x16x32_bf16 a[104:107],v[232:235],v[168:171],0
ds_read_b64_tr_b16 v[220:221],v253 offset:352
v_mfma_f32_16x16x32_bf16 a[108:111],v[232:235],v[172:175],0
ds_read_b64_tr_b16 v[222:223],v253 offset:864
v_mfma_f32_16x16x32_bf16 a[112:115],v[236:239],v[160:163],0
v_exp_f32 v250,v150
v_mfma_f32_16x16x32_bf16 a[116:119],v[236:239],v[164:167],0
v_exp_f32 v251,v151
v_mfma_f32_16x16x32_bf16 a[120:123],v[236:239],v[168:171],0
v_exp_f32 v248,v152
v_mfma_f32_16x16x32_bf16 a[124:127],v[236:239],v[172:175],0
v_add_f32 v245,v245,v250
s_waitcnt lgkmcnt(4)
v_mfma_f32_16x16x32_bf16 a[128:131],v[208:211],v[160:163],0
ds_read_b64_tr_b16 v[224:225],v253 offset:384
v_add_f32 v245,v245,v251
v_mfma_f32_16x16x32_bf16 a[132:135],v[208:211],v[164:167],0
ds_read_b64_tr_b16 v[226:227],v253 offset:896
v_cvt_pk_bf16_f32 v183,v250,v251
v_mfma_f32_16x16x32_bf16 a[136:139],v[208:211],v[168:171],0
ds_read_b64_tr_b16 v[228:229],v253 offset:416
v_mfma_f32_16x16x32_bf16 a[140:143],v[208:211],v[172:175],0
ds_read_b64_tr_b16 v[230:231],v253 offset:928
v_mfma_f32_16x16x32_bf16 a[144:147],v[212:215],v[160:163],0
v_exp_f32 v249,v153
v_mfma_f32_16x16x32_bf16 a[148:151],v[212:215],v[164:167],0
v_exp_f32 v250,v154
v_mfma_f32_16x16x32_bf16 a[152:155],v[212:215],v[168:171],0
v_exp_f32 v251,v155
v_mfma_f32_16x16x32_bf16 a[156:159],v[212:215],v[172:175],0
v_add_f32 v246,v246,v248
s_waitcnt lgkmcnt(4)
v_mfma_f32_16x16x32_bf16 a[160:163],v[216:219],v[160:163],0
ds_read_b64_tr_b16 v[232:233],v253 offset:448
v_add_f32 v246,v246,v249
v_mfma_f32_16x16x32_bf16 a[164:167],v[216:219],v[164:167],0
ds_read_b64_tr_b16 v[234:235],v253 offset:960
v_cvt_pk_bf16_f32 v186,v248,v249
v_mfma_f32_16x16x32_bf16 a[168:171],v[216:219],v[168:171],0
ds_read_b64_tr_b16 v[236:237],v253 offset:480
v_add_f32 v246,v246,v250
v_mfma_f32_16x16x32_bf16 a[172:175],v[216:219],v[172:175],0
ds_read_b64_tr_b16 v[238:239],v253 offset:992
v_add_f32 v246,v246,v251
v_mfma_f32_16x16x32_bf16 a[176:179],v[220:223],v[160:163],0
v_exp_f32 v248,v156
v_mfma_f32_16x16x32_bf16 a[180:183],v[220:223],v[164:167],0
v_exp_f32 v249,v157
v_mfma_f32_16x16x32_bf16 a[184:187],v[220:223],v[168:171],0
v_cvt_pk_bf16_f32 v187,v250,v251
v_mfma_f32_16x16x32_bf16 a[188:191],v[220:223],v[172:175],0
v_add_f32 v247,v247,v248
s_waitcnt lgkmcnt(4)
v_mfma_f32_16x16x32_bf16 a[192:195],v[224:227],v[160:163],0
v_exp_f32 v250,v158
v_mfma_f32_16x16x32_bf16 a[196:199],v[224:227],v[164:167],0
s_waitcnt vmcnt(16) lgkmcnt(0)
s_barrier
v_mfma_f32_16x16x32_bf16 a[200:203],v[224:227],v[168:171],0
ds_read_b128 v[208:211],v252 offset:16896
v_add_f32 v247,v247,v249
v_mfma_f32_16x16x32_bf16 a[204:207],v[224:227],v[172:175],0
v_exp_f32 v251,v159
v_mfma_f32_16x16x32_bf16 a[208:211],v[228:231],v[160:163],0
ds_read_b128 v[212:215],v252 offset:16960
v_cvt_pk_bf16_f32 v190,v248,v249
v_mfma_f32_16x16x32_bf16 a[212:215],v[228:231],v[164:167],0
v_add_f32 v247,v247,v250
v_add_f32 v247,v247,v251
v_mfma_f32_16x16x32_bf16 a[216:219],v[228:231],v[168:171],0
v_cvt_pk_bf16_f32 v191,v250,v251
v_max3_f32 v248,v244,v245,v246
v_mfma_f32_16x16x32_bf16 a[220:223],v[228:231],v[172:175],0
v_max_f32 v248,v248,v247
v_cmp_lt_f32 vcc,0x49800000,v248
v_mfma_f32_16x16x32_bf16 a[224:227],v[232:235],v[160:163],0
ds_read_b128 v[216:219],v252 offset:17024
v_mfma_f32_16x16x32_bf16 a[228:231],v[232:235],v[164:167],0
v_mfma_f32_16x16x32_bf16 a[232:235],v[232:235],v[168:171],0
ds_read_b128 v[220:223],v252 offset:17088
v_mfma_f32_16x16x32_bf16 a[236:239],v[232:235],v[172:175],0
v_mfma_f32_16x16x32_bf16 a[240:243],v[236:239],v[160:163],0
v_mfma_f32_16x16x32_bf16 a[244:247],v[236:239],v[164:167],0
v_mfma_f32_16x16x32_bf16 a[248:251],v[236:239],v[168:171],0
s_waitcnt lgkmcnt(2)
v_mfma_f32_16x16x32_bf16 a[252:255],v[236:239],v[172:175],0
s_cbranch_vccnz L_stub0
L_back0:
v_mfma_f32_16x16x32_bf16 v[128:131],v[208:211],v[0:3],v[192:195]
ds_read_b128 v[224:227],v252 offset:17152
s_add_u32 m0,s35,33792
v_mfma_f32_16x16x32_bf16 v[132:135],v[208:211],v[4:7],v[196:199]
buffer_load_dwordx4 v254,s[8:11],s30 offen offset:0 nt lds
s_add_u32 m0,m0,0x00000220
v_mfma_f32_16x16x32_bf16 v[136:139],v[208:211],v[8:11],v[200:203]
ds_read_b128 v[228:231],v252 offset:17216
v_add_f32 v240,v240,v244
v_mfma_f32_16x16x32_bf16 v[140:143],v[208:211],v[12:15],v[204:207]
v_add_f32 v241,v241,v245
v_add_f32 v242,v242,v246
v_mfma_f32_16x16x32_bf16 v[128:131],v[212:215],v[16:19],v[128:131]
v_add_f32 v243,v243,v247
v_mfma_f32_16x16x32_bf16 v[132:135],v[212:215],v[20:23],v[132:135]
buffer_load_dwordx4 v254,s[8:11],s30 offen offset:512 nt lds
s_add_u32 m0,m0,0x00000220
v_mfma_f32_16x16x32_bf16 v[136:139],v[212:215],v[24:27],v[136:139]
v_mfma_f32_16x16x32_bf16 v[140:143],v[212:215],v[28:31],v[140:143]
s_waitcnt lgkmcnt(2)
v_mfma_f32_16x16x32_bf16 v[128:131],v[216:219],v[32:35],v[128:131]
ds_read_b128 v[232:235],v252 offset:17280
v_mfma_f32_16x16x32_bf16 v[132:135],v[216:219],v[36:39],v[132:135]
buffer_load_dwordx4 v254,s[8:11],s30 offen offset:1024 nt lds
s_add_u32 m0,m0,0x00000220
v_mfma_f32_16x16x32_bf16 v[136:139],v[216:219],v[40:43],v[136:139]
ds_read_b128 v[236:239],v252 offset:17344
v_mfma_f32_16x16x32_bf16 v[140:143],v[216:219],v[44:47],v[140:143]
v_mfma_f32_16x16x32_bf16 v[128:131],v[220:223],v[48:51],v[128:131]
v_mfma_f32_16x16x32_bf16 v[132:135],v[220:223],v[52:55],v[132:135]
buffer_load_dwordx4 v254,s[8:11],s30 offen offset:1536 nt lds
s_add_u32 s30,s30,16384
v_mfma_f32_16x16x32_bf16 v[136:139],v[220:223],v[56:59],v[136:139]
s_add_u32 m0,s34,67584
v_mfma_f32_16x16x32_bf16 v[140:143],v[220:223],v[60:63],v[140:143]
s_waitcnt lgkmcnt(2)
v_mfma_f32_16x16x32_bf16 v[128:131],v[224:227],v[64:67],v[128:131]
ds_read_b128 v[208:211],v252 offset:17408
v_mfma_f32_16x16x32_bf16 v[132:135],v[224:227],v[68:71],v[132:135]
buffer_load_dwordx4 v254,s[12:15],s31 offen offset:0 nt lds
s_add_u32 m0,m0,0x00000220
v_mfma_f32_16x16x32_bf16 v[136:139],v[224:227],v[72:75],v[136:139]
ds_read_b128 v[212:215],v252 offset:17472
v_mfma_f32_16x16x32_bf16 v[140:143],v[224:227],v[76:79],v[140:143]
v_mfma_f32_16x16x32_bf16 v[128:131],v[228:231],v[80:83],v[128:131]
v_mfma_f32_16x16x32_bf16 v[132:135],v[228:231],v[84:87],v[132:135]
buffer_load_dwordx4 v254,s[12:15],s31 offen offset:512 nt lds
s_add_u32 m0,m0,0x00000220
v_mfma_f32_16x16x32_bf16 v[136:139],v[228:231],v[88:91],v[136:139]
v_mfma_f32_16x16x32_bf16 v[140:143],v[228:231],v[92:95],v[140:143]
s_waitcnt lgkmcnt(2)
v_mfma_f32_16x16x32_bf16 v[128:131],v[232:235],v[96:99],v[128:131]
ds_read_b128 v[216:219],v252 offset:17536
v_mfma_f32_16x16x32_bf16 v[132:135],v[232:235],v[100:103],v[132:135]
buffer_load_dwordx4 v254,s[12:15],s31 offen offset:1024 nt lds
s_add_u32 m0,m0,0x00000220
v_mfma_f32_16x16x32_bf16 v[136:139],v[232:235],v[104:107],v[136:139]
ds_read_b128 v[220:223],v252 offset:17600
v_mfma_f32_16x16x32_bf16 v[140:143],v[232:235],v[108:111],v[140:143]
v_mfma_f32_16x16x32_bf16 v[128:131],v[236:239],v[112:115],v[128:131]
v_mfma_f32_16x16x32_bf16 v[132:135],v[236:239],v[116:119],v[132:135]
buffer_load_dwordx4 v254,s[12:15],s31 offen offset:1536 nt lds
s_add_u32 s31,s31,16384
v_mfma_f32_16x16x32_bf16 v[136:139],v[236:239],v[120:123],v[136:139]
v_mfma_f32_16x16x32_bf16 v[140:143],v[236:239],v[124:127],v[140:143]
s_waitcnt lgkmcnt(2)
v_mfma_f32_16x16x32_bf16 v[144:147],v[208:211],v[0:3],v[192:195]
ds_read_b128 v[224:227],v252 offset:17664
v_mfma_f32_16x16x32_bf16 v[148:151],v[208:211],v[4:7],v[196:199]
v_mfma_f32_16x16x32_bf16 v[152:155],v[208:211],v[8:11],v[200:203]
ds_read_b128 v[228:231],v252 offset:17728
v_mfma_f32_16x16x32_bf16 v[156:159],v[208:211],v[12:15],v[204:207]
v_exp_f32 v248,v128
v_mfma_f32_16x16x32_bf16 v[144:147],v[212:215],v[16:19],v[144:147]
v_exp_f32 v249,v129
v_mfma_f32_16x16x32_bf16 v[148:151],v[212:215],v[20:23],v[148:151]
v_exp_f32 v250,v130
v_mfma_f32_16x16x32_bf16 v[152:155],v[212:215],v[24:27],v[152:155]
v_exp_f32 v251,v131
v_mfma_f32_16x16x32_bf16 v[156:159],v[212:215],v[28:31],v[156:159]
v_add_f32 v244,v248,v249
s_waitcnt lgkmcnt(2)
v_mfma_f32_16x16x32_bf16 v[144:147],v[216:219],v[32:35],v[144:147]
ds_read_b128 v[232:235],v252 offset:17792
v_cvt_pk_bf16_f32 v160,v248,v249
v_mfma_f32_16x16x32_bf16 v[148:151],v[216:219],v[36:39],v[148:151]
v_exp_f32 v248,v132
v_mfma_f32_16x16x32_bf16 v[152:155],v[216:219],v[40:43],v[152:155]
ds_read_b128 v[236:239],v252 offset:17856
v_add_f32 v244,v244,v250
v_mfma_f32_16x16x32_bf16 v[156:159],v[216:219],v[44:47],v[156:159]
v_exp_f32 v249,v133
v_mfma_f32_16x16x32_bf16 v[144:147],v[220:223],v[48:51],v[144:147]
v_add_f32 v244,v244,v251
v_cvt_pk_bf16_f32 v161,v250,v251
v_mfma_f32_16x16x32_bf16 v[148:151],v[220:223],v[52:55],v[148:151]
v_exp_f32 v250,v134
v_mfma_f32_16x16x32_bf16 v[152:155],v[220:223],v[56:59],v[152:155]
v_exp_f32 v251,v135
v_mfma_f32_16x16x32_bf16 v[156:159],v[220:223],v[60:63],v[156:159]
v_add_f32 v245,v248,v249
s_waitcnt lgkmcnt(2)
v_mfma_f32_16x16x32_bf16 v[144:147],v[224:227],v[64:67],v[144:147]
ds_read_b64_tr_b16 v[208:209],v253 offset:16896
v_subrev_u32 v252,s33,v252
v_mfma_f32_16x16x32_bf16 v[148:151],v[224:227],v[68:71],v[148:151]
ds_read_b64_tr_b16 v[210:211],v253 offset:17408
v_cvt_pk_bf16_f32 v164,v248,v249
v_mfma_f32_16x16x32_bf16 v[152:155],v[224:227],v[72:75],v[152:155]
ds_read_b64_tr_b16 v[212:213],v253 offset:16928
v_add_f32 v245,v245,v250
v_mfma_f32_16x16x32_bf16 v[156:159],v[224:227],v[76:79],v[156:159]
ds_read_b64_tr_b16 v[214:215],v253 offset:17440
v_add_f32 v245,v245,v251
v_mfma_f32_16x16x32_bf16 v[144:147],v[228:231],v[80:83],v[144:147]
v_exp_f32 v248,v136
v_mfma_f32_16x16x32_bf16 v[148:151],v[228:231],v[84:87],v[148:151]
v_exp_f32 v249,v137
v_mfma_f32_16x16x32_bf16 v[152:155],v[228:231],v[88:91],v[152:155]
v_cvt_pk_bf16_f32 v165,v250,v251
v_mfma_f32_16x16x32_bf16 v[156:159],v[228:231],v[92:95],v[156:159]
v_add_f32 v246,v248,v249
s_waitcnt lgkmcnt(4)
v_mfma_f32_16x16x32_bf16 v[144:147],v[232:235],v[96:99],v[144:147]
ds_read_b64_tr_b16 v[216:217],v253 offset:16960
v_cvt_pk_bf16_f32 v168,v248,v249
v_mfma_f32_16x16x32_bf16 v[148:151],v[232:235],v[100:103],v[148:151]
ds_read_b64_tr_b16 v[218:219],v253 offset:17472
v_mfma_f32_16x16x32_bf16 v[152:155],v[232:235],v[104:107],v[152:155]
ds_read_b64_tr_b16 v[220:221],v253 offset:16992
v_mfma_f32_16x16x32_bf16 v[156:159],v[232:235],v[108:111],v[156:159]
ds_read_b64_tr_b16 v[222:223],v253 offset:17504
v_mfma_f32_16x16x32_bf16 v[144:147],v[236:239],v[112:115],v[144:147]
s_add_u32 s34,s34,s33
s_sub_u32 s35,s35,s33
v_mfma_f32_16x16x32_bf16 v[148:151],v[236:239],v[116:119],v[148:151]
v_exp_f32 v250,v138
v_mfma_f32_16x16x32_bf16 v[152:155],v[236:239],v[120:123],v[152:155]
v_exp_f32 v251,v139
v_mfma_f32_16x16x32_bf16 v[156:159],v[236:239],v[124:127],v[156:159]
v_add_f32 v246,v246,v250
s_waitcnt lgkmcnt(4)
v_mfma_f32_16x16x32_bf16 a[0:3],v[208:211],v[176:179],a[0:3]
ds_read_b64_tr_b16 v[224:225],v253 offset:17024
v_add_f32 v246,v246,v251
v_mfma_f32_16x16x32_bf16 a[4:7],v[208:211],v[180:183],a[4:7]
ds_read_b64_tr_b16 v[226:227],v253 offset:17536
v_cvt_pk_bf16_f32 v169,v250,v251
v_mfma_f32_16x16x32_bf16 a[8:11],v[208:211],v[184:187],a[8:11]
ds_read_b64_tr_b16 v[228:229],v253 offset:17056
v_mfma_f32_16x16x32_bf16 a[12:15],v[208:211],v[188:191],a[12:15]
ds_read_b64_tr_b16 v[230:231],v253 offset:17568
v_mfma_f32_16x16x32_bf16 a[16:19],v[212:215],v[176:179],a[16:19]
v_exp_f32 v248,v140
v_mfma_f32_16x16x32_bf16 a[20:23],v[212:215],v[180:183],a[20:23]
v_exp_f32 v249,v141
v_mfma_f32_16x16x32_bf16 a[24:27],v[212:215],v[184:187],a[24:27]
v_exp_f32 v250,v142
v_mfma_f32_16x16x32_bf16 a[28:31],v[212:215],v[188:191],a[28:31]
v_add_f32 v247,v248,v249
s_waitcnt lgkmcnt(4)
v_mfma_f32_16x16x32_bf16 a[32:35],v[216:219],v[176:179],a[32:35]
ds_read_b64_tr_b16 v[232:233],v253 offset:17088
v_cvt_pk_bf16_f32 v172,v248,v249
v_mfma_f32_16x16x32_bf16 a[36:39],v[216:219],v[180:183],a[36:39]
ds_read_b64_tr_b16 v[234:235],v253 offset:17600
v_mfma_f32_16x16x32_bf16 a[40:43],v[216:219],v[184:187],a[40:43]
ds_read_b64_tr_b16 v[236:237],v253 offset:17120
v_mfma_f32_16x16x32_bf16 a[44:47],v[216:219],v[188:191],a[44:47]
ds_read_b64_tr_b16 v[238:239],v253 offset:17632
v_mfma_f32_16x16x32_bf16 a[48:51],v[220:223],v[176:179],a[48:51]
v_exp_f32 v251,v143
v_mfma_f32_16x16x32_bf16 a[52:55],v[220:223],v[180:183],a[52:55]
v_exp_f32 v248,v144
v_mfma_f32_16x16x32_bf16 a[56:59],v[220:223],v[184:187],a[56:59]
v_exp_f32 v249,v145
v_mfma_f32_16x16x32_bf16 a[60:63],v[220:223],v[188:191],a[60:63]
v_add_f32 v247,v247,v250
s_waitcnt lgkmcnt(4)
v_mfma_f32_16x16x32_bf16 a[64:67],v[224:227],v[176:179],a[64:67]
ds_read_b64_tr_b16 v[208:209],v253 offset:17152
v_add_f32 v247,v247,v251
v_mfma_f32_16x16x32_bf16 a[68:71],v[224:227],v[180:183],a[68:71]
ds_read_b64_tr_b16 v[210:211],v253 offset:17664
v_cvt_pk_bf16_f32 v173,v250,v251
v_mfma_f32_16x16x32_bf16 a[72:75],v[224:227],v[184:187],a[72:75]
ds_read_b64_tr_b16 v[212:213],v253 offset:17184
v_add_f32 v244,v244,v248
v_mfma_f32_16x16x32_bf16 a[76:79],v[224:227],v[188:191],a[76:79]
ds_read_b64_tr_b16 v[214:215],v253 offset:17696
v_add_f32 v244,v244,v249
v_mfma_f32_16x16x32_bf16 a[80:83],v[228:231],v[176:179],a[80:83]
v_exp_f32 v250,v146
v_mfma_f32_16x16x32_bf16 a[84:87],v[228:231],v[180:183],a[84:87]
v_exp_f32 v251,v147
v_mfma_f32_16x16x32_bf16 a[88:91],v[228:231],v[184:187],a[88:91]
v_cvt_pk_bf16_f32 v162,v248,v249
v_mfma_f32_16x16x32_bf16 a[92:95],v[228:231],v[188:191],a[92:95]
v_add_f32 v244,v244,v250
s_waitcnt lgkmcnt(4)
v_mfma_f32_16x16x32_bf16 a[96:99],v[232:235],v[176:179],a[96:99]
ds_read_b64_tr_b16 v[216:217],v253 offset:17216
v_add_f32 v244,v244,v251
v_mfma_f32_16x16x32_bf16 a[100:103],v[232:235],v[180:183],a[100:103]
ds_read_b64_tr_b16 v[218:219],v253 offset:17728
v_cvt_pk_bf16_f32 v163,v250,v251
v_mfma_f32_16x16x32_bf16 a[104:107],v[232:235],v[184:187],a[104:107]
ds_read_b64_tr_b16 v[220:221],v253 offset:17248
v_mfma_f32_16x16x32_bf16 a[108:111],v[232:235],v[188:191],a[108:111]
ds_read_b64_tr_b16 v[222:223],v253 offset:17760
v_mfma_f32_16x16x32_bf16 a[112:115],v[236:239],v[176:179],a[112:115]
v_exp_f32 v248,v148
v_mfma_f32_16x16x32_bf16 a[116:119],v[236:239],v[180:183],a[116:119]
v_exp_f32 v249,v149
v_mfma_f32_16x16x32_bf16 a[120:123],v[236:239],v[184:187],a[120:123]
v_exp_f32 v250,v150
v_mfma_f32_16x16x32_bf16 a[124:127],v[236:239],v[188:191],a[124:127]
v_add_f32 v245,v245,v248
s_waitcnt lgkmcnt(4)
v_mfma_f32_16x16x32_bf16 a[128:131],v[208:211],v[176:179],a[128:131]
ds_read_b64_tr_b16 v[224:225],v253 offset:17280
v_add_f32 v245,v245,v249
v_mfma_f32_16x16x32_bf16 a[132:135],v[208:211],v[180:183],a[132:135]
ds_read_b64_tr_b16 v[226:227],v253 offset:17792
v_cvt_pk_bf16_f32 v166,v248,v249
v_mfma_f32_16x16x32_bf16 a[136:139],v[208:211],v[184:187],a[136:139]
ds_read_b64_tr_b16 v[228:229],v253 offset:17312
v_mfma_f32_16x16x32_bf16 a[140:143],v[208:211],v[188:191],a[140:143]
ds_read_b64_tr_b16 v[230:231],v253 offset:17824
v_mfma_f32_16x16x32_bf16 a[144:147],v[212:215],v[176:179],a[144:147]
v_exp_f32 v251,v151
v_mfma_f32_16x16x32_bf16 a[148:151],v[212:215],v[180:183],a[148:151]
v_exp_f32 v248,v152
v_mfma_f32_16x16x32_bf16 a[152:155],v[212:215],v[184:187],a[152:155]
v_exp_f32 v249,v153
v_mfma_f32_16x16x32_bf16 a[156:159],v[212:215],v[188:191],a[156:159]
v_add_f32 v245,v245,v250
s_waitcnt lgkmcnt(4)
v_mfma_f32_16x16x32_bf16 a[160:163],v[216:219],v[176:179],a[160:163]
ds_read_b64_tr_b16 v[232:233],v253 offset:17344
v_add_f32 v245,v245,v251
v_mfma_f32_16x16x32_bf16 a[164:167],v[216:219],v[180:183],a[164:167]
ds_read_b64_tr_b16 v[234:235],v253 offset:17856
v_cvt_pk_bf16_f32 v167,v250,v251
v_mfma_f32_16x16x32_bf16 a[168:171],v[216:219],v[184:187],a[168:171]
ds_read_b64_tr_b16 v[236:237],v253 offset:17376
v_add_f32 v246,v246,v248
v_mfma_f32_16x16x32_bf16 a[172:175],v[216:219],v[188:191],a[172:175]
ds_read_b64_tr_b16 v[238:239],v253 offset:17888
v_add_f32 v246,v246,v249
v_mfma_f32_16x16x32_bf16 a[176:179],v[220:223],v[176:179],a[176:179]
v_add_u32 v253,s33,v253
s_sub_u32 s33,0,s33
v_mfma_f32_16x16x32_bf16 a[180:183],v[220:223],v[180:183],a[180:183]
v_exp_f32 v250,v154
v_mfma_f32_16x16x32_bf16 a[184:187],v[220:223],v[184:187],a[184:187]
v_exp_f32 v251,v155
v_mfma_f32_16x16x32_bf16 a[188:191],v[220:223],v[188:191],a[188:191]
v_cvt_pk_bf16_f32 v170,v248,v249
s_waitcnt lgkmcnt(4)
v_mfma_f32_16x16x32_bf16 a[192:195],v[224:227],v[176:179],a[192:195]
v_exp_f32 v248,v156
v_mfma_f32_16x16x32_bf16 a[196:199],v[224:227],v[180:183],a[196:199]
s_waitcnt vmcnt(16) lgkmcnt(0)
s_barrier
v_mfma_f32_16x16x32_bf16 a[200:203],v[224:227],v[184:187],a[200:203]
ds_read_b128 v[208:211],v252 offset:0
v_add_f32 v246,v246,v250
v_mfma_f32_16x16x32_bf16 a[204:207],v[224:227],v[188:191],a[204:207]
v_exp_f32 v249,v157
v_mfma_f32_16x16x32_bf16 a[208:211],v[228:231],v[176:179],a[208:211]
ds_read_b128 v[212:215],v252 offset:64
v_add_f32 v246,v246,v251
v_mfma_f32_16x16x32_bf16 a[212:215],v[228:231],v[180:183],a[212:215]
v_cvt_pk_bf16_f32 v171,v250,v251
v_mfma_f32_16x16x32_bf16 a[216:219],v[228:231],v[184:187],a[216:219]
v_exp_f32 v250,v158
v_mfma_f32_16x16x32_bf16 a[220:223],v[228:231],v[188:191],a[220:223]
v_exp_f32 v251,v159
v_mfma_f32_16x16x32_bf16 a[224:227],v[232:235],v[176:179],a[224:227]
ds_read_b128 v[216:219],v252 offset:128
v_add_f32 v247,v247,v248
v_mfma_f32_16x16x32_bf16 a[228:231],v[232:235],v[180:183],a[228:231]
v_add_f32 v247,v247,v249
v_cvt_pk_bf16_f32 v174,v248,v249
v_mfma_f32_16x16x32_bf16 a[232:235],v[232:235],v[184:187],a[232:235]
ds_read_b128 v[220:223],v252 offset:192
v_add_f32 v247,v247,v250
v_mfma_f32_16x16x32_bf16 a[236:239],v[232:235],v[188:191],a[236:239]
v_add_f32 v247,v247,v251
v_cvt_pk_bf16_f32 v175,v250,v251
v_mfma_f32_16x16x32_bf16 a[240:243],v[236:239],v[176:179],a[240:243]
v_max3_f32 v248,v244,v245,v246
v_max_f32 v248,v248,v247
v_mfma_f32_16x16x32_bf16 a[244:247],v[236:239],v[180:183],a[244:247]
v_cmp_lt_f32 vcc,0x49800000,v248
v_mfma_f32_16x16x32_bf16 a[248:251],v[236:239],v[184:187],a[248:251]
s_waitcnt lgkmcnt(2)
v_mfma_f32_16x16x32_bf16 a[252:255],v[236:239],v[188:191],a[252:255]
s_cbranch_vccnz L_stub1
L_back1:
.p2alignl 6, 0xbf800000
L_aloop:
v_mfma_f32_16x16x32_bf16 v[128:131],v[208:211],v[0:3],v[192:195]
ds_read_b128 v[224:227],v252 offset:256
s_add_u32 m0,s34,16896
v_mfma_f32_16x16x32_bf16 v[132:135],v[208:211],v[4:7],v[196:199]
buffer_load_dwordx4 v254,s[8:11],s30 offen offset:0 nt lds
s_add_u32 m0,m0,0x00000220
v_mfma_f32_16x16x32_bf16 v[136:139],v[208:211],v[8:11],v[200:203]
ds_read_b128 v[228:231],v252 offset:320
v_add_f32 v240,v240,v244
v_mfma_f32_16x16x32_bf16 v[140:143],v[208:211],v[12:15],v[204:207]
v_add_f32 v241,v241,v245
v_add_f32 v242,v242,v246
v_mfma_f32_16x16x32_bf16 v[128:131],v[212:215],v[16:19],v[128:131]
v_add_f32 v243,v243,v247
v_mfma_f32_16x16x32_bf16 v[132:135],v[212:215],v[20:23],v[132:135]
buffer_load_dwordx4 v254,s[8:11],s30 offen offset:512 nt lds
s_add_u32 m0,m0,0x00000220
v_mfma_f32_16x16x32_bf16 v[136:139],v[212:215],v[24:27],v[136:139]
v_mfma_f32_16x16x32_bf16 v[140:143],v[212:215],v[28:31],v[140:143]
s_waitcnt lgkmcnt(2)
v_mfma_f32_16x16x32_bf16 v[128:131],v[216:219],v[32:35],v[128:131]
ds_read_b128 v[232:235],v252 offset:384
v_mfma_f32_16x16x32_bf16 v[132:135],v[216:219],v[36:39],v[132:135]
buffer_load_dwordx4 v254,s[8:11],s30 offen offset:1024 nt lds
s_add_u32 m0,m0,0x00000220
v_mfma_f32_16x16x32_bf16 v[136:139],v[216:219],v[40:43],v[136:139]
ds_read_b128 v[236:239],v252 offset:448
v_mfma_f32_16x16x32_bf16 v[140:143],v[216:219],v[44:47],v[140:143]
v_mfma_f32_16x16x32_bf16 v[128:131],v[220:223],v[48:51],v[128:131]
v_mfma_f32_16x16x32_bf16 v[132:135],v[220:223],v[52:55],v[132:135]
buffer_load_dwordx4 v254,s[8:11],s30 offen offset:1536 nt lds
s_add_u32 s30,s30,16384
v_mfma_f32_16x16x32_bf16 v[136:139],v[220:223],v[56:59],v[136:139]
s_add_u32 m0,s35,118272
v_mfma_f32_16x16x32_bf16 v[140:143],v[220:223],v[60:63],v[140:143]
s_waitcnt lgkmcnt(2)
v_mfma_f32_16x16x32_bf16 v[128:131],v[224:227],v[64:67],v[128:131]
ds_read_b128 v[208:211],v252 offset:512
v_mfma_f32_16x16x32_bf16 v[132:135],v[224:227],v[68:71],v[132:135]
buffer_load_dwordx4 v254,s[12:15],s31 offen offset:0 nt lds
s_add_u32 m0,m0,0x00000220
v_mfma_f32_16x16x32_bf16 v[136:139],v[224:227],v[72:75],v[136:139]
ds_read_b128 v[212:215],v252 offset:576
v_mfma_f32_16x16x32_bf16 v[140:143],v[224:227],v[76:79],v[140:143]
v_mfma_f32_16x16x32_bf16 v[128:131],v[228:231],v[80:83],v[128:131]
v_mfma_f32_16x16x32_bf16 v[132:135],v[228:231],v[84:87],v[132:135]
buffer_load_dwordx4 v254,s[12:15],s31 offen offset:512 nt lds
s_add_u32 m0,m0,0x00000220
v_mfma_f32_16x16x32_bf16 v[136:139],v[228:231],v[88:91],v[136:139]
v_mfma_f32_16x16x32_bf16 v[140:143],v[228:231],v[92:95],v[140:143]
s_waitcnt lgkmcnt(2)
v_mfma_f32_16x16x32_bf16 v[128:131],v[232:235],v[96:99],v[128:131]
ds_read_b128 v[216:219],v252 offset:640
v_mfma_f32_16x16x32_bf16 v[132:135],v[232:235],v[100:103],v[132:135]
buffer_load_dwordx4 v254,s[12:15],s31 offen offset:1024 nt lds
s_add_u32 m0,m0,0x00000220
v_mfma_f32_16x16x32_bf16 v[136:139],v[232:235],v[104:107],v[136:139]
ds_read_b128 v[220:223],v252 offset:704
v_mfma_f32_16x16x32_bf16 v[140:143],v[232:235],v[108:111],v[140:143]
v_mfma_f32_16x16x32_bf16 v[128:131],v[236:239],v[112:115],v[128:131]
v_mfma_f32_16x16x32_bf16 v[132:135],v[236:239],v[116:119],v[132:135]
buffer_load_dwordx4 v254,s[12:15],s31 offen offset:1536 nt lds
s_add_u32 s31,s31,16384
v_mfma_f32_16x16x32_bf16 v[136:139],v[236:239],v[120:123],v[136:139]
v_mfma_f32_16x16x32_bf16 v[140:143],v[236:239],v[124:127],v[140:143]
s_waitcnt lgkmcnt(2)
v_mfma_f32_16x16x32_bf16 v[144:147],v[208:211],v[0:3],v[192:195]
ds_read_b128 v[224:227],v252 offset:768
v_mfma_f32_16x16x32_bf16 v[148:151],v[208:211],v[4:7],v[196:199]
v_mfma_f32_16x16x32_bf16 v[152:155],v[208:211],v[8:11],v[200:203]
ds_read_b128 v[228:231],v252 offset:832
v_mfma_f32_16x16x32_bf16 v[156:159],v[208:211],v[12:15],v[204:207]
v_exp_f32 v248,v128
v_mfma_f32_16x16x32_bf16 v[144:147],v[212:215],v[16:19],v[144:147]
v_exp_f32 v249,v129
v_mfma_f32_16x16x32_bf16 v[148:151],v[212:215],v[20:23],v[148:151]
v_exp_f32 v250,v130
v_mfma_f32_16x16x32_bf16 v[152:155],v[212:215],v[24:27],v[152:155]
v_exp_f32 v251,v131
v_mfma_f32_16x16x32_bf16 v[156:159],v[212:215],v[28:31],v[156:159]
v_add_f32 v244,v248,v249
s_waitcnt lgkmcnt(2)
v_mfma_f32_16x16x32_bf16 v[144:147],v[216:219],v[32:35],v[144:147]
ds_read_b128 v[232:235],v252 offset:896
v_cvt_pk_bf16_f32 v176,v248,v249
v_mfma_f32_16x16x32_bf16 v[148:151],v[216:219],v[36:39],v[148:151]
v_exp_f32 v248,v132
v_mfma_f32_16x16x32_bf16 v[152:155],v[216:219],v[40:43],v[152:155]
ds_read_b128 v[236:239],v252 offset:960
v_add_f32 v244,v244,v250
v_mfma_f32_16x16x32_bf16 v[156:159],v[216:219],v[44:47],v[156:159]
v_exp_f32 v249,v133
v_mfma_f32_16x16x32_bf16 v[144:147],v[220:223],v[48:51],v[144:147]
v_add_f32 v244,v244,v251
v_cvt_pk_bf16_f32 v177,v250,v251
v_mfma_f32_16x16x32_bf16 v[148:151],v[220:223],v[52:55],v[148:151]
v_exp_f32 v250,v134
v_mfma_f32_16x16x32_bf16 v[152:155],v[220:223],v[56:59],v[152:155]
v_exp_f32 v251,v135
v_mfma_f32_16x16x32_bf16 v[156:159],v[220:223],v[60:63],v[156:159]
v_add_f32 v245,v248,v249
s_waitcnt lgkmcnt(2)
v_mfma_f32_16x16x32_bf16 v[144:147],v[224:227],v[64:67],v[144:147]
ds_read_b64_tr_b16 v[208:209],v253 offset:0
v_cvt_pk_bf16_f32 v180,v248,v249
v_mfma_f32_16x16x32_bf16 v[148:151],v[224:227],v[68:71],v[148:151]
ds_read_b64_tr_b16 v[210:211],v253 offset:512
v_add_f32 v245,v245,v250
v_mfma_f32_16x16x32_bf16 v[152:155],v[224:227],v[72:75],v[152:155]
ds_read_b64_tr_b16 v[212:213],v253 offset:32
v_add_f32 v245,v245,v251
v_mfma_f32_16x16x32_bf16 v[156:159],v[224:227],v[76:79],v[156:159]
ds_read_b64_tr_b16 v[214:215],v253 offset:544
v_cvt_pk_bf16_f32 v181,v250,v251
v_mfma_f32_16x16x32_bf16 v[144:147],v[228:231],v[80:83],v[144:147]
v_exp_f32 v248,v136
v_mfma_f32_16x16x32_bf16 v[148:151],v[228:231],v[84:87],v[148:151]
v_exp_f32 v249,v137
v_mfma_f32_16x16x32_bf16 v[152:155],v[228:231],v[88:91],v[152:155]
v_exp_f32 v250,v138
v_mfma_f32_16x16x32_bf16 v[156:159],v[228:231],v[92:95],v[156:159]
v_add_f32 v246,v248,v249
s_waitcnt lgkmcnt(4)
v_mfma_f32_16x16x32_bf16 v[144:147],v[232:235],v[96:99],v[144:147]
ds_read_b64_tr_b16 v[216:217],v253 offset:64
v_cvt_pk_bf16_f32 v184,v248,v249
v_mfma_f32_16x16x32_bf16 v[148:151],v[232:235],v[100:103],v[148:151]
ds_read_b64_tr_b16 v[218:219],v253 offset:576
v_mfma_f32_16x16x32_bf16 v[152:155],v[232:235],v[104:107],v[152:155]
ds_read_b64_tr_b16 v[220:221],v253 offset:96
v_mfma_f32_16x16x32_bf16 v[156:159],v[232:235],v[108:111],v[156:159]
ds_read_b64_tr_b16 v[222:223],v253 offset:608
v_mfma_f32_16x16x32_bf16 v[144:147],v[236:239],v[112:115],v[144:147]
v_exp_f32 v251,v139
v_mfma_f32_16x16x32_bf16 v[148:151],v[236:239],v[116:119],v[148:151]
v_exp_f32 v248,v140
v_mfma_f32_16x16x32_bf16 v[152:155],v[236:239],v[120:123],v[152:155]
v_exp_f32 v249,v141
v_mfma_f32_16x16x32_bf16 v[156:159],v[236:239],v[124:127],v[156:159]
v_add_f32 v246,v246,v250
s_waitcnt lgkmcnt(4)
v_mfma_f32_16x16x32_bf16 a[0:3],v[208:211],v[160:163],a[0:3]
ds_read_b64_tr_b16 v[224:225],v253 offset:128
v_add_f32 v246,v246,v251
v_mfma_f32_16x16x32_bf16 a[4:7],v[208:211],v[164:167],a[4:7]
ds_read_b64_tr_b16 v[226:227],v253 offset:640
v_cvt_pk_bf16_f32 v185,v250,v251
v_mfma_f32_16x16x32_bf16 a[8:11],v[208:211],v[168:171],a[8:11]
ds_read_b64_tr_b16 v[228:229],v253 offset:160
v_add_f32 v247,v248,v249
v_mfma_f32_16x16x32_bf16 a[12:15],v[208:211],v[172:175],a[12:15]
ds_read_b64_tr_b16 v[230:231],v253 offset:672
v_cvt_pk_bf16_f32 v188,v248,v249
v_mfma_f32_16x16x32_bf16 a[16:19],v[212:215],v[160:163],a[16:19]
v_exp_f32 v250,v142
v_mfma_f32_16x16x32_bf16 a[20:23],v[212:215],v[164:167],a[20:23]
v_exp_f32 v251,v143
v_mfma_f32_16x16x32_bf16 a[24:27],v[212:215],v[168:171],a[24:27]
v_exp_f32 v248,v144
v_mfma_f32_16x16x32_bf16 a[28:31],v[212:215],v[172:175],a[28:31]
v_add_f32 v247,v247,v250
s_waitcnt lgkmcnt(4)
v_mfma_f32_16x16x32_bf16 a[32:35],v[216:219],v[160:163],a[32:35]
ds_read_b64_tr_b16 v[232:233],v253 offset:192
v_add_f32 v247,v247,v251
v_mfma_f32_16x16x32_bf16 a[36:39],v[216:219],v[164:167],a[36:39]
ds_read_b64_tr_b16 v[234:235],v253 offset:704
v_cvt_pk_bf16_f32 v189,v250,v251
v_mfma_f32_16x16x32_bf16 a[40:43],v[216:219],v[168:171],a[40:43]
ds_read_b64_tr_b16 v[236:237],v253 offset:224
v_mfma_f32_16x16x32_bf16 a[44:47],v[216:219],v[172:175],a[44:47]
ds_read_b64_tr_b16 v[238:239],v253 offset:736
v_mfma_f32_16x16x32_bf16 a[48:51],v[220:223],v[160:163],a[48:51]
v_exp_f32 v249,v145
v_mfma_f32_16x16x32_bf16 a[52:55],v[220:223],v[164:167],a[52:55]
v_exp_f32 v250,v146
v_mfma_f32_16x16x32_bf16 a[56:59],v[220:223],v[168:171],a[56:59]
v_exp_f32 v251,v147
v_mfma_f32_16x16x32_bf16 a[60:63],v[220:223],v[172:175],a[60:63]
v_add_f32 v244,v244,v248
s_waitcnt lgkmcnt(4)
v_mfma_f32_16x16x32_bf16 a[64:67],v[224:227],v[160:163],a[64:67]
ds_read_b64_tr_b16 v[208:209],v253 offset:256
v_add_f32 v244,v244,v249
v_mfma_f32_16x16x32_bf16 a[68:71],v[224:227],v[164:167],a[68:71]
ds_read_b64_tr_b16 v[210:211],v253 offset:768
v_cvt_pk_bf16_f32 v178,v248,v249
v_mfma_f32_16x16x32_bf16 a[72:75],v[224:227],v[168:171],a[72:75]
ds_read_b64_tr_b16 v[212:213],v253 offset:288
v_add_f32 v244,v244,v250
v_mfma_f32_16x16x32_bf16 a[76:79],v[224:227],v[172:175],a[76:79]
ds_read_b64_tr_b16 v[214:215],v253 offset:800
v_add_f32 v244,v244,v251
v_mfma_f32_16x16x32_bf16 a[80:83],v[228:231],v[160:163],a[80:83]
v_exp_f32 v248,v148
v_mfma_f32_16x16x32_bf16 a[84:87],v[228:231],v[164:167],a[84:87]
v_exp_f32 v249,v149
v_mfma_f32_16x16x32_bf16 a[88:91],v[228:231],v[168:171],a[88:91]
v_cvt_pk_bf16_f32 v179,v250,v251
v_mfma_f32_16x16x32_bf16 a[92:95],v[228:231],v[172:175],a[92:95]
v_add_f32 v245,v245,v248
s_waitcnt lgkmcnt(4)
v_mfma_f32_16x16x32_bf16 a[96:99],v[232:235],v[160:163],a[96:99]
ds_read_b64_tr_b16 v[216:217],v253 offset:320
v_add_f32 v245,v245,v249
v_mfma_f32_16x16x32_bf16 a[100:103],v[232:235],v[164:167],a[100:103]
ds_read_b64_tr_b16 v[218:219],v253 offset:832
v_cvt_pk_bf16_f32 v182,v248,v249
v_mfma_f32_16x16x32_bf16 a[104:107],v[232:235],v[168:171],a[104:107]
ds_read_b64_tr_b16 v[220:221],v253 offset:352
v_mfma_f32_16x16x32_bf16 a[108:111],v[232:235],v[172:175],a[108:111]
ds_read_b64_tr_b16 v[222:223],v253 offset:864
v_mfma_f32_16x16x32_bf16 a[112:115],v[236:239],v[160:163],a[112:115]
v_exp_f32 v250,v150
v_mfma_f32_16x16x32_bf16 a[116:119],v[236:239],v[164:167],a[116:119]
v_exp_f32 v251,v151
v_mfma_f32_16x16x32_bf16 a[120:123],v[236:239],v[168:171],a[120:123]
v_exp_f32 v248,v152
v_mfma_f32_16x16x32_bf16 a[124:127],v[236:239],v[172:175],a[124:127]
v_add_f32 v245,v245,v250
s_waitcnt lgkmcnt(4)
v_mfma_f32_16x16x32_bf16 a[128:131],v[208:211],v[160:163],a[128:131]
ds_read_b64_tr_b16 v[224:225],v253 offset:384
v_add_f32 v245,v245,v251
v_mfma_f32_16x16x32_bf16 a[132:135],v[208:211],v[164:167],a[132:135]
ds_read_b64_tr_b16 v[226:227],v253 offset:896
v_cvt_pk_bf16_f32 v183,v250,v251
v_mfma_f32_16x16x32_bf16 a[136:139],v[208:211],v[168:171],a[136:139]
ds_read_b64_tr_b16 v[228:229],v253 offset:416
v_mfma_f32_16x16x32_bf16 a[140:143],v[208:211],v[172:175],a[140:143]
ds_read_b64_tr_b16 v[230:231],v253 offset:928
v_mfma_f32_16x16x32_bf16 a[144:147],v[212:215],v[160:163],a[144:147]
v_exp_f32 v249,v153
v_mfma_f32_16x16x32_bf16 a[148:151],v[212:215],v[164:167],a[148:151]
v_exp_f32 v250,v154
v_mfma_f32_16x16x32_bf16 a[152:155],v[212:215],v[168:171],a[152:155]
v_exp_f32 v251,v155
v_mfma_f32_16x16x32_bf16 a[156:159],v[212:215],v[172:175],a[156:159]
v_add_f32 v246,v246,v248
s_waitcnt lgkmcnt(4)
v_mfma_f32_16x16x32_bf16 a[160:163],v[216:219],v[160:163],a[160:163]
ds_read_b64_tr_b16 v[232:233],v253 offset:448
v_add_f32 v246,v246,v249
v_mfma_f32_16x16x32_bf16 a[164:167],v[216:219],v[164:167],a[164:167]
ds_read_b64_tr_b16 v[234:235],v253 offset:960
v_cvt_pk_bf16_f32 v186,v248,v249
v_mfma_f32_16x16x32_bf16 a[168:171],v[216:219],v[168:171],a[168:171]
ds_read_b64_tr_b16 v[236:237],v253 offset:480
v_add_f32 v246,v246,v250
v_mfma_f32_16x16x32_bf16 a[172:175],v[216:219],v[172:175],a[172:175]
ds_read_b64_tr_b16 v[238:239],v253 offset:992
v_add_f32 v246,v246,v251
v_mfma_f32_16x16x32_bf16 a[176:179],v[220:223],v[160:163],a[176:179]
v_exp_f32 v248,v156
v_mfma_f32_16x16x32_bf16 a[180:183],v[220:223],v[164:167],a[180:183]
v_exp_f32 v249,v157
v_mfma_f32_16x16x32_bf16 a[184:187],v[220:223],v[168:171],a[184:187]
v_cvt_pk_bf16_f32 v187,v250,v251
v_mfma_f32_16x16x32_bf16 a[188:191],v[220:223],v[172:175],a[188:191]
v_add_f32 v247,v247,v248
s_waitcnt lgkmcnt(4)
v_mfma_f32_16x16x32_bf16 a[192:195],v[224:227],v[160:163],a[192:195]
v_exp_f32 v250,v158
v_mfma_f32_16x16x32_bf16 a[196:199],v[224:227],v[164:167],a[196:199]
s_waitcnt vmcnt(16) lgkmcnt(0)
s_barrier
v_mfma_f32_16x16x32_bf16 a[200:203],v[224:227],v[168:171],a[200:203]
ds_read_b128 v[208:211],v252 offset:16896
v_add_f32 v247,v247,v249
v_mfma_f32_16x16x32_bf16 a[204:207],v[224:227],v[172:175],a[204:207]
v_exp_f32 v251,v159
v_mfma_f32_16x16x32_bf16 a[208:211],v[228:231],v[160:163],a[208:211]
ds_read_b128 v[212:215],v252 offset:16960
v_cvt_pk_bf16_f32 v190,v248,v249
v_mfma_f32_16x16x32_bf16 a[212:215],v[228:231],v[164:167],a[212:215]
v_add_f32 v247,v247,v250
v_add_f32 v247,v247,v251
v_mfma_f32_16x16x32_bf16 a[216:219],v[228:231],v[168:171],a[216:219]
v_cvt_pk_bf16_f32 v191,v250,v251
v_max3_f32 v248,v244,v245,v246
v_mfma_f32_16x16x32_bf16 a[220:223],v[228:231],v[172:175],a[220:223]
v_max_f32 v248,v248,v247
v_cmp_lt_f32 vcc,0x49800000,v248
v_mfma_f32_16x16x32_bf16 a[224:227],v[232:235],v[160:163],a[224:227]
ds_read_b128 v[216:219],v252 offset:17024
v_mfma_f32_16x16x32_bf16 a[228:231],v[232:235],v[164:167],a[228:231]
v_mfma_f32_16x16x32_bf16 a[232:235],v[232:235],v[168:171],a[232:235]
ds_read_b128 v[220:223],v252 offset:17088
v_mfma_f32_16x16x32_bf16 a[236:239],v[232:235],v[172:175],a[236:239]
v_mfma_f32_16x16x32_bf16 a[240:243],v[236:239],v[160:163],a[240:243]
v_mfma_f32_16x16x32_bf16 a[244:247],v[236:239],v[164:167],a[244:247]
v_mfma_f32_16x16x32_bf16 a[248:251],v[236:239],v[168:171],a[248:251]
s_waitcnt lgkmcnt(2)
v_mfma_f32_16x16x32_bf16 a[252:255],v[236:239],v[172:175],a[252:255]
s_cbranch_vccnz L_stub2
L_back2:
v_mfma_f32_16x16x32_bf16 v[128:131],v[208:211],v[0:3],v[192:195]
ds_read_b128 v[224:227],v252 offset:17152
s_add_u32 m0,s35,33792
v_mfma_f32_16x16x32_bf16 v[132:135],v[208:211],v[4:7],v[196:199]
buffer_load_dwordx4 v254,s[8:11],s30 offen offset:0 nt lds
s_add_u32 m0,m0,0x00000220
v_mfma_f32_16x16x32_bf16 v[136:139],v[208:211],v[8:11],v[200:203]
ds_read_b128 v[228:231],v252 offset:17216
v_add_f32 v240,v240,v244
v_mfma_f32_16x16x32_bf16 v[140:143],v[208:211],v[12:15],v[204:207]
v_add_f32 v241,v241,v245
v_add_f32 v242,v242,v246
v_mfma_f32_16x16x32_bf16 v[128:131],v[212:215],v[16:19],v[128:131]
v_add_f32 v243,v243,v247
v_mfma_f32_16x16x32_bf16 v[132:135],v[212:215],v[20:23],v[132:135]
buffer_load_dwordx4 v254,s[8:11],s30 offen offset:512 nt lds
s_add_u32 m0,m0,0x00000220
v_mfma_f32_16x16x32_bf16 v[136:139],v[212:215],v[24:27],v[136:139]
v_mfma_f32_16x16x32_bf16 v[140:143],v[212:215],v[28:31],v[140:143]
s_waitcnt lgkmcnt(2)
v_mfma_f32_16x16x32_bf16 v[128:131],v[216:219],v[32:35],v[128:131]
ds_read_b128 v[232:235],v252 offset:17280
v_mfma_f32_16x16x32_bf16 v[132:135],v[216:219],v[36:39],v[132:135]
buffer_load_dwordx4 v254,s[8:11],s30 offen offset:1024 nt lds
s_add_u32 m0,m0,0x00000220
v_mfma_f32_16x16x32_bf16 v[136:139],v[216:219],v[40:43],v[136:139]
ds_read_b128 v[236:239],v252 offset:17344
v_mfma_f32_16x16x32_bf16 v[140:143],v[216:219],v[44:47],v[140:143]
v_mfma_f32_16x16x32_bf16 v[128:131],v[220:223],v[48:51],v[128:131]
v_mfma_f32_16x16x32_bf16 v[132:135],v[220:223],v[52:55],v[132:135]
buffer_load_dwordx4 v254,s[8:11],s30 offen offset:1536 nt lds
s_add_u32 s30,s30,16384
v_mfma_f32_16x16x32_bf16 v[136:139],v[220:223],v[56:59],v[136:139]
s_add_u32 m0,s34,67584
v_mfma_f32_16x16x32_bf16 v[140:143],v[220:223],v[60:63],v[140:143]
s_waitcnt lgkmcnt(2)
v_mfma_f32_16x16x32_bf16 v[128:131],v[224:227],v[64:67],v[128:131]
ds_read_b128 v[208:211],v252 offset:17408
v_mfma_f32_16x16x32_bf16 v[132:135],v[224:227],v[68:71],v[132:135]
buffer_load_dwordx4 v254,s[12:15],s31 offen offset:0 nt lds
s_add_u32 m0,m0,0x00000220
v_mfma_f32_16x16x32_bf16 v[136:139],v[224:227],v[72:75],v[136:139]
ds_read_b128 v[212:215],v252 offset:17472
v_mfma_f32_16x16x32_bf16 v[140:143],v[224:227],v[76:79],v[140:143]
v_mfma_f32_16x16x32_bf16 v[128:131],v[228:231],v[80:83],v[128:131]
v_mfma_f32_16x16x32_bf16 v[132:135],v[228:231],v[84:87],v[132:135]
buffer_load_dwordx4 v254,s[12:15],s31 offen offset:512 nt lds
s_add_u32 m0,m0,0x00000220
v_mfma_f32_16x16x32_bf16 v[136:139],v[228:231],v[88:91],v[136:139]
v_mfma_f32_16x16x32_bf16 v[140:143],v[228:231],v[92:95],v[140:143]
s_waitcnt lgkmcnt(2)
v_mfma_f32_16x16x32_bf16 v[128:131],v[232:235],v[96:99],v[128:131]
ds_read_b128 v[216:219],v252 offset:17536
v_mfma_f32_16x16x32_bf16 v[132:135],v[232:235],v[100:103],v[132:135]
buffer_load_dwordx4 v254,s[12:15],s31 offen offset:1024 nt lds
s_add_u32 m0,m0,0x00000220
v_mfma_f32_16x16x32_bf16 v[136:139],v[232:235],v[104:107],v[136:139]
ds_read_b128 v[220:223],v252 offset:17600
v_mfma_f32_16x16x32_bf16 v[140:143],v[232:235],v[108:111],v[140:143]
v_mfma_f32_16x16x32_bf16 v[128:131],v[236:239],v[112:115],v[128:131]
v_mfma_f32_16x16x32_bf16 v[132:135],v[236:239],v[116:119],v[132:135]
buffer_load_dwordx4 v254,s[12:15],s31 offen offset:1536 nt lds
s_add_u32 s31,s31,16384
v_mfma_f32_16x16x32_bf16 v[136:139],v[236:239],v[120:123],v[136:139]
v_mfma_f32_16x16x32_bf16 v[140:143],v[236:239],v[124:127],v[140:143]
s_waitcnt lgkmcnt(2)
v_mfma_f32_16x16x32_bf16 v[144:147],v[208:211],v[0:3],v[192:195]
ds_read_b128 v[224:227],v252 offset:17664
v_mfma_f32_16x16x32_bf16 v[148:151],v[208:211],v[4:7],v[196:199]
v_mfma_f32_16x16x32_bf16 v[152:155],v[208:211],v[8:11],v[200:203]
ds_read_b128 v[228:231],v252 offset:17728
v_mfma_f32_16x16x32_bf16 v[156:159],v[208:211],v[12:15],v[204:207]
v_exp_f32 v248,v128
v_mfma_f32_16x16x32_bf16 v[144:147],v[212:215],v[16:19],v[144:147]
v_exp_f32 v249,v129
v_mfma_f32_16x16x32_bf16 v[148:151],v[212:215],v[20:23],v[148:151]
v_exp_f32 v250,v130
v_mfma_f32_16x16x32_bf16 v[152:155],v[212:215],v[24:27],v[152:155]
v_exp_f32 v251,v131
v_mfma_f32_16x16x32_bf16 v[156:159],v[212:215],v[28:31],v[156:159]
v_add_f32 v244,v248,v249
s_waitcnt lgkmcnt(2)
v_mfma_f32_16x16x32_bf16 v[144:147],v[216:219],v[32:35],v[144:147]
ds_read_b128 v[232:235],v252 offset:17792
v_cvt_pk_bf16_f32 v160,v248,v249
v_mfma_f32_16x16x32_bf16 v[148:151],v[216:219],v[36:39],v[148:151]
v_exp_f32 v248,v132
v_mfma_f32_16x16x32_bf16 v[152:155],v[216:219],v[40:43],v[152:155]
ds_read_b128 v[236:239],v252 offset:17856
v_add_f32 v244,v244,v250
v_mfma_f32_16x16x32_bf16 v[156:159],v[216:219],v[44:47],v[156:159]
v_exp_f32 v249,v133
v_mfma_f32_16x16x32_bf16 v[144:147],v[220:223],v[48:51],v[144:147]
v_add_f32 v244,v244,v251
v_cvt_pk_bf16_f32 v161,v250,v251
v_mfma_f32_16x16x32_bf16 v[148:151],v[220:223],v[52:55],v[148:151]
v_exp_f32 v250,v134
v_mfma_f32_16x16x32_bf16 v[152:155],v[220:223],v[56:59],v[152:155]
v_exp_f32 v251,v135
v_mfma_f32_16x16x32_bf16 v[156:159],v[220:223],v[60:63],v[156:159]
v_add_f32 v245,v248,v249
s_waitcnt lgkmcnt(2)
v_mfma_f32_16x16x32_bf16 v[144:147],v[224:227],v[64:67],v[144:147]
ds_read_b64_tr_b16 v[208:209],v253 offset:16896
v_subrev_u32 v252,s33,v252
v_mfma_f32_16x16x32_bf16 v[148:151],v[224:227],v[68:71],v[148:151]
ds_read_b64_tr_b16 v[210:211],v253 offset:17408
v_cvt_pk_bf16_f32 v164,v248,v249
v_mfma_f32_16x16x32_bf16 v[152:155],v[224:227],v[72:75],v[152:155]
ds_read_b64_tr_b16 v[212:213],v253 offset:16928
v_add_f32 v245,v245,v250
v_mfma_f32_16x16x32_bf16 v[156:159],v[224:227],v[76:79],v[156:159]
ds_read_b64_tr_b16 v[214:215],v253 offset:17440
v_add_f32 v245,v245,v251
v_mfma_f32_16x16x32_bf16 v[144:147],v[228:231],v[80:83],v[144:147]
v_exp_f32 v248,v136
v_mfma_f32_16x16x32_bf16 v[148:151],v[228:231],v[84:87],v[148:151]
v_exp_f32 v249,v137
v_mfma_f32_16x16x32_bf16 v[152:155],v[228:231],v[88:91],v[152:155]
v_cvt_pk_bf16_f32 v165,v250,v251
v_mfma_f32_16x16x32_bf16 v[156:159],v[228:231],v[92:95],v[156:159]
v_add_f32 v246,v248,v249
s_waitcnt lgkmcnt(4)
v_mfma_f32_16x16x32_bf16 v[144:147],v[232:235],v[96:99],v[144:147]
ds_read_b64_tr_b16 v[216:217],v253 offset:16960
v_cvt_pk_bf16_f32 v168,v248,v249
v_mfma_f32_16x16x32_bf16 v[148:151],v[232:235],v[100:103],v[148:151]
ds_read_b64_tr_b16 v[218:219],v253 offset:17472
v_mfma_f32_16x16x32_bf16 v[152:155],v[232:235],v[104:107],v[152:155]
ds_read_b64_tr_b16 v[220:221],v253 offset:16992
v_mfma_f32_16x16x32_bf16 v[156:159],v[232:235],v[108:111],v[156:159]
ds_read_b64_tr_b16 v[222:223],v253 offset:17504
v_mfma_f32_16x16x32_bf16 v[144:147],v[236:239],v[112:115],v[144:147]
s_add_u32 s34,s34,s33
s_sub_u32 s35,s35,s33
v_mfma_f32_16x16x32_bf16 v[148:151],v[236:239],v[116:119],v[148:151]
v_exp_f32 v250,v138
v_mfma_f32_16x16x32_bf16 v[152:155],v[236:239],v[120:123],v[152:155]
v_exp_f32 v251,v139
v_mfma_f32_16x16x32_bf16 v[156:159],v[236:239],v[124:127],v[156:159]
v_add_f32 v246,v246,v250
s_waitcnt lgkmcnt(4)
v_mfma_f32_16x16x32_bf16 a[0:3],v[208:211],v[176:179],a[0:3]
ds_read_b64_tr_b16 v[224:225],v253 offset:17024
v_add_f32 v246,v246,v251
v_mfma_f32_16x16x32_bf16 a[4:7],v[208:211],v[180:183],a[4:7]
ds_read_b64_tr_b16 v[226:227],v253 offset:17536
v_cvt_pk_bf16_f32 v169,v250,v251
v_mfma_f32_16x16x32_bf16 a[8:11],v[208:211],v[184:187],a[8:11]
ds_read_b64_tr_b16 v[228:229],v253 offset:17056
v_mfma_f32_16x16x32_bf16 a[12:15],v[208:211],v[188:191],a[12:15]
ds_read_b64_tr_b16 v[230:231],v253 offset:17568
v_mfma_f32_16x16x32_bf16 a[16:19],v[212:215],v[176:179],a[16:19]
v_exp_f32 v248,v140
v_mfma_f32_16x16x32_bf16 a[20:23],v[212:215],v[180:183],a[20:23]
v_exp_f32 v249,v141
v_mfma_f32_16x16x32_bf16 a[24:27],v[212:215],v[184:187],a[24:27]
v_exp_f32 v250,v142
v_mfma_f32_16x16x32_bf16 a[28:31],v[212:215],v[188:191],a[28:31]
v_add_f32 v247,v248,v249
s_waitcnt lgkmcnt(4)
v_mfma_f32_16x16x32_bf16 a[32:35],v[216:219],v[176:179],a[32:35]
ds_read_b64_tr_b16 v[232:233],v253 offset:17088
v_cvt_pk_bf16_f32 v172,v248,v249
v_mfma_f32_16x16x32_bf16 a[36:39],v[216:219],v[180:183],a[36:39]
ds_read_b64_tr_b16 v[234:235],v253 offset:17600
v_mfma_f32_16x16x32_bf16 a[40:43],v[216:219],v[184:187],a[40:43]
ds_read_b64_tr_b16 v[236:237],v253 offset:17120
v_mfma_f32_16x16x32_bf16 a[44:47],v[216:219],v[188:191],a[44:47]
ds_read_b64_tr_b16 v[238:239],v253 offset:17632
v_mfma_f32_16x16x32_bf16 a[48:51],v[220:223],v[176:179],a[48:51]
v_exp_f32 v251,v143
v_mfma_f32_16x16x32_bf16 a[52:55],v[220:223],v[180:183],a[52:55]
v_exp_f32 v248,v144
v_mfma_f32_16x16x32_bf16 a[56:59],v[220:223],v[184:187],a[56:59]
v_exp_f32 v249,v145
v_mfma_f32_16x16x32_bf16 a[60:63],v[220:223],v[188:191],a[60:63]
v_add_f32 v247,v247,v250
s_waitcnt lgkmcnt(4)
v_mfma_f32_16x16x32_bf16 a[64:67],v[224:227],v[176:179],a[64:67]
ds_read_b64_tr_b16 v[208:209],v253 offset:17152
v_add_f32 v247,v247,v251
v_mfma_f32_16x16x32_bf16 a[68:71],v[224:227],v[180:183],a[68:71]
ds_read_b64_tr_b16 v[210:211],v253 offset:17664
v_cvt_pk_bf16_f32 v173,v250,v251
v_mfma_f32_16x16x32_bf16 a[72:75],v[224:227],v[184:187],a[72:75]
ds_read_b64_tr_b16 v[212:213],v253 offset:17184
v_add_f32 v244,v244,v248
v_mfma_f32_16x16x32_bf16 a[76:79],v[224:227],v[188:191],a[76:79]
ds_read_b64_tr_b16 v[214:215],v253 offset:17696
v_add_f32 v244,v244,v249
v_mfma_f32_16x16x32_bf16 a[80:83],v[228:231],v[176:179],a[80:83]
v_exp_f32 v250,v146
v_mfma_f32_16x16x32_bf16 a[84:87],v[228:231],v[180:183],a[84:87]
v_exp_f32 v251,v147
v_mfma_f32_16x16x32_bf16 a[88:91],v[228:231],v[184:187],a[88:91]
v_cvt_pk_bf16_f32 v162,v248,v249
v_mfma_f32_16x16x32_bf16 a[92:95],v[228:231],v[188:191],a[92:95]
v_add_f32 v244,v244,v250
s_waitcnt lgkmcnt(4)
v_mfma_f32_16x16x32_bf16 a[96:99],v[232:235],v[176:179],a[96:99]
ds_read_b64_tr_b16 v[216:217],v253 offset:17216
v_add_f32 v244,v244,v251
v_mfma_f32_16x16x32_bf16 a[100:103],v[232:235],v[180:183],a[100:103]
ds_read_b64_tr_b16 v[218:219],v253 offset:17728
v_cvt_pk_bf16_f32 v163,v250,v251
v_mfma_f32_16x16x32_bf16 a[104:107],v[232:235],v[184:187],a[104:107]
ds_read_b64_tr_b16 v[220:221],v253 offset:17248
v_mfma_f32_16x16x32_bf16 a[108:111],v[232:235],v[188:191],a[108:111]
ds_read_b64_tr_b16 v[222:223],v253 offset:17760
v_mfma_f32_16x16x32_bf16 a[112:115],v[236:239],v[176:179],a[112:115]
v_exp_f32 v248,v148
v_mfma_f32_16x16x32_bf16 a[116:119],v[236:239],v[180:183],a[116:119]
v_exp_f32 v249,v149
v_mfma_f32_16x16x32_bf16 a[120:123],v[236:239],v[184:187],a[120:123]
v_exp_f32 v250,v150
v_mfma_f32_16x16x32_bf16 a[124:127],v[236:239],v[188:191],a[124:127]
v_add_f32 v245,v245,v248
s_waitcnt lgkmcnt(4)
v_mfma_f32_16x16x32_bf16 a[128:131],v[208:211],v[176:179],a[128:131]
ds_read_b64_tr_b16 v[224:225],v253 offset:17280
v_add_f32 v245,v245,v249
v_mfma_f32_16x16x32_bf16 a[132:135],v[208:211],v[180:183],a[132:135]
ds_read_b64_tr_b16 v[226:227],v253 offset:17792
v_cvt_pk_bf16_f32 v166,v248,v249
v_mfma_f32_16x16x32_bf16 a[136:139],v[208:211],v[184:187],a[136:139]
ds_read_b64_tr_b16 v[228:229],v253 offset:17312
v_mfma_f32_16x16x32_bf16 a[140:143],v[208:211],v[188:191],a[140:143]
ds_read_b64_tr_b16 v[230:231],v253 offset:17824
v_mfma_f32_16x16x32_bf16 a[144:147],v[212:215],v[176:179],a[144:147]
v_exp_f32 v251,v151
v_mfma_f32_16x16x32_bf16 a[148:151],v[212:215],v[180:183],a[148:151]
v_exp_f32 v248,v152
v_mfma_f32_16x16x32_bf16 a[152:155],v[212:215],v[184:187],a[152:155]
v_exp_f32 v249,v153
v_mfma_f32_16x16x32_bf16 a[156:159],v[212:215],v[188:191],a[156:159]
v_add_f32 v245,v245,v250
s_waitcnt lgkmcnt(4)
v_mfma_f32_16x16x32_bf16 a[160:163],v[216:219],v[176:179],a[160:163]
ds_read_b64_tr_b16 v[232:233],v253 offset:17344
v_add_f32 v245,v245,v251
v_mfma_f32_16x16x32_bf16 a[164:167],v[216:219],v[180:183],a[164:167]
ds_read_b64_tr_b16 v[234:235],v253 offset:17856
v_cvt_pk_bf16_f32 v167,v250,v251
v_mfma_f32_16x16x32_bf16 a[168:171],v[216:219],v[184:187],a[168:171]
ds_read_b64_tr_b16 v[236:237],v253 offset:17376
v_add_f32 v246,v246,v248
v_mfma_f32_16x16x32_bf16 a[172:175],v[216:219],v[188:191],a[172:175]
ds_read_b64_tr_b16 v[238:239],v253 offset:17888
v_add_f32 v246,v246,v249
v_mfma_f32_16x16x32_bf16 a[176:179],v[220:223],v[176:179],a[176:179]
v_add_u32 v253,s33,v253
s_sub_u32 s33,0,s33
v_mfma_f32_16x16x32_bf16 a[180:183],v[220:223],v[180:183],a[180:183]
s_sub_u32 s36,s36,1
v_cvt_pk_bf16_f32 v170,v248,v249
v_mfma_f32_16x16x32_bf16 a[184:187],v[220:223],v[184:187],a[184:187]
v_exp_f32 v250,v154
v_mfma_f32_16x16x32_bf16 a[188:191],v[220:223],v[188:191],a[188:191]
s_waitcnt lgkmcnt(4)
v_mfma_f32_16x16x32_bf16 a[192:195],v[224:227],v[176:179],a[192:195]
v_exp_f32 v251,v155
v_mfma_f32_16x16x32_bf16 a[196:199],v[224:227],v[180:183],a[196:199]
s_waitcnt vmcnt(16) lgkmcnt(0)
s_barrier
v_mfma_f32_16x16x32_bf16 a[200:203],v[224:227],v[184:187],a[200:203]
ds_read_b128 v[208:211],v252 offset:0
v_add_f32 v246,v246,v250
v_mfma_f32_16x16x32_bf16 a[204:207],v[224:227],v[188:191],a[204:207]
v_exp_f32 v248,v156
v_mfma_f32_16x16x32_bf16 a[208:211],v[228:231],v[176:179],a[208:211]
ds_read_b128 v[212:215],v252 offset:64
v_add_f32 v246,v246,v251
v_mfma_f32_16x16x32_bf16 a[212:215],v[228:231],v[180:183],a[212:215]
v_exp_f32 v249,v157
v_mfma_f32_16x16x32_bf16 a[216:219],v[228:231],v[184:187],a[216:219]
v_cvt_pk_bf16_f32 v171,v250,v251
v_mfma_f32_16x16x32_bf16 a[220:223],v[228:231],v[188:191],a[220:223]
v_exp_f32 v250,v158
v_mfma_f32_16x16x32_bf16 a[224:227],v[232:235],v[176:179],a[224:227]
ds_read_b128 v[216:219],v252 offset:128
v_add_f32 v247,v247,v248
v_mfma_f32_16x16x32_bf16 a[228:231],v[232:235],v[180:183],a[228:231]
v_exp_f32 v251,v159
v_mfma_f32_16x16x32_bf16 a[232:235],v[232:235],v[184:187],a[232:235]
ds_read_b128 v[220:223],v252 offset:192
v_add_f32 v247,v247,v249
v_mfma_f32_16x16x32_bf16 a[236:239],v[232:235],v[188:191],a[236:239]
v_cvt_pk_bf16_f32 v174,v248,v249
v_mfma_f32_16x16x32_bf16 a[240:243],v[236:239],v[176:179],a[240:243]
v_add_f32 v247,v247,v250
v_add_f32 v247,v247,v251
v_mfma_f32_16x16x32_bf16 a[244:247],v[236:239],v[180:183],a[244:247]
v_cvt_pk_bf16_f32 v175,v250,v251
v_max3_f32 v248,v244,v245,v246
v_mfma_f32_16x16x32_bf16 a[248:251],v[236:239],v[184:187],a[248:251]
s_cmp_lg_u32 s36,0
s_waitcnt lgkmcnt(2)
v_mfma_f32_16x16x32_bf16 a[252:255],v[236:239],v[188:191],a[252:255]
v_max_f32 v248,v248,v247
v_cmp_lt_f32 vcc,0x49800000,v248
s_cbranch_vccnz L_stub3
L_back3:
s_cbranch_scc1 L_aloop
s_cmp_lg_u32 s37,0
s_cbranch_scc1 L_last
v_mfma_f32_16x16x32_bf16 v[128:131],v[208:211],v[0:3],v[192:195]
ds_read_b128 v[224:227],v252 offset:256
s_add_u32 m0,s35,118272
v_mfma_f32_16x16x32_bf16 v[132:135],v[208:211],v[4:7],v[196:199]
buffer_load_dwordx4 v254,s[12:15],s31 offen offset:0 nt lds
s_add_u32 m0,m0,0x00000220
v_mfma_f32_16x16x32_bf16 v[136:139],v[208:211],v[8:11],v[200:203]
ds_read_b128 v[228:231],v252 offset:320
v_add_f32 v240,v240,v244
v_mfma_f32_16x16x32_bf16 v[140:143],v[208:211],v[12:15],v[204:207]
buffer_load_dwordx4 v254,s[12:15],s31 offen offset:512 nt lds
s_add_u32 m0,m0,0x00000220
v_mfma_f32_16x16x32_bf16 v[128:131],v[212:215],v[16:19],v[128:131]
v_add_f32 v241,v241,v245
v_add_f32 v242,v242,v246
v_mfma_f32_16x16x32_bf16 v[132:135],v[212:215],v[20:23],v[132:135]
buffer_load_dwordx4 v254,s[12:15],s31 offen offset:1024 nt lds
s_add_u32 m0,m0,0x00000220
v_mfma_f32_16x16x32_bf16 v[136:139],v[212:215],v[24:27],v[136:139]
v_add_f32 v243,v243,v247
v_mbcnt_lo_u32_b32 v249,-1,0
v_mfma_f32_16x16x32_bf16 v[140:143],v[212:215],v[28:31],v[140:143]
buffer_load_dwordx4 v254,s[12:15],s31 offen offset:1536 nt lds
s_waitcnt lgkmcnt(2)
v_mfma_f32_16x16x32_bf16 v[128:131],v[216:219],v[32:35],v[128:131]
ds_read_b128 v[232:235],v252 offset:384
s_add_u32 s31,s31,16384
v_mfma_f32_16x16x32_bf16 v[132:135],v[216:219],v[36:39],v[132:135]
v_mbcnt_hi_u32_b32 v249,-1,v249
v_min_u32 v249,39,v249
v_mfma_f32_16x16x32_bf16 v[136:139],v[216:219],v[40:43],v[136:139]
ds_read_b128 v[236:239],v252 offset:448
v_lshlrev_b32 v249,7,v249
v_mfma_f32_16x16x32_bf16 v[140:143],v[216:219],v[44:47],v[140:143]
s_lshl_b32 s58,s39,10
v_mfma_f32_16x16x32_bf16 v[128:131],v[220:223],v[48:51],v[128:131]
s_add_u32 s16,s44,s58
s_addc_u32 s17,s45,0
v_mfma_f32_16x16x32_bf16 v[132:135],v[220:223],v[52:55],v[132:135]
s_sub_u32 s18,3670016,s58
v_mbcnt_lo_u32_b32 v255,-1,0
v_mfma_f32_16x16x32_bf16 v[136:139],v[220:223],v[56:59],v[136:139]
v_mbcnt_hi_u32_b32 v255,-1,v255
v_lshrrev_b32 v250,3,v255
v_mfma_f32_16x16x32_bf16 v[140:143],v[220:223],v[60:63],v[140:143]
v_and_b32 v251,6,v250
s_waitcnt lgkmcnt(2)
v_mfma_f32_16x16x32_bf16 v[128:131],v[224:227],v[64:67],v[128:131]
ds_read_b128 v[208:211],v252 offset:512
v_xor_b32 v255,v255,v251
v_mfma_f32_16x16x32_bf16 v[132:135],v[224:227],v[68:71],v[132:135]
v_and_b32 v255,7,v255
s_lshl_b32 s60,s28,6
v_mfma_f32_16x16x32_bf16 v[136:139],v[224:227],v[72:75],v[136:139]
ds_read_b128 v[212:215],v252 offset:576
v_add_u32 v250,s60,v250
v_mfma_f32_16x16x32_bf16 v[140:143],v[224:227],v[76:79],v[140:143]
v_mul_u32_u24 v250,896,v250
v_lshl_add_u32 v255,v255,4,v250
v_mfma_f32_16x16x32_bf16 v[128:131],v[228:231],v[80:83],v[128:131]
v_mfma_f32_16x16x32_bf16 v[132:135],v[228:231],v[84:87],v[132:135]
v_mfma_f32_16x16x32_bf16 v[136:139],v[228:231],v[88:91],v[136:139]
v_mfma_f32_16x16x32_bf16 v[140:143],v[228:231],v[92:95],v[140:143]
s_waitcnt lgkmcnt(2)
v_mfma_f32_16x16x32_bf16 v[128:131],v[232:235],v[96:99],v[128:131]
ds_read_b128 v[216:219],v252 offset:640
v_mfma_f32_16x16x32_bf16 v[132:135],v[232:235],v[100:103],v[132:135]
v_mfma_f32_16x16x32_bf16 v[136:139],v[232:235],v[104:107],v[136:139]
ds_read_b128 v[220:223],v252 offset:704
v_mfma_f32_16x16x32_bf16 v[140:143],v[232:235],v[108:111],v[140:143]
v_mfma_f32_16x16x32_bf16 v[128:131],v[236:239],v[112:115],v[128:131]
s_add_u32 m0,s29,16896
s_nop 0
v_mfma_f32_16x16x32_bf16 v[132:135],v[236:239],v[116:119],v[132:135]
buffer_load_dword v249,s[24:27],s38 offen offset:0 lds
v_mbcnt_lo_u32_b32 v254,-1,0
v_mfma_f32_16x16x32_bf16 v[136:139],v[236:239],v[120:123],v[136:139]
v_mbcnt_hi_u32_b32 v254,-1,v254
v_lshrrev_b32 v248,5,v254
v_mfma_f32_16x16x32_bf16 v[140:143],v[236:239],v[124:127],v[140:143]
v_and_b32 v254,31,v254
s_waitcnt lgkmcnt(2)
v_lshlrev_b32 v248,15,v248
v_lshl_add_u32 v254,v254,4,v248
v_mfma_f32_16x16x32_bf16 v[144:147],v[208:211],v[0:3],v[192:195]
ds_read_b128 v[224:227],v252 offset:768
s_add_u32 m0,s29,16896
v_mfma_f32_16x16x32_bf16 v[148:151],v[208:211],v[4:7],v[196:199]
buffer_load_dwordx4 v254,s[16:19],s0 offen lds
s_add_u32 m0,m0,0x00000428
v_mfma_f32_16x16x32_bf16 v[152:155],v[208:211],v[8:11],v[200:203]
ds_read_b128 v[228:231],v252 offset:832
buffer_load_dwordx4 v254,s[16:19],s1 offen lds
v_mfma_f32_16x16x32_bf16 v[156:159],v[208:211],v[12:15],v[204:207]
s_add_u32 m0,m0,0x00000418
v_mfma_f32_16x16x32_bf16 v[144:147],v[212:215],v[16:19],v[144:147]
buffer_load_dwordx4 v254,s[16:19],s2 offen lds
s_add_u32 m0,m0,0x00000428
v_mfma_f32_16x16x32_bf16 v[148:151],v[212:215],v[20:23],v[148:151]
buffer_load_dwordx4 v254,s[16:19],s3 offen lds
v_mfma_f32_16x16x32_bf16 v[152:155],v[212:215],v[24:27],v[152:155]
s_add_u32 s16,s16,262144
s_addc_u32 s17,s17,0
v_mfma_f32_16x16x32_bf16 v[156:159],v[212:215],v[28:31],v[156:159]
s_sub_u32 s18,s18,262144
s_waitcnt lgkmcnt(2)
v_mfma_f32_16x16x32_bf16 v[144:147],v[216:219],v[32:35],v[144:147]
ds_read_b128 v[232:235],v252 offset:896
v_mfma_f32_16x16x32_bf16 v[148:151],v[216:219],v[36:39],v[148:151]
v_exp_f32 v248,v128
v_mfma_f32_16x16x32_bf16 v[152:155],v[216:219],v[40:43],v[152:155]
ds_read_b128 v[236:239],v252 offset:960
v_mfma_f32_16x16x32_bf16 v[156:159],v[216:219],v[44:47],v[156:159]
v_exp_f32 v249,v129
v_mfma_f32_16x16x32_bf16 v[144:147],v[220:223],v[48:51],v[144:147]
v_exp_f32 v250,v130
v_mfma_f32_16x16x32_bf16 v[148:151],v[220:223],v[52:55],v[148:151]
v_exp_f32 v251,v131
v_mfma_f32_16x16x32_bf16 v[152:155],v[220:223],v[56:59],v[152:155]
v_add_f32 v244,v248,v249
v_cvt_pk_bf16_f32 v176,v248,v249
v_mfma_f32_16x16x32_bf16 v[156:159],v[220:223],v[60:63],v[156:159]
v_add_f32 v244,v244,v250
s_waitcnt lgkmcnt(2)
v_mfma_f32_16x16x32_bf16 v[144:147],v[224:227],v[64:67],v[144:147]
ds_read_b64_tr_b16 v[208:209],v253 offset:0
v_add_f32 v244,v244,v251
v_mfma_f32_16x16x32_bf16 v[148:151],v[224:227],v[68:71],v[148:151]
ds_read_b64_tr_b16 v[210:211],v253 offset:512
v_cvt_pk_bf16_f32 v177,v250,v251
v_mfma_f32_16x16x32_bf16 v[152:155],v[224:227],v[72:75],v[152:155]
ds_read_b64_tr_b16 v[212:213],v253 offset:32
v_mfma_f32_16x16x32_bf16 v[156:159],v[224:227],v[76:79],v[156:159]
ds_read_b64_tr_b16 v[214:215],v253 offset:544
v_mfma_f32_16x16x32_bf16 v[144:147],v[228:231],v[80:83],v[144:147]
v_exp_f32 v248,v132
v_mfma_f32_16x16x32_bf16 v[148:151],v[228:231],v[84:87],v[148:151]
v_exp_f32 v249,v133
v_mfma_f32_16x16x32_bf16 v[152:155],v[228:231],v[88:91],v[152:155]
v_exp_f32 v250,v134
v_mfma_f32_16x16x32_bf16 v[156:159],v[228:231],v[92:95],v[156:159]
v_add_f32 v245,v248,v249
s_waitcnt lgkmcnt(4)
v_mfma_f32_16x16x32_bf16 v[144:147],v[232:235],v[96:99],v[144:147]
ds_read_b64_tr_b16 v[216:217],v253 offset:64
v_cvt_pk_bf16_f32 v180,v248,v249
v_mfma_f32_16x16x32_bf16 v[148:151],v[232:235],v[100:103],v[148:151]
ds_read_b64_tr_b16 v[218:219],v253 offset:576
v_mfma_f32_16x16x32_bf16 v[152:155],v[232:235],v[104:107],v[152:155]
ds_read_b64_tr_b16 v[220:221],v253 offset:96
v_mfma_f32_16x16x32_bf16 v[156:159],v[232:235],v[108:111],v[156:159]
ds_read_b64_tr_b16 v[222:223],v253 offset:608
v_mfma_f32_16x16x32_bf16 v[144:147],v[236:239],v[112:115],v[144:147]
v_exp_f32 v251,v135
v_mfma_f32_16x16x32_bf16 v[148:151],v[236:239],v[116:119],v[148:151]
v_exp_f32 v248,v136
v_mfma_f32_16x16x32_bf16 v[152:155],v[236:239],v[120:123],v[152:155]
v_exp_f32 v249,v137
v_mfma_f32_16x16x32_bf16 v[156:159],v[236:239],v[124:127],v[156:159]
v_add_f32 v245,v245,v250
s_waitcnt lgkmcnt(4)
v_mfma_f32_16x16x32_bf16 a[0:3],v[208:211],v[160:163],a[0:3]
ds_read_b64_tr_b16 v[224:225],v253 offset:128
v_add_f32 v245,v245,v251
v_mfma_f32_16x16x32_bf16 a[4:7],v[208:211],v[164:167],a[4:7]
ds_read_b64_tr_b16 v[226:227],v253 offset:640
v_cvt_pk_bf16_f32 v181,v250,v251
v_mfma_f32_16x16x32_bf16 a[8:11],v[208:211],v[168:171],a[8:11]
ds_read_b64_tr_b16 v[228:229],v253 offset:160
v_add_f32 v246,v248,v249
v_mfma_f32_16x16x32_bf16 a[12:15],v[208:211],v[172:175],a[12:15]
ds_read_b64_tr_b16 v[230:231],v253 offset:672
v_cvt_pk_bf16_f32 v184,v248,v249
v_mfma_f32_16x16x32_bf16 a[16:19],v[212:215],v[160:163],a[16:19]
v_exp_f32 v250,v138
v_mfma_f32_16x16x32_bf16 a[20:23],v[212:215],v[164:167],a[20:23]
v_exp_f32 v251,v139
v_mfma_f32_16x16x32_bf16 a[24:27],v[212:215],v[168:171],a[24:27]
v_exp_f32 v248,v140
v_mfma_f32_16x16x32_bf16 a[28:31],v[212:215],v[172:175],a[28:31]
v_add_f32 v246,v246,v250
s_waitcnt lgkmcnt(4)
v_mfma_f32_16x16x32_bf16 a[32:35],v[216:219],v[160:163],a[32:35]
ds_read_b64_tr_b16 v[232:233],v253 offset:192
v_add_f32 v246,v246,v251
v_mfma_f32_16x16x32_bf16 a[36:39],v[216:219],v[164:167],a[36:39]
ds_read_b64_tr_b16 v[234:235],v253 offset:704
v_cvt_pk_bf16_f32 v185,v250,v251
v_mfma_f32_16x16x32_bf16 a[40:43],v[216:219],v[168:171],a[40:43]
ds_read_b64_tr_b16 v[236:237],v253 offset:224
v_mfma_f32_16x16x32_bf16 a[44:47],v[216:219],v[172:175],a[44:47]
ds_read_b64_tr_b16 v[238:239],v253 offset:736
v_mfma_f32_16x16x32_bf16 a[48:51],v[220:223],v[160:163],a[48:51]
v_exp_f32 v249,v141
v_mfma_f32_16x16x32_bf16 a[52:55],v[220:223],v[164:167],a[52:55]
v_exp_f32 v250,v142
v_mfma_f32_16x16x32_bf16 a[56:59],v[220:223],v[168:171],a[56:59]
v_exp_f32 v251,v143
v_mfma_f32_16x16x32_bf16 a[60:63],v[220:223],v[172:175],a[60:63]
v_add_f32 v247,v248,v249
s_waitcnt lgkmcnt(4)
v_mfma_f32_16x16x32_bf16 a[64:67],v[224:227],v[160:163],a[64:67]
ds_read_b64_tr_b16 v[208:209],v253 offset:256
v_cvt_pk_bf16_f32 v188,v248,v249
v_mfma_f32_16x16x32_bf16 a[68:71],v[224:227],v[164:167],a[68:71]
ds_read_b64_tr_b16 v[210:211],v253 offset:768
v_add_f32 v247,v247,v250
v_mfma_f32_16x16x32_bf16 a[72:75],v[224:227],v[168:171],a[72:75]
ds_read_b64_tr_b16 v[212:213],v253 offset:288
v_add_f32 v247,v247,v251
v_mfma_f32_16x16x32_bf16 a[76:79],v[224:227],v[172:175],a[76:79]
ds_read_b64_tr_b16 v[214:215],v253 offset:800
v_cvt_pk_bf16_f32 v189,v250,v251
v_mfma_f32_16x16x32_bf16 a[80:83],v[228:231],v[160:163],a[80:83]
v_exp_f32 v248,v144
v_mfma_f32_16x16x32_bf16 a[84:87],v[228:231],v[164:167],a[84:87]
v_exp_f32 v249,v145
v_mfma_f32_16x16x32_bf16 a[88:91],v[228:231],v[168:171],a[88:91]
v_exp_f32 v250,v146
v_mfma_f32_16x16x32_bf16 a[92:95],v[228:231],v[172:175],a[92:95]
v_add_f32 v244,v244,v248
s_waitcnt lgkmcnt(4)
v_mfma_f32_16x16x32_bf16 a[96:99],v[232:235],v[160:163],a[96:99]
ds_read_b64_tr_b16 v[216:217],v253 offset:320
v_add_f32 v244,v244,v249
v_mfma_f32_16x16x32_bf16 a[100:103],v[232:235],v[164:167],a[100:103]
ds_read_b64_tr_b16 v[218:219],v253 offset:832
v_cvt_pk_bf16_f32 v178,v248,v249
v_mfma_f32_16x16x32_bf16 a[104:107],v[232:235],v[168:171],a[104:107]
ds_read_b64_tr_b16 v[220:221],v253 offset:352
v_mfma_f32_16x16x32_bf16 a[108:111],v[232:235],v[172:175],a[108:111]
ds_read_b64_tr_b16 v[222:223],v253 offset:864
v_mfma_f32_16x16x32_bf16 a[112:115],v[236:239],v[160:163],a[112:115]
v_exp_f32 v251,v147
v_mfma_f32_16x16x32_bf16 a[116:119],v[236:239],v[164:167],a[116:119]
v_exp_f32 v248,v148
v_mfma_f32_16x16x32_bf16 a[120:123],v[236:239],v[168:171],a[120:123]
v_exp_f32 v249,v149
v_mfma_f32_16x16x32_bf16 a[124:127],v[236:239],v[172:175],a[124:127]
v_add_f32 v244,v244,v250
s_waitcnt lgkmcnt(4)
v_mfma_f32_16x16x32_bf16 a[128:131],v[208:211],v[160:163],a[128:131]
ds_read_b64_tr_b16 v[224:225],v253 offset:384
v_add_f32 v244,v244,v251
v_mfma_f32_16x16x32_bf16 a[132:135],v[208:211],v[164:167],a[132:135]
ds_read_b64_tr_b16 v[226:227],v253 offset:896
v_cvt_pk_bf16_f32 v179,v250,v251
v_mfma_f32_16x16x32_bf16 a[136:139],v[208:211],v[168:171],a[136:139]
ds_read_b64_tr_b16 v[228:229],v253 offset:416
v_add_f32 v245,v245,v248
v_mfma_f32_16x16x32_bf16 a[140:143],v[208:211],v[172:175],a[140:143]
ds_read_b64_tr_b16 v[230:231],v253 offset:928
v_add_f32 v245,v245,v249
v_mfma_f32_16x16x32_bf16 a[144:147],v[212:215],v[160:163],a[144:147]
v_exp_f32 v250,v150
v_mfma_f32_16x16x32_bf16 a[148:151],v[212:215],v[164:167],a[148:151]
v_exp_f32 v251,v151
v_mfma_f32_16x16x32_bf16 a[152:155],v[212:215],v[168:171],a[152:155]
v_cvt_pk_bf16_f32 v182,v248,v249
v_mfma_f32_16x16x32_bf16 a[156:159],v[212:215],v[172:175],a[156:159]
v_add_f32 v245,v245,v250
s_waitcnt lgkmcnt(4)
v_mfma_f32_16x16x32_bf16 a[160:163],v[216:219],v[160:163],a[160:163]
ds_read_b64_tr_b16 v[232:233],v253 offset:448
v_add_f32 v245,v245,v251
v_mfma_f32_16x16x32_bf16 a[164:167],v[216:219],v[164:167],a[164:167]
ds_read_b64_tr_b16 v[234:235],v253 offset:960
v_cvt_pk_bf16_f32 v183,v250,v251
v_mfma_f32_16x16x32_bf16 a[168:171],v[216:219],v[168:171],a[168:171]
ds_read_b64_tr_b16 v[236:237],v253 offset:480
v_mfma_f32_16x16x32_bf16 a[172:175],v[216:219],v[172:175],a[172:175]
ds_read_b64_tr_b16 v[238:239],v253 offset:992
v_mfma_f32_16x16x32_bf16 a[176:179],v[220:223],v[160:163],a[176:179]
v_exp_f32 v248,v152
v_mfma_f32_16x16x32_bf16 a[180:183],v[220:223],v[164:167],a[180:183]
v_exp_f32 v249,v153
v_mfma_f32_16x16x32_bf16 a[184:187],v[220:223],v[168:171],a[184:187]
v_exp_f32 v250,v154
v_mfma_f32_16x16x32_bf16 a[188:191],v[220:223],v[172:175],a[188:191]
v_add_f32 v246,v246,v248
s_waitcnt lgkmcnt(4)
v_mfma_f32_16x16x32_bf16 a[192:195],v[224:227],v[160:163],a[192:195]
v_exp_f32 v251,v155
v_mfma_f32_16x16x32_bf16 a[196:199],v[224:227],v[164:167],a[196:199]
s_waitcnt vmcnt(17) lgkmcnt(0)
s_barrier
v_mfma_f32_16x16x32_bf16 a[200:203],v[224:227],v[168:171],a[200:203]
ds_read_b128 v[208:211],v252 offset:16896
v_add_f32 v246,v246,v249
v_mfma_f32_16x16x32_bf16 a[204:207],v[224:227],v[172:175],a[204:207]
v_cvt_pk_bf16_f32 v186,v248,v249
v_mfma_f32_16x16x32_bf16 a[208:211],v[228:231],v[160:163],a[208:211]
ds_read_b128 v[212:215],v252 offset:16960
v_add_f32 v246,v246,v250
v_mfma_f32_16x16x32_bf16 a[212:215],v[228:231],v[164:167],a[212:215]
v_exp_f32 v248,v156
v_mfma_f32_16x16x32_bf16 a[216:219],v[228:231],v[168:171],a[216:219]
v_exp_f32 v249,v157
v_mfma_f32_16x16x32_bf16 a[220:223],v[228:231],v[172:175],a[220:223]
v_add_f32 v246,v246,v251
v_cvt_pk_bf16_f32 v187,v250,v251
v_mfma_f32_16x16x32_bf16 a[224:227],v[232:235],v[160:163],a[224:227]
ds_read_b128 v[216:219],v252 offset:17024
v_add_f32 v247,v247,v248
v_mfma_f32_16x16x32_bf16 a[228:231],v[232:235],v[164:167],a[228:231]
v_exp_f32 v250,v158
v_mfma_f32_16x16x32_bf16 a[232:235],v[232:235],v[168:171],a[232:235]
ds_read_b128 v[220:223],v252 offset:17088
v_add_f32 v247,v247,v249
v_mfma_f32_16x16x32_bf16 a[236:239],v[232:235],v[172:175],a[236:239]
v_exp_f32 v251,v159
v_mfma_f32_16x16x32_bf16 a[240:243],v[236:239],v[160:163],a[240:243]
v_cvt_pk_bf16_f32 v190,v248,v249
v_mfma_f32_16x16x32_bf16 a[244:247],v[236:239],v[164:167],a[244:247]
v_add_f32 v247,v247,v250
v_add_f32 v247,v247,v251
v_mfma_f32_16x16x32_bf16 a[248:251],v[236:239],v[168:171],a[248:251]
v_cvt_pk_bf16_f32 v191,v250,v251
s_waitcnt lgkmcnt(2)
v_mfma_f32_16x16x32_bf16 a[252:255],v[236:239],v[172:175],a[252:255]
v_max3_f32 v248,v244,v245,v246
v_max_f32 v248,v248,v247
v_cmp_lt_f32 vcc,0x49800000,v248
s_cbranch_vccnz L_stub4
L_back4:
v_mfma_f32_16x16x32_bf16 v[128:131],v[208:211],v[0:3],v[192:195]
ds_read_b128 v[224:227],v252 offset:17152
s_add_u32 m0,s29,67584
v_mfma_f32_16x16x32_bf16 v[132:135],v[208:211],v[4:7],v[196:199]
buffer_load_dwordx4 v255,s[4:7],s68 offen offset:0 lds
s_add_u32 m0,m0,0x00000400
v_mfma_f32_16x16x32_bf16 v[136:139],v[208:211],v[8:11],v[200:203]
ds_read_b128 v[228:231],v252 offset:17216
v_add_f32 v240,v240,v244
v_mfma_f32_16x16x32_bf16 v[140:143],v[208:211],v[12:15],v[204:207]
v_add_f32 v241,v241,v245
v_add_f32 v242,v242,v246
v_mfma_f32_16x16x32_bf16 v[128:131],v[212:215],v[16:19],v[128:131]
v_add_f32 v243,v243,v247
v_mfma_f32_16x16x32_bf16 v[132:135],v[212:215],v[20:23],v[132:135]
buffer_load_dwordx4 v255,s[4:7],s93 offen offset:0 lds
s_add_u32 m0,m0,0x00000400
v_mfma_f32_16x16x32_bf16 v[136:139],v[212:215],v[24:27],v[136:139]
v_mfma_f32_16x16x32_bf16 v[140:143],v[212:215],v[28:31],v[140:143]
s_waitcnt lgkmcnt(2)
v_mfma_f32_16x16x32_bf16 v[128:131],v[216:219],v[32:35],v[128:131]
ds_read_b128 v[232:235],v252 offset:17280
v_mfma_f32_16x16x32_bf16 v[132:135],v[216:219],v[36:39],v[132:135]
buffer_load_dwordx4 v255,s[4:7],s94 offen offset:0 lds
s_add_u32 m0,m0,0x00000400
v_mfma_f32_16x16x32_bf16 v[136:139],v[216:219],v[40:43],v[136:139]
ds_read_b128 v[236:239],v252 offset:17344
v_mfma_f32_16x16x32_bf16 v[140:143],v[216:219],v[44:47],v[140:143]
v_mfma_f32_16x16x32_bf16 v[128:131],v[220:223],v[48:51],v[128:131]
v_mfma_f32_16x16x32_bf16 v[132:135],v[220:223],v[52:55],v[132:135]
buffer_load_dwordx4 v255,s[4:7],s95 offen offset:0 lds
v_mfma_f32_16x16x32_bf16 v[136:139],v[220:223],v[56:59],v[136:139]
v_mfma_f32_16x16x32_bf16 v[140:143],v[220:223],v[60:63],v[140:143]
s_waitcnt lgkmcnt(2)
v_mfma_f32_16x16x32_bf16 v[128:131],v[224:227],v[64:67],v[128:131]
ds_read_b128 v[208:211],v252 offset:17408
v_mfma_f32_16x16x32_bf16 v[132:135],v[224:227],v[68:71],v[132:135]
v_mfma_f32_16x16x32_bf16 v[136:139],v[224:227],v[72:75],v[136:139]
ds_read_b128 v[212:215],v252 offset:17472
v_mfma_f32_16x16x32_bf16 v[140:143],v[224:227],v[76:79],v[140:143]
v_mfma_f32_16x16x32_bf16 v[128:131],v[228:231],v[80:83],v[128:131]
v_mfma_f32_16x16x32_bf16 v[132:135],v[228:231],v[84:87],v[132:135]
v_mfma_f32_16x16x32_bf16 v[136:139],v[228:231],v[88:91],v[136:139]
v_mfma_f32_16x16x32_bf16 v[140:143],v[228:231],v[92:95],v[140:143]
s_waitcnt lgkmcnt(2)
v_mfma_f32_16x16x32_bf16 v[128:131],v[232:235],v[96:99],v[128:131]
ds_read_b128 v[216:219],v252 offset:17536
v_mfma_f32_16x16x32_bf16 v[132:135],v[232:235],v[100:103],v[132:135]
v_mfma_f32_16x16x32_bf16 v[136:139],v[232:235],v[104:107],v[136:139]
ds_read_b128 v[220:223],v252 offset:17600
v_mfma_f32_16x16x32_bf16 v[140:143],v[232:235],v[108:111],v[140:143]
v_mfma_f32_16x16x32_bf16 v[128:131],v[236:239],v[112:115],v[128:131]
v_mfma_f32_16x16x32_bf16 v[132:135],v[236:239],v[116:119],v[132:135]
v_mfma_f32_16x16x32_bf16 v[136:139],v[236:239],v[120:123],v[136:139]
v_mfma_f32_16x16x32_bf16 v[140:143],v[236:239],v[124:127],v[140:143]
s_waitcnt lgkmcnt(2)
v_mfma_f32_16x16x32_bf16 v[144:147],v[208:211],v[0:3],v[192:195]
ds_read_b128 v[224:227],v252 offset:17664
v_mfma_f32_16x16x32_bf16 v[148:151],v[208:211],v[4:7],v[196:199]
v_mfma_f32_16x16x32_bf16 v[152:155],v[208:211],v[8:11],v[200:203]
ds_read_b128 v[228:231],v252 offset:17728
v_mfma_f32_16x16x32_bf16 v[156:159],v[208:211],v[12:15],v[204:207]
v_exp_f32 v248,v128
v_mfma_f32_16x16x32_bf16 v[144:147],v[212:215],v[16:19],v[144:147]
v_exp_f32 v249,v129
v_mfma_f32_16x16x32_bf16 v[148:151],v[212:215],v[20:23],v[148:151]
v_exp_f32 v250,v130
v_mfma_f32_16x16x32_bf16 v[152:155],v[212:215],v[24:27],v[152:155]
v_exp_f32 v251,v131
v_mfma_f32_16x16x32_bf16 v[156:159],v[212:215],v[28:31],v[156:159]
v_add_f32 v244,v248,v249
s_waitcnt lgkmcnt(2)
v_mfma_f32_16x16x32_bf16 v[144:147],v[216:219],v[32:35],v[144:147]
ds_read_b128 v[232:235],v252 offset:17792
v_cvt_pk_bf16_f32 v160,v248,v249
v_mfma_f32_16x16x32_bf16 v[148:151],v[216:219],v[36:39],v[148:151]
v_exp_f32 v248,v132
v_mfma_f32_16x16x32_bf16 v[152:155],v[216:219],v[40:43],v[152:155]
ds_read_b128 v[236:239],v252 offset:17856
v_add_f32 v244,v244,v250
v_mfma_f32_16x16x32_bf16 v[156:159],v[216:219],v[44:47],v[156:159]
v_exp_f32 v249,v133
v_mfma_f32_16x16x32_bf16 v[144:147],v[220:223],v[48:51],v[144:147]
v_add_f32 v244,v244,v251
v_cvt_pk_bf16_f32 v161,v250,v251
v_mfma_f32_16x16x32_bf16 v[148:151],v[220:223],v[52:55],v[148:151]
v_exp_f32 v250,v134
v_mfma_f32_16x16x32_bf16 v[152:155],v[220:223],v[56:59],v[152:155]
v_exp_f32 v251,v135
v_mfma_f32_16x16x32_bf16 v[156:159],v[220:223],v[60:63],v[156:159]
v_add_f32 v245,v248,v249
s_waitcnt lgkmcnt(2)
v_mfma_f32_16x16x32_bf16 v[144:147],v[224:227],v[64:67],v[144:147]
ds_read_b64_tr_b16 v[208:209],v253 offset:16896
v_subrev_u32 v252,s33,v252
v_mfma_f32_16x16x32_bf16 v[148:151],v[224:227],v[68:71],v[148:151]
ds_read_b64_tr_b16 v[210:211],v253 offset:17408
v_cvt_pk_bf16_f32 v164,v248,v249
v_mfma_f32_16x16x32_bf16 v[152:155],v[224:227],v[72:75],v[152:155]
ds_read_b64_tr_b16 v[212:213],v253 offset:16928
v_add_f32 v245,v245,v250
v_mfma_f32_16x16x32_bf16 v[156:159],v[224:227],v[76:79],v[156:159]
ds_read_b64_tr_b16 v[214:215],v253 offset:17440
v_add_f32 v245,v245,v251
v_mfma_f32_16x16x32_bf16 v[144:147],v[228:231],v[80:83],v[144:147]
v_exp_f32 v248,v136
v_mfma_f32_16x16x32_bf16 v[148:151],v[228:231],v[84:87],v[148:151]
v_exp_f32 v249,v137
v_mfma_f32_16x16x32_bf16 v[152:155],v[228:231],v[88:91],v[152:155]
v_cvt_pk_bf16_f32 v165,v250,v251
v_mfma_f32_16x16x32_bf16 v[156:159],v[228:231],v[92:95],v[156:159]
v_add_f32 v246,v248,v249
s_waitcnt lgkmcnt(4)
v_mfma_f32_16x16x32_bf16 v[144:147],v[232:235],v[96:99],v[144:147]
ds_read_b64_tr_b16 v[216:217],v253 offset:16960
v_cvt_pk_bf16_f32 v168,v248,v249
v_mfma_f32_16x16x32_bf16 v[148:151],v[232:235],v[100:103],v[148:151]
ds_read_b64_tr_b16 v[218:219],v253 offset:17472
v_mfma_f32_16x16x32_bf16 v[152:155],v[232:235],v[104:107],v[152:155]
ds_read_b64_tr_b16 v[220:221],v253 offset:16992
v_mfma_f32_16x16x32_bf16 v[156:159],v[232:235],v[108:111],v[156:159]
ds_read_b64_tr_b16 v[222:223],v253 offset:17504
v_mfma_f32_16x16x32_bf16 v[144:147],v[236:239],v[112:115],v[144:147]
s_add_u32 s34,s34,s33
s_sub_u32 s35,s35,s33
v_mfma_f32_16x16x32_bf16 v[148:151],v[236:239],v[116:119],v[148:151]
v_exp_f32 v250,v138
v_mfma_f32_16x16x32_bf16 v[152:155],v[236:239],v[120:123],v[152:155]
v_exp_f32 v251,v139
v_mfma_f32_16x16x32_bf16 v[156:159],v[236:239],v[124:127],v[156:159]
v_add_f32 v246,v246,v250
s_waitcnt lgkmcnt(4)
v_mfma_f32_16x16x32_bf16 a[0:3],v[208:211],v[176:179],a[0:3]
ds_read_b64_tr_b16 v[224:225],v253 offset:17024
v_add_f32 v246,v246,v251
v_mfma_f32_16x16x32_bf16 a[4:7],v[208:211],v[180:183],a[4:7]
ds_read_b64_tr_b16 v[226:227],v253 offset:17536
v_cvt_pk_bf16_f32 v169,v250,v251
v_mfma_f32_16x16x32_bf16 a[8:11],v[208:211],v[184:187],a[8:11]
ds_read_b64_tr_b16 v[228:229],v253 offset:17056
v_mfma_f32_16x16x32_bf16 a[12:15],v[208:211],v[188:191],a[12:15]
ds_read_b64_tr_b16 v[230:231],v253 offset:17568
v_mfma_f32_16x16x32_bf16 a[16:19],v[212:215],v[176:179],a[16:19]
v_exp_f32 v248,v140
v_mfma_f32_16x16x32_bf16 a[20:23],v[212:215],v[180:183],a[20:23]
v_exp_f32 v249,v141
v_mfma_f32_16x16x32_bf16 a[24:27],v[212:215],v[184:187],a[24:27]
v_exp_f32 v250,v142
v_mfma_f32_16x16x32_bf16 a[28:31],v[212:215],v[188:191],a[28:31]
v_add_f32 v247,v248,v249
s_waitcnt lgkmcnt(4)
v_mfma_f32_16x16x32_bf16 a[32:35],v[216:219],v[176:179],a[32:35]
ds_read_b64_tr_b16 v[232:233],v253 offset:17088
v_cvt_pk_bf16_f32 v172,v248,v249
v_mfma_f32_16x16x32_bf16 a[36:39],v[216:219],v[180:183],a[36:39]
ds_read_b64_tr_b16 v[234:235],v253 offset:17600
v_mfma_f32_16x16x32_bf16 a[40:43],v[216:219],v[184:187],a[40:43]
ds_read_b64_tr_b16 v[236:237],v253 offset:17120
v_mfma_f32_16x16x32_bf16 a[44:47],v[216:219],v[188:191],a[44:47]
ds_read_b64_tr_b16 v[238:239],v253 offset:17632
v_mfma_f32_16x16x32_bf16 a[48:51],v[220:223],v[176:179],a[48:51]
v_exp_f32 v251,v143
v_mfma_f32_16x16x32_bf16 a[52:55],v[220:223],v[180:183],a[52:55]
v_exp_f32 v248,v144
v_mfma_f32_16x16x32_bf16 a[56:59],v[220:223],v[184:187],a[56:59]
v_exp_f32 v249,v145
v_mfma_f32_16x16x32_bf16 a[60:63],v[220:223],v[188:191],a[60:63]
v_add_f32 v247,v247,v250
s_waitcnt lgkmcnt(4)
v_mfma_f32_16x16x32_bf16 a[64:67],v[224:227],v[176:179],a[64:67]
ds_read_b64_tr_b16 v[208:209],v253 offset:17152
v_add_f32 v247,v247,v251
v_mfma_f32_16x16x32_bf16 a[68:71],v[224:227],v[180:183],a[68:71]
ds_read_b64_tr_b16 v[210:211],v253 offset:17664
v_cvt_pk_bf16_f32 v173,v250,v251
v_mfma_f32_16x16x32_bf16 a[72:75],v[224:227],v[184:187],a[72:75]
ds_read_b64_tr_b16 v[212:213],v253 offset:17184
v_add_f32 v244,v244,v248
v_mfma_f32_16x16x32_bf16 a[76:79],v[224:227],v[188:191],a[76:79]
ds_read_b64_tr_b16 v[214:215],v253 offset:17696
v_add_f32 v244,v244,v249
v_mfma_f32_16x16x32_bf16 a[80:83],v[228:231],v[176:179],a[80:83]
v_exp_f32 v250,v146
v_mfma_f32_16x16x32_bf16 a[84:87],v[228:231],v[180:183],a[84:87]
v_exp_f32 v251,v147
v_mfma_f32_16x16x32_bf16 a[88:91],v[228:231],v[184:187],a[88:91]
v_cvt_pk_bf16_f32 v162,v248,v249
v_mfma_f32_16x16x32_bf16 a[92:95],v[228:231],v[188:191],a[92:95]
v_add_f32 v244,v244,v250
s_waitcnt lgkmcnt(4)
v_mfma_f32_16x16x32_bf16 a[96:99],v[232:235],v[176:179],a[96:99]
ds_read_b64_tr_b16 v[216:217],v253 offset:17216
v_add_f32 v244,v244,v251
v_mfma_f32_16x16x32_bf16 a[100:103],v[232:235],v[180:183],a[100:103]
ds_read_b64_tr_b16 v[218:219],v253 offset:17728
v_cvt_pk_bf16_f32 v163,v250,v251
v_mfma_f32_16x16x32_bf16 a[104:107],v[232:235],v[184:187],a[104:107]
ds_read_b64_tr_b16 v[220:221],v253 offset:17248
v_mfma_f32_16x16x32_bf16 a[108:111],v[232:235],v[188:191],a[108:111]
ds_read_b64_tr_b16 v[222:223],v253 offset:17760
v_mfma_f32_16x16x32_bf16 a[112:115],v[236:239],v[176:179],a[112:115]
v_exp_f32 v248,v148
v_mfma_f32_16x16x32_bf16 a[116:119],v[236:239],v[180:183],a[116:119]
v_exp_f32 v249,v149
v_mfma_f32_16x16x32_bf16 a[120:123],v[236:239],v[184:187],a[120:123]
v_exp_f32 v250,v150
v_mfma_f32_16x16x32_bf16 a[124:127],v[236:239],v[188:191],a[124:127]
v_add_f32 v245,v245,v248
s_waitcnt lgkmcnt(4)
v_mfma_f32_16x16x32_bf16 a[128:131],v[208:211],v[176:179],a[128:131]
ds_read_b64_tr_b16 v[224:225],v253 offset:17280
v_add_f32 v245,v245,v249
v_mfma_f32_16x16x32_bf16 a[132:135],v[208:211],v[180:183],a[132:135]
ds_read_b64_tr_b16 v[226:227],v253 offset:17792
v_cvt_pk_bf16_f32 v166,v248,v249
v_mfma_f32_16x16x32_bf16 a[136:139],v[208:211],v[184:187],a[136:139]
ds_read_b64_tr_b16 v[228:229],v253 offset:17312
v_mfma_f32_16x16x32_bf16 a[140:143],v[208:211],v[188:191],a[140:143]
ds_read_b64_tr_b16 v[230:231],v253 offset:17824
v_mfma_f32_16x16x32_bf16 a[144:147],v[212:215],v[176:179],a[144:147]
v_exp_f32 v251,v151
v_mfma_f32_16x16x32_bf16 a[148:151],v[212:215],v[180:183],a[148:151]
v_exp_f32 v248,v152
v_mfma_f32_16x16x32_bf16 a[152:155],v[212:215],v[184:187],a[152:155]
v_exp_f32 v249,v153
v_mfma_f32_16x16x32_bf16 a[156:159],v[212:215],v[188:191],a[156:159]
v_add_f32 v245,v245,v250
s_waitcnt lgkmcnt(4)
v_mfma_f32_16x16x32_bf16 a[160:163],v[216:219],v[176:179],a[160:163]
ds_read_b64_tr_b16 v[232:233],v253 offset:17344
v_add_f32 v245,v245,v251
v_mfma_f32_16x16x32_bf16 a[164:167],v[216:219],v[180:183],a[164:167]
ds_read_b64_tr_b16 v[234:235],v253 offset:17856
v_cvt_pk_bf16_f32 v167,v250,v251
v_mfma_f32_16x16x32_bf16 a[168:171],v[216:219],v[184:187],a[168:171]
ds_read_b64_tr_b16 v[236:237],v253 offset:17376
v_add_f32 v246,v246,v248
v_mfma_f32_16x16x32_bf16 a[172:175],v[216:219],v[188:191],a[172:175]
ds_read_b64_tr_b16 v[238:239],v253 offset:17888
v_add_f32 v246,v246,v249
v_mfma_f32_16x16x32_bf16 a[176:179],v[220:223],v[176:179],a[176:179]
v_add_u32 v253,s33,v253
s_sub_u32 s33,0,s33
v_mfma_f32_16x16x32_bf16 a[180:183],v[220:223],v[180:183],a[180:183]
v_exp_f32 v250,v154
v_mfma_f32_16x16x32_bf16 a[184:187],v[220:223],v[184:187],a[184:187]
v_exp_f32 v251,v155
v_mfma_f32_16x16x32_bf16 a[188:191],v[220:223],v[188:191],a[188:191]
v_cvt_pk_bf16_f32 v170,v248,v249
s_waitcnt lgkmcnt(4)
v_mfma_f32_16x16x32_bf16 a[192:195],v[224:227],v[176:179],a[192:195]
v_exp_f32 v248,v156
v_mfma_f32_16x16x32_bf16 a[196:199],v[224:227],v[180:183],a[196:199]
s_waitcnt vmcnt(13) lgkmcnt(0)
s_barrier
v_mfma_f32_16x16x32_bf16 a[200:203],v[224:227],v[184:187],a[200:203]
ds_read_b128 v[208:211],v252 offset:0
v_add_f32 v246,v246,v250
v_mfma_f32_16x16x32_bf16 a[204:207],v[224:227],v[188:191],a[204:207]
v_exp_f32 v249,v157
v_mfma_f32_16x16x32_bf16 a[208:211],v[228:231],v[176:179],a[208:211]
ds_read_b128 v[212:215],v252 offset:64
v_add_f32 v246,v246,v251
v_mfma_f32_16x16x32_bf16 a[212:215],v[228:231],v[180:183],a[212:215]
v_cvt_pk_bf16_f32 v171,v250,v251
v_mfma_f32_16x16x32_bf16 a[216:219],v[228:231],v[184:187],a[216:219]
v_exp_f32 v250,v158
v_mfma_f32_16x16x32_bf16 a[220:223],v[228:231],v[188:191],a[220:223]
v_exp_f32 v251,v159
v_mfma_f32_16x16x32_bf16 a[224:227],v[232:235],v[176:179],a[224:227]
ds_read_b128 v[216:219],v252 offset:128
v_add_f32 v247,v247,v248
v_mfma_f32_16x16x32_bf16 a[228:231],v[232:235],v[180:183],a[228:231]
v_add_f32 v247,v247,v249
v_cvt_pk_bf16_f32 v174,v248,v249
v_mfma_f32_16x16x32_bf16 a[232:235],v[232:235],v[184:187],a[232:235]
ds_read_b128 v[220:223],v252 offset:192
v_add_f32 v247,v247,v250
v_mfma_f32_16x16x32_bf16 a[236:239],v[232:235],v[188:191],a[236:239]
v_add_f32 v247,v247,v251
v_cvt_pk_bf16_f32 v175,v250,v251
v_mfma_f32_16x16x32_bf16 a[240:243],v[236:239],v[176:179],a[240:243]
v_max3_f32 v248,v244,v245,v246
v_max_f32 v248,v248,v247
v_mfma_f32_16x16x32_bf16 a[244:247],v[236:239],v[180:183],a[244:247]
v_cmp_lt_f32 vcc,0x49800000,v248
v_mfma_f32_16x16x32_bf16 a[248:251],v[236:239],v[184:187],a[248:251]
s_waitcnt lgkmcnt(2)
v_mfma_f32_16x16x32_bf16 a[252:255],v[236:239],v[188:191],a[252:255]
s_cbranch_vccnz L_stub5
L_back5:
v_mfma_f32_16x16x32_bf16 v[128:131],v[208:211],v[0:3],v[192:195]
ds_read_b128 v[224:227],v252 offset:256
s_add_u32 m0,s29,84480
v_mfma_f32_16x16x32_bf16 v[132:135],v[208:211],v[4:7],v[196:199]
buffer_load_dwordx4 v255,s[4:7],s96 offen offset:0 lds
s_add_u32 m0,m0,0x00000400
v_mfma_f32_16x16x32_bf16 v[136:139],v[208:211],v[8:11],v[200:203]
ds_read_b128 v[228:231],v252 offset:320
v_add_f32 v240,v240,v244
v_mfma_f32_16x16x32_bf16 v[140:143],v[208:211],v[12:15],v[204:207]
v_add_f32 v241,v241,v245
v_add_f32 v242,v242,v246
v_mfma_f32_16x16x32_bf16 v[128:131],v[212:215],v[16:19],v[128:131]
v_add_f32 v243,v243,v247
v_mfma_f32_16x16x32_bf16 v[132:135],v[212:215],v[20:23],v[132:135]
buffer_load_dwordx4 v255,s[4:7],s97 offen offset:0 lds
s_add_u32 m0,m0,0x00000400
v_mfma_f32_16x16x32_bf16 v[136:139],v[212:215],v[24:27],v[136:139]
v_mfma_f32_16x16x32_bf16 v[140:143],v[212:215],v[28:31],v[140:143]
s_waitcnt lgkmcnt(2)
v_mfma_f32_16x16x32_bf16 v[128:131],v[216:219],v[32:35],v[128:131]
ds_read_b128 v[232:235],v252 offset:384
v_mfma_f32_16x16x32_bf16 v[132:135],v[216:219],v[36:39],v[132:135]
buffer_load_dwordx4 v255,s[4:7],s98 offen offset:0 lds
s_add_u32 m0,m0,0x00000400
v_mfma_f32_16x16x32_bf16 v[136:139],v[216:219],v[40:43],v[136:139]
ds_read_b128 v[236:239],v252 offset:448
v_mfma_f32_16x16x32_bf16 v[140:143],v[216:219],v[44:47],v[140:143]
v_mfma_f32_16x16x32_bf16 v[128:131],v[220:223],v[48:51],v[128:131]
v_mfma_f32_16x16x32_bf16 v[132:135],v[220:223],v[52:55],v[132:135]
buffer_load_dwordx4 v255,s[4:7],s99 offen offset:0 lds
v_mfma_f32_16x16x32_bf16 v[136:139],v[220:223],v[56:59],v[136:139]
v_mfma_f32_16x16x32_bf16 v[140:143],v[220:223],v[60:63],v[140:143]
s_waitcnt lgkmcnt(2)
v_mfma_f32_16x16x32_bf16 v[128:131],v[224:227],v[64:67],v[128:131]
ds_read_b128 v[208:211],v252 offset:512
v_mfma_f32_16x16x32_bf16 v[132:135],v[224:227],v[68:71],v[132:135]
v_mfma_f32_16x16x32_bf16 v[136:139],v[224:227],v[72:75],v[136:139]
ds_read_b128 v[212:215],v252 offset:576
v_mfma_f32_16x16x32_bf16 v[140:143],v[224:227],v[76:79],v[140:143]
v_mfma_f32_16x16x32_bf16 v[128:131],v[228:231],v[80:83],v[128:131]
v_mfma_f32_16x16x32_bf16 v[132:135],v[228:231],v[84:87],v[132:135]
v_mfma_f32_16x16x32_bf16 v[136:139],v[228:231],v[88:91],v[136:139]
v_mfma_f32_16x16x32_bf16 v[140:143],v[228:231],v[92:95],v[140:143]
s_waitcnt lgkmcnt(2)
v_mfma_f32_16x16x32_bf16 v[128:131],v[232:235],v[96:99],v[128:131]
ds_read_b128 v[216:219],v252 offset:640
v_mfma_f32_16x16x32_bf16 v[132:135],v[232:235],v[100:103],v[132:135]
v_mfma_f32_16x16x32_bf16 v[136:139],v[232:235],v[104:107],v[136:139]
ds_read_b128 v[220:223],v252 offset:704
v_mfma_f32_16x16x32_bf16 v[140:143],v[232:235],v[108:111],v[140:143]
v_mfma_f32_16x16x32_bf16 v[128:131],v[236:239],v[112:115],v[128:131]
v_mfma_f32_16x16x32_bf16 v[132:135],v[236:239],v[116:119],v[132:135]
v_mfma_f32_16x16x32_bf16 v[136:139],v[236:239],v[120:123],v[136:139]
v_mfma_f32_16x16x32_bf16 v[140:143],v[236:239],v[124:127],v[140:143]
s_waitcnt lgkmcnt(2)
v_mfma_f32_16x16x32_bf16 v[144:147],v[208:211],v[0:3],v[192:195]
ds_read_b128 v[224:227],v252 offset:768
v_mfma_f32_16x16x32_bf16 v[148:151],v[208:211],v[4:7],v[196:199]
v_mfma_f32_16x16x32_bf16 v[152:155],v[208:211],v[8:11],v[200:203]
ds_read_b128 v[228:231],v252 offset:832
v_mfma_f32_16x16x32_bf16 v[156:159],v[208:211],v[12:15],v[204:207]
v_exp_f32 v248,v128
v_mfma_f32_16x16x32_bf16 v[144:147],v[212:215],v[16:19],v[144:147]
v_exp_f32 v249,v129
v_mfma_f32_16x16x32_bf16 v[148:151],v[212:215],v[20:23],v[148:151]
v_exp_f32 v250,v130
v_mfma_f32_16x16x32_bf16 v[152:155],v[212:215],v[24:27],v[152:155]
v_exp_f32 v251,v131
v_mfma_f32_16x16x32_bf16 v[156:159],v[212:215],v[28:31],v[156:159]
v_add_f32 v244,v248,v249
s_waitcnt lgkmcnt(2)
v_mfma_f32_16x16x32_bf16 v[144:147],v[216:219],v[32:35],v[144:147]
ds_read_b128 v[232:235],v252 offset:896
v_cvt_pk_bf16_f32 v176,v248,v249
v_mfma_f32_16x16x32_bf16 v[148:151],v[216:219],v[36:39],v[148:151]
v_exp_f32 v248,v132
v_mfma_f32_16x16x32_bf16 v[152:155],v[216:219],v[40:43],v[152:155]
ds_read_b128 v[236:239],v252 offset:960
v_add_f32 v244,v244,v250
v_mfma_f32_16x16x32_bf16 v[156:159],v[216:219],v[44:47],v[156:159]
v_exp_f32 v249,v133
v_mfma_f32_16x16x32_bf16 v[144:147],v[220:223],v[48:51],v[144:147]
v_add_f32 v244,v244,v251
v_cvt_pk_bf16_f32 v177,v250,v251
v_mfma_f32_16x16x32_bf16 v[148:151],v[220:223],v[52:55],v[148:151]
v_exp_f32 v250,v134
v_mfma_f32_16x16x32_bf16 v[152:155],v[220:223],v[56:59],v[152:155]
v_exp_f32 v251,v135
v_mfma_f32_16x16x32_bf16 v[156:159],v[220:223],v[60:63],v[156:159]
v_add_f32 v245,v248,v249
s_waitcnt lgkmcnt(2)
v_mfma_f32_16x16x32_bf16 v[144:147],v[224:227],v[64:67],v[144:147]
ds_read_b64_tr_b16 v[208:209],v253 offset:0
v_cvt_pk_bf16_f32 v180,v248,v249
v_mfma_f32_16x16x32_bf16 v[148:151],v[224:227],v[68:71],v[148:151]
ds_read_b64_tr_b16 v[210:211],v253 offset:512
v_add_f32 v245,v245,v250
v_mfma_f32_16x16x32_bf16 v[152:155],v[224:227],v[72:75],v[152:155]
ds_read_b64_tr_b16 v[212:213],v253 offset:32
v_add_f32 v245,v245,v251
v_mfma_f32_16x16x32_bf16 v[156:159],v[224:227],v[76:79],v[156:159]
ds_read_b64_tr_b16 v[214:215],v253 offset:544
v_cvt_pk_bf16_f32 v181,v250,v251
v_mfma_f32_16x16x32_bf16 v[144:147],v[228:231],v[80:83],v[144:147]
v_exp_f32 v248,v136
v_mfma_f32_16x16x32_bf16 v[148:151],v[228:231],v[84:87],v[148:151]
v_exp_f32 v249,v137
v_mfma_f32_16x16x32_bf16 v[152:155],v[228:231],v[88:91],v[152:155]
v_exp_f32 v250,v138
v_mfma_f32_16x16x32_bf16 v[156:159],v[228:231],v[92:95],v[156:159]
v_add_f32 v246,v248,v249
s_waitcnt lgkmcnt(4)
v_mfma_f32_16x16x32_bf16 v[144:147],v[232:235],v[96:99],v[144:147]
ds_read_b64_tr_b16 v[216:217],v253 offset:64
v_cvt_pk_bf16_f32 v184,v248,v249
v_mfma_f32_16x16x32_bf16 v[148:151],v[232:235],v[100:103],v[148:151]
ds_read_b64_tr_b16 v[218:219],v253 offset:576
v_mfma_f32_16x16x32_bf16 v[152:155],v[232:235],v[104:107],v[152:155]
ds_read_b64_tr_b16 v[220:221],v253 offset:96
v_mfma_f32_16x16x32_bf16 v[156:159],v[232:235],v[108:111],v[156:159]
ds_read_b64_tr_b16 v[222:223],v253 offset:608
v_mfma_f32_16x16x32_bf16 v[144:147],v[236:239],v[112:115],v[144:147]
v_exp_f32 v251,v139
v_mfma_f32_16x16x32_bf16 v[148:151],v[236:239],v[116:119],v[148:151]
v_exp_f32 v248,v140
v_mfma_f32_16x16x32_bf16 v[152:155],v[236:239],v[120:123],v[152:155]
v_exp_f32 v249,v141
v_mfma_f32_16x16x32_bf16 v[156:159],v[236:239],v[124:127],v[156:159]
v_add_f32 v246,v246,v250
s_waitcnt lgkmcnt(4)
v_mfma_f32_16x16x32_bf16 a[0:3],v[208:211],v[160:163],a[0:3]
ds_read_b64_tr_b16 v[224:225],v253 offset:128
v_add_f32 v246,v246,v251
v_mfma_f32_16x16x32_bf16 a[4:7],v[208:211],v[164:167],a[4:7]
ds_read_b64_tr_b16 v[226:227],v253 offset:640
v_cvt_pk_bf16_f32 v185,v250,v251
v_mfma_f32_16x16x32_bf16 a[8:11],v[208:211],v[168:171],a[8:11]
ds_read_b64_tr_b16 v[228:229],v253 offset:160
v_add_f32 v247,v248,v249
v_mfma_f32_16x16x32_bf16 a[12:15],v[208:211],v[172:175],a[12:15]
ds_read_b64_tr_b16 v[230:231],v253 offset:672
v_cvt_pk_bf16_f32 v188,v248,v249
v_mfma_f32_16x16x32_bf16 a[16:19],v[212:215],v[160:163],a[16:19]
v_exp_f32 v250,v142
v_mfma_f32_16x16x32_bf16 a[20:23],v[212:215],v[164:167],a[20:23]
v_exp_f32 v251,v143
v_mfma_f32_16x16x32_bf16 a[24:27],v[212:215],v[168:171],a[24:27]
v_exp_f32 v248,v144
v_mfma_f32_16x16x32_bf16 a[28:31],v[212:215],v[172:175],a[28:31]
v_add_f32 v247,v247,v250
s_waitcnt lgkmcnt(4)
v_mfma_f32_16x16x32_bf16 a[32:35],v[216:219],v[160:163],a[32:35]
ds_read_b64_tr_b16 v[232:233],v253 offset:192
v_add_f32 v247,v247,v251
v_mfma_f32_16x16x32_bf16 a[36:39],v[216:219],v[164:167],a[36:39]
ds_read_b64_tr_b16 v[234:235],v253 offset:704
v_cvt_pk_bf16_f32 v189,v250,v251
v_mfma_f32_16x16x32_bf16 a[40:43],v[216:219],v[168:171],a[40:43]
ds_read_b64_tr_b16 v[236:237],v253 offset:224
v_mfma_f32_16x16x32_bf16 a[44:47],v[216:219],v[172:175],a[44:47]
ds_read_b64_tr_b16 v[238:239],v253 offset:736
v_mfma_f32_16x16x32_bf16 a[48:51],v[220:223],v[160:163],a[48:51]
v_exp_f32 v249,v145
v_mfma_f32_16x16x32_bf16 a[52:55],v[220:223],v[164:167],a[52:55]
v_exp_f32 v250,v146
v_mfma_f32_16x16x32_bf16 a[56:59],v[220:223],v[168:171],a[56:59]
v_exp_f32 v251,v147
v_mfma_f32_16x16x32_bf16 a[60:63],v[220:223],v[172:175],a[60:63]
v_add_f32 v244,v244,v248
s_waitcnt lgkmcnt(4)
v_mfma_f32_16x16x32_bf16 a[64:67],v[224:227],v[160:163],a[64:67]
ds_read_b64_tr_b16 v[208:209],v253 offset:256
v_add_f32 v244,v244,v249
v_mfma_f32_16x16x32_bf16 a[68:71],v[224:227],v[164:167],a[68:71]
ds_read_b64_tr_b16 v[210:211],v253 offset:768
v_cvt_pk_bf16_f32 v178,v248,v249
v_mfma_f32_16x16x32_bf16 a[72:75],v[224:227],v[168:171],a[72:75]
ds_read_b64_tr_b16 v[212:213],v253 offset:288
v_add_f32 v244,v244,v250
v_mfma_f32_16x16x32_bf16 a[76:79],v[224:227],v[172:175],a[76:79]
ds_read_b64_tr_b16 v[214:215],v253 offset:800
v_add_f32 v244,v244,v251
v_mfma_f32_16x16x32_bf16 a[80:83],v[228:231],v[160:163],a[80:83]
v_exp_f32 v248,v148
v_mfma_f32_16x16x32_bf16 a[84:87],v[228:231],v[164:167],a[84:87]
v_exp_f32 v249,v149
v_mfma_f32_16x16x32_bf16 a[88:91],v[228:231],v[168:171],a[88:91]
v_cvt_pk_bf16_f32 v179,v250,v251
v_mfma_f32_16x16x32_bf16 a[92:95],v[228:231],v[172:175],a[92:95]
v_add_f32 v245,v245,v248
s_waitcnt lgkmcnt(4)
v_mfma_f32_16x16x32_bf16 a[96:99],v[232:235],v[160:163],a[96:99]
ds_read_b64_tr_b16 v[216:217],v253 offset:320
v_add_f32 v245,v245,v249
v_mfma_f32_16x16x32_bf16 a[100:103],v[232:235],v[164:167],a[100:103]
ds_read_b64_tr_b16 v[218:219],v253 offset:832
v_cvt_pk_bf16_f32 v182,v248,v249
v_mfma_f32_16x16x32_bf16 a[104:107],v[232:235],v[168:171],a[104:107]
ds_read_b64_tr_b16 v[220:221],v253 offset:352
v_mfma_f32_16x16x32_bf16 a[108:111],v[232:235],v[172:175],a[108:111]
ds_read_b64_tr_b16 v[222:223],v253 offset:864
v_mfma_f32_16x16x32_bf16 a[112:115],v[236:239],v[160:163],a[112:115]
v_exp_f32 v250,v150
v_mfma_f32_16x16x32_bf16 a[116:119],v[236:239],v[164:167],a[116:119]
v_exp_f32 v251,v151
v_mfma_f32_16x16x32_bf16 a[120:123],v[236:239],v[168:171],a[120:123]
v_exp_f32 v248,v152
v_mfma_f32_16x16x32_bf16 a[124:127],v[236:239],v[172:175],a[124:127]
v_add_f32 v245,v245,v250
s_waitcnt lgkmcnt(4)
v_mfma_f32_16x16x32_bf16 a[128:131],v[208:211],v[160:163],a[128:131]
ds_read_b64_tr_b16 v[224:225],v253 offset:384
v_add_f32 v245,v245,v251
v_mfma_f32_16x16x32_bf16 a[132:135],v[208:211],v[164:167],a[132:135]
ds_read_b64_tr_b16 v[226:227],v253 offset:896
v_cvt_pk_bf16_f32 v183,v250,v251
v_mfma_f32_16x16x32_bf16 a[136:139],v[208:211],v[168:171],a[136:139]
ds_read_b64_tr_b16 v[228:229],v253 offset:416
v_mfma_f32_16x16x32_bf16 a[140:143],v[208:211],v[172:175],a[140:143]
ds_read_b64_tr_b16 v[230:231],v253 offset:928
v_mfma_f32_16x16x32_bf16 a[144:147],v[212:215],v[160:163],a[144:147]
v_exp_f32 v249,v153
v_mfma_f32_16x16x32_bf16 a[148:151],v[212:215],v[164:167],a[148:151]
v_exp_f32 v250,v154
v_mfma_f32_16x16x32_bf16 a[152:155],v[212:215],v[168:171],a[152:155]
v_exp_f32 v251,v155
v_mfma_f32_16x16x32_bf16 a[156:159],v[212:215],v[172:175],a[156:159]
v_add_f32 v246,v246,v248
s_waitcnt lgkmcnt(4)
v_mfma_f32_16x16x32_bf16 a[160:163],v[216:219],v[160:163],a[160:163]
ds_read_b64_tr_b16 v[232:233],v253 offset:448
v_add_f32 v246,v246,v249
v_mfma_f32_16x16x32_bf16 a[164:167],v[216:219],v[164:167],a[164:167]
ds_read_b64_tr_b16 v[234:235],v253 offset:960
v_cvt_pk_bf16_f32 v186,v248,v249
v_mfma_f32_16x16x32_bf16 a[168:171],v[216:219],v[168:171],a[168:171]
ds_read_b64_tr_b16 v[236:237],v253 offset:480
v_add_f32 v246,v246,v250
v_mfma_f32_16x16x32_bf16 a[172:175],v[216:219],v[172:175],a[172:175]
ds_read_b64_tr_b16 v[238:239],v253 offset:992
v_add_f32 v246,v246,v251
v_mfma_f32_16x16x32_bf16 a[176:179],v[220:223],v[160:163],a[176:179]
v_exp_f32 v248,v156
v_mfma_f32_16x16x32_bf16 a[180:183],v[220:223],v[164:167],a[180:183]
v_exp_f32 v249,v157
v_mfma_f32_16x16x32_bf16 a[184:187],v[220:223],v[168:171],a[184:187]
v_cvt_pk_bf16_f32 v187,v250,v251
v_mfma_f32_16x16x32_bf16 a[188:191],v[220:223],v[172:175],a[188:191]
v_add_f32 v247,v247,v248
s_waitcnt lgkmcnt(4)
v_mfma_f32_16x16x32_bf16 a[192:195],v[224:227],v[160:163],a[192:195]
v_exp_f32 v250,v158
v_mfma_f32_16x16x32_bf16 a[196:199],v[224:227],v[164:167],a[196:199]
s_waitcnt vmcnt(13) lgkmcnt(0)
s_barrier
v_mfma_f32_16x16x32_bf16 a[200:203],v[224:227],v[168:171],a[200:203]
ds_read_b64_tr_b16 v[208:209],v253 offset:16896
v_add_f32 v247,v247,v249
v_mfma_f32_16x16x32_bf16 a[204:207],v[224:227],v[172:175],a[204:207]
ds_read_b64_tr_b16 v[210:211],v253 offset:17408
v_cvt_pk_bf16_f32 v190,v248,v249
v_mfma_f32_16x16x32_bf16 a[208:211],v[228:231],v[160:163],a[208:211]
ds_read_b64_tr_b16 v[212:213],v253 offset:16928
v_mfma_f32_16x16x32_bf16 a[212:215],v[228:231],v[164:167],a[212:215]
ds_read_b64_tr_b16 v[214:215],v253 offset:17440
v_mfma_f32_16x16x32_bf16 a[216:219],v[228:231],v[168:171],a[216:219]
v_exp_f32 v251,v159
v_mfma_f32_16x16x32_bf16 a[220:223],v[228:231],v[172:175],a[220:223]
v_add_f32 v247,v247,v250
v_add_f32 v247,v247,v251
v_mfma_f32_16x16x32_bf16 a[224:227],v[232:235],v[160:163],a[224:227]
ds_read_b64_tr_b16 v[216:217],v253 offset:16960
v_cvt_pk_bf16_f32 v191,v250,v251
v_mfma_f32_16x16x32_bf16 a[228:231],v[232:235],v[164:167],a[228:231]
ds_read_b64_tr_b16 v[218:219],v253 offset:17472
v_max3_f32 v248,v244,v245,v246
v_mfma_f32_16x16x32_bf16 a[232:235],v[232:235],v[168:171],a[232:235]
ds_read_b64_tr_b16 v[220:221],v253 offset:16992
v_max_f32 v248,v248,v247
v_mfma_f32_16x16x32_bf16 a[236:239],v[232:235],v[172:175],a[236:239]
ds_read_b64_tr_b16 v[222:223],v253 offset:17504
v_cmp_lt_f32 vcc,0x49800000,v248
v_mfma_f32_16x16x32_bf16 a[240:243],v[236:239],v[160:163],a[240:243]
v_mfma_f32_16x16x32_bf16 a[244:247],v[236:239],v[164:167],a[244:247]
v_mfma_f32_16x16x32_bf16 a[248:251],v[236:239],v[168:171],a[248:251]
s_waitcnt lgkmcnt(4)
v_mfma_f32_16x16x32_bf16 a[252:255],v[236:239],v[172:175],a[252:255]
s_cbranch_vccnz L_stub6
L_back6:
v_mfma_f32_16x16x32_bf16 a[0:3],v[208:211],v[176:179],a[0:3]
ds_read_b64_tr_b16 v[224:225],v253 offset:17024
s_add_u32 m0,s29,0
v_mfma_f32_16x16x32_bf16 a[4:7],v[208:211],v[180:183],a[4:7]
ds_read_b64_tr_b16 v[226:227],v253 offset:17536
buffer_load_dwordx4 v254,s[16:19],s0 offen lds
v_mfma_f32_16x16x32_bf16 a[8:11],v[208:211],v[184:187],a[8:11]
ds_read_b64_tr_b16 v[228:229],v253 offset:17056
s_add_u32 m0,m0,0x00000428
v_mfma_f32_16x16x32_bf16 a[12:15],v[208:211],v[188:191],a[12:15]
ds_read_b64_tr_b16 v[230:231],v253 offset:17568
v_add_f32 v240,v240,v244
v_mfma_f32_16x16x32_bf16 a[16:19],v[212:215],v[176:179],a[16:19]
v_add_f32 v241,v241,v245
v_add_f32 v242,v242,v246
v_mfma_f32_16x16x32_bf16 a[20:23],v[212:215],v[180:183],a[20:23]
buffer_load_dwordx4 v254,s[16:19],s1 offen lds
s_add_u32 m0,m0,0x00000418
v_mfma_f32_16x16x32_bf16 a[24:27],v[212:215],v[184:187],a[24:27]
v_add_f32 v243,v243,v247
v_mov_b32 v244,v240
v_mfma_f32_16x16x32_bf16 a[28:31],v[212:215],v[188:191],a[28:31]
v_mov_b32 v245,v241
s_waitcnt lgkmcnt(4)
v_mfma_f32_16x16x32_bf16 a[32:35],v[216:219],v[176:179],a[32:35]
ds_read_b64_tr_b16 v[232:233],v253 offset:17088
v_mov_b32 v246,v242
v_mfma_f32_16x16x32_bf16 a[36:39],v[216:219],v[180:183],a[36:39]
ds_read_b64_tr_b16 v[234:235],v253 offset:17600
buffer_load_dwordx4 v254,s[16:19],s2 offen lds
v_mfma_f32_16x16x32_bf16 a[40:43],v[216:219],v[184:187],a[40:43]
ds_read_b64_tr_b16 v[236:237],v253 offset:17120
s_add_u32 m0,m0,0x00000428
v_mfma_f32_16x16x32_bf16 a[44:47],v[216:219],v[188:191],a[44:47]
ds_read_b64_tr_b16 v[238:239],v253 offset:17632
v_mov_b32 v247,v243
v_mfma_f32_16x16x32_bf16 a[48:51],v[220:223],v[176:179],a[48:51]
v_permlane32_swap_b32 v244,v240
v_permlane32_swap_b32 v245,v241
v_mfma_f32_16x16x32_bf16 a[52:55],v[220:223],v[180:183],a[52:55]
buffer_load_dwordx4 v254,s[16:19],s3 offen lds
v_permlane32_swap_b32 v246,v242
v_mfma_f32_16x16x32_bf16 a[56:59],v[220:223],v[184:187],a[56:59]
s_add_u32 s16,s16,262144
s_addc_u32 s17,s17,0
v_mfma_f32_16x16x32_bf16 a[60:63],v[220:223],v[188:191],a[60:63]
s_sub_u32 s18,s18,262144
s_waitcnt lgkmcnt(4)
v_mfma_f32_16x16x32_bf16 a[64:67],v[224:227],v[176:179],a[64:67]
ds_read_b64_tr_b16 v[208:209],v253 offset:17152
v_permlane32_swap_b32 v247,v243
v_mfma_f32_16x16x32_bf16 a[68:71],v[224:227],v[180:183],a[68:71]
ds_read_b64_tr_b16 v[210:211],v253 offset:17664
v_add_f32 v240,v244,v240
v_mfma_f32_16x16x32_bf16 a[72:75],v[224:227],v[184:187],a[72:75]
ds_read_b64_tr_b16 v[212:213],v253 offset:17184
v_add_f32 v241,v245,v241
v_mfma_f32_16x16x32_bf16 a[76:79],v[224:227],v[188:191],a[76:79]
ds_read_b64_tr_b16 v[214:215],v253 offset:17696
v_add_f32 v242,v246,v242
v_mfma_f32_16x16x32_bf16 a[80:83],v[228:231],v[176:179],a[80:83]
v_add_f32 v243,v247,v243
v_mov_b32 v244,v240
v_mfma_f32_16x16x32_bf16 a[84:87],v[228:231],v[180:183],a[84:87]
v_mov_b32 v245,v241
v_mov_b32 v246,v242
v_mfma_f32_16x16x32_bf16 a[88:91],v[228:231],v[184:187],a[88:91]
v_mov_b32 v247,v243
v_permlane16_swap_b32 v244,v240
v_mfma_f32_16x16x32_bf16 a[92:95],v[228:231],v[188:191],a[92:95]
v_permlane16_swap_b32 v245,v241
s_waitcnt lgkmcnt(4)
v_mfma_f32_16x16x32_bf16 a[96:99],v[232:235],v[176:179],a[96:99]
ds_read_b64_tr_b16 v[216:217],v253 offset:17216
v_permlane16_swap_b32 v246,v242
v_mfma_f32_16x16x32_bf16 a[100:103],v[232:235],v[180:183],a[100:103]
ds_read_b64_tr_b16 v[218:219],v253 offset:17728
v_permlane16_swap_b32 v247,v243
v_mfma_f32_16x16x32_bf16 a[104:107],v[232:235],v[184:187],a[104:107]
ds_read_b64_tr_b16 v[220:221],v253 offset:17248
v_add_f32 v240,v244,v240
v_mfma_f32_16x16x32_bf16 a[108:111],v[232:235],v[188:191],a[108:111]
ds_read_b64_tr_b16 v[222:223],v253 offset:17760
v_add_f32 v241,v245,v241
v_mfma_f32_16x16x32_bf16 a[112:115],v[236:239],v[176:179],a[112:115]
v_add_f32 v242,v246,v242
v_add_f32 v243,v247,v243
v_mbcnt_lo_u32_b32 v248,-1,0
v_mbcnt_hi_u32_b32 v248,-1,v248
s_and_b32 s59,s39,3
s_lshl_b32 s59,s59,2
s_add_u32 s59,s59,s28
s_mul_i32 s59,s59,15
v_add_u32 v195,s59,v248
v_mul_u32_u24 v195,896,v195
v_cmp_gt_u32 vcc,15,v248
s_and_b32 s59,s40,7
s_lshl_b32 s59,s59,2
s_add_u32 s59,s59,s28
v_cndmask_b32 v195,-1,v195,vcc
s_mul_i32 s59,s59,2
v_lshrrev_b32 v197,2,v248
v_add_u32 v197,s59,v197
v_cmp_gt_u32 vcc,8,v248
v_and_b32 v248,3,v248
v_lshlrev_b32 v248,7,v248
v_lshl_add_u32 v197,v197,13,v248
v_cndmask_b32 v197,-1,v197,vcc
v_mfma_f32_16x16x32_bf16 a[116:119],v[236:239],v[180:183],a[116:119]
v_rcp_f32 v192,v240
v_mfma_f32_16x16x32_bf16 a[120:123],v[236:239],v[184:187],a[120:123]
s_add_u32 m0,s29,101376
s_nop 0
buffer_load_dword v197,s[16:19],0 offen offset:0 lds
v_mfma_f32_16x16x32_bf16 a[124:127],v[236:239],v[188:191],a[124:127]
s_add_u32 m0,s29,101376
s_waitcnt lgkmcnt(4)
v_mfma_f32_16x16x32_bf16 a[128:131],v[208:211],v[176:179],a[128:131]
ds_read_b64_tr_b16 v[224:225],v253 offset:17280
buffer_load_dword v195,s[4:7],0 offen offset:256 lds
v_mfma_f32_16x16x32_bf16 a[132:135],v[208:211],v[180:183],a[132:135]
ds_read_b64_tr_b16 v[226:227],v253 offset:17792
s_mov_b32 s59,524288
v_mfma_f32_16x16x32_bf16 a[136:139],v[208:211],v[184:187],a[136:139]
ds_read_b64_tr_b16 v[228:229],v253 offset:17312
buffer_load_dword v197,s[16:19],s59 offen offset:0 lds
v_mfma_f32_16x16x32_bf16 a[140:143],v[208:211],v[188:191],a[140:143]
ds_read_b64_tr_b16 v[230:231],v253 offset:17824
s_add_u32 m0,s29,101376
v_mfma_f32_16x16x32_bf16 a[144:147],v[212:215],v[176:179],a[144:147]
buffer_load_dword v195,s[4:7],0 offen offset:384 lds
s_mov_b32 s59,1048576
v_mfma_f32_16x16x32_bf16 a[148:151],v[212:215],v[180:183],a[148:151]
buffer_load_dword v197,s[16:19],s59 offen offset:0 lds
s_add_u32 m0,s29,101376
v_mfma_f32_16x16x32_bf16 a[152:155],v[212:215],v[184:187],a[152:155]
buffer_load_dword v195,s[4:7],0 offen offset:512 lds
s_mov_b32 s59,1572864
v_mfma_f32_16x16x32_bf16 a[156:159],v[212:215],v[188:191],a[156:159]
buffer_load_dword v197,s[16:19],s59 offen offset:0 lds
s_waitcnt lgkmcnt(4)
v_mfma_f32_16x16x32_bf16 a[160:163],v[216:219],v[176:179],a[160:163]
ds_read_b64_tr_b16 v[232:233],v253 offset:17344
s_add_u32 m0,s29,101376
v_mfma_f32_16x16x32_bf16 a[164:167],v[216:219],v[180:183],a[164:167]
ds_read_b64_tr_b16 v[234:235],v253 offset:17856
buffer_load_dword v195,s[4:7],0 offen offset:640 lds
v_mfma_f32_16x16x32_bf16 a[168:171],v[216:219],v[184:187],a[168:171]
ds_read_b64_tr_b16 v[236:237],v253 offset:17376
s_mov_b32 s59,2097152
v_mfma_f32_16x16x32_bf16 a[172:175],v[216:219],v[188:191],a[172:175]
ds_read_b64_tr_b16 v[238:239],v253 offset:17888
buffer_load_dword v197,s[16:19],s59 offen offset:0 lds
v_mfma_f32_16x16x32_bf16 a[176:179],v[220:223],v[176:179],a[176:179]
s_add_u32 m0,s29,101376
v_mbcnt_lo_u32_b32 v252,-1,0
v_mfma_f32_16x16x32_bf16 a[180:183],v[220:223],v[180:183],a[180:183]
buffer_load_dword v195,s[4:7],0 offen offset:768 lds
s_mov_b32 s59,2621440
v_mfma_f32_16x16x32_bf16 a[184:187],v[220:223],v[184:187],a[184:187]
buffer_load_dword v197,s[16:19],s59 offen offset:0 lds
s_add_u32 m0,s29,101248
v_mbcnt_hi_u32_b32 v252,-1,v252
v_lshrrev_b32 v248,2,v252
v_mul_u32_u24 v248,1056,v248
v_and_b32 v252,3,v252
v_lshl_add_u32 v252,v252,4,v248
v_mbcnt_lo_u32_b32 v248,-1,0
v_mbcnt_hi_u32_b32 v248,-1,v248
v_bfe_u32 v248,v248,2,1
v_lshl_add_u32 v252,v248,3,v252
v_mfma_f32_16x16x32_bf16 a[188:191],v[220:223],v[188:191],a[188:191]
buffer_load_dwordx4 v255,s[4:7],s68 offen offset:128 lds
s_waitcnt lgkmcnt(4)
v_mfma_f32_16x16x32_bf16 a[192:195],v[224:227],v[176:179],a[192:195]
s_add_u32 m0,m0,0x00000400
v_mbcnt_lo_u32_b32 v253,-1,0
v_mfma_f32_16x16x32_bf16 a[196:199],v[224:227],v[180:183],a[196:199]
s_waitcnt vmcnt(24) lgkmcnt(0)
s_barrier
v_mfma_f32_16x16x32_bf16 a[200:203],v[224:227],v[184:187],a[200:203]
ds_read_b64_tr_b16 v[208:209],v252 offset:16896
buffer_load_dwordx4 v255,s[4:7],s93 offen offset:128 lds
v_mfma_f32_16x16x32_bf16 a[204:207],v[224:227],v[188:191],a[204:207]
ds_read_b64_tr_b16 v[210:211],v252 offset:17408
s_add_u32 m0,m0,0x00000400
v_mfma_f32_16x16x32_bf16 a[208:211],v[228:231],v[176:179],a[208:211]
ds_read_b64_tr_b16 v[212:213],v252 offset:16904
buffer_load_dwordx4 v255,s[4:7],s94 offen offset:128 lds
v_mfma_f32_16x16x32_bf16 a[212:215],v[228:231],v[180:183],a[212:215]
ds_read_b64_tr_b16 v[214:215],v252 offset:17416
s_add_u32 m0,m0,0x00000400
v_mfma_f32_16x16x32_bf16 a[216:219],v[228:231],v[184:187],a[216:219]
buffer_load_dwordx4 v255,s[4:7],s95 offen offset:128 lds
s_add_u32 m0,s29,118144
v_mfma_f32_16x16x32_bf16 a[220:223],v[228:231],v[188:191],a[220:223]
buffer_load_dwordx4 v255,s[4:7],s96 offen offset:128 lds
s_add_u32 m0,m0,0x00000400
v_mfma_f32_16x16x32_bf16 a[224:227],v[232:235],v[176:179],a[224:227]
ds_read_b64_tr_b16 v[216:217],v252 offset:16960
buffer_load_dwordx4 v255,s[4:7],s97 offen offset:128 lds
v_mfma_f32_16x16x32_bf16 a[228:231],v[232:235],v[180:183],a[228:231]
ds_read_b64_tr_b16 v[218:219],v252 offset:17472
s_add_u32 m0,m0,0x00000400
v_mfma_f32_16x16x32_bf16 a[232:235],v[232:235],v[184:187],a[232:235]
ds_read_b64_tr_b16 v[220:221],v252 offset:16968
buffer_load_dwordx4 v255,s[4:7],s98 offen offset:128 lds
v_mfma_f32_16x16x32_bf16 a[236:239],v[232:235],v[188:191],a[236:239]
ds_read_b64_tr_b16 v[222:223],v252 offset:17480
s_add_u32 m0,m0,0x00000400
v_mfma_f32_16x16x32_bf16 a[240:243],v[236:239],v[176:179],a[240:243]
buffer_load_dwordx4 v255,s[4:7],s99 offen offset:128 lds
v_mbcnt_hi_u32_b32 v253,-1,v253
v_mfma_f32_16x16x32_bf16 a[244:247],v[236:239],v[180:183],a[244:247]
v_rcp_f32 v194,v241
v_mfma_f32_16x16x32_bf16 a[248:251],v[236:239],v[184:187],a[248:251]
v_rcp_f32 v196,v242
v_mfma_f32_16x16x32_bf16 a[252:255],v[236:239],v[188:191],a[252:255]
v_rcp_f32 v198,v243
v_and_b32 v249,15,v253
v_add_u32 v250,4,v249
v_lshrrev_b32 v251,3,v250
v_and_b32 v251,1,v251
v_lshrrev_b32 v250,4,v250
v_lshlrev_b32 v250,3,v250
v_sub_u32 v250,v249,v250
v_lshl_add_u32 v250,v251,2,v250
v_lshrrev_b32 v253,4,v253
v_and_b32 v249,6,v250
v_xor_b32 v253,v253,v249
v_lshlrev_b32 v253,4,v253
v_lshl_add_u32 v253,v250,7,v253
s_add_u32 s60,s29,67584
v_add_u32 v253,s60,v253
v_mbcnt_lo_u32_b32 v248,-1,0
v_mbcnt_hi_u32_b32 v248,-1,v248
v_lshlrev_b32 v248,4,v248
s_lshl_b32 s67,s40,4
s_lshl_b32 s36,s39,1
s_add_u32 s67,s67,s36
s_lshl_b32 s67,s67,18
s_add_u32 s8,s48,s67
s_addc_u32 s9,s49,0
s_add_u32 s12,s50,s67
s_addc_u32 s13,s51,0
s_lshl_b32 s30,s28,11
s_mov_b32 s31,s30
s_mov_b32 s22,57344
s_mov_b32 s37,1
s_mul_i32 s58,s28,7168
s_add_u32 s58,s58,135168
v_add_u32 v249,s58,v248
s_nop 0
v_accvgpr_read_b32 v128,a64
v_accvgpr_read_b32 v129,a65
v_accvgpr_read_b32 v130,a66
v_accvgpr_read_b32 v131,a67
v_accvgpr_read_b32 v132,a80
v_accvgpr_read_b32 v133,a81
v_accvgpr_read_b32 v134,a82
v_accvgpr_read_b32 v135,a83
v_pk_mul_f32 v[128:129],v[128:129],v[192:193] op_sel_hi:[1,0]
v_pk_mul_f32 v[130:131],v[130:131],v[192:193] op_sel_hi:[1,0]
v_pk_mul_f32 v[132:133],v[132:133],v[192:193] op_sel_hi:[1,0]
v_pk_mul_f32 v[134:135],v[134:135],v[192:193] op_sel_hi:[1,0]
v_cvt_pk_bf16_f32 v160,v128,v129
v_cvt_pk_bf16_f32 v161,v130,v131
v_cvt_pk_bf16_f32 v162,v132,v133
v_cvt_pk_bf16_f32 v163,v134,v135
ds_write_b128 v249,v[160:163] offset:0
v_accvgpr_read_b32 v136,a68
v_accvgpr_read_b32 v137,a69
v_accvgpr_read_b32 v138,a70
v_accvgpr_read_b32 v139,a71
v_accvgpr_read_b32 v140,a84
v_accvgpr_read_b32 v141,a85
v_accvgpr_read_b32 v142,a86
v_accvgpr_read_b32 v143,a87
v_pk_mul_f32 v[136:137],v[136:137],v[194:195] op_sel_hi:[1,0]
v_pk_mul_f32 v[138:139],v[138:139],v[194:195] op_sel_hi:[1,0]
v_pk_mul_f32 v[140:141],v[140:141],v[194:195] op_sel_hi:[1,0]
v_pk_mul_f32 v[142:143],v[142:143],v[194:195] op_sel_hi:[1,0]
v_cvt_pk_bf16_f32 v164,v136,v137
v_cvt_pk_bf16_f32 v165,v138,v139
v_cvt_pk_bf16_f32 v166,v140,v141
v_cvt_pk_bf16_f32 v167,v142,v143
ds_write_b128 v249,v[164:167] offset:1024
v_accvgpr_read_b32 v144,a72
v_accvgpr_read_b32 v145,a73
v_accvgpr_read_b32 v146,a74
v_accvgpr_read_b32 v147,a75
v_accvgpr_read_b32 v148,a88
v_accvgpr_read_b32 v149,a89
v_accvgpr_read_b32 v150,a90
v_accvgpr_read_b32 v151,a91
v_pk_mul_f32 v[144:145],v[144:145],v[196:197] op_sel_hi:[1,0]
v_pk_mul_f32 v[146:147],v[146:147],v[196:197] op_sel_hi:[1,0]
v_pk_mul_f32 v[148:149],v[148:149],v[196:197] op_sel_hi:[1,0]
v_pk_mul_f32 v[150:151],v[150:151],v[196:197] op_sel_hi:[1,0]
v_cvt_pk_bf16_f32 v168,v144,v145
v_cvt_pk_bf16_f32 v169,v146,v147
v_cvt_pk_bf16_f32 v170,v148,v149
v_cvt_pk_bf16_f32 v171,v150,v151
ds_write_b128 v249,v[168:171] offset:2048
v_accvgpr_read_b32 v152,a76
v_accvgpr_read_b32 v153,a77
v_accvgpr_read_b32 v154,a78
v_accvgpr_read_b32 v155,a79
v_accvgpr_read_b32 v156,a92
v_accvgpr_read_b32 v157,a93
v_accvgpr_read_b32 v158,a94
v_accvgpr_read_b32 v159,a95
v_pk_mul_f32 v[152:153],v[152:153],v[198:199] op_sel_hi:[1,0]
v_pk_mul_f32 v[154:155],v[154:155],v[198:199] op_sel_hi:[1,0]
v_pk_mul_f32 v[156:157],v[156:157],v[198:199] op_sel_hi:[1,0]
v_pk_mul_f32 v[158:159],v[158:159],v[198:199] op_sel_hi:[1,0]
v_cvt_pk_bf16_f32 v172,v152,v153
v_cvt_pk_bf16_f32 v173,v154,v155
v_cvt_pk_bf16_f32 v174,v156,v157
v_cvt_pk_bf16_f32 v175,v158,v159
buffer_store_dwordx4 v[172:175],v248,s[20:23],s65 offen offset:2048 sc1
v_accvgpr_read_b32 v128,a0
v_accvgpr_read_b32 v129,a1
v_accvgpr_read_b32 v130,a2
v_accvgpr_read_b32 v131,a3
v_accvgpr_read_b32 v132,a16
v_accvgpr_read_b32 v133,a17
v_accvgpr_read_b32 v134,a18
v_accvgpr_read_b32 v135,a19
v_pk_mul_f32 v[128:129],v[128:129],v[192:193] op_sel_hi:[1,0]
v_pk_mul_f32 v[130:131],v[130:131],v[192:193] op_sel_hi:[1,0]
v_pk_mul_f32 v[132:133],v[132:133],v[192:193] op_sel_hi:[1,0]
v_pk_mul_f32 v[134:135],v[134:135],v[192:193] op_sel_hi:[1,0]
v_cvt_pk_bf16_f32 v176,v128,v129
v_cvt_pk_bf16_f32 v177,v130,v131
v_cvt_pk_bf16_f32 v178,v132,v133
v_cvt_pk_bf16_f32 v179,v134,v135
buffer_store_dwordx4 v[176:179],v248,s[20:23],s62 offen offset:0 sc1
v_accvgpr_read_b32 v136,a4
v_accvgpr_read_b32 v137,a5
v_accvgpr_read_b32 v138,a6
v_accvgpr_read_b32 v139,a7
v_accvgpr_read_b32 v140,a20
v_accvgpr_read_b32 v141,a21
v_accvgpr_read_b32 v142,a22
v_accvgpr_read_b32 v143,a23
v_pk_mul_f32 v[136:137],v[136:137],v[194:195] op_sel_hi:[1,0]
v_pk_mul_f32 v[138:139],v[138:139],v[194:195] op_sel_hi:[1,0]
v_pk_mul_f32 v[140:141],v[140:141],v[194:195] op_sel_hi:[1,0]
v_pk_mul_f32 v[142:143],v[142:143],v[194:195] op_sel_hi:[1,0]
v_cvt_pk_bf16_f32 v180,v136,v137
v_cvt_pk_bf16_f32 v181,v138,v139
v_cvt_pk_bf16_f32 v182,v140,v141
v_cvt_pk_bf16_f32 v183,v142,v143
ds_write_b128 v249,v[180:183] offset:3072
v_accvgpr_read_b32 v144,a8
v_accvgpr_read_b32 v145,a9
v_accvgpr_read_b32 v146,a10
v_accvgpr_read_b32 v147,a11
v_accvgpr_read_b32 v148,a24
v_accvgpr_read_b32 v149,a25
v_accvgpr_read_b32 v150,a26
v_accvgpr_read_b32 v151,a27
v_pk_mul_f32 v[144:145],v[144:145],v[196:197] op_sel_hi:[1,0]
v_pk_mul_f32 v[146:147],v[146:147],v[196:197] op_sel_hi:[1,0]
v_pk_mul_f32 v[148:149],v[148:149],v[196:197] op_sel_hi:[1,0]
v_pk_mul_f32 v[150:151],v[150:151],v[196:197] op_sel_hi:[1,0]
v_cvt_pk_bf16_f32 v184,v144,v145
v_cvt_pk_bf16_f32 v185,v146,v147
v_cvt_pk_bf16_f32 v186,v148,v149
v_cvt_pk_bf16_f32 v187,v150,v151
ds_write_b128 v249,v[184:187] offset:4096
v_accvgpr_read_b32 v152,a12
v_accvgpr_read_b32 v153,a13
v_accvgpr_read_b32 v154,a14
v_accvgpr_read_b32 v155,a15
v_accvgpr_read_b32 v156,a28
v_accvgpr_read_b32 v157,a29
v_accvgpr_read_b32 v158,a30
v_accvgpr_read_b32 v159,a31
v_pk_mul_f32 v[152:153],v[152:153],v[198:199] op_sel_hi:[1,0]
v_pk_mul_f32 v[154:155],v[154:155],v[198:199] op_sel_hi:[1,0]
v_pk_mul_f32 v[156:157],v[156:157],v[198:199] op_sel_hi:[1,0]
v_pk_mul_f32 v[158:159],v[158:159],v[198:199] op_sel_hi:[1,0]
v_cvt_pk_bf16_f32 v188,v152,v153
v_cvt_pk_bf16_f32 v189,v154,v155
v_cvt_pk_bf16_f32 v190,v156,v157
v_cvt_pk_bf16_f32 v191,v158,v159
buffer_store_dwordx4 v[188:191],v248,s[20:23],s65 offen offset:0 sc1
s_waitcnt vmcnt(26)
ds_read_b128 a[64:67],v253 offset:0
ds_read_b128 a[68:71],v253 offset:2048
ds_read_b128 a[72:75],v253 offset:16896
ds_read_b128 a[76:79],v253 offset:18944
v_xor_b32 v253,64,v253
ds_read_b128 a[80:83],v253 offset:0
ds_read_b128 a[84:87],v253 offset:2048
ds_read_b128 a[88:91],v253 offset:16896
ds_read_b128 a[92:95],v253 offset:18944
v_xor_b32 v253,64,v253
v_accvgpr_read_b32 v128,a32
v_accvgpr_read_b32 v129,a33
v_accvgpr_read_b32 v130,a34
v_accvgpr_read_b32 v131,a35
v_accvgpr_read_b32 v132,a48
v_accvgpr_read_b32 v133,a49
v_accvgpr_read_b32 v134,a50
v_accvgpr_read_b32 v135,a51
v_pk_mul_f32 v[128:129],v[128:129],v[192:193] op_sel_hi:[1,0]
v_pk_mul_f32 v[130:131],v[130:131],v[192:193] op_sel_hi:[1,0]
v_pk_mul_f32 v[132:133],v[132:133],v[192:193] op_sel_hi:[1,0]
v_pk_mul_f32 v[134:135],v[134:135],v[192:193] op_sel_hi:[1,0]
v_cvt_pk_bf16_f32 v160,v128,v129
v_cvt_pk_bf16_f32 v161,v130,v131
v_cvt_pk_bf16_f32 v162,v132,v133
v_cvt_pk_bf16_f32 v163,v134,v135
buffer_store_dwordx4 v[160:163],v248,s[20:23],s62 offen offset:1024 sc1
v_accvgpr_read_b32 v136,a36
v_accvgpr_read_b32 v137,a37
v_accvgpr_read_b32 v138,a38
v_accvgpr_read_b32 v139,a39
v_accvgpr_read_b32 v140,a52
v_accvgpr_read_b32 v141,a53
v_accvgpr_read_b32 v142,a54
v_accvgpr_read_b32 v143,a55
v_pk_mul_f32 v[136:137],v[136:137],v[194:195] op_sel_hi:[1,0]
v_pk_mul_f32 v[138:139],v[138:139],v[194:195] op_sel_hi:[1,0]
v_pk_mul_f32 v[140:141],v[140:141],v[194:195] op_sel_hi:[1,0]
v_pk_mul_f32 v[142:143],v[142:143],v[194:195] op_sel_hi:[1,0]
v_cvt_pk_bf16_f32 v164,v136,v137
v_cvt_pk_bf16_f32 v165,v138,v139
v_cvt_pk_bf16_f32 v166,v140,v141
v_cvt_pk_bf16_f32 v167,v142,v143
ds_write_b128 v249,v[164:167] offset:5120
v_accvgpr_read_b32 v144,a40
v_accvgpr_read_b32 v145,a41
v_accvgpr_read_b32 v146,a42
v_accvgpr_read_b32 v147,a43
v_accvgpr_read_b32 v148,a56
v_accvgpr_read_b32 v149,a57
v_accvgpr_read_b32 v150,a58
v_accvgpr_read_b32 v151,a59
v_pk_mul_f32 v[144:145],v[144:145],v[196:197] op_sel_hi:[1,0]
v_pk_mul_f32 v[146:147],v[146:147],v[196:197] op_sel_hi:[1,0]
v_pk_mul_f32 v[148:149],v[148:149],v[196:197] op_sel_hi:[1,0]
v_pk_mul_f32 v[150:151],v[150:151],v[196:197] op_sel_hi:[1,0]
v_cvt_pk_bf16_f32 v168,v144,v145
v_cvt_pk_bf16_f32 v169,v146,v147
v_cvt_pk_bf16_f32 v170,v148,v149
v_cvt_pk_bf16_f32 v171,v150,v151
ds_write_b128 v249,v[168:171] offset:6144
v_accvgpr_read_b32 v152,a44
v_accvgpr_read_b32 v153,a45
v_accvgpr_read_b32 v154,a46
v_accvgpr_read_b32 v155,a47
v_accvgpr_read_b32 v156,a60
v_accvgpr_read_b32 v157,a61
v_accvgpr_read_b32 v158,a62
v_accvgpr_read_b32 v159,a63
v_pk_mul_f32 v[152:153],v[152:153],v[198:199] op_sel_hi:[1,0]
v_pk_mul_f32 v[154:155],v[154:155],v[198:199] op_sel_hi:[1,0]
v_pk_mul_f32 v[156:157],v[156:157],v[198:199] op_sel_hi:[1,0]
v_pk_mul_f32 v[158:159],v[158:159],v[198:199] op_sel_hi:[1,0]
v_cvt_pk_bf16_f32 v172,v152,v153
v_cvt_pk_bf16_f32 v173,v154,v155
v_cvt_pk_bf16_f32 v174,v156,v157
v_cvt_pk_bf16_f32 v175,v158,v159
buffer_store_dwordx4 v[172:175],v248,s[20:23],s65 offen offset:1024 sc1
s_branch L_item
L_last:
v_mfma_f32_16x16x32_bf16 v[128:131],v[208:211],v[0:3],v[192:195]
ds_read_b128 v[224:227],v252 offset:256
s_add_u32 m0,s35,118272
v_mfma_f32_16x16x32_bf16 v[132:135],v[208:211],v[4:7],v[196:199]
buffer_load_dwordx4 v254,s[12:15],s31 offen offset:0 nt lds
s_add_u32 m0,m0,0x00000220
v_mfma_f32_16x16x32_bf16 v[136:139],v[208:211],v[8:11],v[200:203]
ds_read_b128 v[228:231],v252 offset:320
v_add_f32 v240,v240,v244
v_mfma_f32_16x16x32_bf16 v[140:143],v[208:211],v[12:15],v[204:207]
buffer_load_dwordx4 v254,s[12:15],s31 offen offset:512 nt lds
s_add_u32 m0,m0,0x00000220
v_mfma_f32_16x16x32_bf16 v[128:131],v[212:215],v[16:19],v[128:131]
v_add_f32 v241,v241,v245
v_add_f32 v242,v242,v246
v_mfma_f32_16x16x32_bf16 v[132:135],v[212:215],v[20:23],v[132:135]
buffer_load_dwordx4 v254,s[12:15],s31 offen offset:1024 nt lds
s_add_u32 m0,m0,0x00000220
v_mfma_f32_16x16x32_bf16 v[136:139],v[212:215],v[24:27],v[136:139]
v_add_f32 v243,v243,v247
s_mul_i32 s58,s39,458752
v_mfma_f32_16x16x32_bf16 v[140:143],v[212:215],v[28:31],v[140:143]
buffer_load_dwordx4 v254,s[12:15],s31 offen offset:1536 nt lds
s_waitcnt lgkmcnt(2)
v_mfma_f32_16x16x32_bf16 v[128:131],v[216:219],v[32:35],v[128:131]
ds_read_b128 v[232:235],v252 offset:384
s_add_u32 s31,s31,16384
v_mfma_f32_16x16x32_bf16 v[132:135],v[216:219],v[36:39],v[132:135]
v_mbcnt_lo_u32_b32 v254,-1,0
v_mbcnt_hi_u32_b32 v254,-1,v254
v_mfma_f32_16x16x32_bf16 v[136:139],v[216:219],v[40:43],v[136:139]
ds_read_b128 v[236:239],v252 offset:448
v_lshrrev_b32 v248,3,v254
v_mfma_f32_16x16x32_bf16 v[140:143],v[216:219],v[44:47],v[140:143]
v_mul_u32_u24 v248,3584,v248
s_lshl_b32 s60,s39,2
v_mfma_f32_16x16x32_bf16 v[128:131],v[220:223],v[48:51],v[128:131]
v_xor_b32 v254,s60,v254
v_and_b32 v254,7,v254
v_mfma_f32_16x16x32_bf16 v[132:135],v[220:223],v[52:55],v[132:135]
v_lshl_add_u32 v254,v254,4,v248
v_mfma_f32_16x16x32_bf16 v[136:139],v[220:223],v[56:59],v[136:139]
s_add_u32 s16,s46,s58
s_addc_u32 s17,s47,0
v_mfma_f32_16x16x32_bf16 v[140:143],v[220:223],v[60:63],v[140:143]
s_mov_b32 s18,458752
s_waitcnt lgkmcnt(2)
v_mfma_f32_16x16x32_bf16 v[128:131],v[224:227],v[64:67],v[128:131]
ds_read_b128 v[208:211],v252 offset:512
s_mul_i32 s32,s28,28672
v_mfma_f32_16x16x32_bf16 v[132:135],v[224:227],v[68:71],v[132:135]
v_mbcnt_lo_u32_b32 v255,-1,0
v_mbcnt_hi_u32_b32 v255,-1,v255
v_mfma_f32_16x16x32_bf16 v[136:139],v[224:227],v[72:75],v[136:139]
ds_read_b128 v[212:215],v252 offset:576
v_cmp_gt_u32 vcc,16,v255
v_mfma_f32_16x16x32_bf16 v[140:143],v[224:227],v[76:79],v[140:143]
s_and_b32 s59,s40,7
s_lshl_b32 s59,s59,2
v_mfma_f32_16x16x32_bf16 v[128:131],v[228:231],v[80:83],v[128:131]
s_add_u32 s59,s59,s28
s_mul_i32 s59,s59,16
v_mfma_f32_16x16x32_bf16 v[132:135],v[228:231],v[84:87],v[132:135]
v_add_u32 v255,s59,v255
v_mul_u32_u24 v255,896,v255
v_mfma_f32_16x16x32_bf16 v[136:139],v[228:231],v[88:91],v[136:139]
v_cndmask_b32 v255,-1,v255,vcc
v_mfma_f32_16x16x32_bf16 v[140:143],v[228:231],v[92:95],v[140:143]
s_waitcnt lgkmcnt(2)
v_mfma_f32_16x16x32_bf16 v[128:131],v[232:235],v[96:99],v[128:131]
ds_read_b128 v[216:219],v252 offset:640
v_mfma_f32_16x16x32_bf16 v[132:135],v[232:235],v[100:103],v[132:135]
v_mfma_f32_16x16x32_bf16 v[136:139],v[232:235],v[104:107],v[136:139]
ds_read_b128 v[220:223],v252 offset:704
v_mfma_f32_16x16x32_bf16 v[140:143],v[232:235],v[108:111],v[140:143]
v_mfma_f32_16x16x32_bf16 v[128:131],v[236:239],v[112:115],v[128:131]
v_mfma_f32_16x16x32_bf16 v[132:135],v[236:239],v[116:119],v[132:135]
v_mfma_f32_16x16x32_bf16 v[136:139],v[236:239],v[120:123],v[136:139]
v_mfma_f32_16x16x32_bf16 v[140:143],v[236:239],v[124:127],v[140:143]
s_waitcnt lgkmcnt(2)
v_mfma_f32_16x16x32_bf16 v[144:147],v[208:211],v[0:3],v[192:195]
ds_read_b128 v[224:227],v252 offset:768
v_mfma_f32_16x16x32_bf16 v[148:151],v[208:211],v[4:7],v[196:199]
v_mfma_f32_16x16x32_bf16 v[152:155],v[208:211],v[8:11],v[200:203]
ds_read_b128 v[228:231],v252 offset:832
s_add_u32 m0,s29,16896
v_mfma_f32_16x16x32_bf16 v[156:159],v[208:211],v[12:15],v[204:207]
buffer_load_dword v255,s[16:19],0 offen offset:256 lds
v_mfma_f32_16x16x32_bf16 v[144:147],v[212:215],v[16:19],v[144:147]
v_exp_f32 v248,v128
v_mfma_f32_16x16x32_bf16 v[148:151],v[212:215],v[20:23],v[148:151]
v_exp_f32 v249,v129
v_mfma_f32_16x16x32_bf16 v[152:155],v[212:215],v[24:27],v[152:155]
v_exp_f32 v250,v130
v_mfma_f32_16x16x32_bf16 v[156:159],v[212:215],v[28:31],v[156:159]
v_add_f32 v244,v248,v249
s_waitcnt lgkmcnt(2)
v_mfma_f32_16x16x32_bf16 v[144:147],v[216:219],v[32:35],v[144:147]
ds_read_b128 v[232:235],v252 offset:896
buffer_load_dword v255,s[16:19],0 offen offset:384 lds
v_mfma_f32_16x16x32_bf16 v[148:151],v[216:219],v[36:39],v[148:151]
v_exp_f32 v251,v131
v_mfma_f32_16x16x32_bf16 v[152:155],v[216:219],v[40:43],v[152:155]
ds_read_b128 v[236:239],v252 offset:960
v_cvt_pk_bf16_f32 v176,v248,v249
v_mfma_f32_16x16x32_bf16 v[156:159],v[216:219],v[44:47],v[156:159]
v_exp_f32 v248,v132
v_mfma_f32_16x16x32_bf16 v[144:147],v[220:223],v[48:51],v[144:147]
v_exp_f32 v249,v133
v_mfma_f32_16x16x32_bf16 v[148:151],v[220:223],v[52:55],v[148:151]
v_add_f32 v244,v244,v250
v_add_f32 v244,v244,v251
v_mfma_f32_16x16x32_bf16 v[152:155],v[220:223],v[56:59],v[152:155]
v_cvt_pk_bf16_f32 v177,v250,v251
v_mfma_f32_16x16x32_bf16 v[156:159],v[220:223],v[60:63],v[156:159]
v_add_f32 v245,v248,v249
s_waitcnt lgkmcnt(2)
v_mfma_f32_16x16x32_bf16 v[144:147],v[224:227],v[64:67],v[144:147]
ds_read_b64_tr_b16 v[208:209],v253 offset:0
v_cvt_pk_bf16_f32 v180,v248,v249
v_mfma_f32_16x16x32_bf16 v[148:151],v[224:227],v[68:71],v[148:151]
ds_read_b64_tr_b16 v[210:211],v253 offset:512
v_mfma_f32_16x16x32_bf16 v[152:155],v[224:227],v[72:75],v[152:155]
ds_read_b64_tr_b16 v[212:213],v253 offset:32
s_add_u32 m0,s29,16896
v_mfma_f32_16x16x32_bf16 v[156:159],v[224:227],v[76:79],v[156:159]
ds_read_b64_tr_b16 v[214:215],v253 offset:544
buffer_load_dwordx4 v254,s[16:19],s32 offen offset:0 lds
v_mfma_f32_16x16x32_bf16 v[144:147],v[228:231],v[80:83],v[144:147]
s_add_u32 m0,m0,0x000000a0
v_mfma_f32_16x16x32_bf16 v[148:151],v[228:231],v[84:87],v[148:151]
v_exp_f32 v250,v134
v_mfma_f32_16x16x32_bf16 v[152:155],v[228:231],v[88:91],v[152:155]
v_exp_f32 v251,v135
v_mfma_f32_16x16x32_bf16 v[156:159],v[228:231],v[92:95],v[156:159]
buffer_load_dwordx4 v254,s[16:19],s32 offen offset:896 lds
s_waitcnt lgkmcnt(4)
v_mfma_f32_16x16x32_bf16 v[144:147],v[232:235],v[96:99],v[144:147]
ds_read_b64_tr_b16 v[216:217],v253 offset:64
s_add_u32 m0,m0,0x000000a0
v_mfma_f32_16x16x32_bf16 v[148:151],v[232:235],v[100:103],v[148:151]
ds_read_b64_tr_b16 v[218:219],v253 offset:576
v_add_f32 v245,v245,v250
v_mfma_f32_16x16x32_bf16 v[152:155],v[232:235],v[104:107],v[152:155]
ds_read_b64_tr_b16 v[220:221],v253 offset:96
v_add_f32 v245,v245,v251
v_mfma_f32_16x16x32_bf16 v[156:159],v[232:235],v[108:111],v[156:159]
ds_read_b64_tr_b16 v[222:223],v253 offset:608
buffer_load_dwordx4 v254,s[16:19],s32 offen offset:1792 lds
v_mfma_f32_16x16x32_bf16 v[144:147],v[236:239],v[112:115],v[144:147]
s_add_u32 m0,m0,0x000000a0
v_cvt_pk_bf16_f32 v181,v250,v251
v_mfma_f32_16x16x32_bf16 v[148:151],v[236:239],v[116:119],v[148:151]
v_exp_f32 v248,v136
v_mfma_f32_16x16x32_bf16 v[152:155],v[236:239],v[120:123],v[152:155]
v_exp_f32 v249,v137
v_mfma_f32_16x16x32_bf16 v[156:159],v[236:239],v[124:127],v[156:159]
buffer_load_dwordx4 v254,s[16:19],s32 offen offset:2688 lds
s_waitcnt lgkmcnt(4)
v_mfma_f32_16x16x32_bf16 a[0:3],v[208:211],v[160:163],a[0:3]
ds_read_b64_tr_b16 v[224:225],v253 offset:128
s_add_u32 s32,s32,0x0001c000
v_mfma_f32_16x16x32_bf16 a[4:7],v[208:211],v[164:167],a[4:7]
ds_read_b64_tr_b16 v[226:227],v253 offset:640
v_add_f32 v246,v248,v249
v_mfma_f32_16x16x32_bf16 a[8:11],v[208:211],v[168:171],a[8:11]
ds_read_b64_tr_b16 v[228:229],v253 offset:160
v_cvt_pk_bf16_f32 v184,v248,v249
v_mfma_f32_16x16x32_bf16 a[12:15],v[208:211],v[172:175],a[12:15]
ds_read_b64_tr_b16 v[230:231],v253 offset:672
v_mfma_f32_16x16x32_bf16 a[16:19],v[212:215],v[160:163],a[16:19]
v_exp_f32 v250,v138
v_mfma_f32_16x16x32_bf16 a[20:23],v[212:215],v[164:167],a[20:23]
v_exp_f32 v251,v139
v_mfma_f32_16x16x32_bf16 a[24:27],v[212:215],v[168:171],a[24:27]
v_exp_f32 v248,v140
v_mfma_f32_16x16x32_bf16 a[28:31],v[212:215],v[172:175],a[28:31]
v_add_f32 v246,v246,v250
s_waitcnt lgkmcnt(4)
v_mfma_f32_16x16x32_bf16 a[32:35],v[216:219],v[160:163],a[32:35]
ds_read_b64_tr_b16 v[232:233],v253 offset:192
v_add_f32 v246,v246,v251
v_mfma_f32_16x16x32_bf16 a[36:39],v[216:219],v[164:167],a[36:39]
ds_read_b64_tr_b16 v[234:235],v253 offset:704
v_cvt_pk_bf16_f32 v185,v250,v251
v_mfma_f32_16x16x32_bf16 a[40:43],v[216:219],v[168:171],a[40:43]
ds_read_b64_tr_b16 v[236:237],v253 offset:224
v_mfma_f32_16x16x32_bf16 a[44:47],v[216:219],v[172:175],a[44:47]
ds_read_b64_tr_b16 v[238:239],v253 offset:736
v_mfma_f32_16x16x32_bf16 a[48:51],v[220:223],v[160:163],a[48:51]
v_exp_f32 v249,v141
v_mfma_f32_16x16x32_bf16 a[52:55],v[220:223],v[164:167],a[52:55]
v_exp_f32 v250,v142
v_mfma_f32_16x16x32_bf16 a[56:59],v[220:223],v[168:171],a[56:59]
v_exp_f32 v251,v143
v_mfma_f32_16x16x32_bf16 a[60:63],v[220:223],v[172:175],a[60:63]
v_add_f32 v247,v248,v249
s_waitcnt lgkmcnt(4)
v_mfma_f32_16x16x32_bf16 a[64:67],v[224:227],v[160:163],a[64:67]
ds_read_b64_tr_b16 v[208:209],v253 offset:256
v_cvt_pk_bf16_f32 v188,v248,v249
v_mfma_f32_16x16x32_bf16 a[68:71],v[224:227],v[164:167],a[68:71]
ds_read_b64_tr_b16 v[210:211],v253 offset:768
v_add_f32 v247,v247,v250
v_mfma_f32_16x16x32_bf16 a[72:75],v[224:227],v[168:171],a[72:75]
ds_read_b64_tr_b16 v[212:213],v253 offset:288
v_add_f32 v247,v247,v251
v_mfma_f32_16x16x32_bf16 a[76:79],v[224:227],v[172:175],a[76:79]
ds_read_b64_tr_b16 v[214:215],v253 offset:800
v_cvt_pk_bf16_f32 v189,v250,v251
v_mfma_f32_16x16x32_bf16 a[80:83],v[228:231],v[160:163],a[80:83]
v_exp_f32 v248,v144
v_mfma_f32_16x16x32_bf16 a[84:87],v[228:231],v[164:167],a[84:87]
v_exp_f32 v249,v145
v_mfma_f32_16x16x32_bf16 a[88:91],v[228:231],v[168:171],a[88:91]
v_exp_f32 v250,v146
v_mfma_f32_16x16x32_bf16 a[92:95],v[228:231],v[172:175],a[92:95]
v_add_f32 v244,v244,v248
s_waitcnt lgkmcnt(4)
v_mfma_f32_16x16x32_bf16 a[96:99],v[232:235],v[160:163],a[96:99]
ds_read_b64_tr_b16 v[216:217],v253 offset:320
v_add_f32 v244,v244,v249
v_mfma_f32_16x16x32_bf16 a[100:103],v[232:235],v[164:167],a[100:103]
ds_read_b64_tr_b16 v[218:219],v253 offset:832
v_cvt_pk_bf16_f32 v178,v248,v249
v_mfma_f32_16x16x32_bf16 a[104:107],v[232:235],v[168:171],a[104:107]
ds_read_b64_tr_b16 v[220:221],v253 offset:352
v_mfma_f32_16x16x32_bf16 a[108:111],v[232:235],v[172:175],a[108:111]
ds_read_b64_tr_b16 v[222:223],v253 offset:864
v_mfma_f32_16x16x32_bf16 a[112:115],v[236:239],v[160:163],a[112:115]
v_exp_f32 v251,v147
v_mfma_f32_16x16x32_bf16 a[116:119],v[236:239],v[164:167],a[116:119]
v_exp_f32 v248,v148
v_mfma_f32_16x16x32_bf16 a[120:123],v[236:239],v[168:171],a[120:123]
v_exp_f32 v249,v149
v_mfma_f32_16x16x32_bf16 a[124:127],v[236:239],v[172:175],a[124:127]
v_add_f32 v244,v244,v250
s_waitcnt lgkmcnt(4)
v_mfma_f32_16x16x32_bf16 a[128:131],v[208:211],v[160:163],a[128:131]
ds_read_b64_tr_b16 v[224:225],v253 offset:384
v_add_f32 v244,v244,v251
v_mfma_f32_16x16x32_bf16 a[132:135],v[208:211],v[164:167],a[132:135]
ds_read_b64_tr_b16 v[226:227],v253 offset:896
v_cvt_pk_bf16_f32 v179,v250,v251
v_mfma_f32_16x16x32_bf16 a[136:139],v[208:211],v[168:171],a[136:139]
ds_read_b64_tr_b16 v[228:229],v253 offset:416
v_add_f32 v245,v245,v248
v_mfma_f32_16x16x32_bf16 a[140:143],v[208:211],v[172:175],a[140:143]
ds_read_b64_tr_b16 v[230:231],v253 offset:928
v_add_f32 v245,v245,v249
v_mfma_f32_16x16x32_bf16 a[144:147],v[212:215],v[160:163],a[144:147]
v_exp_f32 v250,v150
v_mfma_f32_16x16x32_bf16 a[148:151],v[212:215],v[164:167],a[148:151]
v_exp_f32 v251,v151
v_mfma_f32_16x16x32_bf16 a[152:155],v[212:215],v[168:171],a[152:155]
v_cvt_pk_bf16_f32 v182,v248,v249
v_mfma_f32_16x16x32_bf16 a[156:159],v[212:215],v[172:175],a[156:159]
v_add_f32 v245,v245,v250
s_waitcnt lgkmcnt(4)
v_mfma_f32_16x16x32_bf16 a[160:163],v[216:219],v[160:163],a[160:163]
ds_read_b64_tr_b16 v[232:233],v253 offset:448
v_add_f32 v245,v245,v251
v_mfma_f32_16x16x32_bf16 a[164:167],v[216:219],v[164:167],a[164:167]
ds_read_b64_tr_b16 v[234:235],v253 offset:960
v_cvt_pk_bf16_f32 v183,v250,v251
v_mfma_f32_16x16x32_bf16 a[168:171],v[216:219],v[168:171],a[168:171]
ds_read_b64_tr_b16 v[236:237],v253 offset:480
v_mfma_f32_16x16x32_bf16 a[172:175],v[216:219],v[172:175],a[172:175]
ds_read_b64_tr_b16 v[238:239],v253 offset:992
v_mfma_f32_16x16x32_bf16 a[176:179],v[220:223],v[160:163],a[176:179]
v_exp_f32 v248,v152
v_mfma_f32_16x16x32_bf16 a[180:183],v[220:223],v[164:167],a[180:183]
v_exp_f32 v249,v153
v_mfma_f32_16x16x32_bf16 a[184:187],v[220:223],v[168:171],a[184:187]
v_exp_f32 v250,v154
v_mfma_f32_16x16x32_bf16 a[188:191],v[220:223],v[172:175],a[188:191]
v_add_f32 v246,v246,v248
s_waitcnt lgkmcnt(4)
v_mfma_f32_16x16x32_bf16 a[192:195],v[224:227],v[160:163],a[192:195]
v_exp_f32 v251,v155
v_mfma_f32_16x16x32_bf16 a[196:199],v[224:227],v[164:167],a[196:199]
s_waitcnt vmcnt(18) lgkmcnt(0)
s_barrier
v_mfma_f32_16x16x32_bf16 a[200:203],v[224:227],v[168:171],a[200:203]
ds_read_b128 v[208:211],v252 offset:16896
v_add_f32 v246,v246,v249
v_mfma_f32_16x16x32_bf16 a[204:207],v[224:227],v[172:175],a[204:207]
v_cvt_pk_bf16_f32 v186,v248,v249
v_mfma_f32_16x16x32_bf16 a[208:211],v[228:231],v[160:163],a[208:211]
ds_read_b128 v[212:215],v252 offset:16960
v_add_f32 v246,v246,v250
v_mfma_f32_16x16x32_bf16 a[212:215],v[228:231],v[164:167],a[212:215]
v_exp_f32 v248,v156
v_mfma_f32_16x16x32_bf16 a[216:219],v[228:231],v[168:171],a[216:219]
v_exp_f32 v249,v157
v_mfma_f32_16x16x32_bf16 a[220:223],v[228:231],v[172:175],a[220:223]
v_add_f32 v246,v246,v251
v_cvt_pk_bf16_f32 v187,v250,v251
v_mfma_f32_16x16x32_bf16 a[224:227],v[232:235],v[160:163],a[224:227]
ds_read_b128 v[216:219],v252 offset:17024
v_add_f32 v247,v247,v248
v_mfma_f32_16x16x32_bf16 a[228:231],v[232:235],v[164:167],a[228:231]
v_exp_f32 v250,v158
v_mfma_f32_16x16x32_bf16 a[232:235],v[232:235],v[168:171],a[232:235]
ds_read_b128 v[220:223],v252 offset:17088
v_add_f32 v247,v247,v249
v_mfma_f32_16x16x32_bf16 a[236:239],v[232:235],v[172:175],a[236:239]
v_exp_f32 v251,v159
v_mfma_f32_16x16x32_bf16 a[240:243],v[236:239],v[160:163],a[240:243]
v_cvt_pk_bf16_f32 v190,v248,v249
v_mfma_f32_16x16x32_bf16 a[244:247],v[236:239],v[164:167],a[244:247]
v_add_f32 v247,v247,v250
v_add_f32 v247,v247,v251
v_mfma_f32_16x16x32_bf16 a[248:251],v[236:239],v[168:171],a[248:251]
v_cvt_pk_bf16_f32 v191,v250,v251
s_waitcnt lgkmcnt(2)
v_mfma_f32_16x16x32_bf16 a[252:255],v[236:239],v[172:175],a[252:255]
v_max3_f32 v248,v244,v245,v246
v_max_f32 v248,v248,v247
v_cmp_lt_f32 vcc,0x49800000,v248
s_cbranch_vccnz L_stub7
L_back7:
v_mfma_f32_16x16x32_bf16 v[128:131],v[208:211],v[0:3],v[192:195]
ds_read_b128 v[224:227],v252 offset:17152
s_add_u32 m0,s29,33792
v_mfma_f32_16x16x32_bf16 v[132:135],v[208:211],v[4:7],v[196:199]
buffer_load_dword v255,s[16:19],0 offen offset:512 lds
v_add_f32 v240,v240,v244
v_mfma_f32_16x16x32_bf16 v[136:139],v[208:211],v[8:11],v[200:203]
ds_read_b128 v[228:231],v252 offset:17216
v_add_f32 v241,v241,v245
v_mfma_f32_16x16x32_bf16 v[140:143],v[208:211],v[12:15],v[204:207]
v_add_f32 v242,v242,v246
v_add_f32 v243,v243,v247
v_mfma_f32_16x16x32_bf16 v[128:131],v[212:215],v[16:19],v[128:131]
v_mfma_f32_16x16x32_bf16 v[132:135],v[212:215],v[20:23],v[132:135]
v_mfma_f32_16x16x32_bf16 v[136:139],v[212:215],v[24:27],v[136:139]
buffer_load_dword v255,s[16:19],0 offen offset:640 lds
v_mfma_f32_16x16x32_bf16 v[140:143],v[212:215],v[28:31],v[140:143]
s_waitcnt lgkmcnt(2)
v_mfma_f32_16x16x32_bf16 v[128:131],v[216:219],v[32:35],v[128:131]
ds_read_b128 v[232:235],v252 offset:17280
v_mfma_f32_16x16x32_bf16 v[132:135],v[216:219],v[36:39],v[132:135]
v_mfma_f32_16x16x32_bf16 v[136:139],v[216:219],v[40:43],v[136:139]
ds_read_b128 v[236:239],v252 offset:17344
v_mfma_f32_16x16x32_bf16 v[140:143],v[216:219],v[44:47],v[140:143]
buffer_load_dword v255,s[16:19],0 offen offset:768 lds
v_mfma_f32_16x16x32_bf16 v[128:131],v[220:223],v[48:51],v[128:131]
v_mfma_f32_16x16x32_bf16 v[132:135],v[220:223],v[52:55],v[132:135]
v_mfma_f32_16x16x32_bf16 v[136:139],v[220:223],v[56:59],v[136:139]
v_mfma_f32_16x16x32_bf16 v[140:143],v[220:223],v[60:63],v[140:143]
s_waitcnt lgkmcnt(2)
v_mfma_f32_16x16x32_bf16 v[128:131],v[224:227],v[64:67],v[128:131]
ds_read_b128 v[208:211],v252 offset:17408
s_add_u32 m0,s29,33792
v_mfma_f32_16x16x32_bf16 v[132:135],v[224:227],v[68:71],v[132:135]
buffer_load_dwordx4 v254,s[16:19],s32 offen offset:0 lds
s_add_u32 m0,m0,0x000000a0
v_mfma_f32_16x16x32_bf16 v[136:139],v[224:227],v[72:75],v[136:139]
ds_read_b128 v[212:215],v252 offset:17472
v_mfma_f32_16x16x32_bf16 v[140:143],v[224:227],v[76:79],v[140:143]
v_mfma_f32_16x16x32_bf16 v[128:131],v[228:231],v[80:83],v[128:131]
v_mfma_f32_16x16x32_bf16 v[132:135],v[228:231],v[84:87],v[132:135]
buffer_load_dwordx4 v254,s[16:19],s32 offen offset:896 lds
s_add_u32 m0,m0,0x000000a0
v_mfma_f32_16x16x32_bf16 v[136:139],v[228:231],v[88:91],v[136:139]
v_mfma_f32_16x16x32_bf16 v[140:143],v[228:231],v[92:95],v[140:143]
s_waitcnt lgkmcnt(2)
v_mfma_f32_16x16x32_bf16 v[128:131],v[232:235],v[96:99],v[128:131]
ds_read_b128 v[216:219],v252 offset:17536
v_mfma_f32_16x16x32_bf16 v[132:135],v[232:235],v[100:103],v[132:135]
buffer_load_dwordx4 v254,s[16:19],s32 offen offset:1792 lds
s_add_u32 m0,m0,0x000000a0
v_mfma_f32_16x16x32_bf16 v[136:139],v[232:235],v[104:107],v[136:139]
ds_read_b128 v[220:223],v252 offset:17600
v_mfma_f32_16x16x32_bf16 v[140:143],v[232:235],v[108:111],v[140:143]
v_mfma_f32_16x16x32_bf16 v[128:131],v[236:239],v[112:115],v[128:131]
v_mfma_f32_16x16x32_bf16 v[132:135],v[236:239],v[116:119],v[132:135]
buffer_load_dwordx4 v254,s[16:19],s32 offen offset:2688 lds
s_add_u32 s32,s32,0x0001c000
v_mfma_f32_16x16x32_bf16 v[136:139],v[236:239],v[120:123],v[136:139]
s_add_u32 m0,s29,67584
v_mfma_f32_16x16x32_bf16 v[140:143],v[236:239],v[124:127],v[140:143]
s_waitcnt lgkmcnt(2)
v_mfma_f32_16x16x32_bf16 v[144:147],v[208:211],v[0:3],v[192:195]
ds_read_b128 v[224:227],v252 offset:17664
v_mfma_f32_16x16x32_bf16 v[148:151],v[208:211],v[4:7],v[196:199]
buffer_load_dwordx4 v254,s[16:19],s32 offen offset:0 lds
s_add_u32 m0,m0,0x000000a0
v_mfma_f32_16x16x32_bf16 v[152:155],v[208:211],v[8:11],v[200:203]
ds_read_b128 v[228:231],v252 offset:17728
v_mfma_f32_16x16x32_bf16 v[156:159],v[208:211],v[12:15],v[204:207]
v_exp_f32 v248,v128
v_mfma_f32_16x16x32_bf16 v[144:147],v[212:215],v[16:19],v[144:147]
v_exp_f32 v249,v129
v_mfma_f32_16x16x32_bf16 v[148:151],v[212:215],v[20:23],v[148:151]
buffer_load_dwordx4 v254,s[16:19],s32 offen offset:896 lds
s_add_u32 m0,m0,0x000000a0
v_mfma_f32_16x16x32_bf16 v[152:155],v[212:215],v[24:27],v[152:155]
v_exp_f32 v250,v130
v_mfma_f32_16x16x32_bf16 v[156:159],v[212:215],v[28:31],v[156:159]
v_add_f32 v244,v248,v249
s_waitcnt lgkmcnt(2)
v_mfma_f32_16x16x32_bf16 v[144:147],v[216:219],v[32:35],v[144:147]
ds_read_b128 v[232:235],v252 offset:17792
v_cvt_pk_bf16_f32 v160,v248,v249
v_mfma_f32_16x16x32_bf16 v[148:151],v[216:219],v[36:39],v[148:151]
buffer_load_dwordx4 v254,s[16:19],s32 offen offset:1792 lds
s_add_u32 m0,m0,0x000000a0
v_mfma_f32_16x16x32_bf16 v[152:155],v[216:219],v[40:43],v[152:155]
ds_read_b128 v[236:239],v252 offset:17856
v_mfma_f32_16x16x32_bf16 v[156:159],v[216:219],v[44:47],v[156:159]
v_exp_f32 v251,v131
v_mfma_f32_16x16x32_bf16 v[144:147],v[220:223],v[48:51],v[144:147]
v_exp_f32 v248,v132
v_mfma_f32_16x16x32_bf16 v[148:151],v[220:223],v[52:55],v[148:151]
buffer_load_dwordx4 v254,s[16:19],s32 offen offset:2688 lds
s_add_u32 s32,s32,0x0001c000
v_mfma_f32_16x16x32_bf16 v[152:155],v[220:223],v[56:59],v[152:155]
v_exp_f32 v249,v133
v_mfma_f32_16x16x32_bf16 v[156:159],v[220:223],v[60:63],v[156:159]
v_add_f32 v244,v244,v250
s_waitcnt lgkmcnt(2)
v_mfma_f32_16x16x32_bf16 v[144:147],v[224:227],v[64:67],v[144:147]
ds_read_b64_tr_b16 v[208:209],v253 offset:16896
v_subrev_u32 v252,s33,v252
v_mfma_f32_16x16x32_bf16 v[148:151],v[224:227],v[68:71],v[148:151]
ds_read_b64_tr_b16 v[210:211],v253 offset:17408
v_add_f32 v244,v244,v251
v_mfma_f32_16x16x32_bf16 v[152:155],v[224:227],v[72:75],v[152:155]
ds_read_b64_tr_b16 v[212:213],v253 offset:16928
v_cvt_pk_bf16_f32 v161,v250,v251
v_mfma_f32_16x16x32_bf16 v[156:159],v[224:227],v[76:79],v[156:159]
ds_read_b64_tr_b16 v[214:215],v253 offset:17440
v_add_f32 v245,v248,v249
v_mfma_f32_16x16x32_bf16 v[144:147],v[228:231],v[80:83],v[144:147]
v_exp_f32 v250,v134
v_mfma_f32_16x16x32_bf16 v[148:151],v[228:231],v[84:87],v[148:151]
v_exp_f32 v251,v135
v_mfma_f32_16x16x32_bf16 v[152:155],v[228:231],v[88:91],v[152:155]
v_cvt_pk_bf16_f32 v164,v248,v249
v_mfma_f32_16x16x32_bf16 v[156:159],v[228:231],v[92:95],v[156:159]
v_add_f32 v245,v245,v250
s_waitcnt lgkmcnt(4)
v_mfma_f32_16x16x32_bf16 v[144:147],v[232:235],v[96:99],v[144:147]
ds_read_b64_tr_b16 v[216:217],v253 offset:16960
v_add_f32 v245,v245,v251
v_mfma_f32_16x16x32_bf16 v[148:151],v[232:235],v[100:103],v[148:151]
ds_read_b64_tr_b16 v[218:219],v253 offset:17472
v_cvt_pk_bf16_f32 v165,v250,v251
v_mfma_f32_16x16x32_bf16 v[152:155],v[232:235],v[104:107],v[152:155]
ds_read_b64_tr_b16 v[220:221],v253 offset:16992
v_mfma_f32_16x16x32_bf16 v[156:159],v[232:235],v[108:111],v[156:159]
ds_read_b64_tr_b16 v[222:223],v253 offset:17504
v_mfma_f32_16x16x32_bf16 v[144:147],v[236:239],v[112:115],v[144:147]
s_add_u32 s34,s34,s33
s_sub_u32 s35,s35,s33
v_mfma_f32_16x16x32_bf16 v[148:151],v[236:239],v[116:119],v[148:151]
v_exp_f32 v248,v136
v_mfma_f32_16x16x32_bf16 v[152:155],v[236:239],v[120:123],v[152:155]
v_exp_f32 v249,v137
v_mfma_f32_16x16x32_bf16 v[156:159],v[236:239],v[124:127],v[156:159]
v_add_f32 v246,v248,v249
s_waitcnt lgkmcnt(4)
v_mfma_f32_16x16x32_bf16 a[0:3],v[208:211],v[176:179],a[0:3]
ds_read_b64_tr_b16 v[224:225],v253 offset:17024
v_cvt_pk_bf16_f32 v168,v248,v249
v_mfma_f32_16x16x32_bf16 a[4:7],v[208:211],v[180:183],a[4:7]
ds_read_b64_tr_b16 v[226:227],v253 offset:17536
v_mfma_f32_16x16x32_bf16 a[8:11],v[208:211],v[184:187],a[8:11]
ds_read_b64_tr_b16 v[228:229],v253 offset:17056
v_mfma_f32_16x16x32_bf16 a[12:15],v[208:211],v[188:191],a[12:15]
ds_read_b64_tr_b16 v[230:231],v253 offset:17568
v_mfma_f32_16x16x32_bf16 a[16:19],v[212:215],v[176:179],a[16:19]
v_exp_f32 v250,v138
v_mfma_f32_16x16x32_bf16 a[20:23],v[212:215],v[180:183],a[20:23]
v_exp_f32 v251,v139
v_mfma_f32_16x16x32_bf16 a[24:27],v[212:215],v[184:187],a[24:27]
v_exp_f32 v248,v140
v_mfma_f32_16x16x32_bf16 a[28:31],v[212:215],v[188:191],a[28:31]
v_add_f32 v246,v246,v250
s_waitcnt lgkmcnt(4)
v_mfma_f32_16x16x32_bf16 a[32:35],v[216:219],v[176:179],a[32:35]
ds_read_b64_tr_b16 v[232:233],v253 offset:17088
v_add_f32 v246,v246,v251
v_mfma_f32_16x16x32_bf16 a[36:39],v[216:219],v[180:183],a[36:39]
ds_read_b64_tr_b16 v[234:235],v253 offset:17600
v_cvt_pk_bf16_f32 v169,v250,v251
v_mfma_f32_16x16x32_bf16 a[40:43],v[216:219],v[184:187],a[40:43]
ds_read_b64_tr_b16 v[236:237],v253 offset:17120
v_mfma_f32_16x16x32_bf16 a[44:47],v[216:219],v[188:191],a[44:47]
ds_read_b64_tr_b16 v[238:239],v253 offset:17632
v_mfma_f32_16x16x32_bf16 a[48:51],v[220:223],v[176:179],a[48:51]
v_exp_f32 v249,v141
v_mfma_f32_16x16x32_bf16 a[52:55],v[220:223],v[180:183],a[52:55]
v_exp_f32 v250,v142
v_mfma_f32_16x16x32_bf16 a[56:59],v[220:223],v[184:187],a[56:59]
v_exp_f32 v251,v143
v_mfma_f32_16x16x32_bf16 a[60:63],v[220:223],v[188:191],a[60:63]
v_add_f32 v247,v248,v249
s_waitcnt lgkmcnt(4)
v_mfma_f32_16x16x32_bf16 a[64:67],v[224:227],v[176:179],a[64:67]
ds_read_b64_tr_b16 v[208:209],v253 offset:17152
v_cvt_pk_bf16_f32 v172,v248,v249
v_mfma_f32_16x16x32_bf16 a[68:71],v[224:227],v[180:183],a[68:71]
ds_read_b64_tr_b16 v[210:211],v253 offset:17664
v_add_f32 v247,v247,v250
v_mfma_f32_16x16x32_bf16 a[72:75],v[224:227],v[184:187],a[72:75]
ds_read_b64_tr_b16 v[212:213],v253 offset:17184
v_add_f32 v247,v247,v251
v_mfma_f32_16x16x32_bf16 a[76:79],v[224:227],v[188:191],a[76:79]
ds_read_b64_tr_b16 v[214:215],v253 offset:17696
v_cvt_pk_bf16_f32 v173,v250,v251
v_mfma_f32_16x16x32_bf16 a[80:83],v[228:231],v[176:179],a[80:83]
v_exp_f32 v248,v144
v_mfma_f32_16x16x32_bf16 a[84:87],v[228:231],v[180:183],a[84:87]
v_exp_f32 v249,v145
v_mfma_f32_16x16x32_bf16 a[88:91],v[228:231],v[184:187],a[88:91]
v_exp_f32 v250,v146
v_mfma_f32_16x16x32_bf16 a[92:95],v[228:231],v[188:191],a[92:95]
v_add_f32 v244,v244,v248
s_waitcnt lgkmcnt(4)
v_mfma_f32_16x16x32_bf16 a[96:99],v[232:235],v[176:179],a[96:99]
ds_read_b64_tr_b16 v[216:217],v253 offset:17216
v_add_f32 v244,v244,v249
v_mfma_f32_16x16x32_bf16 a[100:103],v[232:235],v[180:183],a[100:103]
ds_read_b64_tr_b16 v[218:219],v253 offset:17728
v_cvt_pk_bf16_f32 v162,v248,v249
v_mfma_f32_16x16x32_bf16 a[104:107],v[232:235],v[184:187],a[104:107]
ds_read_b64_tr_b16 v[220:221],v253 offset:17248
v_mfma_f32_16x16x32_bf16 a[108:111],v[232:235],v[188:191],a[108:111]
ds_read_b64_tr_b16 v[222:223],v253 offset:17760
v_mfma_f32_16x16x32_bf16 a[112:115],v[236:239],v[176:179],a[112:115]
v_exp_f32 v251,v147
v_mfma_f32_16x16x32_bf16 a[116:119],v[236:239],v[180:183],a[116:119]
v_exp_f32 v248,v148
v_mfma_f32_16x16x32_bf16 a[120:123],v[236:239],v[184:187],a[120:123]
v_exp_f32 v249,v149
v_mfma_f32_16x16x32_bf16 a[124:127],v[236:239],v[188:191],a[124:127]
v_add_f32 v244,v244,v250
s_waitcnt lgkmcnt(4)
v_mfma_f32_16x16x32_bf16 a[128:131],v[208:211],v[176:179],a[128:131]
ds_read_b64_tr_b16 v[224:225],v253 offset:17280
v_add_f32 v244,v244,v251
v_mfma_f32_16x16x32_bf16 a[132:135],v[208:211],v[180:183],a[132:135]
ds_read_b64_tr_b16 v[226:227],v253 offset:17792
v_cvt_pk_bf16_f32 v163,v250,v251
v_mfma_f32_16x16x32_bf16 a[136:139],v[208:211],v[184:187],a[136:139]
ds_read_b64_tr_b16 v[228:229],v253 offset:17312
v_add_f32 v245,v245,v248
v_mfma_f32_16x16x32_bf16 a[140:143],v[208:211],v[188:191],a[140:143]
ds_read_b64_tr_b16 v[230:231],v253 offset:17824
v_add_f32 v245,v245,v249
v_mfma_f32_16x16x32_bf16 a[144:147],v[212:215],v[176:179],a[144:147]
v_exp_f32 v250,v150
v_mfma_f32_16x16x32_bf16 a[148:151],v[212:215],v[180:183],a[148:151]
v_exp_f32 v251,v151
v_mfma_f32_16x16x32_bf16 a[152:155],v[212:215],v[184:187],a[152:155]
v_cvt_pk_bf16_f32 v166,v248,v249
v_mfma_f32_16x16x32_bf16 a[156:159],v[212:215],v[188:191],a[156:159]
v_add_f32 v245,v245,v250
s_waitcnt lgkmcnt(4)
v_mfma_f32_16x16x32_bf16 a[160:163],v[216:219],v[176:179],a[160:163]
ds_read_b64_tr_b16 v[232:233],v253 offset:17344
v_add_f32 v245,v245,v251
v_mfma_f32_16x16x32_bf16 a[164:167],v[216:219],v[180:183],a[164:167]
ds_read_b64_tr_b16 v[234:235],v253 offset:17856
v_cvt_pk_bf16_f32 v167,v250,v251
v_mfma_f32_16x16x32_bf16 a[168:171],v[216:219],v[184:187],a[168:171]
ds_read_b64_tr_b16 v[236:237],v253 offset:17376
v_mfma_f32_16x16x32_bf16 a[172:175],v[216:219],v[188:191],a[172:175]
ds_read_b64_tr_b16 v[238:239],v253 offset:17888
v_mfma_f32_16x16x32_bf16 a[176:179],v[220:223],v[176:179],a[176:179]
v_add_u32 v253,s33,v253
s_sub_u32 s33,0,s33
v_mfma_f32_16x16x32_bf16 a[180:183],v[220:223],v[180:183],a[180:183]
v_exp_f32 v248,v152
v_mfma_f32_16x16x32_bf16 a[184:187],v[220:223],v[184:187],a[184:187]
v_exp_f32 v249,v153
v_mfma_f32_16x16x32_bf16 a[188:191],v[220:223],v[188:191],a[188:191]
v_add_f32 v246,v246,v248
s_waitcnt lgkmcnt(4)
v_mfma_f32_16x16x32_bf16 a[192:195],v[224:227],v[176:179],a[192:195]
v_exp_f32 v250,v154
v_mfma_f32_16x16x32_bf16 a[196:199],v[224:227],v[180:183],a[196:199]
s_waitcnt vmcnt(21) lgkmcnt(0)
s_barrier
v_mfma_f32_16x16x32_bf16 a[200:203],v[224:227],v[184:187],a[200:203]
ds_read_b128 v[208:211],v252 offset:0
v_add_f32 v246,v246,v249
v_mfma_f32_16x16x32_bf16 a[204:207],v[224:227],v[188:191],a[204:207]
v_exp_f32 v251,v155
v_mfma_f32_16x16x32_bf16 a[208:211],v[228:231],v[176:179],a[208:211]
ds_read_b128 v[212:215],v252 offset:64
v_cvt_pk_bf16_f32 v170,v248,v249
v_mfma_f32_16x16x32_bf16 a[212:215],v[228:231],v[180:183],a[212:215]
v_exp_f32 v248,v156
v_mfma_f32_16x16x32_bf16 a[216:219],v[228:231],v[184:187],a[216:219]
v_exp_f32 v249,v157
v_mfma_f32_16x16x32_bf16 a[220:223],v[228:231],v[188:191],a[220:223]
v_add_f32 v246,v246,v250
v_add_f32 v246,v246,v251
v_mfma_f32_16x16x32_bf16 a[224:227],v[232:235],v[176:179],a[224:227]
ds_read_b128 v[216:219],v252 offset:128
v_cvt_pk_bf16_f32 v171,v250,v251
v_mfma_f32_16x16x32_bf16 a[228:231],v[232:235],v[180:183],a[228:231]
v_exp_f32 v250,v158
v_mfma_f32_16x16x32_bf16 a[232:235],v[232:235],v[184:187],a[232:235]
ds_read_b128 v[220:223],v252 offset:192
v_add_f32 v247,v247,v248
v_mfma_f32_16x16x32_bf16 a[236:239],v[232:235],v[188:191],a[236:239]
v_exp_f32 v251,v159
v_mfma_f32_16x16x32_bf16 a[240:243],v[236:239],v[176:179],a[240:243]
v_add_f32 v247,v247,v249
v_cvt_pk_bf16_f32 v174,v248,v249
v_mfma_f32_16x16x32_bf16 a[244:247],v[236:239],v[180:183],a[244:247]
v_add_f32 v247,v247,v250
v_add_f32 v247,v247,v251
v_mfma_f32_16x16x32_bf16 a[248:251],v[236:239],v[184:187],a[248:251]
v_cvt_pk_bf16_f32 v175,v250,v251
s_waitcnt lgkmcnt(2)
v_mfma_f32_16x16x32_bf16 a[252:255],v[236:239],v[188:191],a[252:255]
v_max3_f32 v248,v244,v245,v246
v_max_f32 v248,v248,v247
v_cmp_lt_f32 vcc,0x49800000,v248
s_cbranch_vccnz L_stub8
L_back8:
v_mfma_f32_16x16x32_bf16 v[128:131],v[208:211],v[0:3],v[192:195]
ds_read_b128 v[224:227],v252 offset:256
s_add_u32 m0,s29,50688
v_mfma_f32_16x16x32_bf16 v[132:135],v[208:211],v[4:7],v[196:199]
buffer_load_dwordx4 v254,s[16:19],s32 offen offset:0 lds
s_add_u32 m0,m0,0x000000a0
v_mfma_f32_16x16x32_bf16 v[136:139],v[208:211],v[8:11],v[200:203]
ds_read_b128 v[228:231],v252 offset:320
v_add_f32 v240,v240,v244
v_mfma_f32_16x16x32_bf16 v[140:143],v[208:211],v[12:15],v[204:207]
v_add_f32 v241,v241,v245
v_add_f32 v242,v242,v246
v_mfma_f32_16x16x32_bf16 v[128:131],v[212:215],v[16:19],v[128:131]
v_add_f32 v243,v243,v247
v_mbcnt_lo_u32_b32 v255,-1,0
v_mfma_f32_16x16x32_bf16 v[132:135],v[212:215],v[20:23],v[132:135]
buffer_load_dwordx4 v254,s[16:19],s32 offen offset:896 lds
s_add_u32 m0,m0,0x000000a0
v_mfma_f32_16x16x32_bf16 v[136:139],v[212:215],v[24:27],v[136:139]
v_mbcnt_hi_u32_b32 v255,-1,v255
v_lshlrev_b32 v255,4,v255
v_mfma_f32_16x16x32_bf16 v[140:143],v[212:215],v[28:31],v[140:143]
s_waitcnt lgkmcnt(2)
v_mfma_f32_16x16x32_bf16 v[128:131],v[216:219],v[32:35],v[128:131]
ds_read_b128 v[232:235],v252 offset:384
v_mfma_f32_16x16x32_bf16 v[132:135],v[216:219],v[36:39],v[132:135]
buffer_load_dwordx4 v254,s[16:19],s32 offen offset:1792 lds
s_add_u32 m0,m0,0x000000a0
v_mfma_f32_16x16x32_bf16 v[136:139],v[216:219],v[40:43],v[136:139]
ds_read_b128 v[236:239],v252 offset:448
v_mfma_f32_16x16x32_bf16 v[140:143],v[216:219],v[44:47],v[140:143]
v_mfma_f32_16x16x32_bf16 v[128:131],v[220:223],v[48:51],v[128:131]
v_mfma_f32_16x16x32_bf16 v[132:135],v[220:223],v[52:55],v[132:135]
buffer_load_dwordx4 v254,s[16:19],s32 offen offset:2688 lds
s_add_u32 s32,s32,0xfffac080
v_mfma_f32_16x16x32_bf16 v[136:139],v[220:223],v[56:59],v[136:139]
s_add_u32 m0,s29,84480
v_mfma_f32_16x16x32_bf16 v[140:143],v[220:223],v[60:63],v[140:143]
s_waitcnt lgkmcnt(2)
v_mfma_f32_16x16x32_bf16 v[128:131],v[224:227],v[64:67],v[128:131]
ds_read_b128 v[208:211],v252 offset:512
v_mfma_f32_16x16x32_bf16 v[132:135],v[224:227],v[68:71],v[132:135]
buffer_load_dwordx4 v254,s[16:19],s32 offen offset:0 lds
s_add_u32 m0,m0,0x000000a0
v_mfma_f32_16x16x32_bf16 v[136:139],v[224:227],v[72:75],v[136:139]
ds_read_b128 v[212:215],v252 offset:576
v_mfma_f32_16x16x32_bf16 v[140:143],v[224:227],v[76:79],v[140:143]
v_mfma_f32_16x16x32_bf16 v[128:131],v[228:231],v[80:83],v[128:131]
v_mfma_f32_16x16x32_bf16 v[132:135],v[228:231],v[84:87],v[132:135]
buffer_load_dwordx4 v254,s[16:19],s32 offen offset:896 lds
s_add_u32 m0,m0,0x000000a0
v_mfma_f32_16x16x32_bf16 v[136:139],v[228:231],v[88:91],v[136:139]
v_mfma_f32_16x16x32_bf16 v[140:143],v[228:231],v[92:95],v[140:143]
s_waitcnt lgkmcnt(2)
v_mfma_f32_16x16x32_bf16 v[128:131],v[232:235],v[96:99],v[128:131]
ds_read_b128 v[216:219],v252 offset:640
v_mfma_f32_16x16x32_bf16 v[132:135],v[232:235],v[100:103],v[132:135]
buffer_load_dwordx4 v254,s[16:19],s32 offen offset:1792 lds
s_add_u32 m0,m0,0x000000a0
v_mfma_f32_16x16x32_bf16 v[136:139],v[232:235],v[104:107],v[136:139]
ds_read_b128 v[220:223],v252 offset:704
v_mfma_f32_16x16x32_bf16 v[140:143],v[232:235],v[108:111],v[140:143]
v_mfma_f32_16x16x32_bf16 v[128:131],v[236:239],v[112:115],v[128:131]
v_mfma_f32_16x16x32_bf16 v[132:135],v[236:239],v[116:119],v[132:135]
buffer_load_dwordx4 v254,s[16:19],s32 offen offset:2688 lds
s_add_u32 s32,s32,0x0001c000
v_mfma_f32_16x16x32_bf16 v[136:139],v[236:239],v[120:123],v[136:139]
v_mfma_f32_16x16x32_bf16 v[140:143],v[236:239],v[124:127],v[140:143]
s_waitcnt lgkmcnt(2)
v_mfma_f32_16x16x32_bf16 v[144:147],v[208:211],v[0:3],v[192:195]
ds_read_b128 v[224:227],v252 offset:768
v_mfma_f32_16x16x32_bf16 v[148:151],v[208:211],v[4:7],v[196:199]
v_mfma_f32_16x16x32_bf16 v[152:155],v[208:211],v[8:11],v[200:203]
ds_read_b128 v[228:231],v252 offset:832
v_mfma_f32_16x16x32_bf16 v[156:159],v[208:211],v[12:15],v[204:207]
v_exp_f32 v248,v128
v_mfma_f32_16x16x32_bf16 v[144:147],v[212:215],v[16:19],v[144:147]
v_exp_f32 v249,v129
v_mfma_f32_16x16x32_bf16 v[148:151],v[212:215],v[20:23],v[148:151]
v_exp_f32 v250,v130
v_mfma_f32_16x16x32_bf16 v[152:155],v[212:215],v[24:27],v[152:155]
v_exp_f32 v251,v131
v_mfma_f32_16x16x32_bf16 v[156:159],v[212:215],v[28:31],v[156:159]
v_add_f32 v244,v248,v249
s_waitcnt lgkmcnt(2)
v_mfma_f32_16x16x32_bf16 v[144:147],v[216:219],v[32:35],v[144:147]
ds_read_b128 v[232:235],v252 offset:896
v_cvt_pk_bf16_f32 v176,v248,v249
v_mfma_f32_16x16x32_bf16 v[148:151],v[216:219],v[36:39],v[148:151]
v_exp_f32 v248,v132
v_mfma_f32_16x16x32_bf16 v[152:155],v[216:219],v[40:43],v[152:155]
ds_read_b128 v[236:239],v252 offset:960
v_add_f32 v244,v244,v250
v_mfma_f32_16x16x32_bf16 v[156:159],v[216:219],v[44:47],v[156:159]
v_exp_f32 v249,v133
v_mfma_f32_16x16x32_bf16 v[144:147],v[220:223],v[48:51],v[144:147]
v_add_f32 v244,v244,v251
v_cvt_pk_bf16_f32 v177,v250,v251
v_mfma_f32_16x16x32_bf16 v[148:151],v[220:223],v[52:55],v[148:151]
v_exp_f32 v250,v134
v_mfma_f32_16x16x32_bf16 v[152:155],v[220:223],v[56:59],v[152:155]
v_exp_f32 v251,v135
v_mfma_f32_16x16x32_bf16 v[156:159],v[220:223],v[60:63],v[156:159]
v_add_f32 v245,v248,v249
s_waitcnt lgkmcnt(2)
v_mfma_f32_16x16x32_bf16 v[144:147],v[224:227],v[64:67],v[144:147]
ds_read_b64_tr_b16 v[208:209],v253 offset:0
v_cvt_pk_bf16_f32 v180,v248,v249
v_mfma_f32_16x16x32_bf16 v[148:151],v[224:227],v[68:71],v[148:151]
ds_read_b64_tr_b16 v[210:211],v253 offset:512
v_add_f32 v245,v245,v250
v_mfma_f32_16x16x32_bf16 v[152:155],v[224:227],v[72:75],v[152:155]
ds_read_b64_tr_b16 v[212:213],v253 offset:32
v_add_f32 v245,v245,v251
v_mfma_f32_16x16x32_bf16 v[156:159],v[224:227],v[76:79],v[156:159]
ds_read_b64_tr_b16 v[214:215],v253 offset:544
v_cvt_pk_bf16_f32 v181,v250,v251
v_mfma_f32_16x16x32_bf16 v[144:147],v[228:231],v[80:83],v[144:147]
v_exp_f32 v248,v136
v_mfma_f32_16x16x32_bf16 v[148:151],v[228:231],v[84:87],v[148:151]
v_exp_f32 v249,v137
v_mfma_f32_16x16x32_bf16 v[152:155],v[228:231],v[88:91],v[152:155]
v_exp_f32 v250,v138
v_mfma_f32_16x16x32_bf16 v[156:159],v[228:231],v[92:95],v[156:159]
v_add_f32 v246,v248,v249
s_waitcnt lgkmcnt(4)
v_mfma_f32_16x16x32_bf16 v[144:147],v[232:235],v[96:99],v[144:147]
ds_read_b64_tr_b16 v[216:217],v253 offset:64
v_cvt_pk_bf16_f32 v184,v248,v249
v_mfma_f32_16x16x32_bf16 v[148:151],v[232:235],v[100:103],v[148:151]
ds_read_b64_tr_b16 v[218:219],v253 offset:576
v_mfma_f32_16x16x32_bf16 v[152:155],v[232:235],v[104:107],v[152:155]
ds_read_b64_tr_b16 v[220:221],v253 offset:96
v_mfma_f32_16x16x32_bf16 v[156:159],v[232:235],v[108:111],v[156:159]
ds_read_b64_tr_b16 v[222:223],v253 offset:608
v_mfma_f32_16x16x32_bf16 v[144:147],v[236:239],v[112:115],v[144:147]
v_exp_f32 v251,v139
v_mfma_f32_16x16x32_bf16 v[148:151],v[236:239],v[116:119],v[148:151]
v_exp_f32 v248,v140
v_mfma_f32_16x16x32_bf16 v[152:155],v[236:239],v[120:123],v[152:155]
v_exp_f32 v249,v141
v_mfma_f32_16x16x32_bf16 v[156:159],v[236:239],v[124:127],v[156:159]
v_add_f32 v246,v246,v250
s_waitcnt lgkmcnt(4)
v_mfma_f32_16x16x32_bf16 a[0:3],v[208:211],v[160:163],a[0:3]
ds_read_b64_tr_b16 v[224:225],v253 offset:128
v_add_f32 v246,v246,v251
v_mfma_f32_16x16x32_bf16 a[4:7],v[208:211],v[164:167],a[4:7]
ds_read_b64_tr_b16 v[226:227],v253 offset:640
v_cvt_pk_bf16_f32 v185,v250,v251
v_mfma_f32_16x16x32_bf16 a[8:11],v[208:211],v[168:171],a[8:11]
ds_read_b64_tr_b16 v[228:229],v253 offset:160
v_add_f32 v247,v248,v249
v_mfma_f32_16x16x32_bf16 a[12:15],v[208:211],v[172:175],a[12:15]
ds_read_b64_tr_b16 v[230:231],v253 offset:672
buffer_load_dwordx4 v[0:3],v255,s[20:23],s62 offen offset:0
v_mfma_f32_16x16x32_bf16 a[16:19],v[212:215],v[160:163],a[16:19]
v_exp_f32 v250,v142
v_mfma_f32_16x16x32_bf16 a[20:23],v[212:215],v[164:167],a[20:23]
v_exp_f32 v251,v143
v_mfma_f32_16x16x32_bf16 a[24:27],v[212:215],v[168:171],a[24:27]
v_cvt_pk_bf16_f32 v188,v248,v249
v_mfma_f32_16x16x32_bf16 a[28:31],v[212:215],v[172:175],a[28:31]
v_add_f32 v247,v247,v250
s_waitcnt lgkmcnt(4)
v_mfma_f32_16x16x32_bf16 a[32:35],v[216:219],v[160:163],a[32:35]
ds_read_b64_tr_b16 v[232:233],v253 offset:192
v_add_f32 v247,v247,v251
v_mfma_f32_16x16x32_bf16 a[36:39],v[216:219],v[164:167],a[36:39]
ds_read_b64_tr_b16 v[234:235],v253 offset:704
v_cvt_pk_bf16_f32 v189,v250,v251
v_mfma_f32_16x16x32_bf16 a[40:43],v[216:219],v[168:171],a[40:43]
ds_read_b64_tr_b16 v[236:237],v253 offset:224
v_mfma_f32_16x16x32_bf16 a[44:47],v[216:219],v[172:175],a[44:47]
ds_read_b64_tr_b16 v[238:239],v253 offset:736
v_mfma_f32_16x16x32_bf16 a[48:51],v[220:223],v[160:163],a[48:51]
v_exp_f32 v248,v144
v_mfma_f32_16x16x32_bf16 a[52:55],v[220:223],v[164:167],a[52:55]
v_exp_f32 v249,v145
v_mfma_f32_16x16x32_bf16 a[56:59],v[220:223],v[168:171],a[56:59]
v_exp_f32 v250,v146
v_mfma_f32_16x16x32_bf16 a[60:63],v[220:223],v[172:175],a[60:63]
v_add_f32 v244,v244,v248
s_waitcnt lgkmcnt(4)
v_mfma_f32_16x16x32_bf16 a[64:67],v[224:227],v[160:163],a[64:67]
ds_read_b64_tr_b16 v[208:209],v253 offset:256
v_add_f32 v244,v244,v249
v_mfma_f32_16x16x32_bf16 a[68:71],v[224:227],v[164:167],a[68:71]
ds_read_b64_tr_b16 v[210:211],v253 offset:768
v_cvt_pk_bf16_f32 v178,v248,v249
v_mfma_f32_16x16x32_bf16 a[72:75],v[224:227],v[168:171],a[72:75]
ds_read_b64_tr_b16 v[212:213],v253 offset:288
v_mfma_f32_16x16x32_bf16 a[76:79],v[224:227],v[172:175],a[76:79]
ds_read_b64_tr_b16 v[214:215],v253 offset:800
v_mfma_f32_16x16x32_bf16 a[80:83],v[228:231],v[160:163],a[80:83]
v_exp_f32 v251,v147
v_mfma_f32_16x16x32_bf16 a[84:87],v[228:231],v[164:167],a[84:87]
v_exp_f32 v248,v148
v_mfma_f32_16x16x32_bf16 a[88:91],v[228:231],v[168:171],a[88:91]
v_exp_f32 v249,v149
v_mfma_f32_16x16x32_bf16 a[92:95],v[228:231],v[172:175],a[92:95]
v_add_f32 v244,v244,v250
s_waitcnt lgkmcnt(4)
v_mfma_f32_16x16x32_bf16 a[96:99],v[232:235],v[160:163],a[96:99]
ds_read_b64_tr_b16 v[216:217],v253 offset:320
v_add_f32 v244,v244,v251
v_mfma_f32_16x16x32_bf16 a[100:103],v[232:235],v[164:167],a[100:103]
ds_read_b64_tr_b16 v[218:219],v253 offset:832
v_cvt_pk_bf16_f32 v179,v250,v251
v_mfma_f32_16x16x32_bf16 a[104:107],v[232:235],v[168:171],a[104:107]
ds_read_b64_tr_b16 v[220:221],v253 offset:352
v_add_f32 v245,v245,v248
v_mfma_f32_16x16x32_bf16 a[108:111],v[232:235],v[172:175],a[108:111]
ds_read_b64_tr_b16 v[222:223],v253 offset:864
v_add_f32 v245,v245,v249
v_mfma_f32_16x16x32_bf16 a[112:115],v[236:239],v[160:163],a[112:115]
v_exp_f32 v250,v150
v_mfma_f32_16x16x32_bf16 a[116:119],v[236:239],v[164:167],a[116:119]
v_exp_f32 v251,v151
v_mfma_f32_16x16x32_bf16 a[120:123],v[236:239],v[168:171],a[120:123]
v_cvt_pk_bf16_f32 v182,v248,v249
v_mfma_f32_16x16x32_bf16 a[124:127],v[236:239],v[172:175],a[124:127]
v_add_f32 v245,v245,v250
s_waitcnt lgkmcnt(4)
v_mfma_f32_16x16x32_bf16 a[128:131],v[208:211],v[160:163],a[128:131]
ds_read_b64_tr_b16 v[224:225],v253 offset:384
v_add_f32 v245,v245,v251
v_mfma_f32_16x16x32_bf16 a[132:135],v[208:211],v[164:167],a[132:135]
ds_read_b64_tr_b16 v[226:227],v253 offset:896
v_cvt_pk_bf16_f32 v183,v250,v251
v_mfma_f32_16x16x32_bf16 a[136:139],v[208:211],v[168:171],a[136:139]
ds_read_b64_tr_b16 v[228:229],v253 offset:416
v_mfma_f32_16x16x32_bf16 a[140:143],v[208:211],v[172:175],a[140:143]
ds_read_b64_tr_b16 v[230:231],v253 offset:928
v_mfma_f32_16x16x32_bf16 a[144:147],v[212:215],v[160:163],a[144:147]
v_exp_f32 v248,v152
v_mfma_f32_16x16x32_bf16 a[148:151],v[212:215],v[164:167],a[148:151]
v_exp_f32 v249,v153
v_mfma_f32_16x16x32_bf16 a[152:155],v[212:215],v[168:171],a[152:155]
v_exp_f32 v250,v154
v_mfma_f32_16x16x32_bf16 a[156:159],v[212:215],v[172:175],a[156:159]
v_add_f32 v246,v246,v248
s_waitcnt lgkmcnt(4)
v_mfma_f32_16x16x32_bf16 a[160:163],v[216:219],v[160:163],a[160:163]
ds_read_b64_tr_b16 v[232:233],v253 offset:448
v_add_f32 v246,v246,v249
v_mfma_f32_16x16x32_bf16 a[164:167],v[216:219],v[164:167],a[164:167]
ds_read_b64_tr_b16 v[234:235],v253 offset:960
v_cvt_pk_bf16_f32 v186,v248,v249
v_mfma_f32_16x16x32_bf16 a[168:171],v[216:219],v[168:171],a[168:171]
ds_read_b64_tr_b16 v[236:237],v253 offset:480
v_mfma_f32_16x16x32_bf16 a[172:175],v[216:219],v[172:175],a[172:175]
ds_read_b64_tr_b16 v[238:239],v253 offset:992
v_mfma_f32_16x16x32_bf16 a[176:179],v[220:223],v[160:163],a[176:179]
v_exp_f32 v251,v155
v_mfma_f32_16x16x32_bf16 a[180:183],v[220:223],v[164:167],a[180:183]
v_exp_f32 v248,v156
v_mfma_f32_16x16x32_bf16 a[184:187],v[220:223],v[168:171],a[184:187]
v_exp_f32 v249,v157
v_mfma_f32_16x16x32_bf16 a[188:191],v[220:223],v[172:175],a[188:191]
v_add_f32 v246,v246,v250
s_waitcnt lgkmcnt(4)
v_mfma_f32_16x16x32_bf16 a[192:195],v[224:227],v[160:163],a[192:195]
v_add_f32 v246,v246,v251
v_cvt_pk_bf16_f32 v187,v250,v251
v_mfma_f32_16x16x32_bf16 a[196:199],v[224:227],v[164:167],a[196:199]
s_waitcnt vmcnt(26) lgkmcnt(0)
s_barrier
v_mfma_f32_16x16x32_bf16 a[200:203],v[224:227],v[168:171],a[200:203]
ds_read_b64_tr_b16 v[208:209],v253 offset:16896
v_add_f32 v247,v247,v248
v_mfma_f32_16x16x32_bf16 a[204:207],v[224:227],v[172:175],a[204:207]
ds_read_b64_tr_b16 v[210:211],v253 offset:17408
v_add_f32 v247,v247,v249
v_mfma_f32_16x16x32_bf16 a[208:211],v[228:231],v[160:163],a[208:211]
ds_read_b64_tr_b16 v[212:213],v253 offset:16928
v_cvt_pk_bf16_f32 v190,v248,v249
v_mfma_f32_16x16x32_bf16 a[212:215],v[228:231],v[164:167],a[212:215]
ds_read_b64_tr_b16 v[214:215],v253 offset:17440
v_mfma_f32_16x16x32_bf16 a[216:219],v[228:231],v[168:171],a[216:219]
v_exp_f32 v250,v158
v_mfma_f32_16x16x32_bf16 a[220:223],v[228:231],v[172:175],a[220:223]
v_exp_f32 v251,v159
v_mfma_f32_16x16x32_bf16 a[224:227],v[232:235],v[160:163],a[224:227]
ds_read_b64_tr_b16 v[216:217],v253 offset:16960
v_add_f32 v247,v247,v250
v_mfma_f32_16x16x32_bf16 a[228:231],v[232:235],v[164:167],a[228:231]
ds_read_b64_tr_b16 v[218:219],v253 offset:17472
v_add_f32 v247,v247,v251
v_mfma_f32_16x16x32_bf16 a[232:235],v[232:235],v[168:171],a[232:235]
ds_read_b64_tr_b16 v[220:221],v253 offset:16992
v_cvt_pk_bf16_f32 v191,v250,v251
v_mfma_f32_16x16x32_bf16 a[236:239],v[232:235],v[172:175],a[236:239]
ds_read_b64_tr_b16 v[222:223],v253 offset:17504
v_max3_f32 v248,v244,v245,v246
v_mfma_f32_16x16x32_bf16 a[240:243],v[236:239],v[160:163],a[240:243]
v_max_f32 v248,v248,v247
v_cmp_lt_f32 vcc,0x49800000,v248
v_mfma_f32_16x16x32_bf16 a[244:247],v[236:239],v[164:167],a[244:247]
v_mfma_f32_16x16x32_bf16 a[248:251],v[236:239],v[168:171],a[248:251]
s_waitcnt lgkmcnt(4)
v_mfma_f32_16x16x32_bf16 a[252:255],v[236:239],v[172:175],a[252:255]
s_cbranch_vccnz L_stub9
L_back9:
v_mfma_f32_16x16x32_bf16 a[0:3],v[208:211],v[176:179],a[0:3]
ds_read_b64_tr_b16 v[224:225],v253 offset:17024
s_add_u32 m0,s29,0
v_mfma_f32_16x16x32_bf16 a[4:7],v[208:211],v[180:183],a[4:7]
ds_read_b64_tr_b16 v[226:227],v253 offset:17536
buffer_load_dwordx4 v254,s[16:19],s32 offen offset:0 lds
v_mfma_f32_16x16x32_bf16 a[8:11],v[208:211],v[184:187],a[8:11]
ds_read_b64_tr_b16 v[228:229],v253 offset:17056
s_add_u32 m0,m0,0x000000a0
v_mfma_f32_16x16x32_bf16 a[12:15],v[208:211],v[188:191],a[12:15]
ds_read_b64_tr_b16 v[230:231],v253 offset:17568
v_add_f32 v240,v240,v244
v_mfma_f32_16x16x32_bf16 a[16:19],v[212:215],v[176:179],a[16:19]
v_add_f32 v241,v241,v245
v_add_f32 v242,v242,v246
v_mfma_f32_16x16x32_bf16 a[20:23],v[212:215],v[180:183],a[20:23]
buffer_load_dwordx4 v254,s[16:19],s32 offen offset:896 lds
s_add_u32 m0,m0,0x000000a0
v_mfma_f32_16x16x32_bf16 a[24:27],v[212:215],v[184:187],a[24:27]
v_add_f32 v243,v243,v247
v_mov_b32 v244,v240
v_mfma_f32_16x16x32_bf16 a[28:31],v[212:215],v[188:191],a[28:31]
v_mov_b32 v245,v241
s_waitcnt lgkmcnt(4)
v_mbcnt_lo_u32_b32 v248,-1,0
v_mbcnt_hi_u32_b32 v248,-1,v248
v_lshlrev_b32 v248,4,v248
v_mfma_f32_16x16x32_bf16 a[32:35],v[216:219],v[176:179],a[32:35]
ds_read_b64_tr_b16 v[232:233],v253 offset:17088
v_mov_b32 v246,v242
v_mfma_f32_16x16x32_bf16 a[36:39],v[216:219],v[180:183],a[36:39]
ds_read_b64_tr_b16 v[234:235],v253 offset:17600
buffer_load_dwordx4 v254,s[16:19],s32 offen offset:1792 lds
v_mfma_f32_16x16x32_bf16 a[40:43],v[216:219],v[184:187],a[40:43]
ds_read_b64_tr_b16 v[236:237],v253 offset:17120
s_add_u32 m0,m0,0x000000a0
v_mfma_f32_16x16x32_bf16 a[44:47],v[216:219],v[188:191],a[44:47]
ds_read_b64_tr_b16 v[238:239],v253 offset:17632
v_mov_b32 v247,v243
v_mfma_f32_16x16x32_bf16 a[48:51],v[220:223],v[176:179],a[48:51]
v_permlane32_swap_b32 v244,v240
v_permlane32_swap_b32 v245,v241
v_mfma_f32_16x16x32_bf16 a[52:55],v[220:223],v[180:183],a[52:55]
buffer_load_dwordx4 v254,s[16:19],s32 offen offset:2688 lds
s_add_u32 s32,s32,0x0001c000
v_mfma_f32_16x16x32_bf16 a[56:59],v[220:223],v[184:187],a[56:59]
s_add_u32 m0,s29,101376
v_permlane32_swap_b32 v246,v242
v_mfma_f32_16x16x32_bf16 a[60:63],v[220:223],v[188:191],a[60:63]
v_permlane32_swap_b32 v247,v243
s_waitcnt lgkmcnt(4)
v_mfma_f32_16x16x32_bf16 a[64:67],v[224:227],v[176:179],a[64:67]
ds_read_b64_tr_b16 v[208:209],v253 offset:17152
v_add_f32 v240,v244,v240
v_mfma_f32_16x16x32_bf16 a[68:71],v[224:227],v[180:183],a[68:71]
ds_read_b64_tr_b16 v[210:211],v253 offset:17664
buffer_load_dwordx4 v254,s[16:19],s32 offen offset:0 lds
v_mfma_f32_16x16x32_bf16 a[72:75],v[224:227],v[184:187],a[72:75]
ds_read_b64_tr_b16 v[212:213],v253 offset:17184
s_add_u32 m0,m0,0x000000a0
v_mfma_f32_16x16x32_bf16 a[76:79],v[224:227],v[188:191],a[76:79]
ds_read_b64_tr_b16 v[214:215],v253 offset:17696
v_add_f32 v241,v245,v241
v_mbcnt_lo_u32_b32 v255,-1,0
v_mbcnt_hi_u32_b32 v255,-1,v255
v_bfe_u32 v249,v255,2,2
v_mul_u32_u24 v249,1056,v249
v_lshrrev_b32 v250,4,v255
v_lshl_add_u32 v249,v250,7,v249
v_and_b32 v255,3,v255
v_lshl_add_u32 v255,v255,3,v249
v_add_u32 v255,50688,v255
v_subrev_u32 v252,50688,v255
s_mul_i32 s58,s28,7168
s_add_u32 s58,s58,135168
v_add_u32 v251,s58,v248
v_mfma_f32_16x16x32_bf16 a[80:83],v[228:231],v[176:179],a[80:83]
v_add_f32 v242,v246,v242
v_add_f32 v243,v247,v243
v_mfma_f32_16x16x32_bf16 a[84:87],v[228:231],v[180:183],a[84:87]
buffer_load_dwordx4 v254,s[16:19],s32 offen offset:896 lds
s_add_u32 m0,m0,0x000000a0
v_mfma_f32_16x16x32_bf16 a[88:91],v[228:231],v[184:187],a[88:91]
v_mov_b32 v244,v240
v_mov_b32 v245,v241
v_mfma_f32_16x16x32_bf16 a[92:95],v[228:231],v[188:191],a[92:95]
v_mov_b32 v246,v242
s_waitcnt lgkmcnt(4)
v_mfma_f32_16x16x32_bf16 a[96:99],v[232:235],v[176:179],a[96:99]
ds_read_b64_tr_b16 v[216:217],v253 offset:17216
v_mov_b32 v247,v243
v_mfma_f32_16x16x32_bf16 a[100:103],v[232:235],v[180:183],a[100:103]
ds_read_b64_tr_b16 v[218:219],v253 offset:17728
buffer_load_dwordx4 v254,s[16:19],s32 offen offset:1792 lds
v_mfma_f32_16x16x32_bf16 a[104:107],v[232:235],v[184:187],a[104:107]
ds_read_b64_tr_b16 v[220:221],v253 offset:17248
s_add_u32 m0,m0,0x000000a0
v_mfma_f32_16x16x32_bf16 a[108:111],v[232:235],v[188:191],a[108:111]
ds_read_b64_tr_b16 v[222:223],v253 offset:17760
v_permlane16_swap_b32 v244,v240
v_mfma_f32_16x16x32_bf16 a[112:115],v[236:239],v[176:179],a[112:115]
v_permlane16_swap_b32 v245,v241
v_permlane16_swap_b32 v246,v242
v_mfma_f32_16x16x32_bf16 a[116:119],v[236:239],v[180:183],a[116:119]
buffer_load_dwordx4 v254,s[16:19],s32 offen offset:2688 lds
s_add_u32 s32,s32,0x0001c000
v_mfma_f32_16x16x32_bf16 a[120:123],v[236:239],v[184:187],a[120:123]
v_permlane16_swap_b32 v247,v243
v_add_f32 v240,v244,v240
v_mfma_f32_16x16x32_bf16 a[124:127],v[236:239],v[188:191],a[124:127]
v_add_f32 v241,v245,v241
s_waitcnt lgkmcnt(4)
v_mfma_f32_16x16x32_bf16 a[128:131],v[208:211],v[176:179],a[128:131]
ds_read_b64_tr_b16 v[224:225],v253 offset:17280
v_add_f32 v242,v246,v242
v_mfma_f32_16x16x32_bf16 a[132:135],v[208:211],v[180:183],a[132:135]
ds_read_b64_tr_b16 v[226:227],v253 offset:17792
v_add_f32 v243,v247,v243
v_mfma_f32_16x16x32_bf16 a[136:139],v[208:211],v[184:187],a[136:139]
ds_read_b64_tr_b16 v[228:229],v253 offset:17312
s_lshl_b32 s58,s41,4
v_mfma_f32_16x16x32_bf16 a[140:143],v[208:211],v[188:191],a[140:143]
ds_read_b64_tr_b16 v[230:231],v253 offset:17824
s_add_u32 s58,s58,s40
v_mfma_f32_16x16x32_bf16 a[144:147],v[212:215],v[176:179],a[144:147]
v_rcp_f32 v192,v240
v_mfma_f32_16x16x32_bf16 a[148:151],v[212:215],v[180:183],a[148:151]
v_rcp_f32 v194,v241
v_mfma_f32_16x16x32_bf16 a[152:155],v[212:215],v[184:187],a[152:155]
v_rcp_f32 v196,v242
v_mfma_f32_16x16x32_bf16 a[156:159],v[212:215],v[188:191],a[156:159]
s_lshl_b32 s60,s58,3
s_waitcnt lgkmcnt(4)
v_mfma_f32_16x16x32_bf16 a[160:163],v[216:219],v[176:179],a[160:163]
ds_read_b64_tr_b16 v[232:233],v253 offset:17344
buffer_load_dwordx4 v[4:7],v248,s[20:23],s65 offen offset:0
v_mfma_f32_16x16x32_bf16 a[164:167],v[216:219],v[180:183],a[164:167]
ds_read_b64_tr_b16 v[234:235],v253 offset:17856
buffer_load_dwordx4 v[8:11],v248,s[20:23],s62 offen offset:1024
v_mfma_f32_16x16x32_bf16 a[168:171],v[216:219],v[184:187],a[168:171]
ds_read_b64_tr_b16 v[236:237],v253 offset:17376
buffer_load_dwordx4 v[12:15],v248,s[20:23],s65 offen offset:1024
v_mfma_f32_16x16x32_bf16 a[172:175],v[216:219],v[188:191],a[172:175]
ds_read_b64_tr_b16 v[238:239],v253 offset:17888
buffer_load_dwordx4 v[16:19],v248,s[20:23],s65 offen offset:2048
v_mfma_f32_16x16x32_bf16 a[176:179],v[220:223],v[176:179],a[176:179]
v_add_u32 v253,50688,v255
v_mfma_f32_16x16x32_bf16 a[180:183],v[220:223],v[180:183],a[180:183]
v_rcp_f32 v198,v243
v_mfma_f32_16x16x32_bf16 a[184:187],v[220:223],v[184:187],a[184:187]
s_add_u32 s0,s54,s60
s_addc_u32 s1,s55,0
v_mfma_f32_16x16x32_bf16 a[188:191],v[220:223],v[188:191],a[188:191]
s_mov_b32 s3,0x20000
s_waitcnt lgkmcnt(4)
v_mfma_f32_16x16x32_bf16 a[192:195],v[224:227],v[176:179],a[192:195]
s_lshl_b32 s60,s58,10
s_add_u32 s60,s60,58851328
v_mfma_f32_16x16x32_bf16 a[196:199],v[224:227],v[180:183],a[196:199]
s_waitcnt vmcnt(17) lgkmcnt(0)
s_barrier
v_mfma_f32_16x16x32_bf16 a[200:203],v[224:227],v[184:187],a[200:203]
ds_read_b64_tr_b16 v[208:209],v252 offset:16896
s_add_u32 m0,s29,118272
v_mfma_f32_16x16x32_bf16 a[204:207],v[224:227],v[188:191],a[204:207]
ds_read_b64_tr_b16 v[210:211],v252 offset:17408
buffer_load_dwordx4 v254,s[16:19],s32 offen offset:0 lds
v_mfma_f32_16x16x32_bf16 a[208:211],v[228:231],v[176:179],a[208:211]
ds_read_b64_tr_b16 v[212:213],v252 offset:16928
s_add_u32 m0,m0,0x000000a0
v_mfma_f32_16x16x32_bf16 a[212:215],v[228:231],v[180:183],a[212:215]
ds_read_b64_tr_b16 v[214:215],v252 offset:17440
buffer_load_dwordx4 v254,s[16:19],s32 offen offset:896 lds
v_mfma_f32_16x16x32_bf16 a[216:219],v[228:231],v[184:187],a[216:219]
s_add_u32 m0,m0,0x000000a0
buffer_load_dwordx4 v[20:23],v248,s[20:23],s62 offen offset:3072
v_mfma_f32_16x16x32_bf16 a[220:223],v[228:231],v[188:191],a[220:223]
buffer_load_dwordx4 v254,s[16:19],s32 offen offset:1792 lds
s_add_u32 m0,m0,0x000000a0
v_mfma_f32_16x16x32_bf16 a[224:227],v[232:235],v[176:179],a[224:227]
ds_read_b64_tr_b16 v[216:217],v252 offset:21120
buffer_load_dwordx4 v[24:27],v248,s[20:23],s63 offen offset:3072
v_mfma_f32_16x16x32_bf16 a[228:231],v[232:235],v[180:183],a[228:231]
ds_read_b64_tr_b16 v[218:219],v252 offset:21632
buffer_load_dwordx4 v254,s[16:19],s32 offen offset:2688 lds
v_mfma_f32_16x16x32_bf16 a[232:235],v[232:235],v[184:187],a[232:235]
ds_read_b64_tr_b16 v[220:221],v252 offset:21152
s_add_u32 s32,s32,0xfffac080
v_mfma_f32_16x16x32_bf16 a[236:239],v[232:235],v[188:191],a[236:239]
ds_read_b64_tr_b16 v[222:223],v252 offset:21664
v_mfma_f32_16x16x32_bf16 a[240:243],v[236:239],v[176:179],a[240:243]
s_add_u32 s12,s56,s60
s_addc_u32 s13,s57,0
v_mfma_f32_16x16x32_bf16 a[244:247],v[236:239],v[180:183],a[244:247]
s_lshl_b32 s60,s39,4
v_mfma_f32_16x16x32_bf16 a[248:251],v[236:239],v[184:187],a[248:251]
s_add_u32 s24,s12,s60
s_addc_u32 s25,s13,0
v_mfma_f32_16x16x32_bf16 a[252:255],v[236:239],v[188:191],a[252:255]
s_cmp_eq_u32 s28,0
s_cselect_b32 s26,4,0
s_cselect_b32 s2,4,0
s_cselect_b32 s33,8,0
s_mov_b32 s14,1024
s_mov_b32 s68,-1
s_and_b32 s59,s39,1
s_mul_i32 s58,s58,1835008
s_mul_i32 s60,s28,57344
s_add_u32 s58,s58,s60
s_add_u32 s58,s58,s62
s_lshl_b32 s60,s59,10
s_add_u32 s58,s58,s60
s_add_u32 s4,s56,s58
s_addc_u32 s5,s57,0
s_sub_u32 s4,s4,2048
s_subb_u32 s5,s5,0
s_mov_b32 s6,0
s_mul_i32 s58,s40,240
s_lshl_b32 s60,s28,6
s_add_u32 s58,s58,s60
s_mul_i32 s58,s58,1792
s_lshl_b32 s60,s62,1
s_add_u32 s58,s58,s60
s_mul_i32 s60,s41,896
s_add_u32 s58,s58,s60
s_lshl_b32 s60,s59,6
s_add_u32 s58,s58,s60
s_add_u32 s8,s52,s58
s_addc_u32 s9,s53,0
s_sub_u32 s8,s8,256
s_subb_u32 s9,s9,0
s_mov_b32 s10,0
s_add_u32 s60,s39,1
s_and_b32 s60,s60,7
s_mul_i32 s93,s60,229376
s_add_u32 s60,s39,2
s_and_b32 s60,s60,7
s_mul_i32 s94,s60,229376
s_add_u32 s60,s39,3
s_and_b32 s60,s60,7
s_mul_i32 s95,s60,229376
s_add_u32 s60,s39,4
s_and_b32 s60,s60,7
s_mul_i32 s96,s60,229376
s_add_u32 s60,s39,5
s_and_b32 s60,s60,7
s_mul_i32 s97,s60,229376
s_add_u32 s60,s39,6
s_and_b32 s60,s60,7
s_mul_i32 s98,s60,229376
s_add_u32 s60,s39,7
s_and_b32 s60,s60,7
s_mul_i32 s99,s60,229376
v_mbcnt_lo_u32_b32 v139,-1,0
v_mbcnt_hi_u32_b32 v139,-1,v139
v_and_b32 v136,15,v139
v_add_u32 v138,4,v136
v_lshrrev_b32 v137,3,v138
v_and_b32 v137,1,v137
v_lshrrev_b32 v138,4,v138
v_lshlrev_b32 v138,3,v138
v_sub_u32 v138,v136,v138
v_lshl_add_u32 v138,v137,2,v138
v_mul_u32_u24 v138,1792,v138
v_lshrrev_b32 v136,4,v139
v_lshl_add_u32 v138,v136,4,v138
v_and_b32 v142,7,v139
v_lshlrev_b32 v142,4,v142
v_mov_b32 v143,0
v_mov_b32 v139,0
v_mov_b32 v141,1
buffer_store_dword v139,v248,s[24:27],0 offen sc1
s_and_b32 s58,s39,1
s_lshl_b32 s58,s58,10
v_add_u32 v249,s58,v248
v_xor_b32 v250,1024,v249
v_accvgpr_read_b32 v144,a0
v_accvgpr_read_b32 v145,a1
v_accvgpr_read_b32 v146,a2
v_accvgpr_read_b32 v147,a3
v_accvgpr_read_b32 v148,a16
v_accvgpr_read_b32 v149,a17
v_accvgpr_read_b32 v150,a18
v_accvgpr_read_b32 v151,a19
v_pk_mul_f32 v[144:145],v[144:145],v[192:193] op_sel_hi:[1,0]
v_pk_mul_f32 v[146:147],v[146:147],v[192:193] op_sel_hi:[1,0]
v_pk_mul_f32 v[148:149],v[148:149],v[192:193] op_sel_hi:[1,0]
v_pk_mul_f32 v[150:151],v[150:151],v[192:193] op_sel_hi:[1,0]
v_cvt_pk_bf16_f32 v28,v144,v145
v_cvt_pk_bf16_f32 v29,v146,v147
v_cvt_pk_bf16_f32 v30,v148,v149
v_cvt_pk_bf16_f32 v31,v150,v151
v_accvgpr_read_b32 v152,a4
v_accvgpr_read_b32 v153,a5
v_accvgpr_read_b32 v154,a6
v_accvgpr_read_b32 v155,a7
v_accvgpr_read_b32 v156,a20
v_accvgpr_read_b32 v157,a21
v_accvgpr_read_b32 v158,a22
v_accvgpr_read_b32 v159,a23
v_pk_mul_f32 v[152:153],v[152:153],v[194:195] op_sel_hi:[1,0]
v_pk_mul_f32 v[154:155],v[154:155],v[194:195] op_sel_hi:[1,0]
v_pk_mul_f32 v[156:157],v[156:157],v[194:195] op_sel_hi:[1,0]
v_pk_mul_f32 v[158:159],v[158:159],v[194:195] op_sel_hi:[1,0]
v_cvt_pk_bf16_f32 v32,v152,v153
v_cvt_pk_bf16_f32 v33,v154,v155
v_cvt_pk_bf16_f32 v34,v156,v157
v_cvt_pk_bf16_f32 v35,v158,v159
v_accvgpr_read_b32 v160,a8
v_accvgpr_read_b32 v161,a9
v_accvgpr_read_b32 v162,a10
v_accvgpr_read_b32 v163,a11
v_accvgpr_read_b32 v164,a24
v_accvgpr_read_b32 v165,a25
v_accvgpr_read_b32 v166,a26
v_accvgpr_read_b32 v167,a27
v_pk_mul_f32 v[160:161],v[160:161],v[196:197] op_sel_hi:[1,0]
v_pk_mul_f32 v[162:163],v[162:163],v[196:197] op_sel_hi:[1,0]
v_pk_mul_f32 v[164:165],v[164:165],v[196:197] op_sel_hi:[1,0]
v_pk_mul_f32 v[166:167],v[166:167],v[196:197] op_sel_hi:[1,0]
v_cvt_pk_bf16_f32 v36,v160,v161
v_cvt_pk_bf16_f32 v37,v162,v163
v_cvt_pk_bf16_f32 v38,v164,v165
v_cvt_pk_bf16_f32 v39,v166,v167
buffer_load_dwordx4 a[0:3],v248,s[20:23],s64 offen offset:3072
v_accvgpr_read_b32 v168,a12
v_accvgpr_read_b32 v169,a13
v_accvgpr_read_b32 v170,a14
v_accvgpr_read_b32 v171,a15
v_accvgpr_read_b32 v172,a28
v_accvgpr_read_b32 v173,a29
v_accvgpr_read_b32 v174,a30
v_accvgpr_read_b32 v175,a31
v_pk_mul_f32 v[168:169],v[168:169],v[198:199] op_sel_hi:[1,0]
v_pk_mul_f32 v[170:171],v[170:171],v[198:199] op_sel_hi:[1,0]
v_pk_mul_f32 v[172:173],v[172:173],v[198:199] op_sel_hi:[1,0]
v_pk_mul_f32 v[174:175],v[174:175],v[198:199] op_sel_hi:[1,0]
v_cvt_pk_bf16_f32 v40,v168,v169
v_cvt_pk_bf16_f32 v41,v170,v171
v_cvt_pk_bf16_f32 v42,v172,v173
v_cvt_pk_bf16_f32 v43,v174,v175
v_accvgpr_read_b32 v144,a32
v_accvgpr_read_b32 v145,a33
v_accvgpr_read_b32 v146,a34
v_accvgpr_read_b32 v147,a35
v_accvgpr_read_b32 v148,a48
v_accvgpr_read_b32 v149,a49
v_accvgpr_read_b32 v150,a50
v_accvgpr_read_b32 v151,a51
v_pk_mul_f32 v[144:145],v[144:145],v[192:193] op_sel_hi:[1,0]
v_pk_mul_f32 v[146:147],v[146:147],v[192:193] op_sel_hi:[1,0]
v_pk_mul_f32 v[148:149],v[148:149],v[192:193] op_sel_hi:[1,0]
v_pk_mul_f32 v[150:151],v[150:151],v[192:193] op_sel_hi:[1,0]
v_cvt_pk_bf16_f32 v44,v144,v145
v_cvt_pk_bf16_f32 v45,v146,v147
v_cvt_pk_bf16_f32 v46,v148,v149
v_cvt_pk_bf16_f32 v47,v150,v151
v_accvgpr_read_b32 v152,a36
v_accvgpr_read_b32 v153,a37
v_accvgpr_read_b32 v154,a38
v_accvgpr_read_b32 v155,a39
v_accvgpr_read_b32 v156,a52
v_accvgpr_read_b32 v157,a53
v_accvgpr_read_b32 v158,a54
v_accvgpr_read_b32 v159,a55
v_pk_mul_f32 v[152:153],v[152:153],v[194:195] op_sel_hi:[1,0]
v_pk_mul_f32 v[154:155],v[154:155],v[194:195] op_sel_hi:[1,0]
v_pk_mul_f32 v[156:157],v[156:157],v[194:195] op_sel_hi:[1,0]
v_pk_mul_f32 v[158:159],v[158:159],v[194:195] op_sel_hi:[1,0]
v_cvt_pk_bf16_f32 v48,v152,v153
v_cvt_pk_bf16_f32 v49,v154,v155
v_cvt_pk_bf16_f32 v50,v156,v157
v_cvt_pk_bf16_f32 v51,v158,v159
buffer_load_dwordx4 a[4:7],v248,s[20:23],s65 offen offset:3072
v_accvgpr_read_b32 v160,a40
v_accvgpr_read_b32 v161,a41
v_accvgpr_read_b32 v162,a42
v_accvgpr_read_b32 v163,a43
v_accvgpr_read_b32 v164,a56
v_accvgpr_read_b32 v165,a57
v_accvgpr_read_b32 v166,a58
v_accvgpr_read_b32 v167,a59
v_pk_mul_f32 v[160:161],v[160:161],v[196:197] op_sel_hi:[1,0]
v_pk_mul_f32 v[162:163],v[162:163],v[196:197] op_sel_hi:[1,0]
v_pk_mul_f32 v[164:165],v[164:165],v[196:197] op_sel_hi:[1,0]
v_pk_mul_f32 v[166:167],v[166:167],v[196:197] op_sel_hi:[1,0]
v_cvt_pk_bf16_f32 v52,v160,v161
v_cvt_pk_bf16_f32 v53,v162,v163
v_cvt_pk_bf16_f32 v54,v164,v165
v_cvt_pk_bf16_f32 v55,v166,v167
v_accvgpr_read_b32 v168,a44
v_accvgpr_read_b32 v169,a45
v_accvgpr_read_b32 v170,a46
v_accvgpr_read_b32 v171,a47
v_accvgpr_read_b32 v172,a60
v_accvgpr_read_b32 v173,a61
v_accvgpr_read_b32 v174,a62
v_accvgpr_read_b32 v175,a63
v_pk_mul_f32 v[168:169],v[168:169],v[198:199] op_sel_hi:[1,0]
v_pk_mul_f32 v[170:171],v[170:171],v[198:199] op_sel_hi:[1,0]
v_pk_mul_f32 v[172:173],v[172:173],v[198:199] op_sel_hi:[1,0]
v_pk_mul_f32 v[174:175],v[174:175],v[198:199] op_sel_hi:[1,0]
v_cvt_pk_bf16_f32 v56,v168,v169
v_cvt_pk_bf16_f32 v57,v170,v171
v_cvt_pk_bf16_f32 v58,v172,v173
v_cvt_pk_bf16_f32 v59,v174,v175
s_add_u32 s60,s62,4096
buffer_load_dwordx4 a[8:11],v248,s[20:23],s60 offen offset:0
v_accvgpr_read_b32 v144,a64
v_accvgpr_read_b32 v145,a65
v_accvgpr_read_b32 v146,a66
v_accvgpr_read_b32 v147,a67
v_accvgpr_read_b32 v148,a80
v_accvgpr_read_b32 v149,a81
v_accvgpr_read_b32 v150,a82
v_accvgpr_read_b32 v151,a83
v_pk_mul_f32 v[144:145],v[144:145],v[192:193] op_sel_hi:[1,0]
v_pk_mul_f32 v[146:147],v[146:147],v[192:193] op_sel_hi:[1,0]
v_pk_mul_f32 v[148:149],v[148:149],v[192:193] op_sel_hi:[1,0]
v_pk_mul_f32 v[150:151],v[150:151],v[192:193] op_sel_hi:[1,0]
v_cvt_pk_bf16_f32 v60,v144,v145
v_cvt_pk_bf16_f32 v61,v146,v147
v_cvt_pk_bf16_f32 v62,v148,v149
v_cvt_pk_bf16_f32 v63,v150,v151
v_accvgpr_read_b32 v152,a68
v_accvgpr_read_b32 v153,a69
v_accvgpr_read_b32 v154,a70
v_accvgpr_read_b32 v155,a71
v_accvgpr_read_b32 v156,a84
v_accvgpr_read_b32 v157,a85
v_accvgpr_read_b32 v158,a86
v_accvgpr_read_b32 v159,a87
v_pk_mul_f32 v[152:153],v[152:153],v[194:195] op_sel_hi:[1,0]
v_pk_mul_f32 v[154:155],v[154:155],v[194:195] op_sel_hi:[1,0]
v_pk_mul_f32 v[156:157],v[156:157],v[194:195] op_sel_hi:[1,0]
v_pk_mul_f32 v[158:159],v[158:159],v[194:195] op_sel_hi:[1,0]
v_cvt_pk_bf16_f32 v64,v152,v153
v_cvt_pk_bf16_f32 v65,v154,v155
v_cvt_pk_bf16_f32 v66,v156,v157
v_cvt_pk_bf16_f32 v67,v158,v159
v_accvgpr_read_b32 v160,a72
v_accvgpr_read_b32 v161,a73
v_accvgpr_read_b32 v162,a74
v_accvgpr_read_b32 v163,a75
v_accvgpr_read_b32 v164,a88
v_accvgpr_read_b32 v165,a89
v_accvgpr_read_b32 v166,a90
v_accvgpr_read_b32 v167,a91
v_pk_mul_f32 v[160:161],v[160:161],v[196:197] op_sel_hi:[1,0]
v_pk_mul_f32 v[162:163],v[162:163],v[196:197] op_sel_hi:[1,0]
v_pk_mul_f32 v[164:165],v[164:165],v[196:197] op_sel_hi:[1,0]
v_pk_mul_f32 v[166:167],v[166:167],v[196:197] op_sel_hi:[1,0]
v_cvt_pk_bf16_f32 v68,v160,v161
v_cvt_pk_bf16_f32 v69,v162,v163
v_cvt_pk_bf16_f32 v70,v164,v165
v_cvt_pk_bf16_f32 v71,v166,v167
s_add_u32 s60,s63,4096
buffer_load_dwordx4 a[12:15],v248,s[20:23],s60 offen offset:0
v_accvgpr_read_b32 v168,a76
v_accvgpr_read_b32 v169,a77
v_accvgpr_read_b32 v170,a78
v_accvgpr_read_b32 v171,a79
v_accvgpr_read_b32 v172,a92
v_accvgpr_read_b32 v173,a93
v_accvgpr_read_b32 v174,a94
v_accvgpr_read_b32 v175,a95
v_pk_mul_f32 v[168:169],v[168:169],v[198:199] op_sel_hi:[1,0]
v_pk_mul_f32 v[170:171],v[170:171],v[198:199] op_sel_hi:[1,0]
v_pk_mul_f32 v[172:173],v[172:173],v[198:199] op_sel_hi:[1,0]
v_pk_mul_f32 v[174:175],v[174:175],v[198:199] op_sel_hi:[1,0]
v_cvt_pk_bf16_f32 v72,v168,v169
v_cvt_pk_bf16_f32 v73,v170,v171
v_cvt_pk_bf16_f32 v74,v172,v173
v_cvt_pk_bf16_f32 v75,v174,v175
v_accvgpr_read_b32 v144,a96
v_accvgpr_read_b32 v145,a97
v_accvgpr_read_b32 v146,a98
v_accvgpr_read_b32 v147,a99
v_accvgpr_read_b32 v148,a112
v_accvgpr_read_b32 v149,a113
v_accvgpr_read_b32 v150,a114
v_accvgpr_read_b32 v151,a115
v_pk_mul_f32 v[144:145],v[144:145],v[192:193] op_sel_hi:[1,0]
v_pk_mul_f32 v[146:147],v[146:147],v[192:193] op_sel_hi:[1,0]
v_pk_mul_f32 v[148:149],v[148:149],v[192:193] op_sel_hi:[1,0]
v_pk_mul_f32 v[150:151],v[150:151],v[192:193] op_sel_hi:[1,0]
v_cvt_pk_bf16_f32 v76,v144,v145
v_cvt_pk_bf16_f32 v77,v146,v147
v_cvt_pk_bf16_f32 v78,v148,v149
v_cvt_pk_bf16_f32 v79,v150,v151
v_accvgpr_read_b32 v152,a100
v_accvgpr_read_b32 v153,a101
v_accvgpr_read_b32 v154,a102
v_accvgpr_read_b32 v155,a103
v_accvgpr_read_b32 v156,a116
v_accvgpr_read_b32 v157,a117
v_accvgpr_read_b32 v158,a118
v_accvgpr_read_b32 v159,a119
v_pk_mul_f32 v[152:153],v[152:153],v[194:195] op_sel_hi:[1,0]
v_pk_mul_f32 v[154:155],v[154:155],v[194:195] op_sel_hi:[1,0]
v_pk_mul_f32 v[156:157],v[156:157],v[194:195] op_sel_hi:[1,0]
v_pk_mul_f32 v[158:159],v[158:159],v[194:195] op_sel_hi:[1,0]
v_cvt_pk_bf16_f32 v80,v152,v153
v_cvt_pk_bf16_f32 v81,v154,v155
v_cvt_pk_bf16_f32 v82,v156,v157
v_cvt_pk_bf16_f32 v83,v158,v159
s_add_u32 s60,s64,4096
buffer_load_dwordx4 a[32:35],v248,s[20:23],s60 offen offset:0
v_accvgpr_read_b32 v160,a104
v_accvgpr_read_b32 v161,a105
v_accvgpr_read_b32 v162,a106
v_accvgpr_read_b32 v163,a107
v_accvgpr_read_b32 v164,a120
v_accvgpr_read_b32 v165,a121
v_accvgpr_read_b32 v166,a122
v_accvgpr_read_b32 v167,a123
v_pk_mul_f32 v[160:161],v[160:161],v[196:197] op_sel_hi:[1,0]
v_pk_mul_f32 v[162:163],v[162:163],v[196:197] op_sel_hi:[1,0]
v_pk_mul_f32 v[164:165],v[164:165],v[196:197] op_sel_hi:[1,0]
v_pk_mul_f32 v[166:167],v[166:167],v[196:197] op_sel_hi:[1,0]
v_cvt_pk_bf16_f32 v84,v160,v161
v_cvt_pk_bf16_f32 v85,v162,v163
v_cvt_pk_bf16_f32 v86,v164,v165
v_cvt_pk_bf16_f32 v87,v166,v167
v_accvgpr_read_b32 v168,a108
v_accvgpr_read_b32 v169,a109
v_accvgpr_read_b32 v170,a110
v_accvgpr_read_b32 v171,a111
v_accvgpr_read_b32 v172,a124
v_accvgpr_read_b32 v173,a125
v_accvgpr_read_b32 v174,a126
v_accvgpr_read_b32 v175,a127
v_pk_mul_f32 v[168:169],v[168:169],v[198:199] op_sel_hi:[1,0]
v_pk_mul_f32 v[170:171],v[170:171],v[198:199] op_sel_hi:[1,0]
v_pk_mul_f32 v[172:173],v[172:173],v[198:199] op_sel_hi:[1,0]
v_pk_mul_f32 v[174:175],v[174:175],v[198:199] op_sel_hi:[1,0]
v_cvt_pk_bf16_f32 v88,v168,v169
v_cvt_pk_bf16_f32 v89,v170,v171
v_cvt_pk_bf16_f32 v90,v172,v173
v_cvt_pk_bf16_f32 v91,v174,v175
s_add_u32 s60,s65,4096
buffer_load_dwordx4 a[36:39],v248,s[20:23],s60 offen offset:0
v_accvgpr_read_b32 v144,a128
v_accvgpr_read_b32 v145,a129
v_accvgpr_read_b32 v146,a130
v_accvgpr_read_b32 v147,a131
v_accvgpr_read_b32 v148,a144
v_accvgpr_read_b32 v149,a145
v_accvgpr_read_b32 v150,a146
v_accvgpr_read_b32 v151,a147
v_pk_mul_f32 v[144:145],v[144:145],v[192:193] op_sel_hi:[1,0]
v_pk_mul_f32 v[146:147],v[146:147],v[192:193] op_sel_hi:[1,0]
v_pk_mul_f32 v[148:149],v[148:149],v[192:193] op_sel_hi:[1,0]
v_pk_mul_f32 v[150:151],v[150:151],v[192:193] op_sel_hi:[1,0]
v_cvt_pk_bf16_f32 v92,v144,v145
v_cvt_pk_bf16_f32 v93,v146,v147
v_cvt_pk_bf16_f32 v94,v148,v149
v_cvt_pk_bf16_f32 v95,v150,v151
v_accvgpr_read_b32 v152,a132
v_accvgpr_read_b32 v153,a133
v_accvgpr_read_b32 v154,a134
v_accvgpr_read_b32 v155,a135
v_accvgpr_read_b32 v156,a148
v_accvgpr_read_b32 v157,a149
v_accvgpr_read_b32 v158,a150
v_accvgpr_read_b32 v159,a151
v_pk_mul_f32 v[152:153],v[152:153],v[194:195] op_sel_hi:[1,0]
v_pk_mul_f32 v[154:155],v[154:155],v[194:195] op_sel_hi:[1,0]
v_pk_mul_f32 v[156:157],v[156:157],v[194:195] op_sel_hi:[1,0]
v_pk_mul_f32 v[158:159],v[158:159],v[194:195] op_sel_hi:[1,0]
v_cvt_pk_bf16_f32 v96,v152,v153
v_cvt_pk_bf16_f32 v97,v154,v155
v_cvt_pk_bf16_f32 v98,v156,v157
v_cvt_pk_bf16_f32 v99,v158,v159
v_accvgpr_read_b32 v160,a136
v_accvgpr_read_b32 v161,a137
v_accvgpr_read_b32 v162,a138
v_accvgpr_read_b32 v163,a139
v_accvgpr_read_b32 v164,a152
v_accvgpr_read_b32 v165,a153
v_accvgpr_read_b32 v166,a154
v_accvgpr_read_b32 v167,a155
v_pk_mul_f32 v[160:161],v[160:161],v[196:197] op_sel_hi:[1,0]
v_pk_mul_f32 v[162:163],v[162:163],v[196:197] op_sel_hi:[1,0]
v_pk_mul_f32 v[164:165],v[164:165],v[196:197] op_sel_hi:[1,0]
v_pk_mul_f32 v[166:167],v[166:167],v[196:197] op_sel_hi:[1,0]
v_cvt_pk_bf16_f32 v100,v160,v161
v_cvt_pk_bf16_f32 v101,v162,v163
v_cvt_pk_bf16_f32 v102,v164,v165
v_cvt_pk_bf16_f32 v103,v166,v167
s_add_u32 s60,s62,4096
buffer_load_dwordx4 a[40:43],v248,s[20:23],s60 offen offset:1024
v_accvgpr_read_b32 v168,a140
v_accvgpr_read_b32 v169,a141
v_accvgpr_read_b32 v170,a142
v_accvgpr_read_b32 v171,a143
v_accvgpr_read_b32 v172,a156
v_accvgpr_read_b32 v173,a157
v_accvgpr_read_b32 v174,a158
v_accvgpr_read_b32 v175,a159
v_pk_mul_f32 v[168:169],v[168:169],v[198:199] op_sel_hi:[1,0]
v_pk_mul_f32 v[170:171],v[170:171],v[198:199] op_sel_hi:[1,0]
v_pk_mul_f32 v[172:173],v[172:173],v[198:199] op_sel_hi:[1,0]
v_pk_mul_f32 v[174:175],v[174:175],v[198:199] op_sel_hi:[1,0]
v_cvt_pk_bf16_f32 v104,v168,v169
v_cvt_pk_bf16_f32 v105,v170,v171
v_cvt_pk_bf16_f32 v106,v172,v173
v_cvt_pk_bf16_f32 v107,v174,v175
v_accvgpr_read_b32 v144,a160
v_accvgpr_read_b32 v145,a161
v_accvgpr_read_b32 v146,a162
v_accvgpr_read_b32 v147,a163
v_accvgpr_read_b32 v148,a176
v_accvgpr_read_b32 v149,a177
v_accvgpr_read_b32 v150,a178
v_accvgpr_read_b32 v151,a179
v_pk_mul_f32 v[144:145],v[144:145],v[192:193] op_sel_hi:[1,0]
v_pk_mul_f32 v[146:147],v[146:147],v[192:193] op_sel_hi:[1,0]
v_pk_mul_f32 v[148:149],v[148:149],v[192:193] op_sel_hi:[1,0]
v_pk_mul_f32 v[150:151],v[150:151],v[192:193] op_sel_hi:[1,0]
v_cvt_pk_bf16_f32 v108,v144,v145
v_cvt_pk_bf16_f32 v109,v146,v147
v_cvt_pk_bf16_f32 v110,v148,v149
v_cvt_pk_bf16_f32 v111,v150,v151
v_accvgpr_read_b32 v152,a164
v_accvgpr_read_b32 v153,a165
v_accvgpr_read_b32 v154,a166
v_accvgpr_read_b32 v155,a167
v_accvgpr_read_b32 v156,a180
v_accvgpr_read_b32 v157,a181
v_accvgpr_read_b32 v158,a182
v_accvgpr_read_b32 v159,a183
v_pk_mul_f32 v[152:153],v[152:153],v[194:195] op_sel_hi:[1,0]
v_pk_mul_f32 v[154:155],v[154:155],v[194:195] op_sel_hi:[1,0]
v_pk_mul_f32 v[156:157],v[156:157],v[194:195] op_sel_hi:[1,0]
v_pk_mul_f32 v[158:159],v[158:159],v[194:195] op_sel_hi:[1,0]
v_cvt_pk_bf16_f32 v112,v152,v153
v_cvt_pk_bf16_f32 v113,v154,v155
v_cvt_pk_bf16_f32 v114,v156,v157
v_cvt_pk_bf16_f32 v115,v158,v159
s_add_u32 s60,s63,4096
buffer_load_dwordx4 a[44:47],v248,s[20:23],s60 offen offset:1024
v_accvgpr_read_b32 v160,a168
v_accvgpr_read_b32 v161,a169
v_accvgpr_read_b32 v162,a170
v_accvgpr_read_b32 v163,a171
v_accvgpr_read_b32 v164,a184
v_accvgpr_read_b32 v165,a185
v_accvgpr_read_b32 v166,a186
v_accvgpr_read_b32 v167,a187
v_pk_mul_f32 v[160:161],v[160:161],v[196:197] op_sel_hi:[1,0]
v_pk_mul_f32 v[162:163],v[162:163],v[196:197] op_sel_hi:[1,0]
v_pk_mul_f32 v[164:165],v[164:165],v[196:197] op_sel_hi:[1,0]
v_pk_mul_f32 v[166:167],v[166:167],v[196:197] op_sel_hi:[1,0]
v_cvt_pk_bf16_f32 v116,v160,v161
v_cvt_pk_bf16_f32 v117,v162,v163
v_cvt_pk_bf16_f32 v118,v164,v165
v_cvt_pk_bf16_f32 v119,v166,v167
v_accvgpr_read_b32 v168,a172
v_accvgpr_read_b32 v169,a173
v_accvgpr_read_b32 v170,a174
v_accvgpr_read_b32 v171,a175
v_accvgpr_read_b32 v172,a188
v_accvgpr_read_b32 v173,a189
v_accvgpr_read_b32 v174,a190
v_accvgpr_read_b32 v175,a191
v_pk_mul_f32 v[168:169],v[168:169],v[198:199] op_sel_hi:[1,0]
v_pk_mul_f32 v[170:171],v[170:171],v[198:199] op_sel_hi:[1,0]
v_pk_mul_f32 v[172:173],v[172:173],v[198:199] op_sel_hi:[1,0]
v_pk_mul_f32 v[174:175],v[174:175],v[198:199] op_sel_hi:[1,0]
v_cvt_pk_bf16_f32 v120,v168,v169
v_cvt_pk_bf16_f32 v121,v170,v171
v_cvt_pk_bf16_f32 v122,v172,v173
v_cvt_pk_bf16_f32 v123,v174,v175
s_add_u32 s60,s64,4096
buffer_load_dwordx4 a[64:67],v248,s[20:23],s60 offen offset:1024
v_accvgpr_read_b32 v144,a192
v_accvgpr_read_b32 v145,a193
v_accvgpr_read_b32 v146,a194
v_accvgpr_read_b32 v147,a195
v_accvgpr_read_b32 v148,a208
v_accvgpr_read_b32 v149,a209
v_accvgpr_read_b32 v150,a210
v_accvgpr_read_b32 v151,a211
v_pk_mul_f32 v[144:145],v[144:145],v[192:193] op_sel_hi:[1,0]
v_pk_mul_f32 v[146:147],v[146:147],v[192:193] op_sel_hi:[1,0]
v_pk_mul_f32 v[148:149],v[148:149],v[192:193] op_sel_hi:[1,0]
v_pk_mul_f32 v[150:151],v[150:151],v[192:193] op_sel_hi:[1,0]
v_cvt_pk_bf16_f32 v124,v144,v145
v_cvt_pk_bf16_f32 v125,v146,v147
v_cvt_pk_bf16_f32 v126,v148,v149
v_cvt_pk_bf16_f32 v127,v150,v151
v_accvgpr_read_b32 v152,a196
v_accvgpr_read_b32 v153,a197
v_accvgpr_read_b32 v154,a198
v_accvgpr_read_b32 v155,a199
v_accvgpr_read_b32 v156,a212
v_accvgpr_read_b32 v157,a213
v_accvgpr_read_b32 v158,a214
v_accvgpr_read_b32 v159,a215
v_pk_mul_f32 v[152:153],v[152:153],v[194:195] op_sel_hi:[1,0]
v_pk_mul_f32 v[154:155],v[154:155],v[194:195] op_sel_hi:[1,0]
v_pk_mul_f32 v[156:157],v[156:157],v[194:195] op_sel_hi:[1,0]
v_pk_mul_f32 v[158:159],v[158:159],v[194:195] op_sel_hi:[1,0]
v_cvt_pk_bf16_f32 v180,v152,v153
v_cvt_pk_bf16_f32 v181,v154,v155
v_cvt_pk_bf16_f32 v182,v156,v157
v_cvt_pk_bf16_f32 v183,v158,v159
v_accvgpr_write_b32 a196,v180
v_accvgpr_write_b32 a197,v181
v_accvgpr_write_b32 a198,v182
v_accvgpr_write_b32 a199,v183
ds_read_b128 a[136:139],v251 offset:0
v_accvgpr_read_b32 v160,a200
v_accvgpr_read_b32 v161,a201
v_accvgpr_read_b32 v162,a202
v_accvgpr_read_b32 v163,a203
v_accvgpr_read_b32 v164,a216
v_accvgpr_read_b32 v165,a217
v_accvgpr_read_b32 v166,a218
v_accvgpr_read_b32 v167,a219
v_pk_mul_f32 v[160:161],v[160:161],v[196:197] op_sel_hi:[1,0]
v_pk_mul_f32 v[162:163],v[162:163],v[196:197] op_sel_hi:[1,0]
v_pk_mul_f32 v[164:165],v[164:165],v[196:197] op_sel_hi:[1,0]
v_pk_mul_f32 v[166:167],v[166:167],v[196:197] op_sel_hi:[1,0]
v_cvt_pk_bf16_f32 v184,v160,v161
v_cvt_pk_bf16_f32 v185,v162,v163
v_cvt_pk_bf16_f32 v186,v164,v165
v_cvt_pk_bf16_f32 v187,v166,v167
v_accvgpr_write_b32 a200,v184
v_accvgpr_write_b32 a201,v185
v_accvgpr_write_b32 a202,v186
v_accvgpr_write_b32 a203,v187
s_add_u32 s60,s65,4096
buffer_load_dwordx4 a[68:71],v248,s[20:23],s60 offen offset:1024
ds_read_b128 a[140:143],v251 offset:1024
v_accvgpr_read_b32 v168,a204
v_accvgpr_read_b32 v169,a205
v_accvgpr_read_b32 v170,a206
v_accvgpr_read_b32 v171,a207
v_accvgpr_read_b32 v172,a220
v_accvgpr_read_b32 v173,a221
v_accvgpr_read_b32 v174,a222
v_accvgpr_read_b32 v175,a223
v_pk_mul_f32 v[168:169],v[168:169],v[198:199] op_sel_hi:[1,0]
v_pk_mul_f32 v[170:171],v[170:171],v[198:199] op_sel_hi:[1,0]
v_pk_mul_f32 v[172:173],v[172:173],v[198:199] op_sel_hi:[1,0]
v_pk_mul_f32 v[174:175],v[174:175],v[198:199] op_sel_hi:[1,0]
v_cvt_pk_bf16_f32 v188,v168,v169
v_cvt_pk_bf16_f32 v189,v170,v171
v_cvt_pk_bf16_f32 v190,v172,v173
v_cvt_pk_bf16_f32 v191,v174,v175
v_accvgpr_write_b32 a204,v188
v_accvgpr_write_b32 a205,v189
v_accvgpr_write_b32 a206,v190
v_accvgpr_write_b32 a207,v191
ds_read_b128 a[160:163],v251 offset:2048
v_accvgpr_read_b32 v144,a224
v_accvgpr_read_b32 v145,a225
v_accvgpr_read_b32 v146,a226
v_accvgpr_read_b32 v147,a227
v_accvgpr_read_b32 v148,a240
v_accvgpr_read_b32 v149,a241
v_accvgpr_read_b32 v150,a242
v_accvgpr_read_b32 v151,a243
v_pk_mul_f32 v[144:145],v[144:145],v[192:193] op_sel_hi:[1,0]
v_pk_mul_f32 v[146:147],v[146:147],v[192:193] op_sel_hi:[1,0]
v_pk_mul_f32 v[148:149],v[148:149],v[192:193] op_sel_hi:[1,0]
v_pk_mul_f32 v[150:151],v[150:151],v[192:193] op_sel_hi:[1,0]
v_cvt_pk_bf16_f32 v176,v144,v145
v_cvt_pk_bf16_f32 v177,v146,v147
v_cvt_pk_bf16_f32 v178,v148,v149
v_cvt_pk_bf16_f32 v179,v150,v151
v_accvgpr_write_b32 a224,v176
v_accvgpr_write_b32 a225,v177
v_accvgpr_write_b32 a226,v178
v_accvgpr_write_b32 a227,v179
ds_read_b128 a[164:167],v251 offset:3072
v_accvgpr_read_b32 v152,a228
v_accvgpr_read_b32 v153,a229
v_accvgpr_read_b32 v154,a230
v_accvgpr_read_b32 v155,a231
v_accvgpr_read_b32 v156,a244
v_accvgpr_read_b32 v157,a245
v_accvgpr_read_b32 v158,a246
v_accvgpr_read_b32 v159,a247
v_pk_mul_f32 v[152:153],v[152:153],v[194:195] op_sel_hi:[1,0]
v_pk_mul_f32 v[154:155],v[154:155],v[194:195] op_sel_hi:[1,0]
v_pk_mul_f32 v[156:157],v[156:157],v[194:195] op_sel_hi:[1,0]
v_pk_mul_f32 v[158:159],v[158:159],v[194:195] op_sel_hi:[1,0]
v_cvt_pk_bf16_f32 v180,v152,v153
v_cvt_pk_bf16_f32 v181,v154,v155
v_cvt_pk_bf16_f32 v182,v156,v157
v_cvt_pk_bf16_f32 v183,v158,v159
v_accvgpr_write_b32 a228,v180
v_accvgpr_write_b32 a229,v181
v_accvgpr_write_b32 a230,v182
v_accvgpr_write_b32 a231,v183
s_add_u32 s60,s62,4096
buffer_load_dwordx4 a[72:75],v248,s[20:23],s60 offen offset:2048
ds_read_b128 a[168:171],v251 offset:4096
v_accvgpr_read_b32 v160,a232
v_accvgpr_read_b32 v161,a233
v_accvgpr_read_b32 v162,a234
v_accvgpr_read_b32 v163,a235
v_accvgpr_read_b32 v164,a248
v_accvgpr_read_b32 v165,a249
v_accvgpr_read_b32 v166,a250
v_accvgpr_read_b32 v167,a251
v_pk_mul_f32 v[160:161],v[160:161],v[196:197] op_sel_hi:[1,0]
v_pk_mul_f32 v[162:163],v[162:163],v[196:197] op_sel_hi:[1,0]
v_pk_mul_f32 v[164:165],v[164:165],v[196:197] op_sel_hi:[1,0]
v_pk_mul_f32 v[166:167],v[166:167],v[196:197] op_sel_hi:[1,0]
v_cvt_pk_bf16_f32 v184,v160,v161
v_cvt_pk_bf16_f32 v185,v162,v163
v_cvt_pk_bf16_f32 v186,v164,v165
v_cvt_pk_bf16_f32 v187,v166,v167
v_accvgpr_write_b32 a232,v184
v_accvgpr_write_b32 a233,v185
v_accvgpr_write_b32 a234,v186
v_accvgpr_write_b32 a235,v187
ds_read_b128 a[172:175],v251 offset:5120
v_accvgpr_read_b32 v168,a236
v_accvgpr_read_b32 v169,a237
v_accvgpr_read_b32 v170,a238
v_accvgpr_read_b32 v171,a239
v_accvgpr_read_b32 v172,a252
v_accvgpr_read_b32 v173,a253
v_accvgpr_read_b32 v174,a254
v_accvgpr_read_b32 v175,a255
v_pk_mul_f32 v[168:169],v[168:169],v[198:199] op_sel_hi:[1,0]
v_pk_mul_f32 v[170:171],v[170:171],v[198:199] op_sel_hi:[1,0]
v_pk_mul_f32 v[172:173],v[172:173],v[198:199] op_sel_hi:[1,0]
v_pk_mul_f32 v[174:175],v[174:175],v[198:199] op_sel_hi:[1,0]
v_cvt_pk_bf16_f32 v188,v168,v169
v_cvt_pk_bf16_f32 v189,v170,v171
v_cvt_pk_bf16_f32 v190,v172,v173
v_cvt_pk_bf16_f32 v191,v174,v175
v_accvgpr_write_b32 a236,v188
v_accvgpr_write_b32 a237,v189
v_accvgpr_write_b32 a238,v190
v_accvgpr_write_b32 a239,v191
s_add_u32 s60,s63,4096
buffer_load_dwordx4 a[76:79],v248,s[20:23],s60 offen offset:2048
ds_read_b128 a[192:195],v251 offset:6144
s_mov_b32 s36,3
s_mov_b32 s67,0
s_waitcnt lgkmcnt(11)
v_mfma_f32_16x16x32_bf16 a[16:19],v[208:211],v[28:31],0
ds_read_b64_tr_b16 v[224:225],v252 offset:25344
s_add_u32 s60,s64,4096
v_mfma_f32_16x16x32_bf16 a[20:23],v[208:211],v[32:35],0
ds_read_b64_tr_b16 v[226:227],v252 offset:25856
buffer_load_dwordx4 a[96:99],v248,s[20:23],s60 offen offset:2048
v_mfma_f32_16x16x32_bf16 a[24:27],v[208:211],v[36:39],0
ds_read_b64_tr_b16 v[228:229],v252 offset:25376
s_add_u32 s60,s65,4096
v_mfma_f32_16x16x32_bf16 a[28:31],v[208:211],v[40:43],0
ds_read_b64_tr_b16 v[230:231],v252 offset:25888
v_mfma_f32_16x16x32_bf16 a[48:51],v[212:215],v[28:31],0
v_mfma_f32_16x16x32_bf16 a[52:55],v[212:215],v[32:35],0
v_mfma_f32_16x16x32_bf16 a[56:59],v[212:215],v[36:39],0
v_mfma_f32_16x16x32_bf16 a[60:63],v[212:215],v[40:43],0
buffer_load_dwordx4 a[100:103],v248,s[20:23],s60 offen offset:2048
s_waitcnt lgkmcnt(11)
v_mfma_f32_16x16x32_bf16 a[16:19],v[216:219],v[44:47],a[16:19]
ds_read_b64_tr_b16 v[232:233],v252 offset:29568
s_add_u32 s60,s62,4096
v_mfma_f32_16x16x32_bf16 a[20:23],v[216:219],v[48:51],a[20:23]
ds_read_b64_tr_b16 v[234:235],v252 offset:30080
v_mfma_f32_16x16x32_bf16 a[24:27],v[216:219],v[52:55],a[24:27]
ds_read_b64_tr_b16 v[236:237],v252 offset:29600
v_mfma_f32_16x16x32_bf16 a[28:31],v[216:219],v[56:59],a[28:31]
ds_read_b64_tr_b16 v[238:239],v252 offset:30112
v_mfma_f32_16x16x32_bf16 a[48:51],v[220:223],v[44:47],a[48:51]
v_mfma_f32_16x16x32_bf16 a[52:55],v[220:223],v[48:51],a[52:55]
buffer_load_dwordx4 a[104:107],v248,s[20:23],s60 offen offset:3072
s_add_u32 s60,s63,4096
v_mfma_f32_16x16x32_bf16 a[56:59],v[220:223],v[52:55],a[56:59]
v_mfma_f32_16x16x32_bf16 a[60:63],v[220:223],v[56:59],a[60:63]
s_waitcnt lgkmcnt(4)
v_mfma_f32_16x16x32_bf16 a[16:19],v[224:227],v[60:63],a[16:19]
ds_read_b64_tr_b16 v[208:209],v252 offset:33792
v_mfma_f32_16x16x32_bf16 a[20:23],v[224:227],v[64:67],a[20:23]
ds_read_b64_tr_b16 v[210:211],v252 offset:34304
v_mfma_f32_16x16x32_bf16 a[24:27],v[224:227],v[68:71],a[24:27]
ds_read_b64_tr_b16 v[212:213],v252 offset:33824
v_mfma_f32_16x16x32_bf16 a[28:31],v[224:227],v[72:75],a[28:31]
ds_read_b64_tr_b16 v[214:215],v252 offset:34336
buffer_load_dwordx4 a[108:111],v248,s[20:23],s60 offen offset:3072
v_mfma_f32_16x16x32_bf16 a[48:51],v[228:231],v[60:63],a[48:51]
s_add_u32 s60,s64,4096
v_mfma_f32_16x16x32_bf16 a[52:55],v[228:231],v[64:67],a[52:55]
v_mfma_f32_16x16x32_bf16 a[56:59],v[228:231],v[68:71],a[56:59]
v_mfma_f32_16x16x32_bf16 a[60:63],v[228:231],v[72:75],a[60:63]
s_waitcnt lgkmcnt(4)
v_mfma_f32_16x16x32_bf16 a[16:19],v[232:235],v[76:79],a[16:19]
ds_read_b64_tr_b16 v[216:217],v252 offset:38016
v_mfma_f32_16x16x32_bf16 a[20:23],v[232:235],v[80:83],a[20:23]
ds_read_b64_tr_b16 v[218:219],v252 offset:38528
buffer_load_dwordx4 a[128:131],v248,s[20:23],s60 offen offset:3072
v_mfma_f32_16x16x32_bf16 a[24:27],v[232:235],v[84:87],a[24:27]
ds_read_b64_tr_b16 v[220:221],v252 offset:38048
s_add_u32 s60,s65,4096
v_mfma_f32_16x16x32_bf16 a[28:31],v[232:235],v[88:91],a[28:31]
ds_read_b64_tr_b16 v[222:223],v252 offset:38560
v_mfma_f32_16x16x32_bf16 a[48:51],v[236:239],v[76:79],a[48:51]
v_mfma_f32_16x16x32_bf16 a[52:55],v[236:239],v[80:83],a[52:55]
v_mfma_f32_16x16x32_bf16 a[56:59],v[236:239],v[84:87],a[56:59]
v_mfma_f32_16x16x32_bf16 a[60:63],v[236:239],v[88:91],a[60:63]
buffer_load_dwordx4 a[132:135],v248,s[20:23],s60 offen offset:3072
s_waitcnt lgkmcnt(4)
v_mfma_f32_16x16x32_bf16 a[16:19],v[208:211],v[92:95],a[16:19]
ds_read_b64_tr_b16 v[224:225],v252 offset:42240
v_mfma_f32_16x16x32_bf16 a[20:23],v[208:211],v[96:99],a[20:23]
ds_read_b64_tr_b16 v[226:227],v252 offset:42752
v_mfma_f32_16x16x32_bf16 a[24:27],v[208:211],v[100:103],a[24:27]
ds_read_b64_tr_b16 v[228:229],v252 offset:42272
v_mfma_f32_16x16x32_bf16 a[28:31],v[208:211],v[104:107],a[28:31]
ds_read_b64_tr_b16 v[230:231],v252 offset:42784
v_mfma_f32_16x16x32_bf16 a[48:51],v[212:215],v[92:95],a[48:51]
v_mfma_f32_16x16x32_bf16 a[52:55],v[212:215],v[96:99],a[52:55]
v_mfma_f32_16x16x32_bf16 a[56:59],v[212:215],v[100:103],a[56:59]
v_mfma_f32_16x16x32_bf16 a[60:63],v[212:215],v[104:107],a[60:63]
s_waitcnt lgkmcnt(4)
v_mfma_f32_16x16x32_bf16 a[16:19],v[216:219],v[108:111],a[16:19]
ds_read_b64_tr_b16 v[232:233],v252 offset:46464
v_mfma_f32_16x16x32_bf16 a[20:23],v[216:219],v[112:115],a[20:23]
ds_read_b64_tr_b16 v[234:235],v252 offset:46976
v_mfma_f32_16x16x32_bf16 a[24:27],v[216:219],v[116:119],a[24:27]
ds_read_b64_tr_b16 v[236:237],v252 offset:46496
v_mfma_f32_16x16x32_bf16 a[28:31],v[216:219],v[120:123],a[28:31]
ds_read_b64_tr_b16 v[238:239],v252 offset:47008
v_mfma_f32_16x16x32_bf16 a[48:51],v[220:223],v[108:111],a[48:51]
v_mfma_f32_16x16x32_bf16 a[52:55],v[220:223],v[112:115],a[52:55]
v_mfma_f32_16x16x32_bf16 a[56:59],v[220:223],v[116:119],a[56:59]
v_mfma_f32_16x16x32_bf16 a[60:63],v[220:223],v[120:123],a[60:63]
s_waitcnt lgkmcnt(4)
v_mfma_f32_16x16x32_bf16 a[16:19],v[224:227],v[124:127],a[16:19]
ds_read_b64_tr_b16 v[208:209],v255 offset:16896
v_mfma_f32_16x16x32_bf16 a[20:23],v[224:227],a[196:199],a[20:23]
ds_read_b64_tr_b16 v[210:211],v255 offset:17408
v_mfma_f32_16x16x32_bf16 a[24:27],v[224:227],a[200:203],a[24:27]
ds_read_b64_tr_b16 v[212:213],v255 offset:16928
v_mfma_f32_16x16x32_bf16 a[28:31],v[224:227],a[204:207],a[28:31]
ds_read_b64_tr_b16 v[214:215],v255 offset:17440
v_mfma_f32_16x16x32_bf16 a[48:51],v[228:231],v[124:127],a[48:51]
v_mfma_f32_16x16x32_bf16 a[52:55],v[228:231],a[196:199],a[52:55]
v_mfma_f32_16x16x32_bf16 a[56:59],v[228:231],a[200:203],a[56:59]
v_mfma_f32_16x16x32_bf16 a[60:63],v[228:231],a[204:207],a[60:63]
s_waitcnt lgkmcnt(4)
v_mfma_f32_16x16x32_bf16 a[16:19],v[232:235],a[224:227],a[16:19]
ds_read_b64_tr_b16 v[216:217],v255 offset:21120
v_mfma_f32_16x16x32_bf16 a[20:23],v[232:235],a[228:231],a[20:23]
ds_read_b64_tr_b16 v[218:219],v255 offset:21632
v_mfma_f32_16x16x32_bf16 a[24:27],v[232:235],a[232:235],a[24:27]
ds_read_b64_tr_b16 v[220:221],v255 offset:21152
v_mfma_f32_16x16x32_bf16 a[28:31],v[232:235],a[236:239],a[28:31]
ds_read_b64_tr_b16 v[222:223],v255 offset:21664
v_mfma_f32_16x16x32_bf16 a[48:51],v[236:239],a[224:227],a[48:51]
v_mfma_f32_16x16x32_bf16 a[52:55],v[236:239],a[228:231],a[52:55]
v_mfma_f32_16x16x32_bf16 a[56:59],v[236:239],a[232:235],a[56:59]
v_mfma_f32_16x16x32_bf16 a[60:63],v[236:239],a[236:239],a[60:63]
s_waitcnt vmcnt(28) lgkmcnt(4)
v_mfma_f32_16x16x32_bf16 a[16:19],v[208:211],v[0:3],a[16:19]
ds_read_b64_tr_b16 v[224:225],v255 offset:25344
v_mfma_f32_16x16x32_bf16 a[20:23],v[208:211],a[164:167],a[20:23]
ds_read_b64_tr_b16 v[226:227],v255 offset:25856
v_mfma_f32_16x16x32_bf16 a[24:27],v[208:211],a[168:171],a[24:27]
ds_read_b64_tr_b16 v[228:229],v255 offset:25376
v_mfma_f32_16x16x32_bf16 a[28:31],v[208:211],v[4:7],a[28:31]
ds_read_b64_tr_b16 v[230:231],v255 offset:25888
v_mfma_f32_16x16x32_bf16 a[48:51],v[212:215],v[0:3],a[48:51]
v_mfma_f32_16x16x32_bf16 a[52:55],v[212:215],a[164:167],a[52:55]
v_mfma_f32_16x16x32_bf16 a[56:59],v[212:215],a[168:171],a[56:59]
v_mfma_f32_16x16x32_bf16 a[60:63],v[212:215],v[4:7],a[60:63]
s_waitcnt vmcnt(26) lgkmcnt(4)
v_mfma_f32_16x16x32_bf16 a[16:19],v[216:219],v[8:11],a[16:19]
ds_read_b64_tr_b16 v[232:233],v255 offset:29568
v_mfma_f32_16x16x32_bf16 a[20:23],v[216:219],a[172:175],a[20:23]
ds_read_b64_tr_b16 v[234:235],v255 offset:30080
v_mfma_f32_16x16x32_bf16 a[24:27],v[216:219],a[192:195],a[24:27]
ds_read_b64_tr_b16 v[236:237],v255 offset:29600
v_mfma_f32_16x16x32_bf16 a[28:31],v[216:219],v[12:15],a[28:31]
ds_read_b64_tr_b16 v[238:239],v255 offset:30112
v_mfma_f32_16x16x32_bf16 a[48:51],v[220:223],v[8:11],a[48:51]
v_mfma_f32_16x16x32_bf16 a[52:55],v[220:223],a[172:175],a[52:55]
v_mfma_f32_16x16x32_bf16 a[56:59],v[220:223],a[192:195],a[56:59]
v_mfma_f32_16x16x32_bf16 a[60:63],v[220:223],v[12:15],a[60:63]
s_waitcnt vmcnt(25) lgkmcnt(4)
v_mfma_f32_16x16x32_bf16 a[16:19],v[224:227],a[136:139],a[16:19]
ds_read_b64_tr_b16 v[208:209],v255 offset:0
v_mfma_f32_16x16x32_bf16 a[20:23],v[224:227],a[140:143],a[20:23]
ds_read_b64_tr_b16 v[210:211],v255 offset:512
v_mfma_f32_16x16x32_bf16 a[24:27],v[224:227],a[160:163],a[24:27]
ds_read_b64_tr_b16 v[212:213],v255 offset:32
v_mfma_f32_16x16x32_bf16 a[28:31],v[224:227],v[16:19],a[28:31]
ds_read_b64_tr_b16 v[214:215],v255 offset:544
v_mfma_f32_16x16x32_bf16 a[48:51],v[228:231],a[136:139],a[48:51]
v_mfma_f32_16x16x32_bf16 a[52:55],v[228:231],a[140:143],a[52:55]
v_mfma_f32_16x16x32_bf16 a[56:59],v[228:231],a[160:163],a[56:59]
v_mfma_f32_16x16x32_bf16 a[60:63],v[228:231],v[16:19],a[60:63]
s_waitcnt vmcnt(16) lgkmcnt(4)
v_mfma_f32_16x16x32_bf16 a[16:19],v[232:235],v[20:23],a[16:19]
ds_read_b64_tr_b16 v[216:217],v255 offset:4224
v_mfma_f32_16x16x32_bf16 a[20:23],v[232:235],v[24:27],a[20:23]
ds_read_b64_tr_b16 v[218:219],v255 offset:4736
v_mfma_f32_16x16x32_bf16 a[24:27],v[232:235],a[0:3],a[24:27]
ds_read_b64_tr_b16 v[220:221],v255 offset:4256
v_mfma_f32_16x16x32_bf16 a[28:31],v[232:235],a[4:7],a[28:31]
ds_read_b64_tr_b16 v[222:223],v255 offset:4768
v_mfma_f32_16x16x32_bf16 a[48:51],v[236:239],v[20:23],a[48:51]
v_mfma_f32_16x16x32_bf16 a[52:55],v[236:239],v[24:27],a[52:55]
v_mfma_f32_16x16x32_bf16 a[56:59],v[236:239],a[0:3],a[56:59]
v_mfma_f32_16x16x32_bf16 a[60:63],v[236:239],a[4:7],a[60:63]
s_waitcnt vmcnt(12) lgkmcnt(4)
v_mfma_f32_16x16x32_bf16 a[16:19],v[208:211],a[8:11],a[16:19]
ds_read_b64_tr_b16 v[224:225],v255 offset:8448
v_mfma_f32_16x16x32_bf16 a[20:23],v[208:211],a[12:15],a[20:23]
ds_read_b64_tr_b16 v[226:227],v255 offset:8960
v_mfma_f32_16x16x32_bf16 a[24:27],v[208:211],a[32:35],a[24:27]
ds_read_b64_tr_b16 v[228:229],v255 offset:8480
v_mfma_f32_16x16x32_bf16 a[28:31],v[208:211],a[36:39],a[28:31]
ds_read_b64_tr_b16 v[230:231],v255 offset:8992
v_mfma_f32_16x16x32_bf16 a[48:51],v[212:215],a[8:11],a[48:51]
v_mfma_f32_16x16x32_bf16 a[52:55],v[212:215],a[12:15],a[52:55]
v_mfma_f32_16x16x32_bf16 a[56:59],v[212:215],a[32:35],a[56:59]
v_mfma_f32_16x16x32_bf16 a[60:63],v[212:215],a[36:39],a[60:63]
s_waitcnt vmcnt(8) lgkmcnt(4)
v_mfma_f32_16x16x32_bf16 a[16:19],v[216:219],a[40:43],a[16:19]
ds_read_b64_tr_b16 v[232:233],v255 offset:12672
v_mfma_f32_16x16x32_bf16 a[20:23],v[216:219],a[44:47],a[20:23]
ds_read_b64_tr_b16 v[234:235],v255 offset:13184
v_mfma_f32_16x16x32_bf16 a[24:27],v[216:219],a[64:67],a[24:27]
ds_read_b64_tr_b16 v[236:237],v255 offset:12704
v_mfma_f32_16x16x32_bf16 a[28:31],v[216:219],a[68:71],a[28:31]
ds_read_b64_tr_b16 v[238:239],v255 offset:13216
v_mfma_f32_16x16x32_bf16 a[48:51],v[220:223],a[40:43],a[48:51]
v_mfma_f32_16x16x32_bf16 a[52:55],v[220:223],a[44:47],a[52:55]
v_mfma_f32_16x16x32_bf16 a[56:59],v[220:223],a[64:67],a[56:59]
v_mfma_f32_16x16x32_bf16 a[60:63],v[220:223],a[68:71],a[60:63]
s_waitcnt vmcnt(4) lgkmcnt(4)
v_mfma_f32_16x16x32_bf16 a[16:19],v[224:227],a[72:75],a[16:19]
ds_read_b64_tr_b16 v[208:209],v252 offset:16960
v_mfma_f32_16x16x32_bf16 a[20:23],v[224:227],a[76:79],a[20:23]
ds_read_b64_tr_b16 v[210:211],v252 offset:17472
v_mfma_f32_16x16x32_bf16 a[24:27],v[224:227],a[96:99],a[24:27]
ds_read_b64_tr_b16 v[212:213],v252 offset:16992
v_mfma_f32_16x16x32_bf16 a[28:31],v[224:227],a[100:103],a[28:31]
ds_read_b64_tr_b16 v[214:215],v252 offset:17504
v_mfma_f32_16x16x32_bf16 a[48:51],v[228:231],a[72:75],a[48:51]
v_mfma_f32_16x16x32_bf16 a[52:55],v[228:231],a[76:79],a[52:55]
v_mfma_f32_16x16x32_bf16 a[56:59],v[228:231],a[96:99],a[56:59]
v_mfma_f32_16x16x32_bf16 a[60:63],v[228:231],a[100:103],a[60:63]
s_waitcnt vmcnt(0) lgkmcnt(4)
v_mfma_f32_16x16x32_bf16 a[16:19],v[232:235],a[104:107],a[16:19]
ds_read_b64_tr_b16 v[216:217],v252 offset:21184
v_mfma_f32_16x16x32_bf16 a[20:23],v[232:235],a[108:111],a[20:23]
ds_read_b64_tr_b16 v[218:219],v252 offset:21696
v_mfma_f32_16x16x32_bf16 a[24:27],v[232:235],a[128:131],a[24:27]
ds_read_b64_tr_b16 v[220:221],v252 offset:21216
v_mfma_f32_16x16x32_bf16 a[28:31],v[232:235],a[132:135],a[28:31]
ds_read_b64_tr_b16 v[222:223],v252 offset:21728
v_mfma_f32_16x16x32_bf16 a[48:51],v[236:239],a[104:107],a[48:51]
v_mfma_f32_16x16x32_bf16 a[52:55],v[236:239],a[108:111],a[52:55]
v_mfma_f32_16x16x32_bf16 a[56:59],v[236:239],a[128:131],a[56:59]
v_mfma_f32_16x16x32_bf16 a[60:63],v[236:239],a[132:135],a[60:63]
s_waitcnt lgkmcnt(4)
v_mfma_f32_16x16x32_bf16 a[80:83],v[208:211],v[28:31],0
ds_read_b64_tr_b16 v[224:225],v252 offset:25408
v_mfma_f32_16x16x32_bf16 a[84:87],v[208:211],v[32:35],0
ds_read_b64_tr_b16 v[226:227],v252 offset:25920
v_mfma_f32_16x16x32_bf16 a[88:91],v[208:211],v[36:39],0
ds_read_b64_tr_b16 v[228:229],v252 offset:25440
v_mfma_f32_16x16x32_bf16 a[92:95],v[208:211],v[40:43],0
ds_read_b64_tr_b16 v[230:231],v252 offset:25952
v_mfma_f32_16x16x32_bf16 a[112:115],v[212:215],v[28:31],0
v_mov_b32 v164,v156
v_mov_b32 v165,v157
v_mfma_f32_16x16x32_bf16 a[116:119],v[212:215],v[32:35],0
v_mov_b32 v166,v158
v_mov_b32 v167,v159
v_mfma_f32_16x16x32_bf16 a[120:123],v[212:215],v[36:39],0
v_accvgpr_read_b32 v128,a16
v_accvgpr_read_b32 v129,a17
v_mfma_f32_16x16x32_bf16 a[124:127],v[212:215],v[40:43],0
v_accvgpr_read_b32 v130,a18
s_waitcnt lgkmcnt(4)
v_mfma_f32_16x16x32_bf16 a[80:83],v[216:219],v[44:47],a[80:83]
ds_read_b64_tr_b16 v[232:233],v252 offset:29632
v_accvgpr_read_b32 v131,a19
v_mfma_f32_16x16x32_bf16 a[84:87],v[216:219],v[48:51],a[84:87]
ds_read_b64_tr_b16 v[234:235],v252 offset:30144
v_accvgpr_read_b32 v132,a48
v_mfma_f32_16x16x32_bf16 a[88:91],v[216:219],v[52:55],a[88:91]
ds_read_b64_tr_b16 v[236:237],v252 offset:29664
v_accvgpr_read_b32 v133,a49
v_mfma_f32_16x16x32_bf16 a[92:95],v[216:219],v[56:59],a[92:95]
ds_read_b64_tr_b16 v[238:239],v252 offset:30176
v_accvgpr_read_b32 v134,a50
v_mfma_f32_16x16x32_bf16 a[112:115],v[220:223],v[44:47],a[112:115]
v_accvgpr_read_b32 v135,a51
v_cvt_pk_bf16_f32 v156,v128,v129
v_mfma_f32_16x16x32_bf16 a[116:119],v[220:223],v[48:51],a[116:119]
v_cvt_pk_bf16_f32 v157,v130,v131
v_cvt_pk_bf16_f32 v158,v132,v133
v_mfma_f32_16x16x32_bf16 a[120:123],v[220:223],v[52:55],a[120:123]
v_cvt_pk_bf16_f32 v159,v134,v135
v_accvgpr_read_b32 v128,a20
v_mfma_f32_16x16x32_bf16 a[124:127],v[220:223],v[56:59],a[124:127]
v_accvgpr_read_b32 v129,a21
s_waitcnt lgkmcnt(4)
v_mfma_f32_16x16x32_bf16 a[80:83],v[224:227],v[60:63],a[80:83]
ds_read_b64_tr_b16 v[208:209],v252 offset:33856
v_accvgpr_read_b32 v130,a22
v_mfma_f32_16x16x32_bf16 a[84:87],v[224:227],v[64:67],a[84:87]
ds_read_b64_tr_b16 v[210:211],v252 offset:34368
v_accvgpr_read_b32 v131,a23
v_mfma_f32_16x16x32_bf16 a[88:91],v[224:227],v[68:71],a[88:91]
ds_read_b64_tr_b16 v[212:213],v252 offset:33888
v_accvgpr_read_b32 v132,a52
v_mfma_f32_16x16x32_bf16 a[92:95],v[224:227],v[72:75],a[92:95]
ds_read_b64_tr_b16 v[214:215],v252 offset:34400
v_accvgpr_read_b32 v133,a53
v_mfma_f32_16x16x32_bf16 a[112:115],v[228:231],v[60:63],a[112:115]
v_accvgpr_read_b32 v134,a54
v_accvgpr_read_b32 v135,a55
v_mfma_f32_16x16x32_bf16 a[116:119],v[228:231],v[64:67],a[116:119]
v_cvt_pk_bf16_f32 v148,v128,v129
v_cvt_pk_bf16_f32 v149,v130,v131
v_mfma_f32_16x16x32_bf16 a[120:123],v[228:231],v[68:71],a[120:123]
v_cvt_pk_bf16_f32 v150,v132,v133
v_cvt_pk_bf16_f32 v151,v134,v135
v_mfma_f32_16x16x32_bf16 a[124:127],v[228:231],v[72:75],a[124:127]
s_waitcnt lgkmcnt(4)
v_mfma_f32_16x16x32_bf16 a[80:83],v[232:235],v[76:79],a[80:83]
ds_read_b64_tr_b16 v[216:217],v252 offset:38080
v_mfma_f32_16x16x32_bf16 a[84:87],v[232:235],v[80:83],a[84:87]
ds_read_b64_tr_b16 v[218:219],v252 offset:38592
v_mfma_f32_16x16x32_bf16 a[88:91],v[232:235],v[84:87],a[88:91]
ds_read_b64_tr_b16 v[220:221],v252 offset:38112
v_mfma_f32_16x16x32_bf16 a[92:95],v[232:235],v[88:91],a[92:95]
ds_read_b64_tr_b16 v[222:223],v252 offset:38624
v_mfma_f32_16x16x32_bf16 a[112:115],v[236:239],v[76:79],a[112:115]
v_mfma_f32_16x16x32_bf16 a[116:119],v[236:239],v[80:83],a[116:119]
v_mfma_f32_16x16x32_bf16 a[120:123],v[236:239],v[84:87],a[120:123]
v_mfma_f32_16x16x32_bf16 a[124:127],v[236:239],v[88:91],a[124:127]
s_waitcnt lgkmcnt(4)
v_mfma_f32_16x16x32_bf16 a[80:83],v[208:211],v[92:95],a[80:83]
ds_read_b64_tr_b16 v[224:225],v252 offset:42304
v_mfma_f32_16x16x32_bf16 a[84:87],v[208:211],v[96:99],a[84:87]
ds_read_b64_tr_b16 v[226:227],v252 offset:42816
v_mfma_f32_16x16x32_bf16 a[88:91],v[208:211],v[100:103],a[88:91]
ds_read_b64_tr_b16 v[228:229],v252 offset:42336
buffer_store_dwordx4 v[148:151],v249,s[20:23],s63 offen sc1
v_mfma_f32_16x16x32_bf16 a[92:95],v[208:211],v[104:107],a[92:95]
ds_read_b64_tr_b16 v[230:231],v252 offset:42848
v_accvgpr_read_b32 v128,a24
v_mfma_f32_16x16x32_bf16 a[112:115],v[212:215],v[92:95],a[112:115]
v_accvgpr_read_b32 v129,a25
v_accvgpr_read_b32 v130,a26
v_mfma_f32_16x16x32_bf16 a[116:119],v[212:215],v[96:99],a[116:119]
v_accvgpr_read_b32 v131,a27
v_accvgpr_read_b32 v132,a56
v_mfma_f32_16x16x32_bf16 a[120:123],v[212:215],v[100:103],a[120:123]
v_accvgpr_read_b32 v133,a57
v_accvgpr_read_b32 v134,a58
v_mfma_f32_16x16x32_bf16 a[124:127],v[212:215],v[104:107],a[124:127]
v_accvgpr_read_b32 v135,a59
s_waitcnt lgkmcnt(4)
v_mfma_f32_16x16x32_bf16 a[80:83],v[216:219],v[108:111],a[80:83]
ds_read_b64_tr_b16 v[232:233],v252 offset:46528
v_cvt_pk_bf16_f32 v144,v128,v129
v_mfma_f32_16x16x32_bf16 a[84:87],v[216:219],v[112:115],a[84:87]
ds_read_b64_tr_b16 v[234:235],v252 offset:47040
v_cvt_pk_bf16_f32 v145,v130,v131
v_mfma_f32_16x16x32_bf16 a[88:91],v[216:219],v[116:119],a[88:91]
ds_read_b64_tr_b16 v[236:237],v252 offset:46560
v_cvt_pk_bf16_f32 v146,v132,v133
v_mfma_f32_16x16x32_bf16 a[92:95],v[216:219],v[120:123],a[92:95]
ds_read_b64_tr_b16 v[238:239],v252 offset:47072
v_cvt_pk_bf16_f32 v147,v134,v135
v_mfma_f32_16x16x32_bf16 a[112:115],v[220:223],v[108:111],a[112:115]
v_mfma_f32_16x16x32_bf16 a[116:119],v[220:223],v[112:115],a[116:119]
v_mfma_f32_16x16x32_bf16 a[120:123],v[220:223],v[116:119],a[120:123]
v_mfma_f32_16x16x32_bf16 a[124:127],v[220:223],v[120:123],a[124:127]
s_waitcnt lgkmcnt(4)
v_mfma_f32_16x16x32_bf16 a[80:83],v[224:227],v[124:127],a[80:83]
ds_read_b64_tr_b16 v[208:209],v255 offset:16960
v_mfma_f32_16x16x32_bf16 a[84:87],v[224:227],a[196:199],a[84:87]
ds_read_b64_tr_b16 v[210:211],v255 offset:17472
v_mfma_f32_16x16x32_bf16 a[88:91],v[224:227],a[200:203],a[88:91]
ds_read_b64_tr_b16 v[212:213],v255 offset:16992
v_mfma_f32_16x16x32_bf16 a[92:95],v[224:227],a[204:207],a[92:95]
ds_read_b64_tr_b16 v[214:215],v255 offset:17504
v_mfma_f32_16x16x32_bf16 a[112:115],v[228:231],v[124:127],a[112:115]
v_mfma_f32_16x16x32_bf16 a[116:119],v[228:231],a[196:199],a[116:119]
v_mfma_f32_16x16x32_bf16 a[120:123],v[228:231],a[200:203],a[120:123]
buffer_store_dwordx4 v[144:147],v249,s[20:23],s64 offen sc1
v_accvgpr_read_b32 v128,a28
v_mfma_f32_16x16x32_bf16 a[124:127],v[228:231],a[204:207],a[124:127]
v_accvgpr_read_b32 v129,a29
s_waitcnt lgkmcnt(4)
v_mfma_f32_16x16x32_bf16 a[80:83],v[232:235],a[224:227],a[80:83]
ds_read_b64_tr_b16 v[216:217],v255 offset:21184
v_accvgpr_read_b32 v130,a30
v_mfma_f32_16x16x32_bf16 a[84:87],v[232:235],a[228:231],a[84:87]
ds_read_b64_tr_b16 v[218:219],v255 offset:21696
v_accvgpr_read_b32 v131,a31
v_mfma_f32_16x16x32_bf16 a[88:91],v[232:235],a[232:235],a[88:91]
ds_read_b64_tr_b16 v[220:221],v255 offset:21216
v_accvgpr_read_b32 v132,a60
v_mfma_f32_16x16x32_bf16 a[92:95],v[232:235],a[236:239],a[92:95]
ds_read_b64_tr_b16 v[222:223],v255 offset:21728
v_accvgpr_read_b32 v133,a61
v_mfma_f32_16x16x32_bf16 a[112:115],v[236:239],a[224:227],a[112:115]
v_accvgpr_read_b32 v134,a62
v_accvgpr_read_b32 v135,a63
v_mfma_f32_16x16x32_bf16 a[116:119],v[236:239],a[228:231],a[116:119]
v_cvt_pk_bf16_f32 v148,v128,v129
v_cvt_pk_bf16_f32 v149,v130,v131
v_mfma_f32_16x16x32_bf16 a[120:123],v[236:239],a[232:235],a[120:123]
v_cvt_pk_bf16_f32 v150,v132,v133
v_cvt_pk_bf16_f32 v151,v134,v135
v_mfma_f32_16x16x32_bf16 a[124:127],v[236:239],a[236:239],a[124:127]
s_waitcnt lgkmcnt(4)
v_mfma_f32_16x16x32_bf16 a[80:83],v[208:211],v[0:3],a[80:83]
ds_read_b64_tr_b16 v[224:225],v255 offset:25408
v_mfma_f32_16x16x32_bf16 a[84:87],v[208:211],a[164:167],a[84:87]
ds_read_b64_tr_b16 v[226:227],v255 offset:25920
v_mfma_f32_16x16x32_bf16 a[88:91],v[208:211],a[168:171],a[88:91]
ds_read_b64_tr_b16 v[228:229],v255 offset:25440
v_mfma_f32_16x16x32_bf16 a[92:95],v[208:211],v[4:7],a[92:95]
ds_read_b64_tr_b16 v[230:231],v255 offset:25952
v_mfma_f32_16x16x32_bf16 a[112:115],v[212:215],v[0:3],a[112:115]
v_mfma_f32_16x16x32_bf16 a[116:119],v[212:215],a[164:167],a[116:119]
v_mfma_f32_16x16x32_bf16 a[120:123],v[212:215],a[168:171],a[120:123]
v_mfma_f32_16x16x32_bf16 a[124:127],v[212:215],v[4:7],a[124:127]
s_waitcnt lgkmcnt(4)
v_mfma_f32_16x16x32_bf16 a[80:83],v[216:219],v[8:11],a[80:83]
ds_read_b64_tr_b16 v[232:233],v255 offset:29632
v_mfma_f32_16x16x32_bf16 a[84:87],v[216:219],a[172:175],a[84:87]
ds_read_b64_tr_b16 v[234:235],v255 offset:30144
v_mfma_f32_16x16x32_bf16 a[88:91],v[216:219],a[192:195],a[88:91]
ds_read_b64_tr_b16 v[236:237],v255 offset:29664
buffer_store_dwordx4 v[148:151],v249,s[20:23],s65 offen sc1
v_mfma_f32_16x16x32_bf16 a[92:95],v[216:219],v[12:15],a[92:95]
ds_read_b64_tr_b16 v[238:239],v255 offset:30176
v_mfma_f32_16x16x32_bf16 a[112:115],v[220:223],v[8:11],a[112:115]
v_mfma_f32_16x16x32_bf16 a[116:119],v[220:223],a[172:175],a[116:119]
v_mfma_f32_16x16x32_bf16 a[120:123],v[220:223],a[192:195],a[120:123]
v_mfma_f32_16x16x32_bf16 a[124:127],v[220:223],v[12:15],a[124:127]
s_waitcnt lgkmcnt(4)
v_mfma_f32_16x16x32_bf16 a[80:83],v[224:227],a[136:139],a[80:83]
ds_read_b64_tr_b16 v[208:209],v255 offset:64
v_mfma_f32_16x16x32_bf16 a[84:87],v[224:227],a[140:143],a[84:87]
ds_read_b64_tr_b16 v[210:211],v255 offset:576
v_mfma_f32_16x16x32_bf16 a[88:91],v[224:227],a[160:163],a[88:91]
ds_read_b64_tr_b16 v[212:213],v255 offset:96
v_mfma_f32_16x16x32_bf16 a[92:95],v[224:227],v[16:19],a[92:95]
ds_read_b64_tr_b16 v[214:215],v255 offset:608
v_mfma_f32_16x16x32_bf16 a[112:115],v[228:231],a[136:139],a[112:115]
v_mfma_f32_16x16x32_bf16 a[116:119],v[228:231],a[140:143],a[116:119]
v_mfma_f32_16x16x32_bf16 a[120:123],v[228:231],a[160:163],a[120:123]
v_mfma_f32_16x16x32_bf16 a[124:127],v[228:231],v[16:19],a[124:127]
s_waitcnt lgkmcnt(4)
v_mfma_f32_16x16x32_bf16 a[80:83],v[232:235],v[20:23],a[80:83]
ds_read_b64_tr_b16 v[216:217],v255 offset:4288
v_mfma_f32_16x16x32_bf16 a[84:87],v[232:235],v[24:27],a[84:87]
ds_read_b64_tr_b16 v[218:219],v255 offset:4800
v_mfma_f32_16x16x32_bf16 a[88:91],v[232:235],a[0:3],a[88:91]
ds_read_b64_tr_b16 v[220:221],v255 offset:4320
v_mfma_f32_16x16x32_bf16 a[92:95],v[232:235],a[4:7],a[92:95]
ds_read_b64_tr_b16 v[222:223],v255 offset:4832
v_mfma_f32_16x16x32_bf16 a[112:115],v[236:239],v[20:23],a[112:115]
v_mfma_f32_16x16x32_bf16 a[116:119],v[236:239],v[24:27],a[116:119]
v_mfma_f32_16x16x32_bf16 a[120:123],v[236:239],a[0:3],a[120:123]
v_mfma_f32_16x16x32_bf16 a[124:127],v[236:239],a[4:7],a[124:127]
s_waitcnt lgkmcnt(4)
v_mfma_f32_16x16x32_bf16 a[80:83],v[208:211],a[8:11],a[80:83]
ds_read_b64_tr_b16 v[224:225],v255 offset:8512
v_mfma_f32_16x16x32_bf16 a[84:87],v[208:211],a[12:15],a[84:87]
ds_read_b64_tr_b16 v[226:227],v255 offset:9024
v_mfma_f32_16x16x32_bf16 a[88:91],v[208:211],a[32:35],a[88:91]
ds_read_b64_tr_b16 v[228:229],v255 offset:8544
v_mfma_f32_16x16x32_bf16 a[92:95],v[208:211],a[36:39],a[92:95]
ds_read_b64_tr_b16 v[230:231],v255 offset:9056
v_mfma_f32_16x16x32_bf16 a[112:115],v[212:215],a[8:11],a[112:115]
v_mfma_f32_16x16x32_bf16 a[116:119],v[212:215],a[12:15],a[116:119]
v_mfma_f32_16x16x32_bf16 a[120:123],v[212:215],a[32:35],a[120:123]
v_mfma_f32_16x16x32_bf16 a[124:127],v[212:215],a[36:39],a[124:127]
s_waitcnt lgkmcnt(4)
v_mfma_f32_16x16x32_bf16 a[80:83],v[216:219],a[40:43],a[80:83]
ds_read_b64_tr_b16 v[232:233],v255 offset:12736
v_mfma_f32_16x16x32_bf16 a[84:87],v[216:219],a[44:47],a[84:87]
ds_read_b64_tr_b16 v[234:235],v255 offset:13248
v_mfma_f32_16x16x32_bf16 a[88:91],v[216:219],a[64:67],a[88:91]
ds_read_b64_tr_b16 v[236:237],v255 offset:12768
v_mfma_f32_16x16x32_bf16 a[92:95],v[216:219],a[68:71],a[92:95]
ds_read_b64_tr_b16 v[238:239],v255 offset:13280
v_mfma_f32_16x16x32_bf16 a[112:115],v[220:223],a[40:43],a[112:115]
v_mfma_f32_16x16x32_bf16 a[116:119],v[220:223],a[44:47],a[116:119]
v_mfma_f32_16x16x32_bf16 a[120:123],v[220:223],a[64:67],a[120:123]
v_mfma_f32_16x16x32_bf16 a[124:127],v[220:223],a[68:71],a[124:127]
s_waitcnt lgkmcnt(4)
v_mfma_f32_16x16x32_bf16 a[80:83],v[224:227],a[72:75],a[80:83]
v_mfma_f32_16x16x32_bf16 a[84:87],v[224:227],a[76:79],a[84:87]
s_waitcnt vmcnt(63) lgkmcnt(0)
s_barrier
v_mfma_f32_16x16x32_bf16 a[88:91],v[224:227],a[96:99],a[88:91]
ds_read_b64_tr_b16 v[208:209],v255 offset:33792
buffer_atomic_add v141,v248,s[0:3],0 offen sc1
v_mfma_f32_16x16x32_bf16 a[92:95],v[224:227],a[100:103],a[92:95]
ds_read_b64_tr_b16 v[210:211],v255 offset:34304
v_mfma_f32_16x16x32_bf16 a[112:115],v[228:231],a[72:75],a[112:115]
ds_read_b64_tr_b16 v[212:213],v255 offset:33824
v_mfma_f32_16x16x32_bf16 a[116:119],v[228:231],a[76:79],a[116:119]
ds_read_b64_tr_b16 v[214:215],v255 offset:34336
v_mfma_f32_16x16x32_bf16 a[120:123],v[228:231],a[96:99],a[120:123]
v_mfma_f32_16x16x32_bf16 a[124:127],v[228:231],a[100:103],a[124:127]
v_mfma_f32_16x16x32_bf16 a[80:83],v[232:235],a[104:107],a[80:83]
ds_read_b64_tr_b16 v[216:217],v255 offset:38016
v_mfma_f32_16x16x32_bf16 a[84:87],v[232:235],a[108:111],a[84:87]
ds_read_b64_tr_b16 v[218:219],v255 offset:38528
v_mfma_f32_16x16x32_bf16 a[88:91],v[232:235],a[128:131],a[88:91]
ds_read_b64_tr_b16 v[220:221],v255 offset:38048
v_mfma_f32_16x16x32_bf16 a[92:95],v[232:235],a[132:135],a[92:95]
ds_read_b64_tr_b16 v[222:223],v255 offset:38560
v_mfma_f32_16x16x32_bf16 a[112:115],v[236:239],a[104:107],a[112:115]
v_mfma_f32_16x16x32_bf16 a[116:119],v[236:239],a[108:111],a[116:119]
v_mfma_f32_16x16x32_bf16 a[120:123],v[236:239],a[128:131],a[120:123]
s_waitcnt lgkmcnt(4)
v_mfma_f32_16x16x32_bf16 a[124:127],v[236:239],a[132:135],a[124:127]
.p2alignl 6, 0xbf800000
L_ploop:
v_mfma_f32_16x16x32_bf16 a[16:19],v[208:211],v[28:31],0
ds_read_b64_tr_b16 v[224:225],v255 offset:42240
v_mfma_f32_16x16x32_bf16 a[20:23],v[208:211],v[32:35],0
ds_read_b64_tr_b16 v[226:227],v255 offset:42752
v_mfma_f32_16x16x32_bf16 a[24:27],v[208:211],v[36:39],0
ds_read_b64_tr_b16 v[228:229],v255 offset:42272
v_mfma_f32_16x16x32_bf16 a[28:31],v[208:211],v[40:43],0
ds_read_b64_tr_b16 v[230:231],v255 offset:42784
s_cmp_lg_u32 s36,3
s_cselect_b32 s58,s68,0
s_and_b32 s10,s58,26944
v_mfma_f32_16x16x32_bf16 a[48:51],v[212:215],v[28:31],0
s_add_u32 m0,s29,16896
v_accvgpr_read_b32 v128,a80
v_mfma_f32_16x16x32_bf16 a[52:55],v[212:215],v[32:35],0
buffer_load_dwordx4 v254,s[16:19],s32 offen offset:0 lds
s_add_u32 m0,m0,0x000000a0
v_mfma_f32_16x16x32_bf16 a[56:59],v[212:215],v[36:39],0
v_accvgpr_read_b32 v129,a81
v_accvgpr_read_b32 v130,a82
v_mfma_f32_16x16x32_bf16 a[60:63],v[212:215],v[40:43],0
v_accvgpr_read_b32 v131,a83
s_waitcnt lgkmcnt(4)
v_mfma_f32_16x16x32_bf16 a[16:19],v[216:219],v[44:47],a[16:19]
ds_read_b64_tr_b16 v[232:233],v255 offset:46464
v_accvgpr_read_b32 v132,a112
v_mfma_f32_16x16x32_bf16 a[20:23],v[216:219],v[48:51],a[20:23]
ds_read_b64_tr_b16 v[234:235],v255 offset:46976
buffer_load_dwordx4 v254,s[16:19],s32 offen offset:896 lds
v_mfma_f32_16x16x32_bf16 a[24:27],v[216:219],v[52:55],a[24:27]
ds_read_b64_tr_b16 v[236:237],v255 offset:46496
s_add_u32 m0,m0,0x000000a0
v_mfma_f32_16x16x32_bf16 a[28:31],v[216:219],v[56:59],a[28:31]
ds_read_b64_tr_b16 v[238:239],v255 offset:47008
v_accvgpr_read_b32 v133,a113
v_mfma_f32_16x16x32_bf16 a[48:51],v[220:223],v[44:47],a[48:51]
v_accvgpr_read_b32 v134,a114
v_accvgpr_read_b32 v135,a115
v_mfma_f32_16x16x32_bf16 a[52:55],v[220:223],v[48:51],a[52:55]
v_cvt_pk_bf16_f32 v144,v128,v129
v_cvt_pk_bf16_f32 v145,v130,v131
v_mfma_f32_16x16x32_bf16 a[56:59],v[220:223],v[52:55],a[56:59]
v_cvt_pk_bf16_f32 v146,v132,v133
v_cvt_pk_bf16_f32 v147,v134,v135
v_mfma_f32_16x16x32_bf16 a[60:63],v[220:223],v[56:59],a[60:63]
buffer_load_dwordx4 v254,s[16:19],s32 offen offset:1792 lds
s_waitcnt lgkmcnt(4)
v_mfma_f32_16x16x32_bf16 a[16:19],v[224:227],v[60:63],a[16:19]
ds_read_b64_tr_b16 v[208:209],v252 offset:0
s_add_u32 m0,m0,0x000000a0
v_mfma_f32_16x16x32_bf16 a[20:23],v[224:227],v[64:67],a[20:23]
ds_read_b64_tr_b16 v[210:211],v252 offset:512
v_lshlrev_b32 v240,16,v164
v_mfma_f32_16x16x32_bf16 a[24:27],v[224:227],v[68:71],a[24:27]
ds_read_b64_tr_b16 v[212:213],v252 offset:32
buffer_store_dwordx4 v[144:147],v250,s[20:23],s62 offen sc1
v_mfma_f32_16x16x32_bf16 a[28:31],v[224:227],v[72:75],a[28:31]
ds_read_b64_tr_b16 v[214:215],v252 offset:544
v_accvgpr_read_b32 v128,a84
v_mfma_f32_16x16x32_bf16 a[48:51],v[228:231],v[60:63],a[48:51]
v_accvgpr_read_b32 v129,a85
v_accvgpr_read_b32 v130,a86
v_mfma_f32_16x16x32_bf16 a[52:55],v[228:231],v[64:67],a[52:55]
buffer_load_dwordx4 v254,s[16:19],s32 offen offset:2688 lds
s_add_u32 s32,s32,0x0001c000
v_mfma_f32_16x16x32_bf16 a[56:59],v[228:231],v[68:71],a[56:59]
s_add_u32 m0,s29,33792
v_accvgpr_read_b32 v131,a87
v_mfma_f32_16x16x32_bf16 a[60:63],v[228:231],v[72:75],a[60:63]
v_accvgpr_read_b32 v132,a116
s_waitcnt lgkmcnt(4)
v_mfma_f32_16x16x32_bf16 a[16:19],v[232:235],v[76:79],a[16:19]
ds_read_b64_tr_b16 v[216:217],v252 offset:4224
v_accvgpr_read_b32 v133,a117
v_mfma_f32_16x16x32_bf16 a[20:23],v[232:235],v[80:83],a[20:23]
ds_read_b64_tr_b16 v[218:219],v252 offset:4736
v_accvgpr_read_b32 v134,a118
v_mfma_f32_16x16x32_bf16 a[24:27],v[232:235],v[84:87],a[24:27]
ds_read_b64_tr_b16 v[220:221],v252 offset:4256
v_accvgpr_read_b32 v135,a119
v_mfma_f32_16x16x32_bf16 a[28:31],v[232:235],v[88:91],a[28:31]
ds_read_b64_tr_b16 v[222:223],v252 offset:4768
buffer_load_dwordx4 v254,s[16:19],s32 offen offset:0 lds
v_mfma_f32_16x16x32_bf16 a[48:51],v[236:239],v[76:79],a[48:51]
s_add_u32 m0,m0,0x000000a0
v_cvt_pk_bf16_f32 v148,v128,v129
v_mfma_f32_16x16x32_bf16 a[52:55],v[236:239],v[80:83],a[52:55]
v_cvt_pk_bf16_f32 v149,v130,v131
v_cvt_pk_bf16_f32 v150,v132,v133
v_mfma_f32_16x16x32_bf16 a[56:59],v[236:239],v[84:87],a[56:59]
v_cvt_pk_bf16_f32 v151,v134,v135
v_and_b32 v241,0xffff0000,v164
v_mfma_f32_16x16x32_bf16 a[60:63],v[236:239],v[88:91],a[60:63]
v_lshlrev_b32 v242,16,v165
s_waitcnt lgkmcnt(4)
v_mfma_f32_16x16x32_bf16 a[16:19],v[208:211],v[92:95],a[16:19]
ds_read_b64_tr_b16 v[224:225],v252 offset:8448
v_and_b32 v243,0xffff0000,v165
v_mfma_f32_16x16x32_bf16 a[20:23],v[208:211],v[96:99],a[20:23]
ds_read_b64_tr_b16 v[226:227],v252 offset:8960
buffer_load_dwordx4 v254,s[16:19],s32 offen offset:896 lds
v_mfma_f32_16x16x32_bf16 a[24:27],v[208:211],v[100:103],a[24:27]
ds_read_b64_tr_b16 v[228:229],v252 offset:8480
s_add_u32 m0,m0,0x000000a0
v_mfma_f32_16x16x32_bf16 a[28:31],v[208:211],v[104:107],a[28:31]
ds_read_b64_tr_b16 v[230:231],v252 offset:8992
v_lshlrev_b32 v244,16,v166
v_mfma_f32_16x16x32_bf16 a[48:51],v[212:215],v[92:95],a[48:51]
v_and_b32 v245,0xffff0000,v166
v_lshlrev_b32 v246,16,v167
v_mfma_f32_16x16x32_bf16 a[52:55],v[212:215],v[96:99],a[52:55]
v_and_b32 v247,0xffff0000,v167
s_waitcnt vmcnt(17)
v_mfma_f32_16x16x32_bf16 a[56:59],v[212:215],v[100:103],a[56:59]
v_lshlrev_b32 v136,16,v176
v_and_b32 v176,0xffff0000,v176
v_mfma_f32_16x16x32_bf16 a[60:63],v[212:215],v[104:107],a[60:63]
buffer_load_dwordx4 v254,s[16:19],s32 offen offset:1792 lds
s_waitcnt lgkmcnt(4)
v_mfma_f32_16x16x32_bf16 a[16:19],v[216:219],v[108:111],a[16:19]
ds_read_b64_tr_b16 v[232:233],v252 offset:12672
s_add_u32 m0,m0,0x000000a0
v_mfma_f32_16x16x32_bf16 a[20:23],v[216:219],v[112:115],a[20:23]
ds_read_b64_tr_b16 v[234:235],v252 offset:13184
v_add_f32 v240,v240,v136
v_mfma_f32_16x16x32_bf16 a[24:27],v[216:219],v[116:119],a[24:27]
ds_read_b64_tr_b16 v[236:237],v252 offset:12704
v_add_f32 v241,v241,v176
v_mfma_f32_16x16x32_bf16 a[28:31],v[216:219],v[120:123],a[28:31]
ds_read_b64_tr_b16 v[238:239],v252 offset:13216
v_lshlrev_b32 v136,16,v177
v_mfma_f32_16x16x32_bf16 a[48:51],v[220:223],v[108:111],a[48:51]
buffer_store_dwordx4 v[148:151],v250,s[20:23],s63 offen sc1
v_accvgpr_read_b32 v128,a88
v_mfma_f32_16x16x32_bf16 a[52:55],v[220:223],v[112:115],a[52:55]
buffer_load_dwordx4 v254,s[16:19],s32 offen offset:2688 lds
s_add_u32 s32,s32,0x0001c000
v_mfma_f32_16x16x32_bf16 a[56:59],v[220:223],v[116:119],a[56:59]
s_add_u32 m0,s29,67584
v_accvgpr_read_b32 v129,a89
v_mfma_f32_16x16x32_bf16 a[60:63],v[220:223],v[120:123],a[60:63]
v_accvgpr_read_b32 v130,a90
s_waitcnt lgkmcnt(4)
v_mfma_f32_16x16x32_bf16 a[16:19],v[224:227],v[124:127],a[16:19]
ds_read_b64_tr_b16 v[208:209],v253 offset:0
v_accvgpr_read_b32 v131,a91
v_mfma_f32_16x16x32_bf16 a[20:23],v[224:227],a[196:199],a[20:23]
ds_read_b64_tr_b16 v[210:211],v253 offset:512
v_accvgpr_read_b32 v132,a120
v_mfma_f32_16x16x32_bf16 a[24:27],v[224:227],a[200:203],a[24:27]
ds_read_b64_tr_b16 v[212:213],v253 offset:32
v_accvgpr_read_b32 v133,a121
v_mfma_f32_16x16x32_bf16 a[28:31],v[224:227],a[204:207],a[28:31]
ds_read_b64_tr_b16 v[214:215],v253 offset:544
buffer_load_dwordx4 v254,s[16:19],s32 offen offset:0 lds
v_mfma_f32_16x16x32_bf16 a[48:51],v[228:231],v[124:127],a[48:51]
s_add_u32 m0,m0,0x000000a0
v_accvgpr_read_b32 v134,a122
v_mfma_f32_16x16x32_bf16 a[52:55],v[228:231],a[196:199],a[52:55]
v_accvgpr_read_b32 v135,a123
v_cvt_pk_bf16_f32 v144,v128,v129
v_mfma_f32_16x16x32_bf16 a[56:59],v[228:231],a[200:203],a[56:59]
v_cvt_pk_bf16_f32 v145,v130,v131
v_cvt_pk_bf16_f32 v146,v132,v133
v_mfma_f32_16x16x32_bf16 a[60:63],v[228:231],a[204:207],a[60:63]
v_cvt_pk_bf16_f32 v147,v134,v135
s_waitcnt lgkmcnt(4)
v_mfma_f32_16x16x32_bf16 a[16:19],v[232:235],a[224:227],a[16:19]
ds_read_b64_tr_b16 v[216:217],v253 offset:4224
v_and_b32 v177,0xffff0000,v177
v_mfma_f32_16x16x32_bf16 a[20:23],v[232:235],a[228:231],a[20:23]
ds_read_b64_tr_b16 v[218:219],v253 offset:4736
buffer_load_dwordx4 v254,s[16:19],s32 offen offset:896 lds
v_mfma_f32_16x16x32_bf16 a[24:27],v[232:235],a[232:235],a[24:27]
ds_read_b64_tr_b16 v[220:221],v253 offset:4256
s_add_u32 m0,m0,0x000000a0
v_mfma_f32_16x16x32_bf16 a[28:31],v[232:235],a[236:239],a[28:31]
ds_read_b64_tr_b16 v[222:223],v253 offset:4768
v_add_f32 v242,v242,v136
v_mfma_f32_16x16x32_bf16 a[48:51],v[236:239],a[224:227],a[48:51]
v_add_f32 v243,v243,v177
v_lshlrev_b32 v136,16,v178
v_mfma_f32_16x16x32_bf16 a[52:55],v[236:239],a[228:231],a[52:55]
v_and_b32 v178,0xffff0000,v178
v_add_f32 v244,v244,v136
v_mfma_f32_16x16x32_bf16 a[56:59],v[236:239],a[232:235],a[56:59]
v_add_f32 v245,v245,v178
v_lshlrev_b32 v136,16,v179
v_mfma_f32_16x16x32_bf16 a[60:63],v[236:239],a[236:239],a[60:63]
buffer_load_dwordx4 v254,s[16:19],s32 offen offset:1792 lds
s_waitcnt lgkmcnt(4)
v_mfma_f32_16x16x32_bf16 a[16:19],v[208:211],v[0:3],a[16:19]
ds_read_b64_tr_b16 v[224:225],v253 offset:8448
s_add_u32 m0,m0,0x000000a0
v_mfma_f32_16x16x32_bf16 a[20:23],v[208:211],a[164:167],a[20:23]
ds_read_b64_tr_b16 v[226:227],v253 offset:8960
v_and_b32 v179,0xffff0000,v179
v_mfma_f32_16x16x32_bf16 a[24:27],v[208:211],a[168:171],a[24:27]
ds_read_b64_tr_b16 v[228:229],v253 offset:8480
v_add_f32 v246,v246,v136
v_mfma_f32_16x16x32_bf16 a[28:31],v[208:211],v[4:7],a[28:31]
ds_read_b64_tr_b16 v[230:231],v253 offset:8992
v_add_f32 v247,v247,v179
v_mfma_f32_16x16x32_bf16 a[48:51],v[212:215],v[0:3],a[48:51]
v_lshlrev_b32 v136,16,v180
v_and_b32 v180,0xffff0000,v180
v_mfma_f32_16x16x32_bf16 a[52:55],v[212:215],a[164:167],a[52:55]
buffer_load_dwordx4 v254,s[16:19],s32 offen offset:2688 lds
s_add_u32 s32,s32,0x0001c000
v_mfma_f32_16x16x32_bf16 a[56:59],v[212:215],a[168:171],a[56:59]
s_add_u32 m0,s29,50688
buffer_store_dwordx4 v[144:147],v250,s[20:23],s64 offen sc1
v_mfma_f32_16x16x32_bf16 a[60:63],v[212:215],v[4:7],a[60:63]
v_accvgpr_read_b32 v128,a92
s_waitcnt lgkmcnt(4)
v_mfma_f32_16x16x32_bf16 a[16:19],v[216:219],v[8:11],a[16:19]
ds_read_b64_tr_b16 v[232:233],v253 offset:12672
v_accvgpr_read_b32 v129,a93
v_mfma_f32_16x16x32_bf16 a[20:23],v[216:219],a[172:175],a[20:23]
ds_read_b64_tr_b16 v[234:235],v253 offset:13184
v_accvgpr_read_b32 v130,a94
v_mfma_f32_16x16x32_bf16 a[24:27],v[216:219],a[192:195],a[24:27]
ds_read_b64_tr_b16 v[236:237],v253 offset:12704
v_accvgpr_read_b32 v131,a95
v_mfma_f32_16x16x32_bf16 a[28:31],v[216:219],v[12:15],a[28:31]
ds_read_b64_tr_b16 v[238:239],v253 offset:13216
buffer_load_dwordx4 v254,s[16:19],s32 offen offset:0 lds
v_mfma_f32_16x16x32_bf16 a[48:51],v[220:223],v[8:11],a[48:51]
s_add_u32 m0,m0,0x000000a0
v_accvgpr_read_b32 v132,a124
v_mfma_f32_16x16x32_bf16 a[52:55],v[220:223],a[172:175],a[52:55]
v_accvgpr_read_b32 v133,a125
v_accvgpr_read_b32 v134,a126
v_mfma_f32_16x16x32_bf16 a[56:59],v[220:223],a[192:195],a[56:59]
v_accvgpr_read_b32 v135,a127
v_cvt_pk_bf16_f32 v148,v128,v129
v_mfma_f32_16x16x32_bf16 a[60:63],v[220:223],v[12:15],a[60:63]
v_cvt_pk_bf16_f32 v149,v130,v131
s_waitcnt lgkmcnt(4)
v_mfma_f32_16x16x32_bf16 a[16:19],v[224:227],a[136:139],a[16:19]
ds_read_b64_tr_b16 v[208:209],v253 offset:16896
v_cvt_pk_bf16_f32 v150,v132,v133
v_mfma_f32_16x16x32_bf16 a[20:23],v[224:227],a[140:143],a[20:23]
ds_read_b64_tr_b16 v[210:211],v253 offset:17408
buffer_load_dwordx4 v254,s[16:19],s32 offen offset:896 lds
v_mfma_f32_16x16x32_bf16 a[24:27],v[224:227],a[160:163],a[24:27]
ds_read_b64_tr_b16 v[212:213],v253 offset:16928
s_add_u32 m0,m0,0x000000a0
v_mfma_f32_16x16x32_bf16 a[28:31],v[224:227],v[16:19],a[28:31]
ds_read_b64_tr_b16 v[214:215],v253 offset:17440
v_cvt_pk_bf16_f32 v151,v134,v135
v_mfma_f32_16x16x32_bf16 a[48:51],v[228:231],a[136:139],a[48:51]
buffer_load_dword v137,v142,s[12:15],0 offen sc1
v_add_f32 v240,v240,v136
v_mfma_f32_16x16x32_bf16 a[52:55],v[228:231],a[140:143],a[52:55]
v_add_f32 v241,v241,v180
v_lshlrev_b32 v136,16,v181
v_mfma_f32_16x16x32_bf16 a[56:59],v[228:231],a[160:163],a[56:59]
v_and_b32 v181,0xffff0000,v181
v_add_f32 v242,v242,v136
v_mfma_f32_16x16x32_bf16 a[60:63],v[228:231],v[16:19],a[60:63]
buffer_load_dwordx4 v254,s[16:19],s32 offen offset:1792 lds
s_waitcnt lgkmcnt(4)
v_mfma_f32_16x16x32_bf16 a[16:19],v[232:235],v[20:23],a[16:19]
ds_read_b64_tr_b16 v[216:217],v253 offset:21120
s_add_u32 m0,m0,0x000000a0
v_mfma_f32_16x16x32_bf16 a[20:23],v[232:235],v[24:27],a[20:23]
ds_read_b64_tr_b16 v[218:219],v253 offset:21632
v_add_f32 v243,v243,v181
v_mfma_f32_16x16x32_bf16 a[24:27],v[232:235],a[0:3],a[24:27]
ds_read_b64_tr_b16 v[220:221],v253 offset:21152
v_lshlrev_b32 v136,16,v182
v_mfma_f32_16x16x32_bf16 a[28:31],v[232:235],a[4:7],a[28:31]
ds_read_b64_tr_b16 v[222:223],v253 offset:21664
v_and_b32 v182,0xffff0000,v182
v_mfma_f32_16x16x32_bf16 a[48:51],v[236:239],v[20:23],a[48:51]
v_add_f32 v244,v244,v136
v_add_f32 v245,v245,v182
v_mfma_f32_16x16x32_bf16 a[52:55],v[236:239],v[24:27],a[52:55]
buffer_load_dwordx4 v254,s[16:19],s32 offen offset:2688 lds
s_add_u32 s32,s32,0xfffac080
v_mfma_f32_16x16x32_bf16 a[56:59],v[236:239],a[0:3],a[56:59]
v_lshlrev_b32 v136,16,v183
v_and_b32 v183,0xffff0000,v183
v_mfma_f32_16x16x32_bf16 a[60:63],v[236:239],a[4:7],a[60:63]
v_add_f32 v246,v246,v136
s_waitcnt lgkmcnt(4)
v_mfma_f32_16x16x32_bf16 a[16:19],v[208:211],a[8:11],a[16:19]
ds_read_b64_tr_b16 v[224:225],v253 offset:25344
buffer_store_dwordx4 v[148:151],v250,s[20:23],s65 offen sc1
v_mfma_f32_16x16x32_bf16 a[20:23],v[208:211],a[12:15],a[20:23]
ds_read_b64_tr_b16 v[226:227],v253 offset:25856
v_add_f32 v247,v247,v183
v_mfma_f32_16x16x32_bf16 a[24:27],v[208:211],a[32:35],a[24:27]
ds_read_b64_tr_b16 v[228:229],v253 offset:25376
s_waitcnt vmcnt(28)
v_mfma_f32_16x16x32_bf16 a[28:31],v[208:211],a[36:39],a[28:31]
ds_read_b64_tr_b16 v[230:231],v253 offset:25888
v_lshlrev_b32 v136,16,v184
v_mfma_f32_16x16x32_bf16 a[48:51],v[212:215],a[8:11],a[48:51]
buffer_load_dword v140,v139,s[0:3],0 offen sc1
v_and_b32 v184,0xffff0000,v184
v_mfma_f32_16x16x32_bf16 a[52:55],v[212:215],a[12:15],a[52:55]
s_add_u32 s20,s20,2048
s_addc_u32 s21,s21,0
v_mfma_f32_16x16x32_bf16 a[56:59],v[212:215],a[32:35],a[56:59]
s_sub_u32 s22,s22,2048
v_add_f32 v240,v240,v136
v_mfma_f32_16x16x32_bf16 a[60:63],v[212:215],a[36:39],a[60:63]
v_add_f32 v241,v241,v184
s_waitcnt lgkmcnt(4)
v_mfma_f32_16x16x32_bf16 a[16:19],v[216:219],a[40:43],a[16:19]
ds_read_b64_tr_b16 v[232:233],v253 offset:29568
v_lshlrev_b32 v136,16,v185
v_mfma_f32_16x16x32_bf16 a[20:23],v[216:219],a[44:47],a[20:23]
ds_read_b64_tr_b16 v[234:235],v253 offset:30080
v_and_b32 v185,0xffff0000,v185
v_mfma_f32_16x16x32_bf16 a[24:27],v[216:219],a[64:67],a[24:27]
ds_read_b64_tr_b16 v[236:237],v253 offset:29600
v_add_f32 v242,v242,v136
v_mfma_f32_16x16x32_bf16 a[28:31],v[216:219],a[68:71],a[28:31]
ds_read_b64_tr_b16 v[238:239],v253 offset:30112
v_add_f32 v243,v243,v185
v_mfma_f32_16x16x32_bf16 a[48:51],v[220:223],a[40:43],a[48:51]
v_lshlrev_b32 v136,16,v186
v_and_b32 v186,0xffff0000,v186
v_mfma_f32_16x16x32_bf16 a[52:55],v[220:223],a[44:47],a[52:55]
v_add_f32 v244,v244,v136
v_add_f32 v245,v245,v186
v_mfma_f32_16x16x32_bf16 a[56:59],v[220:223],a[64:67],a[56:59]
v_lshlrev_b32 v136,16,v187
v_and_b32 v187,0xffff0000,v187
v_mfma_f32_16x16x32_bf16 a[60:63],v[220:223],a[68:71],a[60:63]
v_add_f32 v246,v246,v136
s_waitcnt lgkmcnt(4)
v_mfma_f32_16x16x32_bf16 a[16:19],v[224:227],a[72:75],a[16:19]
ds_read_b64_tr_b16 v[208:209],v255 offset:33856
v_add_f32 v247,v247,v187
v_mfma_f32_16x16x32_bf16 a[20:23],v[224:227],a[76:79],a[20:23]
ds_read_b64_tr_b16 v[210:211],v255 offset:34368
v_lshlrev_b32 v136,16,v188
v_mfma_f32_16x16x32_bf16 a[24:27],v[224:227],a[96:99],a[24:27]
ds_read_b64_tr_b16 v[212:213],v255 offset:33888
v_and_b32 v188,0xffff0000,v188
v_mfma_f32_16x16x32_bf16 a[28:31],v[224:227],a[100:103],a[28:31]
ds_read_b64_tr_b16 v[214:215],v255 offset:34400
v_add_f32 v240,v240,v136
v_mfma_f32_16x16x32_bf16 a[48:51],v[228:231],a[72:75],a[48:51]
v_add_f32 v241,v241,v188
v_lshlrev_b32 v136,16,v189
v_mfma_f32_16x16x32_bf16 a[52:55],v[228:231],a[76:79],a[52:55]
v_and_b32 v189,0xffff0000,v189
v_add_f32 v242,v242,v136
v_mfma_f32_16x16x32_bf16 a[56:59],v[228:231],a[96:99],a[56:59]
v_add_f32 v243,v243,v189
v_lshlrev_b32 v136,16,v190
v_mfma_f32_16x16x32_bf16 a[60:63],v[228:231],a[100:103],a[60:63]
v_and_b32 v190,0xffff0000,v190
s_waitcnt lgkmcnt(4)
v_mfma_f32_16x16x32_bf16 a[16:19],v[232:235],a[104:107],a[16:19]
ds_read_b64_tr_b16 v[216:217],v255 offset:38080
v_add_f32 v244,v244,v136
v_mfma_f32_16x16x32_bf16 a[20:23],v[232:235],a[108:111],a[20:23]
ds_read_b64_tr_b16 v[218:219],v255 offset:38592
v_add_f32 v245,v245,v190
v_mfma_f32_16x16x32_bf16 a[24:27],v[232:235],a[128:131],a[24:27]
ds_read_b64_tr_b16 v[220:221],v255 offset:38112
v_lshlrev_b32 v136,16,v191
v_mfma_f32_16x16x32_bf16 a[28:31],v[232:235],a[132:135],a[28:31]
ds_read_b64_tr_b16 v[222:223],v255 offset:38624
v_and_b32 v191,0xffff0000,v191
v_mfma_f32_16x16x32_bf16 a[48:51],v[236:239],a[104:107],a[48:51]
v_add_f32 v246,v246,v136
v_add_f32 v247,v247,v191
v_mfma_f32_16x16x32_bf16 a[52:55],v[236:239],a[108:111],a[52:55]
s_waitcnt vmcnt(26)
v_lshlrev_b32 v136,16,v192
v_mfma_f32_16x16x32_bf16 a[56:59],v[236:239],a[128:131],a[56:59]
v_and_b32 v192,0xffff0000,v192
v_add_f32 v240,v240,v136
v_mfma_f32_16x16x32_bf16 a[60:63],v[236:239],a[132:135],a[60:63]
v_add_f32 v241,v241,v192
s_waitcnt lgkmcnt(4)
v_mfma_f32_16x16x32_bf16 a[80:83],v[208:211],v[28:31],0
ds_read_b64_tr_b16 v[224:225],v255 offset:42304
v_lshlrev_b32 v136,16,v193
v_mfma_f32_16x16x32_bf16 a[84:87],v[208:211],v[32:35],0
ds_read_b64_tr_b16 v[226:227],v255 offset:42816
v_and_b32 v193,0xffff0000,v193
v_mfma_f32_16x16x32_bf16 a[88:91],v[208:211],v[36:39],0
ds_read_b64_tr_b16 v[228:229],v255 offset:42336
v_add_f32 v242,v242,v136
v_mfma_f32_16x16x32_bf16 a[92:95],v[208:211],v[40:43],0
ds_read_b64_tr_b16 v[230:231],v255 offset:42848
v_add_f32 v243,v243,v193
v_mfma_f32_16x16x32_bf16 a[112:115],v[212:215],v[28:31],0
v_mov_b32 v164,v160
v_mov_b32 v165,v161
v_mfma_f32_16x16x32_bf16 a[116:119],v[212:215],v[32:35],0
v_mov_b32 v166,v162
v_mov_b32 v167,v163
v_mfma_f32_16x16x32_bf16 a[120:123],v[212:215],v[36:39],0
v_accvgpr_read_b32 v128,a16
v_accvgpr_read_b32 v129,a17
v_mfma_f32_16x16x32_bf16 a[124:127],v[212:215],v[40:43],0
v_accvgpr_read_b32 v130,a18
s_waitcnt lgkmcnt(4)
v_mfma_f32_16x16x32_bf16 a[80:83],v[216:219],v[44:47],a[80:83]
ds_read_b64_tr_b16 v[232:233],v255 offset:46528
v_accvgpr_read_b32 v131,a19
v_mfma_f32_16x16x32_bf16 a[84:87],v[216:219],v[48:51],a[84:87]
ds_read_b64_tr_b16 v[234:235],v255 offset:47040
v_accvgpr_read_b32 v132,a48
v_mfma_f32_16x16x32_bf16 a[88:91],v[216:219],v[52:55],a[88:91]
ds_read_b64_tr_b16 v[236:237],v255 offset:46560
v_accvgpr_read_b32 v133,a49
v_mfma_f32_16x16x32_bf16 a[92:95],v[216:219],v[56:59],a[92:95]
ds_read_b64_tr_b16 v[238:239],v255 offset:47072
v_accvgpr_read_b32 v134,a50
v_mfma_f32_16x16x32_bf16 a[112:115],v[220:223],v[44:47],a[112:115]
v_accvgpr_read_b32 v135,a51
v_cvt_pk_bf16_f32 v160,v128,v129
v_mfma_f32_16x16x32_bf16 a[116:119],v[220:223],v[48:51],a[116:119]
v_cvt_pk_bf16_f32 v161,v130,v131
v_cvt_pk_bf16_f32 v162,v132,v133
v_mfma_f32_16x16x32_bf16 a[120:123],v[220:223],v[52:55],a[120:123]
v_cvt_pk_bf16_f32 v163,v134,v135
v_accvgpr_read_b32 v128,a20
v_mfma_f32_16x16x32_bf16 a[124:127],v[220:223],v[56:59],a[124:127]
v_accvgpr_read_b32 v129,a21
s_waitcnt lgkmcnt(4)
v_mfma_f32_16x16x32_bf16 a[80:83],v[224:227],v[60:63],a[80:83]
ds_read_b64_tr_b16 v[208:209],v252 offset:64
v_accvgpr_read_b32 v130,a22
v_mfma_f32_16x16x32_bf16 a[84:87],v[224:227],v[64:67],a[84:87]
ds_read_b64_tr_b16 v[210:211],v252 offset:576
v_accvgpr_read_b32 v131,a23
v_mfma_f32_16x16x32_bf16 a[88:91],v[224:227],v[68:71],a[88:91]
ds_read_b64_tr_b16 v[212:213],v252 offset:96
v_accvgpr_read_b32 v132,a52
v_mfma_f32_16x16x32_bf16 a[92:95],v[224:227],v[72:75],a[92:95]
ds_read_b64_tr_b16 v[214:215],v252 offset:608
v_accvgpr_read_b32 v133,a53
v_mfma_f32_16x16x32_bf16 a[112:115],v[228:231],v[60:63],a[112:115]
s_waitcnt vmcnt(4)
v_accvgpr_read_b32 v134,a54
v_mfma_f32_16x16x32_bf16 a[116:119],v[228:231],v[64:67],a[116:119]
v_cmp_gt_u32 vcc,s67,v137
s_cbranch_vccnz L_stub10
L_back10:
v_mfma_f32_16x16x32_bf16 a[120:123],v[228:231],v[68:71],a[120:123]
buffer_load_dwordx4 v[176:179],v248,s[4:7],s93 offen sc1
v_accvgpr_read_b32 v135,a55
v_mfma_f32_16x16x32_bf16 a[124:127],v[228:231],v[72:75],a[124:127]
v_cvt_pk_bf16_f32 v148,v128,v129
s_waitcnt lgkmcnt(4)
v_mfma_f32_16x16x32_bf16 a[80:83],v[232:235],v[76:79],a[80:83]
ds_read_b64_tr_b16 v[216:217],v252 offset:4288
v_cvt_pk_bf16_f32 v149,v130,v131
v_mfma_f32_16x16x32_bf16 a[84:87],v[232:235],v[80:83],a[84:87]
ds_read_b64_tr_b16 v[218:219],v252 offset:4800
v_cvt_pk_bf16_f32 v150,v132,v133
v_mfma_f32_16x16x32_bf16 a[88:91],v[232:235],v[84:87],a[88:91]
ds_read_b64_tr_b16 v[220:221],v252 offset:4320
v_cvt_pk_bf16_f32 v151,v134,v135
v_mfma_f32_16x16x32_bf16 a[92:95],v[232:235],v[88:91],a[92:95]
ds_read_b64_tr_b16 v[222:223],v252 offset:4832
v_lshlrev_b32 v136,16,v194
v_mfma_f32_16x16x32_bf16 a[112:115],v[236:239],v[76:79],a[112:115]
v_and_b32 v194,0xffff0000,v194
v_add_f32 v244,v244,v136
v_mfma_f32_16x16x32_bf16 a[116:119],v[236:239],v[80:83],a[116:119]
v_add_f32 v245,v245,v194
v_lshlrev_b32 v136,16,v195
v_mfma_f32_16x16x32_bf16 a[120:123],v[236:239],v[84:87],a[120:123]
v_and_b32 v195,0xffff0000,v195
v_add_f32 v246,v246,v136
v_mfma_f32_16x16x32_bf16 a[124:127],v[236:239],v[88:91],a[124:127]
buffer_load_dwordx4 v[180:183],v248,s[4:7],s94 offen sc1
s_waitcnt lgkmcnt(4)
v_mfma_f32_16x16x32_bf16 a[80:83],v[208:211],v[92:95],a[80:83]
ds_read_b64_tr_b16 v[224:225],v252 offset:8512
v_add_f32 v247,v247,v195
v_mfma_f32_16x16x32_bf16 a[84:87],v[208:211],v[96:99],a[84:87]
ds_read_b64_tr_b16 v[226:227],v252 offset:9024
v_lshlrev_b32 v136,16,v196
v_mfma_f32_16x16x32_bf16 a[88:91],v[208:211],v[100:103],a[88:91]
ds_read_b64_tr_b16 v[228:229],v252 offset:8544
buffer_store_dwordx4 v[148:151],v249,s[20:23],s63 offen sc1
v_mfma_f32_16x16x32_bf16 a[92:95],v[208:211],v[104:107],a[92:95]
ds_read_b64_tr_b16 v[230:231],v252 offset:9056
v_accvgpr_read_b32 v128,a24
v_mfma_f32_16x16x32_bf16 a[112:115],v[212:215],v[92:95],a[112:115]
v_accvgpr_read_b32 v129,a25
v_accvgpr_read_b32 v130,a26
v_mfma_f32_16x16x32_bf16 a[116:119],v[212:215],v[96:99],a[116:119]
v_accvgpr_read_b32 v131,a27
v_accvgpr_read_b32 v132,a56
v_mfma_f32_16x16x32_bf16 a[120:123],v[212:215],v[100:103],a[120:123]
v_accvgpr_read_b32 v133,a57
v_accvgpr_read_b32 v134,a58
v_mfma_f32_16x16x32_bf16 a[124:127],v[212:215],v[104:107],a[124:127]
v_accvgpr_read_b32 v135,a59
s_waitcnt lgkmcnt(4)
v_mfma_f32_16x16x32_bf16 a[80:83],v[216:219],v[108:111],a[80:83]
ds_read_b64_tr_b16 v[232:233],v252 offset:12736
buffer_load_dwordx4 v[184:187],v248,s[4:7],s95 offen sc1
v_mfma_f32_16x16x32_bf16 a[84:87],v[216:219],v[112:115],a[84:87]
ds_read_b64_tr_b16 v[234:235],v252 offset:13248
v_cvt_pk_bf16_f32 v144,v128,v129
v_mfma_f32_16x16x32_bf16 a[88:91],v[216:219],v[116:119],a[88:91]
ds_read_b64_tr_b16 v[236:237],v252 offset:12768
v_cvt_pk_bf16_f32 v145,v130,v131
v_mfma_f32_16x16x32_bf16 a[92:95],v[216:219],v[120:123],a[92:95]
ds_read_b64_tr_b16 v[238:239],v252 offset:13280
v_cvt_pk_bf16_f32 v146,v132,v133
v_mfma_f32_16x16x32_bf16 a[112:115],v[220:223],v[108:111],a[112:115]
v_cvt_pk_bf16_f32 v147,v134,v135
v_and_b32 v196,0xffff0000,v196
v_mfma_f32_16x16x32_bf16 a[116:119],v[220:223],v[112:115],a[116:119]
v_add_f32 v240,v240,v136
v_add_f32 v241,v241,v196
v_mfma_f32_16x16x32_bf16 a[120:123],v[220:223],v[116:119],a[120:123]
v_lshlrev_b32 v136,16,v197
v_and_b32 v197,0xffff0000,v197
v_mfma_f32_16x16x32_bf16 a[124:127],v[220:223],v[120:123],a[124:127]
v_add_f32 v242,v242,v136
s_waitcnt lgkmcnt(4)
v_mfma_f32_16x16x32_bf16 a[80:83],v[224:227],v[124:127],a[80:83]
ds_read_b64_tr_b16 v[208:209],v253 offset:64
v_add_f32 v243,v243,v197
v_mfma_f32_16x16x32_bf16 a[84:87],v[224:227],a[196:199],a[84:87]
ds_read_b64_tr_b16 v[210:211],v253 offset:576
buffer_load_dwordx4 v[188:191],v248,s[4:7],s96 offen sc1
v_mfma_f32_16x16x32_bf16 a[88:91],v[224:227],a[200:203],a[88:91]
ds_read_b64_tr_b16 v[212:213],v253 offset:96
v_lshlrev_b32 v136,16,v198
v_mfma_f32_16x16x32_bf16 a[92:95],v[224:227],a[204:207],a[92:95]
ds_read_b64_tr_b16 v[214:215],v253 offset:608
v_and_b32 v198,0xffff0000,v198
v_mfma_f32_16x16x32_bf16 a[112:115],v[228:231],v[124:127],a[112:115]
v_add_f32 v244,v244,v136
v_add_f32 v245,v245,v198
v_mfma_f32_16x16x32_bf16 a[116:119],v[228:231],a[196:199],a[116:119]
v_lshlrev_b32 v136,16,v199
v_and_b32 v199,0xffff0000,v199
v_mfma_f32_16x16x32_bf16 a[120:123],v[228:231],a[200:203],a[120:123]
buffer_store_dwordx4 v[144:147],v249,s[20:23],s64 offen sc1
v_accvgpr_read_b32 v128,a28
v_mfma_f32_16x16x32_bf16 a[124:127],v[228:231],a[204:207],a[124:127]
v_accvgpr_read_b32 v129,a29
s_waitcnt lgkmcnt(4)
v_mfma_f32_16x16x32_bf16 a[80:83],v[232:235],a[224:227],a[80:83]
ds_read_b64_tr_b16 v[216:217],v253 offset:4288
v_accvgpr_read_b32 v130,a30
v_mfma_f32_16x16x32_bf16 a[84:87],v[232:235],a[228:231],a[84:87]
ds_read_b64_tr_b16 v[218:219],v253 offset:4800
v_accvgpr_read_b32 v131,a31
v_mfma_f32_16x16x32_bf16 a[88:91],v[232:235],a[232:235],a[88:91]
ds_read_b64_tr_b16 v[220:221],v253 offset:4320
buffer_load_dwordx4 v[192:195],v248,s[4:7],s97 offen sc1
v_mfma_f32_16x16x32_bf16 a[92:95],v[232:235],a[236:239],a[92:95]
ds_read_b64_tr_b16 v[222:223],v253 offset:4832
v_accvgpr_read_b32 v132,a60
v_mfma_f32_16x16x32_bf16 a[112:115],v[236:239],a[224:227],a[112:115]
v_accvgpr_read_b32 v133,a61
v_accvgpr_read_b32 v134,a62
v_mfma_f32_16x16x32_bf16 a[116:119],v[236:239],a[228:231],a[116:119]
v_accvgpr_read_b32 v135,a63
v_cvt_pk_bf16_f32 v148,v128,v129
v_mfma_f32_16x16x32_bf16 a[120:123],v[236:239],a[232:235],a[120:123]
v_cvt_pk_bf16_f32 v149,v130,v131
v_cvt_pk_bf16_f32 v150,v132,v133
v_mfma_f32_16x16x32_bf16 a[124:127],v[236:239],a[236:239],a[124:127]
v_cvt_pk_bf16_f32 v151,v134,v135
s_waitcnt lgkmcnt(4)
v_mfma_f32_16x16x32_bf16 a[80:83],v[208:211],v[0:3],a[80:83]
ds_read_b64_tr_b16 v[224:225],v253 offset:8512
v_add_f32 v246,v246,v136
v_mfma_f32_16x16x32_bf16 a[84:87],v[208:211],a[164:167],a[84:87]
ds_read_b64_tr_b16 v[226:227],v253 offset:9024
v_add_f32 v247,v247,v199
v_mfma_f32_16x16x32_bf16 a[88:91],v[208:211],a[168:171],a[88:91]
ds_read_b64_tr_b16 v[228:229],v253 offset:8544
s_waitcnt vmcnt(63)
v_mfma_f32_16x16x32_bf16 a[92:95],v[208:211],v[4:7],a[92:95]
ds_read_b64_tr_b16 v[230:231],v253 offset:9056
buffer_load_dwordx4 v[196:199],v248,s[4:7],s98 offen sc1
v_mfma_f32_16x16x32_bf16 a[112:115],v[212:215],v[0:3],a[112:115]
v_lshlrev_b32 v136,16,v200
v_and_b32 v200,0xffff0000,v200
v_mfma_f32_16x16x32_bf16 a[116:119],v[212:215],a[164:167],a[116:119]
v_add_f32 v240,v240,v136
v_add_f32 v241,v241,v200
v_mfma_f32_16x16x32_bf16 a[120:123],v[212:215],a[168:171],a[120:123]
v_lshlrev_b32 v136,16,v201
v_and_b32 v201,0xffff0000,v201
v_mfma_f32_16x16x32_bf16 a[124:127],v[212:215],v[4:7],a[124:127]
v_add_f32 v242,v242,v136
s_waitcnt lgkmcnt(4)
v_mfma_f32_16x16x32_bf16 a[80:83],v[216:219],v[8:11],a[80:83]
ds_read_b64_tr_b16 v[232:233],v253 offset:12736
v_add_f32 v243,v243,v201
v_mfma_f32_16x16x32_bf16 a[84:87],v[216:219],a[172:175],a[84:87]
ds_read_b64_tr_b16 v[234:235],v253 offset:13248
v_lshlrev_b32 v136,16,v202
v_mfma_f32_16x16x32_bf16 a[88:91],v[216:219],a[192:195],a[88:91]
ds_read_b64_tr_b16 v[236:237],v253 offset:12768
buffer_store_dwordx4 v[148:151],v249,s[20:23],s65 offen sc1
v_mfma_f32_16x16x32_bf16 a[92:95],v[216:219],v[12:15],a[92:95]
ds_read_b64_tr_b16 v[238:239],v253 offset:13280
v_and_b32 v202,0xffff0000,v202
v_mfma_f32_16x16x32_bf16 a[112:115],v[220:223],v[8:11],a[112:115]
v_add_f32 v244,v244,v136
v_add_f32 v245,v245,v202
v_mfma_f32_16x16x32_bf16 a[116:119],v[220:223],a[172:175],a[116:119]
v_lshlrev_b32 v136,16,v203
v_and_b32 v203,0xffff0000,v203
v_mfma_f32_16x16x32_bf16 a[120:123],v[220:223],a[192:195],a[120:123]
v_add_f32 v246,v246,v136
v_add_f32 v247,v247,v203
v_mfma_f32_16x16x32_bf16 a[124:127],v[220:223],v[12:15],a[124:127]
buffer_load_dwordx4 v[200:203],v248,s[4:7],s99 offen sc1
s_waitcnt lgkmcnt(4)
v_mfma_f32_16x16x32_bf16 a[80:83],v[224:227],a[136:139],a[80:83]
ds_read_b64_tr_b16 v[208:209],v253 offset:16960
v_cvt_pk_bf16_f32 v152,v240,v241
v_mfma_f32_16x16x32_bf16 a[84:87],v[224:227],a[140:143],a[84:87]
ds_read_b64_tr_b16 v[210:211],v253 offset:17472
v_cvt_pk_bf16_f32 v153,v242,v243
v_mfma_f32_16x16x32_bf16 a[88:91],v[224:227],a[160:163],a[88:91]
ds_read_b64_tr_b16 v[212:213],v253 offset:16992
v_cvt_pk_bf16_f32 v154,v244,v245
v_mfma_f32_16x16x32_bf16 a[92:95],v[224:227],v[16:19],a[92:95]
ds_read_b64_tr_b16 v[214:215],v253 offset:17504
v_cvt_pk_bf16_f32 v155,v246,v247
v_mfma_f32_16x16x32_bf16 a[112:115],v[228:231],a[136:139],a[112:115]
s_add_u32 s4,s4,2048
s_addc_u32 s5,s5,0
v_mfma_f32_16x16x32_bf16 a[116:119],v[228:231],a[140:143],a[116:119]
v_permlane32_swap_b32 v152,v154
v_permlane32_swap_b32 v153,v155
v_mfma_f32_16x16x32_bf16 a[120:123],v[228:231],a[160:163],a[120:123]
v_permlane16_swap_b32 v152,v154
v_permlane16_swap_b32 v153,v155
v_mfma_f32_16x16x32_bf16 a[124:127],v[228:231],v[16:19],a[124:127]
buffer_store_dwordx4 v[152:155],v138,s[8:11],0 offen sc1
s_waitcnt lgkmcnt(4)
v_mfma_f32_16x16x32_bf16 a[80:83],v[232:235],v[20:23],a[80:83]
ds_read_b64_tr_b16 v[216:217],v253 offset:21184
v_mfma_f32_16x16x32_bf16 a[84:87],v[232:235],v[24:27],a[84:87]
ds_read_b64_tr_b16 v[218:219],v253 offset:21696
v_mfma_f32_16x16x32_bf16 a[88:91],v[232:235],a[0:3],a[88:91]
ds_read_b64_tr_b16 v[220:221],v253 offset:21216
v_mfma_f32_16x16x32_bf16 a[92:95],v[232:235],a[4:7],a[92:95]
ds_read_b64_tr_b16 v[222:223],v253 offset:21728
v_mfma_f32_16x16x32_bf16 a[112:115],v[236:239],v[20:23],a[112:115]
s_add_u32 s8,s8,128
s_addc_u32 s9,s9,0
v_mfma_f32_16x16x32_bf16 a[116:119],v[236:239],v[24:27],a[116:119]
v_mfma_f32_16x16x32_bf16 a[120:123],v[236:239],a[0:3],a[120:123]
v_mfma_f32_16x16x32_bf16 a[124:127],v[236:239],a[4:7],a[124:127]
s_waitcnt lgkmcnt(4)
v_mfma_f32_16x16x32_bf16 a[80:83],v[208:211],a[8:11],a[80:83]
ds_read_b64_tr_b16 v[224:225],v253 offset:25408
v_mfma_f32_16x16x32_bf16 a[84:87],v[208:211],a[12:15],a[84:87]
ds_read_b64_tr_b16 v[226:227],v253 offset:25920
v_mfma_f32_16x16x32_bf16 a[88:91],v[208:211],a[32:35],a[88:91]
ds_read_b64_tr_b16 v[228:229],v253 offset:25440
v_mfma_f32_16x16x32_bf16 a[92:95],v[208:211],a[36:39],a[92:95]
ds_read_b64_tr_b16 v[230:231],v253 offset:25952
v_mfma_f32_16x16x32_bf16 a[112:115],v[212:215],a[8:11],a[112:115]
v_mfma_f32_16x16x32_bf16 a[116:119],v[212:215],a[12:15],a[116:119]
v_mfma_f32_16x16x32_bf16 a[120:123],v[212:215],a[32:35],a[120:123]
v_mfma_f32_16x16x32_bf16 a[124:127],v[212:215],a[36:39],a[124:127]
s_waitcnt lgkmcnt(4)
v_mfma_f32_16x16x32_bf16 a[80:83],v[216:219],a[40:43],a[80:83]
ds_read_b64_tr_b16 v[232:233],v253 offset:29632
v_mfma_f32_16x16x32_bf16 a[84:87],v[216:219],a[44:47],a[84:87]
ds_read_b64_tr_b16 v[234:235],v253 offset:30144
v_mfma_f32_16x16x32_bf16 a[88:91],v[216:219],a[64:67],a[88:91]
ds_read_b64_tr_b16 v[236:237],v253 offset:29664
v_mfma_f32_16x16x32_bf16 a[92:95],v[216:219],a[68:71],a[92:95]
ds_read_b64_tr_b16 v[238:239],v253 offset:30176
v_mfma_f32_16x16x32_bf16 a[112:115],v[220:223],a[40:43],a[112:115]
v_mfma_f32_16x16x32_bf16 a[116:119],v[220:223],a[44:47],a[116:119]
v_mfma_f32_16x16x32_bf16 a[120:123],v[220:223],a[64:67],a[120:123]
v_mfma_f32_16x16x32_bf16 a[124:127],v[220:223],a[68:71],a[124:127]
s_waitcnt vmcnt(11) lgkmcnt(4)
v_mfma_f32_16x16x32_bf16 a[80:83],v[224:227],a[72:75],a[80:83]
v_cmp_gt_u32 vcc,s33,v140
s_cbranch_vccnz L_stub11
L_back11:
v_mfma_f32_16x16x32_bf16 a[84:87],v[224:227],a[76:79],a[84:87]
s_waitcnt vmcnt(63) lgkmcnt(0)
s_barrier
v_mfma_f32_16x16x32_bf16 a[88:91],v[224:227],a[96:99],a[88:91]
ds_read_b64_tr_b16 v[208:209],v252 offset:16896
v_add_u32 v143,1,v143
v_mfma_f32_16x16x32_bf16 a[92:95],v[224:227],a[100:103],a[92:95]
ds_read_b64_tr_b16 v[210:211],v252 offset:17408
buffer_store_dword v143,v248,s[24:27],0 offen sc1
v_mfma_f32_16x16x32_bf16 a[112:115],v[228:231],a[72:75],a[112:115]
ds_read_b64_tr_b16 v[212:213],v252 offset:16928
s_add_u32 s67,s67,1
v_mfma_f32_16x16x32_bf16 a[116:119],v[228:231],a[76:79],a[116:119]
ds_read_b64_tr_b16 v[214:215],v252 offset:17440
s_mov_b32 s2,0
v_mfma_f32_16x16x32_bf16 a[120:123],v[228:231],a[96:99],a[120:123]
s_mov_b32 s33,0
v_mfma_f32_16x16x32_bf16 a[124:127],v[228:231],a[100:103],a[124:127]
v_mfma_f32_16x16x32_bf16 a[80:83],v[232:235],a[104:107],a[80:83]
ds_read_b64_tr_b16 v[216:217],v252 offset:21120
v_mfma_f32_16x16x32_bf16 a[84:87],v[232:235],a[108:111],a[84:87]
ds_read_b64_tr_b16 v[218:219],v252 offset:21632
v_mfma_f32_16x16x32_bf16 a[88:91],v[232:235],a[128:131],a[88:91]
ds_read_b64_tr_b16 v[220:221],v252 offset:21152
v_mfma_f32_16x16x32_bf16 a[92:95],v[232:235],a[132:135],a[92:95]
ds_read_b64_tr_b16 v[222:223],v252 offset:21664
v_mfma_f32_16x16x32_bf16 a[112:115],v[236:239],a[104:107],a[112:115]
v_mfma_f32_16x16x32_bf16 a[116:119],v[236:239],a[108:111],a[116:119]
v_mfma_f32_16x16x32_bf16 a[120:123],v[236:239],a[128:131],a[120:123]
s_cmp_eq_u32 s36,1
s_waitcnt lgkmcnt(4)
v_mfma_f32_16x16x32_bf16 a[124:127],v[236:239],a[132:135],a[124:127]
s_cbranch_scc1 L_plast
v_mfma_f32_16x16x32_bf16 a[16:19],v[208:211],v[28:31],0
ds_read_b64_tr_b16 v[224:225],v252 offset:25344
s_and_b32 s6,s68,1606656
v_mfma_f32_16x16x32_bf16 a[20:23],v[208:211],v[32:35],0
ds_read_b64_tr_b16 v[226:227],v252 offset:25856
v_mfma_f32_16x16x32_bf16 a[24:27],v[208:211],v[36:39],0
ds_read_b64_tr_b16 v[228:229],v252 offset:25376
s_add_u32 m0,s29,84480
v_mfma_f32_16x16x32_bf16 a[28:31],v[208:211],v[40:43],0
ds_read_b64_tr_b16 v[230:231],v252 offset:25888
buffer_load_dwordx4 v254,s[16:19],s32 offen offset:0 lds
v_mfma_f32_16x16x32_bf16 a[48:51],v[212:215],v[28:31],0
s_add_u32 m0,m0,0x000000a0
v_accvgpr_read_b32 v128,a80
v_mfma_f32_16x16x32_bf16 a[52:55],v[212:215],v[32:35],0
v_accvgpr_read_b32 v129,a81
v_accvgpr_read_b32 v130,a82
v_mfma_f32_16x16x32_bf16 a[56:59],v[212:215],v[36:39],0
v_accvgpr_read_b32 v131,a83
v_accvgpr_read_b32 v132,a112
v_mfma_f32_16x16x32_bf16 a[60:63],v[212:215],v[40:43],0
v_accvgpr_read_b32 v133,a113
s_waitcnt lgkmcnt(4)
v_mfma_f32_16x16x32_bf16 a[16:19],v[216:219],v[44:47],a[16:19]
ds_read_b64_tr_b16 v[232:233],v252 offset:29568
v_accvgpr_read_b32 v134,a114
v_mfma_f32_16x16x32_bf16 a[20:23],v[216:219],v[48:51],a[20:23]
ds_read_b64_tr_b16 v[234:235],v252 offset:30080
buffer_load_dwordx4 v254,s[16:19],s32 offen offset:896 lds
v_mfma_f32_16x16x32_bf16 a[24:27],v[216:219],v[52:55],a[24:27]
ds_read_b64_tr_b16 v[236:237],v252 offset:29600
s_add_u32 m0,m0,0x000000a0
v_mfma_f32_16x16x32_bf16 a[28:31],v[216:219],v[56:59],a[28:31]
ds_read_b64_tr_b16 v[238:239],v252 offset:30112
v_accvgpr_read_b32 v135,a115
v_mfma_f32_16x16x32_bf16 a[48:51],v[220:223],v[44:47],a[48:51]
v_cvt_pk_bf16_f32 v144,v128,v129
v_cvt_pk_bf16_f32 v145,v130,v131
v_mfma_f32_16x16x32_bf16 a[52:55],v[220:223],v[48:51],a[52:55]
v_cvt_pk_bf16_f32 v146,v132,v133
v_cvt_pk_bf16_f32 v147,v134,v135
v_mfma_f32_16x16x32_bf16 a[56:59],v[220:223],v[52:55],a[56:59]
v_lshlrev_b32 v240,16,v164
v_and_b32 v241,0xffff0000,v164
v_mfma_f32_16x16x32_bf16 a[60:63],v[220:223],v[56:59],a[60:63]
buffer_load_dwordx4 v254,s[16:19],s32 offen offset:1792 lds
s_waitcnt lgkmcnt(4)
v_mfma_f32_16x16x32_bf16 a[16:19],v[224:227],v[60:63],a[16:19]
ds_read_b64_tr_b16 v[208:209],v252 offset:33792
s_add_u32 m0,m0,0x000000a0
v_mfma_f32_16x16x32_bf16 a[20:23],v[224:227],v[64:67],a[20:23]
ds_read_b64_tr_b16 v[210:211],v252 offset:34304
v_lshlrev_b32 v242,16,v165
v_mfma_f32_16x16x32_bf16 a[24:27],v[224:227],v[68:71],a[24:27]
ds_read_b64_tr_b16 v[212:213],v252 offset:33824
buffer_store_dwordx4 v[144:147],v250,s[20:23],s62 offen sc1
v_mfma_f32_16x16x32_bf16 a[28:31],v[224:227],v[72:75],a[28:31]
ds_read_b64_tr_b16 v[214:215],v252 offset:34336
v_accvgpr_read_b32 v128,a84
v_mfma_f32_16x16x32_bf16 a[48:51],v[228:231],v[60:63],a[48:51]
v_accvgpr_read_b32 v129,a85
v_accvgpr_read_b32 v130,a86
v_mfma_f32_16x16x32_bf16 a[52:55],v[228:231],v[64:67],a[52:55]
buffer_load_dwordx4 v254,s[16:19],s32 offen offset:2688 lds
s_add_u32 s32,s32,0x0001c000
v_mfma_f32_16x16x32_bf16 a[56:59],v[228:231],v[68:71],a[56:59]
s_add_u32 m0,s29,0
v_accvgpr_read_b32 v131,a87
v_mfma_f32_16x16x32_bf16 a[60:63],v[228:231],v[72:75],a[60:63]
v_accvgpr_read_b32 v132,a116
s_waitcnt lgkmcnt(4)
v_mfma_f32_16x16x32_bf16 a[16:19],v[232:235],v[76:79],a[16:19]
ds_read_b64_tr_b16 v[216:217],v252 offset:38016
v_accvgpr_read_b32 v133,a117
v_mfma_f32_16x16x32_bf16 a[20:23],v[232:235],v[80:83],a[20:23]
ds_read_b64_tr_b16 v[218:219],v252 offset:38528
v_accvgpr_read_b32 v134,a118
v_mfma_f32_16x16x32_bf16 a[24:27],v[232:235],v[84:87],a[24:27]
ds_read_b64_tr_b16 v[220:221],v252 offset:38048
v_accvgpr_read_b32 v135,a119
v_mfma_f32_16x16x32_bf16 a[28:31],v[232:235],v[88:91],a[28:31]
ds_read_b64_tr_b16 v[222:223],v252 offset:38560
buffer_load_dwordx4 v254,s[16:19],s32 offen offset:0 lds
v_mfma_f32_16x16x32_bf16 a[48:51],v[236:239],v[76:79],a[48:51]
s_add_u32 m0,m0,0x000000a0
v_cvt_pk_bf16_f32 v148,v128,v129
v_mfma_f32_16x16x32_bf16 a[52:55],v[236:239],v[80:83],a[52:55]
v_cvt_pk_bf16_f32 v149,v130,v131
v_cvt_pk_bf16_f32 v150,v132,v133
v_mfma_f32_16x16x32_bf16 a[56:59],v[236:239],v[84:87],a[56:59]
v_cvt_pk_bf16_f32 v151,v134,v135
v_and_b32 v243,0xffff0000,v165
v_mfma_f32_16x16x32_bf16 a[60:63],v[236:239],v[88:91],a[60:63]
v_lshlrev_b32 v244,16,v166
s_waitcnt lgkmcnt(4)
v_mfma_f32_16x16x32_bf16 a[16:19],v[208:211],v[92:95],a[16:19]
ds_read_b64_tr_b16 v[224:225],v252 offset:42240
v_and_b32 v245,0xffff0000,v166
v_mfma_f32_16x16x32_bf16 a[20:23],v[208:211],v[96:99],a[20:23]
ds_read_b64_tr_b16 v[226:227],v252 offset:42752
buffer_load_dwordx4 v254,s[16:19],s32 offen offset:896 lds
v_mfma_f32_16x16x32_bf16 a[24:27],v[208:211],v[100:103],a[24:27]
ds_read_b64_tr_b16 v[228:229],v252 offset:42272
s_add_u32 m0,m0,0x000000a0
v_mfma_f32_16x16x32_bf16 a[28:31],v[208:211],v[104:107],a[28:31]
ds_read_b64_tr_b16 v[230:231],v252 offset:42784
v_lshlrev_b32 v246,16,v167
v_mfma_f32_16x16x32_bf16 a[48:51],v[212:215],v[92:95],a[48:51]
v_and_b32 v247,0xffff0000,v167
s_waitcnt vmcnt(17)
v_mfma_f32_16x16x32_bf16 a[52:55],v[212:215],v[96:99],a[52:55]
v_lshlrev_b32 v136,16,v176
v_and_b32 v176,0xffff0000,v176
v_mfma_f32_16x16x32_bf16 a[56:59],v[212:215],v[100:103],a[56:59]
v_add_f32 v240,v240,v136
v_add_f32 v241,v241,v176
v_mfma_f32_16x16x32_bf16 a[60:63],v[212:215],v[104:107],a[60:63]
buffer_load_dwordx4 v254,s[16:19],s32 offen offset:1792 lds
s_waitcnt lgkmcnt(4)
v_mfma_f32_16x16x32_bf16 a[16:19],v[216:219],v[108:111],a[16:19]
ds_read_b64_tr_b16 v[232:233],v252 offset:46464
s_add_u32 m0,m0,0x000000a0
v_mfma_f32_16x16x32_bf16 a[20:23],v[216:219],v[112:115],a[20:23]
ds_read_b64_tr_b16 v[234:235],v252 offset:46976
v_lshlrev_b32 v136,16,v177
v_mfma_f32_16x16x32_bf16 a[24:27],v[216:219],v[116:119],a[24:27]
ds_read_b64_tr_b16 v[236:237],v252 offset:46496
v_and_b32 v177,0xffff0000,v177
v_mfma_f32_16x16x32_bf16 a[28:31],v[216:219],v[120:123],a[28:31]
ds_read_b64_tr_b16 v[238:239],v252 offset:47008
v_add_f32 v242,v242,v136
v_mfma_f32_16x16x32_bf16 a[48:51],v[220:223],v[108:111],a[48:51]
buffer_store_dwordx4 v[148:151],v250,s[20:23],s63 offen sc1
v_accvgpr_read_b32 v128,a88
v_mfma_f32_16x16x32_bf16 a[52:55],v[220:223],v[112:115],a[52:55]
buffer_load_dwordx4 v254,s[16:19],s32 offen offset:2688 lds
s_add_u32 s32,s32,0x0001c000
v_mfma_f32_16x16x32_bf16 a[56:59],v[220:223],v[116:119],a[56:59]
s_add_u32 m0,s29,101376
v_accvgpr_read_b32 v129,a89
v_mfma_f32_16x16x32_bf16 a[60:63],v[220:223],v[120:123],a[60:63]
v_accvgpr_read_b32 v130,a90
s_waitcnt lgkmcnt(4)
v_mfma_f32_16x16x32_bf16 a[16:19],v[224:227],v[124:127],a[16:19]
ds_read_b64_tr_b16 v[208:209],v255 offset:16896
v_accvgpr_read_b32 v131,a91
v_mfma_f32_16x16x32_bf16 a[20:23],v[224:227],a[196:199],a[20:23]
ds_read_b64_tr_b16 v[210:211],v255 offset:17408
v_accvgpr_read_b32 v132,a120
v_mfma_f32_16x16x32_bf16 a[24:27],v[224:227],a[200:203],a[24:27]
ds_read_b64_tr_b16 v[212:213],v255 offset:16928
v_accvgpr_read_b32 v133,a121
v_mfma_f32_16x16x32_bf16 a[28:31],v[224:227],a[204:207],a[28:31]
ds_read_b64_tr_b16 v[214:215],v255 offset:17440
buffer_load_dwordx4 v254,s[16:19],s32 offen offset:0 lds
v_mfma_f32_16x16x32_bf16 a[48:51],v[228:231],v[124:127],a[48:51]
s_add_u32 m0,m0,0x000000a0
v_accvgpr_read_b32 v134,a122
v_mfma_f32_16x16x32_bf16 a[52:55],v[228:231],a[196:199],a[52:55]
v_accvgpr_read_b32 v135,a123
v_cvt_pk_bf16_f32 v144,v128,v129
v_mfma_f32_16x16x32_bf16 a[56:59],v[228:231],a[200:203],a[56:59]
v_cvt_pk_bf16_f32 v145,v130,v131
v_cvt_pk_bf16_f32 v146,v132,v133
v_mfma_f32_16x16x32_bf16 a[60:63],v[228:231],a[204:207],a[60:63]
v_cvt_pk_bf16_f32 v147,v134,v135
s_waitcnt lgkmcnt(4)
v_mfma_f32_16x16x32_bf16 a[16:19],v[232:235],a[224:227],a[16:19]
ds_read_b64_tr_b16 v[216:217],v255 offset:21120
v_add_f32 v243,v243,v177
v_mfma_f32_16x16x32_bf16 a[20:23],v[232:235],a[228:231],a[20:23]
ds_read_b64_tr_b16 v[218:219],v255 offset:21632
buffer_load_dwordx4 v254,s[16:19],s32 offen offset:896 lds
v_mfma_f32_16x16x32_bf16 a[24:27],v[232:235],a[232:235],a[24:27]
ds_read_b64_tr_b16 v[220:221],v255 offset:21152
s_add_u32 m0,m0,0x000000a0
v_mfma_f32_16x16x32_bf16 a[28:31],v[232:235],a[236:239],a[28:31]
ds_read_b64_tr_b16 v[222:223],v255 offset:21664
v_lshlrev_b32 v136,16,v178
v_mfma_f32_16x16x32_bf16 a[48:51],v[236:239],a[224:227],a[48:51]
v_and_b32 v178,0xffff0000,v178
v_add_f32 v244,v244,v136
v_mfma_f32_16x16x32_bf16 a[52:55],v[236:239],a[228:231],a[52:55]
v_add_f32 v245,v245,v178
v_lshlrev_b32 v136,16,v179
v_mfma_f32_16x16x32_bf16 a[56:59],v[236:239],a[232:235],a[56:59]
v_and_b32 v179,0xffff0000,v179
v_add_f32 v246,v246,v136
v_mfma_f32_16x16x32_bf16 a[60:63],v[236:239],a[236:239],a[60:63]
buffer_load_dwordx4 v254,s[16:19],s32 offen offset:1792 lds
s_waitcnt lgkmcnt(4)
v_mfma_f32_16x16x32_bf16 a[16:19],v[208:211],v[0:3],a[16:19]
ds_read_b64_tr_b16 v[224:225],v255 offset:25344
s_add_u32 m0,m0,0x000000a0
v_mfma_f32_16x16x32_bf16 a[20:23],v[208:211],a[164:167],a[20:23]
ds_read_b64_tr_b16 v[226:227],v255 offset:25856
v_add_f32 v247,v247,v179
v_mfma_f32_16x16x32_bf16 a[24:27],v[208:211],a[168:171],a[24:27]
ds_read_b64_tr_b16 v[228:229],v255 offset:25376
v_lshlrev_b32 v136,16,v180
v_mfma_f32_16x16x32_bf16 a[28:31],v[208:211],v[4:7],a[28:31]
ds_read_b64_tr_b16 v[230:231],v255 offset:25888
v_and_b32 v180,0xffff0000,v180
v_mfma_f32_16x16x32_bf16 a[48:51],v[212:215],v[0:3],a[48:51]
v_add_f32 v240,v240,v136
v_add_f32 v241,v241,v180
v_mfma_f32_16x16x32_bf16 a[52:55],v[212:215],a[164:167],a[52:55]
buffer_load_dwordx4 v254,s[16:19],s32 offen offset:2688 lds
s_add_u32 s32,s32,0x0001c000
v_mfma_f32_16x16x32_bf16 a[56:59],v[212:215],a[168:171],a[56:59]
s_add_u32 m0,s29,118272
buffer_store_dwordx4 v[144:147],v250,s[20:23],s64 offen sc1
v_mfma_f32_16x16x32_bf16 a[60:63],v[212:215],v[4:7],a[60:63]
v_accvgpr_read_b32 v128,a92
s_waitcnt lgkmcnt(4)
v_mfma_f32_16x16x32_bf16 a[16:19],v[216:219],v[8:11],a[16:19]
ds_read_b64_tr_b16 v[232:233],v255 offset:29568
v_accvgpr_read_b32 v129,a93
v_mfma_f32_16x16x32_bf16 a[20:23],v[216:219],a[172:175],a[20:23]
ds_read_b64_tr_b16 v[234:235],v255 offset:30080
v_accvgpr_read_b32 v130,a94
v_mfma_f32_16x16x32_bf16 a[24:27],v[216:219],a[192:195],a[24:27]
ds_read_b64_tr_b16 v[236:237],v255 offset:29600
v_accvgpr_read_b32 v131,a95
v_mfma_f32_16x16x32_bf16 a[28:31],v[216:219],v[12:15],a[28:31]
ds_read_b64_tr_b16 v[238:239],v255 offset:30112
buffer_load_dwordx4 v254,s[16:19],s32 offen offset:0 lds
v_mfma_f32_16x16x32_bf16 a[48:51],v[220:223],v[8:11],a[48:51]
s_add_u32 m0,m0,0x000000a0
v_accvgpr_read_b32 v132,a124
v_mfma_f32_16x16x32_bf16 a[52:55],v[220:223],a[172:175],a[52:55]
v_accvgpr_read_b32 v133,a125
v_accvgpr_read_b32 v134,a126
v_mfma_f32_16x16x32_bf16 a[56:59],v[220:223],a[192:195],a[56:59]
v_accvgpr_read_b32 v135,a127
v_cvt_pk_bf16_f32 v148,v128,v129
v_mfma_f32_16x16x32_bf16 a[60:63],v[220:223],v[12:15],a[60:63]
v_cvt_pk_bf16_f32 v149,v130,v131
s_waitcnt lgkmcnt(4)
v_mfma_f32_16x16x32_bf16 a[16:19],v[224:227],a[136:139],a[16:19]
ds_read_b64_tr_b16 v[208:209],v255 offset:0
v_cvt_pk_bf16_f32 v150,v132,v133
v_mfma_f32_16x16x32_bf16 a[20:23],v[224:227],a[140:143],a[20:23]
ds_read_b64_tr_b16 v[210:211],v255 offset:512
buffer_load_dwordx4 v254,s[16:19],s32 offen offset:896 lds
v_mfma_f32_16x16x32_bf16 a[24:27],v[224:227],a[160:163],a[24:27]
ds_read_b64_tr_b16 v[212:213],v255 offset:32
s_add_u32 m0,m0,0x000000a0
v_mfma_f32_16x16x32_bf16 a[28:31],v[224:227],v[16:19],a[28:31]
ds_read_b64_tr_b16 v[214:215],v255 offset:544
v_cvt_pk_bf16_f32 v151,v134,v135
v_mfma_f32_16x16x32_bf16 a[48:51],v[228:231],a[136:139],a[48:51]
buffer_load_dword v137,v142,s[12:15],0 offen sc1
v_lshlrev_b32 v136,16,v181
v_mfma_f32_16x16x32_bf16 a[52:55],v[228:231],a[140:143],a[52:55]
v_and_b32 v181,0xffff0000,v181
v_add_f32 v242,v242,v136
v_mfma_f32_16x16x32_bf16 a[56:59],v[228:231],a[160:163],a[56:59]
v_add_f32 v243,v243,v181
v_lshlrev_b32 v136,16,v182
v_mfma_f32_16x16x32_bf16 a[60:63],v[228:231],v[16:19],a[60:63]
buffer_load_dwordx4 v254,s[16:19],s32 offen offset:1792 lds
s_waitcnt lgkmcnt(4)
v_mfma_f32_16x16x32_bf16 a[16:19],v[232:235],v[20:23],a[16:19]
ds_read_b64_tr_b16 v[216:217],v255 offset:4224
s_add_u32 m0,m0,0x000000a0
v_mfma_f32_16x16x32_bf16 a[20:23],v[232:235],v[24:27],a[20:23]
ds_read_b64_tr_b16 v[218:219],v255 offset:4736
v_and_b32 v182,0xffff0000,v182
v_mfma_f32_16x16x32_bf16 a[24:27],v[232:235],a[0:3],a[24:27]
ds_read_b64_tr_b16 v[220:221],v255 offset:4256
v_add_f32 v244,v244,v136
v_mfma_f32_16x16x32_bf16 a[28:31],v[232:235],a[4:7],a[28:31]
ds_read_b64_tr_b16 v[222:223],v255 offset:4768
v_add_f32 v245,v245,v182
v_mfma_f32_16x16x32_bf16 a[48:51],v[236:239],v[20:23],a[48:51]
v_lshlrev_b32 v136,16,v183
v_and_b32 v183,0xffff0000,v183
v_mfma_f32_16x16x32_bf16 a[52:55],v[236:239],v[24:27],a[52:55]
buffer_load_dwordx4 v254,s[16:19],s32 offen offset:2688 lds
s_add_u32 s32,s32,0xfffac080
v_mfma_f32_16x16x32_bf16 a[56:59],v[236:239],a[0:3],a[56:59]
v_add_f32 v246,v246,v136
v_add_f32 v247,v247,v183
v_mfma_f32_16x16x32_bf16 a[60:63],v[236:239],a[4:7],a[60:63]
s_waitcnt vmcnt(27)
s_waitcnt lgkmcnt(4)
v_mfma_f32_16x16x32_bf16 a[16:19],v[208:211],a[8:11],a[16:19]
ds_read_b64_tr_b16 v[224:225],v255 offset:8448
buffer_store_dwordx4 v[148:151],v250,s[20:23],s65 offen sc1
v_mfma_f32_16x16x32_bf16 a[20:23],v[208:211],a[12:15],a[20:23]
ds_read_b64_tr_b16 v[226:227],v255 offset:8960
v_lshlrev_b32 v136,16,v184
v_mfma_f32_16x16x32_bf16 a[24:27],v[208:211],a[32:35],a[24:27]
ds_read_b64_tr_b16 v[228:229],v255 offset:8480
v_and_b32 v184,0xffff0000,v184
v_mfma_f32_16x16x32_bf16 a[28:31],v[208:211],a[36:39],a[28:31]
ds_read_b64_tr_b16 v[230:231],v255 offset:8992
v_add_f32 v240,v240,v136
v_mfma_f32_16x16x32_bf16 a[48:51],v[212:215],a[8:11],a[48:51]
s_add_u32 s20,s20,2048
s_addc_u32 s21,s21,0
v_mfma_f32_16x16x32_bf16 a[52:55],v[212:215],a[12:15],a[52:55]
s_sub_u32 s22,s22,2048
v_add_f32 v241,v241,v184
v_mfma_f32_16x16x32_bf16 a[56:59],v[212:215],a[32:35],a[56:59]
v_lshlrev_b32 v136,16,v185
v_and_b32 v185,0xffff0000,v185
v_mfma_f32_16x16x32_bf16 a[60:63],v[212:215],a[36:39],a[60:63]
v_add_f32 v242,v242,v136
s_waitcnt lgkmcnt(4)
v_mfma_f32_16x16x32_bf16 a[16:19],v[216:219],a[40:43],a[16:19]
ds_read_b64_tr_b16 v[232:233],v255 offset:12672
v_add_f32 v243,v243,v185
v_mfma_f32_16x16x32_bf16 a[20:23],v[216:219],a[44:47],a[20:23]
ds_read_b64_tr_b16 v[234:235],v255 offset:13184
v_lshlrev_b32 v136,16,v186
v_mfma_f32_16x16x32_bf16 a[24:27],v[216:219],a[64:67],a[24:27]
ds_read_b64_tr_b16 v[236:237],v255 offset:12704
v_and_b32 v186,0xffff0000,v186
v_mfma_f32_16x16x32_bf16 a[28:31],v[216:219],a[68:71],a[28:31]
ds_read_b64_tr_b16 v[238:239],v255 offset:13216
v_add_f32 v244,v244,v136
v_mfma_f32_16x16x32_bf16 a[48:51],v[220:223],a[40:43],a[48:51]
v_add_f32 v245,v245,v186
v_lshlrev_b32 v136,16,v187
v_mfma_f32_16x16x32_bf16 a[52:55],v[220:223],a[44:47],a[52:55]
v_and_b32 v187,0xffff0000,v187
v_add_f32 v246,v246,v136
v_mfma_f32_16x16x32_bf16 a[56:59],v[220:223],a[64:67],a[56:59]
v_add_f32 v247,v247,v187
v_lshlrev_b32 v136,16,v188
v_mfma_f32_16x16x32_bf16 a[60:63],v[220:223],a[68:71],a[60:63]
v_and_b32 v188,0xffff0000,v188
s_waitcnt lgkmcnt(4)
v_mfma_f32_16x16x32_bf16 a[16:19],v[224:227],a[72:75],a[16:19]
ds_read_b64_tr_b16 v[208:209],v252 offset:16960
v_add_f32 v240,v240,v136
v_mfma_f32_16x16x32_bf16 a[20:23],v[224:227],a[76:79],a[20:23]
ds_read_b64_tr_b16 v[210:211],v252 offset:17472
v_add_f32 v241,v241,v188
v_mfma_f32_16x16x32_bf16 a[24:27],v[224:227],a[96:99],a[24:27]
ds_read_b64_tr_b16 v[212:213],v252 offset:16992
v_lshlrev_b32 v136,16,v189
v_mfma_f32_16x16x32_bf16 a[28:31],v[224:227],a[100:103],a[28:31]
ds_read_b64_tr_b16 v[214:215],v252 offset:17504
v_and_b32 v189,0xffff0000,v189
v_mfma_f32_16x16x32_bf16 a[48:51],v[228:231],a[72:75],a[48:51]
v_add_f32 v242,v242,v136
v_add_f32 v243,v243,v189
v_mfma_f32_16x16x32_bf16 a[52:55],v[228:231],a[76:79],a[52:55]
v_lshlrev_b32 v136,16,v190
v_and_b32 v190,0xffff0000,v190
v_mfma_f32_16x16x32_bf16 a[56:59],v[228:231],a[96:99],a[56:59]
v_add_f32 v244,v244,v136
v_add_f32 v245,v245,v190
v_mfma_f32_16x16x32_bf16 a[60:63],v[228:231],a[100:103],a[60:63]
v_lshlrev_b32 v136,16,v191
s_waitcnt lgkmcnt(4)
v_mfma_f32_16x16x32_bf16 a[16:19],v[232:235],a[104:107],a[16:19]
ds_read_b64_tr_b16 v[216:217],v252 offset:21184
v_and_b32 v191,0xffff0000,v191
v_mfma_f32_16x16x32_bf16 a[20:23],v[232:235],a[108:111],a[20:23]
ds_read_b64_tr_b16 v[218:219],v252 offset:21696
v_add_f32 v246,v246,v136
v_mfma_f32_16x16x32_bf16 a[24:27],v[232:235],a[128:131],a[24:27]
ds_read_b64_tr_b16 v[220:221],v252 offset:21216
v_add_f32 v247,v247,v191
v_mfma_f32_16x16x32_bf16 a[28:31],v[232:235],a[132:135],a[28:31]
ds_read_b64_tr_b16 v[222:223],v252 offset:21728
s_waitcnt vmcnt(25)
v_mfma_f32_16x16x32_bf16 a[48:51],v[236:239],a[104:107],a[48:51]
v_lshlrev_b32 v136,16,v192
v_and_b32 v192,0xffff0000,v192
v_mfma_f32_16x16x32_bf16 a[52:55],v[236:239],a[108:111],a[52:55]
v_add_f32 v240,v240,v136
v_add_f32 v241,v241,v192
v_mfma_f32_16x16x32_bf16 a[56:59],v[236:239],a[128:131],a[56:59]
v_lshlrev_b32 v136,16,v193
v_and_b32 v193,0xffff0000,v193
v_mfma_f32_16x16x32_bf16 a[60:63],v[236:239],a[132:135],a[60:63]
v_add_f32 v242,v242,v136
s_waitcnt lgkmcnt(4)
v_mfma_f32_16x16x32_bf16 a[80:83],v[208:211],v[28:31],0
ds_read_b64_tr_b16 v[224:225],v252 offset:25408
v_add_f32 v243,v243,v193
v_mfma_f32_16x16x32_bf16 a[84:87],v[208:211],v[32:35],0
ds_read_b64_tr_b16 v[226:227],v252 offset:25920
v_lshlrev_b32 v136,16,v194
v_mfma_f32_16x16x32_bf16 a[88:91],v[208:211],v[36:39],0
ds_read_b64_tr_b16 v[228:229],v252 offset:25440
v_and_b32 v194,0xffff0000,v194
v_mfma_f32_16x16x32_bf16 a[92:95],v[208:211],v[40:43],0
ds_read_b64_tr_b16 v[230:231],v252 offset:25952
v_add_f32 v244,v244,v136
v_mfma_f32_16x16x32_bf16 a[112:115],v[212:215],v[28:31],0
v_mov_b32 v164,v156
v_mov_b32 v165,v157
v_mfma_f32_16x16x32_bf16 a[116:119],v[212:215],v[32:35],0
v_mov_b32 v166,v158
v_mov_b32 v167,v159
v_mfma_f32_16x16x32_bf16 a[120:123],v[212:215],v[36:39],0
v_accvgpr_read_b32 v128,a16
v_accvgpr_read_b32 v129,a17
v_mfma_f32_16x16x32_bf16 a[124:127],v[212:215],v[40:43],0
v_accvgpr_read_b32 v130,a18
s_waitcnt lgkmcnt(4)
v_mfma_f32_16x16x32_bf16 a[80:83],v[216:219],v[44:47],a[80:83]
ds_read_b64_tr_b16 v[232:233],v252 offset:29632
v_accvgpr_read_b32 v131,a19
v_mfma_f32_16x16x32_bf16 a[84:87],v[216:219],v[48:51],a[84:87]
ds_read_b64_tr_b16 v[234:235],v252 offset:30144
v_accvgpr_read_b32 v132,a48
v_mfma_f32_16x16x32_bf16 a[88:91],v[216:219],v[52:55],a[88:91]
ds_read_b64_tr_b16 v[236:237],v252 offset:29664
v_accvgpr_read_b32 v133,a49
v_mfma_f32_16x16x32_bf16 a[92:95],v[216:219],v[56:59],a[92:95]
ds_read_b64_tr_b16 v[238:239],v252 offset:30176
v_accvgpr_read_b32 v134,a50
v_mfma_f32_16x16x32_bf16 a[112:115],v[220:223],v[44:47],a[112:115]
v_accvgpr_read_b32 v135,a51
v_cvt_pk_bf16_f32 v156,v128,v129
v_mfma_f32_16x16x32_bf16 a[116:119],v[220:223],v[48:51],a[116:119]
v_cvt_pk_bf16_f32 v157,v130,v131
v_cvt_pk_bf16_f32 v158,v132,v133
v_mfma_f32_16x16x32_bf16 a[120:123],v[220:223],v[52:55],a[120:123]
v_cvt_pk_bf16_f32 v159,v134,v135
v_accvgpr_read_b32 v128,a20
v_mfma_f32_16x16x32_bf16 a[124:127],v[220:223],v[56:59],a[124:127]
v_accvgpr_read_b32 v129,a21
s_waitcnt lgkmcnt(4)
v_mfma_f32_16x16x32_bf16 a[80:83],v[224:227],v[60:63],a[80:83]
ds_read_b64_tr_b16 v[208:209],v252 offset:33856
v_accvgpr_read_b32 v130,a22
v_mfma_f32_16x16x32_bf16 a[84:87],v[224:227],v[64:67],a[84:87]
ds_read_b64_tr_b16 v[210:211],v252 offset:34368
v_accvgpr_read_b32 v131,a23
v_mfma_f32_16x16x32_bf16 a[88:91],v[224:227],v[68:71],a[88:91]
ds_read_b64_tr_b16 v[212:213],v252 offset:33888
v_accvgpr_read_b32 v132,a52
v_mfma_f32_16x16x32_bf16 a[92:95],v[224:227],v[72:75],a[92:95]
ds_read_b64_tr_b16 v[214:215],v252 offset:34400
v_accvgpr_read_b32 v133,a53
v_mfma_f32_16x16x32_bf16 a[112:115],v[228:231],v[60:63],a[112:115]
s_waitcnt vmcnt(3)
v_accvgpr_read_b32 v134,a54
v_mfma_f32_16x16x32_bf16 a[116:119],v[228:231],v[64:67],a[116:119]
v_cmp_gt_u32 vcc,s67,v137
s_cbranch_vccnz L_stub12
L_back12:
v_mfma_f32_16x16x32_bf16 a[120:123],v[228:231],v[68:71],a[120:123]
buffer_load_dwordx4 v[176:179],v248,s[4:7],s93 offen sc1
v_accvgpr_read_b32 v135,a55
v_mfma_f32_16x16x32_bf16 a[124:127],v[228:231],v[72:75],a[124:127]
v_cvt_pk_bf16_f32 v148,v128,v129
s_waitcnt lgkmcnt(4)
v_mfma_f32_16x16x32_bf16 a[80:83],v[232:235],v[76:79],a[80:83]
ds_read_b64_tr_b16 v[216:217],v252 offset:38080
v_cvt_pk_bf16_f32 v149,v130,v131
v_mfma_f32_16x16x32_bf16 a[84:87],v[232:235],v[80:83],a[84:87]
ds_read_b64_tr_b16 v[218:219],v252 offset:38592
v_cvt_pk_bf16_f32 v150,v132,v133
v_mfma_f32_16x16x32_bf16 a[88:91],v[232:235],v[84:87],a[88:91]
ds_read_b64_tr_b16 v[220:221],v252 offset:38112
v_cvt_pk_bf16_f32 v151,v134,v135
v_mfma_f32_16x16x32_bf16 a[92:95],v[232:235],v[88:91],a[92:95]
ds_read_b64_tr_b16 v[222:223],v252 offset:38624
v_add_f32 v245,v245,v194
v_mfma_f32_16x16x32_bf16 a[112:115],v[236:239],v[76:79],a[112:115]
v_lshlrev_b32 v136,16,v195
v_and_b32 v195,0xffff0000,v195
v_mfma_f32_16x16x32_bf16 a[116:119],v[236:239],v[80:83],a[116:119]
v_add_f32 v246,v246,v136
v_add_f32 v247,v247,v195
v_mfma_f32_16x16x32_bf16 a[120:123],v[236:239],v[84:87],a[120:123]
v_lshlrev_b32 v136,16,v196
v_and_b32 v196,0xffff0000,v196
v_mfma_f32_16x16x32_bf16 a[124:127],v[236:239],v[88:91],a[124:127]
buffer_load_dwordx4 v[180:183],v248,s[4:7],s94 offen sc1
s_waitcnt lgkmcnt(4)
v_mfma_f32_16x16x32_bf16 a[80:83],v[208:211],v[92:95],a[80:83]
ds_read_b64_tr_b16 v[224:225],v252 offset:42304
v_add_f32 v240,v240,v136
v_mfma_f32_16x16x32_bf16 a[84:87],v[208:211],v[96:99],a[84:87]
ds_read_b64_tr_b16 v[226:227],v252 offset:42816
v_add_f32 v241,v241,v196
v_mfma_f32_16x16x32_bf16 a[88:91],v[208:211],v[100:103],a[88:91]
ds_read_b64_tr_b16 v[228:229],v252 offset:42336
buffer_store_dwordx4 v[148:151],v249,s[20:23],s63 offen sc1
v_mfma_f32_16x16x32_bf16 a[92:95],v[208:211],v[104:107],a[92:95]
ds_read_b64_tr_b16 v[230:231],v252 offset:42848
v_accvgpr_read_b32 v128,a24
v_mfma_f32_16x16x32_bf16 a[112:115],v[212:215],v[92:95],a[112:115]
v_accvgpr_read_b32 v129,a25
v_accvgpr_read_b32 v130,a26
v_mfma_f32_16x16x32_bf16 a[116:119],v[212:215],v[96:99],a[116:119]
v_accvgpr_read_b32 v131,a27
v_accvgpr_read_b32 v132,a56
v_mfma_f32_16x16x32_bf16 a[120:123],v[212:215],v[100:103],a[120:123]
v_accvgpr_read_b32 v133,a57
v_accvgpr_read_b32 v134,a58
v_mfma_f32_16x16x32_bf16 a[124:127],v[212:215],v[104:107],a[124:127]
v_accvgpr_read_b32 v135,a59
s_waitcnt lgkmcnt(4)
v_mfma_f32_16x16x32_bf16 a[80:83],v[216:219],v[108:111],a[80:83]
ds_read_b64_tr_b16 v[232:233],v252 offset:46528
buffer_load_dwordx4 v[184:187],v248,s[4:7],s95 offen sc1
v_mfma_f32_16x16x32_bf16 a[84:87],v[216:219],v[112:115],a[84:87]
ds_read_b64_tr_b16 v[234:235],v252 offset:47040
v_cvt_pk_bf16_f32 v144,v128,v129
v_mfma_f32_16x16x32_bf16 a[88:91],v[216:219],v[116:119],a[88:91]
ds_read_b64_tr_b16 v[236:237],v252 offset:46560
v_cvt_pk_bf16_f32 v145,v130,v131
v_mfma_f32_16x16x32_bf16 a[92:95],v[216:219],v[120:123],a[92:95]
ds_read_b64_tr_b16 v[238:239],v252 offset:47072
v_cvt_pk_bf16_f32 v146,v132,v133
v_mfma_f32_16x16x32_bf16 a[112:115],v[220:223],v[108:111],a[112:115]
v_cvt_pk_bf16_f32 v147,v134,v135
v_lshlrev_b32 v136,16,v197
v_mfma_f32_16x16x32_bf16 a[116:119],v[220:223],v[112:115],a[116:119]
v_and_b32 v197,0xffff0000,v197
v_add_f32 v242,v242,v136
v_mfma_f32_16x16x32_bf16 a[120:123],v[220:223],v[116:119],a[120:123]
v_add_f32 v243,v243,v197
v_lshlrev_b32 v136,16,v198
v_mfma_f32_16x16x32_bf16 a[124:127],v[220:223],v[120:123],a[124:127]
v_and_b32 v198,0xffff0000,v198
s_waitcnt lgkmcnt(4)
v_mfma_f32_16x16x32_bf16 a[80:83],v[224:227],v[124:127],a[80:83]
ds_read_b64_tr_b16 v[208:209],v255 offset:16960
v_add_f32 v244,v244,v136
v_mfma_f32_16x16x32_bf16 a[84:87],v[224:227],a[196:199],a[84:87]
ds_read_b64_tr_b16 v[210:211],v255 offset:17472
buffer_load_dwordx4 v[188:191],v248,s[4:7],s96 offen sc1
v_mfma_f32_16x16x32_bf16 a[88:91],v[224:227],a[200:203],a[88:91]
ds_read_b64_tr_b16 v[212:213],v255 offset:16992
v_add_f32 v245,v245,v198
v_mfma_f32_16x16x32_bf16 a[92:95],v[224:227],a[204:207],a[92:95]
ds_read_b64_tr_b16 v[214:215],v255 offset:17504
v_lshlrev_b32 v136,16,v199
v_mfma_f32_16x16x32_bf16 a[112:115],v[228:231],v[124:127],a[112:115]
v_and_b32 v199,0xffff0000,v199
v_add_f32 v246,v246,v136
v_mfma_f32_16x16x32_bf16 a[116:119],v[228:231],a[196:199],a[116:119]
v_add_f32 v247,v247,v199
s_waitcnt vmcnt(63)
v_mfma_f32_16x16x32_bf16 a[120:123],v[228:231],a[200:203],a[120:123]
buffer_store_dwordx4 v[144:147],v249,s[20:23],s64 offen sc1
v_accvgpr_read_b32 v128,a28
v_mfma_f32_16x16x32_bf16 a[124:127],v[228:231],a[204:207],a[124:127]
v_accvgpr_read_b32 v129,a29
s_waitcnt lgkmcnt(4)
v_mfma_f32_16x16x32_bf16 a[80:83],v[232:235],a[224:227],a[80:83]
ds_read_b64_tr_b16 v[216:217],v255 offset:21184
v_accvgpr_read_b32 v130,a30
v_mfma_f32_16x16x32_bf16 a[84:87],v[232:235],a[228:231],a[84:87]
ds_read_b64_tr_b16 v[218:219],v255 offset:21696
v_accvgpr_read_b32 v131,a31
v_mfma_f32_16x16x32_bf16 a[88:91],v[232:235],a[232:235],a[88:91]
ds_read_b64_tr_b16 v[220:221],v255 offset:21216
buffer_load_dwordx4 v[192:195],v248,s[4:7],s97 offen sc1
v_mfma_f32_16x16x32_bf16 a[92:95],v[232:235],a[236:239],a[92:95]
ds_read_b64_tr_b16 v[222:223],v255 offset:21728
v_accvgpr_read_b32 v132,a60
v_mfma_f32_16x16x32_bf16 a[112:115],v[236:239],a[224:227],a[112:115]
v_accvgpr_read_b32 v133,a61
v_accvgpr_read_b32 v134,a62
v_mfma_f32_16x16x32_bf16 a[116:119],v[236:239],a[228:231],a[116:119]
v_accvgpr_read_b32 v135,a63
v_cvt_pk_bf16_f32 v148,v128,v129
v_mfma_f32_16x16x32_bf16 a[120:123],v[236:239],a[232:235],a[120:123]
v_cvt_pk_bf16_f32 v149,v130,v131
v_cvt_pk_bf16_f32 v150,v132,v133
v_mfma_f32_16x16x32_bf16 a[124:127],v[236:239],a[236:239],a[124:127]
v_cvt_pk_bf16_f32 v151,v134,v135
s_waitcnt lgkmcnt(4)
v_mfma_f32_16x16x32_bf16 a[80:83],v[208:211],v[0:3],a[80:83]
ds_read_b64_tr_b16 v[224:225],v255 offset:25408
v_lshlrev_b32 v136,16,v200
v_mfma_f32_16x16x32_bf16 a[84:87],v[208:211],a[164:167],a[84:87]
ds_read_b64_tr_b16 v[226:227],v255 offset:25920
v_and_b32 v200,0xffff0000,v200
v_mfma_f32_16x16x32_bf16 a[88:91],v[208:211],a[168:171],a[88:91]
ds_read_b64_tr_b16 v[228:229],v255 offset:25440
v_add_f32 v240,v240,v136
v_mfma_f32_16x16x32_bf16 a[92:95],v[208:211],v[4:7],a[92:95]
ds_read_b64_tr_b16 v[230:231],v255 offset:25952
buffer_load_dwordx4 v[196:199],v248,s[4:7],s98 offen sc1
v_mfma_f32_16x16x32_bf16 a[112:115],v[212:215],v[0:3],a[112:115]
v_add_f32 v241,v241,v200
v_lshlrev_b32 v136,16,v201
v_mfma_f32_16x16x32_bf16 a[116:119],v[212:215],a[164:167],a[116:119]
v_and_b32 v201,0xffff0000,v201
v_add_f32 v242,v242,v136
v_mfma_f32_16x16x32_bf16 a[120:123],v[212:215],a[168:171],a[120:123]
v_add_f32 v243,v243,v201
v_lshlrev_b32 v136,16,v202
v_mfma_f32_16x16x32_bf16 a[124:127],v[212:215],v[4:7],a[124:127]
v_and_b32 v202,0xffff0000,v202
s_waitcnt lgkmcnt(4)
v_mfma_f32_16x16x32_bf16 a[80:83],v[216:219],v[8:11],a[80:83]
ds_read_b64_tr_b16 v[232:233],v255 offset:29632
v_add_f32 v244,v244,v136
v_mfma_f32_16x16x32_bf16 a[84:87],v[216:219],a[172:175],a[84:87]
ds_read_b64_tr_b16 v[234:235],v255 offset:30144
v_add_f32 v245,v245,v202
v_mfma_f32_16x16x32_bf16 a[88:91],v[216:219],a[192:195],a[88:91]
ds_read_b64_tr_b16 v[236:237],v255 offset:29664
buffer_store_dwordx4 v[148:151],v249,s[20:23],s65 offen sc1
v_mfma_f32_16x16x32_bf16 a[92:95],v[216:219],v[12:15],a[92:95]
ds_read_b64_tr_b16 v[238:239],v255 offset:30176
v_lshlrev_b32 v136,16,v203
v_mfma_f32_16x16x32_bf16 a[112:115],v[220:223],v[8:11],a[112:115]
v_and_b32 v203,0xffff0000,v203
v_add_f32 v246,v246,v136
v_mfma_f32_16x16x32_bf16 a[116:119],v[220:223],a[172:175],a[116:119]
v_add_f32 v247,v247,v203
buffer_load_dwordx4 v[200:203],v248,s[4:7],s99 offen sc1
v_mfma_f32_16x16x32_bf16 a[120:123],v[220:223],a[192:195],a[120:123]
s_add_u32 s4,s4,2048
s_addc_u32 s5,s5,0
v_mfma_f32_16x16x32_bf16 a[124:127],v[220:223],v[12:15],a[124:127]
v_cvt_pk_bf16_f32 v152,v240,v241
s_waitcnt lgkmcnt(4)
v_mfma_f32_16x16x32_bf16 a[80:83],v[224:227],a[136:139],a[80:83]
ds_read_b64_tr_b16 v[208:209],v255 offset:64
v_cvt_pk_bf16_f32 v153,v242,v243
v_mfma_f32_16x16x32_bf16 a[84:87],v[224:227],a[140:143],a[84:87]
ds_read_b64_tr_b16 v[210:211],v255 offset:576
v_cvt_pk_bf16_f32 v154,v244,v245
v_mfma_f32_16x16x32_bf16 a[88:91],v[224:227],a[160:163],a[88:91]
ds_read_b64_tr_b16 v[212:213],v255 offset:96
v_cvt_pk_bf16_f32 v155,v246,v247
v_mfma_f32_16x16x32_bf16 a[92:95],v[224:227],v[16:19],a[92:95]
ds_read_b64_tr_b16 v[214:215],v255 offset:608
v_permlane32_swap_b32 v152,v154
v_mfma_f32_16x16x32_bf16 a[112:115],v[228:231],a[136:139],a[112:115]
v_permlane32_swap_b32 v153,v155
v_mfma_f32_16x16x32_bf16 a[116:119],v[228:231],a[140:143],a[116:119]
v_permlane16_swap_b32 v152,v154
v_permlane16_swap_b32 v153,v155
v_mfma_f32_16x16x32_bf16 a[120:123],v[228:231],a[160:163],a[120:123]
buffer_store_dwordx4 v[152:155],v138,s[8:11],0 offen sc1
v_mfma_f32_16x16x32_bf16 a[124:127],v[228:231],v[16:19],a[124:127]
s_waitcnt lgkmcnt(4)
v_mfma_f32_16x16x32_bf16 a[80:83],v[232:235],v[20:23],a[80:83]
ds_read_b64_tr_b16 v[216:217],v255 offset:4288
v_mfma_f32_16x16x32_bf16 a[84:87],v[232:235],v[24:27],a[84:87]
ds_read_b64_tr_b16 v[218:219],v255 offset:4800
v_mfma_f32_16x16x32_bf16 a[88:91],v[232:235],a[0:3],a[88:91]
ds_read_b64_tr_b16 v[220:221],v255 offset:4320
v_mfma_f32_16x16x32_bf16 a[92:95],v[232:235],a[4:7],a[92:95]
ds_read_b64_tr_b16 v[222:223],v255 offset:4832
v_mfma_f32_16x16x32_bf16 a[112:115],v[236:239],v[20:23],a[112:115]
s_add_u32 s8,s8,128
s_addc_u32 s9,s9,0
v_mfma_f32_16x16x32_bf16 a[116:119],v[236:239],v[24:27],a[116:119]
v_mfma_f32_16x16x32_bf16 a[120:123],v[236:239],a[0:3],a[120:123]
v_mfma_f32_16x16x32_bf16 a[124:127],v[236:239],a[4:7],a[124:127]
s_waitcnt lgkmcnt(4)
v_mfma_f32_16x16x32_bf16 a[80:83],v[208:211],a[8:11],a[80:83]
ds_read_b64_tr_b16 v[224:225],v255 offset:8512
v_mfma_f32_16x16x32_bf16 a[84:87],v[208:211],a[12:15],a[84:87]
ds_read_b64_tr_b16 v[226:227],v255 offset:9024
v_mfma_f32_16x16x32_bf16 a[88:91],v[208:211],a[32:35],a[88:91]
ds_read_b64_tr_b16 v[228:229],v255 offset:8544
v_mfma_f32_16x16x32_bf16 a[92:95],v[208:211],a[36:39],a[92:95]
ds_read_b64_tr_b16 v[230:231],v255 offset:9056
v_mfma_f32_16x16x32_bf16 a[112:115],v[212:215],a[8:11],a[112:115]
v_mfma_f32_16x16x32_bf16 a[116:119],v[212:215],a[12:15],a[116:119]
v_mfma_f32_16x16x32_bf16 a[120:123],v[212:215],a[32:35],a[120:123]
v_mfma_f32_16x16x32_bf16 a[124:127],v[212:215],a[36:39],a[124:127]
s_waitcnt lgkmcnt(4)
v_mfma_f32_16x16x32_bf16 a[80:83],v[216:219],a[40:43],a[80:83]
ds_read_b64_tr_b16 v[232:233],v255 offset:12736
v_mfma_f32_16x16x32_bf16 a[84:87],v[216:219],a[44:47],a[84:87]
ds_read_b64_tr_b16 v[234:235],v255 offset:13248
v_mfma_f32_16x16x32_bf16 a[88:91],v[216:219],a[64:67],a[88:91]
ds_read_b64_tr_b16 v[236:237],v255 offset:12768
v_mfma_f32_16x16x32_bf16 a[92:95],v[216:219],a[68:71],a[92:95]
ds_read_b64_tr_b16 v[238:239],v255 offset:13280
v_mfma_f32_16x16x32_bf16 a[112:115],v[220:223],a[40:43],a[112:115]
v_mfma_f32_16x16x32_bf16 a[116:119],v[220:223],a[44:47],a[116:119]
v_mfma_f32_16x16x32_bf16 a[120:123],v[220:223],a[64:67],a[120:123]
v_mfma_f32_16x16x32_bf16 a[124:127],v[220:223],a[68:71],a[124:127]
s_waitcnt vmcnt(11) lgkmcnt(4)
v_mfma_f32_16x16x32_bf16 a[80:83],v[224:227],a[72:75],a[80:83]
v_mfma_f32_16x16x32_bf16 a[84:87],v[224:227],a[76:79],a[84:87]
s_waitcnt vmcnt(63) lgkmcnt(0)
s_barrier
v_mfma_f32_16x16x32_bf16 a[88:91],v[224:227],a[96:99],a[88:91]
ds_read_b64_tr_b16 v[208:209],v255 offset:33792
v_add_u32 v143,1,v143
v_mfma_f32_16x16x32_bf16 a[92:95],v[224:227],a[100:103],a[92:95]
ds_read_b64_tr_b16 v[210:211],v255 offset:34304
buffer_store_dword v143,v248,s[24:27],0 offen sc1
v_mfma_f32_16x16x32_bf16 a[112:115],v[228:231],a[72:75],a[112:115]
ds_read_b64_tr_b16 v[212:213],v255 offset:33824
s_add_u32 s67,s67,1
v_mfma_f32_16x16x32_bf16 a[116:119],v[228:231],a[76:79],a[116:119]
ds_read_b64_tr_b16 v[214:215],v255 offset:34336
s_sub_u32 s36,s36,1
v_mfma_f32_16x16x32_bf16 a[120:123],v[228:231],a[96:99],a[120:123]
v_mfma_f32_16x16x32_bf16 a[124:127],v[228:231],a[100:103],a[124:127]
v_mfma_f32_16x16x32_bf16 a[80:83],v[232:235],a[104:107],a[80:83]
ds_read_b64_tr_b16 v[216:217],v255 offset:38016
v_mfma_f32_16x16x32_bf16 a[84:87],v[232:235],a[108:111],a[84:87]
ds_read_b64_tr_b16 v[218:219],v255 offset:38528
v_mfma_f32_16x16x32_bf16 a[88:91],v[232:235],a[128:131],a[88:91]
ds_read_b64_tr_b16 v[220:221],v255 offset:38048
v_mfma_f32_16x16x32_bf16 a[92:95],v[232:235],a[132:135],a[92:95]
ds_read_b64_tr_b16 v[222:223],v255 offset:38560
v_mfma_f32_16x16x32_bf16 a[112:115],v[236:239],a[104:107],a[112:115]
v_mfma_f32_16x16x32_bf16 a[116:119],v[236:239],a[108:111],a[116:119]
v_mfma_f32_16x16x32_bf16 a[120:123],v[236:239],a[128:131],a[120:123]
s_cmp_lg_u32 s36,0
s_waitcnt lgkmcnt(4)
v_mfma_f32_16x16x32_bf16 a[124:127],v[236:239],a[132:135],a[124:127]
s_cbranch_scc1 L_ploop
L_plast:
v_mfma_f32_16x16x32_bf16 a[16:19],v[208:211],v[28:31],0
ds_read_b64_tr_b16 v[224:225],v252 offset:25344
v_mfma_f32_16x16x32_bf16 a[20:23],v[208:211],v[32:35],0
ds_read_b64_tr_b16 v[226:227],v252 offset:25856
v_mfma_f32_16x16x32_bf16 a[24:27],v[208:211],v[36:39],0
ds_read_b64_tr_b16 v[228:229],v252 offset:25376
v_mfma_f32_16x16x32_bf16 a[28:31],v[208:211],v[40:43],0
ds_read_b64_tr_b16 v[230:231],v252 offset:25888
v_mfma_f32_16x16x32_bf16 a[48:51],v[212:215],v[28:31],0
v_accvgpr_read_b32 v128,a80
v_accvgpr_read_b32 v129,a81
v_mfma_f32_16x16x32_bf16 a[52:55],v[212:215],v[32:35],0
v_accvgpr_read_b32 v130,a82
v_accvgpr_read_b32 v131,a83
v_mfma_f32_16x16x32_bf16 a[56:59],v[212:215],v[36:39],0
v_accvgpr_read_b32 v132,a112
v_accvgpr_read_b32 v133,a113
v_mfma_f32_16x16x32_bf16 a[60:63],v[212:215],v[40:43],0
v_accvgpr_read_b32 v134,a114
s_waitcnt lgkmcnt(4)
v_mfma_f32_16x16x32_bf16 a[16:19],v[216:219],v[44:47],a[16:19]
ds_read_b64_tr_b16 v[232:233],v252 offset:29568
v_accvgpr_read_b32 v135,a115
v_mfma_f32_16x16x32_bf16 a[20:23],v[216:219],v[48:51],a[20:23]
ds_read_b64_tr_b16 v[234:235],v252 offset:30080
v_cvt_pk_bf16_f32 v144,v128,v129
v_mfma_f32_16x16x32_bf16 a[24:27],v[216:219],v[52:55],a[24:27]
ds_read_b64_tr_b16 v[236:237],v252 offset:29600
v_cvt_pk_bf16_f32 v145,v130,v131
v_mfma_f32_16x16x32_bf16 a[28:31],v[216:219],v[56:59],a[28:31]
ds_read_b64_tr_b16 v[238:239],v252 offset:30112
v_cvt_pk_bf16_f32 v146,v132,v133
v_mfma_f32_16x16x32_bf16 a[48:51],v[220:223],v[44:47],a[48:51]
v_cvt_pk_bf16_f32 v147,v134,v135
buffer_store_dwordx4 v[144:147],v250,s[20:23],s62 offen sc1
v_mfma_f32_16x16x32_bf16 a[52:55],v[220:223],v[48:51],a[52:55]
v_accvgpr_read_b32 v128,a84
v_accvgpr_read_b32 v129,a85
v_mfma_f32_16x16x32_bf16 a[56:59],v[220:223],v[52:55],a[56:59]
v_accvgpr_read_b32 v130,a86
v_accvgpr_read_b32 v131,a87
v_mfma_f32_16x16x32_bf16 a[60:63],v[220:223],v[56:59],a[60:63]
v_accvgpr_read_b32 v132,a116
s_waitcnt lgkmcnt(4)
v_mfma_f32_16x16x32_bf16 a[16:19],v[224:227],v[60:63],a[16:19]
ds_read_b64_tr_b16 v[208:209],v252 offset:33792
v_accvgpr_read_b32 v133,a117
v_mfma_f32_16x16x32_bf16 a[20:23],v[224:227],v[64:67],a[20:23]
ds_read_b64_tr_b16 v[210:211],v252 offset:34304
v_accvgpr_read_b32 v134,a118
v_mfma_f32_16x16x32_bf16 a[24:27],v[224:227],v[68:71],a[24:27]
ds_read_b64_tr_b16 v[212:213],v252 offset:33824
v_accvgpr_read_b32 v135,a119
v_mfma_f32_16x16x32_bf16 a[28:31],v[224:227],v[72:75],a[28:31]
ds_read_b64_tr_b16 v[214:215],v252 offset:34336
v_cvt_pk_bf16_f32 v148,v128,v129
v_mfma_f32_16x16x32_bf16 a[48:51],v[228:231],v[60:63],a[48:51]
v_cvt_pk_bf16_f32 v149,v130,v131
v_cvt_pk_bf16_f32 v150,v132,v133
v_mfma_f32_16x16x32_bf16 a[52:55],v[228:231],v[64:67],a[52:55]
v_cvt_pk_bf16_f32 v151,v134,v135
v_lshlrev_b32 v240,16,v164
v_mfma_f32_16x16x32_bf16 a[56:59],v[228:231],v[68:71],a[56:59]
v_and_b32 v241,0xffff0000,v164
v_lshlrev_b32 v242,16,v165
v_mfma_f32_16x16x32_bf16 a[60:63],v[228:231],v[72:75],a[60:63]
v_and_b32 v243,0xffff0000,v165
s_waitcnt lgkmcnt(4)
v_mfma_f32_16x16x32_bf16 a[16:19],v[232:235],v[76:79],a[16:19]
ds_read_b64_tr_b16 v[216:217],v252 offset:38016
v_lshlrev_b32 v244,16,v166
v_mfma_f32_16x16x32_bf16 a[20:23],v[232:235],v[80:83],a[20:23]
ds_read_b64_tr_b16 v[218:219],v252 offset:38528
v_and_b32 v245,0xffff0000,v166
v_mfma_f32_16x16x32_bf16 a[24:27],v[232:235],v[84:87],a[24:27]
ds_read_b64_tr_b16 v[220:221],v252 offset:38048
v_lshlrev_b32 v246,16,v167
v_mfma_f32_16x16x32_bf16 a[28:31],v[232:235],v[88:91],a[28:31]
ds_read_b64_tr_b16 v[222:223],v252 offset:38560
v_and_b32 v247,0xffff0000,v167
v_mfma_f32_16x16x32_bf16 a[48:51],v[236:239],v[76:79],a[48:51]
s_waitcnt vmcnt(11)
v_lshlrev_b32 v136,16,v176
v_mfma_f32_16x16x32_bf16 a[52:55],v[236:239],v[80:83],a[52:55]
v_and_b32 v176,0xffff0000,v176
v_add_f32 v240,v240,v136
v_mfma_f32_16x16x32_bf16 a[56:59],v[236:239],v[84:87],a[56:59]
buffer_store_dwordx4 v[148:151],v250,s[20:23],s63 offen sc1
v_accvgpr_read_b32 v128,a88
v_mfma_f32_16x16x32_bf16 a[60:63],v[236:239],v[88:91],a[60:63]
v_accvgpr_read_b32 v129,a89
s_waitcnt lgkmcnt(4)
v_mfma_f32_16x16x32_bf16 a[16:19],v[208:211],v[92:95],a[16:19]
ds_read_b64_tr_b16 v[224:225],v252 offset:42240
v_accvgpr_read_b32 v130,a90
v_mfma_f32_16x16x32_bf16 a[20:23],v[208:211],v[96:99],a[20:23]
ds_read_b64_tr_b16 v[226:227],v252 offset:42752
v_accvgpr_read_b32 v131,a91
v_mfma_f32_16x16x32_bf16 a[24:27],v[208:211],v[100:103],a[24:27]
ds_read_b64_tr_b16 v[228:229],v252 offset:42272
v_accvgpr_read_b32 v132,a120
v_mfma_f32_16x16x32_bf16 a[28:31],v[208:211],v[104:107],a[28:31]
ds_read_b64_tr_b16 v[230:231],v252 offset:42784
v_accvgpr_read_b32 v133,a121
v_mfma_f32_16x16x32_bf16 a[48:51],v[212:215],v[92:95],a[48:51]
v_accvgpr_read_b32 v134,a122
v_accvgpr_read_b32 v135,a123
v_mfma_f32_16x16x32_bf16 a[52:55],v[212:215],v[96:99],a[52:55]
v_cvt_pk_bf16_f32 v144,v128,v129
v_cvt_pk_bf16_f32 v145,v130,v131
v_mfma_f32_16x16x32_bf16 a[56:59],v[212:215],v[100:103],a[56:59]
v_cvt_pk_bf16_f32 v146,v132,v133
v_cvt_pk_bf16_f32 v147,v134,v135
v_mfma_f32_16x16x32_bf16 a[60:63],v[212:215],v[104:107],a[60:63]
v_add_f32 v241,v241,v176
s_waitcnt lgkmcnt(4)
v_mfma_f32_16x16x32_bf16 a[16:19],v[216:219],v[108:111],a[16:19]
ds_read_b64_tr_b16 v[232:233],v252 offset:46464
v_lshlrev_b32 v136,16,v177
v_mfma_f32_16x16x32_bf16 a[20:23],v[216:219],v[112:115],a[20:23]
ds_read_b64_tr_b16 v[234:235],v252 offset:46976
v_and_b32 v177,0xffff0000,v177
v_mfma_f32_16x16x32_bf16 a[24:27],v[216:219],v[116:119],a[24:27]
ds_read_b64_tr_b16 v[236:237],v252 offset:46496
v_add_f32 v242,v242,v136
v_mfma_f32_16x16x32_bf16 a[28:31],v[216:219],v[120:123],a[28:31]
ds_read_b64_tr_b16 v[238:239],v252 offset:47008
v_add_f32 v243,v243,v177
v_mfma_f32_16x16x32_bf16 a[48:51],v[220:223],v[108:111],a[48:51]
v_lshlrev_b32 v136,16,v178
v_and_b32 v178,0xffff0000,v178
v_mfma_f32_16x16x32_bf16 a[52:55],v[220:223],v[112:115],a[52:55]
v_add_f32 v244,v244,v136
v_add_f32 v245,v245,v178
v_mfma_f32_16x16x32_bf16 a[56:59],v[220:223],v[116:119],a[56:59]
v_lshlrev_b32 v136,16,v179
v_and_b32 v179,0xffff0000,v179
v_mfma_f32_16x16x32_bf16 a[60:63],v[220:223],v[120:123],a[60:63]
v_add_f32 v246,v246,v136
s_waitcnt lgkmcnt(4)
v_mfma_f32_16x16x32_bf16 a[16:19],v[224:227],v[124:127],a[16:19]
ds_read_b64_tr_b16 v[208:209],v255 offset:16896
v_add_f32 v247,v247,v179
v_mfma_f32_16x16x32_bf16 a[20:23],v[224:227],a[196:199],a[20:23]
ds_read_b64_tr_b16 v[210:211],v255 offset:17408
v_lshlrev_b32 v136,16,v180
v_mfma_f32_16x16x32_bf16 a[24:27],v[224:227],a[200:203],a[24:27]
ds_read_b64_tr_b16 v[212:213],v255 offset:16928
buffer_store_dwordx4 v[144:147],v250,s[20:23],s64 offen sc1
v_mfma_f32_16x16x32_bf16 a[28:31],v[224:227],a[204:207],a[28:31]
ds_read_b64_tr_b16 v[214:215],v255 offset:17440
v_accvgpr_read_b32 v128,a92
v_mfma_f32_16x16x32_bf16 a[48:51],v[228:231],v[124:127],a[48:51]
buffer_load_dword v137,v142,s[12:15],0 offen sc1
v_accvgpr_read_b32 v129,a93
v_mfma_f32_16x16x32_bf16 a[52:55],v[228:231],a[196:199],a[52:55]
v_accvgpr_read_b32 v130,a94
v_accvgpr_read_b32 v131,a95
v_mfma_f32_16x16x32_bf16 a[56:59],v[228:231],a[200:203],a[56:59]
v_accvgpr_read_b32 v132,a124
v_accvgpr_read_b32 v133,a125
v_mfma_f32_16x16x32_bf16 a[60:63],v[228:231],a[204:207],a[60:63]
v_accvgpr_read_b32 v134,a126
s_waitcnt lgkmcnt(4)
v_mfma_f32_16x16x32_bf16 a[16:19],v[232:235],a[224:227],a[16:19]
ds_read_b64_tr_b16 v[216:217],v255 offset:21120
v_accvgpr_read_b32 v135,a127
v_mfma_f32_16x16x32_bf16 a[20:23],v[232:235],a[228:231],a[20:23]
ds_read_b64_tr_b16 v[218:219],v255 offset:21632
v_cvt_pk_bf16_f32 v148,v128,v129
v_mfma_f32_16x16x32_bf16 a[24:27],v[232:235],a[232:235],a[24:27]
ds_read_b64_tr_b16 v[220:221],v255 offset:21152
v_cvt_pk_bf16_f32 v149,v130,v131
v_mfma_f32_16x16x32_bf16 a[28:31],v[232:235],a[236:239],a[28:31]
ds_read_b64_tr_b16 v[222:223],v255 offset:21664
v_cvt_pk_bf16_f32 v150,v132,v133
v_mfma_f32_16x16x32_bf16 a[48:51],v[236:239],a[224:227],a[48:51]
v_cvt_pk_bf16_f32 v151,v134,v135
v_and_b32 v180,0xffff0000,v180
v_mfma_f32_16x16x32_bf16 a[52:55],v[236:239],a[228:231],a[52:55]
v_add_f32 v240,v240,v136
v_add_f32 v241,v241,v180
v_mfma_f32_16x16x32_bf16 a[56:59],v[236:239],a[232:235],a[56:59]
v_lshlrev_b32 v136,16,v181
v_and_b32 v181,0xffff0000,v181
v_mfma_f32_16x16x32_bf16 a[60:63],v[236:239],a[236:239],a[60:63]
v_add_f32 v242,v242,v136
s_waitcnt lgkmcnt(4)
v_mfma_f32_16x16x32_bf16 a[16:19],v[208:211],v[0:3],a[16:19]
ds_read_b64_tr_b16 v[224:225],v255 offset:25344
v_add_f32 v243,v243,v181
v_mfma_f32_16x16x32_bf16 a[20:23],v[208:211],a[164:167],a[20:23]
ds_read_b64_tr_b16 v[226:227],v255 offset:25856
v_lshlrev_b32 v136,16,v182
v_mfma_f32_16x16x32_bf16 a[24:27],v[208:211],a[168:171],a[24:27]
ds_read_b64_tr_b16 v[228:229],v255 offset:25376
v_and_b32 v182,0xffff0000,v182
v_mfma_f32_16x16x32_bf16 a[28:31],v[208:211],v[4:7],a[28:31]
ds_read_b64_tr_b16 v[230:231],v255 offset:25888
v_add_f32 v244,v244,v136
v_mfma_f32_16x16x32_bf16 a[48:51],v[212:215],v[0:3],a[48:51]
v_add_f32 v245,v245,v182
v_lshlrev_b32 v136,16,v183
v_mfma_f32_16x16x32_bf16 a[52:55],v[212:215],a[164:167],a[52:55]
v_and_b32 v183,0xffff0000,v183
v_add_f32 v246,v246,v136
v_mfma_f32_16x16x32_bf16 a[56:59],v[212:215],a[168:171],a[56:59]
buffer_store_dwordx4 v[148:151],v250,s[20:23],s65 offen sc1
v_add_f32 v247,v247,v183
v_mfma_f32_16x16x32_bf16 a[60:63],v[212:215],v[4:7],a[60:63]
s_waitcnt vmcnt(12)
s_waitcnt lgkmcnt(4)
v_mfma_f32_16x16x32_bf16 a[16:19],v[216:219],v[8:11],a[16:19]
ds_read_b64_tr_b16 v[232:233],v255 offset:29568
v_lshlrev_b32 v136,16,v184
v_mfma_f32_16x16x32_bf16 a[20:23],v[216:219],a[172:175],a[20:23]
ds_read_b64_tr_b16 v[234:235],v255 offset:30080
v_and_b32 v184,0xffff0000,v184
v_mfma_f32_16x16x32_bf16 a[24:27],v[216:219],a[192:195],a[24:27]
ds_read_b64_tr_b16 v[236:237],v255 offset:29600
v_add_f32 v240,v240,v136
v_mfma_f32_16x16x32_bf16 a[28:31],v[216:219],v[12:15],a[28:31]
ds_read_b64_tr_b16 v[238:239],v255 offset:30112
v_add_f32 v241,v241,v184
v_mfma_f32_16x16x32_bf16 a[48:51],v[220:223],v[8:11],a[48:51]
s_add_u32 s20,s20,2048
s_addc_u32 s21,s21,0
v_mfma_f32_16x16x32_bf16 a[52:55],v[220:223],a[172:175],a[52:55]
s_sub_u32 s22,s22,2048
v_lshlrev_b32 v136,16,v185
v_mfma_f32_16x16x32_bf16 a[56:59],v[220:223],a[192:195],a[56:59]
v_and_b32 v185,0xffff0000,v185
v_add_f32 v242,v242,v136
v_mfma_f32_16x16x32_bf16 a[60:63],v[220:223],v[12:15],a[60:63]
v_add_f32 v243,v243,v185
s_waitcnt lgkmcnt(4)
v_mfma_f32_16x16x32_bf16 a[16:19],v[224:227],a[136:139],a[16:19]
ds_read_b64_tr_b16 v[208:209],v255 offset:0
v_lshlrev_b32 v136,16,v186
v_mfma_f32_16x16x32_bf16 a[20:23],v[224:227],a[140:143],a[20:23]
ds_read_b64_tr_b16 v[210:211],v255 offset:512
v_and_b32 v186,0xffff0000,v186
v_mfma_f32_16x16x32_bf16 a[24:27],v[224:227],a[160:163],a[24:27]
ds_read_b64_tr_b16 v[212:213],v255 offset:32
v_add_f32 v244,v244,v136
v_mfma_f32_16x16x32_bf16 a[28:31],v[224:227],v[16:19],a[28:31]
ds_read_b64_tr_b16 v[214:215],v255 offset:544
v_add_f32 v245,v245,v186
v_mfma_f32_16x16x32_bf16 a[48:51],v[228:231],a[136:139],a[48:51]
v_lshlrev_b32 v136,16,v187
v_and_b32 v187,0xffff0000,v187
v_mfma_f32_16x16x32_bf16 a[52:55],v[228:231],a[140:143],a[52:55]
v_add_f32 v246,v246,v136
v_add_f32 v247,v247,v187
v_mfma_f32_16x16x32_bf16 a[56:59],v[228:231],a[160:163],a[56:59]
v_lshlrev_b32 v136,16,v188
v_and_b32 v188,0xffff0000,v188
v_mfma_f32_16x16x32_bf16 a[60:63],v[228:231],v[16:19],a[60:63]
v_add_f32 v240,v240,v136
s_waitcnt lgkmcnt(4)
v_mfma_f32_16x16x32_bf16 a[16:19],v[232:235],v[20:23],a[16:19]
ds_read_b64_tr_b16 v[216:217],v255 offset:4224
v_add_f32 v241,v241,v188
v_mfma_f32_16x16x32_bf16 a[20:23],v[232:235],v[24:27],a[20:23]
ds_read_b64_tr_b16 v[218:219],v255 offset:4736
v_lshlrev_b32 v136,16,v189
v_mfma_f32_16x16x32_bf16 a[24:27],v[232:235],a[0:3],a[24:27]
ds_read_b64_tr_b16 v[220:221],v255 offset:4256
v_and_b32 v189,0xffff0000,v189
v_mfma_f32_16x16x32_bf16 a[28:31],v[232:235],a[4:7],a[28:31]
ds_read_b64_tr_b16 v[222:223],v255 offset:4768
v_add_f32 v242,v242,v136
v_mfma_f32_16x16x32_bf16 a[48:51],v[236:239],v[20:23],a[48:51]
v_add_f32 v243,v243,v189
v_lshlrev_b32 v136,16,v190
v_mfma_f32_16x16x32_bf16 a[52:55],v[236:239],v[24:27],a[52:55]
v_and_b32 v190,0xffff0000,v190
v_add_f32 v244,v244,v136
v_mfma_f32_16x16x32_bf16 a[56:59],v[236:239],a[0:3],a[56:59]
v_add_f32 v245,v245,v190
v_lshlrev_b32 v136,16,v191
v_mfma_f32_16x16x32_bf16 a[60:63],v[236:239],a[4:7],a[60:63]
v_and_b32 v191,0xffff0000,v191
s_waitcnt lgkmcnt(4)
v_mfma_f32_16x16x32_bf16 a[16:19],v[208:211],a[8:11],a[16:19]
ds_read_b64_tr_b16 v[224:225],v255 offset:8448
v_add_f32 v246,v246,v136
v_mfma_f32_16x16x32_bf16 a[20:23],v[208:211],a[12:15],a[20:23]
ds_read_b64_tr_b16 v[226:227],v255 offset:8960
v_add_f32 v247,v247,v191
v_mfma_f32_16x16x32_bf16 a[24:27],v[208:211],a[32:35],a[24:27]
ds_read_b64_tr_b16 v[228:229],v255 offset:8480
s_waitcnt vmcnt(9)
v_mfma_f32_16x16x32_bf16 a[28:31],v[208:211],a[36:39],a[28:31]
ds_read_b64_tr_b16 v[230:231],v255 offset:8992
v_lshlrev_b32 v136,16,v192
v_mfma_f32_16x16x32_bf16 a[48:51],v[212:215],a[8:11],a[48:51]
v_and_b32 v192,0xffff0000,v192
v_add_f32 v240,v240,v136
v_mfma_f32_16x16x32_bf16 a[52:55],v[212:215],a[12:15],a[52:55]
v_add_f32 v241,v241,v192
v_lshlrev_b32 v136,16,v193
v_mfma_f32_16x16x32_bf16 a[56:59],v[212:215],a[32:35],a[56:59]
v_and_b32 v193,0xffff0000,v193
v_add_f32 v242,v242,v136
v_mfma_f32_16x16x32_bf16 a[60:63],v[212:215],a[36:39],a[60:63]
v_add_f32 v243,v243,v193
s_waitcnt lgkmcnt(4)
v_mfma_f32_16x16x32_bf16 a[16:19],v[216:219],a[40:43],a[16:19]
ds_read_b64_tr_b16 v[232:233],v255 offset:12672
v_lshlrev_b32 v136,16,v194
v_mfma_f32_16x16x32_bf16 a[20:23],v[216:219],a[44:47],a[20:23]
ds_read_b64_tr_b16 v[234:235],v255 offset:13184
v_and_b32 v194,0xffff0000,v194
v_mfma_f32_16x16x32_bf16 a[24:27],v[216:219],a[64:67],a[24:27]
ds_read_b64_tr_b16 v[236:237],v255 offset:12704
v_add_f32 v244,v244,v136
v_mfma_f32_16x16x32_bf16 a[28:31],v[216:219],a[68:71],a[28:31]
ds_read_b64_tr_b16 v[238:239],v255 offset:13216
v_add_f32 v245,v245,v194
v_mfma_f32_16x16x32_bf16 a[48:51],v[220:223],a[40:43],a[48:51]
v_lshlrev_b32 v136,16,v195
v_and_b32 v195,0xffff0000,v195
v_mfma_f32_16x16x32_bf16 a[52:55],v[220:223],a[44:47],a[52:55]
v_add_f32 v246,v246,v136
v_add_f32 v247,v247,v195
v_mfma_f32_16x16x32_bf16 a[56:59],v[220:223],a[64:67],a[56:59]
v_lshlrev_b32 v136,16,v196
v_and_b32 v196,0xffff0000,v196
v_mfma_f32_16x16x32_bf16 a[60:63],v[220:223],a[68:71],a[60:63]
v_add_f32 v240,v240,v136
s_waitcnt lgkmcnt(4)
v_mfma_f32_16x16x32_bf16 a[16:19],v[224:227],a[72:75],a[16:19]
v_add_f32 v241,v241,v196
v_lshlrev_b32 v136,16,v197
v_mfma_f32_16x16x32_bf16 a[20:23],v[224:227],a[76:79],a[20:23]
s_waitcnt vmcnt(0) lgkmcnt(0)
s_barrier
v_mfma_f32_16x16x32_bf16 a[24:27],v[224:227],a[96:99],a[24:27]
ds_read_b64_tr_b16 v[208:209],v252 offset:16960
v_and_b32 v197,0xffff0000,v197
v_mfma_f32_16x16x32_bf16 a[28:31],v[224:227],a[100:103],a[28:31]
ds_read_b64_tr_b16 v[210:211],v252 offset:17472
v_add_f32 v242,v242,v136
v_mfma_f32_16x16x32_bf16 a[48:51],v[228:231],a[72:75],a[48:51]
s_waitcnt vmcnt(63)
ds_read_b64_tr_b16 v[212:213],v252 offset:16992
v_mfma_f32_16x16x32_bf16 a[52:55],v[228:231],a[76:79],a[52:55]
v_cmp_gt_u32 vcc,s67,v137
s_cbranch_vccnz L_stub13
L_back13:
ds_read_b64_tr_b16 v[214:215],v252 offset:17504
v_mfma_f32_16x16x32_bf16 a[56:59],v[228:231],a[96:99],a[56:59]
buffer_load_dwordx4 v[176:179],v248,s[4:7],s93 offen sc1
v_add_f32 v243,v243,v197
v_mfma_f32_16x16x32_bf16 a[60:63],v[228:231],a[100:103],a[60:63]
v_lshlrev_b32 v136,16,v198
v_and_b32 v198,0xffff0000,v198
v_add_u32 v143,1,v143
buffer_store_dword v143,v248,s[24:27],0 offen sc1
v_mfma_f32_16x16x32_bf16 a[16:19],v[232:235],a[104:107],a[16:19]
ds_read_b64_tr_b16 v[216:217],v252 offset:21184
v_add_f32 v244,v244,v136
v_mfma_f32_16x16x32_bf16 a[20:23],v[232:235],a[108:111],a[20:23]
ds_read_b64_tr_b16 v[218:219],v252 offset:21696
v_add_f32 v245,v245,v198
v_mfma_f32_16x16x32_bf16 a[24:27],v[232:235],a[128:131],a[24:27]
ds_read_b64_tr_b16 v[220:221],v252 offset:21216
v_lshlrev_b32 v136,16,v199
v_mfma_f32_16x16x32_bf16 a[28:31],v[232:235],a[132:135],a[28:31]
ds_read_b64_tr_b16 v[222:223],v252 offset:21728
v_and_b32 v199,0xffff0000,v199
v_mfma_f32_16x16x32_bf16 a[48:51],v[236:239],a[104:107],a[48:51]
v_add_f32 v246,v246,v136
v_add_f32 v247,v247,v199
v_mfma_f32_16x16x32_bf16 a[52:55],v[236:239],a[108:111],a[52:55]
s_waitcnt vmcnt(63)
v_lshlrev_b32 v136,16,v200
v_mfma_f32_16x16x32_bf16 a[56:59],v[236:239],a[128:131],a[56:59]
buffer_load_dwordx4 v[180:183],v248,s[4:7],s94 offen sc1
v_and_b32 v200,0xffff0000,v200
v_mfma_f32_16x16x32_bf16 a[60:63],v[236:239],a[132:135],a[60:63]
v_add_f32 v240,v240,v136
s_waitcnt lgkmcnt(4)
v_mfma_f32_16x16x32_bf16 a[80:83],v[208:211],v[28:31],0
ds_read_b64_tr_b16 v[224:225],v252 offset:25408
v_add_f32 v241,v241,v200
v_mfma_f32_16x16x32_bf16 a[84:87],v[208:211],v[32:35],0
ds_read_b64_tr_b16 v[226:227],v252 offset:25920
v_lshlrev_b32 v136,16,v201
v_mfma_f32_16x16x32_bf16 a[88:91],v[208:211],v[36:39],0
ds_read_b64_tr_b16 v[228:229],v252 offset:25440
v_and_b32 v201,0xffff0000,v201
v_mfma_f32_16x16x32_bf16 a[92:95],v[208:211],v[40:43],0
ds_read_b64_tr_b16 v[230:231],v252 offset:25952
v_add_f32 v242,v242,v136
v_mfma_f32_16x16x32_bf16 a[112:115],v[212:215],v[28:31],0
v_mov_b32 v164,v156
v_mov_b32 v165,v157
v_mfma_f32_16x16x32_bf16 a[116:119],v[212:215],v[32:35],0
v_mov_b32 v166,v158
v_mov_b32 v167,v159
v_mfma_f32_16x16x32_bf16 a[120:123],v[212:215],v[36:39],0
buffer_load_dwordx4 v[184:187],v248,s[4:7],s95 offen sc1
v_accvgpr_read_b32 v128,a16
v_mfma_f32_16x16x32_bf16 a[124:127],v[212:215],v[40:43],0
v_accvgpr_read_b32 v129,a17
s_waitcnt lgkmcnt(4)
v_mfma_f32_16x16x32_bf16 a[80:83],v[216:219],v[44:47],a[80:83]
ds_read_b64_tr_b16 v[232:233],v252 offset:29632
v_accvgpr_read_b32 v130,a18
v_mfma_f32_16x16x32_bf16 a[84:87],v[216:219],v[48:51],a[84:87]
ds_read_b64_tr_b16 v[234:235],v252 offset:30144
v_accvgpr_read_b32 v131,a19
v_mfma_f32_16x16x32_bf16 a[88:91],v[216:219],v[52:55],a[88:91]
ds_read_b64_tr_b16 v[236:237],v252 offset:29664
v_accvgpr_read_b32 v132,a48
v_mfma_f32_16x16x32_bf16 a[92:95],v[216:219],v[56:59],a[92:95]
ds_read_b64_tr_b16 v[238:239],v252 offset:30176
v_accvgpr_read_b32 v133,a49
v_mfma_f32_16x16x32_bf16 a[112:115],v[220:223],v[44:47],a[112:115]
v_accvgpr_read_b32 v134,a50
v_accvgpr_read_b32 v135,a51
v_mfma_f32_16x16x32_bf16 a[116:119],v[220:223],v[48:51],a[116:119]
v_cvt_pk_bf16_f32 v156,v128,v129
v_cvt_pk_bf16_f32 v157,v130,v131
v_mfma_f32_16x16x32_bf16 a[120:123],v[220:223],v[52:55],a[120:123]
buffer_load_dwordx4 v[188:191],v248,s[4:7],s96 offen sc1
v_cvt_pk_bf16_f32 v158,v132,v133
v_mfma_f32_16x16x32_bf16 a[124:127],v[220:223],v[56:59],a[124:127]
v_cvt_pk_bf16_f32 v159,v134,v135
s_waitcnt lgkmcnt(4)
v_mfma_f32_16x16x32_bf16 a[80:83],v[224:227],v[60:63],a[80:83]
ds_read_b64_tr_b16 v[208:209],v252 offset:33856
v_accvgpr_read_b32 v128,a20
v_mfma_f32_16x16x32_bf16 a[84:87],v[224:227],v[64:67],a[84:87]
ds_read_b64_tr_b16 v[210:211],v252 offset:34368
v_accvgpr_read_b32 v129,a21
v_mfma_f32_16x16x32_bf16 a[88:91],v[224:227],v[68:71],a[88:91]
ds_read_b64_tr_b16 v[212:213],v252 offset:33888
v_accvgpr_read_b32 v130,a22
v_mfma_f32_16x16x32_bf16 a[92:95],v[224:227],v[72:75],a[92:95]
ds_read_b64_tr_b16 v[214:215],v252 offset:34400
v_accvgpr_read_b32 v131,a23
v_mfma_f32_16x16x32_bf16 a[112:115],v[228:231],v[60:63],a[112:115]
v_accvgpr_read_b32 v132,a52
v_accvgpr_read_b32 v133,a53
v_mfma_f32_16x16x32_bf16 a[116:119],v[228:231],v[64:67],a[116:119]
v_accvgpr_read_b32 v134,a54
v_accvgpr_read_b32 v135,a55
v_mfma_f32_16x16x32_bf16 a[120:123],v[228:231],v[68:71],a[120:123]
buffer_load_dwordx4 v[192:195],v248,s[4:7],s97 offen sc1
v_cvt_pk_bf16_f32 v148,v128,v129
v_mfma_f32_16x16x32_bf16 a[124:127],v[228:231],v[72:75],a[124:127]
v_cvt_pk_bf16_f32 v149,v130,v131
s_waitcnt lgkmcnt(4)
v_mfma_f32_16x16x32_bf16 a[80:83],v[232:235],v[76:79],a[80:83]
ds_read_b64_tr_b16 v[216:217],v252 offset:38080
v_cvt_pk_bf16_f32 v150,v132,v133
v_mfma_f32_16x16x32_bf16 a[84:87],v[232:235],v[80:83],a[84:87]
ds_read_b64_tr_b16 v[218:219],v252 offset:38592
v_cvt_pk_bf16_f32 v151,v134,v135
v_mfma_f32_16x16x32_bf16 a[88:91],v[232:235],v[84:87],a[88:91]
ds_read_b64_tr_b16 v[220:221],v252 offset:38112
v_add_f32 v243,v243,v201
v_mfma_f32_16x16x32_bf16 a[92:95],v[232:235],v[88:91],a[92:95]
ds_read_b64_tr_b16 v[222:223],v252 offset:38624
v_lshlrev_b32 v136,16,v202
v_mfma_f32_16x16x32_bf16 a[112:115],v[236:239],v[76:79],a[112:115]
v_and_b32 v202,0xffff0000,v202
v_add_f32 v244,v244,v136
v_mfma_f32_16x16x32_bf16 a[116:119],v[236:239],v[80:83],a[116:119]
v_add_f32 v245,v245,v202
v_lshlrev_b32 v136,16,v203
v_mfma_f32_16x16x32_bf16 a[120:123],v[236:239],v[84:87],a[120:123]
buffer_load_dwordx4 v[196:199],v248,s[4:7],s98 offen sc1
v_and_b32 v203,0xffff0000,v203
v_mfma_f32_16x16x32_bf16 a[124:127],v[236:239],v[88:91],a[124:127]
v_add_f32 v246,v246,v136
s_waitcnt lgkmcnt(4)
v_mfma_f32_16x16x32_bf16 a[80:83],v[208:211],v[92:95],a[80:83]
ds_read_b64_tr_b16 v[224:225],v252 offset:42304
v_add_f32 v247,v247,v203
v_mfma_f32_16x16x32_bf16 a[84:87],v[208:211],v[96:99],a[84:87]
ds_read_b64_tr_b16 v[226:227],v252 offset:42816
v_cvt_pk_bf16_f32 v152,v240,v241
v_mfma_f32_16x16x32_bf16 a[88:91],v[208:211],v[100:103],a[88:91]
ds_read_b64_tr_b16 v[228:229],v252 offset:42336
buffer_store_dwordx4 v[148:151],v249,s[20:23],s63 offen sc1
v_mfma_f32_16x16x32_bf16 a[92:95],v[208:211],v[104:107],a[92:95]
ds_read_b64_tr_b16 v[230:231],v252 offset:42848
v_accvgpr_read_b32 v128,a24
v_mfma_f32_16x16x32_bf16 a[112:115],v[212:215],v[92:95],a[112:115]
v_accvgpr_read_b32 v129,a25
v_accvgpr_read_b32 v130,a26
v_mfma_f32_16x16x32_bf16 a[116:119],v[212:215],v[96:99],a[116:119]
v_accvgpr_read_b32 v131,a27
v_accvgpr_read_b32 v132,a56
v_mfma_f32_16x16x32_bf16 a[120:123],v[212:215],v[100:103],a[120:123]
buffer_load_dwordx4 v[200:203],v248,s[4:7],s99 offen sc1
v_accvgpr_read_b32 v133,a57
v_mfma_f32_16x16x32_bf16 a[124:127],v[212:215],v[104:107],a[124:127]
v_accvgpr_read_b32 v134,a58
s_waitcnt lgkmcnt(4)
v_mfma_f32_16x16x32_bf16 a[80:83],v[216:219],v[108:111],a[80:83]
ds_read_b64_tr_b16 v[232:233],v252 offset:46528
v_accvgpr_read_b32 v135,a59
v_mfma_f32_16x16x32_bf16 a[84:87],v[216:219],v[112:115],a[84:87]
ds_read_b64_tr_b16 v[234:235],v252 offset:47040
v_cvt_pk_bf16_f32 v144,v128,v129
v_mfma_f32_16x16x32_bf16 a[88:91],v[216:219],v[116:119],a[88:91]
ds_read_b64_tr_b16 v[236:237],v252 offset:46560
v_cvt_pk_bf16_f32 v145,v130,v131
v_mfma_f32_16x16x32_bf16 a[92:95],v[216:219],v[120:123],a[92:95]
ds_read_b64_tr_b16 v[238:239],v252 offset:47072
v_cvt_pk_bf16_f32 v146,v132,v133
v_mfma_f32_16x16x32_bf16 a[112:115],v[220:223],v[108:111],a[112:115]
s_add_u32 s4,s4,2048
s_addc_u32 s5,s5,0
v_mfma_f32_16x16x32_bf16 a[116:119],v[220:223],v[112:115],a[116:119]
v_cvt_pk_bf16_f32 v147,v134,v135
v_cvt_pk_bf16_f32 v153,v242,v243
v_mfma_f32_16x16x32_bf16 a[120:123],v[220:223],v[116:119],a[120:123]
v_cvt_pk_bf16_f32 v154,v244,v245
v_cvt_pk_bf16_f32 v155,v246,v247
v_mfma_f32_16x16x32_bf16 a[124:127],v[220:223],v[120:123],a[124:127]
v_permlane32_swap_b32 v152,v154
s_waitcnt lgkmcnt(4)
v_mfma_f32_16x16x32_bf16 a[80:83],v[224:227],v[124:127],a[80:83]
ds_read_b64_tr_b16 v[208:209],v255 offset:16960
v_permlane32_swap_b32 v153,v155
v_mfma_f32_16x16x32_bf16 a[84:87],v[224:227],a[196:199],a[84:87]
ds_read_b64_tr_b16 v[210:211],v255 offset:17472
v_permlane16_swap_b32 v152,v154
v_mfma_f32_16x16x32_bf16 a[88:91],v[224:227],a[200:203],a[88:91]
ds_read_b64_tr_b16 v[212:213],v255 offset:16992
v_permlane16_swap_b32 v153,v155
v_mfma_f32_16x16x32_bf16 a[92:95],v[224:227],a[204:207],a[92:95]
ds_read_b64_tr_b16 v[214:215],v255 offset:17504
buffer_store_dwordx4 v[152:155],v138,s[8:11],0 offen sc1
v_mfma_f32_16x16x32_bf16 a[112:115],v[228:231],v[124:127],a[112:115]
s_add_u32 s8,s8,128
s_addc_u32 s9,s9,0
v_mfma_f32_16x16x32_bf16 a[116:119],v[228:231],a[196:199],a[116:119]
s_add_u32 s67,s67,1
v_mfma_f32_16x16x32_bf16 a[120:123],v[228:231],a[200:203],a[120:123]
buffer_store_dwordx4 v[144:147],v249,s[20:23],s64 offen sc1
v_accvgpr_read_b32 v128,a28
v_mfma_f32_16x16x32_bf16 a[124:127],v[228:231],a[204:207],a[124:127]
v_accvgpr_read_b32 v129,a29
s_waitcnt lgkmcnt(4)
v_mfma_f32_16x16x32_bf16 a[80:83],v[232:235],a[224:227],a[80:83]
ds_read_b64_tr_b16 v[216:217],v255 offset:21184
v_accvgpr_read_b32 v130,a30
v_mfma_f32_16x16x32_bf16 a[84:87],v[232:235],a[228:231],a[84:87]
ds_read_b64_tr_b16 v[218:219],v255 offset:21696
v_accvgpr_read_b32 v131,a31
v_mfma_f32_16x16x32_bf16 a[88:91],v[232:235],a[232:235],a[88:91]
ds_read_b64_tr_b16 v[220:221],v255 offset:21216
v_accvgpr_read_b32 v132,a60
v_mfma_f32_16x16x32_bf16 a[92:95],v[232:235],a[236:239],a[92:95]
ds_read_b64_tr_b16 v[222:223],v255 offset:21728
v_accvgpr_read_b32 v133,a61
v_mfma_f32_16x16x32_bf16 a[112:115],v[236:239],a[224:227],a[112:115]
v_accvgpr_read_b32 v134,a62
v_accvgpr_read_b32 v135,a63
v_mfma_f32_16x16x32_bf16 a[116:119],v[236:239],a[228:231],a[116:119]
v_cvt_pk_bf16_f32 v148,v128,v129
v_cvt_pk_bf16_f32 v149,v130,v131
v_mfma_f32_16x16x32_bf16 a[120:123],v[236:239],a[232:235],a[120:123]
v_cvt_pk_bf16_f32 v150,v132,v133
v_cvt_pk_bf16_f32 v151,v134,v135
v_mfma_f32_16x16x32_bf16 a[124:127],v[236:239],a[236:239],a[124:127]
s_waitcnt lgkmcnt(4)
v_mfma_f32_16x16x32_bf16 a[80:83],v[208:211],v[0:3],a[80:83]
ds_read_b64_tr_b16 v[224:225],v255 offset:25408
v_mfma_f32_16x16x32_bf16 a[84:87],v[208:211],a[164:167],a[84:87]
ds_read_b64_tr_b16 v[226:227],v255 offset:25920
v_mfma_f32_16x16x32_bf16 a[88:91],v[208:211],a[168:171],a[88:91]
ds_read_b64_tr_b16 v[228:229],v255 offset:25440
v_mfma_f32_16x16x32_bf16 a[92:95],v[208:211],v[4:7],a[92:95]
ds_read_b64_tr_b16 v[230:231],v255 offset:25952
v_mfma_f32_16x16x32_bf16 a[112:115],v[212:215],v[0:3],a[112:115]
buffer_load_dword v137,v142,s[12:15],0 offen sc1
v_mfma_f32_16x16x32_bf16 a[116:119],v[212:215],a[164:167],a[116:119]
v_mfma_f32_16x16x32_bf16 a[120:123],v[212:215],a[168:171],a[120:123]
v_mfma_f32_16x16x32_bf16 a[124:127],v[212:215],v[4:7],a[124:127]
s_waitcnt lgkmcnt(4)
v_mfma_f32_16x16x32_bf16 a[80:83],v[216:219],v[8:11],a[80:83]
ds_read_b64_tr_b16 v[232:233],v255 offset:29632
v_mfma_f32_16x16x32_bf16 a[84:87],v[216:219],a[172:175],a[84:87]
ds_read_b64_tr_b16 v[234:235],v255 offset:30144
v_mfma_f32_16x16x32_bf16 a[88:91],v[216:219],a[192:195],a[88:91]
ds_read_b64_tr_b16 v[236:237],v255 offset:29664
buffer_store_dwordx4 v[148:151],v249,s[20:23],s65 offen sc1
v_mfma_f32_16x16x32_bf16 a[92:95],v[216:219],v[12:15],a[92:95]
ds_read_b64_tr_b16 v[238:239],v255 offset:30176
v_mfma_f32_16x16x32_bf16 a[112:115],v[220:223],v[8:11],a[112:115]
v_mfma_f32_16x16x32_bf16 a[116:119],v[220:223],a[172:175],a[116:119]
v_mfma_f32_16x16x32_bf16 a[120:123],v[220:223],a[192:195],a[120:123]
v_mfma_f32_16x16x32_bf16 a[124:127],v[220:223],v[12:15],a[124:127]
s_waitcnt lgkmcnt(4)
v_mfma_f32_16x16x32_bf16 a[80:83],v[224:227],a[136:139],a[80:83]
ds_read_b64_tr_b16 v[208:209],v255 offset:64
v_mfma_f32_16x16x32_bf16 a[84:87],v[224:227],a[140:143],a[84:87]
ds_read_b64_tr_b16 v[210:211],v255 offset:576
v_mfma_f32_16x16x32_bf16 a[88:91],v[224:227],a[160:163],a[88:91]
ds_read_b64_tr_b16 v[212:213],v255 offset:96
v_mfma_f32_16x16x32_bf16 a[92:95],v[224:227],v[16:19],a[92:95]
ds_read_b64_tr_b16 v[214:215],v255 offset:608
v_mfma_f32_16x16x32_bf16 a[112:115],v[228:231],a[136:139],a[112:115]
v_mfma_f32_16x16x32_bf16 a[116:119],v[228:231],a[140:143],a[116:119]
v_mfma_f32_16x16x32_bf16 a[120:123],v[228:231],a[160:163],a[120:123]
v_mfma_f32_16x16x32_bf16 a[124:127],v[228:231],v[16:19],a[124:127]
s_waitcnt lgkmcnt(4)
v_mfma_f32_16x16x32_bf16 a[80:83],v[232:235],v[20:23],a[80:83]
ds_read_b64_tr_b16 v[216:217],v255 offset:4288
v_mfma_f32_16x16x32_bf16 a[84:87],v[232:235],v[24:27],a[84:87]
ds_read_b64_tr_b16 v[218:219],v255 offset:4800
v_mfma_f32_16x16x32_bf16 a[88:91],v[232:235],a[0:3],a[88:91]
ds_read_b64_tr_b16 v[220:221],v255 offset:4320
v_mfma_f32_16x16x32_bf16 a[92:95],v[232:235],a[4:7],a[92:95]
ds_read_b64_tr_b16 v[222:223],v255 offset:4832
v_mfma_f32_16x16x32_bf16 a[112:115],v[236:239],v[20:23],a[112:115]
v_mfma_f32_16x16x32_bf16 a[116:119],v[236:239],v[24:27],a[116:119]
v_mfma_f32_16x16x32_bf16 a[120:123],v[236:239],a[0:3],a[120:123]
v_mfma_f32_16x16x32_bf16 a[124:127],v[236:239],a[4:7],a[124:127]
s_waitcnt lgkmcnt(4)
v_mfma_f32_16x16x32_bf16 a[80:83],v[208:211],a[8:11],a[80:83]
ds_read_b64_tr_b16 v[224:225],v255 offset:8512
v_mfma_f32_16x16x32_bf16 a[84:87],v[208:211],a[12:15],a[84:87]
ds_read_b64_tr_b16 v[226:227],v255 offset:9024
v_mfma_f32_16x16x32_bf16 a[88:91],v[208:211],a[32:35],a[88:91]
ds_read_b64_tr_b16 v[228:229],v255 offset:8544
v_mfma_f32_16x16x32_bf16 a[92:95],v[208:211],a[36:39],a[92:95]
ds_read_b64_tr_b16 v[230:231],v255 offset:9056
v_mfma_f32_16x16x32_bf16 a[112:115],v[212:215],a[8:11],a[112:115]
v_mfma_f32_16x16x32_bf16 a[116:119],v[212:215],a[12:15],a[116:119]
v_mfma_f32_16x16x32_bf16 a[120:123],v[212:215],a[32:35],a[120:123]
v_mfma_f32_16x16x32_bf16 a[124:127],v[212:215],a[36:39],a[124:127]
s_waitcnt lgkmcnt(4)
v_mfma_f32_16x16x32_bf16 a[80:83],v[216:219],a[40:43],a[80:83]
ds_read_b64_tr_b16 v[232:233],v255 offset:12736
v_mfma_f32_16x16x32_bf16 a[84:87],v[216:219],a[44:47],a[84:87]
ds_read_b64_tr_b16 v[234:235],v255 offset:13248
v_mfma_f32_16x16x32_bf16 a[88:91],v[216:219],a[64:67],a[88:91]
ds_read_b64_tr_b16 v[236:237],v255 offset:12768
v_mfma_f32_16x16x32_bf16 a[92:95],v[216:219],a[68:71],a[92:95]
ds_read_b64_tr_b16 v[238:239],v255 offset:13280
v_mfma_f32_16x16x32_bf16 a[112:115],v[220:223],a[40:43],a[112:115]
v_mfma_f32_16x16x32_bf16 a[116:119],v[220:223],a[44:47],a[116:119]
v_mfma_f32_16x16x32_bf16 a[120:123],v[220:223],a[64:67],a[120:123]
v_mfma_f32_16x16x32_bf16 a[124:127],v[220:223],a[68:71],a[124:127]
s_waitcnt lgkmcnt(4)
v_mfma_f32_16x16x32_bf16 a[80:83],v[224:227],a[72:75],a[80:83]
v_mfma_f32_16x16x32_bf16 a[84:87],v[224:227],a[76:79],a[84:87]
v_mfma_f32_16x16x32_bf16 a[88:91],v[224:227],a[96:99],a[88:91]
v_mfma_f32_16x16x32_bf16 a[92:95],v[224:227],a[100:103],a[92:95]
v_mfma_f32_16x16x32_bf16 a[112:115],v[228:231],a[72:75],a[112:115]
v_mfma_f32_16x16x32_bf16 a[116:119],v[228:231],a[76:79],a[116:119]
v_mfma_f32_16x16x32_bf16 a[120:123],v[228:231],a[96:99],a[120:123]
v_mfma_f32_16x16x32_bf16 a[124:127],v[228:231],a[100:103],a[124:127]
s_waitcnt lgkmcnt(0)
v_mfma_f32_16x16x32_bf16 a[80:83],v[232:235],a[104:107],a[80:83]
v_mfma_f32_16x16x32_bf16 a[84:87],v[232:235],a[108:111],a[84:87]
v_mfma_f32_16x16x32_bf16 a[88:91],v[232:235],a[128:131],a[88:91]
v_mfma_f32_16x16x32_bf16 a[92:95],v[232:235],a[132:135],a[92:95]
v_mfma_f32_16x16x32_bf16 a[112:115],v[236:239],a[104:107],a[112:115]
v_mfma_f32_16x16x32_bf16 a[116:119],v[236:239],a[108:111],a[116:119]
v_mfma_f32_16x16x32_bf16 a[120:123],v[236:239],a[128:131],a[120:123]
v_mfma_f32_16x16x32_bf16 a[124:127],v[236:239],a[132:135],a[124:127]
s_waitcnt vmcnt(1)
v_cmp_gt_u32 vcc,s67,v137
s_cbranch_vccnz L_stub14
L_back14:
s_lshl_b32 s58,s39,4
v_cmp_eq_u32 vcc,s58,v142
v_mov_b32 v136,7
s_nop 0
v_cndmask_b32 v140,0,v136,vcc
v_accvgpr_read_b32 v128,a80
v_accvgpr_read_b32 v129,a81
v_accvgpr_read_b32 v130,a82
v_accvgpr_read_b32 v131,a83
v_accvgpr_read_b32 v132,a112
v_accvgpr_read_b32 v133,a113
v_accvgpr_read_b32 v134,a114
v_accvgpr_read_b32 v135,a115
v_cvt_pk_bf16_f32 v144,v128,v129
v_cvt_pk_bf16_f32 v145,v130,v131
v_cvt_pk_bf16_f32 v146,v132,v133
v_cvt_pk_bf16_f32 v147,v134,v135
buffer_store_dwordx4 v[144:147],v250,s[20:23],s62 offen sc1
v_accvgpr_read_b32 v128,a84
v_accvgpr_read_b32 v129,a85
v_accvgpr_read_b32 v130,a86
v_accvgpr_read_b32 v131,a87
v_accvgpr_read_b32 v132,a116
v_accvgpr_read_b32 v133,a117
v_accvgpr_read_b32 v134,a118
v_accvgpr_read_b32 v135,a119
v_cvt_pk_bf16_f32 v148,v128,v129
v_cvt_pk_bf16_f32 v149,v130,v131
v_cvt_pk_bf16_f32 v150,v132,v133
v_cvt_pk_bf16_f32 v151,v134,v135
buffer_store_dwordx4 v[148:151],v250,s[20:23],s63 offen sc1
v_accvgpr_read_b32 v128,a88
v_accvgpr_read_b32 v129,a89
v_accvgpr_read_b32 v130,a90
v_accvgpr_read_b32 v131,a91
v_accvgpr_read_b32 v132,a120
v_accvgpr_read_b32 v133,a121
v_accvgpr_read_b32 v134,a122
v_accvgpr_read_b32 v135,a123
v_cvt_pk_bf16_f32 v144,v128,v129
v_cvt_pk_bf16_f32 v145,v130,v131
v_cvt_pk_bf16_f32 v146,v132,v133
v_cvt_pk_bf16_f32 v147,v134,v135
buffer_store_dwordx4 v[144:147],v250,s[20:23],s64 offen sc1
v_accvgpr_read_b32 v128,a92
v_accvgpr_read_b32 v129,a93
v_accvgpr_read_b32 v130,a94
v_accvgpr_read_b32 v131,a95
v_accvgpr_read_b32 v132,a124
v_accvgpr_read_b32 v133,a125
v_accvgpr_read_b32 v134,a126
v_accvgpr_read_b32 v135,a127
v_cvt_pk_bf16_f32 v148,v128,v129
v_cvt_pk_bf16_f32 v149,v130,v131
v_cvt_pk_bf16_f32 v150,v132,v133
v_cvt_pk_bf16_f32 v151,v134,v135
buffer_store_dwordx4 v[148:151],v250,s[20:23],s65 offen sc1
buffer_load_dwordx4 v[0:3],v248,s[4:7],s93 offen sc1
buffer_load_dwordx4 v[4:7],v248,s[4:7],s94 offen sc1
buffer_load_dwordx4 v[8:11],v248,s[4:7],s95 offen sc1
buffer_load_dwordx4 v[12:15],v248,s[4:7],s96 offen sc1
buffer_load_dwordx4 v[16:19],v248,s[4:7],s97 offen sc1
buffer_load_dwordx4 v[20:23],v248,s[4:7],s98 offen sc1
buffer_load_dwordx4 v[24:27],v248,s[4:7],s99 offen sc1
s_add_u32 s4,s4,2048
s_addc_u32 s5,s5,0
s_waitcnt vmcnt(63)
v_lshlrev_b32 v240,16,v164
v_and_b32 v241,0xffff0000,v164
v_lshlrev_b32 v242,16,v165
v_and_b32 v243,0xffff0000,v165
v_lshlrev_b32 v244,16,v166
v_and_b32 v245,0xffff0000,v166
v_lshlrev_b32 v246,16,v167
v_and_b32 v247,0xffff0000,v167
v_lshlrev_b32 v128,16,v176
v_and_b32 v129,0xffff0000,v176
v_pk_add_f32 v[240:241],v[240:241],v[128:129]
v_lshlrev_b32 v130,16,v177
v_and_b32 v131,0xffff0000,v177
v_pk_add_f32 v[242:243],v[242:243],v[130:131]
v_lshlrev_b32 v132,16,v178
v_and_b32 v133,0xffff0000,v178
v_pk_add_f32 v[244:245],v[244:245],v[132:133]
v_lshlrev_b32 v134,16,v179
v_and_b32 v135,0xffff0000,v179
v_pk_add_f32 v[246:247],v[246:247],v[134:135]
v_lshlrev_b32 v128,16,v180
v_and_b32 v129,0xffff0000,v180
v_pk_add_f32 v[240:241],v[240:241],v[128:129]
v_lshlrev_b32 v130,16,v181
v_and_b32 v131,0xffff0000,v181
v_pk_add_f32 v[242:243],v[242:243],v[130:131]
v_lshlrev_b32 v132,16,v182
v_and_b32 v133,0xffff0000,v182
v_pk_add_f32 v[244:245],v[244:245],v[132:133]
v_lshlrev_b32 v134,16,v183
v_and_b32 v135,0xffff0000,v183
v_pk_add_f32 v[246:247],v[246:247],v[134:135]
v_lshlrev_b32 v128,16,v184
v_and_b32 v129,0xffff0000,v184
v_pk_add_f32 v[240:241],v[240:241],v[128:129]
v_lshlrev_b32 v130,16,v185
v_and_b32 v131,0xffff0000,v185
v_pk_add_f32 v[242:243],v[242:243],v[130:131]
v_lshlrev_b32 v132,16,v186
v_and_b32 v133,0xffff0000,v186
v_pk_add_f32 v[244:245],v[244:245],v[132:133]
v_lshlrev_b32 v134,16,v187
v_and_b32 v135,0xffff0000,v187
v_pk_add_f32 v[246:247],v[246:247],v[134:135]
v_lshlrev_b32 v128,16,v188
v_and_b32 v129,0xffff0000,v188
v_pk_add_f32 v[240:241],v[240:241],v[128:129]
v_lshlrev_b32 v130,16,v189
v_and_b32 v131,0xffff0000,v189
v_pk_add_f32 v[242:243],v[242:243],v[130:131]
v_lshlrev_b32 v132,16,v190
v_and_b32 v133,0xffff0000,v190
v_pk_add_f32 v[244:245],v[244:245],v[132:133]
v_lshlrev_b32 v134,16,v191
v_and_b32 v135,0xffff0000,v191
v_pk_add_f32 v[246:247],v[246:247],v[134:135]
v_lshlrev_b32 v128,16,v192
v_and_b32 v129,0xffff0000,v192
v_pk_add_f32 v[240:241],v[240:241],v[128:129]
v_lshlrev_b32 v130,16,v193
v_and_b32 v131,0xffff0000,v193
v_pk_add_f32 v[242:243],v[242:243],v[130:131]
v_lshlrev_b32 v132,16,v194
v_and_b32 v133,0xffff0000,v194
v_pk_add_f32 v[244:245],v[244:245],v[132:133]
v_lshlrev_b32 v134,16,v195
v_and_b32 v135,0xffff0000,v195
v_pk_add_f32 v[246:247],v[246:247],v[134:135]
v_lshlrev_b32 v128,16,v196
v_and_b32 v129,0xffff0000,v196
v_pk_add_f32 v[240:241],v[240:241],v[128:129]
v_lshlrev_b32 v130,16,v197
v_and_b32 v131,0xffff0000,v197
v_pk_add_f32 v[242:243],v[242:243],v[130:131]
v_lshlrev_b32 v132,16,v198
v_and_b32 v133,0xffff0000,v198
v_pk_add_f32 v[244:245],v[244:245],v[132:133]
v_lshlrev_b32 v134,16,v199
v_and_b32 v135,0xffff0000,v199
v_pk_add_f32 v[246:247],v[246:247],v[134:135]
v_lshlrev_b32 v128,16,v200
v_and_b32 v129,0xffff0000,v200
v_pk_add_f32 v[240:241],v[240:241],v[128:129]
v_lshlrev_b32 v130,16,v201
v_and_b32 v131,0xffff0000,v201
v_pk_add_f32 v[242:243],v[242:243],v[130:131]
v_lshlrev_b32 v132,16,v202
v_and_b32 v133,0xffff0000,v202
v_pk_add_f32 v[244:245],v[244:245],v[132:133]
v_lshlrev_b32 v134,16,v203
v_and_b32 v135,0xffff0000,v203
v_pk_add_f32 v[246:247],v[246:247],v[134:135]
v_cvt_pk_bf16_f32 v152,v240,v241
v_cvt_pk_bf16_f32 v153,v242,v243
v_cvt_pk_bf16_f32 v154,v244,v245
v_cvt_pk_bf16_f32 v155,v246,v247
s_nop 0
v_permlane32_swap_b32 v152,v154
v_permlane32_swap_b32 v153,v155
s_nop 0
v_permlane16_swap_b32 v152,v154
v_permlane16_swap_b32 v153,v155
s_waitcnt vmcnt(7)
s_barrier
v_add_u32 v143,1,v143
buffer_store_dword v143,v248,s[24:27],0 offen sc1
buffer_store_dwordx4 v[152:155],v138,s[8:11],0 offen sc1
s_add_u32 s8,s8,128
s_addc_u32 s9,s9,0
s_mov_b32 s67,7
s_waitcnt vmcnt(2)
buffer_load_dword v137,v142,s[12:15],0 offen sc1
v_lshlrev_b32 v240,16,v160
v_and_b32 v241,0xffff0000,v160
v_lshlrev_b32 v242,16,v161
v_and_b32 v243,0xffff0000,v161
v_lshlrev_b32 v244,16,v162
v_and_b32 v245,0xffff0000,v162
v_lshlrev_b32 v246,16,v163
v_and_b32 v247,0xffff0000,v163
v_lshlrev_b32 v128,16,v0
v_and_b32 v129,0xffff0000,v0
v_pk_add_f32 v[240:241],v[240:241],v[128:129]
v_lshlrev_b32 v130,16,v1
v_and_b32 v131,0xffff0000,v1
v_pk_add_f32 v[242:243],v[242:243],v[130:131]
v_lshlrev_b32 v132,16,v2
v_and_b32 v133,0xffff0000,v2
v_pk_add_f32 v[244:245],v[244:245],v[132:133]
v_lshlrev_b32 v134,16,v3
v_and_b32 v135,0xffff0000,v3
v_pk_add_f32 v[246:247],v[246:247],v[134:135]
v_lshlrev_b32 v128,16,v4
v_and_b32 v129,0xffff0000,v4
v_pk_add_f32 v[240:241],v[240:241],v[128:129]
v_lshlrev_b32 v130,16,v5
v_and_b32 v131,0xffff0000,v5
v_pk_add_f32 v[242:243],v[242:243],v[130:131]
v_lshlrev_b32 v132,16,v6
v_and_b32 v133,0xffff0000,v6
v_pk_add_f32 v[244:245],v[244:245],v[132:133]
v_lshlrev_b32 v134,16,v7
v_and_b32 v135,0xffff0000,v7
v_pk_add_f32 v[246:247],v[246:247],v[134:135]
v_lshlrev_b32 v128,16,v8
v_and_b32 v129,0xffff0000,v8
v_pk_add_f32 v[240:241],v[240:241],v[128:129]
v_lshlrev_b32 v130,16,v9
v_and_b32 v131,0xffff0000,v9
v_pk_add_f32 v[242:243],v[242:243],v[130:131]
v_lshlrev_b32 v132,16,v10
v_and_b32 v133,0xffff0000,v10
v_pk_add_f32 v[244:245],v[244:245],v[132:133]
v_lshlrev_b32 v134,16,v11
v_and_b32 v135,0xffff0000,v11
v_pk_add_f32 v[246:247],v[246:247],v[134:135]
v_lshlrev_b32 v128,16,v12
v_and_b32 v129,0xffff0000,v12
v_pk_add_f32 v[240:241],v[240:241],v[128:129]
v_lshlrev_b32 v130,16,v13
v_and_b32 v131,0xffff0000,v13
v_pk_add_f32 v[242:243],v[242:243],v[130:131]
v_lshlrev_b32 v132,16,v14
v_and_b32 v133,0xffff0000,v14
v_pk_add_f32 v[244:245],v[244:245],v[132:133]
v_lshlrev_b32 v134,16,v15
v_and_b32 v135,0xffff0000,v15
v_pk_add_f32 v[246:247],v[246:247],v[134:135]
v_lshlrev_b32 v128,16,v16
v_and_b32 v129,0xffff0000,v16
v_pk_add_f32 v[240:241],v[240:241],v[128:129]
v_lshlrev_b32 v130,16,v17
v_and_b32 v131,0xffff0000,v17
v_pk_add_f32 v[242:243],v[242:243],v[130:131]
v_lshlrev_b32 v132,16,v18
v_and_b32 v133,0xffff0000,v18
v_pk_add_f32 v[244:245],v[244:245],v[132:133]
v_lshlrev_b32 v134,16,v19
v_and_b32 v135,0xffff0000,v19
v_pk_add_f32 v[246:247],v[246:247],v[134:135]
v_lshlrev_b32 v128,16,v20
v_and_b32 v129,0xffff0000,v20
v_pk_add_f32 v[240:241],v[240:241],v[128:129]
v_lshlrev_b32 v130,16,v21
v_and_b32 v131,0xffff0000,v21
v_pk_add_f32 v[242:243],v[242:243],v[130:131]
v_lshlrev_b32 v132,16,v22
v_and_b32 v133,0xffff0000,v22
v_pk_add_f32 v[244:245],v[244:245],v[132:133]
v_lshlrev_b32 v134,16,v23
v_and_b32 v135,0xffff0000,v23
v_pk_add_f32 v[246:247],v[246:247],v[134:135]
v_lshlrev_b32 v128,16,v24
v_and_b32 v129,0xffff0000,v24
v_pk_add_f32 v[240:241],v[240:241],v[128:129]
v_lshlrev_b32 v130,16,v25
v_and_b32 v131,0xffff0000,v25
v_pk_add_f32 v[242:243],v[242:243],v[130:131]
v_lshlrev_b32 v132,16,v26
v_and_b32 v133,0xffff0000,v26
v_pk_add_f32 v[244:245],v[244:245],v[132:133]
v_lshlrev_b32 v134,16,v27
v_and_b32 v135,0xffff0000,v27
v_pk_add_f32 v[246:247],v[246:247],v[134:135]
v_cvt_pk_bf16_f32 v168,v240,v241
v_cvt_pk_bf16_f32 v169,v242,v243
v_cvt_pk_bf16_f32 v170,v244,v245
v_cvt_pk_bf16_f32 v171,v246,v247
s_nop 0
v_permlane32_swap_b32 v168,v170
v_permlane32_swap_b32 v169,v171
s_nop 0
v_permlane16_swap_b32 v168,v170
v_permlane16_swap_b32 v169,v171
s_waitcnt vmcnt(0)
v_max_u32 v137,v137,v140
v_cmp_gt_u32 vcc,s67,v137
s_cbranch_vccnz L_stub15
L_back15:
buffer_load_dwordx4 v[32:35],v248,s[4:7],s93 offen sc1
buffer_load_dwordx4 v[36:39],v248,s[4:7],s94 offen sc1
buffer_load_dwordx4 v[40:43],v248,s[4:7],s95 offen sc1
buffer_load_dwordx4 v[44:47],v248,s[4:7],s96 offen sc1
buffer_load_dwordx4 v[48:51],v248,s[4:7],s97 offen sc1
buffer_load_dwordx4 v[52:55],v248,s[4:7],s98 offen sc1
buffer_load_dwordx4 v[56:59],v248,s[4:7],s99 offen sc1
s_add_u32 s4,s4,2048
s_addc_u32 s5,s5,0
buffer_store_dwordx4 v[168:171],v138,s[8:11],0 offen sc1
s_add_u32 s8,s8,128
s_addc_u32 s9,s9,0
v_lshlrev_b32 v240,16,v156
v_and_b32 v241,0xffff0000,v156
v_lshlrev_b32 v242,16,v157
v_and_b32 v243,0xffff0000,v157
v_lshlrev_b32 v244,16,v158
v_and_b32 v245,0xffff0000,v158
v_lshlrev_b32 v246,16,v159
v_and_b32 v247,0xffff0000,v159
s_waitcnt vmcnt(7)
v_lshlrev_b32 v128,16,v32
v_and_b32 v129,0xffff0000,v32
v_pk_add_f32 v[240:241],v[240:241],v[128:129]
v_lshlrev_b32 v130,16,v33
v_and_b32 v131,0xffff0000,v33
v_pk_add_f32 v[242:243],v[242:243],v[130:131]
v_lshlrev_b32 v132,16,v34
v_and_b32 v133,0xffff0000,v34
v_pk_add_f32 v[244:245],v[244:245],v[132:133]
v_lshlrev_b32 v134,16,v35
v_and_b32 v135,0xffff0000,v35
v_pk_add_f32 v[246:247],v[246:247],v[134:135]
s_waitcnt vmcnt(6)
v_lshlrev_b32 v128,16,v36
v_and_b32 v129,0xffff0000,v36
v_pk_add_f32 v[240:241],v[240:241],v[128:129]
v_lshlrev_b32 v130,16,v37
v_and_b32 v131,0xffff0000,v37
v_pk_add_f32 v[242:243],v[242:243],v[130:131]
v_lshlrev_b32 v132,16,v38
v_and_b32 v133,0xffff0000,v38
v_pk_add_f32 v[244:245],v[244:245],v[132:133]
v_lshlrev_b32 v134,16,v39
v_and_b32 v135,0xffff0000,v39
v_pk_add_f32 v[246:247],v[246:247],v[134:135]
s_waitcnt vmcnt(5)
v_lshlrev_b32 v128,16,v40
v_and_b32 v129,0xffff0000,v40
v_pk_add_f32 v[240:241],v[240:241],v[128:129]
v_lshlrev_b32 v130,16,v41
v_and_b32 v131,0xffff0000,v41
v_pk_add_f32 v[242:243],v[242:243],v[130:131]
v_lshlrev_b32 v132,16,v42
v_and_b32 v133,0xffff0000,v42
v_pk_add_f32 v[244:245],v[244:245],v[132:133]
v_lshlrev_b32 v134,16,v43
v_and_b32 v135,0xffff0000,v43
v_pk_add_f32 v[246:247],v[246:247],v[134:135]
s_waitcnt vmcnt(4)
v_lshlrev_b32 v128,16,v44
v_and_b32 v129,0xffff0000,v44
v_pk_add_f32 v[240:241],v[240:241],v[128:129]
v_lshlrev_b32 v130,16,v45
v_and_b32 v131,0xffff0000,v45
v_pk_add_f32 v[242:243],v[242:243],v[130:131]
v_lshlrev_b32 v132,16,v46
v_and_b32 v133,0xffff0000,v46
v_pk_add_f32 v[244:245],v[244:245],v[132:133]
v_lshlrev_b32 v134,16,v47
v_and_b32 v135,0xffff0000,v47
v_pk_add_f32 v[246:247],v[246:247],v[134:135]
s_waitcnt vmcnt(3)
v_lshlrev_b32 v128,16,v48
v_and_b32 v129,0xffff0000,v48
v_pk_add_f32 v[240:241],v[240:241],v[128:129]
v_lshlrev_b32 v130,16,v49
v_and_b32 v131,0xffff0000,v49
v_pk_add_f32 v[242:243],v[242:243],v[130:131]
v_lshlrev_b32 v132,16,v50
v_and_b32 v133,0xffff0000,v50
v_pk_add_f32 v[244:245],v[244:245],v[132:133]
v_lshlrev_b32 v134,16,v51
v_and_b32 v135,0xffff0000,v51
v_pk_add_f32 v[246:247],v[246:247],v[134:135]
s_waitcnt vmcnt(2)
v_lshlrev_b32 v128,16,v52
v_and_b32 v129,0xffff0000,v52
v_pk_add_f32 v[240:241],v[240:241],v[128:129]
v_lshlrev_b32 v130,16,v53
v_and_b32 v131,0xffff0000,v53
v_pk_add_f32 v[242:243],v[242:243],v[130:131]
v_lshlrev_b32 v132,16,v54
v_and_b32 v133,0xffff0000,v54
v_pk_add_f32 v[244:245],v[244:245],v[132:133]
v_lshlrev_b32 v134,16,v55
v_and_b32 v135,0xffff0000,v55
v_pk_add_f32 v[246:247],v[246:247],v[134:135]
s_waitcnt vmcnt(1)
v_lshlrev_b32 v128,16,v56
v_and_b32 v129,0xffff0000,v56
v_pk_add_f32 v[240:241],v[240:241],v[128:129]
v_lshlrev_b32 v130,16,v57
v_and_b32 v131,0xffff0000,v57
v_pk_add_f32 v[242:243],v[242:243],v[130:131]
v_lshlrev_b32 v132,16,v58
v_and_b32 v133,0xffff0000,v58
v_pk_add_f32 v[244:245],v[244:245],v[132:133]
v_lshlrev_b32 v134,16,v59
v_and_b32 v135,0xffff0000,v59
v_pk_add_f32 v[246:247],v[246:247],v[134:135]
v_cvt_pk_bf16_f32 v172,v240,v241
v_cvt_pk_bf16_f32 v173,v242,v243
v_cvt_pk_bf16_f32 v174,v244,v245
v_cvt_pk_bf16_f32 v175,v246,v247
s_nop 0
v_permlane32_swap_b32 v172,v174
v_permlane32_swap_b32 v173,v175
s_nop 0
v_permlane16_swap_b32 v172,v174
v_permlane16_swap_b32 v173,v175
buffer_store_dwordx4 v[172:175],v138,s[8:11],0 offen sc1
s_add_u32 s8,s8,128
s_addc_u32 s9,s9,0
L_end:
s_endpgm
L_stub0:
s_call_b64 s[42:43],L_fb1
s_branch L_back0
L_stub1:
s_call_b64 s[42:43],L_fb0
s_branch L_back1
L_stub2:
s_call_b64 s[42:43],L_fb1
s_branch L_back2
L_stub3:
s_call_b64 s[42:43],L_fb0
s_branch L_back3
L_stub4:
s_call_b64 s[42:43],L_fb1
s_branch L_back4
L_stub5:
s_call_b64 s[42:43],L_fb0
s_branch L_back5
L_stub6:
s_call_b64 s[42:43],L_fb1
s_branch L_back6
L_stub7:
s_call_b64 s[42:43],L_fb1
s_branch L_back7
L_stub8:
s_call_b64 s[42:43],L_fb0
s_branch L_back8
L_stub9:
s_call_b64 s[42:43],L_fb1
s_branch L_back9
L_stub10:
s_mov_b32 s60,s67
s_call_b64 s[42:43],L_spinf
s_branch L_back10
L_stub11:
s_mov_b32 s60,s33
s_call_b64 s[42:43],L_spind
s_branch L_back11
L_stub12:
s_mov_b32 s60,s67
s_call_b64 s[42:43],L_spinf
s_branch L_back12
L_stub13:
s_mov_b32 s60,s67
s_call_b64 s[42:43],L_spinf
s_branch L_back13
L_stub14:
s_mov_b32 s60,s67
s_call_b64 s[42:43],L_spinf
s_branch L_back14
L_stub15:
s_mov_b32 s60,s67
s_call_b64 s[42:43],L_spinf
s_branch L_back15
L_fb0:
s_nop 7
s_nop 7
v_max3_f32 v248,v128,v129,v130
v_max3_f32 v248,v248,v131,v144
v_max3_f32 v248,v248,v145,v146
v_max_f32 v248,v248,v147
v_mov_b32 v249,v248
s_nop 1
v_permlane32_swap_b32 v249,v248
v_max_f32 v248,v249,v248
v_mov_b32 v249,v248
s_nop 1
v_permlane16_swap_b32 v249,v248
v_max_f32 v248,v249,v248
v_max_f32 v248,0,v248
v_sub_f32 v249,0,v248
v_exp_f32 v249,v249
v_sub_f32 v128,v128,v248
v_sub_f32 v129,v129,v248
v_sub_f32 v130,v130,v248
v_sub_f32 v131,v131,v248
v_sub_f32 v144,v144,v248
v_sub_f32 v145,v145,v248
v_sub_f32 v146,v146,v248
v_sub_f32 v147,v147,v248
v_sub_f32 v192,v192,v248
v_sub_f32 v193,v193,v248
v_sub_f32 v194,v194,v248
v_sub_f32 v195,v195,v248
v_mul_f32 v240,v240,v249
v_accvgpr_read_b32 v250,a0
v_accvgpr_read_b32 v251,a1
v_mul_f32 v250,v250,v249
v_mul_f32 v251,v251,v249
v_accvgpr_write_b32 a0,v250
v_accvgpr_write_b32 a1,v251
v_accvgpr_read_b32 v250,a2
v_accvgpr_read_b32 v251,a3
v_mul_f32 v250,v250,v249
v_mul_f32 v251,v251,v249
v_accvgpr_write_b32 a2,v250
v_accvgpr_write_b32 a3,v251
v_accvgpr_read_b32 v250,a16
v_accvgpr_read_b32 v251,a17
v_mul_f32 v250,v250,v249
v_mul_f32 v251,v251,v249
v_accvgpr_write_b32 a16,v250
v_accvgpr_write_b32 a17,v251
v_accvgpr_read_b32 v250,a18
v_accvgpr_read_b32 v251,a19
v_mul_f32 v250,v250,v249
v_mul_f32 v251,v251,v249
v_accvgpr_write_b32 a18,v250
v_accvgpr_write_b32 a19,v251
v_accvgpr_read_b32 v250,a32
v_accvgpr_read_b32 v251,a33
v_mul_f32 v250,v250,v249
v_mul_f32 v251,v251,v249
v_accvgpr_write_b32 a32,v250
v_accvgpr_write_b32 a33,v251
v_accvgpr_read_b32 v250,a34
v_accvgpr_read_b32 v251,a35
v_mul_f32 v250,v250,v249
v_mul_f32 v251,v251,v249
v_accvgpr_write_b32 a34,v250
v_accvgpr_write_b32 a35,v251
v_accvgpr_read_b32 v250,a48
v_accvgpr_read_b32 v251,a49
v_mul_f32 v250,v250,v249
v_mul_f32 v251,v251,v249
v_accvgpr_write_b32 a48,v250
v_accvgpr_write_b32 a49,v251
v_accvgpr_read_b32 v250,a50
v_accvgpr_read_b32 v251,a51
v_mul_f32 v250,v250,v249
v_mul_f32 v251,v251,v249
v_accvgpr_write_b32 a50,v250
v_accvgpr_write_b32 a51,v251
v_accvgpr_read_b32 v250,a64
v_accvgpr_read_b32 v251,a65
v_mul_f32 v250,v250,v249
v_mul_f32 v251,v251,v249
v_accvgpr_write_b32 a64,v250
v_accvgpr_write_b32 a65,v251
v_accvgpr_read_b32 v250,a66
v_accvgpr_read_b32 v251,a67
v_mul_f32 v250,v250,v249
v_mul_f32 v251,v251,v249
v_accvgpr_write_b32 a66,v250
v_accvgpr_write_b32 a67,v251
v_accvgpr_read_b32 v250,a80
v_accvgpr_read_b32 v251,a81
v_mul_f32 v250,v250,v249
v_mul_f32 v251,v251,v249
v_accvgpr_write_b32 a80,v250
v_accvgpr_write_b32 a81,v251
v_accvgpr_read_b32 v250,a82
v_accvgpr_read_b32 v251,a83
v_mul_f32 v250,v250,v249
v_mul_f32 v251,v251,v249
v_accvgpr_write_b32 a82,v250
v_accvgpr_write_b32 a83,v251
v_accvgpr_read_b32 v250,a96
v_accvgpr_read_b32 v251,a97
v_mul_f32 v250,v250,v249
v_mul_f32 v251,v251,v249
v_accvgpr_write_b32 a96,v250
v_accvgpr_write_b32 a97,v251
v_accvgpr_read_b32 v250,a98
v_accvgpr_read_b32 v251,a99
v_mul_f32 v250,v250,v249
v_mul_f32 v251,v251,v249
v_accvgpr_write_b32 a98,v250
v_accvgpr_write_b32 a99,v251
v_accvgpr_read_b32 v250,a112
v_accvgpr_read_b32 v251,a113
v_mul_f32 v250,v250,v249
v_mul_f32 v251,v251,v249
v_accvgpr_write_b32 a112,v250
v_accvgpr_write_b32 a113,v251
v_accvgpr_read_b32 v250,a114
v_accvgpr_read_b32 v251,a115
v_mul_f32 v250,v250,v249
v_mul_f32 v251,v251,v249
v_accvgpr_write_b32 a114,v250
v_accvgpr_write_b32 a115,v251
v_accvgpr_read_b32 v250,a128
v_accvgpr_read_b32 v251,a129
v_mul_f32 v250,v250,v249
v_mul_f32 v251,v251,v249
v_accvgpr_write_b32 a128,v250
v_accvgpr_write_b32 a129,v251
v_accvgpr_read_b32 v250,a130
v_accvgpr_read_b32 v251,a131
v_mul_f32 v250,v250,v249
v_mul_f32 v251,v251,v249
v_accvgpr_write_b32 a130,v250
v_accvgpr_write_b32 a131,v251
v_accvgpr_read_b32 v250,a144
v_accvgpr_read_b32 v251,a145
v_mul_f32 v250,v250,v249
v_mul_f32 v251,v251,v249
v_accvgpr_write_b32 a144,v250
v_accvgpr_write_b32 a145,v251
v_accvgpr_read_b32 v250,a146
v_accvgpr_read_b32 v251,a147
v_mul_f32 v250,v250,v249
v_mul_f32 v251,v251,v249
v_accvgpr_write_b32 a146,v250
v_accvgpr_write_b32 a147,v251
v_accvgpr_read_b32 v250,a160
v_accvgpr_read_b32 v251,a161
v_mul_f32 v250,v250,v249
v_mul_f32 v251,v251,v249
v_accvgpr_write_b32 a160,v250
v_accvgpr_write_b32 a161,v251
v_accvgpr_read_b32 v250,a162
v_accvgpr_read_b32 v251,a163
v_mul_f32 v250,v250,v249
v_mul_f32 v251,v251,v249
v_accvgpr_write_b32 a162,v250
v_accvgpr_write_b32 a163,v251
v_accvgpr_read_b32 v250,a176
v_accvgpr_read_b32 v251,a177
v_mul_f32 v250,v250,v249
v_mul_f32 v251,v251,v249
v_accvgpr_write_b32 a176,v250
v_accvgpr_write_b32 a177,v251
v_accvgpr_read_b32 v250,a178
v_accvgpr_read_b32 v251,a179
v_mul_f32 v250,v250,v249
v_mul_f32 v251,v251,v249
v_accvgpr_write_b32 a178,v250
v_accvgpr_write_b32 a179,v251
v_accvgpr_read_b32 v250,a192
v_accvgpr_read_b32 v251,a193
v_mul_f32 v250,v250,v249
v_mul_f32 v251,v251,v249
v_accvgpr_write_b32 a192,v250
v_accvgpr_write_b32 a193,v251
v_accvgpr_read_b32 v250,a194
v_accvgpr_read_b32 v251,a195
v_mul_f32 v250,v250,v249
v_mul_f32 v251,v251,v249
v_accvgpr_write_b32 a194,v250
v_accvgpr_write_b32 a195,v251
v_accvgpr_read_b32 v250,a208
v_accvgpr_read_b32 v251,a209
v_mul_f32 v250,v250,v249
v_mul_f32 v251,v251,v249
v_accvgpr_write_b32 a208,v250
v_accvgpr_write_b32 a209,v251
v_accvgpr_read_b32 v250,a210
v_accvgpr_read_b32 v251,a211
v_mul_f32 v250,v250,v249
v_mul_f32 v251,v251,v249
v_accvgpr_write_b32 a210,v250
v_accvgpr_write_b32 a211,v251
v_accvgpr_read_b32 v250,a224
v_accvgpr_read_b32 v251,a225
v_mul_f32 v250,v250,v249
v_mul_f32 v251,v251,v249
v_accvgpr_write_b32 a224,v250
v_accvgpr_write_b32 a225,v251
v_accvgpr_read_b32 v250,a226
v_accvgpr_read_b32 v251,a227
v_mul_f32 v250,v250,v249
v_mul_f32 v251,v251,v249
v_accvgpr_write_b32 a226,v250
v_accvgpr_write_b32 a227,v251
v_accvgpr_read_b32 v250,a240
v_accvgpr_read_b32 v251,a241
v_mul_f32 v250,v250,v249
v_mul_f32 v251,v251,v249
v_accvgpr_write_b32 a240,v250
v_accvgpr_write_b32 a241,v251
v_accvgpr_read_b32 v250,a242
v_accvgpr_read_b32 v251,a243
v_mul_f32 v250,v250,v249
v_mul_f32 v251,v251,v249
v_accvgpr_write_b32 a242,v250
v_accvgpr_write_b32 a243,v251
v_exp_f32 v128,v128
v_exp_f32 v129,v129
v_exp_f32 v130,v130
v_exp_f32 v131,v131
v_exp_f32 v144,v144
v_exp_f32 v145,v145
v_exp_f32 v146,v146
v_exp_f32 v147,v147
v_add_f32 v244,v128,v129
v_add_f32 v244,v244,v130
v_add_f32 v244,v244,v131
v_add_f32 v244,v244,v144
v_add_f32 v244,v244,v145
v_add_f32 v244,v244,v146
v_add_f32 v244,v244,v147
v_cvt_pk_bf16_f32 v160,v128,v129
v_cvt_pk_bf16_f32 v161,v130,v131
v_cvt_pk_bf16_f32 v162,v144,v145
v_cvt_pk_bf16_f32 v163,v146,v147
v_max3_f32 v248,v132,v133,v134
v_max3_f32 v248,v248,v135,v148
v_max3_f32 v248,v248,v149,v150
v_max_f32 v248,v248,v151
v_mov_b32 v249,v248
s_nop 1
v_permlane32_swap_b32 v249,v248
v_max_f32 v248,v249,v248
v_mov_b32 v249,v248
s_nop 1
v_permlane16_swap_b32 v249,v248
v_max_f32 v248,v249,v248
v_max_f32 v248,0,v248
v_sub_f32 v249,0,v248
v_exp_f32 v249,v249
v_sub_f32 v132,v132,v248
v_sub_f32 v133,v133,v248
v_sub_f32 v134,v134,v248
v_sub_f32 v135,v135,v248
v_sub_f32 v148,v148,v248
v_sub_f32 v149,v149,v248
v_sub_f32 v150,v150,v248
v_sub_f32 v151,v151,v248
v_sub_f32 v196,v196,v248
v_sub_f32 v197,v197,v248
v_sub_f32 v198,v198,v248
v_sub_f32 v199,v199,v248
v_mul_f32 v241,v241,v249
v_accvgpr_read_b32 v250,a4
v_accvgpr_read_b32 v251,a5
v_mul_f32 v250,v250,v249
v_mul_f32 v251,v251,v249
v_accvgpr_write_b32 a4,v250
v_accvgpr_write_b32 a5,v251
v_accvgpr_read_b32 v250,a6
v_accvgpr_read_b32 v251,a7
v_mul_f32 v250,v250,v249
v_mul_f32 v251,v251,v249
v_accvgpr_write_b32 a6,v250
v_accvgpr_write_b32 a7,v251
v_accvgpr_read_b32 v250,a20
v_accvgpr_read_b32 v251,a21
v_mul_f32 v250,v250,v249
v_mul_f32 v251,v251,v249
v_accvgpr_write_b32 a20,v250
v_accvgpr_write_b32 a21,v251
v_accvgpr_read_b32 v250,a22
v_accvgpr_read_b32 v251,a23
v_mul_f32 v250,v250,v249
v_mul_f32 v251,v251,v249
v_accvgpr_write_b32 a22,v250
v_accvgpr_write_b32 a23,v251
v_accvgpr_read_b32 v250,a36
v_accvgpr_read_b32 v251,a37
v_mul_f32 v250,v250,v249
v_mul_f32 v251,v251,v249
v_accvgpr_write_b32 a36,v250
v_accvgpr_write_b32 a37,v251
v_accvgpr_read_b32 v250,a38
v_accvgpr_read_b32 v251,a39
v_mul_f32 v250,v250,v249
v_mul_f32 v251,v251,v249
v_accvgpr_write_b32 a38,v250
v_accvgpr_write_b32 a39,v251
v_accvgpr_read_b32 v250,a52
v_accvgpr_read_b32 v251,a53
v_mul_f32 v250,v250,v249
v_mul_f32 v251,v251,v249
v_accvgpr_write_b32 a52,v250
v_accvgpr_write_b32 a53,v251
v_accvgpr_read_b32 v250,a54
v_accvgpr_read_b32 v251,a55
v_mul_f32 v250,v250,v249
v_mul_f32 v251,v251,v249
v_accvgpr_write_b32 a54,v250
v_accvgpr_write_b32 a55,v251
v_accvgpr_read_b32 v250,a68
v_accvgpr_read_b32 v251,a69
v_mul_f32 v250,v250,v249
v_mul_f32 v251,v251,v249
v_accvgpr_write_b32 a68,v250
v_accvgpr_write_b32 a69,v251
v_accvgpr_read_b32 v250,a70
v_accvgpr_read_b32 v251,a71
v_mul_f32 v250,v250,v249
v_mul_f32 v251,v251,v249
v_accvgpr_write_b32 a70,v250
v_accvgpr_write_b32 a71,v251
v_accvgpr_read_b32 v250,a84
v_accvgpr_read_b32 v251,a85
v_mul_f32 v250,v250,v249
v_mul_f32 v251,v251,v249
v_accvgpr_write_b32 a84,v250
v_accvgpr_write_b32 a85,v251
v_accvgpr_read_b32 v250,a86
v_accvgpr_read_b32 v251,a87
v_mul_f32 v250,v250,v249
v_mul_f32 v251,v251,v249
v_accvgpr_write_b32 a86,v250
v_accvgpr_write_b32 a87,v251
v_accvgpr_read_b32 v250,a100
v_accvgpr_read_b32 v251,a101
v_mul_f32 v250,v250,v249
v_mul_f32 v251,v251,v249
v_accvgpr_write_b32 a100,v250
v_accvgpr_write_b32 a101,v251
v_accvgpr_read_b32 v250,a102
v_accvgpr_read_b32 v251,a103
v_mul_f32 v250,v250,v249
v_mul_f32 v251,v251,v249
v_accvgpr_write_b32 a102,v250
v_accvgpr_write_b32 a103,v251
v_accvgpr_read_b32 v250,a116
v_accvgpr_read_b32 v251,a117
v_mul_f32 v250,v250,v249
v_mul_f32 v251,v251,v249
v_accvgpr_write_b32 a116,v250
v_accvgpr_write_b32 a117,v251
v_accvgpr_read_b32 v250,a118
v_accvgpr_read_b32 v251,a119
v_mul_f32 v250,v250,v249
v_mul_f32 v251,v251,v249
v_accvgpr_write_b32 a118,v250
v_accvgpr_write_b32 a119,v251
v_accvgpr_read_b32 v250,a132
v_accvgpr_read_b32 v251,a133
v_mul_f32 v250,v250,v249
v_mul_f32 v251,v251,v249
v_accvgpr_write_b32 a132,v250
v_accvgpr_write_b32 a133,v251
v_accvgpr_read_b32 v250,a134
v_accvgpr_read_b32 v251,a135
v_mul_f32 v250,v250,v249
v_mul_f32 v251,v251,v249
v_accvgpr_write_b32 a134,v250
v_accvgpr_write_b32 a135,v251
v_accvgpr_read_b32 v250,a148
v_accvgpr_read_b32 v251,a149
v_mul_f32 v250,v250,v249
v_mul_f32 v251,v251,v249
v_accvgpr_write_b32 a148,v250
v_accvgpr_write_b32 a149,v251
v_accvgpr_read_b32 v250,a150
v_accvgpr_read_b32 v251,a151
v_mul_f32 v250,v250,v249
v_mul_f32 v251,v251,v249
v_accvgpr_write_b32 a150,v250
v_accvgpr_write_b32 a151,v251
v_accvgpr_read_b32 v250,a164
v_accvgpr_read_b32 v251,a165
v_mul_f32 v250,v250,v249
v_mul_f32 v251,v251,v249
v_accvgpr_write_b32 a164,v250
v_accvgpr_write_b32 a165,v251
v_accvgpr_read_b32 v250,a166
v_accvgpr_read_b32 v251,a167
v_mul_f32 v250,v250,v249
v_mul_f32 v251,v251,v249
v_accvgpr_write_b32 a166,v250
v_accvgpr_write_b32 a167,v251
v_accvgpr_read_b32 v250,a180
v_accvgpr_read_b32 v251,a181
v_mul_f32 v250,v250,v249
v_mul_f32 v251,v251,v249
v_accvgpr_write_b32 a180,v250
v_accvgpr_write_b32 a181,v251
v_accvgpr_read_b32 v250,a182
v_accvgpr_read_b32 v251,a183
v_mul_f32 v250,v250,v249
v_mul_f32 v251,v251,v249
v_accvgpr_write_b32 a182,v250
v_accvgpr_write_b32 a183,v251
v_accvgpr_read_b32 v250,a196
v_accvgpr_read_b32 v251,a197
v_mul_f32 v250,v250,v249
v_mul_f32 v251,v251,v249
v_accvgpr_write_b32 a196,v250
v_accvgpr_write_b32 a197,v251
v_accvgpr_read_b32 v250,a198
v_accvgpr_read_b32 v251,a199
v_mul_f32 v250,v250,v249
v_mul_f32 v251,v251,v249
v_accvgpr_write_b32 a198,v250
v_accvgpr_write_b32 a199,v251
v_accvgpr_read_b32 v250,a212
v_accvgpr_read_b32 v251,a213
v_mul_f32 v250,v250,v249
v_mul_f32 v251,v251,v249
v_accvgpr_write_b32 a212,v250
v_accvgpr_write_b32 a213,v251
v_accvgpr_read_b32 v250,a214
v_accvgpr_read_b32 v251,a215
v_mul_f32 v250,v250,v249
v_mul_f32 v251,v251,v249
v_accvgpr_write_b32 a214,v250
v_accvgpr_write_b32 a215,v251
v_accvgpr_read_b32 v250,a228
v_accvgpr_read_b32 v251,a229
v_mul_f32 v250,v250,v249
v_mul_f32 v251,v251,v249
v_accvgpr_write_b32 a228,v250
v_accvgpr_write_b32 a229,v251
v_accvgpr_read_b32 v250,a230
v_accvgpr_read_b32 v251,a231
v_mul_f32 v250,v250,v249
v_mul_f32 v251,v251,v249
v_accvgpr_write_b32 a230,v250
v_accvgpr_write_b32 a231,v251
v_accvgpr_read_b32 v250,a244
v_accvgpr_read_b32 v251,a245
v_mul_f32 v250,v250,v249
v_mul_f32 v251,v251,v249
v_accvgpr_write_b32 a244,v250
v_accvgpr_write_b32 a245,v251
v_accvgpr_read_b32 v250,a246
v_accvgpr_read_b32 v251,a247
v_mul_f32 v250,v250,v249
v_mul_f32 v251,v251,v249
v_accvgpr_write_b32 a246,v250
v_accvgpr_write_b32 a247,v251
v_exp_f32 v132,v132
v_exp_f32 v133,v133
v_exp_f32 v134,v134
v_exp_f32 v135,v135
v_exp_f32 v148,v148
v_exp_f32 v149,v149
v_exp_f32 v150,v150
v_exp_f32 v151,v151
v_add_f32 v245,v132,v133
v_add_f32 v245,v245,v134
v_add_f32 v245,v245,v135
v_add_f32 v245,v245,v148
v_add_f32 v245,v245,v149
v_add_f32 v245,v245,v150
v_add_f32 v245,v245,v151
v_cvt_pk_bf16_f32 v164,v132,v133
v_cvt_pk_bf16_f32 v165,v134,v135
v_cvt_pk_bf16_f32 v166,v148,v149
v_cvt_pk_bf16_f32 v167,v150,v151
v_max3_f32 v248,v136,v137,v138
v_max3_f32 v248,v248,v139,v152
v_max3_f32 v248,v248,v153,v154
v_max_f32 v248,v248,v155
v_mov_b32 v249,v248
s_nop 1
v_permlane32_swap_b32 v249,v248
v_max_f32 v248,v249,v248
v_mov_b32 v249,v248
s_nop 1
v_permlane16_swap_b32 v249,v248
v_max_f32 v248,v249,v248
v_max_f32 v248,0,v248
v_sub_f32 v249,0,v248
v_exp_f32 v249,v249
v_sub_f32 v136,v136,v248
v_sub_f32 v137,v137,v248
v_sub_f32 v138,v138,v248
v_sub_f32 v139,v139,v248
v_sub_f32 v152,v152,v248
v_sub_f32 v153,v153,v248
v_sub_f32 v154,v154,v248
v_sub_f32 v155,v155,v248
v_sub_f32 v200,v200,v248
v_sub_f32 v201,v201,v248
v_sub_f32 v202,v202,v248
v_sub_f32 v203,v203,v248
v_mul_f32 v242,v242,v249
v_accvgpr_read_b32 v250,a8
v_accvgpr_read_b32 v251,a9
v_mul_f32 v250,v250,v249
v_mul_f32 v251,v251,v249
v_accvgpr_write_b32 a8,v250
v_accvgpr_write_b32 a9,v251
v_accvgpr_read_b32 v250,a10
v_accvgpr_read_b32 v251,a11
v_mul_f32 v250,v250,v249
v_mul_f32 v251,v251,v249
v_accvgpr_write_b32 a10,v250
v_accvgpr_write_b32 a11,v251
v_accvgpr_read_b32 v250,a24
v_accvgpr_read_b32 v251,a25
v_mul_f32 v250,v250,v249
v_mul_f32 v251,v251,v249
v_accvgpr_write_b32 a24,v250
v_accvgpr_write_b32 a25,v251
v_accvgpr_read_b32 v250,a26
v_accvgpr_read_b32 v251,a27
v_mul_f32 v250,v250,v249
v_mul_f32 v251,v251,v249
v_accvgpr_write_b32 a26,v250
v_accvgpr_write_b32 a27,v251
v_accvgpr_read_b32 v250,a40
v_accvgpr_read_b32 v251,a41
v_mul_f32 v250,v250,v249
v_mul_f32 v251,v251,v249
v_accvgpr_write_b32 a40,v250
v_accvgpr_write_b32 a41,v251
v_accvgpr_read_b32 v250,a42
v_accvgpr_read_b32 v251,a43
v_mul_f32 v250,v250,v249
v_mul_f32 v251,v251,v249
v_accvgpr_write_b32 a42,v250
v_accvgpr_write_b32 a43,v251
v_accvgpr_read_b32 v250,a56
v_accvgpr_read_b32 v251,a57
v_mul_f32 v250,v250,v249
v_mul_f32 v251,v251,v249
v_accvgpr_write_b32 a56,v250
v_accvgpr_write_b32 a57,v251
v_accvgpr_read_b32 v250,a58
v_accvgpr_read_b32 v251,a59
v_mul_f32 v250,v250,v249
v_mul_f32 v251,v251,v249
v_accvgpr_write_b32 a58,v250
v_accvgpr_write_b32 a59,v251
v_accvgpr_read_b32 v250,a72
v_accvgpr_read_b32 v251,a73
v_mul_f32 v250,v250,v249
v_mul_f32 v251,v251,v249
v_accvgpr_write_b32 a72,v250
v_accvgpr_write_b32 a73,v251
v_accvgpr_read_b32 v250,a74
v_accvgpr_read_b32 v251,a75
v_mul_f32 v250,v250,v249
v_mul_f32 v251,v251,v249
v_accvgpr_write_b32 a74,v250
v_accvgpr_write_b32 a75,v251
v_accvgpr_read_b32 v250,a88
v_accvgpr_read_b32 v251,a89
v_mul_f32 v250,v250,v249
v_mul_f32 v251,v251,v249
v_accvgpr_write_b32 a88,v250
v_accvgpr_write_b32 a89,v251
v_accvgpr_read_b32 v250,a90
v_accvgpr_read_b32 v251,a91
v_mul_f32 v250,v250,v249
v_mul_f32 v251,v251,v249
v_accvgpr_write_b32 a90,v250
v_accvgpr_write_b32 a91,v251
v_accvgpr_read_b32 v250,a104
v_accvgpr_read_b32 v251,a105
v_mul_f32 v250,v250,v249
v_mul_f32 v251,v251,v249
v_accvgpr_write_b32 a104,v250
v_accvgpr_write_b32 a105,v251
v_accvgpr_read_b32 v250,a106
v_accvgpr_read_b32 v251,a107
v_mul_f32 v250,v250,v249
v_mul_f32 v251,v251,v249
v_accvgpr_write_b32 a106,v250
v_accvgpr_write_b32 a107,v251
v_accvgpr_read_b32 v250,a120
v_accvgpr_read_b32 v251,a121
v_mul_f32 v250,v250,v249
v_mul_f32 v251,v251,v249
v_accvgpr_write_b32 a120,v250
v_accvgpr_write_b32 a121,v251
v_accvgpr_read_b32 v250,a122
v_accvgpr_read_b32 v251,a123
v_mul_f32 v250,v250,v249
v_mul_f32 v251,v251,v249
v_accvgpr_write_b32 a122,v250
v_accvgpr_write_b32 a123,v251
v_accvgpr_read_b32 v250,a136
v_accvgpr_read_b32 v251,a137
v_mul_f32 v250,v250,v249
v_mul_f32 v251,v251,v249
v_accvgpr_write_b32 a136,v250
v_accvgpr_write_b32 a137,v251
v_accvgpr_read_b32 v250,a138
v_accvgpr_read_b32 v251,a139
v_mul_f32 v250,v250,v249
v_mul_f32 v251,v251,v249
v_accvgpr_write_b32 a138,v250
v_accvgpr_write_b32 a139,v251
v_accvgpr_read_b32 v250,a152
v_accvgpr_read_b32 v251,a153
v_mul_f32 v250,v250,v249
v_mul_f32 v251,v251,v249
v_accvgpr_write_b32 a152,v250
v_accvgpr_write_b32 a153,v251
v_accvgpr_read_b32 v250,a154
v_accvgpr_read_b32 v251,a155
v_mul_f32 v250,v250,v249
v_mul_f32 v251,v251,v249
v_accvgpr_write_b32 a154,v250
v_accvgpr_write_b32 a155,v251
v_accvgpr_read_b32 v250,a168
v_accvgpr_read_b32 v251,a169
v_mul_f32 v250,v250,v249
v_mul_f32 v251,v251,v249
v_accvgpr_write_b32 a168,v250
v_accvgpr_write_b32 a169,v251
v_accvgpr_read_b32 v250,a170
v_accvgpr_read_b32 v251,a171
v_mul_f32 v250,v250,v249
v_mul_f32 v251,v251,v249
v_accvgpr_write_b32 a170,v250
v_accvgpr_write_b32 a171,v251
v_accvgpr_read_b32 v250,a184
v_accvgpr_read_b32 v251,a185
v_mul_f32 v250,v250,v249
v_mul_f32 v251,v251,v249
v_accvgpr_write_b32 a184,v250
v_accvgpr_write_b32 a185,v251
v_accvgpr_read_b32 v250,a186
v_accvgpr_read_b32 v251,a187
v_mul_f32 v250,v250,v249
v_mul_f32 v251,v251,v249
v_accvgpr_write_b32 a186,v250
v_accvgpr_write_b32 a187,v251
v_accvgpr_read_b32 v250,a200
v_accvgpr_read_b32 v251,a201
v_mul_f32 v250,v250,v249
v_mul_f32 v251,v251,v249
v_accvgpr_write_b32 a200,v250
v_accvgpr_write_b32 a201,v251
v_accvgpr_read_b32 v250,a202
v_accvgpr_read_b32 v251,a203
v_mul_f32 v250,v250,v249
v_mul_f32 v251,v251,v249
v_accvgpr_write_b32 a202,v250
v_accvgpr_write_b32 a203,v251
v_accvgpr_read_b32 v250,a216
v_accvgpr_read_b32 v251,a217
v_mul_f32 v250,v250,v249
v_mul_f32 v251,v251,v249
v_accvgpr_write_b32 a216,v250
v_accvgpr_write_b32 a217,v251
v_accvgpr_read_b32 v250,a218
v_accvgpr_read_b32 v251,a219
v_mul_f32 v250,v250,v249
v_mul_f32 v251,v251,v249
v_accvgpr_write_b32 a218,v250
v_accvgpr_write_b32 a219,v251
v_accvgpr_read_b32 v250,a232
v_accvgpr_read_b32 v251,a233
v_mul_f32 v250,v250,v249
v_mul_f32 v251,v251,v249
v_accvgpr_write_b32 a232,v250
v_accvgpr_write_b32 a233,v251
v_accvgpr_read_b32 v250,a234
v_accvgpr_read_b32 v251,a235
v_mul_f32 v250,v250,v249
v_mul_f32 v251,v251,v249
v_accvgpr_write_b32 a234,v250
v_accvgpr_write_b32 a235,v251
v_accvgpr_read_b32 v250,a248
v_accvgpr_read_b32 v251,a249
v_mul_f32 v250,v250,v249
v_mul_f32 v251,v251,v249
v_accvgpr_write_b32 a248,v250
v_accvgpr_write_b32 a249,v251
v_accvgpr_read_b32 v250,a250
v_accvgpr_read_b32 v251,a251
v_mul_f32 v250,v250,v249
v_mul_f32 v251,v251,v249
v_accvgpr_write_b32 a250,v250
v_accvgpr_write_b32 a251,v251
v_exp_f32 v136,v136
v_exp_f32 v137,v137
v_exp_f32 v138,v138
v_exp_f32 v139,v139
v_exp_f32 v152,v152
v_exp_f32 v153,v153
v_exp_f32 v154,v154
v_exp_f32 v155,v155
v_add_f32 v246,v136,v137
v_add_f32 v246,v246,v138
v_add_f32 v246,v246,v139
v_add_f32 v246,v246,v152
v_add_f32 v246,v246,v153
v_add_f32 v246,v246,v154
v_add_f32 v246,v246,v155
v_cvt_pk_bf16_f32 v168,v136,v137
v_cvt_pk_bf16_f32 v169,v138,v139
v_cvt_pk_bf16_f32 v170,v152,v153
v_cvt_pk_bf16_f32 v171,v154,v155
v_max3_f32 v248,v140,v141,v142
v_max3_f32 v248,v248,v143,v156
v_max3_f32 v248,v248,v157,v158
v_max_f32 v248,v248,v159
v_mov_b32 v249,v248
s_nop 1
v_permlane32_swap_b32 v249,v248
v_max_f32 v248,v249,v248
v_mov_b32 v249,v248
s_nop 1
v_permlane16_swap_b32 v249,v248
v_max_f32 v248,v249,v248
v_max_f32 v248,0,v248
v_sub_f32 v249,0,v248
v_exp_f32 v249,v249
v_sub_f32 v140,v140,v248
v_sub_f32 v141,v141,v248
v_sub_f32 v142,v142,v248
v_sub_f32 v143,v143,v248
v_sub_f32 v156,v156,v248
v_sub_f32 v157,v157,v248
v_sub_f32 v158,v158,v248
v_sub_f32 v159,v159,v248
v_sub_f32 v204,v204,v248
v_sub_f32 v205,v205,v248
v_sub_f32 v206,v206,v248
v_sub_f32 v207,v207,v248
v_mul_f32 v243,v243,v249
v_accvgpr_read_b32 v250,a12
v_accvgpr_read_b32 v251,a13
v_mul_f32 v250,v250,v249
v_mul_f32 v251,v251,v249
v_accvgpr_write_b32 a12,v250
v_accvgpr_write_b32 a13,v251
v_accvgpr_read_b32 v250,a14
v_accvgpr_read_b32 v251,a15
v_mul_f32 v250,v250,v249
v_mul_f32 v251,v251,v249
v_accvgpr_write_b32 a14,v250
v_accvgpr_write_b32 a15,v251
v_accvgpr_read_b32 v250,a28
v_accvgpr_read_b32 v251,a29
v_mul_f32 v250,v250,v249
v_mul_f32 v251,v251,v249
v_accvgpr_write_b32 a28,v250
v_accvgpr_write_b32 a29,v251
v_accvgpr_read_b32 v250,a30
v_accvgpr_read_b32 v251,a31
v_mul_f32 v250,v250,v249
v_mul_f32 v251,v251,v249
v_accvgpr_write_b32 a30,v250
v_accvgpr_write_b32 a31,v251
v_accvgpr_read_b32 v250,a44
v_accvgpr_read_b32 v251,a45
v_mul_f32 v250,v250,v249
v_mul_f32 v251,v251,v249
v_accvgpr_write_b32 a44,v250
v_accvgpr_write_b32 a45,v251
v_accvgpr_read_b32 v250,a46
v_accvgpr_read_b32 v251,a47
v_mul_f32 v250,v250,v249
v_mul_f32 v251,v251,v249
v_accvgpr_write_b32 a46,v250
v_accvgpr_write_b32 a47,v251
v_accvgpr_read_b32 v250,a60
v_accvgpr_read_b32 v251,a61
v_mul_f32 v250,v250,v249
v_mul_f32 v251,v251,v249
v_accvgpr_write_b32 a60,v250
v_accvgpr_write_b32 a61,v251
v_accvgpr_read_b32 v250,a62
v_accvgpr_read_b32 v251,a63
v_mul_f32 v250,v250,v249
v_mul_f32 v251,v251,v249
v_accvgpr_write_b32 a62,v250
v_accvgpr_write_b32 a63,v251
v_accvgpr_read_b32 v250,a76
v_accvgpr_read_b32 v251,a77
v_mul_f32 v250,v250,v249
v_mul_f32 v251,v251,v249
v_accvgpr_write_b32 a76,v250
v_accvgpr_write_b32 a77,v251
v_accvgpr_read_b32 v250,a78
v_accvgpr_read_b32 v251,a79
v_mul_f32 v250,v250,v249
v_mul_f32 v251,v251,v249
v_accvgpr_write_b32 a78,v250
v_accvgpr_write_b32 a79,v251
v_accvgpr_read_b32 v250,a92
v_accvgpr_read_b32 v251,a93
v_mul_f32 v250,v250,v249
v_mul_f32 v251,v251,v249
v_accvgpr_write_b32 a92,v250
v_accvgpr_write_b32 a93,v251
v_accvgpr_read_b32 v250,a94
v_accvgpr_read_b32 v251,a95
v_mul_f32 v250,v250,v249
v_mul_f32 v251,v251,v249
v_accvgpr_write_b32 a94,v250
v_accvgpr_write_b32 a95,v251
v_accvgpr_read_b32 v250,a108
v_accvgpr_read_b32 v251,a109
v_mul_f32 v250,v250,v249
v_mul_f32 v251,v251,v249
v_accvgpr_write_b32 a108,v250
v_accvgpr_write_b32 a109,v251
v_accvgpr_read_b32 v250,a110
v_accvgpr_read_b32 v251,a111
v_mul_f32 v250,v250,v249
v_mul_f32 v251,v251,v249
v_accvgpr_write_b32 a110,v250
v_accvgpr_write_b32 a111,v251
v_accvgpr_read_b32 v250,a124
v_accvgpr_read_b32 v251,a125
v_mul_f32 v250,v250,v249
v_mul_f32 v251,v251,v249
v_accvgpr_write_b32 a124,v250
v_accvgpr_write_b32 a125,v251
v_accvgpr_read_b32 v250,a126
v_accvgpr_read_b32 v251,a127
v_mul_f32 v250,v250,v249
v_mul_f32 v251,v251,v249
v_accvgpr_write_b32 a126,v250
v_accvgpr_write_b32 a127,v251
v_accvgpr_read_b32 v250,a140
v_accvgpr_read_b32 v251,a141
v_mul_f32 v250,v250,v249
v_mul_f32 v251,v251,v249
v_accvgpr_write_b32 a140,v250
v_accvgpr_write_b32 a141,v251
v_accvgpr_read_b32 v250,a142
v_accvgpr_read_b32 v251,a143
v_mul_f32 v250,v250,v249
v_mul_f32 v251,v251,v249
v_accvgpr_write_b32 a142,v250
v_accvgpr_write_b32 a143,v251
v_accvgpr_read_b32 v250,a156
v_accvgpr_read_b32 v251,a157
v_mul_f32 v250,v250,v249
v_mul_f32 v251,v251,v249
v_accvgpr_write_b32 a156,v250
v_accvgpr_write_b32 a157,v251
v_accvgpr_read_b32 v250,a158
v_accvgpr_read_b32 v251,a159
v_mul_f32 v250,v250,v249
v_mul_f32 v251,v251,v249
v_accvgpr_write_b32 a158,v250
v_accvgpr_write_b32 a159,v251
v_accvgpr_read_b32 v250,a172
v_accvgpr_read_b32 v251,a173
v_mul_f32 v250,v250,v249
v_mul_f32 v251,v251,v249
v_accvgpr_write_b32 a172,v250
v_accvgpr_write_b32 a173,v251
v_accvgpr_read_b32 v250,a174
v_accvgpr_read_b32 v251,a175
v_mul_f32 v250,v250,v249
v_mul_f32 v251,v251,v249
v_accvgpr_write_b32 a174,v250
v_accvgpr_write_b32 a175,v251
v_accvgpr_read_b32 v250,a188
v_accvgpr_read_b32 v251,a189
v_mul_f32 v250,v250,v249
v_mul_f32 v251,v251,v249
v_accvgpr_write_b32 a188,v250
v_accvgpr_write_b32 a189,v251
v_accvgpr_read_b32 v250,a190
v_accvgpr_read_b32 v251,a191
v_mul_f32 v250,v250,v249
v_mul_f32 v251,v251,v249
v_accvgpr_write_b32 a190,v250
v_accvgpr_write_b32 a191,v251
v_accvgpr_read_b32 v250,a204
v_accvgpr_read_b32 v251,a205
v_mul_f32 v250,v250,v249
v_mul_f32 v251,v251,v249
v_accvgpr_write_b32 a204,v250
v_accvgpr_write_b32 a205,v251
v_accvgpr_read_b32 v250,a206
v_accvgpr_read_b32 v251,a207
v_mul_f32 v250,v250,v249
v_mul_f32 v251,v251,v249
v_accvgpr_write_b32 a206,v250
v_accvgpr_write_b32 a207,v251
v_accvgpr_read_b32 v250,a220
v_accvgpr_read_b32 v251,a221
v_mul_f32 v250,v250,v249
v_mul_f32 v251,v251,v249
v_accvgpr_write_b32 a220,v250
v_accvgpr_write_b32 a221,v251
v_accvgpr_read_b32 v250,a222
v_accvgpr_read_b32 v251,a223
v_mul_f32 v250,v250,v249
v_mul_f32 v251,v251,v249
v_accvgpr_write_b32 a222,v250
v_accvgpr_write_b32 a223,v251
v_accvgpr_read_b32 v250,a236
v_accvgpr_read_b32 v251,a237
v_mul_f32 v250,v250,v249
v_mul_f32 v251,v251,v249
v_accvgpr_write_b32 a236,v250
v_accvgpr_write_b32 a237,v251
v_accvgpr_read_b32 v250,a238
v_accvgpr_read_b32 v251,a239
v_mul_f32 v250,v250,v249
v_mul_f32 v251,v251,v249
v_accvgpr_write_b32 a238,v250
v_accvgpr_write_b32 a239,v251
v_accvgpr_read_b32 v250,a252
v_accvgpr_read_b32 v251,a253
v_mul_f32 v250,v250,v249
v_mul_f32 v251,v251,v249
v_accvgpr_write_b32 a252,v250
v_accvgpr_write_b32 a253,v251
v_accvgpr_read_b32 v250,a254
v_accvgpr_read_b32 v251,a255
v_mul_f32 v250,v250,v249
v_mul_f32 v251,v251,v249
v_accvgpr_write_b32 a254,v250
v_accvgpr_write_b32 a255,v251
v_exp_f32 v140,v140
v_exp_f32 v141,v141
v_exp_f32 v142,v142
v_exp_f32 v143,v143
v_exp_f32 v156,v156
v_exp_f32 v157,v157
v_exp_f32 v158,v158
v_exp_f32 v159,v159
v_add_f32 v247,v140,v141
v_add_f32 v247,v247,v142
v_add_f32 v247,v247,v143
v_add_f32 v247,v247,v156
v_add_f32 v247,v247,v157
v_add_f32 v247,v247,v158
v_add_f32 v247,v247,v159
v_cvt_pk_bf16_f32 v172,v140,v141
v_cvt_pk_bf16_f32 v173,v142,v143
v_cvt_pk_bf16_f32 v174,v156,v157
v_cvt_pk_bf16_f32 v175,v158,v159
s_nop 3
s_setpc_b64 s[42:43]
L_fb1:
s_nop 7
s_nop 7
v_max3_f32 v248,v128,v129,v130
v_max3_f32 v248,v248,v131,v144
v_max3_f32 v248,v248,v145,v146
v_max_f32 v248,v248,v147
v_mov_b32 v249,v248
s_nop 1
v_permlane32_swap_b32 v249,v248
v_max_f32 v248,v249,v248
v_mov_b32 v249,v248
s_nop 1
v_permlane16_swap_b32 v249,v248
v_max_f32 v248,v249,v248
v_max_f32 v248,0,v248
v_sub_f32 v249,0,v248
v_exp_f32 v249,v249
v_sub_f32 v128,v128,v248
v_sub_f32 v129,v129,v248
v_sub_f32 v130,v130,v248
v_sub_f32 v131,v131,v248
v_sub_f32 v144,v144,v248
v_sub_f32 v145,v145,v248
v_sub_f32 v146,v146,v248
v_sub_f32 v147,v147,v248
v_sub_f32 v192,v192,v248
v_sub_f32 v193,v193,v248
v_sub_f32 v194,v194,v248
v_sub_f32 v195,v195,v248
v_mul_f32 v240,v240,v249
v_accvgpr_read_b32 v250,a0
v_accvgpr_read_b32 v251,a1
v_mul_f32 v250,v250,v249
v_mul_f32 v251,v251,v249
v_accvgpr_write_b32 a0,v250
v_accvgpr_write_b32 a1,v251
v_accvgpr_read_b32 v250,a2
v_accvgpr_read_b32 v251,a3
v_mul_f32 v250,v250,v249
v_mul_f32 v251,v251,v249
v_accvgpr_write_b32 a2,v250
v_accvgpr_write_b32 a3,v251
v_accvgpr_read_b32 v250,a16
v_accvgpr_read_b32 v251,a17
v_mul_f32 v250,v250,v249
v_mul_f32 v251,v251,v249
v_accvgpr_write_b32 a16,v250
v_accvgpr_write_b32 a17,v251
v_accvgpr_read_b32 v250,a18
v_accvgpr_read_b32 v251,a19
v_mul_f32 v250,v250,v249
v_mul_f32 v251,v251,v249
v_accvgpr_write_b32 a18,v250
v_accvgpr_write_b32 a19,v251
v_accvgpr_read_b32 v250,a32
v_accvgpr_read_b32 v251,a33
v_mul_f32 v250,v250,v249
v_mul_f32 v251,v251,v249
v_accvgpr_write_b32 a32,v250
v_accvgpr_write_b32 a33,v251
v_accvgpr_read_b32 v250,a34
v_accvgpr_read_b32 v251,a35
v_mul_f32 v250,v250,v249
v_mul_f32 v251,v251,v249
v_accvgpr_write_b32 a34,v250
v_accvgpr_write_b32 a35,v251
v_accvgpr_read_b32 v250,a48
v_accvgpr_read_b32 v251,a49
v_mul_f32 v250,v250,v249
v_mul_f32 v251,v251,v249
v_accvgpr_write_b32 a48,v250
v_accvgpr_write_b32 a49,v251
v_accvgpr_read_b32 v250,a50
v_accvgpr_read_b32 v251,a51
v_mul_f32 v250,v250,v249
v_mul_f32 v251,v251,v249
v_accvgpr_write_b32 a50,v250
v_accvgpr_write_b32 a51,v251
v_accvgpr_read_b32 v250,a64
v_accvgpr_read_b32 v251,a65
v_mul_f32 v250,v250,v249
v_mul_f32 v251,v251,v249
v_accvgpr_write_b32 a64,v250
v_accvgpr_write_b32 a65,v251
v_accvgpr_read_b32 v250,a66
v_accvgpr_read_b32 v251,a67
v_mul_f32 v250,v250,v249
v_mul_f32 v251,v251,v249
v_accvgpr_write_b32 a66,v250
v_accvgpr_write_b32 a67,v251
v_accvgpr_read_b32 v250,a80
v_accvgpr_read_b32 v251,a81
v_mul_f32 v250,v250,v249
v_mul_f32 v251,v251,v249
v_accvgpr_write_b32 a80,v250
v_accvgpr_write_b32 a81,v251
v_accvgpr_read_b32 v250,a82
v_accvgpr_read_b32 v251,a83
v_mul_f32 v250,v250,v249
v_mul_f32 v251,v251,v249
v_accvgpr_write_b32 a82,v250
v_accvgpr_write_b32 a83,v251
v_accvgpr_read_b32 v250,a96
v_accvgpr_read_b32 v251,a97
v_mul_f32 v250,v250,v249
v_mul_f32 v251,v251,v249
v_accvgpr_write_b32 a96,v250
v_accvgpr_write_b32 a97,v251
v_accvgpr_read_b32 v250,a98
v_accvgpr_read_b32 v251,a99
v_mul_f32 v250,v250,v249
v_mul_f32 v251,v251,v249
v_accvgpr_write_b32 a98,v250
v_accvgpr_write_b32 a99,v251
v_accvgpr_read_b32 v250,a112
v_accvgpr_read_b32 v251,a113
v_mul_f32 v250,v250,v249
v_mul_f32 v251,v251,v249
v_accvgpr_write_b32 a112,v250
v_accvgpr_write_b32 a113,v251
v_accvgpr_read_b32 v250,a114
v_accvgpr_read_b32 v251,a115
v_mul_f32 v250,v250,v249
v_mul_f32 v251,v251,v249
v_accvgpr_write_b32 a114,v250
v_accvgpr_write_b32 a115,v251
v_accvgpr_read_b32 v250,a128
v_accvgpr_read_b32 v251,a129
v_mul_f32 v250,v250,v249
v_mul_f32 v251,v251,v249
v_accvgpr_write_b32 a128,v250
v_accvgpr_write_b32 a129,v251
v_accvgpr_read_b32 v250,a130
v_accvgpr_read_b32 v251,a131
v_mul_f32 v250,v250,v249
v_mul_f32 v251,v251,v249
v_accvgpr_write_b32 a130,v250
v_accvgpr_write_b32 a131,v251
v_accvgpr_read_b32 v250,a144
v_accvgpr_read_b32 v251,a145
v_mul_f32 v250,v250,v249
v_mul_f32 v251,v251,v249
v_accvgpr_write_b32 a144,v250
v_accvgpr_write_b32 a145,v251
v_accvgpr_read_b32 v250,a146
v_accvgpr_read_b32 v251,a147
v_mul_f32 v250,v250,v249
v_mul_f32 v251,v251,v249
v_accvgpr_write_b32 a146,v250
v_accvgpr_write_b32 a147,v251
v_accvgpr_read_b32 v250,a160
v_accvgpr_read_b32 v251,a161
v_mul_f32 v250,v250,v249
v_mul_f32 v251,v251,v249
v_accvgpr_write_b32 a160,v250
v_accvgpr_write_b32 a161,v251
v_accvgpr_read_b32 v250,a162
v_accvgpr_read_b32 v251,a163
v_mul_f32 v250,v250,v249
v_mul_f32 v251,v251,v249
v_accvgpr_write_b32 a162,v250
v_accvgpr_write_b32 a163,v251
v_accvgpr_read_b32 v250,a176
v_accvgpr_read_b32 v251,a177
v_mul_f32 v250,v250,v249
v_mul_f32 v251,v251,v249
v_accvgpr_write_b32 a176,v250
v_accvgpr_write_b32 a177,v251
v_accvgpr_read_b32 v250,a178
v_accvgpr_read_b32 v251,a179
v_mul_f32 v250,v250,v249
v_mul_f32 v251,v251,v249
v_accvgpr_write_b32 a178,v250
v_accvgpr_write_b32 a179,v251
v_accvgpr_read_b32 v250,a192
v_accvgpr_read_b32 v251,a193
v_mul_f32 v250,v250,v249
v_mul_f32 v251,v251,v249
v_accvgpr_write_b32 a192,v250
v_accvgpr_write_b32 a193,v251
v_accvgpr_read_b32 v250,a194
v_accvgpr_read_b32 v251,a195
v_mul_f32 v250,v250,v249
v_mul_f32 v251,v251,v249
v_accvgpr_write_b32 a194,v250
v_accvgpr_write_b32 a195,v251
v_accvgpr_read_b32 v250,a208
v_accvgpr_read_b32 v251,a209
v_mul_f32 v250,v250,v249
v_mul_f32 v251,v251,v249
v_accvgpr_write_b32 a208,v250
v_accvgpr_write_b32 a209,v251
v_accvgpr_read_b32 v250,a210
v_accvgpr_read_b32 v251,a211
v_mul_f32 v250,v250,v249
v_mul_f32 v251,v251,v249
v_accvgpr_write_b32 a210,v250
v_accvgpr_write_b32 a211,v251
v_accvgpr_read_b32 v250,a224
v_accvgpr_read_b32 v251,a225
v_mul_f32 v250,v250,v249
v_mul_f32 v251,v251,v249
v_accvgpr_write_b32 a224,v250
v_accvgpr_write_b32 a225,v251
v_accvgpr_read_b32 v250,a226
v_accvgpr_read_b32 v251,a227
v_mul_f32 v250,v250,v249
v_mul_f32 v251,v251,v249
v_accvgpr_write_b32 a226,v250
v_accvgpr_write_b32 a227,v251
v_accvgpr_read_b32 v250,a240
v_accvgpr_read_b32 v251,a241
v_mul_f32 v250,v250,v249
v_mul_f32 v251,v251,v249
v_accvgpr_write_b32 a240,v250
v_accvgpr_write_b32 a241,v251
v_accvgpr_read_b32 v250,a242
v_accvgpr_read_b32 v251,a243
v_mul_f32 v250,v250,v249
v_mul_f32 v251,v251,v249
v_accvgpr_write_b32 a242,v250
v_accvgpr_write_b32 a243,v251
v_exp_f32 v128,v128
v_exp_f32 v129,v129
v_exp_f32 v130,v130
v_exp_f32 v131,v131
v_exp_f32 v144,v144
v_exp_f32 v145,v145
v_exp_f32 v146,v146
v_exp_f32 v147,v147
v_add_f32 v244,v128,v129
v_add_f32 v244,v244,v130
v_add_f32 v244,v244,v131
v_add_f32 v244,v244,v144
v_add_f32 v244,v244,v145
v_add_f32 v244,v244,v146
v_add_f32 v244,v244,v147
v_cvt_pk_bf16_f32 v176,v128,v129
v_cvt_pk_bf16_f32 v177,v130,v131
v_cvt_pk_bf16_f32 v178,v144,v145
v_cvt_pk_bf16_f32 v179,v146,v147
v_max3_f32 v248,v132,v133,v134
v_max3_f32 v248,v248,v135,v148
v_max3_f32 v248,v248,v149,v150
v_max_f32 v248,v248,v151
v_mov_b32 v249,v248
s_nop 1
v_permlane32_swap_b32 v249,v248
v_max_f32 v248,v249,v248
v_mov_b32 v249,v248
s_nop 1
v_permlane16_swap_b32 v249,v248
v_max_f32 v248,v249,v248
v_max_f32 v248,0,v248
v_sub_f32 v249,0,v248
v_exp_f32 v249,v249
v_sub_f32 v132,v132,v248
v_sub_f32 v133,v133,v248
v_sub_f32 v134,v134,v248
v_sub_f32 v135,v135,v248
v_sub_f32 v148,v148,v248
v_sub_f32 v149,v149,v248
v_sub_f32 v150,v150,v248
v_sub_f32 v151,v151,v248
v_sub_f32 v196,v196,v248
v_sub_f32 v197,v197,v248
v_sub_f32 v198,v198,v248
v_sub_f32 v199,v199,v248
v_mul_f32 v241,v241,v249
v_accvgpr_read_b32 v250,a4
v_accvgpr_read_b32 v251,a5
v_mul_f32 v250,v250,v249
v_mul_f32 v251,v251,v249
v_accvgpr_write_b32 a4,v250
v_accvgpr_write_b32 a5,v251
v_accvgpr_read_b32 v250,a6
v_accvgpr_read_b32 v251,a7
v_mul_f32 v250,v250,v249
v_mul_f32 v251,v251,v249
v_accvgpr_write_b32 a6,v250
v_accvgpr_write_b32 a7,v251
v_accvgpr_read_b32 v250,a20
v_accvgpr_read_b32 v251,a21
v_mul_f32 v250,v250,v249
v_mul_f32 v251,v251,v249
v_accvgpr_write_b32 a20,v250
v_accvgpr_write_b32 a21,v251
v_accvgpr_read_b32 v250,a22
v_accvgpr_read_b32 v251,a23
v_mul_f32 v250,v250,v249
v_mul_f32 v251,v251,v249
v_accvgpr_write_b32 a22,v250
v_accvgpr_write_b32 a23,v251
v_accvgpr_read_b32 v250,a36
v_accvgpr_read_b32 v251,a37
v_mul_f32 v250,v250,v249
v_mul_f32 v251,v251,v249
v_accvgpr_write_b32 a36,v250
v_accvgpr_write_b32 a37,v251
v_accvgpr_read_b32 v250,a38
v_accvgpr_read_b32 v251,a39
v_mul_f32 v250,v250,v249
v_mul_f32 v251,v251,v249
v_accvgpr_write_b32 a38,v250
v_accvgpr_write_b32 a39,v251
v_accvgpr_read_b32 v250,a52
v_accvgpr_read_b32 v251,a53
v_mul_f32 v250,v250,v249
v_mul_f32 v251,v251,v249
v_accvgpr_write_b32 a52,v250
v_accvgpr_write_b32 a53,v251
v_accvgpr_read_b32 v250,a54
v_accvgpr_read_b32 v251,a55
v_mul_f32 v250,v250,v249
v_mul_f32 v251,v251,v249
v_accvgpr_write_b32 a54,v250
v_accvgpr_write_b32 a55,v251
v_accvgpr_read_b32 v250,a68
v_accvgpr_read_b32 v251,a69
v_mul_f32 v250,v250,v249
v_mul_f32 v251,v251,v249
v_accvgpr_write_b32 a68,v250
v_accvgpr_write_b32 a69,v251
v_accvgpr_read_b32 v250,a70
v_accvgpr_read_b32 v251,a71
v_mul_f32 v250,v250,v249
v_mul_f32 v251,v251,v249
v_accvgpr_write_b32 a70,v250
v_accvgpr_write_b32 a71,v251
v_accvgpr_read_b32 v250,a84
v_accvgpr_read_b32 v251,a85
v_mul_f32 v250,v250,v249
v_mul_f32 v251,v251,v249
v_accvgpr_write_b32 a84,v250
v_accvgpr_write_b32 a85,v251
v_accvgpr_read_b32 v250,a86
v_accvgpr_read_b32 v251,a87
v_mul_f32 v250,v250,v249
v_mul_f32 v251,v251,v249
v_accvgpr_write_b32 a86,v250
v_accvgpr_write_b32 a87,v251
v_accvgpr_read_b32 v250,a100
v_accvgpr_read_b32 v251,a101
v_mul_f32 v250,v250,v249
v_mul_f32 v251,v251,v249
v_accvgpr_write_b32 a100,v250
v_accvgpr_write_b32 a101,v251
v_accvgpr_read_b32 v250,a102
v_accvgpr_read_b32 v251,a103
v_mul_f32 v250,v250,v249
v_mul_f32 v251,v251,v249
v_accvgpr_write_b32 a102,v250
v_accvgpr_write_b32 a103,v251
v_accvgpr_read_b32 v250,a116
v_accvgpr_read_b32 v251,a117
v_mul_f32 v250,v250,v249
v_mul_f32 v251,v251,v249
v_accvgpr_write_b32 a116,v250
v_accvgpr_write_b32 a117,v251
v_accvgpr_read_b32 v250,a118
v_accvgpr_read_b32 v251,a119
v_mul_f32 v250,v250,v249
v_mul_f32 v251,v251,v249
v_accvgpr_write_b32 a118,v250
v_accvgpr_write_b32 a119,v251
v_accvgpr_read_b32 v250,a132
v_accvgpr_read_b32 v251,a133
v_mul_f32 v250,v250,v249
v_mul_f32 v251,v251,v249
v_accvgpr_write_b32 a132,v250
v_accvgpr_write_b32 a133,v251
v_accvgpr_read_b32 v250,a134
v_accvgpr_read_b32 v251,a135
v_mul_f32 v250,v250,v249
v_mul_f32 v251,v251,v249
v_accvgpr_write_b32 a134,v250
v_accvgpr_write_b32 a135,v251
v_accvgpr_read_b32 v250,a148
v_accvgpr_read_b32 v251,a149
v_mul_f32 v250,v250,v249
v_mul_f32 v251,v251,v249
v_accvgpr_write_b32 a148,v250
v_accvgpr_write_b32 a149,v251
v_accvgpr_read_b32 v250,a150
v_accvgpr_read_b32 v251,a151
v_mul_f32 v250,v250,v249
v_mul_f32 v251,v251,v249
v_accvgpr_write_b32 a150,v250
v_accvgpr_write_b32 a151,v251
v_accvgpr_read_b32 v250,a164
v_accvgpr_read_b32 v251,a165
v_mul_f32 v250,v250,v249
v_mul_f32 v251,v251,v249
v_accvgpr_write_b32 a164,v250
v_accvgpr_write_b32 a165,v251
v_accvgpr_read_b32 v250,a166
v_accvgpr_read_b32 v251,a167
v_mul_f32 v250,v250,v249
v_mul_f32 v251,v251,v249
v_accvgpr_write_b32 a166,v250
v_accvgpr_write_b32 a167,v251
v_accvgpr_read_b32 v250,a180
v_accvgpr_read_b32 v251,a181
v_mul_f32 v250,v250,v249
v_mul_f32 v251,v251,v249
v_accvgpr_write_b32 a180,v250
v_accvgpr_write_b32 a181,v251
v_accvgpr_read_b32 v250,a182
v_accvgpr_read_b32 v251,a183
v_mul_f32 v250,v250,v249
v_mul_f32 v251,v251,v249
v_accvgpr_write_b32 a182,v250
v_accvgpr_write_b32 a183,v251
v_accvgpr_read_b32 v250,a196
v_accvgpr_read_b32 v251,a197
v_mul_f32 v250,v250,v249
v_mul_f32 v251,v251,v249
v_accvgpr_write_b32 a196,v250
v_accvgpr_write_b32 a197,v251
v_accvgpr_read_b32 v250,a198
v_accvgpr_read_b32 v251,a199
v_mul_f32 v250,v250,v249
v_mul_f32 v251,v251,v249
v_accvgpr_write_b32 a198,v250
v_accvgpr_write_b32 a199,v251
v_accvgpr_read_b32 v250,a212
v_accvgpr_read_b32 v251,a213
v_mul_f32 v250,v250,v249
v_mul_f32 v251,v251,v249
v_accvgpr_write_b32 a212,v250
v_accvgpr_write_b32 a213,v251
v_accvgpr_read_b32 v250,a214
v_accvgpr_read_b32 v251,a215
v_mul_f32 v250,v250,v249
v_mul_f32 v251,v251,v249
v_accvgpr_write_b32 a214,v250
v_accvgpr_write_b32 a215,v251
v_accvgpr_read_b32 v250,a228
v_accvgpr_read_b32 v251,a229
v_mul_f32 v250,v250,v249
v_mul_f32 v251,v251,v249
v_accvgpr_write_b32 a228,v250
v_accvgpr_write_b32 a229,v251
v_accvgpr_read_b32 v250,a230
v_accvgpr_read_b32 v251,a231
v_mul_f32 v250,v250,v249
v_mul_f32 v251,v251,v249
v_accvgpr_write_b32 a230,v250
v_accvgpr_write_b32 a231,v251
v_accvgpr_read_b32 v250,a244
v_accvgpr_read_b32 v251,a245
v_mul_f32 v250,v250,v249
v_mul_f32 v251,v251,v249
v_accvgpr_write_b32 a244,v250
v_accvgpr_write_b32 a245,v251
v_accvgpr_read_b32 v250,a246
v_accvgpr_read_b32 v251,a247
v_mul_f32 v250,v250,v249
v_mul_f32 v251,v251,v249
v_accvgpr_write_b32 a246,v250
v_accvgpr_write_b32 a247,v251
v_exp_f32 v132,v132
v_exp_f32 v133,v133
v_exp_f32 v134,v134
v_exp_f32 v135,v135
v_exp_f32 v148,v148
v_exp_f32 v149,v149
v_exp_f32 v150,v150
v_exp_f32 v151,v151
v_add_f32 v245,v132,v133
v_add_f32 v245,v245,v134
v_add_f32 v245,v245,v135
v_add_f32 v245,v245,v148
v_add_f32 v245,v245,v149
v_add_f32 v245,v245,v150
v_add_f32 v245,v245,v151
v_cvt_pk_bf16_f32 v180,v132,v133
v_cvt_pk_bf16_f32 v181,v134,v135
v_cvt_pk_bf16_f32 v182,v148,v149
v_cvt_pk_bf16_f32 v183,v150,v151
v_max3_f32 v248,v136,v137,v138
v_max3_f32 v248,v248,v139,v152
v_max3_f32 v248,v248,v153,v154
v_max_f32 v248,v248,v155
v_mov_b32 v249,v248
s_nop 1
v_permlane32_swap_b32 v249,v248
v_max_f32 v248,v249,v248
v_mov_b32 v249,v248
s_nop 1
v_permlane16_swap_b32 v249,v248
v_max_f32 v248,v249,v248
v_max_f32 v248,0,v248
v_sub_f32 v249,0,v248
v_exp_f32 v249,v249
v_sub_f32 v136,v136,v248
v_sub_f32 v137,v137,v248
v_sub_f32 v138,v138,v248
v_sub_f32 v139,v139,v248
v_sub_f32 v152,v152,v248
v_sub_f32 v153,v153,v248
v_sub_f32 v154,v154,v248
v_sub_f32 v155,v155,v248
v_sub_f32 v200,v200,v248
v_sub_f32 v201,v201,v248
v_sub_f32 v202,v202,v248
v_sub_f32 v203,v203,v248
v_mul_f32 v242,v242,v249
v_accvgpr_read_b32 v250,a8
v_accvgpr_read_b32 v251,a9
v_mul_f32 v250,v250,v249
v_mul_f32 v251,v251,v249
v_accvgpr_write_b32 a8,v250
v_accvgpr_write_b32 a9,v251
v_accvgpr_read_b32 v250,a10
v_accvgpr_read_b32 v251,a11
v_mul_f32 v250,v250,v249
v_mul_f32 v251,v251,v249
v_accvgpr_write_b32 a10,v250
v_accvgpr_write_b32 a11,v251
v_accvgpr_read_b32 v250,a24
v_accvgpr_read_b32 v251,a25
v_mul_f32 v250,v250,v249
v_mul_f32 v251,v251,v249
v_accvgpr_write_b32 a24,v250
v_accvgpr_write_b32 a25,v251
v_accvgpr_read_b32 v250,a26
v_accvgpr_read_b32 v251,a27
v_mul_f32 v250,v250,v249
v_mul_f32 v251,v251,v249
v_accvgpr_write_b32 a26,v250
v_accvgpr_write_b32 a27,v251
v_accvgpr_read_b32 v250,a40
v_accvgpr_read_b32 v251,a41
v_mul_f32 v250,v250,v249
v_mul_f32 v251,v251,v249
v_accvgpr_write_b32 a40,v250
v_accvgpr_write_b32 a41,v251
v_accvgpr_read_b32 v250,a42
v_accvgpr_read_b32 v251,a43
v_mul_f32 v250,v250,v249
v_mul_f32 v251,v251,v249
v_accvgpr_write_b32 a42,v250
v_accvgpr_write_b32 a43,v251
v_accvgpr_read_b32 v250,a56
v_accvgpr_read_b32 v251,a57
v_mul_f32 v250,v250,v249
v_mul_f32 v251,v251,v249
v_accvgpr_write_b32 a56,v250
v_accvgpr_write_b32 a57,v251
v_accvgpr_read_b32 v250,a58
v_accvgpr_read_b32 v251,a59
v_mul_f32 v250,v250,v249
v_mul_f32 v251,v251,v249
v_accvgpr_write_b32 a58,v250
v_accvgpr_write_b32 a59,v251
v_accvgpr_read_b32 v250,a72
v_accvgpr_read_b32 v251,a73
v_mul_f32 v250,v250,v249
v_mul_f32 v251,v251,v249
v_accvgpr_write_b32 a72,v250
v_accvgpr_write_b32 a73,v251
v_accvgpr_read_b32 v250,a74
v_accvgpr_read_b32 v251,a75
v_mul_f32 v250,v250,v249
v_mul_f32 v251,v251,v249
v_accvgpr_write_b32 a74,v250
v_accvgpr_write_b32 a75,v251
v_accvgpr_read_b32 v250,a88
v_accvgpr_read_b32 v251,a89
v_mul_f32 v250,v250,v249
v_mul_f32 v251,v251,v249
v_accvgpr_write_b32 a88,v250
v_accvgpr_write_b32 a89,v251
v_accvgpr_read_b32 v250,a90
v_accvgpr_read_b32 v251,a91
v_mul_f32 v250,v250,v249
v_mul_f32 v251,v251,v249
v_accvgpr_write_b32 a90,v250
v_accvgpr_write_b32 a91,v251
v_accvgpr_read_b32 v250,a104
v_accvgpr_read_b32 v251,a105
v_mul_f32 v250,v250,v249
v_mul_f32 v251,v251,v249
v_accvgpr_write_b32 a104,v250
v_accvgpr_write_b32 a105,v251
v_accvgpr_read_b32 v250,a106
v_accvgpr_read_b32 v251,a107
v_mul_f32 v250,v250,v249
v_mul_f32 v251,v251,v249
v_accvgpr_write_b32 a106,v250
v_accvgpr_write_b32 a107,v251
v_accvgpr_read_b32 v250,a120
v_accvgpr_read_b32 v251,a121
v_mul_f32 v250,v250,v249
v_mul_f32 v251,v251,v249
v_accvgpr_write_b32 a120,v250
v_accvgpr_write_b32 a121,v251
v_accvgpr_read_b32 v250,a122
v_accvgpr_read_b32 v251,a123
v_mul_f32 v250,v250,v249
v_mul_f32 v251,v251,v249
v_accvgpr_write_b32 a122,v250
v_accvgpr_write_b32 a123,v251
v_accvgpr_read_b32 v250,a136
v_accvgpr_read_b32 v251,a137
v_mul_f32 v250,v250,v249
v_mul_f32 v251,v251,v249
v_accvgpr_write_b32 a136,v250
v_accvgpr_write_b32 a137,v251
v_accvgpr_read_b32 v250,a138
v_accvgpr_read_b32 v251,a139
v_mul_f32 v250,v250,v249
v_mul_f32 v251,v251,v249
v_accvgpr_write_b32 a138,v250
v_accvgpr_write_b32 a139,v251
v_accvgpr_read_b32 v250,a152
v_accvgpr_read_b32 v251,a153
v_mul_f32 v250,v250,v249
v_mul_f32 v251,v251,v249
v_accvgpr_write_b32 a152,v250
v_accvgpr_write_b32 a153,v251
v_accvgpr_read_b32 v250,a154
v_accvgpr_read_b32 v251,a155
v_mul_f32 v250,v250,v249
v_mul_f32 v251,v251,v249
v_accvgpr_write_b32 a154,v250
v_accvgpr_write_b32 a155,v251
v_accvgpr_read_b32 v250,a168
v_accvgpr_read_b32 v251,a169
v_mul_f32 v250,v250,v249
v_mul_f32 v251,v251,v249
v_accvgpr_write_b32 a168,v250
v_accvgpr_write_b32 a169,v251
v_accvgpr_read_b32 v250,a170
v_accvgpr_read_b32 v251,a171
v_mul_f32 v250,v250,v249
v_mul_f32 v251,v251,v249
v_accvgpr_write_b32 a170,v250
v_accvgpr_write_b32 a171,v251
v_accvgpr_read_b32 v250,a184
v_accvgpr_read_b32 v251,a185
v_mul_f32 v250,v250,v249
v_mul_f32 v251,v251,v249
v_accvgpr_write_b32 a184,v250
v_accvgpr_write_b32 a185,v251
v_accvgpr_read_b32 v250,a186
v_accvgpr_read_b32 v251,a187
v_mul_f32 v250,v250,v249
v_mul_f32 v251,v251,v249
v_accvgpr_write_b32 a186,v250
v_accvgpr_write_b32 a187,v251
v_accvgpr_read_b32 v250,a200
v_accvgpr_read_b32 v251,a201
v_mul_f32 v250,v250,v249
v_mul_f32 v251,v251,v249
v_accvgpr_write_b32 a200,v250
v_accvgpr_write_b32 a201,v251
v_accvgpr_read_b32 v250,a202
v_accvgpr_read_b32 v251,a203
v_mul_f32 v250,v250,v249
v_mul_f32 v251,v251,v249
v_accvgpr_write_b32 a202,v250
v_accvgpr_write_b32 a203,v251
v_accvgpr_read_b32 v250,a216
v_accvgpr_read_b32 v251,a217
v_mul_f32 v250,v250,v249
v_mul_f32 v251,v251,v249
v_accvgpr_write_b32 a216,v250
v_accvgpr_write_b32 a217,v251
v_accvgpr_read_b32 v250,a218
v_accvgpr_read_b32 v251,a219
v_mul_f32 v250,v250,v249
v_mul_f32 v251,v251,v249
v_accvgpr_write_b32 a218,v250
v_accvgpr_write_b32 a219,v251
v_accvgpr_read_b32 v250,a232
v_accvgpr_read_b32 v251,a233
v_mul_f32 v250,v250,v249
v_mul_f32 v251,v251,v249
v_accvgpr_write_b32 a232,v250
v_accvgpr_write_b32 a233,v251
v_accvgpr_read_b32 v250,a234
v_accvgpr_read_b32 v251,a235
v_mul_f32 v250,v250,v249
v_mul_f32 v251,v251,v249
v_accvgpr_write_b32 a234,v250
v_accvgpr_write_b32 a235,v251
v_accvgpr_read_b32 v250,a248
v_accvgpr_read_b32 v251,a249
v_mul_f32 v250,v250,v249
v_mul_f32 v251,v251,v249
v_accvgpr_write_b32 a248,v250
v_accvgpr_write_b32 a249,v251
v_accvgpr_read_b32 v250,a250
v_accvgpr_read_b32 v251,a251
v_mul_f32 v250,v250,v249
v_mul_f32 v251,v251,v249
v_accvgpr_write_b32 a250,v250
v_accvgpr_write_b32 a251,v251
v_exp_f32 v136,v136
v_exp_f32 v137,v137
v_exp_f32 v138,v138
v_exp_f32 v139,v139
v_exp_f32 v152,v152
v_exp_f32 v153,v153
v_exp_f32 v154,v154
v_exp_f32 v155,v155
v_add_f32 v246,v136,v137
v_add_f32 v246,v246,v138
v_add_f32 v246,v246,v139
v_add_f32 v246,v246,v152
v_add_f32 v246,v246,v153
v_add_f32 v246,v246,v154
v_add_f32 v246,v246,v155
v_cvt_pk_bf16_f32 v184,v136,v137
v_cvt_pk_bf16_f32 v185,v138,v139
v_cvt_pk_bf16_f32 v186,v152,v153
v_cvt_pk_bf16_f32 v187,v154,v155
v_max3_f32 v248,v140,v141,v142
v_max3_f32 v248,v248,v143,v156
v_max3_f32 v248,v248,v157,v158
v_max_f32 v248,v248,v159
v_mov_b32 v249,v248
s_nop 1
v_permlane32_swap_b32 v249,v248
v_max_f32 v248,v249,v248
v_mov_b32 v249,v248
s_nop 1
v_permlane16_swap_b32 v249,v248
v_max_f32 v248,v249,v248
v_max_f32 v248,0,v248
v_sub_f32 v249,0,v248
v_exp_f32 v249,v249
v_sub_f32 v140,v140,v248
v_sub_f32 v141,v141,v248
v_sub_f32 v142,v142,v248
v_sub_f32 v143,v143,v248
v_sub_f32 v156,v156,v248
v_sub_f32 v157,v157,v248
v_sub_f32 v158,v158,v248
v_sub_f32 v159,v159,v248
v_sub_f32 v204,v204,v248
v_sub_f32 v205,v205,v248
v_sub_f32 v206,v206,v248
v_sub_f32 v207,v207,v248
v_mul_f32 v243,v243,v249
v_accvgpr_read_b32 v250,a12
v_accvgpr_read_b32 v251,a13
v_mul_f32 v250,v250,v249
v_mul_f32 v251,v251,v249
v_accvgpr_write_b32 a12,v250
v_accvgpr_write_b32 a13,v251
v_accvgpr_read_b32 v250,a14
v_accvgpr_read_b32 v251,a15
v_mul_f32 v250,v250,v249
v_mul_f32 v251,v251,v249
v_accvgpr_write_b32 a14,v250
v_accvgpr_write_b32 a15,v251
v_accvgpr_read_b32 v250,a28
v_accvgpr_read_b32 v251,a29
v_mul_f32 v250,v250,v249
v_mul_f32 v251,v251,v249
v_accvgpr_write_b32 a28,v250
v_accvgpr_write_b32 a29,v251
v_accvgpr_read_b32 v250,a30
v_accvgpr_read_b32 v251,a31
v_mul_f32 v250,v250,v249
v_mul_f32 v251,v251,v249
v_accvgpr_write_b32 a30,v250
v_accvgpr_write_b32 a31,v251
v_accvgpr_read_b32 v250,a44
v_accvgpr_read_b32 v251,a45
v_mul_f32 v250,v250,v249
v_mul_f32 v251,v251,v249
v_accvgpr_write_b32 a44,v250
v_accvgpr_write_b32 a45,v251
v_accvgpr_read_b32 v250,a46
v_accvgpr_read_b32 v251,a47
v_mul_f32 v250,v250,v249
v_mul_f32 v251,v251,v249
v_accvgpr_write_b32 a46,v250
v_accvgpr_write_b32 a47,v251
v_accvgpr_read_b32 v250,a60
v_accvgpr_read_b32 v251,a61
v_mul_f32 v250,v250,v249
v_mul_f32 v251,v251,v249
v_accvgpr_write_b32 a60,v250
v_accvgpr_write_b32 a61,v251
v_accvgpr_read_b32 v250,a62
v_accvgpr_read_b32 v251,a63
v_mul_f32 v250,v250,v249
v_mul_f32 v251,v251,v249
v_accvgpr_write_b32 a62,v250
v_accvgpr_write_b32 a63,v251
v_accvgpr_read_b32 v250,a76
v_accvgpr_read_b32 v251,a77
v_mul_f32 v250,v250,v249
v_mul_f32 v251,v251,v249
v_accvgpr_write_b32 a76,v250
v_accvgpr_write_b32 a77,v251
v_accvgpr_read_b32 v250,a78
v_accvgpr_read_b32 v251,a79
v_mul_f32 v250,v250,v249
v_mul_f32 v251,v251,v249
v_accvgpr_write_b32 a78,v250
v_accvgpr_write_b32 a79,v251
v_accvgpr_read_b32 v250,a92
v_accvgpr_read_b32 v251,a93
v_mul_f32 v250,v250,v249
v_mul_f32 v251,v251,v249
v_accvgpr_write_b32 a92,v250
v_accvgpr_write_b32 a93,v251
v_accvgpr_read_b32 v250,a94
v_accvgpr_read_b32 v251,a95
v_mul_f32 v250,v250,v249
v_mul_f32 v251,v251,v249
v_accvgpr_write_b32 a94,v250
v_accvgpr_write_b32 a95,v251
v_accvgpr_read_b32 v250,a108
v_accvgpr_read_b32 v251,a109
v_mul_f32 v250,v250,v249
v_mul_f32 v251,v251,v249
v_accvgpr_write_b32 a108,v250
v_accvgpr_write_b32 a109,v251
v_accvgpr_read_b32 v250,a110
v_accvgpr_read_b32 v251,a111
v_mul_f32 v250,v250,v249
v_mul_f32 v251,v251,v249
v_accvgpr_write_b32 a110,v250
v_accvgpr_write_b32 a111,v251
v_accvgpr_read_b32 v250,a124
v_accvgpr_read_b32 v251,a125
v_mul_f32 v250,v250,v249
v_mul_f32 v251,v251,v249
v_accvgpr_write_b32 a124,v250
v_accvgpr_write_b32 a125,v251
v_accvgpr_read_b32 v250,a126
v_accvgpr_read_b32 v251,a127
v_mul_f32 v250,v250,v249
v_mul_f32 v251,v251,v249
v_accvgpr_write_b32 a126,v250
v_accvgpr_write_b32 a127,v251
v_accvgpr_read_b32 v250,a140
v_accvgpr_read_b32 v251,a141
v_mul_f32 v250,v250,v249
v_mul_f32 v251,v251,v249
v_accvgpr_write_b32 a140,v250
v_accvgpr_write_b32 a141,v251
v_accvgpr_read_b32 v250,a142
v_accvgpr_read_b32 v251,a143
v_mul_f32 v250,v250,v249
v_mul_f32 v251,v251,v249
v_accvgpr_write_b32 a142,v250
v_accvgpr_write_b32 a143,v251
v_accvgpr_read_b32 v250,a156
v_accvgpr_read_b32 v251,a157
v_mul_f32 v250,v250,v249
v_mul_f32 v251,v251,v249
v_accvgpr_write_b32 a156,v250
v_accvgpr_write_b32 a157,v251
v_accvgpr_read_b32 v250,a158
v_accvgpr_read_b32 v251,a159
v_mul_f32 v250,v250,v249
v_mul_f32 v251,v251,v249
v_accvgpr_write_b32 a158,v250
v_accvgpr_write_b32 a159,v251
v_accvgpr_read_b32 v250,a172
v_accvgpr_read_b32 v251,a173
v_mul_f32 v250,v250,v249
v_mul_f32 v251,v251,v249
v_accvgpr_write_b32 a172,v250
v_accvgpr_write_b32 a173,v251
v_accvgpr_read_b32 v250,a174
v_accvgpr_read_b32 v251,a175
v_mul_f32 v250,v250,v249
v_mul_f32 v251,v251,v249
v_accvgpr_write_b32 a174,v250
v_accvgpr_write_b32 a175,v251
v_accvgpr_read_b32 v250,a188
v_accvgpr_read_b32 v251,a189
v_mul_f32 v250,v250,v249
v_mul_f32 v251,v251,v249
v_accvgpr_write_b32 a188,v250
v_accvgpr_write_b32 a189,v251
v_accvgpr_read_b32 v250,a190
v_accvgpr_read_b32 v251,a191
v_mul_f32 v250,v250,v249
v_mul_f32 v251,v251,v249
v_accvgpr_write_b32 a190,v250
v_accvgpr_write_b32 a191,v251
v_accvgpr_read_b32 v250,a204
v_accvgpr_read_b32 v251,a205
v_mul_f32 v250,v250,v249
v_mul_f32 v251,v251,v249
v_accvgpr_write_b32 a204,v250
v_accvgpr_write_b32 a205,v251
v_accvgpr_read_b32 v250,a206
v_accvgpr_read_b32 v251,a207
v_mul_f32 v250,v250,v249
v_mul_f32 v251,v251,v249
v_accvgpr_write_b32 a206,v250
v_accvgpr_write_b32 a207,v251
v_accvgpr_read_b32 v250,a220
v_accvgpr_read_b32 v251,a221
v_mul_f32 v250,v250,v249
v_mul_f32 v251,v251,v249
v_accvgpr_write_b32 a220,v250
v_accvgpr_write_b32 a221,v251
v_accvgpr_read_b32 v250,a222
v_accvgpr_read_b32 v251,a223
v_mul_f32 v250,v250,v249
v_mul_f32 v251,v251,v249
v_accvgpr_write_b32 a222,v250
v_accvgpr_write_b32 a223,v251
v_accvgpr_read_b32 v250,a236
v_accvgpr_read_b32 v251,a237
v_mul_f32 v250,v250,v249
v_mul_f32 v251,v251,v249
v_accvgpr_write_b32 a236,v250
v_accvgpr_write_b32 a237,v251
v_accvgpr_read_b32 v250,a238
v_accvgpr_read_b32 v251,a239
v_mul_f32 v250,v250,v249
v_mul_f32 v251,v251,v249
v_accvgpr_write_b32 a238,v250
v_accvgpr_write_b32 a239,v251
v_accvgpr_read_b32 v250,a252
v_accvgpr_read_b32 v251,a253
v_mul_f32 v250,v250,v249
v_mul_f32 v251,v251,v249
v_accvgpr_write_b32 a252,v250
v_accvgpr_write_b32 a253,v251
v_accvgpr_read_b32 v250,a254
v_accvgpr_read_b32 v251,a255
v_mul_f32 v250,v250,v249
v_mul_f32 v251,v251,v249
v_accvgpr_write_b32 a254,v250
v_accvgpr_write_b32 a255,v251
v_exp_f32 v140,v140
v_exp_f32 v141,v141
v_exp_f32 v142,v142
v_exp_f32 v143,v143
v_exp_f32 v156,v156
v_exp_f32 v157,v157
v_exp_f32 v158,v158
v_exp_f32 v159,v159
v_add_f32 v247,v140,v141
v_add_f32 v247,v247,v142
v_add_f32 v247,v247,v143
v_add_f32 v247,v247,v156
v_add_f32 v247,v247,v157
v_add_f32 v247,v247,v158
v_add_f32 v247,v247,v159
v_cvt_pk_bf16_f32 v188,v140,v141
v_cvt_pk_bf16_f32 v189,v142,v143
v_cvt_pk_bf16_f32 v190,v156,v157
v_cvt_pk_bf16_f32 v191,v158,v159
s_nop 3
s_setpc_b64 s[42:43]
L_spinf:
s_mov_b32 s69,0x20000
L_spinf_l:
buffer_load_dword v137,v142,s[12:15],0 offen sc1
s_sub_u32 s69,s69,1
s_waitcnt vmcnt(0)
v_cmp_gt_u32 vcc,s60,v137
s_cbranch_vccz L_spinf_e
s_cmp_lg_u32 s69,0
s_cbranch_scc1 L_spinf_l
L_spinf_e:
s_setpc_b64 s[42:43]
L_spind:
s_mov_b32 s69,0x20000
L_spind_l:
buffer_load_dword v140,v139,s[0:3],0 offen sc1
s_sub_u32 s69,s69,1
s_waitcnt vmcnt(0)
v_cmp_gt_u32 vcc,s60,v140
s_cbranch_vccz L_spind_e
s_cmp_lg_u32 s69,0
s_cbranch_scc1 L_spind_l
L_spind_e:
s_setpc_b64 s[42:43]
M_start:
s_waitcnt vmcnt(15)
s_barrier
ds_read_b64_tr_b16 v[208:209],v252 offset:16896
ds_read_b64_tr_b16 v[210:211],v252 offset:17408
ds_read_b64_tr_b16 v[212:213],v252 offset:16904
ds_read_b64_tr_b16 v[214:215],v252 offset:17416
ds_read_b64_tr_b16 v[216:217],v252 offset:16960
ds_read_b64_tr_b16 v[218:219],v252 offset:17472
ds_read_b64_tr_b16 v[220:221],v252 offset:16968
ds_read_b64_tr_b16 v[222:223],v252 offset:17480
ds_read_b128 a[64:67],v253 offset:0
ds_read_b128 a[68:71],v253 offset:2048
ds_read_b128 a[72:75],v253 offset:16896
v_xor_b32 v253,64,v253
ds_read_b128 a[80:83],v253 offset:0
ds_read_b128 a[84:87],v253 offset:2048
ds_read_b128 a[88:91],v253 offset:16896
v_xor_b32 v253,64,v253
.p2alignl 6, 0xbf800000
M_item:
s_waitcnt lgkmcnt(3)
v_mfma_f32_16x16x32_bf16 v[0:3],v[208:211],a[64:67],0
ds_read_b64_tr_b16 v[224:225],v252 offset:17024
s_add_u32 m0,s29,33792
v_mfma_f32_16x16x32_bf16 v[4:7],v[208:211],a[68:71],0
ds_read_b64_tr_b16 v[226:227],v252 offset:17536
buffer_load_dwordx4 v254,s[16:19],s0 offen lds
v_mfma_f32_16x16x32_bf16 v[8:11],v[208:211],a[72:75],0
ds_read_b64_tr_b16 v[228:229],v252 offset:17032
s_add_u32 m0,m0,0x00000428
ds_read_b64_tr_b16 v[230:231],v252 offset:17544
v_accvgpr_read_b32 v200,a96
v_mfma_f32_16x16x32_bf16 v[128:131],v[212:215],a[64:67],0
buffer_load_dwordx4 v254,s[16:19],s1 offen lds
s_add_u32 m0,m0,0x00000418
v_mfma_f32_16x16x32_bf16 v[132:135],v[212:215],a[68:71],0
v_accvgpr_read_b32 v201,a97
v_accvgpr_read_b32 v202,a98
v_mfma_f32_16x16x32_bf16 v[136:139],v[212:215],a[72:75],0
v_accvgpr_read_b32 v203,a99
v_accvgpr_read_b32 v204,a112
buffer_load_dwordx4 v254,s[16:19],s2 offen lds
s_waitcnt lgkmcnt(15)
v_mfma_f32_16x16x32_bf16 v[16:19],v[216:219],a[64:67],0
ds_read_b64_tr_b16 v[232:233],v252 offset:17088
s_add_u32 m0,m0,0x00000428
v_mfma_f32_16x16x32_bf16 v[20:23],v[216:219],a[68:71],0
ds_read_b64_tr_b16 v[234:235],v252 offset:17600
v_accvgpr_read_b32 v205,a113
v_mfma_f32_16x16x32_bf16 v[24:27],v[216:219],a[72:75],0
ds_read_b64_tr_b16 v[236:237],v252 offset:17096
buffer_load_dwordx4 v254,s[16:19],s3 offen lds
ds_read_b64_tr_b16 v[238:239],v252 offset:17608
v_accvgpr_read_b32 v206,a114
v_mfma_f32_16x16x32_bf16 v[144:147],v[220:223],a[64:67],0
s_add_u32 s16,s16,262144
s_addc_u32 s17,s17,0
v_mfma_f32_16x16x32_bf16 v[148:151],v[220:223],a[68:71],0
s_sub_u32 s18,s18,262144
s_add_u32 m0,s29,50688
v_mfma_f32_16x16x32_bf16 v[152:155],v[220:223],a[72:75],0
buffer_load_dwordx4 v254,s[16:19],s0 offen lds
s_add_u32 m0,m0,0x00000428
v_accvgpr_read_b32 v207,a115
s_waitcnt lgkmcnt(4)
v_mfma_f32_16x16x32_bf16 v[32:35],v[224:227],a[64:67],0
ds_read_b64_tr_b16 v[208:209],v252 offset:17152
buffer_load_dwordx4 v254,s[16:19],s1 offen lds
v_mfma_f32_16x16x32_bf16 v[36:39],v[224:227],a[68:71],0
ds_read_b64_tr_b16 v[210:211],v252 offset:17664
s_add_u32 m0,m0,0x00000418
v_mfma_f32_16x16x32_bf16 v[40:43],v[224:227],a[72:75],0
ds_read_b64_tr_b16 v[212:213],v252 offset:17160
v_mul_f32 v200,v192,v200
ds_read_b64_tr_b16 v[214:215],v252 offset:17672
buffer_load_dwordx4 v254,s[16:19],s2 offen lds
v_mfma_f32_16x16x32_bf16 v[160:163],v[228:231],a[64:67],0
s_add_u32 m0,m0,0x00000428
v_mul_f32 v201,v192,v201
v_mfma_f32_16x16x32_bf16 v[164:167],v[228:231],a[68:71],0
v_mul_f32 v202,v192,v202
v_mul_f32 v203,v192,v203
v_mfma_f32_16x16x32_bf16 v[168:171],v[228:231],a[72:75],0
buffer_load_dwordx4 v254,s[16:19],s3 offen lds
v_mul_f32 v204,v192,v204
v_mul_f32 v205,v192,v205
s_waitcnt lgkmcnt(4)
v_mfma_f32_16x16x32_bf16 v[48:51],v[232:235],a[64:67],0
ds_read_b64_tr_b16 v[216:217],v252 offset:17216
v_mul_f32 v206,v192,v206
v_mfma_f32_16x16x32_bf16 v[52:55],v[232:235],a[68:71],0
ds_read_b64_tr_b16 v[218:219],v252 offset:17728
v_mul_f32 v207,v192,v207
v_mfma_f32_16x16x32_bf16 v[56:59],v[232:235],a[72:75],0
ds_read_b64_tr_b16 v[220:221],v252 offset:17224
v_cvt_pk_bf16_f32 v240,v200,v201
ds_read_b64_tr_b16 v[222:223],v252 offset:17736
v_cvt_pk_bf16_f32 v241,v202,v203
v_mfma_f32_16x16x32_bf16 v[176:179],v[236:239],a[64:67],0
s_add_u32 s16,s16,262144
s_addc_u32 s17,s17,0
v_mfma_f32_16x16x32_bf16 v[180:183],v[236:239],a[68:71],0
s_sub_u32 s18,s18,262144
v_mbcnt_lo_u32_b32 v251,-1,0
v_mfma_f32_16x16x32_bf16 v[184:187],v[236:239],a[72:75],0
v_mbcnt_hi_u32_b32 v251,-1,v251
v_lshrrev_b32 v250,5,v251
v_and_b32 v251,31,v251
s_waitcnt lgkmcnt(4)
v_mfma_f32_16x16x32_bf16 v[64:67],v[208:211],a[64:67],0
ds_read_b64_tr_b16 v[224:225],v252 offset:17280
v_lshlrev_b32 v250,13,v250
v_mfma_f32_16x16x32_bf16 v[68:71],v[208:211],a[68:71],0
ds_read_b64_tr_b16 v[226:227],v252 offset:17792
v_lshl_add_u32 v251,v251,4,v250
v_mfma_f32_16x16x32_bf16 v[72:75],v[208:211],a[72:75],0
ds_read_b64_tr_b16 v[228:229],v252 offset:17288
v_cvt_pk_bf16_f32 v242,v204,v205
ds_read_b64_tr_b16 v[230:231],v252 offset:17800
v_cvt_pk_bf16_f32 v243,v206,v207
v_mfma_f32_16x16x32_bf16 a[0:3],v[212:215],a[64:67],0
buffer_store_dwordx4 v[240:243],v248,s[20:23],s62 offen offset:3072 sc1
v_accvgpr_read_b32 v200,a100
v_mfma_f32_16x16x32_bf16 a[4:7],v[212:215],a[68:71],0
v_accvgpr_read_b32 v201,a101
v_accvgpr_read_b32 v202,a102
v_mfma_f32_16x16x32_bf16 a[8:11],v[212:215],a[72:75],0
v_accvgpr_read_b32 v203,a103
v_accvgpr_read_b32 v204,a116
v_accvgpr_read_b32 v205,a117
s_waitcnt lgkmcnt(4)
v_mfma_f32_16x16x32_bf16 v[80:83],v[216:219],a[64:67],0
ds_read_b64_tr_b16 v[232:233],v252 offset:17344
v_accvgpr_read_b32 v206,a118
v_mfma_f32_16x16x32_bf16 v[84:87],v[216:219],a[68:71],0
ds_read_b64_tr_b16 v[234:235],v252 offset:17856
v_accvgpr_read_b32 v207,a119
v_mfma_f32_16x16x32_bf16 v[88:91],v[216:219],a[72:75],0
ds_read_b64_tr_b16 v[236:237],v252 offset:17352
v_mul_f32 v200,v194,v200
ds_read_b64_tr_b16 v[238:239],v252 offset:17864
v_mul_f32 v201,v194,v201
v_mfma_f32_16x16x32_bf16 a[16:19],v[220:223],a[64:67],0
v_mul_f32 v202,v194,v202
v_mul_f32 v203,v194,v203
v_mfma_f32_16x16x32_bf16 a[20:23],v[220:223],a[68:71],0
v_mul_f32 v204,v194,v204
v_mul_f32 v205,v194,v205
v_mfma_f32_16x16x32_bf16 a[24:27],v[220:223],a[72:75],0
v_mul_f32 v206,v194,v206
v_mul_f32 v207,v194,v207
v_cvt_pk_bf16_f32 v244,v200,v201
s_waitcnt lgkmcnt(4)
v_mfma_f32_16x16x32_bf16 v[96:99],v[224:227],a[64:67],0
v_cvt_pk_bf16_f32 v245,v202,v203
v_cvt_pk_bf16_f32 v246,v204,v205
v_mfma_f32_16x16x32_bf16 v[100:103],v[224:227],a[68:71],0
s_waitcnt vmcnt(20) lgkmcnt(0)
s_barrier
v_mfma_f32_16x16x32_bf16 v[104:107],v[224:227],a[72:75],0
ds_read_b64_tr_b16 v[208:209],v252 offset:0
v_cvt_pk_bf16_f32 v247,v206,v207
ds_read_b64_tr_b16 v[210:211],v252 offset:512
buffer_store_dwordx4 v[244:247],v248,s[20:23],s63 offen offset:3072 sc1
v_mfma_f32_16x16x32_bf16 a[32:35],v[228:231],a[64:67],0
ds_read_b64_tr_b16 v[212:213],v252 offset:8
v_accvgpr_read_b32 v200,a104
v_mfma_f32_16x16x32_bf16 a[36:39],v[228:231],a[68:71],0
ds_read_b64_tr_b16 v[214:215],v252 offset:520
v_accvgpr_read_b32 v201,a105
v_mfma_f32_16x16x32_bf16 a[40:43],v[228:231],a[72:75],0
v_accvgpr_read_b32 v202,a106
v_accvgpr_read_b32 v203,a107
v_accvgpr_read_b32 v204,a120
v_accvgpr_read_b32 v205,a121
v_mfma_f32_16x16x32_bf16 v[112:115],v[232:235],a[64:67],0
ds_read_b64_tr_b16 v[216:217],v252 offset:64
v_accvgpr_read_b32 v206,a122
v_mfma_f32_16x16x32_bf16 v[116:119],v[232:235],a[68:71],0
ds_read_b64_tr_b16 v[218:219],v252 offset:576
v_accvgpr_read_b32 v207,a123
v_mfma_f32_16x16x32_bf16 v[120:123],v[232:235],a[72:75],0
ds_read_b64_tr_b16 v[220:221],v252 offset:72
v_mul_f32 v200,v196,v200
ds_read_b64_tr_b16 v[222:223],v252 offset:584
v_mul_f32 v201,v196,v201
v_mfma_f32_16x16x32_bf16 a[48:51],v[236:239],a[64:67],0
v_mul_f32 v202,v196,v202
v_mul_f32 v203,v196,v203
v_mfma_f32_16x16x32_bf16 a[52:55],v[236:239],a[68:71],0
v_mul_f32 v204,v196,v204
v_mul_f32 v205,v196,v205
v_mfma_f32_16x16x32_bf16 a[56:59],v[236:239],a[72:75],0
v_mul_f32 v206,v196,v206
v_mul_f32 v207,v196,v207
v_cvt_pk_bf16_f32 v240,v200,v201
s_waitcnt lgkmcnt(4)
v_mfma_f32_16x16x32_bf16 v[0:3],v[208:211],a[80:83],v[0:3]
ds_read_b64_tr_b16 v[224:225],v252 offset:128
v_cvt_pk_bf16_f32 v241,v202,v203
v_mfma_f32_16x16x32_bf16 v[4:7],v[208:211],a[84:87],v[4:7]
ds_read_b64_tr_b16 v[226:227],v252 offset:640
v_cvt_pk_bf16_f32 v242,v204,v205
v_mfma_f32_16x16x32_bf16 v[8:11],v[208:211],a[88:91],v[8:11]
ds_read_b64_tr_b16 v[228:229],v252 offset:136
v_cvt_pk_bf16_f32 v243,v206,v207
s_waitcnt vmcnt(12)
ds_read_b64_tr_b16 v[230:231],v252 offset:648
v_mfma_f32_16x16x32_bf16 v[128:131],v[212:215],a[80:83],v[128:131]
ds_read_b128 a[64:67],v253 offset:33792
buffer_store_dwordx4 v[240:243],v248,s[20:23],s64 offen offset:3072 sc1
v_mfma_f32_16x16x32_bf16 v[132:135],v[212:215],a[84:87],v[132:135]
ds_read_b128 a[68:71],v253 offset:35840
v_mfma_f32_16x16x32_bf16 v[136:139],v[212:215],a[88:91],v[136:139]
ds_read_b128 a[72:75],v253 offset:50688
s_waitcnt lgkmcnt(7)
v_mfma_f32_16x16x32_bf16 v[16:19],v[216:219],a[80:83],v[16:19]
ds_read_b64_tr_b16 v[232:233],v252 offset:192
v_mfma_f32_16x16x32_bf16 v[20:23],v[216:219],a[84:87],v[20:23]
ds_read_b64_tr_b16 v[234:235],v252 offset:704
v_mfma_f32_16x16x32_bf16 v[24:27],v[216:219],a[88:91],v[24:27]
ds_read_b64_tr_b16 v[236:237],v252 offset:200
ds_read_b64_tr_b16 v[238:239],v252 offset:712
v_mfma_f32_16x16x32_bf16 v[144:147],v[220:223],a[80:83],v[144:147]
v_xor_b32 v253,64,v253
v_mfma_f32_16x16x32_bf16 v[148:151],v[220:223],a[84:87],v[148:151]
ds_read_b128 a[96:99],v253 offset:33792
v_mfma_f32_16x16x32_bf16 v[152:155],v[220:223],a[88:91],v[152:155]
ds_read_b128 a[100:103],v253 offset:35840
s_waitcnt lgkmcnt(9)
v_mfma_f32_16x16x32_bf16 v[32:35],v[224:227],a[80:83],v[32:35]
ds_read_b64_tr_b16 v[208:209],v252 offset:256
v_mfma_f32_16x16x32_bf16 v[36:39],v[224:227],a[84:87],v[36:39]
ds_read_b64_tr_b16 v[210:211],v252 offset:768
v_mfma_f32_16x16x32_bf16 v[40:43],v[224:227],a[88:91],v[40:43]
ds_read_b64_tr_b16 v[212:213],v252 offset:264
ds_read_b64_tr_b16 v[214:215],v252 offset:776
v_mfma_f32_16x16x32_bf16 v[160:163],v[228:231],a[80:83],v[160:163]
ds_read_b128 a[104:107],v253 offset:50688
v_mfma_f32_16x16x32_bf16 v[164:167],v[228:231],a[84:87],v[164:167]
v_xor_b32 v253,64,v253
v_mfma_f32_16x16x32_bf16 v[168:171],v[228:231],a[88:91],v[168:171]
s_waitcnt lgkmcnt(7)
v_mfma_f32_16x16x32_bf16 v[48:51],v[232:235],a[80:83],v[48:51]
ds_read_b64_tr_b16 v[216:217],v252 offset:320
v_accvgpr_read_b32 v200,a128
v_mfma_f32_16x16x32_bf16 v[52:55],v[232:235],a[84:87],v[52:55]
ds_read_b64_tr_b16 v[218:219],v252 offset:832
v_accvgpr_read_b32 v201,a129
v_mfma_f32_16x16x32_bf16 v[56:59],v[232:235],a[88:91],v[56:59]
ds_read_b64_tr_b16 v[220:221],v252 offset:328
v_accvgpr_read_b32 v202,a130
ds_read_b64_tr_b16 v[222:223],v252 offset:840
v_accvgpr_read_b32 v203,a131
v_mfma_f32_16x16x32_bf16 v[176:179],v[236:239],a[80:83],v[176:179]
v_accvgpr_read_b32 v204,a144
v_accvgpr_read_b32 v205,a145
v_mfma_f32_16x16x32_bf16 v[180:183],v[236:239],a[84:87],v[180:183]
v_accvgpr_read_b32 v206,a146
v_accvgpr_read_b32 v207,a147
v_mfma_f32_16x16x32_bf16 v[184:187],v[236:239],a[88:91],v[184:187]
v_mul_f32 v200,v192,v200
v_mul_f32 v201,v192,v201
v_mul_f32 v202,v192,v202
s_waitcnt lgkmcnt(5)
v_mfma_f32_16x16x32_bf16 v[64:67],v[208:211],a[80:83],v[64:67]
ds_read_b64_tr_b16 v[224:225],v252 offset:384
v_mul_f32 v203,v192,v203
v_mfma_f32_16x16x32_bf16 v[68:71],v[208:211],a[84:87],v[68:71]
ds_read_b64_tr_b16 v[226:227],v252 offset:896
v_mul_f32 v204,v192,v204
v_mfma_f32_16x16x32_bf16 v[72:75],v[208:211],a[88:91],v[72:75]
ds_read_b64_tr_b16 v[228:229],v252 offset:392
v_mul_f32 v205,v192,v205
ds_read_b64_tr_b16 v[230:231],v252 offset:904
v_mul_f32 v206,v192,v206
v_mfma_f32_16x16x32_bf16 a[0:3],v[212:215],a[80:83],a[0:3]
v_mul_f32 v207,v192,v207
v_cvt_pk_bf16_f32 v240,v200,v201
v_mfma_f32_16x16x32_bf16 a[4:7],v[212:215],a[84:87],a[4:7]
v_cvt_pk_bf16_f32 v241,v202,v203
v_cvt_pk_bf16_f32 v242,v204,v205
v_mfma_f32_16x16x32_bf16 a[8:11],v[212:215],a[88:91],a[8:11]
v_cvt_pk_bf16_f32 v243,v206,v207
s_add_u32 s60,s62,4096
s_add_u32 m0,s29,84224
s_waitcnt lgkmcnt(4)
v_mfma_f32_16x16x32_bf16 v[80:83],v[216:219],a[80:83],v[80:83]
ds_read_b64_tr_b16 v[232:233],v252 offset:448
buffer_load_dwordx4 v255,s[4:7],s68 offen offset:256 lds
v_mfma_f32_16x16x32_bf16 v[84:87],v[216:219],a[84:87],v[84:87]
ds_read_b64_tr_b16 v[234:235],v252 offset:960
s_add_u32 m0,m0,0x00000400
v_mfma_f32_16x16x32_bf16 v[88:91],v[216:219],a[88:91],v[88:91]
ds_read_b64_tr_b16 v[236:237],v252 offset:456
buffer_store_dwordx4 v[240:243],v248,s[20:23],s60 offen offset:0 sc1
ds_read_b64_tr_b16 v[238:239],v252 offset:968
buffer_load_dwordx4 v255,s[4:7],s93 offen offset:256 lds
v_mfma_f32_16x16x32_bf16 a[16:19],v[220:223],a[80:83],a[16:19]
s_add_u32 m0,m0,0x00000400
v_mfma_f32_16x16x32_bf16 a[20:23],v[220:223],a[84:87],a[20:23]
v_mfma_f32_16x16x32_bf16 a[24:27],v[220:223],a[88:91],a[24:27]
buffer_load_dwordx4 v255,s[4:7],s94 offen offset:256 lds
s_add_u32 m0,m0,0x00000400
s_waitcnt lgkmcnt(4)
v_mfma_f32_16x16x32_bf16 v[96:99],v[224:227],a[80:83],v[96:99]
v_mfma_f32_16x16x32_bf16 v[100:103],v[224:227],a[84:87],v[100:103]
s_waitcnt vmcnt(7) lgkmcnt(0)
s_barrier
v_mfma_f32_16x16x32_bf16 v[104:107],v[224:227],a[88:91],v[104:107]
ds_read_b64_tr_b16 v[208:209],v252 offset:33792
buffer_load_dwordx4 v255,s[4:7],s95 offen offset:256 lds
ds_read_b64_tr_b16 v[210:211],v252 offset:34304
s_add_u32 m0,s29,101120
v_mfma_f32_16x16x32_bf16 a[32:35],v[228:231],a[80:83],a[32:35]
ds_read_b64_tr_b16 v[212:213],v252 offset:33800
buffer_load_dwordx4 v255,s[4:7],s96 offen offset:256 lds
v_mfma_f32_16x16x32_bf16 a[36:39],v[228:231],a[84:87],a[36:39]
ds_read_b64_tr_b16 v[214:215],v252 offset:34312
s_add_u32 m0,m0,0x00000400
v_mfma_f32_16x16x32_bf16 a[40:43],v[228:231],a[88:91],a[40:43]
buffer_load_dwordx4 v255,s[4:7],s97 offen offset:256 lds
v_mfma_f32_16x16x32_bf16 v[112:115],v[232:235],a[80:83],v[112:115]
ds_read_b64_tr_b16 v[216:217],v252 offset:33856
v_mfma_f32_16x16x32_bf16 v[116:119],v[232:235],a[84:87],v[116:119]
ds_read_b64_tr_b16 v[218:219],v252 offset:34368
v_mfma_f32_16x16x32_bf16 v[120:123],v[232:235],a[88:91],v[120:123]
ds_read_b64_tr_b16 v[220:221],v252 offset:33864
ds_read_b64_tr_b16 v[222:223],v252 offset:34376
v_mfma_f32_16x16x32_bf16 a[48:51],v[236:239],a[80:83],a[48:51]
v_mfma_f32_16x16x32_bf16 a[52:55],v[236:239],a[84:87],a[52:55]
v_mfma_f32_16x16x32_bf16 a[56:59],v[236:239],a[88:91],a[56:59]
s_add_u32 m0,s29,16896
s_waitcnt lgkmcnt(4)
v_mfma_f32_16x16x32_bf16 v[0:3],v[208:211],a[64:67],v[0:3]
ds_read_b64_tr_b16 v[224:225],v252 offset:33920
buffer_load_dwordx4 v254,s[16:19],s0 offen lds
v_mfma_f32_16x16x32_bf16 v[4:7],v[208:211],a[68:71],v[4:7]
ds_read_b64_tr_b16 v[226:227],v252 offset:34432
s_add_u32 m0,m0,0x00000428
v_mfma_f32_16x16x32_bf16 v[8:11],v[208:211],a[72:75],v[8:11]
ds_read_b64_tr_b16 v[228:229],v252 offset:33928
v_accvgpr_read_b32 v200,a132
ds_read_b64_tr_b16 v[230:231],v252 offset:34440
buffer_load_dwordx4 v254,s[16:19],s1 offen lds
v_mfma_f32_16x16x32_bf16 v[128:131],v[212:215],a[64:67],v[128:131]
s_add_u32 m0,m0,0x00000418
v_accvgpr_read_b32 v201,a133
v_mfma_f32_16x16x32_bf16 v[132:135],v[212:215],a[68:71],v[132:135]
v_accvgpr_read_b32 v202,a134
v_accvgpr_read_b32 v203,a135
v_mfma_f32_16x16x32_bf16 v[136:139],v[212:215],a[72:75],v[136:139]
buffer_load_dwordx4 v254,s[16:19],s2 offen lds
s_add_u32 m0,m0,0x00000428
v_accvgpr_read_b32 v204,a148
s_waitcnt lgkmcnt(4)
v_mfma_f32_16x16x32_bf16 v[16:19],v[216:219],a[64:67],v[16:19]
ds_read_b64_tr_b16 v[232:233],v252 offset:33984
v_accvgpr_read_b32 v205,a149
v_mfma_f32_16x16x32_bf16 v[20:23],v[216:219],a[68:71],v[20:23]
ds_read_b64_tr_b16 v[234:235],v252 offset:34496
buffer_load_dwordx4 v254,s[16:19],s3 offen lds
v_mfma_f32_16x16x32_bf16 v[24:27],v[216:219],a[72:75],v[24:27]
ds_read_b64_tr_b16 v[236:237],v252 offset:33992
v_accvgpr_read_b32 v206,a150
ds_read_b64_tr_b16 v[238:239],v252 offset:34504
v_accvgpr_read_b32 v207,a151
v_mfma_f32_16x16x32_bf16 v[144:147],v[220:223],a[64:67],v[144:147]
s_add_u32 s16,s16,262144
s_addc_u32 s17,s17,0
v_mfma_f32_16x16x32_bf16 v[148:151],v[220:223],a[68:71],v[148:151]
s_sub_u32 s18,s18,262144
s_add_u32 m0,s29,0
v_mfma_f32_16x16x32_bf16 v[152:155],v[220:223],a[72:75],v[152:155]
buffer_load_dwordx4 v254,s[16:19],s0 offen lds
s_add_u32 m0,m0,0x00000428
s_nop 0
buffer_load_dwordx4 v254,s[16:19],s1 offen lds
s_waitcnt lgkmcnt(4)
v_mfma_f32_16x16x32_bf16 v[32:35],v[224:227],a[64:67],v[32:35]
ds_read_b64_tr_b16 v[208:209],v252 offset:34048
s_add_u32 m0,m0,0x00000418
v_mfma_f32_16x16x32_bf16 v[36:39],v[224:227],a[68:71],v[36:39]
ds_read_b64_tr_b16 v[210:211],v252 offset:34560
v_mul_f32 v200,v194,v200
v_mfma_f32_16x16x32_bf16 v[40:43],v[224:227],a[72:75],v[40:43]
ds_read_b64_tr_b16 v[212:213],v252 offset:34056
buffer_load_dwordx4 v254,s[16:19],s2 offen lds
ds_read_b64_tr_b16 v[214:215],v252 offset:34568
s_add_u32 m0,m0,0x00000428
v_mfma_f32_16x16x32_bf16 v[160:163],v[228:231],a[64:67],v[160:163]
v_mul_f32 v201,v194,v201
v_mul_f32 v202,v194,v202
v_mfma_f32_16x16x32_bf16 v[164:167],v[228:231],a[68:71],v[164:167]
buffer_load_dwordx4 v254,s[16:19],s3 offen lds
v_mul_f32 v203,v194,v203
v_mfma_f32_16x16x32_bf16 v[168:171],v[228:231],a[72:75],v[168:171]
s_add_u32 s16,s16,262144
s_addc_u32 s17,s17,0
s_sub_u32 s18,s18,262144
s_waitcnt lgkmcnt(4)
v_mfma_f32_16x16x32_bf16 v[48:51],v[232:235],a[64:67],v[48:51]
ds_read_b64_tr_b16 v[216:217],v252 offset:34112
s_add_u32 m0,s29,118272
v_mfma_f32_16x16x32_bf16 v[52:55],v[232:235],a[68:71],v[52:55]
ds_read_b64_tr_b16 v[218:219],v252 offset:34624
buffer_load_dword v195,s[4:7],0 offen offset:384 lds
v_mfma_f32_16x16x32_bf16 v[56:59],v[232:235],a[72:75],v[56:59]
ds_read_b64_tr_b16 v[220:221],v252 offset:34120
buffer_load_dword v197,s[16:19],0 offen offset:0 lds
ds_read_b64_tr_b16 v[222:223],v252 offset:34632
v_mul_f32 v204,v194,v204
v_mfma_f32_16x16x32_bf16 v[176:179],v[236:239],a[64:67],v[176:179]
v_mul_f32 v205,v194,v205
v_mul_f32 v206,v194,v206
v_mfma_f32_16x16x32_bf16 v[180:183],v[236:239],a[68:71],v[180:183]
v_mul_f32 v207,v194,v207
v_cvt_pk_bf16_f32 v244,v200,v201
v_mfma_f32_16x16x32_bf16 v[184:187],v[236:239],a[72:75],v[184:187]
v_cvt_pk_bf16_f32 v245,v202,v203
v_cvt_pk_bf16_f32 v246,v204,v205
v_cvt_pk_bf16_f32 v247,v206,v207
s_waitcnt lgkmcnt(4)
v_mfma_f32_16x16x32_bf16 v[64:67],v[208:211],a[64:67],v[64:67]
ds_read_b64_tr_b16 v[224:225],v252 offset:34176
s_add_u32 s60,s63,4096
v_mfma_f32_16x16x32_bf16 v[68:71],v[208:211],a[68:71],v[68:71]
ds_read_b64_tr_b16 v[226:227],v252 offset:34688
buffer_store_dwordx4 v[244:247],v248,s[20:23],s60 offen offset:0 sc1
v_mfma_f32_16x16x32_bf16 v[72:75],v[208:211],a[72:75],v[72:75]
ds_read_b64_tr_b16 v[228:229],v252 offset:34184
ds_read_b64_tr_b16 v[230:231],v252 offset:34696
v_mfma_f32_16x16x32_bf16 a[0:3],v[212:215],a[64:67],a[0:3]
v_mfma_f32_16x16x32_bf16 a[4:7],v[212:215],a[68:71],a[4:7]
v_mfma_f32_16x16x32_bf16 a[8:11],v[212:215],a[72:75],a[8:11]
s_waitcnt lgkmcnt(4)
v_mfma_f32_16x16x32_bf16 v[80:83],v[216:219],a[64:67],v[80:83]
ds_read_b64_tr_b16 v[232:233],v252 offset:34240
v_mfma_f32_16x16x32_bf16 v[84:87],v[216:219],a[68:71],v[84:87]
ds_read_b64_tr_b16 v[234:235],v252 offset:34752
v_mfma_f32_16x16x32_bf16 v[88:91],v[216:219],a[72:75],v[88:91]
ds_read_b64_tr_b16 v[236:237],v252 offset:34248
v_accvgpr_read_b32 v200,a136
ds_read_b64_tr_b16 v[238:239],v252 offset:34760
v_accvgpr_read_b32 v201,a137
v_mfma_f32_16x16x32_bf16 a[16:19],v[220:223],a[64:67],a[16:19]
v_accvgpr_read_b32 v202,a138
v_accvgpr_read_b32 v203,a139
v_mfma_f32_16x16x32_bf16 a[20:23],v[220:223],a[68:71],a[20:23]
v_accvgpr_read_b32 v204,a152
v_accvgpr_read_b32 v205,a153
v_mfma_f32_16x16x32_bf16 a[24:27],v[220:223],a[72:75],a[24:27]
v_accvgpr_read_b32 v206,a154
v_accvgpr_read_b32 v207,a155
v_mul_f32 v200,v196,v200
s_waitcnt lgkmcnt(4)
v_mfma_f32_16x16x32_bf16 v[96:99],v[224:227],a[64:67],v[96:99]
ds_read_b64_tr_b16 v[208:209],v252 offset:50688
v_mul_f32 v201,v196,v201
v_mfma_f32_16x16x32_bf16 v[100:103],v[224:227],a[68:71],v[100:103]
ds_read_b64_tr_b16 v[210:211],v252 offset:51200
v_mul_f32 v202,v196,v202
v_mfma_f32_16x16x32_bf16 v[104:107],v[224:227],a[72:75],v[104:107]
ds_read_b64_tr_b16 v[212:213],v252 offset:50696
v_mul_f32 v203,v196,v203
ds_read_b64_tr_b16 v[214:215],v252 offset:51208
v_mul_f32 v204,v196,v204
v_mfma_f32_16x16x32_bf16 a[32:35],v[228:231],a[64:67],a[32:35]
v_mul_f32 v205,v196,v205
v_mul_f32 v206,v196,v206
v_mfma_f32_16x16x32_bf16 a[36:39],v[228:231],a[68:71],a[36:39]
v_mul_f32 v207,v196,v207
v_cvt_pk_bf16_f32 v240,v200,v201
v_mfma_f32_16x16x32_bf16 a[40:43],v[228:231],a[72:75],a[40:43]
v_cvt_pk_bf16_f32 v241,v202,v203
v_cvt_pk_bf16_f32 v242,v204,v205
v_cvt_pk_bf16_f32 v243,v206,v207
s_waitcnt lgkmcnt(4)
v_mfma_f32_16x16x32_bf16 v[112:115],v[232:235],a[64:67],v[112:115]
ds_read_b64_tr_b16 v[216:217],v252 offset:50752
s_add_u32 s60,s64,4096
v_mfma_f32_16x16x32_bf16 v[116:119],v[232:235],a[68:71],v[116:119]
ds_read_b64_tr_b16 v[218:219],v252 offset:51264
buffer_store_dwordx4 v[240:243],v248,s[20:23],s60 offen offset:0 sc1
v_mfma_f32_16x16x32_bf16 v[120:123],v[232:235],a[72:75],v[120:123]
ds_read_b64_tr_b16 v[220:221],v252 offset:50760
ds_read_b64_tr_b16 v[222:223],v252 offset:51272
v_mfma_f32_16x16x32_bf16 a[48:51],v[236:239],a[64:67],a[48:51]
v_mfma_f32_16x16x32_bf16 a[52:55],v[236:239],a[68:71],a[52:55]
v_mfma_f32_16x16x32_bf16 a[56:59],v[236:239],a[72:75],a[56:59]
s_waitcnt lgkmcnt(4)
v_mfma_f32_16x16x32_bf16 v[0:3],v[208:211],a[96:99],v[0:3]
ds_read_b64_tr_b16 v[224:225],v252 offset:50816
v_mfma_f32_16x16x32_bf16 v[4:7],v[208:211],a[100:103],v[4:7]
ds_read_b64_tr_b16 v[226:227],v252 offset:51328
v_mfma_f32_16x16x32_bf16 v[8:11],v[208:211],a[104:107],v[8:11]
ds_read_b64_tr_b16 v[228:229],v252 offset:50824
s_waitcnt vmcnt(12)
ds_read_b64_tr_b16 v[230:231],v252 offset:51336
v_mfma_f32_16x16x32_bf16 v[128:131],v[212:215],a[96:99],v[128:131]
ds_read_b128 a[64:67],v253 offset:16896
v_mfma_f32_16x16x32_bf16 v[132:135],v[212:215],a[100:103],v[132:135]
ds_read_b128 a[68:71],v253 offset:18944
v_mfma_f32_16x16x32_bf16 v[136:139],v[212:215],a[104:107],v[136:139]
ds_read_b128 a[72:75],v253 offset:33792
s_waitcnt lgkmcnt(7)
v_mfma_f32_16x16x32_bf16 v[16:19],v[216:219],a[96:99],v[16:19]
ds_read_b64_tr_b16 v[232:233],v252 offset:50880
v_mfma_f32_16x16x32_bf16 v[20:23],v[216:219],a[100:103],v[20:23]
ds_read_b64_tr_b16 v[234:235],v252 offset:51392
v_mfma_f32_16x16x32_bf16 v[24:27],v[216:219],a[104:107],v[24:27]
ds_read_b64_tr_b16 v[236:237],v252 offset:50888
ds_read_b64_tr_b16 v[238:239],v252 offset:51400
v_mfma_f32_16x16x32_bf16 v[144:147],v[220:223],a[96:99],v[144:147]
v_xor_b32 v253,64,v253
v_mfma_f32_16x16x32_bf16 v[148:151],v[220:223],a[100:103],v[148:151]
ds_read_b128 a[80:83],v253 offset:16896
v_mfma_f32_16x16x32_bf16 v[152:155],v[220:223],a[104:107],v[152:155]
ds_read_b128 a[84:87],v253 offset:18944
s_waitcnt lgkmcnt(9)
v_mfma_f32_16x16x32_bf16 v[32:35],v[224:227],a[96:99],v[32:35]
ds_read_b64_tr_b16 v[208:209],v252 offset:50944
v_mfma_f32_16x16x32_bf16 v[36:39],v[224:227],a[100:103],v[36:39]
ds_read_b64_tr_b16 v[210:211],v252 offset:51456
v_mfma_f32_16x16x32_bf16 v[40:43],v[224:227],a[104:107],v[40:43]
ds_read_b64_tr_b16 v[212:213],v252 offset:50952
ds_read_b64_tr_b16 v[214:215],v252 offset:51464
v_mfma_f32_16x16x32_bf16 v[160:163],v[228:231],a[96:99],v[160:163]
ds_read_b128 a[88:91],v253 offset:33792
v_mfma_f32_16x16x32_bf16 v[164:167],v[228:231],a[100:103],v[164:167]
v_xor_b32 v253,64,v253
v_mfma_f32_16x16x32_bf16 v[168:171],v[228:231],a[104:107],v[168:171]
s_waitcnt lgkmcnt(7)
v_mfma_f32_16x16x32_bf16 v[48:51],v[232:235],a[96:99],v[48:51]
ds_read_b64_tr_b16 v[216:217],v252 offset:51008
v_mfma_f32_16x16x32_bf16 v[52:55],v[232:235],a[100:103],v[52:55]
ds_read_b64_tr_b16 v[218:219],v252 offset:51520
v_mfma_f32_16x16x32_bf16 v[56:59],v[232:235],a[104:107],v[56:59]
ds_read_b64_tr_b16 v[220:221],v252 offset:51016
ds_read_b64_tr_b16 v[222:223],v252 offset:51528
v_mfma_f32_16x16x32_bf16 v[176:179],v[236:239],a[96:99],v[176:179]
v_mfma_f32_16x16x32_bf16 v[180:183],v[236:239],a[100:103],v[180:183]
v_mfma_f32_16x16x32_bf16 v[184:187],v[236:239],a[104:107],v[184:187]
s_waitcnt lgkmcnt(5)
v_mfma_f32_16x16x32_bf16 v[64:67],v[208:211],a[96:99],v[64:67]
ds_read_b64_tr_b16 v[224:225],v252 offset:51072
v_mfma_f32_16x16x32_bf16 v[68:71],v[208:211],a[100:103],v[68:71]
ds_read_b64_tr_b16 v[226:227],v252 offset:51584
v_mfma_f32_16x16x32_bf16 v[72:75],v[208:211],a[104:107],v[72:75]
ds_read_b64_tr_b16 v[228:229],v252 offset:51080
ds_read_b64_tr_b16 v[230:231],v252 offset:51592
v_mfma_f32_16x16x32_bf16 a[0:3],v[212:215],a[96:99],a[0:3]
v_mfma_f32_16x16x32_bf16 a[4:7],v[212:215],a[100:103],a[4:7]
v_mfma_f32_16x16x32_bf16 a[8:11],v[212:215],a[104:107],a[8:11]
s_add_u32 m0,s29,84096
s_waitcnt lgkmcnt(4)
v_mfma_f32_16x16x32_bf16 v[80:83],v[216:219],a[96:99],v[80:83]
ds_read_b64_tr_b16 v[232:233],v252 offset:51136
buffer_load_dwordx4 v255,s[4:7],s68 offen offset:384 lds
v_mfma_f32_16x16x32_bf16 v[84:87],v[216:219],a[100:103],v[84:87]
ds_read_b64_tr_b16 v[234:235],v252 offset:51648
s_add_u32 m0,m0,0x00000400
v_mfma_f32_16x16x32_bf16 v[88:91],v[216:219],a[104:107],v[88:91]
ds_read_b64_tr_b16 v[236:237],v252 offset:51144
ds_read_b64_tr_b16 v[238:239],v252 offset:51656
buffer_load_dwordx4 v255,s[4:7],s93 offen offset:384 lds
v_mfma_f32_16x16x32_bf16 a[16:19],v[220:223],a[96:99],a[16:19]
s_add_u32 m0,m0,0x00000400
v_mfma_f32_16x16x32_bf16 a[20:23],v[220:223],a[100:103],a[20:23]
v_mfma_f32_16x16x32_bf16 a[24:27],v[220:223],a[104:107],a[24:27]
buffer_load_dwordx4 v255,s[4:7],s94 offen offset:384 lds
s_add_u32 m0,m0,0x00000400
s_waitcnt lgkmcnt(4)
v_mfma_f32_16x16x32_bf16 v[96:99],v[224:227],a[96:99],v[96:99]
v_mfma_f32_16x16x32_bf16 v[100:103],v[224:227],a[100:103],v[100:103]
s_waitcnt vmcnt(7) lgkmcnt(0)
s_barrier
v_mfma_f32_16x16x32_bf16 v[104:107],v[224:227],a[104:107],v[104:107]
ds_read_b64_tr_b16 v[208:209],v252 offset:16896
buffer_load_dwordx4 v255,s[4:7],s95 offen offset:384 lds
ds_read_b64_tr_b16 v[210:211],v252 offset:17408
s_add_u32 m0,s29,100992
v_mfma_f32_16x16x32_bf16 a[32:35],v[228:231],a[96:99],a[32:35]
ds_read_b64_tr_b16 v[212:213],v252 offset:16904
buffer_load_dwordx4 v255,s[4:7],s96 offen offset:384 lds
v_mfma_f32_16x16x32_bf16 a[36:39],v[228:231],a[100:103],a[36:39]
ds_read_b64_tr_b16 v[214:215],v252 offset:17416
s_add_u32 m0,m0,0x00000400
v_mfma_f32_16x16x32_bf16 a[40:43],v[228:231],a[104:107],a[40:43]
buffer_load_dwordx4 v255,s[4:7],s97 offen offset:384 lds
v_mfma_f32_16x16x32_bf16 v[112:115],v[232:235],a[96:99],v[112:115]
ds_read_b64_tr_b16 v[216:217],v252 offset:16960
v_mfma_f32_16x16x32_bf16 v[116:119],v[232:235],a[100:103],v[116:119]
ds_read_b64_tr_b16 v[218:219],v252 offset:17472
v_mfma_f32_16x16x32_bf16 v[120:123],v[232:235],a[104:107],v[120:123]
ds_read_b64_tr_b16 v[220:221],v252 offset:16968
ds_read_b64_tr_b16 v[222:223],v252 offset:17480
v_mfma_f32_16x16x32_bf16 a[48:51],v[236:239],a[96:99],a[48:51]
v_accvgpr_read_b32 v200,a160
v_accvgpr_read_b32 v201,a161
v_mfma_f32_16x16x32_bf16 a[52:55],v[236:239],a[100:103],a[52:55]
v_accvgpr_read_b32 v202,a162
v_accvgpr_read_b32 v203,a163
v_mfma_f32_16x16x32_bf16 a[56:59],v[236:239],a[104:107],a[56:59]
v_accvgpr_read_b32 v204,a176
v_accvgpr_read_b32 v205,a177
s_add_u32 m0,s29,33792
s_waitcnt lgkmcnt(4)
v_mfma_f32_16x16x32_bf16 v[0:3],v[208:211],a[64:67],v[0:3]
ds_read_b64_tr_b16 v[224:225],v252 offset:17024
buffer_load_dwordx4 v254,s[16:19],s0 offen lds
v_mfma_f32_16x16x32_bf16 v[4:7],v[208:211],a[68:71],v[4:7]
ds_read_b64_tr_b16 v[226:227],v252 offset:17536
s_add_u32 m0,m0,0x00000428
v_mfma_f32_16x16x32_bf16 v[8:11],v[208:211],a[72:75],v[8:11]
ds_read_b64_tr_b16 v[228:229],v252 offset:17032
v_accvgpr_read_b32 v206,a178
ds_read_b64_tr_b16 v[230:231],v252 offset:17544
buffer_load_dwordx4 v254,s[16:19],s1 offen lds
v_mfma_f32_16x16x32_bf16 v[128:131],v[212:215],a[64:67],v[128:131]
s_add_u32 m0,m0,0x00000418
v_accvgpr_read_b32 v207,a179
v_mfma_f32_16x16x32_bf16 v[132:135],v[212:215],a[68:71],v[132:135]
v_mul_f32 v200,v192,v200
v_mul_f32 v201,v192,v201
v_mfma_f32_16x16x32_bf16 v[136:139],v[212:215],a[72:75],v[136:139]
buffer_load_dwordx4 v254,s[16:19],s2 offen lds
s_add_u32 m0,m0,0x00000428
v_mul_f32 v202,v192,v202
s_waitcnt lgkmcnt(4)
v_mfma_f32_16x16x32_bf16 v[16:19],v[216:219],a[64:67],v[16:19]
ds_read_b64_tr_b16 v[232:233],v252 offset:17088
v_mul_f32 v203,v192,v203
v_mfma_f32_16x16x32_bf16 v[20:23],v[216:219],a[68:71],v[20:23]
ds_read_b64_tr_b16 v[234:235],v252 offset:17600
buffer_load_dwordx4 v254,s[16:19],s3 offen lds
v_mfma_f32_16x16x32_bf16 v[24:27],v[216:219],a[72:75],v[24:27]
ds_read_b64_tr_b16 v[236:237],v252 offset:17096
v_mul_f32 v204,v192,v204
ds_read_b64_tr_b16 v[238:239],v252 offset:17608
v_mul_f32 v205,v192,v205
v_mfma_f32_16x16x32_bf16 v[144:147],v[220:223],a[64:67],v[144:147]
s_add_u32 s16,s16,262144
s_addc_u32 s17,s17,0
v_mfma_f32_16x16x32_bf16 v[148:151],v[220:223],a[68:71],v[148:151]
s_sub_u32 s18,s18,262144
s_add_u32 m0,s29,50688
v_mfma_f32_16x16x32_bf16 v[152:155],v[220:223],a[72:75],v[152:155]
buffer_load_dwordx4 v254,s[16:19],s0 offen lds
s_add_u32 m0,m0,0x00000428
s_nop 0
buffer_load_dwordx4 v254,s[16:19],s1 offen lds
s_waitcnt lgkmcnt(4)
v_mfma_f32_16x16x32_bf16 v[32:35],v[224:227],a[64:67],v[32:35]
ds_read_b64_tr_b16 v[208:209],v252 offset:17152
s_add_u32 m0,m0,0x00000418
v_mfma_f32_16x16x32_bf16 v[36:39],v[224:227],a[68:71],v[36:39]
ds_read_b64_tr_b16 v[210:211],v252 offset:17664
v_mul_f32 v206,v192,v206
v_mfma_f32_16x16x32_bf16 v[40:43],v[224:227],a[72:75],v[40:43]
ds_read_b64_tr_b16 v[212:213],v252 offset:17160
buffer_load_dwordx4 v254,s[16:19],s2 offen lds
ds_read_b64_tr_b16 v[214:215],v252 offset:17672
s_add_u32 m0,m0,0x00000428
v_mfma_f32_16x16x32_bf16 v[160:163],v[228:231],a[64:67],v[160:163]
v_mul_f32 v207,v192,v207
v_cvt_pk_bf16_f32 v240,v200,v201
v_mfma_f32_16x16x32_bf16 v[164:167],v[228:231],a[68:71],v[164:167]
buffer_load_dwordx4 v254,s[16:19],s3 offen lds
v_cvt_pk_bf16_f32 v241,v202,v203
v_mfma_f32_16x16x32_bf16 v[168:171],v[228:231],a[72:75],v[168:171]
s_add_u32 s16,s16,262144
s_addc_u32 s17,s17,0
s_sub_u32 s18,s18,262144
s_waitcnt lgkmcnt(4)
v_mfma_f32_16x16x32_bf16 v[48:51],v[232:235],a[64:67],v[48:51]
ds_read_b64_tr_b16 v[216:217],v252 offset:17216
s_add_u32 m0,s29,118272
v_mfma_f32_16x16x32_bf16 v[52:55],v[232:235],a[68:71],v[52:55]
ds_read_b64_tr_b16 v[218:219],v252 offset:17728
buffer_load_dword v195,s[4:7],0 offen offset:512 lds
v_mfma_f32_16x16x32_bf16 v[56:59],v[232:235],a[72:75],v[56:59]
ds_read_b64_tr_b16 v[220:221],v252 offset:17224
buffer_load_dword v197,s[16:19],0 offen offset:0 lds
ds_read_b64_tr_b16 v[222:223],v252 offset:17736
v_cvt_pk_bf16_f32 v242,v204,v205
v_mfma_f32_16x16x32_bf16 v[176:179],v[236:239],a[64:67],v[176:179]
v_cvt_pk_bf16_f32 v243,v206,v207
s_add_u32 s60,s62,4096
v_mfma_f32_16x16x32_bf16 v[180:183],v[236:239],a[68:71],v[180:183]
buffer_store_dwordx4 v[240:243],v248,s[20:23],s60 offen offset:1024 sc1
v_mfma_f32_16x16x32_bf16 v[184:187],v[236:239],a[72:75],v[184:187]
s_waitcnt lgkmcnt(4)
v_mfma_f32_16x16x32_bf16 v[64:67],v[208:211],a[64:67],v[64:67]
ds_read_b64_tr_b16 v[224:225],v252 offset:17280
v_mfma_f32_16x16x32_bf16 v[68:71],v[208:211],a[68:71],v[68:71]
ds_read_b64_tr_b16 v[226:227],v252 offset:17792
v_mfma_f32_16x16x32_bf16 v[72:75],v[208:211],a[72:75],v[72:75]
ds_read_b64_tr_b16 v[228:229],v252 offset:17288
ds_read_b64_tr_b16 v[230:231],v252 offset:17800
v_mfma_f32_16x16x32_bf16 a[0:3],v[212:215],a[64:67],a[0:3]
v_mfma_f32_16x16x32_bf16 a[4:7],v[212:215],a[68:71],a[4:7]
v_accvgpr_read_b32 v200,a164
v_accvgpr_read_b32 v201,a165
v_mfma_f32_16x16x32_bf16 a[8:11],v[212:215],a[72:75],a[8:11]
v_accvgpr_read_b32 v202,a166
v_accvgpr_read_b32 v203,a167
v_accvgpr_read_b32 v204,a180
s_waitcnt lgkmcnt(4)
v_mfma_f32_16x16x32_bf16 v[80:83],v[216:219],a[64:67],v[80:83]
ds_read_b64_tr_b16 v[232:233],v252 offset:17344
v_accvgpr_read_b32 v205,a181
v_mfma_f32_16x16x32_bf16 v[84:87],v[216:219],a[68:71],v[84:87]
ds_read_b64_tr_b16 v[234:235],v252 offset:17856
v_accvgpr_read_b32 v206,a182
v_mfma_f32_16x16x32_bf16 v[88:91],v[216:219],a[72:75],v[88:91]
ds_read_b64_tr_b16 v[236:237],v252 offset:17352
v_accvgpr_read_b32 v207,a183
ds_read_b64_tr_b16 v[238:239],v252 offset:17864
v_mul_f32 v200,v194,v200
v_mfma_f32_16x16x32_bf16 a[16:19],v[220:223],a[64:67],a[16:19]
v_mul_f32 v201,v194,v201
v_mul_f32 v202,v194,v202
v_mfma_f32_16x16x32_bf16 a[20:23],v[220:223],a[68:71],a[20:23]
v_mul_f32 v203,v194,v203
v_mul_f32 v204,v194,v204
v_mfma_f32_16x16x32_bf16 a[24:27],v[220:223],a[72:75],a[24:27]
v_mul_f32 v205,v194,v205
v_mul_f32 v206,v194,v206
v_mul_f32 v207,v194,v207
s_waitcnt lgkmcnt(4)
v_mfma_f32_16x16x32_bf16 v[96:99],v[224:227],a[64:67],v[96:99]
ds_read_b64_tr_b16 v[208:209],v252 offset:0
v_cvt_pk_bf16_f32 v244,v200,v201
v_mfma_f32_16x16x32_bf16 v[100:103],v[224:227],a[68:71],v[100:103]
ds_read_b64_tr_b16 v[210:211],v252 offset:512
v_cvt_pk_bf16_f32 v245,v202,v203
v_mfma_f32_16x16x32_bf16 v[104:107],v[224:227],a[72:75],v[104:107]
ds_read_b64_tr_b16 v[212:213],v252 offset:8
v_cvt_pk_bf16_f32 v246,v204,v205
ds_read_b64_tr_b16 v[214:215],v252 offset:520
v_cvt_pk_bf16_f32 v247,v206,v207
v_mfma_f32_16x16x32_bf16 a[32:35],v[228:231],a[64:67],a[32:35]
s_add_u32 s60,s63,4096
buffer_store_dwordx4 v[244:247],v248,s[20:23],s60 offen offset:1024 sc1
v_mfma_f32_16x16x32_bf16 a[36:39],v[228:231],a[68:71],a[36:39]
v_mfma_f32_16x16x32_bf16 a[40:43],v[228:231],a[72:75],a[40:43]
s_waitcnt lgkmcnt(4)
v_mfma_f32_16x16x32_bf16 v[112:115],v[232:235],a[64:67],v[112:115]
ds_read_b64_tr_b16 v[216:217],v252 offset:64
v_mfma_f32_16x16x32_bf16 v[116:119],v[232:235],a[68:71],v[116:119]
ds_read_b64_tr_b16 v[218:219],v252 offset:576
v_mfma_f32_16x16x32_bf16 v[120:123],v[232:235],a[72:75],v[120:123]
ds_read_b64_tr_b16 v[220:221],v252 offset:72
ds_read_b64_tr_b16 v[222:223],v252 offset:584
v_mfma_f32_16x16x32_bf16 a[48:51],v[236:239],a[64:67],a[48:51]
v_mfma_f32_16x16x32_bf16 a[52:55],v[236:239],a[68:71],a[52:55]
v_mfma_f32_16x16x32_bf16 a[56:59],v[236:239],a[72:75],a[56:59]
s_waitcnt lgkmcnt(4)
v_mfma_f32_16x16x32_bf16 v[0:3],v[208:211],a[80:83],v[0:3]
ds_read_b64_tr_b16 v[224:225],v252 offset:128
v_mfma_f32_16x16x32_bf16 v[4:7],v[208:211],a[84:87],v[4:7]
ds_read_b64_tr_b16 v[226:227],v252 offset:640
v_mfma_f32_16x16x32_bf16 v[8:11],v[208:211],a[88:91],v[8:11]
ds_read_b64_tr_b16 v[228:229],v252 offset:136
s_waitcnt vmcnt(12)
ds_read_b64_tr_b16 v[230:231],v252 offset:648
v_mfma_f32_16x16x32_bf16 v[128:131],v[212:215],a[80:83],v[128:131]
ds_read_b128 a[64:67],v253 offset:16896
v_mfma_f32_16x16x32_bf16 v[132:135],v[212:215],a[84:87],v[132:135]
ds_read_b128 a[68:71],v253 offset:18944
v_mfma_f32_16x16x32_bf16 v[136:139],v[212:215],a[88:91],v[136:139]
ds_read_b128 a[72:75],v253 offset:33792
s_waitcnt lgkmcnt(7)
v_mfma_f32_16x16x32_bf16 v[16:19],v[216:219],a[80:83],v[16:19]
ds_read_b64_tr_b16 v[232:233],v252 offset:192
v_mfma_f32_16x16x32_bf16 v[20:23],v[216:219],a[84:87],v[20:23]
ds_read_b64_tr_b16 v[234:235],v252 offset:704
v_mfma_f32_16x16x32_bf16 v[24:27],v[216:219],a[88:91],v[24:27]
ds_read_b64_tr_b16 v[236:237],v252 offset:200
ds_read_b64_tr_b16 v[238:239],v252 offset:712
v_mfma_f32_16x16x32_bf16 v[144:147],v[220:223],a[80:83],v[144:147]
v_xor_b32 v253,64,v253
v_mfma_f32_16x16x32_bf16 v[148:151],v[220:223],a[84:87],v[148:151]
ds_read_b128 a[96:99],v253 offset:16896
v_mfma_f32_16x16x32_bf16 v[152:155],v[220:223],a[88:91],v[152:155]
ds_read_b128 a[100:103],v253 offset:18944
v_accvgpr_read_b32 v200,a168
v_accvgpr_read_b32 v201,a169
s_waitcnt lgkmcnt(9)
v_mfma_f32_16x16x32_bf16 v[32:35],v[224:227],a[80:83],v[32:35]
ds_read_b64_tr_b16 v[208:209],v252 offset:256
v_accvgpr_read_b32 v202,a170
v_mfma_f32_16x16x32_bf16 v[36:39],v[224:227],a[84:87],v[36:39]
ds_read_b64_tr_b16 v[210:211],v252 offset:768
v_accvgpr_read_b32 v203,a171
v_mfma_f32_16x16x32_bf16 v[40:43],v[224:227],a[88:91],v[40:43]
ds_read_b64_tr_b16 v[212:213],v252 offset:264
v_accvgpr_read_b32 v204,a184
ds_read_b64_tr_b16 v[214:215],v252 offset:776
v_accvgpr_read_b32 v205,a185
v_mfma_f32_16x16x32_bf16 v[160:163],v[228:231],a[80:83],v[160:163]
ds_read_b128 a[104:107],v253 offset:33792
v_accvgpr_read_b32 v206,a186
v_mfma_f32_16x16x32_bf16 v[164:167],v[228:231],a[84:87],v[164:167]
v_xor_b32 v253,64,v253
v_accvgpr_read_b32 v207,a187
v_mfma_f32_16x16x32_bf16 v[168:171],v[228:231],a[88:91],v[168:171]
v_mul_f32 v200,v196,v200
v_mul_f32 v201,v196,v201
v_mul_f32 v202,v196,v202
s_waitcnt lgkmcnt(7)
v_mfma_f32_16x16x32_bf16 v[48:51],v[232:235],a[80:83],v[48:51]
ds_read_b64_tr_b16 v[216:217],v252 offset:320
v_mul_f32 v203,v196,v203
v_mfma_f32_16x16x32_bf16 v[52:55],v[232:235],a[84:87],v[52:55]
ds_read_b64_tr_b16 v[218:219],v252 offset:832
v_mul_f32 v204,v196,v204
v_mfma_f32_16x16x32_bf16 v[56:59],v[232:235],a[88:91],v[56:59]
ds_read_b64_tr_b16 v[220:221],v252 offset:328
v_mul_f32 v205,v196,v205
ds_read_b64_tr_b16 v[222:223],v252 offset:840
v_mul_f32 v206,v196,v206
v_mfma_f32_16x16x32_bf16 v[176:179],v[236:239],a[80:83],v[176:179]
v_mul_f32 v207,v196,v207
v_cvt_pk_bf16_f32 v240,v200,v201
v_mfma_f32_16x16x32_bf16 v[180:183],v[236:239],a[84:87],v[180:183]
v_cvt_pk_bf16_f32 v241,v202,v203
v_cvt_pk_bf16_f32 v242,v204,v205
v_mfma_f32_16x16x32_bf16 v[184:187],v[236:239],a[88:91],v[184:187]
v_cvt_pk_bf16_f32 v243,v206,v207
s_add_u32 s60,s64,4096
buffer_store_dwordx4 v[240:243],v248,s[20:23],s60 offen offset:1024 sc1
s_waitcnt lgkmcnt(5)
v_mfma_f32_16x16x32_bf16 v[64:67],v[208:211],a[80:83],v[64:67]
ds_read_b64_tr_b16 v[224:225],v252 offset:384
v_mfma_f32_16x16x32_bf16 v[68:71],v[208:211],a[84:87],v[68:71]
ds_read_b64_tr_b16 v[226:227],v252 offset:896
v_mfma_f32_16x16x32_bf16 v[72:75],v[208:211],a[88:91],v[72:75]
ds_read_b64_tr_b16 v[228:229],v252 offset:392
ds_read_b64_tr_b16 v[230:231],v252 offset:904
v_mfma_f32_16x16x32_bf16 a[0:3],v[212:215],a[80:83],a[0:3]
v_mfma_f32_16x16x32_bf16 a[4:7],v[212:215],a[84:87],a[4:7]
v_mfma_f32_16x16x32_bf16 a[8:11],v[212:215],a[88:91],a[8:11]
s_add_u32 m0,s29,83968
s_waitcnt lgkmcnt(4)
v_mfma_f32_16x16x32_bf16 v[80:83],v[216:219],a[80:83],v[80:83]
ds_read_b64_tr_b16 v[232:233],v252 offset:448
buffer_load_dwordx4 v255,s[4:7],s68 offen offset:512 lds
v_mfma_f32_16x16x32_bf16 v[84:87],v[216:219],a[84:87],v[84:87]
ds_read_b64_tr_b16 v[234:235],v252 offset:960
s_add_u32 m0,m0,0x00000400
v_mfma_f32_16x16x32_bf16 v[88:91],v[216:219],a[88:91],v[88:91]
ds_read_b64_tr_b16 v[236:237],v252 offset:456
ds_read_b64_tr_b16 v[238:239],v252 offset:968
buffer_load_dwordx4 v255,s[4:7],s93 offen offset:512 lds
v_mfma_f32_16x16x32_bf16 a[16:19],v[220:223],a[80:83],a[16:19]
s_add_u32 m0,m0,0x00000400
v_mfma_f32_16x16x32_bf16 a[20:23],v[220:223],a[84:87],a[20:23]
v_mfma_f32_16x16x32_bf16 a[24:27],v[220:223],a[88:91],a[24:27]
buffer_load_dwordx4 v255,s[4:7],s94 offen offset:512 lds
s_add_u32 m0,m0,0x00000400
s_waitcnt lgkmcnt(4)
v_mfma_f32_16x16x32_bf16 v[96:99],v[224:227],a[80:83],v[96:99]
v_mfma_f32_16x16x32_bf16 v[100:103],v[224:227],a[84:87],v[100:103]
s_waitcnt vmcnt(8) lgkmcnt(0)
s_barrier
v_mfma_f32_16x16x32_bf16 v[104:107],v[224:227],a[88:91],v[104:107]
ds_read_b64_tr_b16 v[208:209],v252 offset:33792
buffer_load_dwordx4 v255,s[4:7],s95 offen offset:512 lds
ds_read_b64_tr_b16 v[210:211],v252 offset:34304
s_add_u32 m0,s29,100864
v_mfma_f32_16x16x32_bf16 a[32:35],v[228:231],a[80:83],a[32:35]
ds_read_b64_tr_b16 v[212:213],v252 offset:33800
buffer_load_dwordx4 v255,s[4:7],s96 offen offset:512 lds
v_mfma_f32_16x16x32_bf16 a[36:39],v[228:231],a[84:87],a[36:39]
ds_read_b64_tr_b16 v[214:215],v252 offset:34312
s_add_u32 m0,m0,0x00000400
v_mfma_f32_16x16x32_bf16 a[40:43],v[228:231],a[88:91],a[40:43]
buffer_load_dwordx4 v255,s[4:7],s97 offen offset:512 lds
v_mfma_f32_16x16x32_bf16 v[112:115],v[232:235],a[80:83],v[112:115]
ds_read_b64_tr_b16 v[216:217],v252 offset:33856
v_mfma_f32_16x16x32_bf16 v[116:119],v[232:235],a[84:87],v[116:119]
ds_read_b64_tr_b16 v[218:219],v252 offset:34368
v_mfma_f32_16x16x32_bf16 v[120:123],v[232:235],a[88:91],v[120:123]
ds_read_b64_tr_b16 v[220:221],v252 offset:33864
ds_read_b64_tr_b16 v[222:223],v252 offset:34376
v_mfma_f32_16x16x32_bf16 a[48:51],v[236:239],a[80:83],a[48:51]
v_mfma_f32_16x16x32_bf16 a[52:55],v[236:239],a[84:87],a[52:55]
v_mfma_f32_16x16x32_bf16 a[56:59],v[236:239],a[88:91],a[56:59]
s_add_u32 m0,s29,16896
s_waitcnt lgkmcnt(4)
v_mfma_f32_16x16x32_bf16 v[0:3],v[208:211],a[64:67],v[0:3]
ds_read_b64_tr_b16 v[224:225],v252 offset:33920
buffer_load_dwordx4 v254,s[16:19],s0 offen lds
v_mfma_f32_16x16x32_bf16 v[4:7],v[208:211],a[68:71],v[4:7]
ds_read_b64_tr_b16 v[226:227],v252 offset:34432
s_add_u32 m0,m0,0x00000428
v_mfma_f32_16x16x32_bf16 v[8:11],v[208:211],a[72:75],v[8:11]
ds_read_b64_tr_b16 v[228:229],v252 offset:33928
ds_read_b64_tr_b16 v[230:231],v252 offset:34440
buffer_load_dwordx4 v254,s[16:19],s1 offen lds
v_mfma_f32_16x16x32_bf16 v[128:131],v[212:215],a[64:67],v[128:131]
s_add_u32 m0,m0,0x00000418
v_mfma_f32_16x16x32_bf16 v[132:135],v[212:215],a[68:71],v[132:135]
v_mfma_f32_16x16x32_bf16 v[136:139],v[212:215],a[72:75],v[136:139]
buffer_load_dwordx4 v254,s[16:19],s2 offen lds
s_add_u32 m0,m0,0x00000428
s_waitcnt lgkmcnt(4)
v_mfma_f32_16x16x32_bf16 v[16:19],v[216:219],a[64:67],v[16:19]
ds_read_b64_tr_b16 v[232:233],v252 offset:33984
v_mfma_f32_16x16x32_bf16 v[20:23],v[216:219],a[68:71],v[20:23]
ds_read_b64_tr_b16 v[234:235],v252 offset:34496
buffer_load_dwordx4 v254,s[16:19],s3 offen lds
v_mfma_f32_16x16x32_bf16 v[24:27],v[216:219],a[72:75],v[24:27]
ds_read_b64_tr_b16 v[236:237],v252 offset:33992
ds_read_b64_tr_b16 v[238:239],v252 offset:34504
v_mfma_f32_16x16x32_bf16 v[144:147],v[220:223],a[64:67],v[144:147]
s_add_u32 s16,s16,262144
s_addc_u32 s17,s17,0
v_mfma_f32_16x16x32_bf16 v[148:151],v[220:223],a[68:71],v[148:151]
s_sub_u32 s18,s18,262144
s_add_u32 m0,s29,0
v_mfma_f32_16x16x32_bf16 v[152:155],v[220:223],a[72:75],v[152:155]
buffer_load_dwordx4 v254,s[16:19],s0 offen lds
s_add_u32 m0,m0,0x00000428
s_nop 0
buffer_load_dwordx4 v254,s[16:19],s1 offen lds
s_waitcnt lgkmcnt(4)
v_mfma_f32_16x16x32_bf16 v[32:35],v[224:227],a[64:67],v[32:35]
ds_read_b64_tr_b16 v[208:209],v252 offset:34048
s_add_u32 m0,m0,0x00000418
v_mfma_f32_16x16x32_bf16 v[36:39],v[224:227],a[68:71],v[36:39]
ds_read_b64_tr_b16 v[210:211],v252 offset:34560
v_mfma_f32_16x16x32_bf16 v[40:43],v[224:227],a[72:75],v[40:43]
ds_read_b64_tr_b16 v[212:213],v252 offset:34056
buffer_load_dwordx4 v254,s[16:19],s2 offen lds
ds_read_b64_tr_b16 v[214:215],v252 offset:34568
s_add_u32 m0,m0,0x00000428
v_mfma_f32_16x16x32_bf16 v[160:163],v[228:231],a[64:67],v[160:163]
v_mfma_f32_16x16x32_bf16 v[164:167],v[228:231],a[68:71],v[164:167]
buffer_load_dwordx4 v254,s[16:19],s3 offen lds
v_mfma_f32_16x16x32_bf16 v[168:171],v[228:231],a[72:75],v[168:171]
s_add_u32 s16,s16,262144
s_addc_u32 s17,s17,0
s_sub_u32 s18,s18,262144
s_waitcnt lgkmcnt(4)
v_mfma_f32_16x16x32_bf16 v[48:51],v[232:235],a[64:67],v[48:51]
ds_read_b64_tr_b16 v[216:217],v252 offset:34112
s_add_u32 m0,s29,118272
v_mfma_f32_16x16x32_bf16 v[52:55],v[232:235],a[68:71],v[52:55]
ds_read_b64_tr_b16 v[218:219],v252 offset:34624
buffer_load_dword v195,s[4:7],0 offen offset:640 lds
v_mfma_f32_16x16x32_bf16 v[56:59],v[232:235],a[72:75],v[56:59]
ds_read_b64_tr_b16 v[220:221],v252 offset:34120
buffer_load_dword v197,s[16:19],0 offen offset:0 lds
ds_read_b64_tr_b16 v[222:223],v252 offset:34632
v_mfma_f32_16x16x32_bf16 v[176:179],v[236:239],a[64:67],v[176:179]
v_mfma_f32_16x16x32_bf16 v[180:183],v[236:239],a[68:71],v[180:183]
v_mfma_f32_16x16x32_bf16 v[184:187],v[236:239],a[72:75],v[184:187]
s_waitcnt lgkmcnt(4)
v_mfma_f32_16x16x32_bf16 v[64:67],v[208:211],a[64:67],v[64:67]
ds_read_b64_tr_b16 v[224:225],v252 offset:34176
v_accvgpr_read_b32 v200,a192
v_mfma_f32_16x16x32_bf16 v[68:71],v[208:211],a[68:71],v[68:71]
ds_read_b64_tr_b16 v[226:227],v252 offset:34688
v_accvgpr_read_b32 v201,a193
v_mfma_f32_16x16x32_bf16 v[72:75],v[208:211],a[72:75],v[72:75]
ds_read_b64_tr_b16 v[228:229],v252 offset:34184
v_accvgpr_read_b32 v202,a194
ds_read_b64_tr_b16 v[230:231],v252 offset:34696
v_accvgpr_read_b32 v203,a195
v_mfma_f32_16x16x32_bf16 a[0:3],v[212:215],a[64:67],a[0:3]
v_accvgpr_read_b32 v204,a208
v_accvgpr_read_b32 v205,a209
v_mfma_f32_16x16x32_bf16 a[4:7],v[212:215],a[68:71],a[4:7]
v_accvgpr_read_b32 v206,a210
v_accvgpr_read_b32 v207,a211
v_mfma_f32_16x16x32_bf16 a[8:11],v[212:215],a[72:75],a[8:11]
v_mul_f32 v200,v192,v200
v_mul_f32 v201,v192,v201
v_mul_f32 v202,v192,v202
s_waitcnt lgkmcnt(4)
v_mfma_f32_16x16x32_bf16 v[80:83],v[216:219],a[64:67],v[80:83]
ds_read_b64_tr_b16 v[232:233],v252 offset:34240
v_mul_f32 v203,v192,v203
v_mfma_f32_16x16x32_bf16 v[84:87],v[216:219],a[68:71],v[84:87]
ds_read_b64_tr_b16 v[234:235],v252 offset:34752
v_mul_f32 v204,v192,v204
v_mfma_f32_16x16x32_bf16 v[88:91],v[216:219],a[72:75],v[88:91]
ds_read_b64_tr_b16 v[236:237],v252 offset:34248
v_mul_f32 v205,v192,v205
ds_read_b64_tr_b16 v[238:239],v252 offset:34760
v_mul_f32 v206,v192,v206
v_mfma_f32_16x16x32_bf16 a[16:19],v[220:223],a[64:67],a[16:19]
v_mul_f32 v207,v192,v207
v_cvt_pk_bf16_f32 v240,v200,v201
v_mfma_f32_16x16x32_bf16 a[20:23],v[220:223],a[68:71],a[20:23]
v_cvt_pk_bf16_f32 v241,v202,v203
v_cvt_pk_bf16_f32 v242,v204,v205
v_mfma_f32_16x16x32_bf16 a[24:27],v[220:223],a[72:75],a[24:27]
v_cvt_pk_bf16_f32 v243,v206,v207
s_add_u32 s60,s62,4096
buffer_store_dwordx4 v[240:243],v248,s[20:23],s60 offen offset:2048 sc1
s_waitcnt lgkmcnt(4)
v_mfma_f32_16x16x32_bf16 v[96:99],v[224:227],a[64:67],v[96:99]
ds_read_b64_tr_b16 v[208:209],v252 offset:50688
v_mfma_f32_16x16x32_bf16 v[100:103],v[224:227],a[68:71],v[100:103]
ds_read_b64_tr_b16 v[210:211],v252 offset:51200
v_mfma_f32_16x16x32_bf16 v[104:107],v[224:227],a[72:75],v[104:107]
ds_read_b64_tr_b16 v[212:213],v252 offset:50696
ds_read_b64_tr_b16 v[214:215],v252 offset:51208
v_mfma_f32_16x16x32_bf16 a[32:35],v[228:231],a[64:67],a[32:35]
v_mfma_f32_16x16x32_bf16 a[36:39],v[228:231],a[68:71],a[36:39]
v_mfma_f32_16x16x32_bf16 a[40:43],v[228:231],a[72:75],a[40:43]
s_waitcnt lgkmcnt(4)
v_mfma_f32_16x16x32_bf16 v[112:115],v[232:235],a[64:67],v[112:115]
ds_read_b64_tr_b16 v[216:217],v252 offset:50752
v_mfma_f32_16x16x32_bf16 v[116:119],v[232:235],a[68:71],v[116:119]
ds_read_b64_tr_b16 v[218:219],v252 offset:51264
v_mfma_f32_16x16x32_bf16 v[120:123],v[232:235],a[72:75],v[120:123]
ds_read_b64_tr_b16 v[220:221],v252 offset:50760
ds_read_b64_tr_b16 v[222:223],v252 offset:51272
v_mfma_f32_16x16x32_bf16 a[48:51],v[236:239],a[64:67],a[48:51]
v_mfma_f32_16x16x32_bf16 a[52:55],v[236:239],a[68:71],a[52:55]
v_mfma_f32_16x16x32_bf16 a[56:59],v[236:239],a[72:75],a[56:59]
s_waitcnt lgkmcnt(4)
v_mfma_f32_16x16x32_bf16 v[0:3],v[208:211],a[96:99],v[0:3]
ds_read_b64_tr_b16 v[224:225],v252 offset:50816
v_mfma_f32_16x16x32_bf16 v[4:7],v[208:211],a[100:103],v[4:7]
ds_read_b64_tr_b16 v[226:227],v252 offset:51328
v_mfma_f32_16x16x32_bf16 v[8:11],v[208:211],a[104:107],v[8:11]
ds_read_b64_tr_b16 v[228:229],v252 offset:50824
s_waitcnt vmcnt(11)
ds_read_b64_tr_b16 v[230:231],v252 offset:51336
v_mfma_f32_16x16x32_bf16 v[128:131],v[212:215],a[96:99],v[128:131]
ds_read_b128 a[64:67],v253 offset:16896
v_mfma_f32_16x16x32_bf16 v[132:135],v[212:215],a[100:103],v[132:135]
ds_read_b128 a[68:71],v253 offset:18944
v_mfma_f32_16x16x32_bf16 v[136:139],v[212:215],a[104:107],v[136:139]
ds_read_b128 a[72:75],v253 offset:33792
s_waitcnt lgkmcnt(7)
v_mfma_f32_16x16x32_bf16 v[16:19],v[216:219],a[96:99],v[16:19]
ds_read_b64_tr_b16 v[232:233],v252 offset:50880
v_mfma_f32_16x16x32_bf16 v[20:23],v[216:219],a[100:103],v[20:23]
ds_read_b64_tr_b16 v[234:235],v252 offset:51392
v_accvgpr_read_b32 v200,a196
v_mfma_f32_16x16x32_bf16 v[24:27],v[216:219],a[104:107],v[24:27]
ds_read_b64_tr_b16 v[236:237],v252 offset:50888
v_accvgpr_read_b32 v201,a197
ds_read_b64_tr_b16 v[238:239],v252 offset:51400
v_accvgpr_read_b32 v202,a198
v_mfma_f32_16x16x32_bf16 v[144:147],v[220:223],a[96:99],v[144:147]
v_xor_b32 v253,64,v253
v_accvgpr_read_b32 v203,a199
v_mfma_f32_16x16x32_bf16 v[148:151],v[220:223],a[100:103],v[148:151]
ds_read_b128 a[80:83],v253 offset:16896
v_accvgpr_read_b32 v204,a212
v_mfma_f32_16x16x32_bf16 v[152:155],v[220:223],a[104:107],v[152:155]
ds_read_b128 a[84:87],v253 offset:18944
v_accvgpr_read_b32 v205,a213
v_accvgpr_read_b32 v206,a214
s_waitcnt lgkmcnt(9)
v_mfma_f32_16x16x32_bf16 v[32:35],v[224:227],a[96:99],v[32:35]
ds_read_b64_tr_b16 v[208:209],v252 offset:50944
v_accvgpr_read_b32 v207,a215
v_mfma_f32_16x16x32_bf16 v[36:39],v[224:227],a[100:103],v[36:39]
ds_read_b64_tr_b16 v[210:211],v252 offset:51456
v_mul_f32 v200,v194,v200
v_mfma_f32_16x16x32_bf16 v[40:43],v[224:227],a[104:107],v[40:43]
ds_read_b64_tr_b16 v[212:213],v252 offset:50952
v_mul_f32 v201,v194,v201
ds_read_b64_tr_b16 v[214:215],v252 offset:51464
v_mul_f32 v202,v194,v202
v_mfma_f32_16x16x32_bf16 v[160:163],v[228:231],a[96:99],v[160:163]
ds_read_b128 a[88:91],v253 offset:33792
v_mul_f32 v203,v194,v203
v_mfma_f32_16x16x32_bf16 v[164:167],v[228:231],a[100:103],v[164:167]
v_xor_b32 v253,64,v253
v_mul_f32 v204,v194,v204
v_mfma_f32_16x16x32_bf16 v[168:171],v[228:231],a[104:107],v[168:171]
v_mul_f32 v205,v194,v205
v_mul_f32 v206,v194,v206
v_mul_f32 v207,v194,v207
s_waitcnt lgkmcnt(7)
v_mfma_f32_16x16x32_bf16 v[48:51],v[232:235],a[96:99],v[48:51]
ds_read_b64_tr_b16 v[216:217],v252 offset:51008
v_cvt_pk_bf16_f32 v244,v200,v201
v_mfma_f32_16x16x32_bf16 v[52:55],v[232:235],a[100:103],v[52:55]
ds_read_b64_tr_b16 v[218:219],v252 offset:51520
v_cvt_pk_bf16_f32 v245,v202,v203
v_mfma_f32_16x16x32_bf16 v[56:59],v[232:235],a[104:107],v[56:59]
ds_read_b64_tr_b16 v[220:221],v252 offset:51016
v_cvt_pk_bf16_f32 v246,v204,v205
ds_read_b64_tr_b16 v[222:223],v252 offset:51528
v_cvt_pk_bf16_f32 v247,v206,v207
v_mfma_f32_16x16x32_bf16 v[176:179],v[236:239],a[96:99],v[176:179]
s_add_u32 s60,s63,4096
buffer_store_dwordx4 v[244:247],v248,s[20:23],s60 offen offset:2048 sc1
v_mfma_f32_16x16x32_bf16 v[180:183],v[236:239],a[100:103],v[180:183]
v_mfma_f32_16x16x32_bf16 v[184:187],v[236:239],a[104:107],v[184:187]
s_waitcnt lgkmcnt(5)
v_mfma_f32_16x16x32_bf16 v[64:67],v[208:211],a[96:99],v[64:67]
ds_read_b64_tr_b16 v[224:225],v252 offset:51072
v_mfma_f32_16x16x32_bf16 v[68:71],v[208:211],a[100:103],v[68:71]
ds_read_b64_tr_b16 v[226:227],v252 offset:51584
v_mfma_f32_16x16x32_bf16 v[72:75],v[208:211],a[104:107],v[72:75]
ds_read_b64_tr_b16 v[228:229],v252 offset:51080
ds_read_b64_tr_b16 v[230:231],v252 offset:51592
v_mfma_f32_16x16x32_bf16 a[0:3],v[212:215],a[96:99],a[0:3]
v_mfma_f32_16x16x32_bf16 a[4:7],v[212:215],a[100:103],a[4:7]
v_mfma_f32_16x16x32_bf16 a[8:11],v[212:215],a[104:107],a[8:11]
s_add_u32 m0,s29,83840
s_waitcnt lgkmcnt(4)
v_mfma_f32_16x16x32_bf16 v[80:83],v[216:219],a[96:99],v[80:83]
ds_read_b64_tr_b16 v[232:233],v252 offset:51136
buffer_load_dwordx4 v255,s[4:7],s68 offen offset:640 lds
v_mfma_f32_16x16x32_bf16 v[84:87],v[216:219],a[100:103],v[84:87]
ds_read_b64_tr_b16 v[234:235],v252 offset:51648
s_add_u32 m0,m0,0x00000400
v_mfma_f32_16x16x32_bf16 v[88:91],v[216:219],a[104:107],v[88:91]
ds_read_b64_tr_b16 v[236:237],v252 offset:51144
ds_read_b64_tr_b16 v[238:239],v252 offset:51656
buffer_load_dwordx4 v255,s[4:7],s93 offen offset:640 lds
v_mfma_f32_16x16x32_bf16 a[16:19],v[220:223],a[96:99],a[16:19]
s_add_u32 m0,m0,0x00000400
v_mfma_f32_16x16x32_bf16 a[20:23],v[220:223],a[100:103],a[20:23]
v_mfma_f32_16x16x32_bf16 a[24:27],v[220:223],a[104:107],a[24:27]
buffer_load_dwordx4 v255,s[4:7],s94 offen offset:640 lds
s_add_u32 m0,m0,0x00000400
s_waitcnt lgkmcnt(4)
v_mfma_f32_16x16x32_bf16 v[96:99],v[224:227],a[96:99],v[96:99]
v_mfma_f32_16x16x32_bf16 v[100:103],v[224:227],a[100:103],v[100:103]
s_waitcnt vmcnt(7) lgkmcnt(0)
s_barrier
v_mfma_f32_16x16x32_bf16 v[104:107],v[224:227],a[104:107],v[104:107]
ds_read_b64_tr_b16 v[208:209],v252 offset:16896
buffer_load_dwordx4 v255,s[4:7],s95 offen offset:640 lds
ds_read_b64_tr_b16 v[210:211],v252 offset:17408
s_add_u32 m0,s29,100736
v_mfma_f32_16x16x32_bf16 a[32:35],v[228:231],a[96:99],a[32:35]
ds_read_b64_tr_b16 v[212:213],v252 offset:16904
buffer_load_dwordx4 v255,s[4:7],s96 offen offset:640 lds
v_mfma_f32_16x16x32_bf16 a[36:39],v[228:231],a[100:103],a[36:39]
ds_read_b64_tr_b16 v[214:215],v252 offset:17416
s_add_u32 m0,m0,0x00000400
v_mfma_f32_16x16x32_bf16 a[40:43],v[228:231],a[104:107],a[40:43]
v_accvgpr_read_b32 v200,a200
v_accvgpr_read_b32 v201,a201
buffer_load_dwordx4 v255,s[4:7],s97 offen offset:640 lds
v_accvgpr_read_b32 v202,a202
v_mfma_f32_16x16x32_bf16 v[112:115],v[232:235],a[96:99],v[112:115]
ds_read_b64_tr_b16 v[216:217],v252 offset:16960
v_accvgpr_read_b32 v203,a203
v_mfma_f32_16x16x32_bf16 v[116:119],v[232:235],a[100:103],v[116:119]
ds_read_b64_tr_b16 v[218:219],v252 offset:17472
v_accvgpr_read_b32 v204,a216
v_mfma_f32_16x16x32_bf16 v[120:123],v[232:235],a[104:107],v[120:123]
ds_read_b64_tr_b16 v[220:221],v252 offset:16968
v_accvgpr_read_b32 v205,a217
ds_read_b64_tr_b16 v[222:223],v252 offset:17480
v_accvgpr_read_b32 v206,a218
v_mfma_f32_16x16x32_bf16 a[48:51],v[236:239],a[96:99],a[48:51]
v_accvgpr_read_b32 v207,a219
v_mul_f32 v200,v196,v200
v_mfma_f32_16x16x32_bf16 a[52:55],v[236:239],a[100:103],a[52:55]
v_mul_f32 v201,v196,v201
v_mul_f32 v202,v196,v202
v_mfma_f32_16x16x32_bf16 a[56:59],v[236:239],a[104:107],a[56:59]
v_mul_f32 v203,v196,v203
v_mul_f32 v204,v196,v204
s_add_u32 m0,s29,33792
s_waitcnt lgkmcnt(4)
v_mfma_f32_16x16x32_bf16 v[0:3],v[208:211],a[64:67],v[0:3]
ds_read_b64_tr_b16 v[224:225],v252 offset:17024
buffer_load_dwordx4 v254,s[16:19],s0 offen lds
v_mfma_f32_16x16x32_bf16 v[4:7],v[208:211],a[68:71],v[4:7]
ds_read_b64_tr_b16 v[226:227],v252 offset:17536
s_add_u32 m0,m0,0x00000428
v_mfma_f32_16x16x32_bf16 v[8:11],v[208:211],a[72:75],v[8:11]
ds_read_b64_tr_b16 v[228:229],v252 offset:17032
v_mul_f32 v205,v196,v205
ds_read_b64_tr_b16 v[230:231],v252 offset:17544
buffer_load_dwordx4 v254,s[16:19],s1 offen lds
v_mfma_f32_16x16x32_bf16 v[128:131],v[212:215],a[64:67],v[128:131]
s_add_u32 m0,m0,0x00000418
v_mul_f32 v206,v196,v206
v_mfma_f32_16x16x32_bf16 v[132:135],v[212:215],a[68:71],v[132:135]
v_mul_f32 v207,v196,v207
v_cvt_pk_bf16_f32 v240,v200,v201
v_mfma_f32_16x16x32_bf16 v[136:139],v[212:215],a[72:75],v[136:139]
buffer_load_dwordx4 v254,s[16:19],s2 offen lds
s_add_u32 m0,m0,0x00000428
v_cvt_pk_bf16_f32 v241,v202,v203
s_waitcnt lgkmcnt(4)
v_mfma_f32_16x16x32_bf16 v[16:19],v[216:219],a[64:67],v[16:19]
ds_read_b64_tr_b16 v[232:233],v252 offset:17088
v_cvt_pk_bf16_f32 v242,v204,v205
v_mfma_f32_16x16x32_bf16 v[20:23],v[216:219],a[68:71],v[20:23]
ds_read_b64_tr_b16 v[234:235],v252 offset:17600
buffer_load_dwordx4 v254,s[16:19],s3 offen lds
v_mfma_f32_16x16x32_bf16 v[24:27],v[216:219],a[72:75],v[24:27]
ds_read_b64_tr_b16 v[236:237],v252 offset:17096
v_cvt_pk_bf16_f32 v243,v206,v207
ds_read_b64_tr_b16 v[238:239],v252 offset:17608
s_add_u32 s60,s64,4096
v_mfma_f32_16x16x32_bf16 v[144:147],v[220:223],a[64:67],v[144:147]
s_add_u32 s16,s16,262144
s_addc_u32 s17,s17,0
v_mfma_f32_16x16x32_bf16 v[148:151],v[220:223],a[68:71],v[148:151]
s_sub_u32 s18,s18,262144
s_add_u32 m0,s29,50688
v_mfma_f32_16x16x32_bf16 v[152:155],v[220:223],a[72:75],v[152:155]
buffer_load_dwordx4 v254,s[16:19],s0 offen lds
s_add_u32 m0,m0,0x00000428
s_nop 0
buffer_load_dwordx4 v254,s[16:19],s1 offen lds
s_waitcnt lgkmcnt(4)
v_mfma_f32_16x16x32_bf16 v[32:35],v[224:227],a[64:67],v[32:35]
ds_read_b64_tr_b16 v[208:209],v252 offset:17152
s_add_u32 m0,m0,0x00000418
v_mfma_f32_16x16x32_bf16 v[36:39],v[224:227],a[68:71],v[36:39]
ds_read_b64_tr_b16 v[210:211],v252 offset:17664
buffer_store_dwordx4 v[240:243],v248,s[20:23],s60 offen offset:2048 sc1
v_mfma_f32_16x16x32_bf16 v[40:43],v[224:227],a[72:75],v[40:43]
ds_read_b64_tr_b16 v[212:213],v252 offset:17160
buffer_load_dwordx4 v254,s[16:19],s2 offen lds
ds_read_b64_tr_b16 v[214:215],v252 offset:17672
s_add_u32 m0,m0,0x00000428
v_mfma_f32_16x16x32_bf16 v[160:163],v[228:231],a[64:67],v[160:163]
v_mfma_f32_16x16x32_bf16 v[164:167],v[228:231],a[68:71],v[164:167]
buffer_load_dwordx4 v254,s[16:19],s3 offen lds
v_mfma_f32_16x16x32_bf16 v[168:171],v[228:231],a[72:75],v[168:171]
s_add_u32 s16,s16,262144
s_addc_u32 s17,s17,0
s_sub_u32 s18,s18,262144
s_waitcnt lgkmcnt(4)
v_mfma_f32_16x16x32_bf16 v[48:51],v[232:235],a[64:67],v[48:51]
ds_read_b64_tr_b16 v[216:217],v252 offset:17216
s_add_u32 m0,s29,118272
v_mfma_f32_16x16x32_bf16 v[52:55],v[232:235],a[68:71],v[52:55]
ds_read_b64_tr_b16 v[218:219],v252 offset:17728
buffer_load_dword v195,s[4:7],0 offen offset:768 lds
v_mfma_f32_16x16x32_bf16 v[56:59],v[232:235],a[72:75],v[56:59]
ds_read_b64_tr_b16 v[220:221],v252 offset:17224
buffer_load_dword v197,s[16:19],0 offen offset:0 lds
ds_read_b64_tr_b16 v[222:223],v252 offset:17736
s_add_u32 m0,s29,118272
v_mfma_f32_16x16x32_bf16 v[176:179],v[236:239],a[64:67],v[176:179]
buffer_load_dwordx4 v251,s[8:11],s30 offen offset:0 nt lds
s_add_u32 m0,s29,118816
v_mfma_f32_16x16x32_bf16 v[180:183],v[236:239],a[68:71],v[180:183]
buffer_load_dwordx4 v251,s[8:11],s30 offen offset:512 nt lds
s_add_u32 m0,s29,119360
v_mfma_f32_16x16x32_bf16 v[184:187],v[236:239],a[72:75],v[184:187]
buffer_load_dwordx4 v251,s[8:11],s30 offen offset:1024 nt lds
s_add_u32 m0,s29,119904
s_nop 0
buffer_load_dwordx4 v251,s[8:11],s30 offen offset:1536 nt lds
s_waitcnt lgkmcnt(4)
v_mfma_f32_16x16x32_bf16 v[64:67],v[208:211],a[64:67],v[64:67]
ds_read_b64_tr_b16 v[224:225],v252 offset:17280
s_add_u32 s30,s30,16384
v_mfma_f32_16x16x32_bf16 v[68:71],v[208:211],a[68:71],v[68:71]
ds_read_b64_tr_b16 v[226:227],v252 offset:17792
v_mfma_f32_16x16x32_bf16 v[72:75],v[208:211],a[72:75],v[72:75]
ds_read_b64_tr_b16 v[228:229],v252 offset:17288
ds_read_b64_tr_b16 v[230:231],v252 offset:17800
v_mfma_f32_16x16x32_bf16 a[0:3],v[212:215],a[64:67],a[0:3]
v_mfma_f32_16x16x32_bf16 a[4:7],v[212:215],a[68:71],a[4:7]
v_mfma_f32_16x16x32_bf16 a[8:11],v[212:215],a[72:75],a[8:11]
s_waitcnt lgkmcnt(4)
v_mfma_f32_16x16x32_bf16 v[80:83],v[216:219],a[64:67],v[80:83]
ds_read_b64_tr_b16 v[232:233],v252 offset:17344
v_mfma_f32_16x16x32_bf16 v[84:87],v[216:219],a[68:71],v[84:87]
ds_read_b64_tr_b16 v[234:235],v252 offset:17856
v_mfma_f32_16x16x32_bf16 v[88:91],v[216:219],a[72:75],v[88:91]
ds_read_b64_tr_b16 v[236:237],v252 offset:17352
ds_read_b64_tr_b16 v[238:239],v252 offset:17864
v_mfma_f32_16x16x32_bf16 a[16:19],v[220:223],a[64:67],a[16:19]
v_mfma_f32_16x16x32_bf16 a[20:23],v[220:223],a[68:71],a[20:23]
v_mfma_f32_16x16x32_bf16 a[24:27],v[220:223],a[72:75],a[24:27]
s_waitcnt lgkmcnt(4)
v_mfma_f32_16x16x32_bf16 v[96:99],v[224:227],a[64:67],v[96:99]
ds_read_b64_tr_b16 v[208:209],v252 offset:0
v_mfma_f32_16x16x32_bf16 v[100:103],v[224:227],a[68:71],v[100:103]
ds_read_b64_tr_b16 v[210:211],v252 offset:512
v_mfma_f32_16x16x32_bf16 v[104:107],v[224:227],a[72:75],v[104:107]
ds_read_b64_tr_b16 v[212:213],v252 offset:8
ds_read_b64_tr_b16 v[214:215],v252 offset:520
v_mfma_f32_16x16x32_bf16 a[32:35],v[228:231],a[64:67],a[32:35]
v_mfma_f32_16x16x32_bf16 a[36:39],v[228:231],a[68:71],a[36:39]
v_mfma_f32_16x16x32_bf16 a[40:43],v[228:231],a[72:75],a[40:43]
s_waitcnt lgkmcnt(4)
v_mfma_f32_16x16x32_bf16 v[112:115],v[232:235],a[64:67],v[112:115]
ds_read_b64_tr_b16 v[216:217],v252 offset:64
v_mfma_f32_16x16x32_bf16 v[116:119],v[232:235],a[68:71],v[116:119]
ds_read_b64_tr_b16 v[218:219],v252 offset:576
v_mfma_f32_16x16x32_bf16 v[120:123],v[232:235],a[72:75],v[120:123]
ds_read_b64_tr_b16 v[220:221],v252 offset:72
ds_read_b64_tr_b16 v[222:223],v252 offset:584
v_mfma_f32_16x16x32_bf16 a[48:51],v[236:239],a[64:67],a[48:51]
v_mfma_f32_16x16x32_bf16 a[52:55],v[236:239],a[68:71],a[52:55]
v_mfma_f32_16x16x32_bf16 a[56:59],v[236:239],a[72:75],a[56:59]
s_waitcnt lgkmcnt(4)
v_mfma_f32_16x16x32_bf16 v[0:3],v[208:211],a[80:83],v[0:3]
ds_read_b64_tr_b16 v[224:225],v252 offset:128
v_mfma_f32_16x16x32_bf16 v[4:7],v[208:211],a[84:87],v[4:7]
ds_read_b64_tr_b16 v[226:227],v252 offset:640
v_mfma_f32_16x16x32_bf16 v[8:11],v[208:211],a[88:91],v[8:11]
ds_read_b64_tr_b16 v[228:229],v252 offset:136
s_waitcnt vmcnt(15)
ds_read_b64_tr_b16 v[230:231],v252 offset:648
v_mfma_f32_16x16x32_bf16 v[128:131],v[212:215],a[80:83],v[128:131]
ds_read_b128 a[64:67],v253 offset:16896
v_accvgpr_read_b32 v200,a224
v_mfma_f32_16x16x32_bf16 v[132:135],v[212:215],a[84:87],v[132:135]
ds_read_b128 a[68:71],v253 offset:18944
v_accvgpr_read_b32 v201,a225
v_mfma_f32_16x16x32_bf16 v[136:139],v[212:215],a[88:91],v[136:139]
ds_read_b128 a[72:75],v253 offset:33792
v_accvgpr_read_b32 v202,a226
v_accvgpr_read_b32 v203,a227
s_waitcnt lgkmcnt(7)
v_mfma_f32_16x16x32_bf16 v[16:19],v[216:219],a[80:83],v[16:19]
ds_read_b64_tr_b16 v[232:233],v252 offset:192
v_accvgpr_read_b32 v204,a240
v_mfma_f32_16x16x32_bf16 v[20:23],v[216:219],a[84:87],v[20:23]
ds_read_b64_tr_b16 v[234:235],v252 offset:704
v_accvgpr_read_b32 v205,a241
v_mfma_f32_16x16x32_bf16 v[24:27],v[216:219],a[88:91],v[24:27]
ds_read_b64_tr_b16 v[236:237],v252 offset:200
v_accvgpr_read_b32 v206,a242
ds_read_b64_tr_b16 v[238:239],v252 offset:712
v_accvgpr_read_b32 v207,a243
v_mfma_f32_16x16x32_bf16 v[144:147],v[220:223],a[80:83],v[144:147]
v_xor_b32 v253,64,v253
v_mul_f32 v200,v192,v200
v_mfma_f32_16x16x32_bf16 v[148:151],v[220:223],a[84:87],v[148:151]
ds_read_b128 a[96:99],v253 offset:16896
v_mul_f32 v201,v192,v201
v_mfma_f32_16x16x32_bf16 v[152:155],v[220:223],a[88:91],v[152:155]
ds_read_b128 a[100:103],v253 offset:18944
v_mul_f32 v202,v192,v202
v_mul_f32 v203,v192,v203
s_waitcnt lgkmcnt(9)
v_mfma_f32_16x16x32_bf16 v[32:35],v[224:227],a[80:83],v[32:35]
ds_read_b64_tr_b16 v[208:209],v252 offset:256
v_mul_f32 v204,v192,v204
v_mfma_f32_16x16x32_bf16 v[36:39],v[224:227],a[84:87],v[36:39]
ds_read_b64_tr_b16 v[210:211],v252 offset:768
v_mul_f32 v205,v192,v205
v_mfma_f32_16x16x32_bf16 v[40:43],v[224:227],a[88:91],v[40:43]
ds_read_b64_tr_b16 v[212:213],v252 offset:264
v_mul_f32 v206,v192,v206
ds_read_b64_tr_b16 v[214:215],v252 offset:776
v_mul_f32 v207,v192,v207
v_mfma_f32_16x16x32_bf16 v[160:163],v[228:231],a[80:83],v[160:163]
ds_read_b128 a[104:107],v253 offset:33792
v_cvt_pk_bf16_f32 v240,v200,v201
v_mfma_f32_16x16x32_bf16 v[164:167],v[228:231],a[84:87],v[164:167]
v_xor_b32 v253,64,v253
v_cvt_pk_bf16_f32 v241,v202,v203
v_mfma_f32_16x16x32_bf16 v[168:171],v[228:231],a[88:91],v[168:171]
v_cvt_pk_bf16_f32 v242,v204,v205
v_cvt_pk_bf16_f32 v243,v206,v207
s_add_u32 s60,s62,4096
s_waitcnt lgkmcnt(7)
v_mfma_f32_16x16x32_bf16 v[48:51],v[232:235],a[80:83],v[48:51]
ds_read_b64_tr_b16 v[216:217],v252 offset:320
buffer_store_dwordx4 v[240:243],v248,s[20:23],s60 offen offset:3072 sc1
v_mfma_f32_16x16x32_bf16 v[52:55],v[232:235],a[84:87],v[52:55]
ds_read_b64_tr_b16 v[218:219],v252 offset:832
v_mfma_f32_16x16x32_bf16 v[56:59],v[232:235],a[88:91],v[56:59]
ds_read_b64_tr_b16 v[220:221],v252 offset:328
ds_read_b64_tr_b16 v[222:223],v252 offset:840
v_mfma_f32_16x16x32_bf16 v[176:179],v[236:239],a[80:83],v[176:179]
v_mfma_f32_16x16x32_bf16 v[180:183],v[236:239],a[84:87],v[180:183]
v_mfma_f32_16x16x32_bf16 v[184:187],v[236:239],a[88:91],v[184:187]
s_waitcnt lgkmcnt(5)
v_mfma_f32_16x16x32_bf16 v[64:67],v[208:211],a[80:83],v[64:67]
ds_read_b64_tr_b16 v[224:225],v252 offset:384
v_mfma_f32_16x16x32_bf16 v[68:71],v[208:211],a[84:87],v[68:71]
ds_read_b64_tr_b16 v[226:227],v252 offset:896
v_mfma_f32_16x16x32_bf16 v[72:75],v[208:211],a[88:91],v[72:75]
ds_read_b64_tr_b16 v[228:229],v252 offset:392
ds_read_b64_tr_b16 v[230:231],v252 offset:904
v_mfma_f32_16x16x32_bf16 a[0:3],v[212:215],a[80:83],a[0:3]
v_mfma_f32_16x16x32_bf16 a[4:7],v[212:215],a[84:87],a[4:7]
v_mfma_f32_16x16x32_bf16 a[8:11],v[212:215],a[88:91],a[8:11]
s_add_u32 m0,s29,83712
s_waitcnt lgkmcnt(4)
v_mfma_f32_16x16x32_bf16 v[80:83],v[216:219],a[80:83],v[80:83]
ds_read_b64_tr_b16 v[232:233],v252 offset:448
buffer_load_dwordx4 v255,s[4:7],s68 offen offset:768 lds
v_mfma_f32_16x16x32_bf16 v[84:87],v[216:219],a[84:87],v[84:87]
ds_read_b64_tr_b16 v[234:235],v252 offset:960
s_add_u32 m0,m0,0x00000400
v_mfma_f32_16x16x32_bf16 v[88:91],v[216:219],a[88:91],v[88:91]
ds_read_b64_tr_b16 v[236:237],v252 offset:456
ds_read_b64_tr_b16 v[238:239],v252 offset:968
buffer_load_dwordx4 v255,s[4:7],s93 offen offset:768 lds
v_mfma_f32_16x16x32_bf16 a[16:19],v[220:223],a[80:83],a[16:19]
s_add_u32 m0,m0,0x00000400
v_mfma_f32_16x16x32_bf16 a[20:23],v[220:223],a[84:87],a[20:23]
v_accvgpr_read_b32 v200,a228
v_accvgpr_read_b32 v201,a229
v_mfma_f32_16x16x32_bf16 a[24:27],v[220:223],a[88:91],a[24:27]
buffer_load_dwordx4 v255,s[4:7],s94 offen offset:768 lds
s_add_u32 m0,m0,0x00000400
v_accvgpr_read_b32 v202,a230
s_waitcnt lgkmcnt(4)
v_mfma_f32_16x16x32_bf16 v[96:99],v[224:227],a[80:83],v[96:99]
v_accvgpr_read_b32 v203,a231
v_accvgpr_read_b32 v204,a244
v_mfma_f32_16x16x32_bf16 v[100:103],v[224:227],a[84:87],v[100:103]
s_waitcnt vmcnt(10) lgkmcnt(0)
s_barrier
v_mfma_f32_16x16x32_bf16 v[104:107],v[224:227],a[88:91],v[104:107]
ds_read_b64_tr_b16 v[208:209],v252 offset:33792
buffer_load_dwordx4 v255,s[4:7],s95 offen offset:768 lds
ds_read_b64_tr_b16 v[210:211],v252 offset:34304
s_add_u32 m0,s29,100608
v_mfma_f32_16x16x32_bf16 a[32:35],v[228:231],a[80:83],a[32:35]
ds_read_b64_tr_b16 v[212:213],v252 offset:33800
buffer_load_dwordx4 v255,s[4:7],s96 offen offset:768 lds
v_mfma_f32_16x16x32_bf16 a[36:39],v[228:231],a[84:87],a[36:39]
ds_read_b64_tr_b16 v[214:215],v252 offset:34312
s_add_u32 m0,m0,0x00000400
v_mfma_f32_16x16x32_bf16 a[40:43],v[228:231],a[88:91],a[40:43]
v_accvgpr_read_b32 v205,a245
v_accvgpr_read_b32 v206,a246
buffer_load_dwordx4 v255,s[4:7],s97 offen offset:768 lds
v_accvgpr_read_b32 v207,a247
v_mfma_f32_16x16x32_bf16 v[112:115],v[232:235],a[80:83],v[112:115]
ds_read_b64_tr_b16 v[216:217],v252 offset:33856
v_mul_f32 v200,v194,v200
v_mfma_f32_16x16x32_bf16 v[116:119],v[232:235],a[84:87],v[116:119]
ds_read_b64_tr_b16 v[218:219],v252 offset:34368
v_mul_f32 v201,v194,v201
v_mfma_f32_16x16x32_bf16 v[120:123],v[232:235],a[88:91],v[120:123]
ds_read_b64_tr_b16 v[220:221],v252 offset:33864
v_mul_f32 v202,v194,v202
ds_read_b64_tr_b16 v[222:223],v252 offset:34376
v_mul_f32 v203,v194,v203
v_mfma_f32_16x16x32_bf16 a[48:51],v[236:239],a[80:83],a[48:51]
v_mul_f32 v204,v194,v204
v_mul_f32 v205,v194,v205
v_mfma_f32_16x16x32_bf16 a[52:55],v[236:239],a[84:87],a[52:55]
v_mul_f32 v206,v194,v206
v_mul_f32 v207,v194,v207
v_mfma_f32_16x16x32_bf16 a[56:59],v[236:239],a[88:91],a[56:59]
v_cvt_pk_bf16_f32 v244,v200,v201
v_cvt_pk_bf16_f32 v245,v202,v203
s_add_u32 m0,s29,16896
s_waitcnt lgkmcnt(4)
v_mfma_f32_16x16x32_bf16 v[0:3],v[208:211],a[64:67],v[0:3]
ds_read_b64_tr_b16 v[224:225],v252 offset:33920
buffer_load_dwordx4 v254,s[16:19],s0 offen lds
v_mfma_f32_16x16x32_bf16 v[4:7],v[208:211],a[68:71],v[4:7]
ds_read_b64_tr_b16 v[226:227],v252 offset:34432
s_add_u32 m0,m0,0x00000428
v_mfma_f32_16x16x32_bf16 v[8:11],v[208:211],a[72:75],v[8:11]
ds_read_b64_tr_b16 v[228:229],v252 offset:33928
v_cvt_pk_bf16_f32 v246,v204,v205
ds_read_b64_tr_b16 v[230:231],v252 offset:34440
buffer_load_dwordx4 v254,s[16:19],s1 offen lds
v_mfma_f32_16x16x32_bf16 v[128:131],v[212:215],a[64:67],v[128:131]
s_add_u32 m0,m0,0x00000418
v_cvt_pk_bf16_f32 v247,v206,v207
v_mfma_f32_16x16x32_bf16 v[132:135],v[212:215],a[68:71],v[132:135]
s_add_u32 s60,s63,4096
buffer_store_dwordx4 v[244:247],v248,s[20:23],s60 offen offset:3072 sc1
v_mfma_f32_16x16x32_bf16 v[136:139],v[212:215],a[72:75],v[136:139]
buffer_load_dwordx4 v254,s[16:19],s2 offen lds
s_add_u32 m0,m0,0x00000428
s_waitcnt lgkmcnt(4)
v_mfma_f32_16x16x32_bf16 v[16:19],v[216:219],a[64:67],v[16:19]
ds_read_b64_tr_b16 v[232:233],v252 offset:33984
v_mfma_f32_16x16x32_bf16 v[20:23],v[216:219],a[68:71],v[20:23]
ds_read_b64_tr_b16 v[234:235],v252 offset:34496
buffer_load_dwordx4 v254,s[16:19],s3 offen lds
v_mfma_f32_16x16x32_bf16 v[24:27],v[216:219],a[72:75],v[24:27]
ds_read_b64_tr_b16 v[236:237],v252 offset:33992
ds_read_b64_tr_b16 v[238:239],v252 offset:34504
v_mfma_f32_16x16x32_bf16 v[144:147],v[220:223],a[64:67],v[144:147]
s_add_u32 s16,s16,262144
s_addc_u32 s17,s17,0
v_mfma_f32_16x16x32_bf16 v[148:151],v[220:223],a[68:71],v[148:151]
s_sub_u32 s18,s18,262144
s_add_u32 m0,s29,0
v_mfma_f32_16x16x32_bf16 v[152:155],v[220:223],a[72:75],v[152:155]
buffer_load_dwordx4 v254,s[16:19],s0 offen lds
s_add_u32 m0,m0,0x00000428
s_nop 0
buffer_load_dwordx4 v254,s[16:19],s1 offen lds
s_waitcnt lgkmcnt(4)
v_mfma_f32_16x16x32_bf16 v[32:35],v[224:227],a[64:67],v[32:35]
ds_read_b64_tr_b16 v[208:209],v252 offset:34048
s_add_u32 m0,m0,0x00000418
v_mfma_f32_16x16x32_bf16 v[36:39],v[224:227],a[68:71],v[36:39]
ds_read_b64_tr_b16 v[210:211],v252 offset:34560
v_mfma_f32_16x16x32_bf16 v[40:43],v[224:227],a[72:75],v[40:43]
ds_read_b64_tr_b16 v[212:213],v252 offset:34056
buffer_load_dwordx4 v254,s[16:19],s2 offen lds
ds_read_b64_tr_b16 v[214:215],v252 offset:34568
s_add_u32 m0,m0,0x00000428
v_mfma_f32_16x16x32_bf16 v[160:163],v[228:231],a[64:67],v[160:163]
v_mfma_f32_16x16x32_bf16 v[164:167],v[228:231],a[68:71],v[164:167]
buffer_load_dwordx4 v254,s[16:19],s3 offen lds
v_mfma_f32_16x16x32_bf16 v[168:171],v[228:231],a[72:75],v[168:171]
s_add_u32 s16,s16,262144
s_addc_u32 s17,s17,0
s_sub_u32 s18,s18,262144
s_waitcnt lgkmcnt(4)
v_mfma_f32_16x16x32_bf16 v[48:51],v[232:235],a[64:67],v[48:51]
ds_read_b64_tr_b16 v[216:217],v252 offset:34112
s_add_u32 m0,s29,67584
v_mfma_f32_16x16x32_bf16 v[52:55],v[232:235],a[68:71],v[52:55]
ds_read_b64_tr_b16 v[218:219],v252 offset:34624
buffer_load_dwordx4 v251,s[12:15],s31 offen offset:0 nt lds
v_mfma_f32_16x16x32_bf16 v[56:59],v[232:235],a[72:75],v[56:59]
ds_read_b64_tr_b16 v[220:221],v252 offset:34120
s_add_u32 m0,s29,68128
ds_read_b64_tr_b16 v[222:223],v252 offset:34632
buffer_load_dwordx4 v251,s[12:15],s31 offen offset:512 nt lds
v_mfma_f32_16x16x32_bf16 v[176:179],v[236:239],a[64:67],v[176:179]
s_add_u32 m0,s29,68672
v_accvgpr_read_b32 v200,a232
v_mfma_f32_16x16x32_bf16 v[180:183],v[236:239],a[68:71],v[180:183]
buffer_load_dwordx4 v251,s[12:15],s31 offen offset:1024 nt lds
s_add_u32 m0,s29,69216
v_mfma_f32_16x16x32_bf16 v[184:187],v[236:239],a[72:75],v[184:187]
buffer_load_dwordx4 v251,s[12:15],s31 offen offset:1536 nt lds
s_add_u32 s31,s31,16384
v_accvgpr_read_b32 v201,a233
s_waitcnt lgkmcnt(4)
v_mfma_f32_16x16x32_bf16 v[64:67],v[208:211],a[64:67],v[64:67]
ds_read_b64_tr_b16 v[224:225],v252 offset:34176
v_accvgpr_read_b32 v202,a234
v_mfma_f32_16x16x32_bf16 v[68:71],v[208:211],a[68:71],v[68:71]
ds_read_b64_tr_b16 v[226:227],v252 offset:34688
v_accvgpr_read_b32 v203,a235
v_mfma_f32_16x16x32_bf16 v[72:75],v[208:211],a[72:75],v[72:75]
ds_read_b64_tr_b16 v[228:229],v252 offset:34184
v_accvgpr_read_b32 v204,a248
ds_read_b64_tr_b16 v[230:231],v252 offset:34696
v_accvgpr_read_b32 v205,a249
v_mfma_f32_16x16x32_bf16 a[0:3],v[212:215],a[64:67],a[0:3]
v_accvgpr_read_b32 v206,a250
v_accvgpr_read_b32 v207,a251
v_mfma_f32_16x16x32_bf16 a[4:7],v[212:215],a[68:71],a[4:7]
v_mul_f32 v200,v196,v200
v_mul_f32 v201,v196,v201
v_mfma_f32_16x16x32_bf16 a[8:11],v[212:215],a[72:75],a[8:11]
v_mul_f32 v202,v196,v202
v_mul_f32 v203,v196,v203
v_mul_f32 v204,v196,v204
s_waitcnt lgkmcnt(4)
v_mfma_f32_16x16x32_bf16 v[80:83],v[216:219],a[64:67],v[80:83]
ds_read_b64_tr_b16 v[232:233],v252 offset:34240
v_mov_b32 v254,v251
v_mfma_f32_16x16x32_bf16 v[84:87],v[216:219],a[68:71],v[84:87]
ds_read_b64_tr_b16 v[234:235],v252 offset:34752
v_mul_f32 v205,v196,v205
v_mfma_f32_16x16x32_bf16 v[88:91],v[216:219],a[72:75],v[88:91]
ds_read_b64_tr_b16 v[236:237],v252 offset:34248
v_mul_f32 v206,v196,v206
ds_read_b64_tr_b16 v[238:239],v252 offset:34760
v_mul_f32 v207,v196,v207
v_mfma_f32_16x16x32_bf16 a[16:19],v[220:223],a[64:67],a[16:19]
v_cvt_pk_bf16_f32 v240,v200,v201
v_cvt_pk_bf16_f32 v241,v202,v203
v_mfma_f32_16x16x32_bf16 a[20:23],v[220:223],a[68:71],a[20:23]
v_cvt_pk_bf16_f32 v242,v204,v205
v_cvt_pk_bf16_f32 v243,v206,v207
v_mfma_f32_16x16x32_bf16 a[24:27],v[220:223],a[72:75],a[24:27]
s_add_u32 s60,s64,4096
buffer_store_dwordx4 v[240:243],v248,s[20:23],s60 offen offset:3072 sc1
s_waitcnt lgkmcnt(4)
v_mfma_f32_16x16x32_bf16 v[96:99],v[224:227],a[64:67],v[96:99]
ds_read_b64_tr_b16 v[208:209],v252 offset:50688
v_mfma_f32_16x16x32_bf16 v[100:103],v[224:227],a[68:71],v[100:103]
ds_read_b64_tr_b16 v[210:211],v252 offset:51200
v_mfma_f32_16x16x32_bf16 v[104:107],v[224:227],a[72:75],v[104:107]
ds_read_b64_tr_b16 v[212:213],v252 offset:50696
ds_read_b64_tr_b16 v[214:215],v252 offset:51208
v_mfma_f32_16x16x32_bf16 a[32:35],v[228:231],a[64:67],a[32:35]
v_mfma_f32_16x16x32_bf16 a[36:39],v[228:231],a[68:71],a[36:39]
v_mfma_f32_16x16x32_bf16 a[40:43],v[228:231],a[72:75],a[40:43]
s_waitcnt lgkmcnt(4)
v_mfma_f32_16x16x32_bf16 v[112:115],v[232:235],a[64:67],v[112:115]
ds_read_b64_tr_b16 v[216:217],v252 offset:50752
v_mfma_f32_16x16x32_bf16 v[116:119],v[232:235],a[68:71],v[116:119]
ds_read_b64_tr_b16 v[218:219],v252 offset:51264
v_mfma_f32_16x16x32_bf16 v[120:123],v[232:235],a[72:75],v[120:123]
ds_read_b64_tr_b16 v[220:221],v252 offset:50760
ds_read_b64_tr_b16 v[222:223],v252 offset:51272
v_mfma_f32_16x16x32_bf16 a[48:51],v[236:239],a[64:67],a[48:51]
v_mbcnt_lo_u32_b32 v250,-1,0
v_mbcnt_hi_u32_b32 v250,-1,v250
v_mfma_f32_16x16x32_bf16 a[52:55],v[236:239],a[68:71],a[52:55]
v_and_b32 v249,15,v250
v_mul_u32_u24 v249,1056,v249
v_mfma_f32_16x16x32_bf16 a[56:59],v[236:239],a[72:75],a[56:59]
v_lshrrev_b32 v250,4,v250
v_lshl_add_u32 v250,v250,4,v249
v_add_u32 v250,118272,v250
s_waitcnt lgkmcnt(4)
v_mfma_f32_16x16x32_bf16 v[0:3],v[208:211],a[96:99],v[0:3]
ds_read_b64_tr_b16 v[224:225],v252 offset:50816
v_mfma_f32_16x16x32_bf16 v[4:7],v[208:211],a[100:103],v[4:7]
ds_read_b64_tr_b16 v[226:227],v252 offset:51328
v_mfma_f32_16x16x32_bf16 v[8:11],v[208:211],a[104:107],v[8:11]
ds_read_b64_tr_b16 v[228:229],v252 offset:50824
s_waitcnt vmcnt(14)
ds_read_b64_tr_b16 v[230:231],v252 offset:51336
v_mfma_f32_16x16x32_bf16 v[128:131],v[212:215],a[96:99],v[128:131]
ds_read_b128 a[64:67],v253 offset:16896
v_mfma_f32_16x16x32_bf16 v[132:135],v[212:215],a[100:103],v[132:135]
ds_read_b128 a[68:71],v253 offset:18944
v_mfma_f32_16x16x32_bf16 v[136:139],v[212:215],a[104:107],v[136:139]
ds_read_b128 a[72:75],v253 offset:33792
s_waitcnt lgkmcnt(7)
v_mfma_f32_16x16x32_bf16 v[16:19],v[216:219],a[96:99],v[16:19]
ds_read_b64_tr_b16 v[232:233],v252 offset:50880
v_mfma_f32_16x16x32_bf16 v[20:23],v[216:219],a[100:103],v[20:23]
ds_read_b64_tr_b16 v[234:235],v252 offset:51392
v_mfma_f32_16x16x32_bf16 v[24:27],v[216:219],a[104:107],v[24:27]
ds_read_b64_tr_b16 v[236:237],v252 offset:50888
ds_read_b64_tr_b16 v[238:239],v252 offset:51400
v_mfma_f32_16x16x32_bf16 v[144:147],v[220:223],a[96:99],v[144:147]
v_xor_b32 v253,64,v253
v_mfma_f32_16x16x32_bf16 v[148:151],v[220:223],a[100:103],v[148:151]
ds_read_b128 a[80:83],v253 offset:16896
v_mfma_f32_16x16x32_bf16 v[152:155],v[220:223],a[104:107],v[152:155]
ds_read_b128 a[84:87],v253 offset:18944
s_waitcnt lgkmcnt(9)
v_mfma_f32_16x16x32_bf16 v[32:35],v[224:227],a[96:99],v[32:35]
ds_read_b64_tr_b16 v[208:209],v252 offset:50944
v_mfma_f32_16x16x32_bf16 v[36:39],v[224:227],a[100:103],v[36:39]
ds_read_b64_tr_b16 v[210:211],v252 offset:51456
v_mfma_f32_16x16x32_bf16 v[40:43],v[224:227],a[104:107],v[40:43]
ds_read_b64_tr_b16 v[212:213],v252 offset:50952
ds_read_b64_tr_b16 v[214:215],v252 offset:51464
v_mfma_f32_16x16x32_bf16 v[160:163],v[228:231],a[96:99],v[160:163]
ds_read_b128 a[88:91],v253 offset:33792
v_mfma_f32_16x16x32_bf16 v[164:167],v[228:231],a[100:103],v[164:167]
v_xor_b32 v253,64,v253
v_mfma_f32_16x16x32_bf16 v[168:171],v[228:231],a[104:107],v[168:171]
s_waitcnt lgkmcnt(7)
v_mfma_f32_16x16x32_bf16 v[48:51],v[232:235],a[96:99],v[48:51]
ds_read_b64_tr_b16 v[216:217],v252 offset:51008
v_mfma_f32_16x16x32_bf16 v[52:55],v[232:235],a[100:103],v[52:55]
ds_read_b64_tr_b16 v[218:219],v252 offset:51520
v_mfma_f32_16x16x32_bf16 v[56:59],v[232:235],a[104:107],v[56:59]
ds_read_b64_tr_b16 v[220:221],v252 offset:51016
ds_read_b64_tr_b16 v[222:223],v252 offset:51528
v_mfma_f32_16x16x32_bf16 v[176:179],v[236:239],a[96:99],v[176:179]
v_mfma_f32_16x16x32_bf16 v[180:183],v[236:239],a[100:103],v[180:183]
v_mfma_f32_16x16x32_bf16 v[184:187],v[236:239],a[104:107],v[184:187]
s_waitcnt lgkmcnt(5)
v_mfma_f32_16x16x32_bf16 v[64:67],v[208:211],a[96:99],v[64:67]
ds_read_b64_tr_b16 v[224:225],v252 offset:51072
v_mfma_f32_16x16x32_bf16 v[68:71],v[208:211],a[100:103],v[68:71]
ds_read_b64_tr_b16 v[226:227],v252 offset:51584
v_mfma_f32_16x16x32_bf16 v[72:75],v[208:211],a[104:107],v[72:75]
ds_read_b64_tr_b16 v[228:229],v252 offset:51080
ds_read_b64_tr_b16 v[230:231],v252 offset:51592
v_mfma_f32_16x16x32_bf16 a[0:3],v[212:215],a[96:99],a[0:3]
v_mfma_f32_16x16x32_bf16 a[4:7],v[212:215],a[100:103],a[4:7]
v_mfma_f32_16x16x32_bf16 a[8:11],v[212:215],a[104:107],a[8:11]
s_add_u32 m0,s29,84480
s_waitcnt lgkmcnt(4)
v_mfma_f32_16x16x32_bf16 v[80:83],v[216:219],a[96:99],v[80:83]
ds_read_b64_tr_b16 v[232:233],v252 offset:51136
buffer_load_dwordx4 v254,s[12:15],s31 offen offset:0 nt lds
v_mfma_f32_16x16x32_bf16 v[84:87],v[216:219],a[100:103],v[84:87]
ds_read_b64_tr_b16 v[234:235],v252 offset:51648
s_add_u32 m0,m0,0x00000220
v_mfma_f32_16x16x32_bf16 v[88:91],v[216:219],a[104:107],v[88:91]
ds_read_b64_tr_b16 v[236:237],v252 offset:51144
ds_read_b64_tr_b16 v[238:239],v252 offset:51656
v_mfma_f32_16x16x32_bf16 a[16:19],v[220:223],a[96:99],a[16:19]
v_mfma_f32_16x16x32_bf16 a[20:23],v[220:223],a[100:103],a[20:23]
buffer_load_dwordx4 v254,s[12:15],s31 offen offset:512 nt lds
v_mfma_f32_16x16x32_bf16 a[24:27],v[220:223],a[104:107],a[24:27]
s_waitcnt lgkmcnt(4)
v_mfma_f32_16x16x32_bf16 v[96:99],v[224:227],a[96:99],v[96:99]
v_mfma_f32_16x16x32_bf16 v[100:103],v[224:227],a[100:103],v[100:103]
s_waitcnt vmcnt(7) lgkmcnt(0)
s_barrier
v_mfma_f32_16x16x32_bf16 v[104:107],v[224:227],a[104:107],v[104:107]
ds_read_b64_tr_b16 v[208:209],v252 offset:16896
s_add_u32 m0,m0,0x00000220
ds_read_b64_tr_b16 v[210:211],v252 offset:17408
buffer_load_dwordx4 v254,s[12:15],s31 offen offset:1024 nt lds
v_mfma_f32_16x16x32_bf16 a[32:35],v[228:231],a[96:99],a[32:35]
ds_read_b64_tr_b16 v[212:213],v252 offset:0
s_add_u32 m0,m0,0x00000220
v_mfma_f32_16x16x32_bf16 a[36:39],v[228:231],a[100:103],a[36:39]
ds_read_b64_tr_b16 v[214:215],v252 offset:512
v_mfma_f32_16x16x32_bf16 a[40:43],v[228:231],a[104:107],a[40:43]
v_mfma_f32_16x16x32_bf16 v[112:115],v[232:235],a[96:99],v[112:115]
ds_read_b64_tr_b16 v[216:217],v252 offset:16904
v_mfma_f32_16x16x32_bf16 v[116:119],v[232:235],a[100:103],v[116:119]
ds_read_b64_tr_b16 v[218:219],v252 offset:17416
v_mfma_f32_16x16x32_bf16 v[120:123],v[232:235],a[104:107],v[120:123]
ds_read_b64_tr_b16 v[220:221],v252 offset:8
ds_read_b64_tr_b16 v[222:223],v252 offset:520
v_mfma_f32_16x16x32_bf16 a[48:51],v[236:239],a[96:99],a[48:51]
v_mfma_f32_16x16x32_bf16 a[52:55],v[236:239],a[100:103],a[52:55]
v_mfma_f32_16x16x32_bf16 a[56:59],v[236:239],a[104:107],a[56:59]
buffer_load_dwordx4 v254,s[12:15],s31 offen offset:1536 nt lds
s_add_u32 s31,s31,16384
s_add_u32 m0,s29,33792
s_waitcnt lgkmcnt(4)
v_mfma_f32_16x16x32_bf16 v[0:3],v[208:211],a[64:67],v[0:3]
ds_read_b64_tr_b16 v[224:225],v252 offset:16960
v_mfma_f32_16x16x32_bf16 v[4:7],v[208:211],a[68:71],v[4:7]
ds_read_b64_tr_b16 v[226:227],v252 offset:17472
v_mfma_f32_16x16x32_bf16 v[8:11],v[208:211],a[72:75],v[8:11]
ds_read_b64_tr_b16 v[228:229],v252 offset:64
ds_read_b64_tr_b16 v[230:231],v252 offset:576
v_mov_b32 v192,s61
v_mfma_f32_16x16x32_bf16 v[0:3],v[212:215],a[80:83],v[0:3]
v_mfma_f32_16x16x32_bf16 v[4:7],v[212:215],a[84:87],v[4:7]
v_mfma_f32_16x16x32_bf16 v[8:11],v[212:215],a[88:91],v[8:11]
s_waitcnt lgkmcnt(4)
v_mfma_f32_16x16x32_bf16 v[128:131],v[216:219],a[64:67],v[128:131]
ds_read_b64_tr_b16 v[232:233],v252 offset:16968
v_mfma_f32_16x16x32_bf16 v[132:135],v[216:219],a[68:71],v[132:135]
ds_read_b64_tr_b16 v[234:235],v252 offset:17480
buffer_load_dwordx4 v254,s[8:11],s30 offen offset:0 nt lds
v_mfma_f32_16x16x32_bf16 v[136:139],v[216:219],a[72:75],v[136:139]
ds_read_b64_tr_b16 v[236:237],v252 offset:72
s_add_u32 m0,m0,0x00000220
ds_read_b64_tr_b16 v[238:239],v252 offset:584
v_mfma_f32_16x16x32_bf16 v[128:131],v[220:223],a[80:83],v[128:131]
v_mfma_f32_16x16x32_bf16 v[132:135],v[220:223],a[84:87],v[132:135]
v_mfma_f32_16x16x32_bf16 v[136:139],v[220:223],a[88:91],v[136:139]
s_waitcnt lgkmcnt(4)
v_mfma_f32_16x16x32_bf16 v[16:19],v[224:227],a[64:67],v[16:19]
ds_read_b64_tr_b16 v[208:209],v252 offset:17024
v_mfma_f32_16x16x32_bf16 v[20:23],v[224:227],a[68:71],v[20:23]
ds_read_b64_tr_b16 v[210:211],v252 offset:17536
v_mul_f32 v0,s61,v0
v_mfma_f32_16x16x32_bf16 v[24:27],v[224:227],a[72:75],v[24:27]
ds_read_b64_tr_b16 v[212:213],v252 offset:128
v_mul_f32 v1,s61,v1
ds_read_b64_tr_b16 v[214:215],v252 offset:640
v_mul_f32 v2,s61,v2
v_mfma_f32_16x16x32_bf16 v[16:19],v[228:231],a[80:83],v[16:19]
buffer_load_dwordx4 v254,s[8:11],s30 offen offset:512 nt lds
s_add_u32 m0,m0,0x00000220
v_mfma_f32_16x16x32_bf16 v[20:23],v[228:231],a[84:87],v[20:23]
v_mul_f32 v3,s61,v3
v_cvt_pk_bf16_f32 v0,v0,v1
v_mfma_f32_16x16x32_bf16 v[24:27],v[228:231],a[88:91],v[24:27]
v_cvt_pk_bf16_f32 v1,v2,v3
v_mul_f32 v128,s61,v128
v_mul_f32 v129,s61,v129
s_waitcnt lgkmcnt(4)
v_mfma_f32_16x16x32_bf16 v[144:147],v[232:235],a[64:67],v[144:147]
ds_read_b64_tr_b16 v[216:217],v252 offset:17032
v_mul_f32 v130,s61,v130
v_mfma_f32_16x16x32_bf16 v[148:151],v[232:235],a[68:71],v[148:151]
ds_read_b64_tr_b16 v[218:219],v252 offset:17544
v_mul_f32 v131,s61,v131
v_mfma_f32_16x16x32_bf16 v[152:155],v[232:235],a[72:75],v[152:155]
ds_read_b64_tr_b16 v[220:221],v252 offset:136
v_cvt_pk_bf16_f32 v2,v128,v129
ds_read_b64_tr_b16 v[222:223],v252 offset:648
v_cvt_pk_bf16_f32 v3,v130,v131
v_mfma_f32_16x16x32_bf16 v[144:147],v[236:239],a[80:83],v[144:147]
v_mul_f32 v4,s61,v4
v_mul_f32 v5,s61,v5
v_mfma_f32_16x16x32_bf16 v[148:151],v[236:239],a[84:87],v[148:151]
v_mul_f32 v6,s61,v6
v_mul_f32 v7,s61,v7
v_mfma_f32_16x16x32_bf16 v[152:155],v[236:239],a[88:91],v[152:155]
v_cvt_pk_bf16_f32 v4,v4,v5
v_cvt_pk_bf16_f32 v5,v6,v7
buffer_load_dwordx4 v254,s[8:11],s30 offen offset:1024 nt lds
s_waitcnt lgkmcnt(4)
v_mfma_f32_16x16x32_bf16 v[32:35],v[208:211],a[64:67],v[32:35]
ds_read_b64_tr_b16 v[224:225],v252 offset:17088
s_add_u32 m0,m0,0x00000220
v_mfma_f32_16x16x32_bf16 v[36:39],v[208:211],a[68:71],v[36:39]
ds_read_b64_tr_b16 v[226:227],v252 offset:17600
v_mul_f32 v132,s61,v132
v_mfma_f32_16x16x32_bf16 v[40:43],v[208:211],a[72:75],v[40:43]
ds_read_b64_tr_b16 v[228:229],v252 offset:192
v_mul_f32 v133,s61,v133
ds_read_b64_tr_b16 v[230:231],v252 offset:704
v_mul_f32 v134,s61,v134
v_mfma_f32_16x16x32_bf16 v[32:35],v[212:215],a[80:83],v[32:35]
v_mul_f32 v135,s61,v135
v_cvt_pk_bf16_f32 v6,v132,v133
v_mfma_f32_16x16x32_bf16 v[36:39],v[212:215],a[84:87],v[36:39]
v_cvt_pk_bf16_f32 v7,v134,v135
v_mul_f32 v8,s61,v8
v_mfma_f32_16x16x32_bf16 v[40:43],v[212:215],a[88:91],v[40:43]
v_mul_f32 v9,s61,v9
v_mul_f32 v10,s61,v10
v_mul_f32 v11,s61,v11
s_waitcnt lgkmcnt(4)
v_mfma_f32_16x16x32_bf16 v[160:163],v[216:219],a[64:67],v[160:163]
ds_read_b64_tr_b16 v[232:233],v252 offset:17096
v_cvt_pk_bf16_f32 v8,v8,v9
v_mfma_f32_16x16x32_bf16 v[164:167],v[216:219],a[68:71],v[164:167]
ds_read_b64_tr_b16 v[234:235],v252 offset:17608
v_cvt_pk_bf16_f32 v9,v10,v11
v_mfma_f32_16x16x32_bf16 v[168:171],v[216:219],a[72:75],v[168:171]
ds_read_b64_tr_b16 v[236:237],v252 offset:200
buffer_load_dwordx4 v254,s[8:11],s30 offen offset:1536 nt lds
ds_read_b64_tr_b16 v[238:239],v252 offset:712
s_add_u32 s30,s30,16384
v_mfma_f32_16x16x32_bf16 v[160:163],v[220:223],a[80:83],v[160:163]
s_add_u32 m0,s29,50688
v_mul_f32 v136,s61,v136
v_mfma_f32_16x16x32_bf16 v[164:167],v[220:223],a[84:87],v[164:167]
v_mul_f32 v137,s61,v137
v_mul_f32 v138,s61,v138
v_mfma_f32_16x16x32_bf16 v[168:171],v[220:223],a[88:91],v[168:171]
v_mul_f32 v139,s61,v139
v_cvt_pk_bf16_f32 v10,v136,v137
v_cvt_pk_bf16_f32 v11,v138,v139
s_waitcnt lgkmcnt(4)
v_mfma_f32_16x16x32_bf16 v[48:51],v[224:227],a[64:67],v[48:51]
ds_read_b64_tr_b16 v[208:209],v252 offset:17152
v_mul_f32 v16,s61,v16
v_mfma_f32_16x16x32_bf16 v[52:55],v[224:227],a[68:71],v[52:55]
ds_read_b64_tr_b16 v[210:211],v252 offset:17664
v_mul_f32 v17,s61,v17
v_mfma_f32_16x16x32_bf16 v[56:59],v[224:227],a[72:75],v[56:59]
ds_read_b64_tr_b16 v[212:213],v252 offset:256
v_mul_f32 v18,s61,v18
ds_read_b64_tr_b16 v[214:215],v252 offset:768
v_mul_f32 v19,s61,v19
v_mfma_f32_16x16x32_bf16 v[48:51],v[228:231],a[80:83],v[48:51]
v_cvt_pk_bf16_f32 v16,v16,v17
v_cvt_pk_bf16_f32 v17,v18,v19
v_mfma_f32_16x16x32_bf16 v[52:55],v[228:231],a[84:87],v[52:55]
buffer_load_dwordx4 v254,s[8:11],s30 offen offset:0 nt lds
s_add_u32 m0,m0,0x00000220
v_mfma_f32_16x16x32_bf16 v[56:59],v[228:231],a[88:91],v[56:59]
v_mul_f32 v144,s61,v144
v_mul_f32 v145,s61,v145
v_mul_f32 v146,s61,v146
s_waitcnt lgkmcnt(4)
v_mfma_f32_16x16x32_bf16 v[176:179],v[232:235],a[64:67],v[176:179]
ds_read_b64_tr_b16 v[216:217],v252 offset:17160
v_mul_f32 v147,s61,v147
v_mfma_f32_16x16x32_bf16 v[180:183],v[232:235],a[68:71],v[180:183]
ds_read_b64_tr_b16 v[218:219],v252 offset:17672
v_cvt_pk_bf16_f32 v18,v144,v145
v_mfma_f32_16x16x32_bf16 v[184:187],v[232:235],a[72:75],v[184:187]
ds_read_b64_tr_b16 v[220:221],v252 offset:264
v_cvt_pk_bf16_f32 v19,v146,v147
ds_read_b64_tr_b16 v[222:223],v252 offset:776
v_mul_f32 v20,s61,v20
v_mfma_f32_16x16x32_bf16 v[176:179],v[236:239],a[80:83],v[176:179]
v_mul_f32 v21,s61,v21
v_mul_f32 v22,s61,v22
v_mfma_f32_16x16x32_bf16 v[180:183],v[236:239],a[84:87],v[180:183]
v_mul_f32 v23,s61,v23
v_cvt_pk_bf16_f32 v20,v20,v21
v_mfma_f32_16x16x32_bf16 v[184:187],v[236:239],a[88:91],v[184:187]
v_cvt_pk_bf16_f32 v21,v22,v23
v_mul_f32 v148,s61,v148
v_mul_f32 v149,s61,v149
s_waitcnt lgkmcnt(4)
v_mfma_f32_16x16x32_bf16 v[64:67],v[208:211],a[64:67],v[64:67]
ds_read_b64_tr_b16 v[224:225],v252 offset:17216
buffer_load_dwordx4 v254,s[8:11],s30 offen offset:512 nt lds
v_mfma_f32_16x16x32_bf16 v[68:71],v[208:211],a[68:71],v[68:71]
ds_read_b64_tr_b16 v[226:227],v252 offset:17728
s_add_u32 m0,m0,0x00000220
v_mfma_f32_16x16x32_bf16 v[72:75],v[208:211],a[72:75],v[72:75]
ds_read_b64_tr_b16 v[228:229],v252 offset:320
v_mul_f32 v150,s61,v150
ds_read_b64_tr_b16 v[230:231],v252 offset:832
v_mul_f32 v151,s61,v151
v_mfma_f32_16x16x32_bf16 v[64:67],v[212:215],a[80:83],v[64:67]
v_cvt_pk_bf16_f32 v22,v148,v149
v_cvt_pk_bf16_f32 v23,v150,v151
v_mfma_f32_16x16x32_bf16 v[68:71],v[212:215],a[84:87],v[68:71]
v_mul_f32 v24,s61,v24
v_mul_f32 v25,s61,v25
v_mfma_f32_16x16x32_bf16 v[72:75],v[212:215],a[88:91],v[72:75]
v_mul_f32 v26,s61,v26
v_mul_f32 v27,s61,v27
v_cvt_pk_bf16_f32 v24,v24,v25
s_waitcnt lgkmcnt(4)
v_mfma_f32_16x16x32_bf16 a[0:3],v[216:219],a[64:67],a[0:3]
ds_read_b64_tr_b16 v[232:233],v252 offset:17224
v_cvt_pk_bf16_f32 v25,v26,v27
v_mfma_f32_16x16x32_bf16 a[4:7],v[216:219],a[68:71],a[4:7]
ds_read_b64_tr_b16 v[234:235],v252 offset:17736
v_mul_f32 v152,s61,v152
v_mfma_f32_16x16x32_bf16 a[8:11],v[216:219],a[72:75],a[8:11]
ds_read_b64_tr_b16 v[236:237],v252 offset:328
v_mul_f32 v153,s61,v153
ds_read_b64_tr_b16 v[238:239],v252 offset:840
buffer_load_dwordx4 v254,s[8:11],s30 offen offset:1024 nt lds
v_mfma_f32_16x16x32_bf16 a[0:3],v[220:223],a[80:83],a[0:3]
s_add_u32 m0,m0,0x00000220
v_mul_f32 v154,s61,v154
v_mfma_f32_16x16x32_bf16 a[4:7],v[220:223],a[84:87],a[4:7]
v_mul_f32 v155,s61,v155
v_cvt_pk_bf16_f32 v26,v152,v153
v_mfma_f32_16x16x32_bf16 a[8:11],v[220:223],a[88:91],a[8:11]
v_cvt_pk_bf16_f32 v27,v154,v155
v_mul_f32 v32,s61,v32
v_mul_f32 v33,s61,v33
s_waitcnt lgkmcnt(4)
v_mfma_f32_16x16x32_bf16 v[80:83],v[224:227],a[64:67],v[80:83]
ds_read_b64_tr_b16 v[208:209],v252 offset:17280
v_mul_f32 v34,s61,v34
v_mfma_f32_16x16x32_bf16 v[84:87],v[224:227],a[68:71],v[84:87]
ds_read_b64_tr_b16 v[210:211],v252 offset:17792
v_mul_f32 v35,s61,v35
v_mfma_f32_16x16x32_bf16 v[88:91],v[224:227],a[72:75],v[88:91]
ds_read_b64_tr_b16 v[212:213],v252 offset:384
v_cvt_pk_bf16_f32 v32,v32,v33
ds_read_b64_tr_b16 v[214:215],v252 offset:896
v_cvt_pk_bf16_f32 v33,v34,v35
v_mfma_f32_16x16x32_bf16 v[80:83],v[228:231],a[80:83],v[80:83]
v_mul_f32 v160,s61,v160
v_mul_f32 v161,s61,v161
v_mfma_f32_16x16x32_bf16 v[84:87],v[228:231],a[84:87],v[84:87]
v_mul_f32 v162,s61,v162
v_mul_f32 v163,s61,v163
v_mfma_f32_16x16x32_bf16 v[88:91],v[228:231],a[88:91],v[88:91]
buffer_load_dwordx4 v254,s[8:11],s30 offen offset:1536 nt lds
s_add_u32 s30,s30,16384
s_add_u32 m0,s29,101376
s_waitcnt lgkmcnt(4)
v_mfma_f32_16x16x32_bf16 a[16:19],v[232:235],a[64:67],a[16:19]
ds_read_b64_tr_b16 v[216:217],v252 offset:17288
v_cvt_pk_bf16_f32 v34,v160,v161
v_mfma_f32_16x16x32_bf16 a[20:23],v[232:235],a[68:71],a[20:23]
ds_read_b64_tr_b16 v[218:219],v252 offset:17800
v_cvt_pk_bf16_f32 v35,v162,v163
v_mfma_f32_16x16x32_bf16 a[24:27],v[232:235],a[72:75],a[24:27]
ds_read_b64_tr_b16 v[220:221],v252 offset:392
v_mul_f32 v36,s61,v36
ds_read_b64_tr_b16 v[222:223],v252 offset:904
v_mul_f32 v37,s61,v37
v_mfma_f32_16x16x32_bf16 a[16:19],v[236:239],a[80:83],a[16:19]
v_mul_f32 v38,s61,v38
v_mul_f32 v39,s61,v39
v_mfma_f32_16x16x32_bf16 a[20:23],v[236:239],a[84:87],a[20:23]
v_cvt_pk_bf16_f32 v36,v36,v37
v_cvt_pk_bf16_f32 v37,v38,v39
v_mfma_f32_16x16x32_bf16 a[24:27],v[236:239],a[88:91],a[24:27]
v_mul_f32 v164,s61,v164
v_mul_f32 v165,s61,v165
v_mul_f32 v166,s61,v166
s_waitcnt lgkmcnt(4)
v_mfma_f32_16x16x32_bf16 v[96:99],v[208:211],a[64:67],v[96:99]
ds_read_b64_tr_b16 v[224:225],v252 offset:17344
v_mul_f32 v167,s61,v167
v_mfma_f32_16x16x32_bf16 v[100:103],v[208:211],a[68:71],v[100:103]
ds_read_b64_tr_b16 v[226:227],v252 offset:17856
buffer_load_dwordx4 v254,s[12:15],s31 offen offset:0 nt lds
v_mfma_f32_16x16x32_bf16 v[104:107],v[208:211],a[72:75],v[104:107]
ds_read_b64_tr_b16 v[228:229],v252 offset:448
s_add_u32 m0,m0,0x00000220
ds_read_b64_tr_b16 v[230:231],v252 offset:960
v_cvt_pk_bf16_f32 v38,v164,v165
v_mfma_f32_16x16x32_bf16 v[96:99],v[212:215],a[80:83],v[96:99]
v_cvt_pk_bf16_f32 v39,v166,v167
v_mul_f32 v40,s61,v40
v_mfma_f32_16x16x32_bf16 v[100:103],v[212:215],a[84:87],v[100:103]
v_mul_f32 v41,s61,v41
v_mul_f32 v42,s61,v42
v_mfma_f32_16x16x32_bf16 v[104:107],v[212:215],a[88:91],v[104:107]
v_mul_f32 v43,s61,v43
v_cvt_pk_bf16_f32 v40,v40,v41
v_cvt_pk_bf16_f32 v41,v42,v43
s_waitcnt lgkmcnt(4)
v_mfma_f32_16x16x32_bf16 a[32:35],v[216:219],a[64:67],a[32:35]
ds_read_b64_tr_b16 v[232:233],v252 offset:17352
v_mul_f32 v168,s61,v168
v_mfma_f32_16x16x32_bf16 a[36:39],v[216:219],a[68:71],a[36:39]
ds_read_b64_tr_b16 v[234:235],v252 offset:17864
v_mul_f32 v169,s61,v169
v_mfma_f32_16x16x32_bf16 a[40:43],v[216:219],a[72:75],a[40:43]
ds_read_b64_tr_b16 v[236:237],v252 offset:456
v_mul_f32 v170,s61,v170
ds_read_b64_tr_b16 v[238:239],v252 offset:968
v_mul_f32 v171,s61,v171
v_mfma_f32_16x16x32_bf16 a[32:35],v[220:223],a[80:83],a[32:35]
v_mov_b32 v252,v250
buffer_load_dwordx4 v254,s[12:15],s31 offen offset:512 nt lds
v_mfma_f32_16x16x32_bf16 a[36:39],v[220:223],a[84:87],a[36:39]
s_add_u32 m0,m0,0x00000220
v_cvt_pk_bf16_f32 v42,v168,v169
v_mfma_f32_16x16x32_bf16 a[40:43],v[220:223],a[88:91],a[40:43]
v_cvt_pk_bf16_f32 v43,v170,v171
s_waitcnt lgkmcnt(4)
v_mfma_f32_16x16x32_bf16 v[112:115],v[224:227],a[64:67],v[112:115]
v_mfma_f32_16x16x32_bf16 v[116:119],v[224:227],a[68:71],v[116:119]
s_waitcnt vmcnt(63) lgkmcnt(0)
s_barrier
v_mfma_f32_16x16x32_bf16 v[120:123],v[224:227],a[72:75],v[120:123]
ds_read_b128 v[208:211],v252 offset:0
v_mfma_f32_16x16x32_bf16 v[112:115],v[228:231],a[80:83],v[112:115]
ds_read_b128 v[212:215],v252 offset:512
v_mfma_f32_16x16x32_bf16 v[116:119],v[228:231],a[84:87],v[116:119]
v_mfma_f32_16x16x32_bf16 v[120:123],v[228:231],a[88:91],v[120:123]
buffer_load_dwordx4 v254,s[12:15],s31 offen offset:1024 nt lds
s_add_u32 m0,m0,0x00000220
v_mfma_f32_16x16x32_bf16 a[48:51],v[232:235],a[64:67],a[48:51]
ds_read_b128 v[216:219],v252 offset:64
v_mfma_f32_16x16x32_bf16 a[52:55],v[232:235],a[68:71],a[52:55]
v_mfma_f32_16x16x32_bf16 a[56:59],v[232:235],a[72:75],a[56:59]
ds_read_b128 v[220:223],v252 offset:576
v_mfma_f32_16x16x32_bf16 a[48:51],v[236:239],a[80:83],a[48:51]
v_mfma_f32_16x16x32_bf16 a[52:55],v[236:239],a[84:87],a[52:55]
v_mfma_f32_16x16x32_bf16 a[56:59],v[236:239],a[88:91],a[56:59]
s_waitcnt lgkmcnt(2)
v_pk_mul_f32 v[48:49],v[48:49],v[192:193] op_sel_hi:[1,0]
v_pk_mul_f32 v[50:51],v[50:51],v[192:193] op_sel_hi:[1,0]
v_cvt_pk_bf16_f32 v48,v48,v49
v_cvt_pk_bf16_f32 v49,v50,v51
v_pk_mul_f32 v[176:177],v[176:177],v[192:193] op_sel_hi:[1,0]
v_pk_mul_f32 v[178:179],v[178:179],v[192:193] op_sel_hi:[1,0]
v_cvt_pk_bf16_f32 v50,v176,v177
v_cvt_pk_bf16_f32 v51,v178,v179
v_pk_mul_f32 v[52:53],v[52:53],v[192:193] op_sel_hi:[1,0]
v_pk_mul_f32 v[54:55],v[54:55],v[192:193] op_sel_hi:[1,0]
v_cvt_pk_bf16_f32 v52,v52,v53
v_cvt_pk_bf16_f32 v53,v54,v55
v_pk_mul_f32 v[180:181],v[180:181],v[192:193] op_sel_hi:[1,0]
v_pk_mul_f32 v[182:183],v[182:183],v[192:193] op_sel_hi:[1,0]
v_cvt_pk_bf16_f32 v54,v180,v181
v_cvt_pk_bf16_f32 v55,v182,v183
v_pk_mul_f32 v[56:57],v[56:57],v[192:193] op_sel_hi:[1,0]
v_pk_mul_f32 v[58:59],v[58:59],v[192:193] op_sel_hi:[1,0]
v_cvt_pk_bf16_f32 v56,v56,v57
v_cvt_pk_bf16_f32 v57,v58,v59
v_pk_mul_f32 v[184:185],v[184:185],v[192:193] op_sel_hi:[1,0]
v_pk_mul_f32 v[186:187],v[186:187],v[192:193] op_sel_hi:[1,0]
v_cvt_pk_bf16_f32 v58,v184,v185
v_cvt_pk_bf16_f32 v59,v186,v187
v_pk_mul_f32 v[64:65],v[64:65],v[192:193] op_sel_hi:[1,0]
v_pk_mul_f32 v[66:67],v[66:67],v[192:193] op_sel_hi:[1,0]
v_cvt_pk_bf16_f32 v64,v64,v65
v_cvt_pk_bf16_f32 v65,v66,v67
v_accvgpr_read_b32 v200,a0
v_accvgpr_read_b32 v201,a1
v_accvgpr_read_b32 v202,a2
v_accvgpr_read_b32 v203,a3
v_pk_mul_f32 v[200:201],v[200:201],v[192:193] op_sel_hi:[1,0]
v_pk_mul_f32 v[202:203],v[202:203],v[192:193] op_sel_hi:[1,0]
v_cvt_pk_bf16_f32 v66,v200,v201
v_cvt_pk_bf16_f32 v67,v202,v203
v_pk_mul_f32 v[68:69],v[68:69],v[192:193] op_sel_hi:[1,0]
v_pk_mul_f32 v[70:71],v[70:71],v[192:193] op_sel_hi:[1,0]
v_cvt_pk_bf16_f32 v68,v68,v69
v_cvt_pk_bf16_f32 v69,v70,v71
v_accvgpr_read_b32 v204,a4
v_accvgpr_read_b32 v205,a5
v_accvgpr_read_b32 v206,a6
v_accvgpr_read_b32 v207,a7
v_pk_mul_f32 v[204:205],v[204:205],v[192:193] op_sel_hi:[1,0]
v_pk_mul_f32 v[206:207],v[206:207],v[192:193] op_sel_hi:[1,0]
v_cvt_pk_bf16_f32 v70,v204,v205
v_cvt_pk_bf16_f32 v71,v206,v207
v_pk_mul_f32 v[72:73],v[72:73],v[192:193] op_sel_hi:[1,0]
v_pk_mul_f32 v[74:75],v[74:75],v[192:193] op_sel_hi:[1,0]
v_cvt_pk_bf16_f32 v72,v72,v73
v_cvt_pk_bf16_f32 v73,v74,v75
v_accvgpr_read_b32 v200,a8
v_accvgpr_read_b32 v201,a9
v_accvgpr_read_b32 v202,a10
v_accvgpr_read_b32 v203,a11
v_pk_mul_f32 v[200:201],v[200:201],v[192:193] op_sel_hi:[1,0]
v_pk_mul_f32 v[202:203],v[202:203],v[192:193] op_sel_hi:[1,0]
v_cvt_pk_bf16_f32 v74,v200,v201
v_cvt_pk_bf16_f32 v75,v202,v203
v_pk_mul_f32 v[80:81],v[80:81],v[192:193] op_sel_hi:[1,0]
v_pk_mul_f32 v[82:83],v[82:83],v[192:193] op_sel_hi:[1,0]
v_cvt_pk_bf16_f32 v80,v80,v81
v_cvt_pk_bf16_f32 v81,v82,v83
v_accvgpr_read_b32 v200,a16
v_accvgpr_read_b32 v201,a17
v_accvgpr_read_b32 v202,a18
v_accvgpr_read_b32 v203,a19
v_pk_mul_f32 v[200:201],v[200:201],v[192:193] op_sel_hi:[1,0]
v_pk_mul_f32 v[202:203],v[202:203],v[192:193] op_sel_hi:[1,0]
v_cvt_pk_bf16_f32 v82,v200,v201
v_cvt_pk_bf16_f32 v83,v202,v203
v_pk_mul_f32 v[84:85],v[84:85],v[192:193] op_sel_hi:[1,0]
v_pk_mul_f32 v[86:87],v[86:87],v[192:193] op_sel_hi:[1,0]
v_cvt_pk_bf16_f32 v84,v84,v85
v_cvt_pk_bf16_f32 v85,v86,v87
v_accvgpr_read_b32 v204,a20
v_accvgpr_read_b32 v205,a21
v_accvgpr_read_b32 v206,a22
v_accvgpr_read_b32 v207,a23
v_pk_mul_f32 v[204:205],v[204:205],v[192:193] op_sel_hi:[1,0]
v_pk_mul_f32 v[206:207],v[206:207],v[192:193] op_sel_hi:[1,0]
v_cvt_pk_bf16_f32 v86,v204,v205
v_cvt_pk_bf16_f32 v87,v206,v207
v_pk_mul_f32 v[88:89],v[88:89],v[192:193] op_sel_hi:[1,0]
v_pk_mul_f32 v[90:91],v[90:91],v[192:193] op_sel_hi:[1,0]
v_cvt_pk_bf16_f32 v88,v88,v89
v_cvt_pk_bf16_f32 v89,v90,v91
v_accvgpr_read_b32 v200,a24
v_accvgpr_read_b32 v201,a25
v_accvgpr_read_b32 v202,a26
v_accvgpr_read_b32 v203,a27
v_pk_mul_f32 v[200:201],v[200:201],v[192:193] op_sel_hi:[1,0]
v_pk_mul_f32 v[202:203],v[202:203],v[192:193] op_sel_hi:[1,0]
v_cvt_pk_bf16_f32 v90,v200,v201
v_cvt_pk_bf16_f32 v91,v202,v203
v_mfma_f32_16x16x32_bf16 v[128:131],v[208:211],v[0:3],0
ds_read_b128 v[224:227],v252 offset:128
v_mul_f32 v96,s61,v96
v_mfma_f32_16x16x32_bf16 v[132:135],v[208:211],v[4:7],0
v_mul_f32 v97,s61,v97
v_mul_f32 v98,s61,v98
v_mfma_f32_16x16x32_bf16 v[136:139],v[208:211],v[8:11],0
ds_read_b128 v[228:231],v252 offset:640
buffer_load_dwordx4 v254,s[12:15],s31 offen offset:1536 nt lds
s_add_u32 s31,s31,16384
v_mul_f32 v99,s61,v99
v_mfma_f32_16x16x32_bf16 v[144:147],v[212:215],v[0:3],0
v_cvt_pk_bf16_f32 v96,v96,v97
v_cvt_pk_bf16_f32 v97,v98,v99
v_mfma_f32_16x16x32_bf16 v[148:151],v[212:215],v[4:7],0
v_accvgpr_read_b32 v200,a32
v_accvgpr_read_b32 v201,a33
v_mfma_f32_16x16x32_bf16 v[152:155],v[212:215],v[8:11],0
v_accvgpr_read_b32 v202,a34
v_accvgpr_read_b32 v203,a35
v_mul_f32 v200,s61,v200
s_waitcnt lgkmcnt(2)
v_mfma_f32_16x16x32_bf16 v[128:131],v[216:219],v[16:19],v[128:131]
ds_read_b128 v[232:235],v252 offset:192
v_mul_f32 v201,s61,v201
v_mfma_f32_16x16x32_bf16 v[132:135],v[216:219],v[20:23],v[132:135]
v_mul_f32 v202,s61,v202
v_mul_f32 v203,s61,v203
v_mfma_f32_16x16x32_bf16 v[136:139],v[216:219],v[24:27],v[136:139]
ds_read_b128 v[236:239],v252 offset:704
v_cvt_pk_bf16_f32 v98,v200,v201
v_cvt_pk_bf16_f32 v99,v202,v203
v_mul_f32 v100,s61,v100
v_mfma_f32_16x16x32_bf16 v[144:147],v[220:223],v[16:19],v[144:147]
s_add_u32 m0,s29,0
v_mul_f32 v101,s61,v101
v_mfma_f32_16x16x32_bf16 v[148:151],v[220:223],v[20:23],v[148:151]
buffer_load_dwordx4 v254,s[8:11],s30 offen offset:0 nt lds
s_add_u32 m0,m0,0x00000220
v_mfma_f32_16x16x32_bf16 v[152:155],v[220:223],v[24:27],v[152:155]
v_mul_f32 v102,s61,v102
v_mul_f32 v103,s61,v103
v_cvt_pk_bf16_f32 v100,v100,v101
s_waitcnt lgkmcnt(2)
v_mfma_f32_16x16x32_bf16 v[128:131],v[224:227],v[32:35],v[128:131]
ds_read_b128 v[208:211],v252 offset:256
v_cvt_pk_bf16_f32 v101,v102,v103
v_mfma_f32_16x16x32_bf16 v[132:135],v[224:227],v[36:39],v[132:135]
v_accvgpr_read_b32 v204,a36
v_accvgpr_read_b32 v205,a37
v_mfma_f32_16x16x32_bf16 v[136:139],v[224:227],v[40:43],v[136:139]
ds_read_b128 v[212:215],v252 offset:768
v_accvgpr_read_b32 v206,a38
v_accvgpr_read_b32 v207,a39
v_mul_f32 v204,s61,v204
v_mfma_f32_16x16x32_bf16 v[144:147],v[228:231],v[32:35],v[144:147]
v_mul_f32 v205,s61,v205
v_mul_f32 v206,s61,v206
v_mfma_f32_16x16x32_bf16 v[148:151],v[228:231],v[36:39],v[148:151]
v_mul_f32 v207,s61,v207
v_cvt_pk_bf16_f32 v102,v204,v205
v_mfma_f32_16x16x32_bf16 v[152:155],v[228:231],v[40:43],v[152:155]
v_cvt_pk_bf16_f32 v103,v206,v207
v_mul_f32 v104,s61,v104
v_mul_f32 v105,s61,v105
s_waitcnt lgkmcnt(2)
v_mfma_f32_16x16x32_bf16 v[128:131],v[232:235],v[48:51],v[128:131]
ds_read_b128 v[216:219],v252 offset:320
buffer_load_dwordx4 v254,s[8:11],s30 offen offset:512 nt lds
v_mfma_f32_16x16x32_bf16 v[132:135],v[232:235],v[52:55],v[132:135]
s_add_u32 m0,m0,0x00000220
v_mul_f32 v106,s61,v106
v_mfma_f32_16x16x32_bf16 v[136:139],v[232:235],v[56:59],v[136:139]
ds_read_b128 v[220:223],v252 offset:832
v_mul_f32 v107,s61,v107
v_cvt_pk_bf16_f32 v104,v104,v105
v_cvt_pk_bf16_f32 v105,v106,v107
v_mfma_f32_16x16x32_bf16 v[144:147],v[236:239],v[48:51],v[144:147]
v_accvgpr_read_b32 v200,a40
v_accvgpr_read_b32 v201,a41
v_mfma_f32_16x16x32_bf16 v[148:151],v[236:239],v[52:55],v[148:151]
v_accvgpr_read_b32 v202,a42
v_accvgpr_read_b32 v203,a43
v_mfma_f32_16x16x32_bf16 v[152:155],v[236:239],v[56:59],v[152:155]
v_mul_f32 v200,s61,v200
v_mul_f32 v201,s61,v201
v_mul_f32 v202,s61,v202
s_waitcnt lgkmcnt(2)
v_mfma_f32_16x16x32_bf16 v[128:131],v[208:211],v[64:67],v[128:131]
ds_read_b128 v[224:227],v252 offset:384
v_mul_f32 v203,s61,v203
v_mfma_f32_16x16x32_bf16 v[132:135],v[208:211],v[68:71],v[132:135]
v_cvt_pk_bf16_f32 v106,v200,v201
v_cvt_pk_bf16_f32 v107,v202,v203
v_mfma_f32_16x16x32_bf16 v[136:139],v[208:211],v[72:75],v[136:139]
ds_read_b128 v[228:231],v252 offset:896
v_mul_f32 v112,s61,v112
buffer_load_dwordx4 v254,s[8:11],s30 offen offset:1024 nt lds
s_add_u32 m0,m0,0x00000220
v_mfma_f32_16x16x32_bf16 v[144:147],v[212:215],v[64:67],v[144:147]
v_mul_f32 v113,s61,v113
v_mul_f32 v114,s61,v114
v_mfma_f32_16x16x32_bf16 v[148:151],v[212:215],v[68:71],v[148:151]
v_mul_f32 v115,s61,v115
v_cvt_pk_bf16_f32 v112,v112,v113
v_mfma_f32_16x16x32_bf16 v[152:155],v[212:215],v[72:75],v[152:155]
v_cvt_pk_bf16_f32 v113,v114,v115
v_accvgpr_read_b32 v200,a48
v_accvgpr_read_b32 v201,a49
s_waitcnt lgkmcnt(2)
v_mfma_f32_16x16x32_bf16 v[128:131],v[216:219],v[80:83],v[128:131]
ds_read_b128 v[232:235],v252 offset:448
v_accvgpr_read_b32 v202,a50
v_mfma_f32_16x16x32_bf16 v[132:135],v[216:219],v[84:87],v[132:135]
v_accvgpr_read_b32 v203,a51
v_mul_f32 v200,s61,v200
v_mfma_f32_16x16x32_bf16 v[136:139],v[216:219],v[88:91],v[136:139]
ds_read_b128 v[236:239],v252 offset:960
v_mul_f32 v201,s61,v201
v_mul_f32 v202,s61,v202
v_mul_f32 v203,s61,v203
v_mfma_f32_16x16x32_bf16 v[144:147],v[220:223],v[80:83],v[144:147]
v_cvt_pk_bf16_f32 v114,v200,v201
v_cvt_pk_bf16_f32 v115,v202,v203
v_mfma_f32_16x16x32_bf16 v[148:151],v[220:223],v[84:87],v[148:151]
v_subrev_u32 v252,84480,v252
v_mul_f32 v116,s61,v116
v_mfma_f32_16x16x32_bf16 v[152:155],v[220:223],v[88:91],v[152:155]
buffer_load_dwordx4 v254,s[8:11],s30 offen offset:1536 nt lds
s_add_u32 s30,s30,16384
v_mul_f32 v117,s61,v117
s_waitcnt lgkmcnt(2)
v_mfma_f32_16x16x32_bf16 v[128:131],v[224:227],v[96:99],v[128:131]
v_mul_f32 v118,s61,v118
v_mul_f32 v119,s61,v119
v_mfma_f32_16x16x32_bf16 v[132:135],v[224:227],v[100:103],v[132:135]
s_waitcnt vmcnt(12) lgkmcnt(0)
s_barrier
v_mfma_f32_16x16x32_bf16 v[136:139],v[224:227],v[104:107],v[136:139]
ds_read_b128 v[208:211],v252 offset:0
v_cvt_pk_bf16_f32 v116,v116,v117
v_cvt_pk_bf16_f32 v117,v118,v119
v_accvgpr_read_b32 v204,a52
v_mfma_f32_16x16x32_bf16 v[144:147],v[228:231],v[96:99],v[144:147]
ds_read_b128 v[212:215],v252 offset:64
v_accvgpr_read_b32 v205,a53
v_mfma_f32_16x16x32_bf16 v[148:151],v[228:231],v[100:103],v[148:151]
v_accvgpr_read_b32 v206,a54
v_accvgpr_read_b32 v207,a55
v_mfma_f32_16x16x32_bf16 v[152:155],v[228:231],v[104:107],v[152:155]
v_mul_f32 v204,s61,v204
v_mul_f32 v205,s61,v205
v_mul_f32 v206,s61,v206
v_mul_f32 v207,s61,v207
v_cvt_pk_bf16_f32 v118,v204,v205
v_cvt_pk_bf16_f32 v119,v206,v207
v_mfma_f32_16x16x32_bf16 v[128:131],v[232:235],v[112:115],v[128:131]
ds_read_b128 v[216:219],v252 offset:128
v_mul_f32 v120,s61,v120
v_mul_f32 v121,s61,v121
v_mul_f32 v122,s61,v122
v_mul_f32 v123,s61,v123
v_cvt_pk_bf16_f32 v120,v120,v121
v_cvt_pk_bf16_f32 v121,v122,v123
v_accvgpr_read_b32 v200,a56
v_accvgpr_read_b32 v201,a57
v_accvgpr_read_b32 v202,a58
v_accvgpr_read_b32 v203,a59
v_mul_f32 v200,s61,v200
v_mul_f32 v201,s61,v201
v_mul_f32 v202,s61,v202
v_mul_f32 v203,s61,v203
v_cvt_pk_bf16_f32 v122,v200,v201
v_cvt_pk_bf16_f32 v123,v202,v203
v_mfma_f32_16x16x32_bf16 v[132:135],v[232:235],v[116:119],v[132:135]
v_mbcnt_lo_u32_b32 v253,-1,0
v_mbcnt_hi_u32_b32 v253,-1,v253
v_mfma_f32_16x16x32_bf16 v[136:139],v[232:235],v[120:123],v[136:139]
ds_read_b128 v[220:223],v252 offset:192
v_lshrrev_b32 v249,2,v253
v_mul_u32_u24 v249,1056,v249
v_and_b32 v253,3,v253
v_lshl_add_u32 v253,v253,3,v249
v_add_u32 v253,67584,v253
s_mov_b32 s34,s29
s_mov_b32 s35,s29
s_mov_b32 s33,33792
s_add_u32 s70,s29,67584
s_mov_b32 s36,5
v_mfma_f32_16x16x32_bf16 v[144:147],v[236:239],v[112:115],v[144:147]
v_mfma_f32_16x16x32_bf16 v[148:151],v[236:239],v[116:119],v[148:151]
v_mfma_f32_16x16x32_bf16 v[152:155],v[236:239],v[120:123],v[152:155]
v_mov_b32 v240,0
v_mov_b32 v241,0
v_mov_b32 v242,0
s_nop 3
v_max3_f32 v248,v128,v129,v130
v_max3_f32 v248,v248,v131,v144
v_max3_f32 v248,v248,v145,v146
v_max_f32 v248,v248,v147
v_max3_f32 v249,v132,v133,v134
v_max3_f32 v249,v249,v135,v148
v_max3_f32 v249,v249,v149,v150
v_max_f32 v249,v249,v151
v_max3_f32 v250,v136,v137,v138
v_max3_f32 v250,v250,v139,v152
v_max3_f32 v250,v250,v153,v154
v_max_f32 v250,v250,v155
v_mov_b32 v244,v248
v_mov_b32 v245,v249
v_mov_b32 v246,v250
v_permlane32_swap_b32 v244,v248
v_permlane32_swap_b32 v245,v249
v_permlane32_swap_b32 v246,v250
v_max_f32 v248,v244,v248
v_max_f32 v249,v245,v249
v_max_f32 v250,v246,v250
v_mov_b32 v244,v248
v_mov_b32 v245,v249
v_mov_b32 v246,v250
v_permlane16_swap_b32 v244,v248
v_permlane16_swap_b32 v245,v249
v_permlane16_swap_b32 v246,v250
v_max_f32 v248,v244,v248
v_max_f32 v249,v245,v249
v_max_f32 v250,v246,v250
v_sub_f32 v192,0,v248
v_sub_f32 v193,0,v248
v_sub_f32 v196,0,v249
v_sub_f32 v197,0,v249
v_sub_f32 v200,0,v250
v_sub_f32 v201,0,v250
v_pk_mul_f32 v[194:195],v[192:193],1.0 op_sel_hi:[1,0]
v_pk_add_f32 v[128:129],v[128:129],v[192:193]
v_pk_add_f32 v[130:131],v[130:131],v[192:193]
v_pk_add_f32 v[144:145],v[144:145],v[192:193]
v_pk_add_f32 v[146:147],v[146:147],v[192:193]
v_pk_mul_f32 v[198:199],v[196:197],1.0 op_sel_hi:[1,0]
v_pk_add_f32 v[132:133],v[132:133],v[196:197]
v_pk_add_f32 v[134:135],v[134:135],v[196:197]
v_pk_add_f32 v[148:149],v[148:149],v[196:197]
v_pk_add_f32 v[150:151],v[150:151],v[196:197]
v_pk_mul_f32 v[202:203],v[200:201],1.0 op_sel_hi:[1,0]
v_pk_add_f32 v[136:137],v[136:137],v[200:201]
v_pk_add_f32 v[138:139],v[138:139],v[200:201]
v_pk_add_f32 v[152:153],v[152:153],v[200:201]
v_pk_add_f32 v[154:155],v[154:155],v[200:201]
v_exp_f32 v128,v128
v_exp_f32 v129,v129
v_exp_f32 v130,v130
v_exp_f32 v131,v131
v_exp_f32 v144,v144
v_exp_f32 v145,v145
v_exp_f32 v146,v146
v_exp_f32 v147,v147
v_cvt_pk_bf16_f32 v160,v128,v129
v_cvt_pk_bf16_f32 v161,v130,v131
v_cvt_pk_bf16_f32 v162,v144,v145
v_cvt_pk_bf16_f32 v163,v146,v147
v_pk_add_f32 v[128:129],v[128:129],v[130:131]
v_pk_add_f32 v[144:145],v[144:145],v[146:147]
v_pk_add_f32 v[128:129],v[128:129],v[144:145]
v_add_f32 v244,v128,v129
v_exp_f32 v132,v132
v_exp_f32 v133,v133
v_exp_f32 v134,v134
v_exp_f32 v135,v135
v_exp_f32 v148,v148
v_exp_f32 v149,v149
v_exp_f32 v150,v150
v_exp_f32 v151,v151
v_cvt_pk_bf16_f32 v164,v132,v133
v_cvt_pk_bf16_f32 v165,v134,v135
v_cvt_pk_bf16_f32 v166,v148,v149
v_cvt_pk_bf16_f32 v167,v150,v151
v_pk_add_f32 v[132:133],v[132:133],v[134:135]
v_pk_add_f32 v[148:149],v[148:149],v[150:151]
v_pk_add_f32 v[132:133],v[132:133],v[148:149]
v_add_f32 v245,v132,v133
v_exp_f32 v136,v136
v_exp_f32 v137,v137
v_exp_f32 v138,v138
v_exp_f32 v139,v139
v_exp_f32 v152,v152
v_exp_f32 v153,v153
v_exp_f32 v154,v154
v_exp_f32 v155,v155
v_cvt_pk_bf16_f32 v168,v136,v137
v_cvt_pk_bf16_f32 v169,v138,v139
v_cvt_pk_bf16_f32 v170,v152,v153
v_cvt_pk_bf16_f32 v171,v154,v155
v_pk_add_f32 v[136:137],v[136:137],v[138:139]
v_pk_add_f32 v[152:153],v[152:153],v[154:155]
v_pk_add_f32 v[136:137],v[136:137],v[152:153]
v_add_f32 v246,v136,v137
s_waitcnt lgkmcnt(2)
v_mfma_f32_16x16x32_bf16 v[128:131],v[208:211],v[0:3],v[192:195]
ds_read_b128 v[224:227],v252 offset:256
s_add_u32 m0,s34,16896
v_mfma_f32_16x16x32_bf16 v[132:135],v[208:211],v[4:7],v[196:199]
buffer_load_dwordx4 v254,s[8:11],s30 offen offset:0 nt lds
s_add_u32 m0,m0,0x00000220
v_mfma_f32_16x16x32_bf16 v[136:139],v[208:211],v[8:11],v[200:203]
ds_read_b128 v[228:231],v252 offset:320
v_add_f32 v240,v240,v244
v_add_f32 v241,v241,v245
v_add_f32 v242,v242,v246
v_mfma_f32_16x16x32_bf16 v[128:131],v[212:215],v[16:19],v[128:131]
v_mfma_f32_16x16x32_bf16 v[132:135],v[212:215],v[20:23],v[132:135]
buffer_load_dwordx4 v254,s[8:11],s30 offen offset:512 nt lds
s_add_u32 m0,m0,0x00000220
v_mfma_f32_16x16x32_bf16 v[136:139],v[212:215],v[24:27],v[136:139]
s_waitcnt lgkmcnt(2)
v_mfma_f32_16x16x32_bf16 v[128:131],v[216:219],v[32:35],v[128:131]
ds_read_b128 v[232:235],v252 offset:384
v_mfma_f32_16x16x32_bf16 v[132:135],v[216:219],v[36:39],v[132:135]
buffer_load_dwordx4 v254,s[8:11],s30 offen offset:1024 nt lds
s_add_u32 m0,m0,0x00000220
v_mfma_f32_16x16x32_bf16 v[136:139],v[216:219],v[40:43],v[136:139]
ds_read_b128 v[236:239],v252 offset:448
v_mfma_f32_16x16x32_bf16 v[128:131],v[220:223],v[48:51],v[128:131]
v_mfma_f32_16x16x32_bf16 v[132:135],v[220:223],v[52:55],v[132:135]
buffer_load_dwordx4 v254,s[8:11],s30 offen offset:1536 nt lds
s_add_u32 s30,s30,16384
v_mfma_f32_16x16x32_bf16 v[136:139],v[220:223],v[56:59],v[136:139]
s_add_u32 m0,s35,118272
s_waitcnt lgkmcnt(2)
v_mfma_f32_16x16x32_bf16 v[128:131],v[224:227],v[64:67],v[128:131]
ds_read_b128 v[208:211],v252 offset:512
v_mfma_f32_16x16x32_bf16 v[132:135],v[224:227],v[68:71],v[132:135]
buffer_load_dwordx4 v254,s[12:15],s31 offen offset:0 nt lds
s_add_u32 m0,m0,0x00000220
v_mfma_f32_16x16x32_bf16 v[136:139],v[224:227],v[72:75],v[136:139]
ds_read_b128 v[212:215],v252 offset:576
v_mfma_f32_16x16x32_bf16 v[128:131],v[228:231],v[80:83],v[128:131]
v_mfma_f32_16x16x32_bf16 v[132:135],v[228:231],v[84:87],v[132:135]
buffer_load_dwordx4 v254,s[12:15],s31 offen offset:512 nt lds
s_add_u32 m0,m0,0x00000220
v_mfma_f32_16x16x32_bf16 v[136:139],v[228:231],v[88:91],v[136:139]
s_waitcnt lgkmcnt(2)
v_mfma_f32_16x16x32_bf16 v[128:131],v[232:235],v[96:99],v[128:131]
ds_read_b128 v[216:219],v252 offset:640
v_mfma_f32_16x16x32_bf16 v[132:135],v[232:235],v[100:103],v[132:135]
buffer_load_dwordx4 v254,s[12:15],s31 offen offset:1024 nt lds
s_add_u32 m0,m0,0x00000220
v_mfma_f32_16x16x32_bf16 v[136:139],v[232:235],v[104:107],v[136:139]
ds_read_b128 v[220:223],v252 offset:704
v_mfma_f32_16x16x32_bf16 v[128:131],v[236:239],v[112:115],v[128:131]
v_mfma_f32_16x16x32_bf16 v[132:135],v[236:239],v[116:119],v[132:135]
buffer_load_dwordx4 v254,s[12:15],s31 offen offset:1536 nt lds
s_add_u32 s31,s31,16384
v_mfma_f32_16x16x32_bf16 v[136:139],v[236:239],v[120:123],v[136:139]
s_waitcnt lgkmcnt(2)
v_mfma_f32_16x16x32_bf16 v[144:147],v[208:211],v[0:3],v[192:195]
ds_read_b128 v[224:227],v252 offset:768
v_mfma_f32_16x16x32_bf16 v[148:151],v[208:211],v[4:7],v[196:199]
v_mfma_f32_16x16x32_bf16 v[152:155],v[208:211],v[8:11],v[200:203]
ds_read_b128 v[228:231],v252 offset:832
v_exp_f32 v248,v128
v_mfma_f32_16x16x32_bf16 v[144:147],v[212:215],v[16:19],v[144:147]
v_exp_f32 v249,v129
v_mfma_f32_16x16x32_bf16 v[148:151],v[212:215],v[20:23],v[148:151]
v_exp_f32 v250,v130
v_mfma_f32_16x16x32_bf16 v[152:155],v[212:215],v[24:27],v[152:155]
v_exp_f32 v251,v131
v_add_f32 v244,v248,v249
s_waitcnt lgkmcnt(2)
v_mfma_f32_16x16x32_bf16 v[144:147],v[216:219],v[32:35],v[144:147]
ds_read_b128 v[232:235],v252 offset:896
v_cvt_pk_bf16_f32 v176,v248,v249
v_mfma_f32_16x16x32_bf16 v[148:151],v[216:219],v[36:39],v[148:151]
v_exp_f32 v248,v132
v_mfma_f32_16x16x32_bf16 v[152:155],v[216:219],v[40:43],v[152:155]
ds_read_b128 v[236:239],v252 offset:960
v_add_f32 v244,v244,v250
v_exp_f32 v249,v133
v_mfma_f32_16x16x32_bf16 v[144:147],v[220:223],v[48:51],v[144:147]
v_add_f32 v244,v244,v251
v_cvt_pk_bf16_f32 v177,v250,v251
v_mfma_f32_16x16x32_bf16 v[148:151],v[220:223],v[52:55],v[148:151]
v_exp_f32 v250,v134
v_mfma_f32_16x16x32_bf16 v[152:155],v[220:223],v[56:59],v[152:155]
v_exp_f32 v251,v135
v_add_f32 v245,v248,v249
s_waitcnt lgkmcnt(2)
v_mfma_f32_16x16x32_bf16 v[144:147],v[224:227],v[64:67],v[144:147]
ds_read_b64_tr_b16 v[208:209],v253 offset:0
v_cvt_pk_bf16_f32 v180,v248,v249
v_mfma_f32_16x16x32_bf16 v[148:151],v[224:227],v[68:71],v[148:151]
ds_read_b64_tr_b16 v[210:211],v253 offset:512
v_add_f32 v245,v245,v250
v_mfma_f32_16x16x32_bf16 v[152:155],v[224:227],v[72:75],v[152:155]
ds_read_b64_tr_b16 v[212:213],v253 offset:32
v_add_f32 v245,v245,v251
ds_read_b64_tr_b16 v[214:215],v253 offset:544
v_cvt_pk_bf16_f32 v181,v250,v251
v_mfma_f32_16x16x32_bf16 v[144:147],v[228:231],v[80:83],v[144:147]
v_exp_f32 v248,v136
v_mfma_f32_16x16x32_bf16 v[148:151],v[228:231],v[84:87],v[148:151]
v_exp_f32 v249,v137
v_mfma_f32_16x16x32_bf16 v[152:155],v[228:231],v[88:91],v[152:155]
v_exp_f32 v250,v138
v_add_f32 v246,v248,v249
s_waitcnt lgkmcnt(4)
v_mfma_f32_16x16x32_bf16 v[144:147],v[232:235],v[96:99],v[144:147]
ds_read_b64_tr_b16 v[216:217],v253 offset:64
v_cvt_pk_bf16_f32 v184,v248,v249
v_mfma_f32_16x16x32_bf16 v[148:151],v[232:235],v[100:103],v[148:151]
ds_read_b64_tr_b16 v[218:219],v253 offset:576
v_mfma_f32_16x16x32_bf16 v[152:155],v[232:235],v[104:107],v[152:155]
ds_read_b64_tr_b16 v[220:221],v253 offset:96
ds_read_b64_tr_b16 v[222:223],v253 offset:608
v_mfma_f32_16x16x32_bf16 v[144:147],v[236:239],v[112:115],v[144:147]
v_exp_f32 v251,v139
v_mfma_f32_16x16x32_bf16 v[148:151],v[236:239],v[116:119],v[148:151]
v_add_f32 v246,v246,v250
v_add_f32 v246,v246,v251
v_mfma_f32_16x16x32_bf16 v[152:155],v[236:239],v[120:123],v[152:155]
v_cvt_pk_bf16_f32 v185,v250,v251
s_waitcnt lgkmcnt(4)
v_mfma_f32_16x16x32_bf16 a[0:3],v[208:211],v[160:163],0
ds_read_b64_tr_b16 v[224:225],v253 offset:128
v_mfma_f32_16x16x32_bf16 a[4:7],v[208:211],v[164:167],0
ds_read_b64_tr_b16 v[226:227],v253 offset:640
v_mfma_f32_16x16x32_bf16 a[8:11],v[208:211],v[168:171],0
ds_read_b64_tr_b16 v[228:229],v253 offset:160
ds_read_b64_tr_b16 v[230:231],v253 offset:672
v_mfma_f32_16x16x32_bf16 a[16:19],v[212:215],v[160:163],0
v_exp_f32 v248,v144
v_mfma_f32_16x16x32_bf16 a[20:23],v[212:215],v[164:167],0
v_exp_f32 v249,v145
v_mfma_f32_16x16x32_bf16 a[24:27],v[212:215],v[168:171],0
v_exp_f32 v250,v146
v_add_f32 v244,v244,v248
s_waitcnt lgkmcnt(4)
v_mfma_f32_16x16x32_bf16 a[32:35],v[216:219],v[160:163],0
ds_read_b64_tr_b16 v[232:233],v253 offset:192
v_add_f32 v244,v244,v249
v_mfma_f32_16x16x32_bf16 a[36:39],v[216:219],v[164:167],0
ds_read_b64_tr_b16 v[234:235],v253 offset:704
v_cvt_pk_bf16_f32 v178,v248,v249
v_mfma_f32_16x16x32_bf16 a[40:43],v[216:219],v[168:171],0
ds_read_b64_tr_b16 v[236:237],v253 offset:224
ds_read_b64_tr_b16 v[238:239],v253 offset:736
v_mfma_f32_16x16x32_bf16 a[48:51],v[220:223],v[160:163],0
v_exp_f32 v251,v147
v_mfma_f32_16x16x32_bf16 a[52:55],v[220:223],v[164:167],0
v_exp_f32 v248,v148
v_mfma_f32_16x16x32_bf16 a[56:59],v[220:223],v[168:171],0
v_exp_f32 v249,v149
v_add_f32 v244,v244,v250
s_waitcnt lgkmcnt(4)
v_mfma_f32_16x16x32_bf16 a[64:67],v[224:227],v[160:163],0
ds_read_b64_tr_b16 v[208:209],v253 offset:256
v_add_f32 v244,v244,v251
v_mfma_f32_16x16x32_bf16 a[68:71],v[224:227],v[164:167],0
ds_read_b64_tr_b16 v[210:211],v253 offset:768
v_cvt_pk_bf16_f32 v179,v250,v251
v_mfma_f32_16x16x32_bf16 a[72:75],v[224:227],v[168:171],0
ds_read_b64_tr_b16 v[212:213],v253 offset:288
v_add_f32 v245,v245,v248
ds_read_b64_tr_b16 v[214:215],v253 offset:800
v_add_f32 v245,v245,v249
v_mfma_f32_16x16x32_bf16 a[80:83],v[228:231],v[160:163],0
v_exp_f32 v250,v150
v_mfma_f32_16x16x32_bf16 a[84:87],v[228:231],v[164:167],0
v_exp_f32 v251,v151
v_mfma_f32_16x16x32_bf16 a[88:91],v[228:231],v[168:171],0
v_cvt_pk_bf16_f32 v182,v248,v249
v_add_f32 v245,v245,v250
s_waitcnt lgkmcnt(4)
v_mfma_f32_16x16x32_bf16 a[96:99],v[232:235],v[160:163],0
ds_read_b64_tr_b16 v[216:217],v253 offset:320
v_add_f32 v245,v245,v251
v_mfma_f32_16x16x32_bf16 a[100:103],v[232:235],v[164:167],0
ds_read_b64_tr_b16 v[218:219],v253 offset:832
v_cvt_pk_bf16_f32 v183,v250,v251
v_mfma_f32_16x16x32_bf16 a[104:107],v[232:235],v[168:171],0
ds_read_b64_tr_b16 v[220:221],v253 offset:352
ds_read_b64_tr_b16 v[222:223],v253 offset:864
v_mfma_f32_16x16x32_bf16 a[112:115],v[236:239],v[160:163],0
v_exp_f32 v248,v152
v_mfma_f32_16x16x32_bf16 a[116:119],v[236:239],v[164:167],0
v_exp_f32 v249,v153
v_mfma_f32_16x16x32_bf16 a[120:123],v[236:239],v[168:171],0
v_exp_f32 v250,v154
v_add_f32 v246,v246,v248
s_waitcnt lgkmcnt(4)
v_mfma_f32_16x16x32_bf16 a[128:131],v[208:211],v[160:163],0
ds_read_b64_tr_b16 v[224:225],v253 offset:384
v_add_f32 v246,v246,v249
v_mfma_f32_16x16x32_bf16 a[132:135],v[208:211],v[164:167],0
ds_read_b64_tr_b16 v[226:227],v253 offset:896
v_cvt_pk_bf16_f32 v186,v248,v249
v_mfma_f32_16x16x32_bf16 a[136:139],v[208:211],v[168:171],0
ds_read_b64_tr_b16 v[228:229],v253 offset:416
ds_read_b64_tr_b16 v[230:231],v253 offset:928
v_mfma_f32_16x16x32_bf16 a[144:147],v[212:215],v[160:163],0
v_exp_f32 v251,v155
v_mfma_f32_16x16x32_bf16 a[148:151],v[212:215],v[164:167],0
v_add_f32 v246,v246,v250
v_add_f32 v246,v246,v251
v_mfma_f32_16x16x32_bf16 a[152:155],v[212:215],v[168:171],0
v_cvt_pk_bf16_f32 v187,v250,v251
v_max3_f32 v248,v244,v245,v246
v_cmp_lt_f32 vcc,0x49800000,v248
s_waitcnt lgkmcnt(4)
v_mfma_f32_16x16x32_bf16 a[160:163],v[216:219],v[160:163],0
ds_read_b64_tr_b16 v[232:233],v253 offset:448
v_mfma_f32_16x16x32_bf16 a[164:167],v[216:219],v[164:167],0
ds_read_b64_tr_b16 v[234:235],v253 offset:960
v_mfma_f32_16x16x32_bf16 a[168:171],v[216:219],v[168:171],0
ds_read_b64_tr_b16 v[236:237],v253 offset:480
ds_read_b64_tr_b16 v[238:239],v253 offset:992
v_mfma_f32_16x16x32_bf16 a[176:179],v[220:223],v[160:163],0
v_mfma_f32_16x16x32_bf16 a[180:183],v[220:223],v[164:167],0
v_mfma_f32_16x16x32_bf16 a[184:187],v[220:223],v[168:171],0
s_waitcnt lgkmcnt(4)
v_mfma_f32_16x16x32_bf16 a[192:195],v[224:227],v[160:163],0
v_mfma_f32_16x16x32_bf16 a[196:199],v[224:227],v[164:167],0
s_waitcnt vmcnt(16) lgkmcnt(0)
s_barrier
v_mfma_f32_16x16x32_bf16 a[200:203],v[224:227],v[168:171],0
ds_read_b128 v[208:211],v252 offset:16896
v_mfma_f32_16x16x32_bf16 a[208:211],v[228:231],v[160:163],0
ds_read_b128 v[212:215],v252 offset:16960
v_mfma_f32_16x16x32_bf16 a[212:215],v[228:231],v[164:167],0
v_mfma_f32_16x16x32_bf16 a[216:219],v[228:231],v[168:171],0
v_mfma_f32_16x16x32_bf16 a[224:227],v[232:235],v[160:163],0
ds_read_b128 v[216:219],v252 offset:17024
v_mfma_f32_16x16x32_bf16 a[228:231],v[232:235],v[164:167],0
v_mfma_f32_16x16x32_bf16 a[232:235],v[232:235],v[168:171],0
ds_read_b128 v[220:223],v252 offset:17088
v_mfma_f32_16x16x32_bf16 a[240:243],v[236:239],v[160:163],0
v_mfma_f32_16x16x32_bf16 a[244:247],v[236:239],v[164:167],0
v_mfma_f32_16x16x32_bf16 a[248:251],v[236:239],v[168:171],0
s_waitcnt lgkmcnt(2)
s_cbranch_vccnz M_stub0
M_back0:
v_mfma_f32_16x16x32_bf16 v[128:131],v[208:211],v[0:3],v[192:195]
ds_read_b128 v[224:227],v252 offset:17152
s_add_u32 m0,s35,33792
v_mfma_f32_16x16x32_bf16 v[132:135],v[208:211],v[4:7],v[196:199]
buffer_load_dwordx4 v254,s[8:11],s30 offen offset:0 nt lds
s_add_u32 m0,m0,0x00000220
v_mfma_f32_16x16x32_bf16 v[136:139],v[208:211],v[8:11],v[200:203]
ds_read_b128 v[228:231],v252 offset:17216
v_add_f32 v240,v240,v244
v_add_f32 v241,v241,v245
v_add_f32 v242,v242,v246
v_mfma_f32_16x16x32_bf16 v[128:131],v[212:215],v[16:19],v[128:131]
v_mfma_f32_16x16x32_bf16 v[132:135],v[212:215],v[20:23],v[132:135]
buffer_load_dwordx4 v254,s[8:11],s30 offen offset:512 nt lds
s_add_u32 m0,m0,0x00000220
v_mfma_f32_16x16x32_bf16 v[136:139],v[212:215],v[24:27],v[136:139]
s_waitcnt lgkmcnt(2)
v_mfma_f32_16x16x32_bf16 v[128:131],v[216:219],v[32:35],v[128:131]
ds_read_b128 v[232:235],v252 offset:17280
v_mfma_f32_16x16x32_bf16 v[132:135],v[216:219],v[36:39],v[132:135]
buffer_load_dwordx4 v254,s[8:11],s30 offen offset:1024 nt lds
s_add_u32 m0,m0,0x00000220
v_mfma_f32_16x16x32_bf16 v[136:139],v[216:219],v[40:43],v[136:139]
ds_read_b128 v[236:239],v252 offset:17344
v_mfma_f32_16x16x32_bf16 v[128:131],v[220:223],v[48:51],v[128:131]
v_mfma_f32_16x16x32_bf16 v[132:135],v[220:223],v[52:55],v[132:135]
buffer_load_dwordx4 v254,s[8:11],s30 offen offset:1536 nt lds
s_add_u32 s30,s30,16384
v_mfma_f32_16x16x32_bf16 v[136:139],v[220:223],v[56:59],v[136:139]
s_add_u32 m0,s34,67584
s_waitcnt lgkmcnt(2)
v_mfma_f32_16x16x32_bf16 v[128:131],v[224:227],v[64:67],v[128:131]
ds_read_b128 v[208:211],v252 offset:17408
v_mfma_f32_16x16x32_bf16 v[132:135],v[224:227],v[68:71],v[132:135]
buffer_load_dwordx4 v254,s[12:15],s31 offen offset:0 nt lds
s_add_u32 m0,m0,0x00000220
v_mfma_f32_16x16x32_bf16 v[136:139],v[224:227],v[72:75],v[136:139]
ds_read_b128 v[212:215],v252 offset:17472
v_mfma_f32_16x16x32_bf16 v[128:131],v[228:231],v[80:83],v[128:131]
v_mfma_f32_16x16x32_bf16 v[132:135],v[228:231],v[84:87],v[132:135]
buffer_load_dwordx4 v254,s[12:15],s31 offen offset:512 nt lds
s_add_u32 m0,m0,0x00000220
v_mfma_f32_16x16x32_bf16 v[136:139],v[228:231],v[88:91],v[136:139]
s_waitcnt lgkmcnt(2)
v_mfma_f32_16x16x32_bf16 v[128:131],v[232:235],v[96:99],v[128:131]
ds_read_b128 v[216:219],v252 offset:17536
v_mfma_f32_16x16x32_bf16 v[132:135],v[232:235],v[100:103],v[132:135]
buffer_load_dwordx4 v254,s[12:15],s31 offen offset:1024 nt lds
s_add_u32 m0,m0,0x00000220
v_mfma_f32_16x16x32_bf16 v[136:139],v[232:235],v[104:107],v[136:139]
ds_read_b128 v[220:223],v252 offset:17600
v_mfma_f32_16x16x32_bf16 v[128:131],v[236:239],v[112:115],v[128:131]
v_mfma_f32_16x16x32_bf16 v[132:135],v[236:239],v[116:119],v[132:135]
buffer_load_dwordx4 v254,s[12:15],s31 offen offset:1536 nt lds
s_add_u32 s31,s31,16384
v_mfma_f32_16x16x32_bf16 v[136:139],v[236:239],v[120:123],v[136:139]
s_waitcnt lgkmcnt(2)
v_mfma_f32_16x16x32_bf16 v[144:147],v[208:211],v[0:3],v[192:195]
ds_read_b128 v[224:227],v252 offset:17664
v_mfma_f32_16x16x32_bf16 v[148:151],v[208:211],v[4:7],v[196:199]
v_mfma_f32_16x16x32_bf16 v[152:155],v[208:211],v[8:11],v[200:203]
ds_read_b128 v[228:231],v252 offset:17728
v_exp_f32 v248,v128
v_mfma_f32_16x16x32_bf16 v[144:147],v[212:215],v[16:19],v[144:147]
v_exp_f32 v249,v129
v_mfma_f32_16x16x32_bf16 v[148:151],v[212:215],v[20:23],v[148:151]
v_exp_f32 v250,v130
v_mfma_f32_16x16x32_bf16 v[152:155],v[212:215],v[24:27],v[152:155]
v_exp_f32 v251,v131
v_add_f32 v244,v248,v249
s_waitcnt lgkmcnt(2)
v_mfma_f32_16x16x32_bf16 v[144:147],v[216:219],v[32:35],v[144:147]
ds_read_b128 v[232:235],v252 offset:17792
v_cvt_pk_bf16_f32 v160,v248,v249
v_mfma_f32_16x16x32_bf16 v[148:151],v[216:219],v[36:39],v[148:151]
v_exp_f32 v248,v132
v_mfma_f32_16x16x32_bf16 v[152:155],v[216:219],v[40:43],v[152:155]
ds_read_b128 v[236:239],v252 offset:17856
v_add_f32 v244,v244,v250
v_exp_f32 v249,v133
v_mfma_f32_16x16x32_bf16 v[144:147],v[220:223],v[48:51],v[144:147]
v_add_f32 v244,v244,v251
v_cvt_pk_bf16_f32 v161,v250,v251
v_mfma_f32_16x16x32_bf16 v[148:151],v[220:223],v[52:55],v[148:151]
v_exp_f32 v250,v134
v_mfma_f32_16x16x32_bf16 v[152:155],v[220:223],v[56:59],v[152:155]
v_exp_f32 v251,v135
v_add_f32 v245,v248,v249
s_waitcnt lgkmcnt(2)
v_mfma_f32_16x16x32_bf16 v[144:147],v[224:227],v[64:67],v[144:147]
ds_read_b64_tr_b16 v[208:209],v253 offset:16896
v_subrev_u32 v252,s33,v252
v_mfma_f32_16x16x32_bf16 v[148:151],v[224:227],v[68:71],v[148:151]
ds_read_b64_tr_b16 v[210:211],v253 offset:17408
v_cvt_pk_bf16_f32 v164,v248,v249
v_mfma_f32_16x16x32_bf16 v[152:155],v[224:227],v[72:75],v[152:155]
ds_read_b64_tr_b16 v[212:213],v253 offset:16928
v_add_f32 v245,v245,v250
ds_read_b64_tr_b16 v[214:215],v253 offset:17440
v_add_f32 v245,v245,v251
v_mfma_f32_16x16x32_bf16 v[144:147],v[228:231],v[80:83],v[144:147]
v_exp_f32 v248,v136
v_mfma_f32_16x16x32_bf16 v[148:151],v[228:231],v[84:87],v[148:151]
v_exp_f32 v249,v137
v_mfma_f32_16x16x32_bf16 v[152:155],v[228:231],v[88:91],v[152:155]
v_cvt_pk_bf16_f32 v165,v250,v251
v_add_f32 v246,v248,v249
s_waitcnt lgkmcnt(4)
v_mfma_f32_16x16x32_bf16 v[144:147],v[232:235],v[96:99],v[144:147]
ds_read_b64_tr_b16 v[216:217],v253 offset:16960
v_cvt_pk_bf16_f32 v168,v248,v249
v_mfma_f32_16x16x32_bf16 v[148:151],v[232:235],v[100:103],v[148:151]
ds_read_b64_tr_b16 v[218:219],v253 offset:17472
v_mfma_f32_16x16x32_bf16 v[152:155],v[232:235],v[104:107],v[152:155]
ds_read_b64_tr_b16 v[220:221],v253 offset:16992
ds_read_b64_tr_b16 v[222:223],v253 offset:17504
v_mfma_f32_16x16x32_bf16 v[144:147],v[236:239],v[112:115],v[144:147]
s_add_u32 s34,s34,s33
s_sub_u32 s35,s35,s33
v_mfma_f32_16x16x32_bf16 v[148:151],v[236:239],v[116:119],v[148:151]
v_exp_f32 v250,v138
v_mfma_f32_16x16x32_bf16 v[152:155],v[236:239],v[120:123],v[152:155]
v_exp_f32 v251,v139
v_add_f32 v246,v246,v250
s_waitcnt lgkmcnt(4)
v_mfma_f32_16x16x32_bf16 a[0:3],v[208:211],v[176:179],a[0:3]
ds_read_b64_tr_b16 v[224:225],v253 offset:17024
v_add_f32 v246,v246,v251
v_mfma_f32_16x16x32_bf16 a[4:7],v[208:211],v[180:183],a[4:7]
ds_read_b64_tr_b16 v[226:227],v253 offset:17536
v_cvt_pk_bf16_f32 v169,v250,v251
v_mfma_f32_16x16x32_bf16 a[8:11],v[208:211],v[184:187],a[8:11]
ds_read_b64_tr_b16 v[228:229],v253 offset:17056
ds_read_b64_tr_b16 v[230:231],v253 offset:17568
v_mfma_f32_16x16x32_bf16 a[16:19],v[212:215],v[176:179],a[16:19]
v_exp_f32 v248,v144
v_mfma_f32_16x16x32_bf16 a[20:23],v[212:215],v[180:183],a[20:23]
v_exp_f32 v249,v145
v_mfma_f32_16x16x32_bf16 a[24:27],v[212:215],v[184:187],a[24:27]
v_exp_f32 v250,v146
v_add_f32 v244,v244,v248
s_waitcnt lgkmcnt(4)
v_mfma_f32_16x16x32_bf16 a[32:35],v[216:219],v[176:179],a[32:35]
ds_read_b64_tr_b16 v[232:233],v253 offset:17088
v_add_f32 v244,v244,v249
v_mfma_f32_16x16x32_bf16 a[36:39],v[216:219],v[180:183],a[36:39]
ds_read_b64_tr_b16 v[234:235],v253 offset:17600
v_cvt_pk_bf16_f32 v162,v248,v249
v_mfma_f32_16x16x32_bf16 a[40:43],v[216:219],v[184:187],a[40:43]
ds_read_b64_tr_b16 v[236:237],v253 offset:17120
ds_read_b64_tr_b16 v[238:239],v253 offset:17632
v_mfma_f32_16x16x32_bf16 a[48:51],v[220:223],v[176:179],a[48:51]
v_exp_f32 v251,v147
v_mfma_f32_16x16x32_bf16 a[52:55],v[220:223],v[180:183],a[52:55]
v_exp_f32 v248,v148
v_mfma_f32_16x16x32_bf16 a[56:59],v[220:223],v[184:187],a[56:59]
v_exp_f32 v249,v149
v_add_f32 v244,v244,v250
s_waitcnt lgkmcnt(4)
v_mfma_f32_16x16x32_bf16 a[64:67],v[224:227],v[176:179],a[64:67]
ds_read_b64_tr_b16 v[208:209],v253 offset:17152
v_add_f32 v244,v244,v251
v_mfma_f32_16x16x32_bf16 a[68:71],v[224:227],v[180:183],a[68:71]
ds_read_b64_tr_b16 v[210:211],v253 offset:17664
v_cvt_pk_bf16_f32 v163,v250,v251
v_mfma_f32_16x16x32_bf16 a[72:75],v[224:227],v[184:187],a[72:75]
ds_read_b64_tr_b16 v[212:213],v253 offset:17184
v_add_f32 v245,v245,v248
ds_read_b64_tr_b16 v[214:215],v253 offset:17696
v_add_f32 v245,v245,v249
v_mfma_f32_16x16x32_bf16 a[80:83],v[228:231],v[176:179],a[80:83]
v_exp_f32 v250,v150
v_mfma_f32_16x16x32_bf16 a[84:87],v[228:231],v[180:183],a[84:87]
v_exp_f32 v251,v151
v_mfma_f32_16x16x32_bf16 a[88:91],v[228:231],v[184:187],a[88:91]
v_cvt_pk_bf16_f32 v166,v248,v249
v_add_f32 v245,v245,v250
s_waitcnt lgkmcnt(4)
v_mfma_f32_16x16x32_bf16 a[96:99],v[232:235],v[176:179],a[96:99]
ds_read_b64_tr_b16 v[216:217],v253 offset:17216
v_add_f32 v245,v245,v251
v_mfma_f32_16x16x32_bf16 a[100:103],v[232:235],v[180:183],a[100:103]
ds_read_b64_tr_b16 v[218:219],v253 offset:17728
v_cvt_pk_bf16_f32 v167,v250,v251
v_mfma_f32_16x16x32_bf16 a[104:107],v[232:235],v[184:187],a[104:107]
ds_read_b64_tr_b16 v[220:221],v253 offset:17248
ds_read_b64_tr_b16 v[222:223],v253 offset:17760
v_mfma_f32_16x16x32_bf16 a[112:115],v[236:239],v[176:179],a[112:115]
v_exp_f32 v248,v152
v_mfma_f32_16x16x32_bf16 a[116:119],v[236:239],v[180:183],a[116:119]
v_exp_f32 v249,v153
v_mfma_f32_16x16x32_bf16 a[120:123],v[236:239],v[184:187],a[120:123]
v_exp_f32 v250,v154
v_add_f32 v246,v246,v248
s_waitcnt lgkmcnt(4)
v_mfma_f32_16x16x32_bf16 a[128:131],v[208:211],v[176:179],a[128:131]
ds_read_b64_tr_b16 v[224:225],v253 offset:17280
v_add_f32 v246,v246,v249
v_mfma_f32_16x16x32_bf16 a[132:135],v[208:211],v[180:183],a[132:135]
ds_read_b64_tr_b16 v[226:227],v253 offset:17792
v_cvt_pk_bf16_f32 v170,v248,v249
v_mfma_f32_16x16x32_bf16 a[136:139],v[208:211],v[184:187],a[136:139]
ds_read_b64_tr_b16 v[228:229],v253 offset:17312
ds_read_b64_tr_b16 v[230:231],v253 offset:17824
v_mfma_f32_16x16x32_bf16 a[144:147],v[212:215],v[176:179],a[144:147]
v_exp_f32 v251,v155
v_mfma_f32_16x16x32_bf16 a[148:151],v[212:215],v[180:183],a[148:151]
v_add_f32 v246,v246,v250
v_add_f32 v246,v246,v251
v_mfma_f32_16x16x32_bf16 a[152:155],v[212:215],v[184:187],a[152:155]
v_cvt_pk_bf16_f32 v171,v250,v251
v_max3_f32 v248,v244,v245,v246
v_cmp_lt_f32 vcc,0x49800000,v248
s_waitcnt lgkmcnt(4)
v_mfma_f32_16x16x32_bf16 a[160:163],v[216:219],v[176:179],a[160:163]
ds_read_b64_tr_b16 v[232:233],v253 offset:17344
v_mfma_f32_16x16x32_bf16 a[164:167],v[216:219],v[180:183],a[164:167]
ds_read_b64_tr_b16 v[234:235],v253 offset:17856
v_mfma_f32_16x16x32_bf16 a[168:171],v[216:219],v[184:187],a[168:171]
ds_read_b64_tr_b16 v[236:237],v253 offset:17376
ds_read_b64_tr_b16 v[238:239],v253 offset:17888
v_mfma_f32_16x16x32_bf16 a[176:179],v[220:223],v[176:179],a[176:179]
v_add_u32 v253,s33,v253
s_sub_u32 s33,0,s33
v_mfma_f32_16x16x32_bf16 a[180:183],v[220:223],v[180:183],a[180:183]
v_mfma_f32_16x16x32_bf16 a[184:187],v[220:223],v[184:187],a[184:187]
s_waitcnt lgkmcnt(4)
v_mfma_f32_16x16x32_bf16 a[192:195],v[224:227],v[176:179],a[192:195]
v_mfma_f32_16x16x32_bf16 a[196:199],v[224:227],v[180:183],a[196:199]
s_waitcnt vmcnt(16) lgkmcnt(0)
s_barrier
v_mfma_f32_16x16x32_bf16 a[200:203],v[224:227],v[184:187],a[200:203]
ds_read_b128 v[208:211],v252 offset:0
v_mfma_f32_16x16x32_bf16 a[208:211],v[228:231],v[176:179],a[208:211]
ds_read_b128 v[212:215],v252 offset:64
v_mfma_f32_16x16x32_bf16 a[212:215],v[228:231],v[180:183],a[212:215]
v_mfma_f32_16x16x32_bf16 a[216:219],v[228:231],v[184:187],a[216:219]
v_mfma_f32_16x16x32_bf16 a[224:227],v[232:235],v[176:179],a[224:227]
ds_read_b128 v[216:219],v252 offset:128
v_mfma_f32_16x16x32_bf16 a[228:231],v[232:235],v[180:183],a[228:231]
v_mfma_f32_16x16x32_bf16 a[232:235],v[232:235],v[184:187],a[232:235]
ds_read_b128 v[220:223],v252 offset:192
v_mfma_f32_16x16x32_bf16 a[240:243],v[236:239],v[176:179],a[240:243]
v_mfma_f32_16x16x32_bf16 a[244:247],v[236:239],v[180:183],a[244:247]
v_mfma_f32_16x16x32_bf16 a[248:251],v[236:239],v[184:187],a[248:251]
s_waitcnt lgkmcnt(2)
s_cbranch_vccnz M_stub1
M_back1:
.p2alignl 6, 0xbf800000
M_aloop:
v_mfma_f32_16x16x32_bf16 v[128:131],v[208:211],v[0:3],v[192:195]
ds_read_b128 v[224:227],v252 offset:256
s_add_u32 m0,s34,16896
v_mfma_f32_16x16x32_bf16 v[132:135],v[208:211],v[4:7],v[196:199]
buffer_load_dwordx4 v254,s[8:11],s30 offen offset:0 nt lds
s_add_u32 m0,m0,0x00000220
v_mfma_f32_16x16x32_bf16 v[136:139],v[208:211],v[8:11],v[200:203]
ds_read_b128 v[228:231],v252 offset:320
v_add_f32 v240,v240,v244
v_add_f32 v241,v241,v245
v_add_f32 v242,v242,v246
v_mfma_f32_16x16x32_bf16 v[128:131],v[212:215],v[16:19],v[128:131]
v_mfma_f32_16x16x32_bf16 v[132:135],v[212:215],v[20:23],v[132:135]
buffer_load_dwordx4 v254,s[8:11],s30 offen offset:512 nt lds
s_add_u32 m0,m0,0x00000220
v_mfma_f32_16x16x32_bf16 v[136:139],v[212:215],v[24:27],v[136:139]
s_waitcnt lgkmcnt(2)
v_mfma_f32_16x16x32_bf16 v[128:131],v[216:219],v[32:35],v[128:131]
ds_read_b128 v[232:235],v252 offset:384
v_mfma_f32_16x16x32_bf16 v[132:135],v[216:219],v[36:39],v[132:135]
buffer_load_dwordx4 v254,s[8:11],s30 offen offset:1024 nt lds
s_add_u32 m0,m0,0x00000220
v_mfma_f32_16x16x32_bf16 v[136:139],v[216:219],v[40:43],v[136:139]
ds_read_b128 v[236:239],v252 offset:448
v_mfma_f32_16x16x32_bf16 v[128:131],v[220:223],v[48:51],v[128:131]
v_mfma_f32_16x16x32_bf16 v[132:135],v[220:223],v[52:55],v[132:135]
buffer_load_dwordx4 v254,s[8:11],s30 offen offset:1536 nt lds
s_add_u32 s30,s30,16384
v_mfma_f32_16x16x32_bf16 v[136:139],v[220:223],v[56:59],v[136:139]
s_add_u32 m0,s35,118272
s_waitcnt lgkmcnt(2)
v_mfma_f32_16x16x32_bf16 v[128:131],v[224:227],v[64:67],v[128:131]
ds_read_b128 v[208:211],v252 offset:512
v_mfma_f32_16x16x32_bf16 v[132:135],v[224:227],v[68:71],v[132:135]
buffer_load_dwordx4 v254,s[12:15],s31 offen offset:0 nt lds
s_add_u32 m0,m0,0x00000220
v_mfma_f32_16x16x32_bf16 v[136:139],v[224:227],v[72:75],v[136:139]
ds_read_b128 v[212:215],v252 offset:576
v_mfma_f32_16x16x32_bf16 v[128:131],v[228:231],v[80:83],v[128:131]
v_mfma_f32_16x16x32_bf16 v[132:135],v[228:231],v[84:87],v[132:135]
buffer_load_dwordx4 v254,s[12:15],s31 offen offset:512 nt lds
s_add_u32 m0,m0,0x00000220
v_mfma_f32_16x16x32_bf16 v[136:139],v[228:231],v[88:91],v[136:139]
s_waitcnt lgkmcnt(2)
v_mfma_f32_16x16x32_bf16 v[128:131],v[232:235],v[96:99],v[128:131]
ds_read_b128 v[216:219],v252 offset:640
v_mfma_f32_16x16x32_bf16 v[132:135],v[232:235],v[100:103],v[132:135]
buffer_load_dwordx4 v254,s[12:15],s31 offen offset:1024 nt lds
s_add_u32 m0,m0,0x00000220
v_mfma_f32_16x16x32_bf16 v[136:139],v[232:235],v[104:107],v[136:139]
ds_read_b128 v[220:223],v252 offset:704
v_mfma_f32_16x16x32_bf16 v[128:131],v[236:239],v[112:115],v[128:131]
v_mfma_f32_16x16x32_bf16 v[132:135],v[236:239],v[116:119],v[132:135]
buffer_load_dwordx4 v254,s[12:15],s31 offen offset:1536 nt lds
s_add_u32 s31,s31,16384
v_mfma_f32_16x16x32_bf16 v[136:139],v[236:239],v[120:123],v[136:139]
s_waitcnt lgkmcnt(2)
v_mfma_f32_16x16x32_bf16 v[144:147],v[208:211],v[0:3],v[192:195]
ds_read_b128 v[224:227],v252 offset:768
v_mfma_f32_16x16x32_bf16 v[148:151],v[208:211],v[4:7],v[196:199]
v_mfma_f32_16x16x32_bf16 v[152:155],v[208:211],v[8:11],v[200:203]
ds_read_b128 v[228:231],v252 offset:832
v_exp_f32 v248,v128
v_mfma_f32_16x16x32_bf16 v[144:147],v[212:215],v[16:19],v[144:147]
v_exp_f32 v249,v129
v_mfma_f32_16x16x32_bf16 v[148:151],v[212:215],v[20:23],v[148:151]
v_exp_f32 v250,v130
v_mfma_f32_16x16x32_bf16 v[152:155],v[212:215],v[24:27],v[152:155]
v_exp_f32 v251,v131
v_add_f32 v244,v248,v249
s_waitcnt lgkmcnt(2)
v_mfma_f32_16x16x32_bf16 v[144:147],v[216:219],v[32:35],v[144:147]
ds_read_b128 v[232:235],v252 offset:896
v_cvt_pk_bf16_f32 v176,v248,v249
v_mfma_f32_16x16x32_bf16 v[148:151],v[216:219],v[36:39],v[148:151]
v_exp_f32 v248,v132
v_mfma_f32_16x16x32_bf16 v[152:155],v[216:219],v[40:43],v[152:155]
ds_read_b128 v[236:239],v252 offset:960
v_add_f32 v244,v244,v250
v_exp_f32 v249,v133
v_mfma_f32_16x16x32_bf16 v[144:147],v[220:223],v[48:51],v[144:147]
v_add_f32 v244,v244,v251
v_cvt_pk_bf16_f32 v177,v250,v251
v_mfma_f32_16x16x32_bf16 v[148:151],v[220:223],v[52:55],v[148:151]
v_exp_f32 v250,v134
v_mfma_f32_16x16x32_bf16 v[152:155],v[220:223],v[56:59],v[152:155]
v_exp_f32 v251,v135
v_add_f32 v245,v248,v249
s_waitcnt lgkmcnt(2)
v_mfma_f32_16x16x32_bf16 v[144:147],v[224:227],v[64:67],v[144:147]
ds_read_b64_tr_b16 v[208:209],v253 offset:0
v_cvt_pk_bf16_f32 v180,v248,v249
v_mfma_f32_16x16x32_bf16 v[148:151],v[224:227],v[68:71],v[148:151]
ds_read_b64_tr_b16 v[210:211],v253 offset:512
v_add_f32 v245,v245,v250
v_mfma_f32_16x16x32_bf16 v[152:155],v[224:227],v[72:75],v[152:155]
ds_read_b64_tr_b16 v[212:213],v253 offset:32
v_add_f32 v245,v245,v251
ds_read_b64_tr_b16 v[214:215],v253 offset:544
v_cvt_pk_bf16_f32 v181,v250,v251
v_mfma_f32_16x16x32_bf16 v[144:147],v[228:231],v[80:83],v[144:147]
v_exp_f32 v248,v136
v_mfma_f32_16x16x32_bf16 v[148:151],v[228:231],v[84:87],v[148:151]
v_exp_f32 v249,v137
v_mfma_f32_16x16x32_bf16 v[152:155],v[228:231],v[88:91],v[152:155]
v_exp_f32 v250,v138
v_add_f32 v246,v248,v249
s_waitcnt lgkmcnt(4)
v_mfma_f32_16x16x32_bf16 v[144:147],v[232:235],v[96:99],v[144:147]
ds_read_b64_tr_b16 v[216:217],v253 offset:64
v_cvt_pk_bf16_f32 v184,v248,v249
v_mfma_f32_16x16x32_bf16 v[148:151],v[232:235],v[100:103],v[148:151]
ds_read_b64_tr_b16 v[218:219],v253 offset:576
v_mfma_f32_16x16x32_bf16 v[152:155],v[232:235],v[104:107],v[152:155]
ds_read_b64_tr_b16 v[220:221],v253 offset:96
ds_read_b64_tr_b16 v[222:223],v253 offset:608
v_mfma_f32_16x16x32_bf16 v[144:147],v[236:239],v[112:115],v[144:147]
v_exp_f32 v251,v139
v_mfma_f32_16x16x32_bf16 v[148:151],v[236:239],v[116:119],v[148:151]
v_add_f32 v246,v246,v250
v_add_f32 v246,v246,v251
v_mfma_f32_16x16x32_bf16 v[152:155],v[236:239],v[120:123],v[152:155]
v_cvt_pk_bf16_f32 v185,v250,v251
s_waitcnt lgkmcnt(4)
v_mfma_f32_16x16x32_bf16 a[0:3],v[208:211],v[160:163],a[0:3]
ds_read_b64_tr_b16 v[224:225],v253 offset:128
v_mfma_f32_16x16x32_bf16 a[4:7],v[208:211],v[164:167],a[4:7]
ds_read_b64_tr_b16 v[226:227],v253 offset:640
v_mfma_f32_16x16x32_bf16 a[8:11],v[208:211],v[168:171],a[8:11]
ds_read_b64_tr_b16 v[228:229],v253 offset:160
ds_read_b64_tr_b16 v[230:231],v253 offset:672
v_mfma_f32_16x16x32_bf16 a[16:19],v[212:215],v[160:163],a[16:19]
v_exp_f32 v248,v144
v_mfma_f32_16x16x32_bf16 a[20:23],v[212:215],v[164:167],a[20:23]
v_exp_f32 v249,v145
v_mfma_f32_16x16x32_bf16 a[24:27],v[212:215],v[168:171],a[24:27]
v_exp_f32 v250,v146
v_add_f32 v244,v244,v248
s_waitcnt lgkmcnt(4)
v_mfma_f32_16x16x32_bf16 a[32:35],v[216:219],v[160:163],a[32:35]
ds_read_b64_tr_b16 v[232:233],v253 offset:192
v_add_f32 v244,v244,v249
v_mfma_f32_16x16x32_bf16 a[36:39],v[216:219],v[164:167],a[36:39]
ds_read_b64_tr_b16 v[234:235],v253 offset:704
v_cvt_pk_bf16_f32 v178,v248,v249
v_mfma_f32_16x16x32_bf16 a[40:43],v[216:219],v[168:171],a[40:43]
ds_read_b64_tr_b16 v[236:237],v253 offset:224
ds_read_b64_tr_b16 v[238:239],v253 offset:736
v_mfma_f32_16x16x32_bf16 a[48:51],v[220:223],v[160:163],a[48:51]
v_exp_f32 v251,v147
v_mfma_f32_16x16x32_bf16 a[52:55],v[220:223],v[164:167],a[52:55]
v_exp_f32 v248,v148
v_mfma_f32_16x16x32_bf16 a[56:59],v[220:223],v[168:171],a[56:59]
v_exp_f32 v249,v149
v_add_f32 v244,v244,v250
s_waitcnt lgkmcnt(4)
v_mfma_f32_16x16x32_bf16 a[64:67],v[224:227],v[160:163],a[64:67]
ds_read_b64_tr_b16 v[208:209],v253 offset:256
v_add_f32 v244,v244,v251
v_mfma_f32_16x16x32_bf16 a[68:71],v[224:227],v[164:167],a[68:71]
ds_read_b64_tr_b16 v[210:211],v253 offset:768
v_cvt_pk_bf16_f32 v179,v250,v251
v_mfma_f32_16x16x32_bf16 a[72:75],v[224:227],v[168:171],a[72:75]
ds_read_b64_tr_b16 v[212:213],v253 offset:288
v_add_f32 v245,v245,v248
ds_read_b64_tr_b16 v[214:215],v253 offset:800
v_add_f32 v245,v245,v249
v_mfma_f32_16x16x32_bf16 a[80:83],v[228:231],v[160:163],a[80:83]
v_exp_f32 v250,v150
v_mfma_f32_16x16x32_bf16 a[84:87],v[228:231],v[164:167],a[84:87]
v_exp_f32 v251,v151
v_mfma_f32_16x16x32_bf16 a[88:91],v[228:231],v[168:171],a[88:91]
v_cvt_pk_bf16_f32 v182,v248,v249
v_add_f32 v245,v245,v250
s_waitcnt lgkmcnt(4)
v_mfma_f32_16x16x32_bf16 a[96:99],v[232:235],v[160:163],a[96:99]
ds_read_b64_tr_b16 v[216:217],v253 offset:320
v_add_f32 v245,v245,v251
v_mfma_f32_16x16x32_bf16 a[100:103],v[232:235],v[164:167],a[100:103]
ds_read_b64_tr_b16 v[218:219],v253 offset:832
v_cvt_pk_bf16_f32 v183,v250,v251
v_mfma_f32_16x16x32_bf16 a[104:107],v[232:235],v[168:171],a[104:107]
ds_read_b64_tr_b16 v[220:221],v253 offset:352
ds_read_b64_tr_b16 v[222:223],v253 offset:864
v_mfma_f32_16x16x32_bf16 a[112:115],v[236:239],v[160:163],a[112:115]
v_exp_f32 v248,v152
v_mfma_f32_16x16x32_bf16 a[116:119],v[236:239],v[164:167],a[116:119]
v_exp_f32 v249,v153
v_mfma_f32_16x16x32_bf16 a[120:123],v[236:239],v[168:171],a[120:123]
v_exp_f32 v250,v154
v_add_f32 v246,v246,v248
s_waitcnt lgkmcnt(4)
v_mfma_f32_16x16x32_bf16 a[128:131],v[208:211],v[160:163],a[128:131]
ds_read_b64_tr_b16 v[224:225],v253 offset:384
v_add_f32 v246,v246,v249
v_mfma_f32_16x16x32_bf16 a[132:135],v[208:211],v[164:167],a[132:135]
ds_read_b64_tr_b16 v[226:227],v253 offset:896
v_cvt_pk_bf16_f32 v186,v248,v249
v_mfma_f32_16x16x32_bf16 a[136:139],v[208:211],v[168:171],a[136:139]
ds_read_b64_tr_b16 v[228:229],v253 offset:416
ds_read_b64_tr_b16 v[230:231],v253 offset:928
v_mfma_f32_16x16x32_bf16 a[144:147],v[212:215],v[160:163],a[144:147]
v_exp_f32 v251,v155
v_mfma_f32_16x16x32_bf16 a[148:151],v[212:215],v[164:167],a[148:151]
v_add_f32 v246,v246,v250
v_add_f32 v246,v246,v251
v_mfma_f32_16x16x32_bf16 a[152:155],v[212:215],v[168:171],a[152:155]
v_cvt_pk_bf16_f32 v187,v250,v251
v_max3_f32 v248,v244,v245,v246
v_cmp_lt_f32 vcc,0x49800000,v248
s_waitcnt lgkmcnt(4)
v_mfma_f32_16x16x32_bf16 a[160:163],v[216:219],v[160:163],a[160:163]
ds_read_b64_tr_b16 v[232:233],v253 offset:448
v_mfma_f32_16x16x32_bf16 a[164:167],v[216:219],v[164:167],a[164:167]
ds_read_b64_tr_b16 v[234:235],v253 offset:960
v_mfma_f32_16x16x32_bf16 a[168:171],v[216:219],v[168:171],a[168:171]
ds_read_b64_tr_b16 v[236:237],v253 offset:480
ds_read_b64_tr_b16 v[238:239],v253 offset:992
v_mfma_f32_16x16x32_bf16 a[176:179],v[220:223],v[160:163],a[176:179]
v_mfma_f32_16x16x32_bf16 a[180:183],v[220:223],v[164:167],a[180:183]
v_mfma_f32_16x16x32_bf16 a[184:187],v[220:223],v[168:171],a[184:187]
s_waitcnt lgkmcnt(4)
v_mfma_f32_16x16x32_bf16 a[192:195],v[224:227],v[160:163],a[192:195]
v_mfma_f32_16x16x32_bf16 a[196:199],v[224:227],v[164:167],a[196:199]
s_waitcnt vmcnt(16) lgkmcnt(0)
s_barrier
v_mfma_f32_16x16x32_bf16 a[200:203],v[224:227],v[168:171],a[200:203]
ds_read_b128 v[208:211],v252 offset:16896
v_mfma_f32_16x16x32_bf16 a[208:211],v[228:231],v[160:163],a[208:211]
ds_read_b128 v[212:215],v252 offset:16960
v_mfma_f32_16x16x32_bf16 a[212:215],v[228:231],v[164:167],a[212:215]
v_mfma_f32_16x16x32_bf16 a[216:219],v[228:231],v[168:171],a[216:219]
v_mfma_f32_16x16x32_bf16 a[224:227],v[232:235],v[160:163],a[224:227]
ds_read_b128 v[216:219],v252 offset:17024
v_mfma_f32_16x16x32_bf16 a[228:231],v[232:235],v[164:167],a[228:231]
v_mfma_f32_16x16x32_bf16 a[232:235],v[232:235],v[168:171],a[232:235]
ds_read_b128 v[220:223],v252 offset:17088
v_mfma_f32_16x16x32_bf16 a[240:243],v[236:239],v[160:163],a[240:243]
v_mfma_f32_16x16x32_bf16 a[244:247],v[236:239],v[164:167],a[244:247]
v_mfma_f32_16x16x32_bf16 a[248:251],v[236:239],v[168:171],a[248:251]
s_waitcnt lgkmcnt(2)
s_cbranch_vccnz M_stub2
M_back2:
v_mfma_f32_16x16x32_bf16 v[128:131],v[208:211],v[0:3],v[192:195]
ds_read_b128 v[224:227],v252 offset:17152
s_add_u32 m0,s35,33792
v_mfma_f32_16x16x32_bf16 v[132:135],v[208:211],v[4:7],v[196:199]
buffer_load_dwordx4 v254,s[8:11],s30 offen offset:0 nt lds
s_add_u32 m0,m0,0x00000220
v_mfma_f32_16x16x32_bf16 v[136:139],v[208:211],v[8:11],v[200:203]
ds_read_b128 v[228:231],v252 offset:17216
v_add_f32 v240,v240,v244
v_add_f32 v241,v241,v245
v_add_f32 v242,v242,v246
v_mfma_f32_16x16x32_bf16 v[128:131],v[212:215],v[16:19],v[128:131]
v_mfma_f32_16x16x32_bf16 v[132:135],v[212:215],v[20:23],v[132:135]
buffer_load_dwordx4 v254,s[8:11],s30 offen offset:512 nt lds
s_add_u32 m0,m0,0x00000220
v_mfma_f32_16x16x32_bf16 v[136:139],v[212:215],v[24:27],v[136:139]
s_waitcnt lgkmcnt(2)
v_mfma_f32_16x16x32_bf16 v[128:131],v[216:219],v[32:35],v[128:131]
ds_read_b128 v[232:235],v252 offset:17280
v_mfma_f32_16x16x32_bf16 v[132:135],v[216:219],v[36:39],v[132:135]
buffer_load_dwordx4 v254,s[8:11],s30 offen offset:1024 nt lds
s_add_u32 m0,m0,0x00000220
v_mfma_f32_16x16x32_bf16 v[136:139],v[216:219],v[40:43],v[136:139]
ds_read_b128 v[236:239],v252 offset:17344
v_mfma_f32_16x16x32_bf16 v[128:131],v[220:223],v[48:51],v[128:131]
v_mfma_f32_16x16x32_bf16 v[132:135],v[220:223],v[52:55],v[132:135]
buffer_load_dwordx4 v254,s[8:11],s30 offen offset:1536 nt lds
s_add_u32 s30,s30,16384
v_mfma_f32_16x16x32_bf16 v[136:139],v[220:223],v[56:59],v[136:139]
s_add_u32 m0,s34,67584
s_waitcnt lgkmcnt(2)
v_mfma_f32_16x16x32_bf16 v[128:131],v[224:227],v[64:67],v[128:131]
ds_read_b128 v[208:211],v252 offset:17408
v_mfma_f32_16x16x32_bf16 v[132:135],v[224:227],v[68:71],v[132:135]
buffer_load_dwordx4 v254,s[12:15],s31 offen offset:0 nt lds
s_add_u32 m0,m0,0x00000220
v_mfma_f32_16x16x32_bf16 v[136:139],v[224:227],v[72:75],v[136:139]
ds_read_b128 v[212:215],v252 offset:17472
v_mfma_f32_16x16x32_bf16 v[128:131],v[228:231],v[80:83],v[128:131]
v_mfma_f32_16x16x32_bf16 v[132:135],v[228:231],v[84:87],v[132:135]
buffer_load_dwordx4 v254,s[12:15],s31 offen offset:512 nt lds
s_add_u32 m0,m0,0x00000220
v_mfma_f32_16x16x32_bf16 v[136:139],v[228:231],v[88:91],v[136:139]
s_waitcnt lgkmcnt(2)
v_mfma_f32_16x16x32_bf16 v[128:131],v[232:235],v[96:99],v[128:131]
ds_read_b128 v[216:219],v252 offset:17536
v_mfma_f32_16x16x32_bf16 v[132:135],v[232:235],v[100:103],v[132:135]
buffer_load_dwordx4 v254,s[12:15],s31 offen offset:1024 nt lds
s_add_u32 m0,m0,0x00000220
v_mfma_f32_16x16x32_bf16 v[136:139],v[232:235],v[104:107],v[136:139]
ds_read_b128 v[220:223],v252 offset:17600
v_mfma_f32_16x16x32_bf16 v[128:131],v[236:239],v[112:115],v[128:131]
v_mfma_f32_16x16x32_bf16 v[132:135],v[236:239],v[116:119],v[132:135]
buffer_load_dwordx4 v254,s[12:15],s31 offen offset:1536 nt lds
s_add_u32 s31,s31,16384
v_mfma_f32_16x16x32_bf16 v[136:139],v[236:239],v[120:123],v[136:139]
s_waitcnt lgkmcnt(2)
v_mfma_f32_16x16x32_bf16 v[144:147],v[208:211],v[0:3],v[192:195]
ds_read_b128 v[224:227],v252 offset:17664
v_mfma_f32_16x16x32_bf16 v[148:151],v[208:211],v[4:7],v[196:199]
v_mfma_f32_16x16x32_bf16 v[152:155],v[208:211],v[8:11],v[200:203]
ds_read_b128 v[228:231],v252 offset:17728
v_exp_f32 v248,v128
v_mfma_f32_16x16x32_bf16 v[144:147],v[212:215],v[16:19],v[144:147]
v_exp_f32 v249,v129
v_mfma_f32_16x16x32_bf16 v[148:151],v[212:215],v[20:23],v[148:151]
v_exp_f32 v250,v130
v_mfma_f32_16x16x32_bf16 v[152:155],v[212:215],v[24:27],v[152:155]
v_exp_f32 v251,v131
v_add_f32 v244,v248,v249
s_waitcnt lgkmcnt(2)
v_mfma_f32_16x16x32_bf16 v[144:147],v[216:219],v[32:35],v[144:147]
ds_read_b128 v[232:235],v252 offset:17792
v_cvt_pk_bf16_f32 v160,v248,v249
v_mfma_f32_16x16x32_bf16 v[148:151],v[216:219],v[36:39],v[148:151]
v_exp_f32 v248,v132
v_mfma_f32_16x16x32_bf16 v[152:155],v[216:219],v[40:43],v[152:155]
ds_read_b128 v[236:239],v252 offset:17856
v_add_f32 v244,v244,v250
v_exp_f32 v249,v133
v_mfma_f32_16x16x32_bf16 v[144:147],v[220:223],v[48:51],v[144:147]
v_add_f32 v244,v244,v251
v_cvt_pk_bf16_f32 v161,v250,v251
v_mfma_f32_16x16x32_bf16 v[148:151],v[220:223],v[52:55],v[148:151]
v_exp_f32 v250,v134
v_mfma_f32_16x16x32_bf16 v[152:155],v[220:223],v[56:59],v[152:155]
v_exp_f32 v251,v135
v_add_f32 v245,v248,v249
s_waitcnt lgkmcnt(2)
v_mfma_f32_16x16x32_bf16 v[144:147],v[224:227],v[64:67],v[144:147]
ds_read_b64_tr_b16 v[208:209],v253 offset:16896
v_subrev_u32 v252,s33,v252
v_mfma_f32_16x16x32_bf16 v[148:151],v[224:227],v[68:71],v[148:151]
ds_read_b64_tr_b16 v[210:211],v253 offset:17408
v_cvt_pk_bf16_f32 v164,v248,v249
v_mfma_f32_16x16x32_bf16 v[152:155],v[224:227],v[72:75],v[152:155]
ds_read_b64_tr_b16 v[212:213],v253 offset:16928
v_add_f32 v245,v245,v250
ds_read_b64_tr_b16 v[214:215],v253 offset:17440
v_add_f32 v245,v245,v251
v_mfma_f32_16x16x32_bf16 v[144:147],v[228:231],v[80:83],v[144:147]
v_exp_f32 v248,v136
v_mfma_f32_16x16x32_bf16 v[148:151],v[228:231],v[84:87],v[148:151]
v_exp_f32 v249,v137
v_mfma_f32_16x16x32_bf16 v[152:155],v[228:231],v[88:91],v[152:155]
v_cvt_pk_bf16_f32 v165,v250,v251
v_add_f32 v246,v248,v249
s_waitcnt lgkmcnt(4)
v_mfma_f32_16x16x32_bf16 v[144:147],v[232:235],v[96:99],v[144:147]
ds_read_b64_tr_b16 v[216:217],v253 offset:16960
v_cvt_pk_bf16_f32 v168,v248,v249
v_mfma_f32_16x16x32_bf16 v[148:151],v[232:235],v[100:103],v[148:151]
ds_read_b64_tr_b16 v[218:219],v253 offset:17472
v_mfma_f32_16x16x32_bf16 v[152:155],v[232:235],v[104:107],v[152:155]
ds_read_b64_tr_b16 v[220:221],v253 offset:16992
ds_read_b64_tr_b16 v[222:223],v253 offset:17504
v_mfma_f32_16x16x32_bf16 v[144:147],v[236:239],v[112:115],v[144:147]
s_add_u32 s34,s34,s33
s_sub_u32 s35,s35,s33
v_mfma_f32_16x16x32_bf16 v[148:151],v[236:239],v[116:119],v[148:151]
v_exp_f32 v250,v138
v_mfma_f32_16x16x32_bf16 v[152:155],v[236:239],v[120:123],v[152:155]
v_exp_f32 v251,v139
v_add_f32 v246,v246,v250
s_waitcnt lgkmcnt(4)
v_mfma_f32_16x16x32_bf16 a[0:3],v[208:211],v[176:179],a[0:3]
ds_read_b64_tr_b16 v[224:225],v253 offset:17024
v_add_f32 v246,v246,v251
v_mfma_f32_16x16x32_bf16 a[4:7],v[208:211],v[180:183],a[4:7]
ds_read_b64_tr_b16 v[226:227],v253 offset:17536
v_cvt_pk_bf16_f32 v169,v250,v251
v_mfma_f32_16x16x32_bf16 a[8:11],v[208:211],v[184:187],a[8:11]
ds_read_b64_tr_b16 v[228:229],v253 offset:17056
ds_read_b64_tr_b16 v[230:231],v253 offset:17568
v_mfma_f32_16x16x32_bf16 a[16:19],v[212:215],v[176:179],a[16:19]
v_exp_f32 v248,v144
v_mfma_f32_16x16x32_bf16 a[20:23],v[212:215],v[180:183],a[20:23]
v_exp_f32 v249,v145
v_mfma_f32_16x16x32_bf16 a[24:27],v[212:215],v[184:187],a[24:27]
v_exp_f32 v250,v146
v_add_f32 v244,v244,v248
s_waitcnt lgkmcnt(4)
v_mfma_f32_16x16x32_bf16 a[32:35],v[216:219],v[176:179],a[32:35]
ds_read_b64_tr_b16 v[232:233],v253 offset:17088
v_add_f32 v244,v244,v249
v_mfma_f32_16x16x32_bf16 a[36:39],v[216:219],v[180:183],a[36:39]
ds_read_b64_tr_b16 v[234:235],v253 offset:17600
v_cvt_pk_bf16_f32 v162,v248,v249
v_mfma_f32_16x16x32_bf16 a[40:43],v[216:219],v[184:187],a[40:43]
ds_read_b64_tr_b16 v[236:237],v253 offset:17120
ds_read_b64_tr_b16 v[238:239],v253 offset:17632
v_mfma_f32_16x16x32_bf16 a[48:51],v[220:223],v[176:179],a[48:51]
v_exp_f32 v251,v147
v_mfma_f32_16x16x32_bf16 a[52:55],v[220:223],v[180:183],a[52:55]
v_exp_f32 v248,v148
v_mfma_f32_16x16x32_bf16 a[56:59],v[220:223],v[184:187],a[56:59]
v_exp_f32 v249,v149
v_add_f32 v244,v244,v250
s_waitcnt lgkmcnt(4)
v_mfma_f32_16x16x32_bf16 a[64:67],v[224:227],v[176:179],a[64:67]
ds_read_b64_tr_b16 v[208:209],v253 offset:17152
v_add_f32 v244,v244,v251
v_mfma_f32_16x16x32_bf16 a[68:71],v[224:227],v[180:183],a[68:71]
ds_read_b64_tr_b16 v[210:211],v253 offset:17664
v_cvt_pk_bf16_f32 v163,v250,v251
v_mfma_f32_16x16x32_bf16 a[72:75],v[224:227],v[184:187],a[72:75]
ds_read_b64_tr_b16 v[212:213],v253 offset:17184
v_add_f32 v245,v245,v248
ds_read_b64_tr_b16 v[214:215],v253 offset:17696
v_add_f32 v245,v245,v249
v_mfma_f32_16x16x32_bf16 a[80:83],v[228:231],v[176:179],a[80:83]
v_exp_f32 v250,v150
v_mfma_f32_16x16x32_bf16 a[84:87],v[228:231],v[180:183],a[84:87]
v_exp_f32 v251,v151
v_mfma_f32_16x16x32_bf16 a[88:91],v[228:231],v[184:187],a[88:91]
v_cvt_pk_bf16_f32 v166,v248,v249
v_add_f32 v245,v245,v250
s_waitcnt lgkmcnt(4)
v_mfma_f32_16x16x32_bf16 a[96:99],v[232:235],v[176:179],a[96:99]
ds_read_b64_tr_b16 v[216:217],v253 offset:17216
v_add_f32 v245,v245,v251
v_mfma_f32_16x16x32_bf16 a[100:103],v[232:235],v[180:183],a[100:103]
ds_read_b64_tr_b16 v[218:219],v253 offset:17728
v_cvt_pk_bf16_f32 v167,v250,v251
v_mfma_f32_16x16x32_bf16 a[104:107],v[232:235],v[184:187],a[104:107]
ds_read_b64_tr_b16 v[220:221],v253 offset:17248
ds_read_b64_tr_b16 v[222:223],v253 offset:17760
v_mfma_f32_16x16x32_bf16 a[112:115],v[236:239],v[176:179],a[112:115]
v_exp_f32 v248,v152
v_mfma_f32_16x16x32_bf16 a[116:119],v[236:239],v[180:183],a[116:119]
v_exp_f32 v249,v153
v_mfma_f32_16x16x32_bf16 a[120:123],v[236:239],v[184:187],a[120:123]
v_exp_f32 v250,v154
v_add_f32 v246,v246,v248
s_waitcnt lgkmcnt(4)
v_mfma_f32_16x16x32_bf16 a[128:131],v[208:211],v[176:179],a[128:131]
ds_read_b64_tr_b16 v[224:225],v253 offset:17280
v_add_f32 v246,v246,v249
v_mfma_f32_16x16x32_bf16 a[132:135],v[208:211],v[180:183],a[132:135]
ds_read_b64_tr_b16 v[226:227],v253 offset:17792
v_cvt_pk_bf16_f32 v170,v248,v249
v_mfma_f32_16x16x32_bf16 a[136:139],v[208:211],v[184:187],a[136:139]
ds_read_b64_tr_b16 v[228:229],v253 offset:17312
ds_read_b64_tr_b16 v[230:231],v253 offset:17824
v_mfma_f32_16x16x32_bf16 a[144:147],v[212:215],v[176:179],a[144:147]
v_exp_f32 v251,v155
v_mfma_f32_16x16x32_bf16 a[148:151],v[212:215],v[180:183],a[148:151]
v_add_f32 v246,v246,v250
v_add_f32 v246,v246,v251
v_mfma_f32_16x16x32_bf16 a[152:155],v[212:215],v[184:187],a[152:155]
v_cvt_pk_bf16_f32 v171,v250,v251
v_max3_f32 v248,v244,v245,v246
v_cmp_lt_f32 vcc,0x49800000,v248
s_waitcnt lgkmcnt(4)
v_mfma_f32_16x16x32_bf16 a[160:163],v[216:219],v[176:179],a[160:163]
ds_read_b64_tr_b16 v[232:233],v253 offset:17344
v_mfma_f32_16x16x32_bf16 a[164:167],v[216:219],v[180:183],a[164:167]
ds_read_b64_tr_b16 v[234:235],v253 offset:17856
v_mfma_f32_16x16x32_bf16 a[168:171],v[216:219],v[184:187],a[168:171]
ds_read_b64_tr_b16 v[236:237],v253 offset:17376
ds_read_b64_tr_b16 v[238:239],v253 offset:17888
v_mfma_f32_16x16x32_bf16 a[176:179],v[220:223],v[176:179],a[176:179]
v_add_u32 v253,s33,v253
s_sub_u32 s33,0,s33
v_mfma_f32_16x16x32_bf16 a[180:183],v[220:223],v[180:183],a[180:183]
s_sub_u32 s36,s36,1
v_mfma_f32_16x16x32_bf16 a[184:187],v[220:223],v[184:187],a[184:187]
s_waitcnt lgkmcnt(4)
v_mfma_f32_16x16x32_bf16 a[192:195],v[224:227],v[176:179],a[192:195]
v_mfma_f32_16x16x32_bf16 a[196:199],v[224:227],v[180:183],a[196:199]
s_waitcnt vmcnt(16) lgkmcnt(0)
s_barrier
v_mfma_f32_16x16x32_bf16 a[200:203],v[224:227],v[184:187],a[200:203]
ds_read_b128 v[208:211],v252 offset:0
v_mfma_f32_16x16x32_bf16 a[208:211],v[228:231],v[176:179],a[208:211]
ds_read_b128 v[212:215],v252 offset:64
v_mfma_f32_16x16x32_bf16 a[212:215],v[228:231],v[180:183],a[212:215]
v_mfma_f32_16x16x32_bf16 a[216:219],v[228:231],v[184:187],a[216:219]
v_mfma_f32_16x16x32_bf16 a[224:227],v[232:235],v[176:179],a[224:227]
ds_read_b128 v[216:219],v252 offset:128
v_mfma_f32_16x16x32_bf16 a[228:231],v[232:235],v[180:183],a[228:231]
v_mfma_f32_16x16x32_bf16 a[232:235],v[232:235],v[184:187],a[232:235]
ds_read_b128 v[220:223],v252 offset:192
v_mfma_f32_16x16x32_bf16 a[240:243],v[236:239],v[176:179],a[240:243]
v_mfma_f32_16x16x32_bf16 a[244:247],v[236:239],v[180:183],a[244:247]
v_mfma_f32_16x16x32_bf16 a[248:251],v[236:239],v[184:187],a[248:251]
s_cmp_lg_u32 s36,0
s_waitcnt lgkmcnt(2)
s_cbranch_vccnz M_stub3
M_back3:
s_cbranch_scc1 M_aloop
s_cmp_lg_u32 s37,0
s_cbranch_scc1 M_last
v_mfma_f32_16x16x32_bf16 v[128:131],v[208:211],v[0:3],v[192:195]
ds_read_b128 v[224:227],v252 offset:256
s_add_u32 m0,s35,118272
v_mfma_f32_16x16x32_bf16 v[132:135],v[208:211],v[4:7],v[196:199]
buffer_load_dwordx4 v254,s[12:15],s31 offen offset:0 nt lds
s_add_u32 m0,m0,0x00000220
v_mfma_f32_16x16x32_bf16 v[136:139],v[208:211],v[8:11],v[200:203]
ds_read_b128 v[228:231],v252 offset:320
v_add_f32 v240,v240,v244
buffer_load_dwordx4 v254,s[12:15],s31 offen offset:512 nt lds
s_add_u32 m0,m0,0x00000220
v_mfma_f32_16x16x32_bf16 v[128:131],v[212:215],v[16:19],v[128:131]
v_add_f32 v241,v241,v245
v_add_f32 v242,v242,v246
v_mfma_f32_16x16x32_bf16 v[132:135],v[212:215],v[20:23],v[132:135]
buffer_load_dwordx4 v254,s[12:15],s31 offen offset:1024 nt lds
s_add_u32 m0,m0,0x00000220
v_mfma_f32_16x16x32_bf16 v[136:139],v[212:215],v[24:27],v[136:139]
v_mbcnt_lo_u32_b32 v249,-1,0
v_mbcnt_hi_u32_b32 v249,-1,v249
buffer_load_dwordx4 v254,s[12:15],s31 offen offset:1536 nt lds
s_waitcnt lgkmcnt(2)
v_mfma_f32_16x16x32_bf16 v[128:131],v[216:219],v[32:35],v[128:131]
ds_read_b128 v[232:235],v252 offset:384
s_add_u32 s31,s31,16384
v_mfma_f32_16x16x32_bf16 v[132:135],v[216:219],v[36:39],v[132:135]
v_min_u32 v249,39,v249
v_lshlrev_b32 v249,7,v249
v_mfma_f32_16x16x32_bf16 v[136:139],v[216:219],v[40:43],v[136:139]
ds_read_b128 v[236:239],v252 offset:448
s_lshl_b32 s58,s39,10
s_add_u32 s16,s44,s58
s_addc_u32 s17,s45,0
v_mfma_f32_16x16x32_bf16 v[128:131],v[220:223],v[48:51],v[128:131]
s_sub_u32 s18,3670016,s58
v_mbcnt_lo_u32_b32 v255,-1,0
v_mfma_f32_16x16x32_bf16 v[132:135],v[220:223],v[52:55],v[132:135]
v_mbcnt_hi_u32_b32 v255,-1,v255
v_lshrrev_b32 v250,3,v255
v_mfma_f32_16x16x32_bf16 v[136:139],v[220:223],v[56:59],v[136:139]
v_and_b32 v251,6,v250
v_xor_b32 v255,v255,v251
v_and_b32 v255,7,v255
s_waitcnt lgkmcnt(2)
v_mfma_f32_16x16x32_bf16 v[128:131],v[224:227],v[64:67],v[128:131]
ds_read_b128 v[208:211],v252 offset:512
s_lshl_b32 s60,s28,6
v_mfma_f32_16x16x32_bf16 v[132:135],v[224:227],v[68:71],v[132:135]
v_add_u32 v250,s60,v250
v_mul_u32_u24 v250,896,v250
v_mfma_f32_16x16x32_bf16 v[136:139],v[224:227],v[72:75],v[136:139]
ds_read_b128 v[212:215],v252 offset:576
v_lshl_add_u32 v255,v255,4,v250
v_mfma_f32_16x16x32_bf16 v[128:131],v[228:231],v[80:83],v[128:131]
v_mfma_f32_16x16x32_bf16 v[132:135],v[228:231],v[84:87],v[132:135]
v_mfma_f32_16x16x32_bf16 v[136:139],v[228:231],v[88:91],v[136:139]
s_waitcnt lgkmcnt(2)
v_mfma_f32_16x16x32_bf16 v[128:131],v[232:235],v[96:99],v[128:131]
ds_read_b128 v[216:219],v252 offset:640
v_mfma_f32_16x16x32_bf16 v[132:135],v[232:235],v[100:103],v[132:135]
v_mfma_f32_16x16x32_bf16 v[136:139],v[232:235],v[104:107],v[136:139]
ds_read_b128 v[220:223],v252 offset:704
v_mfma_f32_16x16x32_bf16 v[128:131],v[236:239],v[112:115],v[128:131]
s_add_u32 m0,s29,16896
s_nop 0
v_mfma_f32_16x16x32_bf16 v[132:135],v[236:239],v[116:119],v[132:135]
buffer_load_dword v249,s[24:27],s38 offen offset:0 lds
v_mbcnt_lo_u32_b32 v254,-1,0
v_mfma_f32_16x16x32_bf16 v[136:139],v[236:239],v[120:123],v[136:139]
v_mbcnt_hi_u32_b32 v254,-1,v254
v_lshrrev_b32 v248,5,v254
v_and_b32 v254,31,v254
s_waitcnt lgkmcnt(2)
v_lshlrev_b32 v248,15,v248
v_lshl_add_u32 v254,v254,4,v248
v_mfma_f32_16x16x32_bf16 v[144:147],v[208:211],v[0:3],v[192:195]
ds_read_b128 v[224:227],v252 offset:768
s_add_u32 m0,s29,16896
v_mfma_f32_16x16x32_bf16 v[148:151],v[208:211],v[4:7],v[196:199]
buffer_load_dwordx4 v254,s[16:19],s0 offen lds
s_add_u32 m0,m0,0x00000428
v_mfma_f32_16x16x32_bf16 v[152:155],v[208:211],v[8:11],v[200:203]
ds_read_b128 v[228:231],v252 offset:832
buffer_load_dwordx4 v254,s[16:19],s1 offen lds
s_add_u32 m0,m0,0x00000418
v_mfma_f32_16x16x32_bf16 v[144:147],v[212:215],v[16:19],v[144:147]
buffer_load_dwordx4 v254,s[16:19],s2 offen lds
s_add_u32 m0,m0,0x00000428
v_mfma_f32_16x16x32_bf16 v[148:151],v[212:215],v[20:23],v[148:151]
buffer_load_dwordx4 v254,s[16:19],s3 offen lds
v_mfma_f32_16x16x32_bf16 v[152:155],v[212:215],v[24:27],v[152:155]
s_add_u32 s16,s16,262144
s_addc_u32 s17,s17,0
s_sub_u32 s18,s18,262144
s_waitcnt lgkmcnt(2)
v_mfma_f32_16x16x32_bf16 v[144:147],v[216:219],v[32:35],v[144:147]
ds_read_b128 v[232:235],v252 offset:896
v_mfma_f32_16x16x32_bf16 v[148:151],v[216:219],v[36:39],v[148:151]
v_exp_f32 v248,v128
v_mfma_f32_16x16x32_bf16 v[152:155],v[216:219],v[40:43],v[152:155]
ds_read_b128 v[236:239],v252 offset:960
v_exp_f32 v249,v129
v_mfma_f32_16x16x32_bf16 v[144:147],v[220:223],v[48:51],v[144:147]
v_exp_f32 v250,v130
v_mfma_f32_16x16x32_bf16 v[148:151],v[220:223],v[52:55],v[148:151]
v_exp_f32 v251,v131
v_mfma_f32_16x16x32_bf16 v[152:155],v[220:223],v[56:59],v[152:155]
v_add_f32 v244,v248,v249
v_cvt_pk_bf16_f32 v176,v248,v249
v_add_f32 v244,v244,v250
s_waitcnt lgkmcnt(2)
v_mfma_f32_16x16x32_bf16 v[144:147],v[224:227],v[64:67],v[144:147]
ds_read_b64_tr_b16 v[208:209],v253 offset:0
v_add_f32 v244,v244,v251
v_mfma_f32_16x16x32_bf16 v[148:151],v[224:227],v[68:71],v[148:151]
ds_read_b64_tr_b16 v[210:211],v253 offset:512
v_cvt_pk_bf16_f32 v177,v250,v251
v_mfma_f32_16x16x32_bf16 v[152:155],v[224:227],v[72:75],v[152:155]
ds_read_b64_tr_b16 v[212:213],v253 offset:32
ds_read_b64_tr_b16 v[214:215],v253 offset:544
v_mfma_f32_16x16x32_bf16 v[144:147],v[228:231],v[80:83],v[144:147]
v_exp_f32 v248,v132
v_mfma_f32_16x16x32_bf16 v[148:151],v[228:231],v[84:87],v[148:151]
v_exp_f32 v249,v133
v_mfma_f32_16x16x32_bf16 v[152:155],v[228:231],v[88:91],v[152:155]
v_exp_f32 v250,v134
v_add_f32 v245,v248,v249
s_waitcnt lgkmcnt(4)
v_mfma_f32_16x16x32_bf16 v[144:147],v[232:235],v[96:99],v[144:147]
ds_read_b64_tr_b16 v[216:217],v253 offset:64
v_cvt_pk_bf16_f32 v180,v248,v249
v_mfma_f32_16x16x32_bf16 v[148:151],v[232:235],v[100:103],v[148:151]
ds_read_b64_tr_b16 v[218:219],v253 offset:576
v_mfma_f32_16x16x32_bf16 v[152:155],v[232:235],v[104:107],v[152:155]
ds_read_b64_tr_b16 v[220:221],v253 offset:96
ds_read_b64_tr_b16 v[222:223],v253 offset:608
v_mfma_f32_16x16x32_bf16 v[144:147],v[236:239],v[112:115],v[144:147]
v_exp_f32 v251,v135
v_mfma_f32_16x16x32_bf16 v[148:151],v[236:239],v[116:119],v[148:151]
v_exp_f32 v248,v136
v_mfma_f32_16x16x32_bf16 v[152:155],v[236:239],v[120:123],v[152:155]
v_exp_f32 v249,v137
v_add_f32 v245,v245,v250
s_waitcnt lgkmcnt(4)
v_mfma_f32_16x16x32_bf16 a[0:3],v[208:211],v[160:163],a[0:3]
ds_read_b64_tr_b16 v[224:225],v253 offset:128
v_add_f32 v245,v245,v251
v_mfma_f32_16x16x32_bf16 a[4:7],v[208:211],v[164:167],a[4:7]
ds_read_b64_tr_b16 v[226:227],v253 offset:640
v_cvt_pk_bf16_f32 v181,v250,v251
v_mfma_f32_16x16x32_bf16 a[8:11],v[208:211],v[168:171],a[8:11]
ds_read_b64_tr_b16 v[228:229],v253 offset:160
v_add_f32 v246,v248,v249
ds_read_b64_tr_b16 v[230:231],v253 offset:672
v_cvt_pk_bf16_f32 v184,v248,v249
v_mfma_f32_16x16x32_bf16 a[16:19],v[212:215],v[160:163],a[16:19]
v_exp_f32 v250,v138
v_mfma_f32_16x16x32_bf16 a[20:23],v[212:215],v[164:167],a[20:23]
v_exp_f32 v251,v139
v_mfma_f32_16x16x32_bf16 a[24:27],v[212:215],v[168:171],a[24:27]
v_exp_f32 v248,v144
v_add_f32 v246,v246,v250
s_waitcnt lgkmcnt(4)
v_mfma_f32_16x16x32_bf16 a[32:35],v[216:219],v[160:163],a[32:35]
ds_read_b64_tr_b16 v[232:233],v253 offset:192
v_add_f32 v246,v246,v251
v_mfma_f32_16x16x32_bf16 a[36:39],v[216:219],v[164:167],a[36:39]
ds_read_b64_tr_b16 v[234:235],v253 offset:704
v_cvt_pk_bf16_f32 v185,v250,v251
v_mfma_f32_16x16x32_bf16 a[40:43],v[216:219],v[168:171],a[40:43]
ds_read_b64_tr_b16 v[236:237],v253 offset:224
ds_read_b64_tr_b16 v[238:239],v253 offset:736
v_mfma_f32_16x16x32_bf16 a[48:51],v[220:223],v[160:163],a[48:51]
v_exp_f32 v249,v145
v_mfma_f32_16x16x32_bf16 a[52:55],v[220:223],v[164:167],a[52:55]
v_exp_f32 v250,v146
v_mfma_f32_16x16x32_bf16 a[56:59],v[220:223],v[168:171],a[56:59]
v_exp_f32 v251,v147
v_add_f32 v244,v244,v248
s_waitcnt lgkmcnt(4)
v_mfma_f32_16x16x32_bf16 a[64:67],v[224:227],v[160:163],a[64:67]
ds_read_b64_tr_b16 v[208:209],v253 offset:256
v_add_f32 v244,v244,v249
v_mfma_f32_16x16x32_bf16 a[68:71],v[224:227],v[164:167],a[68:71]
ds_read_b64_tr_b16 v[210:211],v253 offset:768
v_cvt_pk_bf16_f32 v178,v248,v249
v_mfma_f32_16x16x32_bf16 a[72:75],v[224:227],v[168:171],a[72:75]
ds_read_b64_tr_b16 v[212:213],v253 offset:288
v_add_f32 v244,v244,v250
ds_read_b64_tr_b16 v[214:215],v253 offset:800
v_add_f32 v244,v244,v251
v_mfma_f32_16x16x32_bf16 a[80:83],v[228:231],v[160:163],a[80:83]
v_exp_f32 v248,v148
v_mfma_f32_16x16x32_bf16 a[84:87],v[228:231],v[164:167],a[84:87]
v_exp_f32 v249,v149
v_mfma_f32_16x16x32_bf16 a[88:91],v[228:231],v[168:171],a[88:91]
v_cvt_pk_bf16_f32 v179,v250,v251
v_add_f32 v245,v245,v248
s_waitcnt lgkmcnt(4)
v_mfma_f32_16x16x32_bf16 a[96:99],v[232:235],v[160:163],a[96:99]
ds_read_b64_tr_b16 v[216:217],v253 offset:320
v_add_f32 v245,v245,v249
v_mfma_f32_16x16x32_bf16 a[100:103],v[232:235],v[164:167],a[100:103]
ds_read_b64_tr_b16 v[218:219],v253 offset:832
v_cvt_pk_bf16_f32 v182,v248,v249
v_mfma_f32_16x16x32_bf16 a[104:107],v[232:235],v[168:171],a[104:107]
ds_read_b64_tr_b16 v[220:221],v253 offset:352
ds_read_b64_tr_b16 v[222:223],v253 offset:864
v_mfma_f32_16x16x32_bf16 a[112:115],v[236:239],v[160:163],a[112:115]
v_exp_f32 v250,v150
v_mfma_f32_16x16x32_bf16 a[116:119],v[236:239],v[164:167],a[116:119]
v_exp_f32 v251,v151
v_mfma_f32_16x16x32_bf16 a[120:123],v[236:239],v[168:171],a[120:123]
v_exp_f32 v248,v152
v_add_f32 v245,v245,v250
s_waitcnt lgkmcnt(4)
v_mfma_f32_16x16x32_bf16 a[128:131],v[208:211],v[160:163],a[128:131]
ds_read_b64_tr_b16 v[224:225],v253 offset:384
v_add_f32 v245,v245,v251
v_mfma_f32_16x16x32_bf16 a[132:135],v[208:211],v[164:167],a[132:135]
ds_read_b64_tr_b16 v[226:227],v253 offset:896
v_cvt_pk_bf16_f32 v183,v250,v251
v_mfma_f32_16x16x32_bf16 a[136:139],v[208:211],v[168:171],a[136:139]
ds_read_b64_tr_b16 v[228:229],v253 offset:416
ds_read_b64_tr_b16 v[230:231],v253 offset:928
v_mfma_f32_16x16x32_bf16 a[144:147],v[212:215],v[160:163],a[144:147]
v_exp_f32 v249,v153
v_mfma_f32_16x16x32_bf16 a[148:151],v[212:215],v[164:167],a[148:151]
v_exp_f32 v250,v154
v_mfma_f32_16x16x32_bf16 a[152:155],v[212:215],v[168:171],a[152:155]
v_exp_f32 v251,v155
v_add_f32 v246,v246,v248
s_waitcnt lgkmcnt(4)
v_mfma_f32_16x16x32_bf16 a[160:163],v[216:219],v[160:163],a[160:163]
ds_read_b64_tr_b16 v[232:233],v253 offset:448
v_add_f32 v246,v246,v249
v_mfma_f32_16x16x32_bf16 a[164:167],v[216:219],v[164:167],a[164:167]
ds_read_b64_tr_b16 v[234:235],v253 offset:960
v_cvt_pk_bf16_f32 v186,v248,v249
v_mfma_f32_16x16x32_bf16 a[168:171],v[216:219],v[168:171],a[168:171]
ds_read_b64_tr_b16 v[236:237],v253 offset:480
v_add_f32 v246,v246,v250
ds_read_b64_tr_b16 v[238:239],v253 offset:992
v_add_f32 v246,v246,v251
v_mfma_f32_16x16x32_bf16 a[176:179],v[220:223],v[160:163],a[176:179]
v_cvt_pk_bf16_f32 v187,v250,v251
v_max3_f32 v248,v244,v245,v246
v_mfma_f32_16x16x32_bf16 a[180:183],v[220:223],v[164:167],a[180:183]
v_cmp_lt_f32 vcc,0x49800000,v248
v_mfma_f32_16x16x32_bf16 a[184:187],v[220:223],v[168:171],a[184:187]
s_waitcnt lgkmcnt(4)
v_mfma_f32_16x16x32_bf16 a[192:195],v[224:227],v[160:163],a[192:195]
v_mfma_f32_16x16x32_bf16 a[196:199],v[224:227],v[164:167],a[196:199]
s_waitcnt vmcnt(17) lgkmcnt(0)
s_barrier
v_mfma_f32_16x16x32_bf16 a[200:203],v[224:227],v[168:171],a[200:203]
ds_read_b128 v[208:211],v252 offset:16896
v_mfma_f32_16x16x32_bf16 a[208:211],v[228:231],v[160:163],a[208:211]
ds_read_b128 v[212:215],v252 offset:16960
v_mfma_f32_16x16x32_bf16 a[212:215],v[228:231],v[164:167],a[212:215]
v_mfma_f32_16x16x32_bf16 a[216:219],v[228:231],v[168:171],a[216:219]
v_mfma_f32_16x16x32_bf16 a[224:227],v[232:235],v[160:163],a[224:227]
ds_read_b128 v[216:219],v252 offset:17024
v_mfma_f32_16x16x32_bf16 a[228:231],v[232:235],v[164:167],a[228:231]
v_mfma_f32_16x16x32_bf16 a[232:235],v[232:235],v[168:171],a[232:235]
ds_read_b128 v[220:223],v252 offset:17088
v_mfma_f32_16x16x32_bf16 a[240:243],v[236:239],v[160:163],a[240:243]
v_mfma_f32_16x16x32_bf16 a[244:247],v[236:239],v[164:167],a[244:247]
v_mfma_f32_16x16x32_bf16 a[248:251],v[236:239],v[168:171],a[248:251]
s_waitcnt lgkmcnt(2)
s_cbranch_vccnz M_stub4
M_back4:
v_mfma_f32_16x16x32_bf16 v[128:131],v[208:211],v[0:3],v[192:195]
ds_read_b128 v[224:227],v252 offset:17152
s_add_u32 m0,s29,67584
v_mfma_f32_16x16x32_bf16 v[132:135],v[208:211],v[4:7],v[196:199]
buffer_load_dwordx4 v255,s[4:7],s68 offen offset:0 lds
s_add_u32 m0,m0,0x00000400
v_mfma_f32_16x16x32_bf16 v[136:139],v[208:211],v[8:11],v[200:203]
ds_read_b128 v[228:231],v252 offset:17216
v_add_f32 v240,v240,v244
v_add_f32 v241,v241,v245
v_add_f32 v242,v242,v246
v_mfma_f32_16x16x32_bf16 v[128:131],v[212:215],v[16:19],v[128:131]
v_mfma_f32_16x16x32_bf16 v[132:135],v[212:215],v[20:23],v[132:135]
buffer_load_dwordx4 v255,s[4:7],s93 offen offset:0 lds
s_add_u32 m0,m0,0x00000400
v_mfma_f32_16x16x32_bf16 v[136:139],v[212:215],v[24:27],v[136:139]
s_waitcnt lgkmcnt(2)
v_mfma_f32_16x16x32_bf16 v[128:131],v[216:219],v[32:35],v[128:131]
ds_read_b128 v[232:235],v252 offset:17280
v_mfma_f32_16x16x32_bf16 v[132:135],v[216:219],v[36:39],v[132:135]
buffer_load_dwordx4 v255,s[4:7],s94 offen offset:0 lds
s_add_u32 m0,m0,0x00000400
v_mfma_f32_16x16x32_bf16 v[136:139],v[216:219],v[40:43],v[136:139]
ds_read_b128 v[236:239],v252 offset:17344
v_mfma_f32_16x16x32_bf16 v[128:131],v[220:223],v[48:51],v[128:131]
v_mfma_f32_16x16x32_bf16 v[132:135],v[220:223],v[52:55],v[132:135]
buffer_load_dwordx4 v255,s[4:7],s95 offen offset:0 lds
v_mfma_f32_16x16x32_bf16 v[136:139],v[220:223],v[56:59],v[136:139]
s_waitcnt lgkmcnt(2)
v_mfma_f32_16x16x32_bf16 v[128:131],v[224:227],v[64:67],v[128:131]
ds_read_b128 v[208:211],v252 offset:17408
v_mfma_f32_16x16x32_bf16 v[132:135],v[224:227],v[68:71],v[132:135]
v_mfma_f32_16x16x32_bf16 v[136:139],v[224:227],v[72:75],v[136:139]
ds_read_b128 v[212:215],v252 offset:17472
v_mfma_f32_16x16x32_bf16 v[128:131],v[228:231],v[80:83],v[128:131]
v_mfma_f32_16x16x32_bf16 v[132:135],v[228:231],v[84:87],v[132:135]
v_mfma_f32_16x16x32_bf16 v[136:139],v[228:231],v[88:91],v[136:139]
s_waitcnt lgkmcnt(2)
v_mfma_f32_16x16x32_bf16 v[128:131],v[232:235],v[96:99],v[128:131]
ds_read_b128 v[216:219],v252 offset:17536
v_mfma_f32_16x16x32_bf16 v[132:135],v[232:235],v[100:103],v[132:135]
v_mfma_f32_16x16x32_bf16 v[136:139],v[232:235],v[104:107],v[136:139]
ds_read_b128 v[220:223],v252 offset:17600
v_mfma_f32_16x16x32_bf16 v[128:131],v[236:239],v[112:115],v[128:131]
v_mfma_f32_16x16x32_bf16 v[132:135],v[236:239],v[116:119],v[132:135]
v_mfma_f32_16x16x32_bf16 v[136:139],v[236:239],v[120:123],v[136:139]
s_waitcnt lgkmcnt(2)
v_mfma_f32_16x16x32_bf16 v[144:147],v[208:211],v[0:3],v[192:195]
ds_read_b128 v[224:227],v252 offset:17664
v_mfma_f32_16x16x32_bf16 v[148:151],v[208:211],v[4:7],v[196:199]
v_mfma_f32_16x16x32_bf16 v[152:155],v[208:211],v[8:11],v[200:203]
ds_read_b128 v[228:231],v252 offset:17728
v_exp_f32 v248,v128
v_mfma_f32_16x16x32_bf16 v[144:147],v[212:215],v[16:19],v[144:147]
v_exp_f32 v249,v129
v_mfma_f32_16x16x32_bf16 v[148:151],v[212:215],v[20:23],v[148:151]
v_exp_f32 v250,v130
v_mfma_f32_16x16x32_bf16 v[152:155],v[212:215],v[24:27],v[152:155]
v_exp_f32 v251,v131
v_add_f32 v244,v248,v249
s_waitcnt lgkmcnt(2)
v_mfma_f32_16x16x32_bf16 v[144:147],v[216:219],v[32:35],v[144:147]
ds_read_b128 v[232:235],v252 offset:17792
v_cvt_pk_bf16_f32 v160,v248,v249
v_mfma_f32_16x16x32_bf16 v[148:151],v[216:219],v[36:39],v[148:151]
v_exp_f32 v248,v132
v_mfma_f32_16x16x32_bf16 v[152:155],v[216:219],v[40:43],v[152:155]
ds_read_b128 v[236:239],v252 offset:17856
v_add_f32 v244,v244,v250
v_exp_f32 v249,v133
v_mfma_f32_16x16x32_bf16 v[144:147],v[220:223],v[48:51],v[144:147]
v_add_f32 v244,v244,v251
v_cvt_pk_bf16_f32 v161,v250,v251
v_mfma_f32_16x16x32_bf16 v[148:151],v[220:223],v[52:55],v[148:151]
v_exp_f32 v250,v134
v_mfma_f32_16x16x32_bf16 v[152:155],v[220:223],v[56:59],v[152:155]
v_exp_f32 v251,v135
v_add_f32 v245,v248,v249
s_waitcnt lgkmcnt(2)
v_mfma_f32_16x16x32_bf16 v[144:147],v[224:227],v[64:67],v[144:147]
ds_read_b64_tr_b16 v[208:209],v253 offset:16896
v_subrev_u32 v252,s33,v252
v_mfma_f32_16x16x32_bf16 v[148:151],v[224:227],v[68:71],v[148:151]
ds_read_b64_tr_b16 v[210:211],v253 offset:17408
v_cvt_pk_bf16_f32 v164,v248,v249
v_mfma_f32_16x16x32_bf16 v[152:155],v[224:227],v[72:75],v[152:155]
ds_read_b64_tr_b16 v[212:213],v253 offset:16928
v_add_f32 v245,v245,v250
ds_read_b64_tr_b16 v[214:215],v253 offset:17440
v_add_f32 v245,v245,v251
v_mfma_f32_16x16x32_bf16 v[144:147],v[228:231],v[80:83],v[144:147]
v_exp_f32 v248,v136
v_mfma_f32_16x16x32_bf16 v[148:151],v[228:231],v[84:87],v[148:151]
v_exp_f32 v249,v137
v_mfma_f32_16x16x32_bf16 v[152:155],v[228:231],v[88:91],v[152:155]
v_cvt_pk_bf16_f32 v165,v250,v251
v_add_f32 v246,v248,v249
s_waitcnt lgkmcnt(4)
v_mfma_f32_16x16x32_bf16 v[144:147],v[232:235],v[96:99],v[144:147]
ds_read_b64_tr_b16 v[216:217],v253 offset:16960
v_cvt_pk_bf16_f32 v168,v248,v249
v_mfma_f32_16x16x32_bf16 v[148:151],v[232:235],v[100:103],v[148:151]
ds_read_b64_tr_b16 v[218:219],v253 offset:17472
v_mfma_f32_16x16x32_bf16 v[152:155],v[232:235],v[104:107],v[152:155]
ds_read_b64_tr_b16 v[220:221],v253 offset:16992
ds_read_b64_tr_b16 v[222:223],v253 offset:17504
v_mfma_f32_16x16x32_bf16 v[144:147],v[236:239],v[112:115],v[144:147]
s_add_u32 s34,s34,s33
s_sub_u32 s35,s35,s33
v_mfma_f32_16x16x32_bf16 v[148:151],v[236:239],v[116:119],v[148:151]
v_exp_f32 v250,v138
v_mfma_f32_16x16x32_bf16 v[152:155],v[236:239],v[120:123],v[152:155]
v_exp_f32 v251,v139
v_add_f32 v246,v246,v250
s_waitcnt lgkmcnt(4)
v_mfma_f32_16x16x32_bf16 a[0:3],v[208:211],v[176:179],a[0:3]
ds_read_b64_tr_b16 v[224:225],v253 offset:17024
v_add_f32 v246,v246,v251
v_mfma_f32_16x16x32_bf16 a[4:7],v[208:211],v[180:183],a[4:7]
ds_read_b64_tr_b16 v[226:227],v253 offset:17536
v_cvt_pk_bf16_f32 v169,v250,v251
v_mfma_f32_16x16x32_bf16 a[8:11],v[208:211],v[184:187],a[8:11]
ds_read_b64_tr_b16 v[228:229],v253 offset:17056
ds_read_b64_tr_b16 v[230:231],v253 offset:17568
v_mfma_f32_16x16x32_bf16 a[16:19],v[212:215],v[176:179],a[16:19]
v_exp_f32 v248,v144
v_mfma_f32_16x16x32_bf16 a[20:23],v[212:215],v[180:183],a[20:23]
v_exp_f32 v249,v145
v_mfma_f32_16x16x32_bf16 a[24:27],v[212:215],v[184:187],a[24:27]
v_exp_f32 v250,v146
v_add_f32 v244,v244,v248
s_waitcnt lgkmcnt(4)
v_mfma_f32_16x16x32_bf16 a[32:35],v[216:219],v[176:179],a[32:35]
ds_read_b64_tr_b16 v[232:233],v253 offset:17088
v_add_f32 v244,v244,v249
v_mfma_f32_16x16x32_bf16 a[36:39],v[216:219],v[180:183],a[36:39]
ds_read_b64_tr_b16 v[234:235],v253 offset:17600
v_cvt_pk_bf16_f32 v162,v248,v249
v_mfma_f32_16x16x32_bf16 a[40:43],v[216:219],v[184:187],a[40:43]
ds_read_b64_tr_b16 v[236:237],v253 offset:17120
ds_read_b64_tr_b16 v[238:239],v253 offset:17632
v_mfma_f32_16x16x32_bf16 a[48:51],v[220:223],v[176:179],a[48:51]
v_exp_f32 v251,v147
v_mfma_f32_16x16x32_bf16 a[52:55],v[220:223],v[180:183],a[52:55]
v_exp_f32 v248,v148
v_mfma_f32_16x16x32_bf16 a[56:59],v[220:223],v[184:187],a[56:59]
v_exp_f32 v249,v149
v_add_f32 v244,v244,v250
s_waitcnt lgkmcnt(4)
v_mfma_f32_16x16x32_bf16 a[64:67],v[224:227],v[176:179],a[64:67]
ds_read_b64_tr_b16 v[208:209],v253 offset:17152
v_add_f32 v244,v244,v251
v_mfma_f32_16x16x32_bf16 a[68:71],v[224:227],v[180:183],a[68:71]
ds_read_b64_tr_b16 v[210:211],v253 offset:17664
v_cvt_pk_bf16_f32 v163,v250,v251
v_mfma_f32_16x16x32_bf16 a[72:75],v[224:227],v[184:187],a[72:75]
ds_read_b64_tr_b16 v[212:213],v253 offset:17184
v_add_f32 v245,v245,v248
ds_read_b64_tr_b16 v[214:215],v253 offset:17696
v_add_f32 v245,v245,v249
v_mfma_f32_16x16x32_bf16 a[80:83],v[228:231],v[176:179],a[80:83]
v_exp_f32 v250,v150
v_mfma_f32_16x16x32_bf16 a[84:87],v[228:231],v[180:183],a[84:87]
v_exp_f32 v251,v151
v_mfma_f32_16x16x32_bf16 a[88:91],v[228:231],v[184:187],a[88:91]
v_cvt_pk_bf16_f32 v166,v248,v249
v_add_f32 v245,v245,v250
s_waitcnt lgkmcnt(4)
v_mfma_f32_16x16x32_bf16 a[96:99],v[232:235],v[176:179],a[96:99]
ds_read_b64_tr_b16 v[216:217],v253 offset:17216
v_add_f32 v245,v245,v251
v_mfma_f32_16x16x32_bf16 a[100:103],v[232:235],v[180:183],a[100:103]
ds_read_b64_tr_b16 v[218:219],v253 offset:17728
v_cvt_pk_bf16_f32 v167,v250,v251
v_mfma_f32_16x16x32_bf16 a[104:107],v[232:235],v[184:187],a[104:107]
ds_read_b64_tr_b16 v[220:221],v253 offset:17248
ds_read_b64_tr_b16 v[222:223],v253 offset:17760
v_mfma_f32_16x16x32_bf16 a[112:115],v[236:239],v[176:179],a[112:115]
v_exp_f32 v248,v152
v_mfma_f32_16x16x32_bf16 a[116:119],v[236:239],v[180:183],a[116:119]
v_exp_f32 v249,v153
v_mfma_f32_16x16x32_bf16 a[120:123],v[236:239],v[184:187],a[120:123]
v_exp_f32 v250,v154
v_add_f32 v246,v246,v248
s_waitcnt lgkmcnt(4)
v_mfma_f32_16x16x32_bf16 a[128:131],v[208:211],v[176:179],a[128:131]
ds_read_b64_tr_b16 v[224:225],v253 offset:17280
v_add_f32 v246,v246,v249
v_mfma_f32_16x16x32_bf16 a[132:135],v[208:211],v[180:183],a[132:135]
ds_read_b64_tr_b16 v[226:227],v253 offset:17792
v_cvt_pk_bf16_f32 v170,v248,v249
v_mfma_f32_16x16x32_bf16 a[136:139],v[208:211],v[184:187],a[136:139]
ds_read_b64_tr_b16 v[228:229],v253 offset:17312
ds_read_b64_tr_b16 v[230:231],v253 offset:17824
v_mfma_f32_16x16x32_bf16 a[144:147],v[212:215],v[176:179],a[144:147]
v_exp_f32 v251,v155
v_mfma_f32_16x16x32_bf16 a[148:151],v[212:215],v[180:183],a[148:151]
v_add_f32 v246,v246,v250
v_add_f32 v246,v246,v251
v_mfma_f32_16x16x32_bf16 a[152:155],v[212:215],v[184:187],a[152:155]
v_cvt_pk_bf16_f32 v171,v250,v251
v_max3_f32 v248,v244,v245,v246
v_cmp_lt_f32 vcc,0x49800000,v248
s_waitcnt lgkmcnt(4)
v_mfma_f32_16x16x32_bf16 a[160:163],v[216:219],v[176:179],a[160:163]
ds_read_b64_tr_b16 v[232:233],v253 offset:17344
v_mfma_f32_16x16x32_bf16 a[164:167],v[216:219],v[180:183],a[164:167]
ds_read_b64_tr_b16 v[234:235],v253 offset:17856
v_mfma_f32_16x16x32_bf16 a[168:171],v[216:219],v[184:187],a[168:171]
ds_read_b64_tr_b16 v[236:237],v253 offset:17376
ds_read_b64_tr_b16 v[238:239],v253 offset:17888
v_mfma_f32_16x16x32_bf16 a[176:179],v[220:223],v[176:179],a[176:179]
v_add_u32 v253,s33,v253
s_sub_u32 s33,0,s33
v_mfma_f32_16x16x32_bf16 a[180:183],v[220:223],v[180:183],a[180:183]
v_mfma_f32_16x16x32_bf16 a[184:187],v[220:223],v[184:187],a[184:187]
s_waitcnt lgkmcnt(4)
v_mfma_f32_16x16x32_bf16 a[192:195],v[224:227],v[176:179],a[192:195]
v_mfma_f32_16x16x32_bf16 a[196:199],v[224:227],v[180:183],a[196:199]
s_waitcnt vmcnt(13) lgkmcnt(0)
s_barrier
v_mfma_f32_16x16x32_bf16 a[200:203],v[224:227],v[184:187],a[200:203]
ds_read_b128 v[208:211],v252 offset:0
v_mfma_f32_16x16x32_bf16 a[208:211],v[228:231],v[176:179],a[208:211]
ds_read_b128 v[212:215],v252 offset:64
v_mfma_f32_16x16x32_bf16 a[212:215],v[228:231],v[180:183],a[212:215]
v_mfma_f32_16x16x32_bf16 a[216:219],v[228:231],v[184:187],a[216:219]
v_mfma_f32_16x16x32_bf16 a[224:227],v[232:235],v[176:179],a[224:227]
ds_read_b128 v[216:219],v252 offset:128
v_mfma_f32_16x16x32_bf16 a[228:231],v[232:235],v[180:183],a[228:231]
v_mfma_f32_16x16x32_bf16 a[232:235],v[232:235],v[184:187],a[232:235]
ds_read_b128 v[220:223],v252 offset:192
v_mfma_f32_16x16x32_bf16 a[240:243],v[236:239],v[176:179],a[240:243]
v_mfma_f32_16x16x32_bf16 a[244:247],v[236:239],v[180:183],a[244:247]
v_mfma_f32_16x16x32_bf16 a[248:251],v[236:239],v[184:187],a[248:251]
s_waitcnt lgkmcnt(2)
s_cbranch_vccnz M_stub5
M_back5:
v_mfma_f32_16x16x32_bf16 v[128:131],v[208:211],v[0:3],v[192:195]
ds_read_b128 v[224:227],v252 offset:256
s_add_u32 m0,s29,84480
v_mfma_f32_16x16x32_bf16 v[132:135],v[208:211],v[4:7],v[196:199]
buffer_load_dwordx4 v255,s[4:7],s96 offen offset:0 lds
s_add_u32 m0,m0,0x00000400
v_mfma_f32_16x16x32_bf16 v[136:139],v[208:211],v[8:11],v[200:203]
ds_read_b128 v[228:231],v252 offset:320
v_add_f32 v240,v240,v244
v_add_f32 v241,v241,v245
v_add_f32 v242,v242,v246
v_mfma_f32_16x16x32_bf16 v[128:131],v[212:215],v[16:19],v[128:131]
v_mfma_f32_16x16x32_bf16 v[132:135],v[212:215],v[20:23],v[132:135]
buffer_load_dwordx4 v255,s[4:7],s97 offen offset:0 lds
v_mfma_f32_16x16x32_bf16 v[136:139],v[212:215],v[24:27],v[136:139]
s_waitcnt lgkmcnt(2)
v_mfma_f32_16x16x32_bf16 v[128:131],v[216:219],v[32:35],v[128:131]
ds_read_b128 v[232:235],v252 offset:384
v_mfma_f32_16x16x32_bf16 v[132:135],v[216:219],v[36:39],v[132:135]
v_mfma_f32_16x16x32_bf16 v[136:139],v[216:219],v[40:43],v[136:139]
ds_read_b128 v[236:239],v252 offset:448
v_mfma_f32_16x16x32_bf16 v[128:131],v[220:223],v[48:51],v[128:131]
v_mfma_f32_16x16x32_bf16 v[132:135],v[220:223],v[52:55],v[132:135]
v_mfma_f32_16x16x32_bf16 v[136:139],v[220:223],v[56:59],v[136:139]
s_waitcnt lgkmcnt(2)
v_mfma_f32_16x16x32_bf16 v[128:131],v[224:227],v[64:67],v[128:131]
ds_read_b128 v[208:211],v252 offset:512
v_mfma_f32_16x16x32_bf16 v[132:135],v[224:227],v[68:71],v[132:135]
v_mfma_f32_16x16x32_bf16 v[136:139],v[224:227],v[72:75],v[136:139]
ds_read_b128 v[212:215],v252 offset:576
v_mfma_f32_16x16x32_bf16 v[128:131],v[228:231],v[80:83],v[128:131]
v_mfma_f32_16x16x32_bf16 v[132:135],v[228:231],v[84:87],v[132:135]
v_mfma_f32_16x16x32_bf16 v[136:139],v[228:231],v[88:91],v[136:139]
s_waitcnt lgkmcnt(2)
v_mfma_f32_16x16x32_bf16 v[128:131],v[232:235],v[96:99],v[128:131]
ds_read_b128 v[216:219],v252 offset:640
v_mfma_f32_16x16x32_bf16 v[132:135],v[232:235],v[100:103],v[132:135]
v_mfma_f32_16x16x32_bf16 v[136:139],v[232:235],v[104:107],v[136:139]
ds_read_b128 v[220:223],v252 offset:704
v_mfma_f32_16x16x32_bf16 v[128:131],v[236:239],v[112:115],v[128:131]
v_mfma_f32_16x16x32_bf16 v[132:135],v[236:239],v[116:119],v[132:135]
v_mfma_f32_16x16x32_bf16 v[136:139],v[236:239],v[120:123],v[136:139]
s_waitcnt lgkmcnt(2)
v_mfma_f32_16x16x32_bf16 v[144:147],v[208:211],v[0:3],v[192:195]
ds_read_b128 v[224:227],v252 offset:768
v_mfma_f32_16x16x32_bf16 v[148:151],v[208:211],v[4:7],v[196:199]
v_mfma_f32_16x16x32_bf16 v[152:155],v[208:211],v[8:11],v[200:203]
ds_read_b128 v[228:231],v252 offset:832
v_exp_f32 v248,v128
v_mfma_f32_16x16x32_bf16 v[144:147],v[212:215],v[16:19],v[144:147]
v_exp_f32 v249,v129
v_mfma_f32_16x16x32_bf16 v[148:151],v[212:215],v[20:23],v[148:151]
v_exp_f32 v250,v130
v_mfma_f32_16x16x32_bf16 v[152:155],v[212:215],v[24:27],v[152:155]
v_exp_f32 v251,v131
v_add_f32 v244,v248,v249
s_waitcnt lgkmcnt(2)
v_mfma_f32_16x16x32_bf16 v[144:147],v[216:219],v[32:35],v[144:147]
ds_read_b128 v[232:235],v252 offset:896
v_cvt_pk_bf16_f32 v176,v248,v249
v_mfma_f32_16x16x32_bf16 v[148:151],v[216:219],v[36:39],v[148:151]
v_exp_f32 v248,v132
v_mfma_f32_16x16x32_bf16 v[152:155],v[216:219],v[40:43],v[152:155]
ds_read_b128 v[236:239],v252 offset:960
v_add_f32 v244,v244,v250
v_exp_f32 v249,v133
v_mfma_f32_16x16x32_bf16 v[144:147],v[220:223],v[48:51],v[144:147]
v_add_f32 v244,v244,v251
v_cvt_pk_bf16_f32 v177,v250,v251
v_mfma_f32_16x16x32_bf16 v[148:151],v[220:223],v[52:55],v[148:151]
v_exp_f32 v250,v134
v_mfma_f32_16x16x32_bf16 v[152:155],v[220:223],v[56:59],v[152:155]
v_exp_f32 v251,v135
v_add_f32 v245,v248,v249
s_waitcnt lgkmcnt(2)
v_mfma_f32_16x16x32_bf16 v[144:147],v[224:227],v[64:67],v[144:147]
ds_read_b64_tr_b16 v[208:209],v253 offset:0
v_cvt_pk_bf16_f32 v180,v248,v249
v_mfma_f32_16x16x32_bf16 v[148:151],v[224:227],v[68:71],v[148:151]
ds_read_b64_tr_b16 v[210:211],v253 offset:512
v_add_f32 v245,v245,v250
v_mfma_f32_16x16x32_bf16 v[152:155],v[224:227],v[72:75],v[152:155]
ds_read_b64_tr_b16 v[212:213],v253 offset:32
v_add_f32 v245,v245,v251
ds_read_b64_tr_b16 v[214:215],v253 offset:544
v_cvt_pk_bf16_f32 v181,v250,v251
v_mfma_f32_16x16x32_bf16 v[144:147],v[228:231],v[80:83],v[144:147]
v_exp_f32 v248,v136
v_mfma_f32_16x16x32_bf16 v[148:151],v[228:231],v[84:87],v[148:151]
v_exp_f32 v249,v137
v_mfma_f32_16x16x32_bf16 v[152:155],v[228:231],v[88:91],v[152:155]
v_exp_f32 v250,v138
v_add_f32 v246,v248,v249
s_waitcnt lgkmcnt(4)
v_mfma_f32_16x16x32_bf16 v[144:147],v[232:235],v[96:99],v[144:147]
ds_read_b64_tr_b16 v[216:217],v253 offset:64
v_cvt_pk_bf16_f32 v184,v248,v249
v_mfma_f32_16x16x32_bf16 v[148:151],v[232:235],v[100:103],v[148:151]
ds_read_b64_tr_b16 v[218:219],v253 offset:576
v_mfma_f32_16x16x32_bf16 v[152:155],v[232:235],v[104:107],v[152:155]
ds_read_b64_tr_b16 v[220:221],v253 offset:96
ds_read_b64_tr_b16 v[222:223],v253 offset:608
v_mfma_f32_16x16x32_bf16 v[144:147],v[236:239],v[112:115],v[144:147]
v_exp_f32 v251,v139
v_mfma_f32_16x16x32_bf16 v[148:151],v[236:239],v[116:119],v[148:151]
v_add_f32 v246,v246,v250
v_add_f32 v246,v246,v251
v_mfma_f32_16x16x32_bf16 v[152:155],v[236:239],v[120:123],v[152:155]
v_cvt_pk_bf16_f32 v185,v250,v251
s_waitcnt lgkmcnt(4)
v_mfma_f32_16x16x32_bf16 a[0:3],v[208:211],v[160:163],a[0:3]
ds_read_b64_tr_b16 v[224:225],v253 offset:128
v_mfma_f32_16x16x32_bf16 a[4:7],v[208:211],v[164:167],a[4:7]
ds_read_b64_tr_b16 v[226:227],v253 offset:640
v_mfma_f32_16x16x32_bf16 a[8:11],v[208:211],v[168:171],a[8:11]
ds_read_b64_tr_b16 v[228:229],v253 offset:160
ds_read_b64_tr_b16 v[230:231],v253 offset:672
v_mfma_f32_16x16x32_bf16 a[16:19],v[212:215],v[160:163],a[16:19]
v_exp_f32 v248,v144
v_mfma_f32_16x16x32_bf16 a[20:23],v[212:215],v[164:167],a[20:23]
v_exp_f32 v249,v145
v_mfma_f32_16x16x32_bf16 a[24:27],v[212:215],v[168:171],a[24:27]
v_exp_f32 v250,v146
v_add_f32 v244,v244,v248
s_waitcnt lgkmcnt(4)
v_mfma_f32_16x16x32_bf16 a[32:35],v[216:219],v[160:163],a[32:35]
ds_read_b64_tr_b16 v[232:233],v253 offset:192
v_add_f32 v244,v244,v249
v_mfma_f32_16x16x32_bf16 a[36:39],v[216:219],v[164:167],a[36:39]
ds_read_b64_tr_b16 v[234:235],v253 offset:704
v_cvt_pk_bf16_f32 v178,v248,v249
v_mfma_f32_16x16x32_bf16 a[40:43],v[216:219],v[168:171],a[40:43]
ds_read_b64_tr_b16 v[236:237],v253 offset:224
ds_read_b64_tr_b16 v[238:239],v253 offset:736
v_mfma_f32_16x16x32_bf16 a[48:51],v[220:223],v[160:163],a[48:51]
v_exp_f32 v251,v147
v_mfma_f32_16x16x32_bf16 a[52:55],v[220:223],v[164:167],a[52:55]
v_exp_f32 v248,v148
v_mfma_f32_16x16x32_bf16 a[56:59],v[220:223],v[168:171],a[56:59]
v_exp_f32 v249,v149
v_add_f32 v244,v244,v250
s_waitcnt lgkmcnt(4)
v_mfma_f32_16x16x32_bf16 a[64:67],v[224:227],v[160:163],a[64:67]
ds_read_b64_tr_b16 v[208:209],v253 offset:256
v_add_f32 v244,v244,v251
v_mfma_f32_16x16x32_bf16 a[68:71],v[224:227],v[164:167],a[68:71]
ds_read_b64_tr_b16 v[210:211],v253 offset:768
v_cvt_pk_bf16_f32 v179,v250,v251
v_mfma_f32_16x16x32_bf16 a[72:75],v[224:227],v[168:171],a[72:75]
ds_read_b64_tr_b16 v[212:213],v253 offset:288
v_add_f32 v245,v245,v248
ds_read_b64_tr_b16 v[214:215],v253 offset:800
v_add_f32 v245,v245,v249
v_mfma_f32_16x16x32_bf16 a[80:83],v[228:231],v[160:163],a[80:83]
v_exp_f32 v250,v150
v_mfma_f32_16x16x32_bf16 a[84:87],v[228:231],v[164:167],a[84:87]
v_exp_f32 v251,v151
v_mfma_f32_16x16x32_bf16 a[88:91],v[228:231],v[168:171],a[88:91]
v_cvt_pk_bf16_f32 v182,v248,v249
v_add_f32 v245,v245,v250
s_waitcnt lgkmcnt(4)
v_mfma_f32_16x16x32_bf16 a[96:99],v[232:235],v[160:163],a[96:99]
ds_read_b64_tr_b16 v[216:217],v253 offset:320
v_add_f32 v245,v245,v251
v_mfma_f32_16x16x32_bf16 a[100:103],v[232:235],v[164:167],a[100:103]
ds_read_b64_tr_b16 v[218:219],v253 offset:832
v_cvt_pk_bf16_f32 v183,v250,v251
v_mfma_f32_16x16x32_bf16 a[104:107],v[232:235],v[168:171],a[104:107]
ds_read_b64_tr_b16 v[220:221],v253 offset:352
ds_read_b64_tr_b16 v[222:223],v253 offset:864
v_mfma_f32_16x16x32_bf16 a[112:115],v[236:239],v[160:163],a[112:115]
v_exp_f32 v248,v152
v_mfma_f32_16x16x32_bf16 a[116:119],v[236:239],v[164:167],a[116:119]
v_exp_f32 v249,v153
v_mfma_f32_16x16x32_bf16 a[120:123],v[236:239],v[168:171],a[120:123]
v_exp_f32 v250,v154
v_add_f32 v246,v246,v248
s_waitcnt lgkmcnt(4)
v_mfma_f32_16x16x32_bf16 a[128:131],v[208:211],v[160:163],a[128:131]
ds_read_b64_tr_b16 v[224:225],v253 offset:384
v_add_f32 v246,v246,v249
v_mfma_f32_16x16x32_bf16 a[132:135],v[208:211],v[164:167],a[132:135]
ds_read_b64_tr_b16 v[226:227],v253 offset:896
v_cvt_pk_bf16_f32 v186,v248,v249
v_mfma_f32_16x16x32_bf16 a[136:139],v[208:211],v[168:171],a[136:139]
ds_read_b64_tr_b16 v[228:229],v253 offset:416
ds_read_b64_tr_b16 v[230:231],v253 offset:928
v_mfma_f32_16x16x32_bf16 a[144:147],v[212:215],v[160:163],a[144:147]
v_exp_f32 v251,v155
v_mfma_f32_16x16x32_bf16 a[148:151],v[212:215],v[164:167],a[148:151]
v_add_f32 v246,v246,v250
v_add_f32 v246,v246,v251
v_mfma_f32_16x16x32_bf16 a[152:155],v[212:215],v[168:171],a[152:155]
v_cvt_pk_bf16_f32 v187,v250,v251
v_max3_f32 v248,v244,v245,v246
v_cmp_lt_f32 vcc,0x49800000,v248
s_waitcnt lgkmcnt(4)
v_mfma_f32_16x16x32_bf16 a[160:163],v[216:219],v[160:163],a[160:163]
ds_read_b64_tr_b16 v[232:233],v253 offset:448
v_mfma_f32_16x16x32_bf16 a[164:167],v[216:219],v[164:167],a[164:167]
ds_read_b64_tr_b16 v[234:235],v253 offset:960
v_mfma_f32_16x16x32_bf16 a[168:171],v[216:219],v[168:171],a[168:171]
ds_read_b64_tr_b16 v[236:237],v253 offset:480
ds_read_b64_tr_b16 v[238:239],v253 offset:992
v_mfma_f32_16x16x32_bf16 a[176:179],v[220:223],v[160:163],a[176:179]
v_mfma_f32_16x16x32_bf16 a[180:183],v[220:223],v[164:167],a[180:183]
v_mfma_f32_16x16x32_bf16 a[184:187],v[220:223],v[168:171],a[184:187]
s_waitcnt lgkmcnt(4)
v_mfma_f32_16x16x32_bf16 a[192:195],v[224:227],v[160:163],a[192:195]
v_mfma_f32_16x16x32_bf16 a[196:199],v[224:227],v[164:167],a[196:199]
s_waitcnt vmcnt(11) lgkmcnt(0)
s_barrier
v_mfma_f32_16x16x32_bf16 a[200:203],v[224:227],v[168:171],a[200:203]
ds_read_b64_tr_b16 v[208:209],v253 offset:16896
ds_read_b64_tr_b16 v[210:211],v253 offset:17408
v_mfma_f32_16x16x32_bf16 a[208:211],v[228:231],v[160:163],a[208:211]
ds_read_b64_tr_b16 v[212:213],v253 offset:16928
v_mfma_f32_16x16x32_bf16 a[212:215],v[228:231],v[164:167],a[212:215]
ds_read_b64_tr_b16 v[214:215],v253 offset:17440
v_mfma_f32_16x16x32_bf16 a[216:219],v[228:231],v[168:171],a[216:219]
v_mfma_f32_16x16x32_bf16 a[224:227],v[232:235],v[160:163],a[224:227]
ds_read_b64_tr_b16 v[216:217],v253 offset:16960
v_mfma_f32_16x16x32_bf16 a[228:231],v[232:235],v[164:167],a[228:231]
ds_read_b64_tr_b16 v[218:219],v253 offset:17472
v_mfma_f32_16x16x32_bf16 a[232:235],v[232:235],v[168:171],a[232:235]
ds_read_b64_tr_b16 v[220:221],v253 offset:16992
ds_read_b64_tr_b16 v[222:223],v253 offset:17504
v_mfma_f32_16x16x32_bf16 a[240:243],v[236:239],v[160:163],a[240:243]
v_mfma_f32_16x16x32_bf16 a[244:247],v[236:239],v[164:167],a[244:247]
v_mfma_f32_16x16x32_bf16 a[248:251],v[236:239],v[168:171],a[248:251]
s_waitcnt lgkmcnt(4)
s_cbranch_vccnz M_stub6
M_back6:
v_mfma_f32_16x16x32_bf16 a[0:3],v[208:211],v[176:179],a[0:3]
ds_read_b64_tr_b16 v[224:225],v253 offset:17024
s_add_u32 m0,s29,0
v_mfma_f32_16x16x32_bf16 a[4:7],v[208:211],v[180:183],a[4:7]
ds_read_b64_tr_b16 v[226:227],v253 offset:17536
buffer_load_dwordx4 v254,s[16:19],s0 offen lds
v_mfma_f32_16x16x32_bf16 a[8:11],v[208:211],v[184:187],a[8:11]
ds_read_b64_tr_b16 v[228:229],v253 offset:17056
s_add_u32 m0,m0,0x00000428
ds_read_b64_tr_b16 v[230:231],v253 offset:17568
v_add_f32 v240,v240,v244
v_mfma_f32_16x16x32_bf16 a[16:19],v[212:215],v[176:179],a[16:19]
v_add_f32 v241,v241,v245
v_add_f32 v242,v242,v246
v_mfma_f32_16x16x32_bf16 a[20:23],v[212:215],v[180:183],a[20:23]
buffer_load_dwordx4 v254,s[16:19],s1 offen lds
s_add_u32 m0,m0,0x00000418
v_mfma_f32_16x16x32_bf16 a[24:27],v[212:215],v[184:187],a[24:27]
v_mov_b32 v244,v240
v_mov_b32 v245,v241
v_mov_b32 v246,v242
s_waitcnt lgkmcnt(4)
v_mfma_f32_16x16x32_bf16 a[32:35],v[216:219],v[176:179],a[32:35]
ds_read_b64_tr_b16 v[232:233],v253 offset:17088
v_permlane32_swap_b32 v244,v240
v_mfma_f32_16x16x32_bf16 a[36:39],v[216:219],v[180:183],a[36:39]
ds_read_b64_tr_b16 v[234:235],v253 offset:17600
buffer_load_dwordx4 v254,s[16:19],s2 offen lds
v_mfma_f32_16x16x32_bf16 a[40:43],v[216:219],v[184:187],a[40:43]
ds_read_b64_tr_b16 v[236:237],v253 offset:17120
s_add_u32 m0,m0,0x00000428
ds_read_b64_tr_b16 v[238:239],v253 offset:17632
v_permlane32_swap_b32 v245,v241
v_mfma_f32_16x16x32_bf16 a[48:51],v[220:223],v[176:179],a[48:51]
v_permlane32_swap_b32 v246,v242
v_add_f32 v240,v244,v240
v_mfma_f32_16x16x32_bf16 a[52:55],v[220:223],v[180:183],a[52:55]
buffer_load_dwordx4 v254,s[16:19],s3 offen lds
v_add_f32 v241,v245,v241
v_mfma_f32_16x16x32_bf16 a[56:59],v[220:223],v[184:187],a[56:59]
s_add_u32 s16,s16,262144
s_addc_u32 s17,s17,0
s_sub_u32 s18,s18,262144
s_waitcnt lgkmcnt(4)
v_mfma_f32_16x16x32_bf16 a[64:67],v[224:227],v[176:179],a[64:67]
ds_read_b64_tr_b16 v[208:209],v253 offset:17152
v_add_f32 v242,v246,v242
v_mfma_f32_16x16x32_bf16 a[68:71],v[224:227],v[180:183],a[68:71]
ds_read_b64_tr_b16 v[210:211],v253 offset:17664
v_mov_b32 v244,v240
v_mfma_f32_16x16x32_bf16 a[72:75],v[224:227],v[184:187],a[72:75]
ds_read_b64_tr_b16 v[212:213],v253 offset:17184
v_mov_b32 v245,v241
ds_read_b64_tr_b16 v[214:215],v253 offset:17696
v_mov_b32 v246,v242
v_mfma_f32_16x16x32_bf16 a[80:83],v[228:231],v[176:179],a[80:83]
v_permlane16_swap_b32 v244,v240
v_permlane16_swap_b32 v245,v241
v_mfma_f32_16x16x32_bf16 a[84:87],v[228:231],v[180:183],a[84:87]
v_permlane16_swap_b32 v246,v242
v_add_f32 v240,v244,v240
v_mfma_f32_16x16x32_bf16 a[88:91],v[228:231],v[184:187],a[88:91]
v_add_f32 v241,v245,v241
v_add_f32 v242,v246,v242
v_mbcnt_lo_u32_b32 v248,-1,0
s_waitcnt lgkmcnt(4)
v_mfma_f32_16x16x32_bf16 a[96:99],v[232:235],v[176:179],a[96:99]
ds_read_b64_tr_b16 v[216:217],v253 offset:17216
v_mbcnt_hi_u32_b32 v248,-1,v248
v_mfma_f32_16x16x32_bf16 a[100:103],v[232:235],v[180:183],a[100:103]
ds_read_b64_tr_b16 v[218:219],v253 offset:17728
s_and_b32 s59,s39,3
v_mfma_f32_16x16x32_bf16 a[104:107],v[232:235],v[184:187],a[104:107]
ds_read_b64_tr_b16 v[220:221],v253 offset:17248
s_lshl_b32 s59,s59,2
ds_read_b64_tr_b16 v[222:223],v253 offset:17760
s_add_u32 s59,s59,s28
v_mfma_f32_16x16x32_bf16 a[112:115],v[236:239],v[176:179],a[112:115]
v_rcp_f32 v192,v240
s_mul_i32 s59,s59,15
v_add_u32 v195,s59,v248
v_mul_u32_u24 v195,896,v195
v_cmp_gt_u32 vcc,15,v248
s_and_b32 s59,s40,7
s_lshl_b32 s59,s59,2
s_add_u32 s59,s59,s28
v_cndmask_b32 v195,-1,v195,vcc
s_mul_i32 s59,s59,2
v_lshrrev_b32 v197,2,v248
v_add_u32 v197,s59,v197
v_cmp_gt_u32 vcc,8,v248
v_and_b32 v248,3,v248
v_lshlrev_b32 v248,7,v248
v_lshl_add_u32 v197,v197,13,v248
v_cndmask_b32 v197,-1,v197,vcc
v_mfma_f32_16x16x32_bf16 a[116:119],v[236:239],v[180:183],a[116:119]
v_rcp_f32 v194,v241
v_mfma_f32_16x16x32_bf16 a[120:123],v[236:239],v[184:187],a[120:123]
s_add_u32 m0,s29,101376
s_nop 0
buffer_load_dword v197,s[16:19],0 offen offset:0 lds
s_add_u32 m0,s29,101376
s_waitcnt lgkmcnt(4)
v_mfma_f32_16x16x32_bf16 a[128:131],v[208:211],v[176:179],a[128:131]
ds_read_b64_tr_b16 v[224:225],v253 offset:17280
buffer_load_dword v195,s[4:7],0 offen offset:256 lds
v_mfma_f32_16x16x32_bf16 a[132:135],v[208:211],v[180:183],a[132:135]
ds_read_b64_tr_b16 v[226:227],v253 offset:17792
s_mov_b32 s59,524288
v_mfma_f32_16x16x32_bf16 a[136:139],v[208:211],v[184:187],a[136:139]
ds_read_b64_tr_b16 v[228:229],v253 offset:17312
buffer_load_dword v197,s[16:19],s59 offen offset:0 lds
ds_read_b64_tr_b16 v[230:231],v253 offset:17824
s_add_u32 m0,s29,101376
v_mfma_f32_16x16x32_bf16 a[144:147],v[212:215],v[176:179],a[144:147]
buffer_load_dword v195,s[4:7],0 offen offset:384 lds
s_mov_b32 s59,1048576
v_mfma_f32_16x16x32_bf16 a[148:151],v[212:215],v[180:183],a[148:151]
buffer_load_dword v197,s[16:19],s59 offen offset:0 lds
s_add_u32 m0,s29,101376
v_mfma_f32_16x16x32_bf16 a[152:155],v[212:215],v[184:187],a[152:155]
buffer_load_dword v195,s[4:7],0 offen offset:512 lds
s_mov_b32 s59,1572864
buffer_load_dword v197,s[16:19],s59 offen offset:0 lds
s_waitcnt lgkmcnt(4)
v_mfma_f32_16x16x32_bf16 a[160:163],v[216:219],v[176:179],a[160:163]
ds_read_b64_tr_b16 v[232:233],v253 offset:17344
s_add_u32 m0,s29,101376
v_mfma_f32_16x16x32_bf16 a[164:167],v[216:219],v[180:183],a[164:167]
ds_read_b64_tr_b16 v[234:235],v253 offset:17856
buffer_load_dword v195,s[4:7],0 offen offset:640 lds
v_mfma_f32_16x16x32_bf16 a[168:171],v[216:219],v[184:187],a[168:171]
ds_read_b64_tr_b16 v[236:237],v253 offset:17376
s_mov_b32 s59,2097152
ds_read_b64_tr_b16 v[238:239],v253 offset:17888
buffer_load_dword v197,s[16:19],s59 offen offset:0 lds
v_mfma_f32_16x16x32_bf16 a[176:179],v[220:223],v[176:179],a[176:179]
s_add_u32 m0,s29,101376
v_mbcnt_lo_u32_b32 v252,-1,0
v_mfma_f32_16x16x32_bf16 a[180:183],v[220:223],v[180:183],a[180:183]
buffer_load_dword v195,s[4:7],0 offen offset:768 lds
s_mov_b32 s59,2621440
v_mfma_f32_16x16x32_bf16 a[184:187],v[220:223],v[184:187],a[184:187]
buffer_load_dword v197,s[16:19],s59 offen offset:0 lds
s_add_u32 m0,s29,101248
v_mbcnt_hi_u32_b32 v252,-1,v252
v_lshrrev_b32 v248,2,v252
v_mul_u32_u24 v248,1056,v248
v_and_b32 v252,3,v252
v_lshl_add_u32 v252,v252,4,v248
v_mbcnt_lo_u32_b32 v248,-1,0
v_mbcnt_hi_u32_b32 v248,-1,v248
v_bfe_u32 v248,v248,2,1
v_lshl_add_u32 v252,v248,3,v252
buffer_load_dwordx4 v255,s[4:7],s68 offen offset:128 lds
s_waitcnt lgkmcnt(4)
v_mfma_f32_16x16x32_bf16 a[192:195],v[224:227],v[176:179],a[192:195]
s_add_u32 m0,m0,0x00000400
v_mbcnt_lo_u32_b32 v253,-1,0
v_mfma_f32_16x16x32_bf16 a[196:199],v[224:227],v[180:183],a[196:199]
s_waitcnt vmcnt(22) lgkmcnt(0)
s_barrier
v_mfma_f32_16x16x32_bf16 a[200:203],v[224:227],v[184:187],a[200:203]
ds_read_b64_tr_b16 v[208:209],v252 offset:16896
buffer_load_dwordx4 v255,s[4:7],s93 offen offset:128 lds
ds_read_b64_tr_b16 v[210:211],v252 offset:17408
s_add_u32 m0,m0,0x00000400
v_mfma_f32_16x16x32_bf16 a[208:211],v[228:231],v[176:179],a[208:211]
ds_read_b64_tr_b16 v[212:213],v252 offset:16904
buffer_load_dwordx4 v255,s[4:7],s94 offen offset:128 lds
v_mfma_f32_16x16x32_bf16 a[212:215],v[228:231],v[180:183],a[212:215]
ds_read_b64_tr_b16 v[214:215],v252 offset:17416
s_add_u32 m0,m0,0x00000400
v_mfma_f32_16x16x32_bf16 a[216:219],v[228:231],v[184:187],a[216:219]
buffer_load_dwordx4 v255,s[4:7],s95 offen offset:128 lds
s_add_u32 m0,s29,118144
s_nop 0
buffer_load_dwordx4 v255,s[4:7],s96 offen offset:128 lds
s_add_u32 m0,m0,0x00000400
v_mfma_f32_16x16x32_bf16 a[224:227],v[232:235],v[176:179],a[224:227]
ds_read_b64_tr_b16 v[216:217],v252 offset:16960
buffer_load_dwordx4 v255,s[4:7],s97 offen offset:128 lds
v_mfma_f32_16x16x32_bf16 a[228:231],v[232:235],v[180:183],a[228:231]
ds_read_b64_tr_b16 v[218:219],v252 offset:17472
v_mbcnt_hi_u32_b32 v253,-1,v253
v_mfma_f32_16x16x32_bf16 a[232:235],v[232:235],v[184:187],a[232:235]
ds_read_b64_tr_b16 v[220:221],v252 offset:16968
v_and_b32 v249,15,v253
ds_read_b64_tr_b16 v[222:223],v252 offset:17480
v_add_u32 v250,4,v249
v_mfma_f32_16x16x32_bf16 a[240:243],v[236:239],v[176:179],a[240:243]
v_rcp_f32 v196,v242
v_mfma_f32_16x16x32_bf16 a[244:247],v[236:239],v[180:183],a[244:247]
v_lshrrev_b32 v251,3,v250
v_and_b32 v251,1,v251
v_mfma_f32_16x16x32_bf16 a[248:251],v[236:239],v[184:187],a[248:251]
v_lshrrev_b32 v250,4,v250
v_lshlrev_b32 v250,3,v250
v_sub_u32 v250,v249,v250
v_lshl_add_u32 v250,v251,2,v250
v_lshrrev_b32 v253,4,v253
v_and_b32 v249,6,v250
v_xor_b32 v253,v253,v249
v_lshlrev_b32 v253,4,v253
v_lshl_add_u32 v253,v250,7,v253
s_add_u32 s60,s29,67584
v_add_u32 v253,s60,v253
v_mbcnt_lo_u32_b32 v248,-1,0
v_mbcnt_hi_u32_b32 v248,-1,v248
v_lshlrev_b32 v248,4,v248
s_lshl_b32 s67,s40,4
s_lshl_b32 s36,s39,1
s_add_u32 s67,s67,s36
s_lshl_b32 s67,s67,18
s_add_u32 s8,s48,s67
s_addc_u32 s9,s49,0
s_add_u32 s12,s50,s67
s_addc_u32 s13,s51,0
s_lshl_b32 s30,s28,11
s_mov_b32 s31,s30
s_mov_b32 s22,43008
s_mov_b32 s37,1
s_mul_i32 s58,s28,7168
s_add_u32 s58,s58,135168
v_add_u32 v249,s58,v248
s_nop 0
v_accvgpr_read_b32 v128,a64
v_accvgpr_read_b32 v129,a65
v_accvgpr_read_b32 v130,a66
v_accvgpr_read_b32 v131,a67
v_accvgpr_read_b32 v132,a80
v_accvgpr_read_b32 v133,a81
v_accvgpr_read_b32 v134,a82
v_accvgpr_read_b32 v135,a83
v_pk_mul_f32 v[128:129],v[128:129],v[192:193] op_sel_hi:[1,0]
v_pk_mul_f32 v[130:131],v[130:131],v[192:193] op_sel_hi:[1,0]
v_pk_mul_f32 v[132:133],v[132:133],v[192:193] op_sel_hi:[1,0]
v_pk_mul_f32 v[134:135],v[134:135],v[192:193] op_sel_hi:[1,0]
v_cvt_pk_bf16_f32 v160,v128,v129
v_cvt_pk_bf16_f32 v161,v130,v131
v_cvt_pk_bf16_f32 v162,v132,v133
v_cvt_pk_bf16_f32 v163,v134,v135
ds_write_b128 v249,v[160:163] offset:0
v_accvgpr_read_b32 v136,a68
v_accvgpr_read_b32 v137,a69
v_accvgpr_read_b32 v138,a70
v_accvgpr_read_b32 v139,a71
v_accvgpr_read_b32 v140,a84
v_accvgpr_read_b32 v141,a85
v_accvgpr_read_b32 v142,a86
v_accvgpr_read_b32 v143,a87
v_pk_mul_f32 v[136:137],v[136:137],v[194:195] op_sel_hi:[1,0]
v_pk_mul_f32 v[138:139],v[138:139],v[194:195] op_sel_hi:[1,0]
v_pk_mul_f32 v[140:141],v[140:141],v[194:195] op_sel_hi:[1,0]
v_pk_mul_f32 v[142:143],v[142:143],v[194:195] op_sel_hi:[1,0]
v_cvt_pk_bf16_f32 v164,v136,v137
v_cvt_pk_bf16_f32 v165,v138,v139
v_cvt_pk_bf16_f32 v166,v140,v141
v_cvt_pk_bf16_f32 v167,v142,v143
ds_write_b128 v249,v[164:167] offset:1024
v_accvgpr_read_b32 v144,a72
v_accvgpr_read_b32 v145,a73
v_accvgpr_read_b32 v146,a74
v_accvgpr_read_b32 v147,a75
v_accvgpr_read_b32 v148,a88
v_accvgpr_read_b32 v149,a89
v_accvgpr_read_b32 v150,a90
v_accvgpr_read_b32 v151,a91
v_pk_mul_f32 v[144:145],v[144:145],v[196:197] op_sel_hi:[1,0]
v_pk_mul_f32 v[146:147],v[146:147],v[196:197] op_sel_hi:[1,0]
v_pk_mul_f32 v[148:149],v[148:149],v[196:197] op_sel_hi:[1,0]
v_pk_mul_f32 v[150:151],v[150:151],v[196:197] op_sel_hi:[1,0]
v_cvt_pk_bf16_f32 v168,v144,v145
v_cvt_pk_bf16_f32 v169,v146,v147
v_cvt_pk_bf16_f32 v170,v148,v149
v_cvt_pk_bf16_f32 v171,v150,v151
ds_write_b128 v249,v[168:171] offset:2048
v_accvgpr_read_b32 v152,a0
v_accvgpr_read_b32 v153,a1
v_accvgpr_read_b32 v154,a2
v_accvgpr_read_b32 v155,a3
v_accvgpr_read_b32 v156,a16
v_accvgpr_read_b32 v157,a17
v_accvgpr_read_b32 v158,a18
v_accvgpr_read_b32 v159,a19
v_pk_mul_f32 v[152:153],v[152:153],v[192:193] op_sel_hi:[1,0]
v_pk_mul_f32 v[154:155],v[154:155],v[192:193] op_sel_hi:[1,0]
v_pk_mul_f32 v[156:157],v[156:157],v[192:193] op_sel_hi:[1,0]
v_pk_mul_f32 v[158:159],v[158:159],v[192:193] op_sel_hi:[1,0]
v_cvt_pk_bf16_f32 v172,v152,v153
v_cvt_pk_bf16_f32 v173,v154,v155
v_cvt_pk_bf16_f32 v174,v156,v157
v_cvt_pk_bf16_f32 v175,v158,v159
buffer_store_dwordx4 v[172:175],v248,s[20:23],s62 offen offset:0 sc1
v_accvgpr_read_b32 v128,a4
v_accvgpr_read_b32 v129,a5
v_accvgpr_read_b32 v130,a6
v_accvgpr_read_b32 v131,a7
v_accvgpr_read_b32 v132,a20
v_accvgpr_read_b32 v133,a21
v_accvgpr_read_b32 v134,a22
v_accvgpr_read_b32 v135,a23
v_pk_mul_f32 v[128:129],v[128:129],v[194:195] op_sel_hi:[1,0]
v_pk_mul_f32 v[130:131],v[130:131],v[194:195] op_sel_hi:[1,0]
v_pk_mul_f32 v[132:133],v[132:133],v[194:195] op_sel_hi:[1,0]
v_pk_mul_f32 v[134:135],v[134:135],v[194:195] op_sel_hi:[1,0]
v_cvt_pk_bf16_f32 v176,v128,v129
v_cvt_pk_bf16_f32 v177,v130,v131
v_cvt_pk_bf16_f32 v178,v132,v133
v_cvt_pk_bf16_f32 v179,v134,v135
ds_write_b128 v249,v[176:179] offset:3072
v_accvgpr_read_b32 v136,a8
v_accvgpr_read_b32 v137,a9
v_accvgpr_read_b32 v138,a10
v_accvgpr_read_b32 v139,a11
v_accvgpr_read_b32 v140,a24
v_accvgpr_read_b32 v141,a25
v_accvgpr_read_b32 v142,a26
v_accvgpr_read_b32 v143,a27
v_pk_mul_f32 v[136:137],v[136:137],v[196:197] op_sel_hi:[1,0]
v_pk_mul_f32 v[138:139],v[138:139],v[196:197] op_sel_hi:[1,0]
v_pk_mul_f32 v[140:141],v[140:141],v[196:197] op_sel_hi:[1,0]
v_pk_mul_f32 v[142:143],v[142:143],v[196:197] op_sel_hi:[1,0]
v_cvt_pk_bf16_f32 v180,v136,v137
v_cvt_pk_bf16_f32 v181,v138,v139
v_cvt_pk_bf16_f32 v182,v140,v141
v_cvt_pk_bf16_f32 v183,v142,v143
ds_write_b128 v249,v[180:183] offset:4096
s_waitcnt vmcnt(22)
ds_read_b128 a[64:67],v253 offset:0
ds_read_b128 a[68:71],v253 offset:2048
ds_read_b128 a[72:75],v253 offset:16896
v_xor_b32 v253,64,v253
ds_read_b128 a[80:83],v253 offset:0
ds_read_b128 a[84:87],v253 offset:2048
ds_read_b128 a[88:91],v253 offset:16896
v_xor_b32 v253,64,v253
v_accvgpr_read_b32 v144,a32
v_accvgpr_read_b32 v145,a33
v_accvgpr_read_b32 v146,a34
v_accvgpr_read_b32 v147,a35
v_accvgpr_read_b32 v148,a48
v_accvgpr_read_b32 v149,a49
v_accvgpr_read_b32 v150,a50
v_accvgpr_read_b32 v151,a51
v_pk_mul_f32 v[144:145],v[144:145],v[192:193] op_sel_hi:[1,0]
v_pk_mul_f32 v[146:147],v[146:147],v[192:193] op_sel_hi:[1,0]
v_pk_mul_f32 v[148:149],v[148:149],v[192:193] op_sel_hi:[1,0]
v_pk_mul_f32 v[150:151],v[150:151],v[192:193] op_sel_hi:[1,0]
v_cvt_pk_bf16_f32 v184,v144,v145
v_cvt_pk_bf16_f32 v185,v146,v147
v_cvt_pk_bf16_f32 v186,v148,v149
v_cvt_pk_bf16_f32 v187,v150,v151
buffer_store_dwordx4 v[184:187],v248,s[20:23],s62 offen offset:1024 sc1
v_accvgpr_read_b32 v152,a36
v_accvgpr_read_b32 v153,a37
v_accvgpr_read_b32 v154,a38
v_accvgpr_read_b32 v155,a39
v_accvgpr_read_b32 v156,a52
v_accvgpr_read_b32 v157,a53
v_accvgpr_read_b32 v158,a54
v_accvgpr_read_b32 v159,a55
v_pk_mul_f32 v[152:153],v[152:153],v[194:195] op_sel_hi:[1,0]
v_pk_mul_f32 v[154:155],v[154:155],v[194:195] op_sel_hi:[1,0]
v_pk_mul_f32 v[156:157],v[156:157],v[194:195] op_sel_hi:[1,0]
v_pk_mul_f32 v[158:159],v[158:159],v[194:195] op_sel_hi:[1,0]
v_cvt_pk_bf16_f32 v188,v152,v153
v_cvt_pk_bf16_f32 v189,v154,v155
v_cvt_pk_bf16_f32 v190,v156,v157
v_cvt_pk_bf16_f32 v191,v158,v159
ds_write_b128 v249,v[188:191] offset:5120
v_accvgpr_read_b32 v128,a40
v_accvgpr_read_b32 v129,a41
v_accvgpr_read_b32 v130,a42
v_accvgpr_read_b32 v131,a43
v_accvgpr_read_b32 v132,a56
v_accvgpr_read_b32 v133,a57
v_accvgpr_read_b32 v134,a58
v_accvgpr_read_b32 v135,a59
v_pk_mul_f32 v[128:129],v[128:129],v[196:197] op_sel_hi:[1,0]
v_pk_mul_f32 v[130:131],v[130:131],v[196:197] op_sel_hi:[1,0]
v_pk_mul_f32 v[132:133],v[132:133],v[196:197] op_sel_hi:[1,0]
v_pk_mul_f32 v[134:135],v[134:135],v[196:197] op_sel_hi:[1,0]
v_cvt_pk_bf16_f32 v160,v128,v129
v_cvt_pk_bf16_f32 v161,v130,v131
v_cvt_pk_bf16_f32 v162,v132,v133
v_cvt_pk_bf16_f32 v163,v134,v135
ds_write_b128 v249,v[160:163] offset:6144
s_branch M_item
M_last:
v_mfma_f32_16x16x32_bf16 v[128:131],v[208:211],v[0:3],v[192:195]
ds_read_b128 v[224:227],v252 offset:256
s_add_u32 m0,s35,118272
v_mfma_f32_16x16x32_bf16 v[132:135],v[208:211],v[4:7],v[196:199]
buffer_load_dwordx4 v254,s[12:15],s31 offen offset:0 nt lds
s_add_u32 m0,m0,0x00000220
v_mfma_f32_16x16x32_bf16 v[136:139],v[208:211],v[8:11],v[200:203]
ds_read_b128 v[228:231],v252 offset:320
v_add_f32 v240,v240,v244
buffer_load_dwordx4 v254,s[12:15],s31 offen offset:512 nt lds
s_add_u32 m0,m0,0x00000220
v_mfma_f32_16x16x32_bf16 v[128:131],v[212:215],v[16:19],v[128:131]
v_add_f32 v241,v241,v245
v_add_f32 v242,v242,v246
v_mfma_f32_16x16x32_bf16 v[132:135],v[212:215],v[20:23],v[132:135]
buffer_load_dwordx4 v254,s[12:15],s31 offen offset:1024 nt lds
s_add_u32 m0,m0,0x00000220
v_mfma_f32_16x16x32_bf16 v[136:139],v[212:215],v[24:27],v[136:139]
s_mul_i32 s58,s39,458752
buffer_load_dwordx4 v254,s[12:15],s31 offen offset:1536 nt lds
s_waitcnt lgkmcnt(2)
v_mfma_f32_16x16x32_bf16 v[128:131],v[216:219],v[32:35],v[128:131]
ds_read_b128 v[232:235],v252 offset:384
s_add_u32 s31,s31,16384
v_mfma_f32_16x16x32_bf16 v[132:135],v[216:219],v[36:39],v[132:135]
v_mbcnt_lo_u32_b32 v254,-1,0
v_mbcnt_hi_u32_b32 v254,-1,v254
v_mfma_f32_16x16x32_bf16 v[136:139],v[216:219],v[40:43],v[136:139]
ds_read_b128 v[236:239],v252 offset:448
v_lshrrev_b32 v248,3,v254
v_mul_u32_u24 v248,3584,v248
s_lshl_b32 s60,s39,2
v_mfma_f32_16x16x32_bf16 v[128:131],v[220:223],v[48:51],v[128:131]
v_xor_b32 v254,s60,v254
v_and_b32 v254,7,v254
v_mfma_f32_16x16x32_bf16 v[132:135],v[220:223],v[52:55],v[132:135]
v_lshl_add_u32 v254,v254,4,v248
v_mfma_f32_16x16x32_bf16 v[136:139],v[220:223],v[56:59],v[136:139]
s_add_u32 s16,s46,s58
s_addc_u32 s17,s47,0
s_mov_b32 s18,458752
s_waitcnt lgkmcnt(2)
v_mfma_f32_16x16x32_bf16 v[128:131],v[224:227],v[64:67],v[128:131]
ds_read_b128 v[208:211],v252 offset:512
s_mul_i32 s32,s28,28672
v_mfma_f32_16x16x32_bf16 v[132:135],v[224:227],v[68:71],v[132:135]
v_mbcnt_lo_u32_b32 v255,-1,0
v_mbcnt_hi_u32_b32 v255,-1,v255
v_mfma_f32_16x16x32_bf16 v[136:139],v[224:227],v[72:75],v[136:139]
ds_read_b128 v[212:215],v252 offset:576
v_cmp_gt_u32 vcc,16,v255
s_and_b32 s59,s40,7
s_lshl_b32 s59,s59,2
v_mfma_f32_16x16x32_bf16 v[128:131],v[228:231],v[80:83],v[128:131]
s_add_u32 s59,s59,s28
s_mul_i32 s59,s59,16
v_mfma_f32_16x16x32_bf16 v[132:135],v[228:231],v[84:87],v[132:135]
v_add_u32 v255,s59,v255
v_mul_u32_u24 v255,896,v255
v_mfma_f32_16x16x32_bf16 v[136:139],v[228:231],v[88:91],v[136:139]
v_cndmask_b32 v255,-1,v255,vcc
s_waitcnt lgkmcnt(2)
v_mfma_f32_16x16x32_bf16 v[128:131],v[232:235],v[96:99],v[128:131]
ds_read_b128 v[216:219],v252 offset:640
v_mfma_f32_16x16x32_bf16 v[132:135],v[232:235],v[100:103],v[132:135]
v_mfma_f32_16x16x32_bf16 v[136:139],v[232:235],v[104:107],v[136:139]
ds_read_b128 v[220:223],v252 offset:704
v_mfma_f32_16x16x32_bf16 v[128:131],v[236:239],v[112:115],v[128:131]
v_mfma_f32_16x16x32_bf16 v[132:135],v[236:239],v[116:119],v[132:135]
v_mfma_f32_16x16x32_bf16 v[136:139],v[236:239],v[120:123],v[136:139]
s_waitcnt lgkmcnt(2)
v_mfma_f32_16x16x32_bf16 v[144:147],v[208:211],v[0:3],v[192:195]
ds_read_b128 v[224:227],v252 offset:768
v_mfma_f32_16x16x32_bf16 v[148:151],v[208:211],v[4:7],v[196:199]
v_mfma_f32_16x16x32_bf16 v[152:155],v[208:211],v[8:11],v[200:203]
ds_read_b128 v[228:231],v252 offset:832
s_add_u32 m0,s29,16896
s_nop 0
buffer_load_dword v255,s[16:19],0 offen offset:256 lds
v_mfma_f32_16x16x32_bf16 v[144:147],v[212:215],v[16:19],v[144:147]
v_exp_f32 v248,v128
v_mfma_f32_16x16x32_bf16 v[148:151],v[212:215],v[20:23],v[148:151]
v_exp_f32 v249,v129
v_mfma_f32_16x16x32_bf16 v[152:155],v[212:215],v[24:27],v[152:155]
v_exp_f32 v250,v130
v_add_f32 v244,v248,v249
s_waitcnt lgkmcnt(2)
v_mfma_f32_16x16x32_bf16 v[144:147],v[216:219],v[32:35],v[144:147]
ds_read_b128 v[232:235],v252 offset:896
buffer_load_dword v255,s[16:19],0 offen offset:384 lds
v_mfma_f32_16x16x32_bf16 v[148:151],v[216:219],v[36:39],v[148:151]
v_exp_f32 v251,v131
v_mfma_f32_16x16x32_bf16 v[152:155],v[216:219],v[40:43],v[152:155]
ds_read_b128 v[236:239],v252 offset:960
v_cvt_pk_bf16_f32 v176,v248,v249
v_exp_f32 v248,v132
v_mfma_f32_16x16x32_bf16 v[144:147],v[220:223],v[48:51],v[144:147]
v_exp_f32 v249,v133
v_mfma_f32_16x16x32_bf16 v[148:151],v[220:223],v[52:55],v[148:151]
v_add_f32 v244,v244,v250
v_add_f32 v244,v244,v251
v_mfma_f32_16x16x32_bf16 v[152:155],v[220:223],v[56:59],v[152:155]
v_cvt_pk_bf16_f32 v177,v250,v251
v_add_f32 v245,v248,v249
s_waitcnt lgkmcnt(2)
v_mfma_f32_16x16x32_bf16 v[144:147],v[224:227],v[64:67],v[144:147]
ds_read_b64_tr_b16 v[208:209],v253 offset:0
v_cvt_pk_bf16_f32 v180,v248,v249
v_mfma_f32_16x16x32_bf16 v[148:151],v[224:227],v[68:71],v[148:151]
ds_read_b64_tr_b16 v[210:211],v253 offset:512
v_mfma_f32_16x16x32_bf16 v[152:155],v[224:227],v[72:75],v[152:155]
ds_read_b64_tr_b16 v[212:213],v253 offset:32
s_add_u32 m0,s29,16896
ds_read_b64_tr_b16 v[214:215],v253 offset:544
buffer_load_dwordx4 v254,s[16:19],s32 offen offset:0 lds
v_mfma_f32_16x16x32_bf16 v[144:147],v[228:231],v[80:83],v[144:147]
s_add_u32 m0,m0,0x000000a0
v_mfma_f32_16x16x32_bf16 v[148:151],v[228:231],v[84:87],v[148:151]
v_exp_f32 v250,v134
v_mfma_f32_16x16x32_bf16 v[152:155],v[228:231],v[88:91],v[152:155]
v_exp_f32 v251,v135
buffer_load_dwordx4 v254,s[16:19],s32 offen offset:896 lds
s_waitcnt lgkmcnt(4)
v_mfma_f32_16x16x32_bf16 v[144:147],v[232:235],v[96:99],v[144:147]
ds_read_b64_tr_b16 v[216:217],v253 offset:64
s_add_u32 m0,m0,0x000000a0
v_mfma_f32_16x16x32_bf16 v[148:151],v[232:235],v[100:103],v[148:151]
ds_read_b64_tr_b16 v[218:219],v253 offset:576
v_add_f32 v245,v245,v250
v_mfma_f32_16x16x32_bf16 v[152:155],v[232:235],v[104:107],v[152:155]
ds_read_b64_tr_b16 v[220:221],v253 offset:96
v_add_f32 v245,v245,v251
ds_read_b64_tr_b16 v[222:223],v253 offset:608
buffer_load_dwordx4 v254,s[16:19],s32 offen offset:1792 lds
v_mfma_f32_16x16x32_bf16 v[144:147],v[236:239],v[112:115],v[144:147]
s_add_u32 m0,m0,0x000000a0
v_cvt_pk_bf16_f32 v181,v250,v251
v_mfma_f32_16x16x32_bf16 v[148:151],v[236:239],v[116:119],v[148:151]
v_exp_f32 v248,v136
v_mfma_f32_16x16x32_bf16 v[152:155],v[236:239],v[120:123],v[152:155]
v_exp_f32 v249,v137
buffer_load_dwordx4 v254,s[16:19],s32 offen offset:2688 lds
s_waitcnt lgkmcnt(4)
v_mfma_f32_16x16x32_bf16 a[0:3],v[208:211],v[160:163],a[0:3]
ds_read_b64_tr_b16 v[224:225],v253 offset:128
s_add_u32 s32,s32,0x0001c000
v_mfma_f32_16x16x32_bf16 a[4:7],v[208:211],v[164:167],a[4:7]
ds_read_b64_tr_b16 v[226:227],v253 offset:640
v_add_f32 v246,v248,v249
v_mfma_f32_16x16x32_bf16 a[8:11],v[208:211],v[168:171],a[8:11]
ds_read_b64_tr_b16 v[228:229],v253 offset:160
v_cvt_pk_bf16_f32 v184,v248,v249
ds_read_b64_tr_b16 v[230:231],v253 offset:672
v_mfma_f32_16x16x32_bf16 a[16:19],v[212:215],v[160:163],a[16:19]
v_exp_f32 v250,v138
v_mfma_f32_16x16x32_bf16 a[20:23],v[212:215],v[164:167],a[20:23]
v_exp_f32 v251,v139
v_mfma_f32_16x16x32_bf16 a[24:27],v[212:215],v[168:171],a[24:27]
v_exp_f32 v248,v144
v_add_f32 v246,v246,v250
s_waitcnt lgkmcnt(4)
v_mfma_f32_16x16x32_bf16 a[32:35],v[216:219],v[160:163],a[32:35]
ds_read_b64_tr_b16 v[232:233],v253 offset:192
v_add_f32 v246,v246,v251
v_mfma_f32_16x16x32_bf16 a[36:39],v[216:219],v[164:167],a[36:39]
ds_read_b64_tr_b16 v[234:235],v253 offset:704
v_cvt_pk_bf16_f32 v185,v250,v251
v_mfma_f32_16x16x32_bf16 a[40:43],v[216:219],v[168:171],a[40:43]
ds_read_b64_tr_b16 v[236:237],v253 offset:224
ds_read_b64_tr_b16 v[238:239],v253 offset:736
v_mfma_f32_16x16x32_bf16 a[48:51],v[220:223],v[160:163],a[48:51]
v_exp_f32 v249,v145
v_mfma_f32_16x16x32_bf16 a[52:55],v[220:223],v[164:167],a[52:55]
v_exp_f32 v250,v146
v_mfma_f32_16x16x32_bf16 a[56:59],v[220:223],v[168:171],a[56:59]
v_exp_f32 v251,v147
v_add_f32 v244,v244,v248
s_waitcnt lgkmcnt(4)
v_mfma_f32_16x16x32_bf16 a[64:67],v[224:227],v[160:163],a[64:67]
ds_read_b64_tr_b16 v[208:209],v253 offset:256
v_add_f32 v244,v244,v249
v_mfma_f32_16x16x32_bf16 a[68:71],v[224:227],v[164:167],a[68:71]
ds_read_b64_tr_b16 v[210:211],v253 offset:768
v_cvt_pk_bf16_f32 v178,v248,v249
v_mfma_f32_16x16x32_bf16 a[72:75],v[224:227],v[168:171],a[72:75]
ds_read_b64_tr_b16 v[212:213],v253 offset:288
v_add_f32 v244,v244,v250
ds_read_b64_tr_b16 v[214:215],v253 offset:800
v_add_f32 v244,v244,v251
v_mfma_f32_16x16x32_bf16 a[80:83],v[228:231],v[160:163],a[80:83]
v_exp_f32 v248,v148
v_mfma_f32_16x16x32_bf16 a[84:87],v[228:231],v[164:167],a[84:87]
v_exp_f32 v249,v149
v_mfma_f32_16x16x32_bf16 a[88:91],v[228:231],v[168:171],a[88:91]
v_cvt_pk_bf16_f32 v179,v250,v251
v_add_f32 v245,v245,v248
s_waitcnt lgkmcnt(4)
v_mfma_f32_16x16x32_bf16 a[96:99],v[232:235],v[160:163],a[96:99]
ds_read_b64_tr_b16 v[216:217],v253 offset:320
v_add_f32 v245,v245,v249
v_mfma_f32_16x16x32_bf16 a[100:103],v[232:235],v[164:167],a[100:103]
ds_read_b64_tr_b16 v[218:219],v253 offset:832
v_cvt_pk_bf16_f32 v182,v248,v249
v_mfma_f32_16x16x32_bf16 a[104:107],v[232:235],v[168:171],a[104:107]
ds_read_b64_tr_b16 v[220:221],v253 offset:352
ds_read_b64_tr_b16 v[222:223],v253 offset:864
v_mfma_f32_16x16x32_bf16 a[112:115],v[236:239],v[160:163],a[112:115]
v_exp_f32 v250,v150
v_mfma_f32_16x16x32_bf16 a[116:119],v[236:239],v[164:167],a[116:119]
v_exp_f32 v251,v151
v_mfma_f32_16x16x32_bf16 a[120:123],v[236:239],v[168:171],a[120:123]
v_exp_f32 v248,v152
v_add_f32 v245,v245,v250
s_waitcnt lgkmcnt(4)
v_mfma_f32_16x16x32_bf16 a[128:131],v[208:211],v[160:163],a[128:131]
ds_read_b64_tr_b16 v[224:225],v253 offset:384
v_add_f32 v245,v245,v251
v_mfma_f32_16x16x32_bf16 a[132:135],v[208:211],v[164:167],a[132:135]
ds_read_b64_tr_b16 v[226:227],v253 offset:896
v_cvt_pk_bf16_f32 v183,v250,v251
v_mfma_f32_16x16x32_bf16 a[136:139],v[208:211],v[168:171],a[136:139]
ds_read_b64_tr_b16 v[228:229],v253 offset:416
ds_read_b64_tr_b16 v[230:231],v253 offset:928
v_mfma_f32_16x16x32_bf16 a[144:147],v[212:215],v[160:163],a[144:147]
v_exp_f32 v249,v153
v_mfma_f32_16x16x32_bf16 a[148:151],v[212:215],v[164:167],a[148:151]
v_exp_f32 v250,v154
v_mfma_f32_16x16x32_bf16 a[152:155],v[212:215],v[168:171],a[152:155]
v_exp_f32 v251,v155
v_add_f32 v246,v246,v248
s_waitcnt lgkmcnt(4)
v_mfma_f32_16x16x32_bf16 a[160:163],v[216:219],v[160:163],a[160:163]
ds_read_b64_tr_b16 v[232:233],v253 offset:448
v_add_f32 v246,v246,v249
v_mfma_f32_16x16x32_bf16 a[164:167],v[216:219],v[164:167],a[164:167]
ds_read_b64_tr_b16 v[234:235],v253 offset:960
v_cvt_pk_bf16_f32 v186,v248,v249
v_mfma_f32_16x16x32_bf16 a[168:171],v[216:219],v[168:171],a[168:171]
ds_read_b64_tr_b16 v[236:237],v253 offset:480
v_add_f32 v246,v246,v250
ds_read_b64_tr_b16 v[238:239],v253 offset:992
v_add_f32 v246,v246,v251
v_mfma_f32_16x16x32_bf16 a[176:179],v[220:223],v[160:163],a[176:179]
v_cvt_pk_bf16_f32 v187,v250,v251
v_max3_f32 v248,v244,v245,v246
v_mfma_f32_16x16x32_bf16 a[180:183],v[220:223],v[164:167],a[180:183]
v_cmp_lt_f32 vcc,0x49800000,v248
v_mfma_f32_16x16x32_bf16 a[184:187],v[220:223],v[168:171],a[184:187]
s_waitcnt lgkmcnt(4)
v_mfma_f32_16x16x32_bf16 a[192:195],v[224:227],v[160:163],a[192:195]
v_mfma_f32_16x16x32_bf16 a[196:199],v[224:227],v[164:167],a[196:199]
s_waitcnt vmcnt(18) lgkmcnt(0)
s_barrier
v_mfma_f32_16x16x32_bf16 a[200:203],v[224:227],v[168:171],a[200:203]
ds_read_b128 v[208:211],v252 offset:16896
v_mfma_f32_16x16x32_bf16 a[208:211],v[228:231],v[160:163],a[208:211]
ds_read_b128 v[212:215],v252 offset:16960
v_mfma_f32_16x16x32_bf16 a[212:215],v[228:231],v[164:167],a[212:215]
v_mfma_f32_16x16x32_bf16 a[216:219],v[228:231],v[168:171],a[216:219]
v_mfma_f32_16x16x32_bf16 a[224:227],v[232:235],v[160:163],a[224:227]
ds_read_b128 v[216:219],v252 offset:17024
v_mfma_f32_16x16x32_bf16 a[228:231],v[232:235],v[164:167],a[228:231]
v_mfma_f32_16x16x32_bf16 a[232:235],v[232:235],v[168:171],a[232:235]
ds_read_b128 v[220:223],v252 offset:17088
v_mfma_f32_16x16x32_bf16 a[240:243],v[236:239],v[160:163],a[240:243]
v_mfma_f32_16x16x32_bf16 a[244:247],v[236:239],v[164:167],a[244:247]
v_mfma_f32_16x16x32_bf16 a[248:251],v[236:239],v[168:171],a[248:251]
s_waitcnt lgkmcnt(2)
s_cbranch_vccnz M_stub7
M_back7:
v_mfma_f32_16x16x32_bf16 v[128:131],v[208:211],v[0:3],v[192:195]
ds_read_b128 v[224:227],v252 offset:17152
s_add_u32 m0,s29,33792
v_mfma_f32_16x16x32_bf16 v[132:135],v[208:211],v[4:7],v[196:199]
buffer_load_dword v255,s[16:19],0 offen offset:512 lds
v_add_f32 v240,v240,v244
v_mfma_f32_16x16x32_bf16 v[136:139],v[208:211],v[8:11],v[200:203]
ds_read_b128 v[228:231],v252 offset:17216
v_add_f32 v241,v241,v245
v_add_f32 v242,v242,v246
v_mfma_f32_16x16x32_bf16 v[128:131],v[212:215],v[16:19],v[128:131]
v_mfma_f32_16x16x32_bf16 v[132:135],v[212:215],v[20:23],v[132:135]
v_mfma_f32_16x16x32_bf16 v[136:139],v[212:215],v[24:27],v[136:139]
buffer_load_dword v255,s[16:19],0 offen offset:640 lds
s_waitcnt lgkmcnt(2)
v_mfma_f32_16x16x32_bf16 v[128:131],v[216:219],v[32:35],v[128:131]
ds_read_b128 v[232:235],v252 offset:17280
v_mfma_f32_16x16x32_bf16 v[132:135],v[216:219],v[36:39],v[132:135]
v_mfma_f32_16x16x32_bf16 v[136:139],v[216:219],v[40:43],v[136:139]
ds_read_b128 v[236:239],v252 offset:17344
buffer_load_dword v255,s[16:19],0 offen offset:768 lds
v_mfma_f32_16x16x32_bf16 v[128:131],v[220:223],v[48:51],v[128:131]
v_mfma_f32_16x16x32_bf16 v[132:135],v[220:223],v[52:55],v[132:135]
v_mfma_f32_16x16x32_bf16 v[136:139],v[220:223],v[56:59],v[136:139]
s_waitcnt lgkmcnt(2)
v_mfma_f32_16x16x32_bf16 v[128:131],v[224:227],v[64:67],v[128:131]
ds_read_b128 v[208:211],v252 offset:17408
s_add_u32 m0,s29,33792
v_mfma_f32_16x16x32_bf16 v[132:135],v[224:227],v[68:71],v[132:135]
buffer_load_dwordx4 v254,s[16:19],s32 offen offset:0 lds
s_add_u32 m0,m0,0x000000a0
v_mfma_f32_16x16x32_bf16 v[136:139],v[224:227],v[72:75],v[136:139]
ds_read_b128 v[212:215],v252 offset:17472
v_mfma_f32_16x16x32_bf16 v[128:131],v[228:231],v[80:83],v[128:131]
v_mfma_f32_16x16x32_bf16 v[132:135],v[228:231],v[84:87],v[132:135]
buffer_load_dwordx4 v254,s[16:19],s32 offen offset:896 lds
s_add_u32 m0,m0,0x000000a0
v_mfma_f32_16x16x32_bf16 v[136:139],v[228:231],v[88:91],v[136:139]
s_waitcnt lgkmcnt(2)
v_mfma_f32_16x16x32_bf16 v[128:131],v[232:235],v[96:99],v[128:131]
ds_read_b128 v[216:219],v252 offset:17536
v_mfma_f32_16x16x32_bf16 v[132:135],v[232:235],v[100:103],v[132:135]
buffer_load_dwordx4 v254,s[16:19],s32 offen offset:1792 lds
s_add_u32 m0,m0,0x000000a0
v_mfma_f32_16x16x32_bf16 v[136:139],v[232:235],v[104:107],v[136:139]
ds_read_b128 v[220:223],v252 offset:17600
v_mfma_f32_16x16x32_bf16 v[128:131],v[236:239],v[112:115],v[128:131]
v_mfma_f32_16x16x32_bf16 v[132:135],v[236:239],v[116:119],v[132:135]
buffer_load_dwordx4 v254,s[16:19],s32 offen offset:2688 lds
s_add_u32 s32,s32,0x0001c000
v_mfma_f32_16x16x32_bf16 v[136:139],v[236:239],v[120:123],v[136:139]
s_add_u32 m0,s29,67584
s_waitcnt lgkmcnt(2)
v_mfma_f32_16x16x32_bf16 v[144:147],v[208:211],v[0:3],v[192:195]
ds_read_b128 v[224:227],v252 offset:17664
v_mfma_f32_16x16x32_bf16 v[148:151],v[208:211],v[4:7],v[196:199]
buffer_load_dwordx4 v254,s[16:19],s32 offen offset:0 lds
s_add_u32 m0,m0,0x000000a0
v_mfma_f32_16x16x32_bf16 v[152:155],v[208:211],v[8:11],v[200:203]
ds_read_b128 v[228:231],v252 offset:17728
v_exp_f32 v248,v128
v_mfma_f32_16x16x32_bf16 v[144:147],v[212:215],v[16:19],v[144:147]
v_exp_f32 v249,v129
v_mfma_f32_16x16x32_bf16 v[148:151],v[212:215],v[20:23],v[148:151]
buffer_load_dwordx4 v254,s[16:19],s32 offen offset:896 lds
s_add_u32 m0,m0,0x000000a0
v_mfma_f32_16x16x32_bf16 v[152:155],v[212:215],v[24:27],v[152:155]
v_exp_f32 v250,v130
v_add_f32 v244,v248,v249
s_waitcnt lgkmcnt(2)
v_mfma_f32_16x16x32_bf16 v[144:147],v[216:219],v[32:35],v[144:147]
ds_read_b128 v[232:235],v252 offset:17792
v_cvt_pk_bf16_f32 v160,v248,v249
v_mfma_f32_16x16x32_bf16 v[148:151],v[216:219],v[36:39],v[148:151]
buffer_load_dwordx4 v254,s[16:19],s32 offen offset:1792 lds
s_add_u32 m0,m0,0x000000a0
v_mfma_f32_16x16x32_bf16 v[152:155],v[216:219],v[40:43],v[152:155]
ds_read_b128 v[236:239],v252 offset:17856
v_exp_f32 v251,v131
v_mfma_f32_16x16x32_bf16 v[144:147],v[220:223],v[48:51],v[144:147]
v_exp_f32 v248,v132
v_mfma_f32_16x16x32_bf16 v[148:151],v[220:223],v[52:55],v[148:151]
buffer_load_dwordx4 v254,s[16:19],s32 offen offset:2688 lds
s_add_u32 s32,s32,0x0001c000
v_mfma_f32_16x16x32_bf16 v[152:155],v[220:223],v[56:59],v[152:155]
v_exp_f32 v249,v133
v_add_f32 v244,v244,v250
s_waitcnt lgkmcnt(2)
v_mfma_f32_16x16x32_bf16 v[144:147],v[224:227],v[64:67],v[144:147]
ds_read_b64_tr_b16 v[208:209],v253 offset:16896
v_subrev_u32 v252,s33,v252
v_mfma_f32_16x16x32_bf16 v[148:151],v[224:227],v[68:71],v[148:151]
ds_read_b64_tr_b16 v[210:211],v253 offset:17408
v_add_f32 v244,v244,v251
v_mfma_f32_16x16x32_bf16 v[152:155],v[224:227],v[72:75],v[152:155]
ds_read_b64_tr_b16 v[212:213],v253 offset:16928
v_cvt_pk_bf16_f32 v161,v250,v251
ds_read_b64_tr_b16 v[214:215],v253 offset:17440
v_add_f32 v245,v248,v249
v_mfma_f32_16x16x32_bf16 v[144:147],v[228:231],v[80:83],v[144:147]
v_exp_f32 v250,v134
v_mfma_f32_16x16x32_bf16 v[148:151],v[228:231],v[84:87],v[148:151]
v_exp_f32 v251,v135
v_mfma_f32_16x16x32_bf16 v[152:155],v[228:231],v[88:91],v[152:155]
v_cvt_pk_bf16_f32 v164,v248,v249
v_add_f32 v245,v245,v250
s_waitcnt lgkmcnt(4)
v_mfma_f32_16x16x32_bf16 v[144:147],v[232:235],v[96:99],v[144:147]
ds_read_b64_tr_b16 v[216:217],v253 offset:16960
v_add_f32 v245,v245,v251
v_mfma_f32_16x16x32_bf16 v[148:151],v[232:235],v[100:103],v[148:151]
ds_read_b64_tr_b16 v[218:219],v253 offset:17472
v_cvt_pk_bf16_f32 v165,v250,v251
v_mfma_f32_16x16x32_bf16 v[152:155],v[232:235],v[104:107],v[152:155]
ds_read_b64_tr_b16 v[220:221],v253 offset:16992
ds_read_b64_tr_b16 v[222:223],v253 offset:17504
v_mfma_f32_16x16x32_bf16 v[144:147],v[236:239],v[112:115],v[144:147]
s_add_u32 s34,s34,s33
s_sub_u32 s35,s35,s33
v_mfma_f32_16x16x32_bf16 v[148:151],v[236:239],v[116:119],v[148:151]
v_exp_f32 v248,v136
v_mfma_f32_16x16x32_bf16 v[152:155],v[236:239],v[120:123],v[152:155]
v_exp_f32 v249,v137
s_nop 0
v_add_f32 v246,v248,v249
s_waitcnt lgkmcnt(4)
v_mfma_f32_16x16x32_bf16 a[0:3],v[208:211],v[176:179],a[0:3]
ds_read_b64_tr_b16 v[224:225],v253 offset:17024
v_cvt_pk_bf16_f32 v168,v248,v249
v_mfma_f32_16x16x32_bf16 a[4:7],v[208:211],v[180:183],a[4:7]
ds_read_b64_tr_b16 v[226:227],v253 offset:17536
v_mfma_f32_16x16x32_bf16 a[8:11],v[208:211],v[184:187],a[8:11]
ds_read_b64_tr_b16 v[228:229],v253 offset:17056
ds_read_b64_tr_b16 v[230:231],v253 offset:17568
v_mfma_f32_16x16x32_bf16 a[16:19],v[212:215],v[176:179],a[16:19]
v_exp_f32 v250,v138
v_mfma_f32_16x16x32_bf16 a[20:23],v[212:215],v[180:183],a[20:23]
v_exp_f32 v251,v139
v_mfma_f32_16x16x32_bf16 a[24:27],v[212:215],v[184:187],a[24:27]
v_exp_f32 v248,v144
v_add_f32 v246,v246,v250
s_waitcnt lgkmcnt(4)
v_mfma_f32_16x16x32_bf16 a[32:35],v[216:219],v[176:179],a[32:35]
ds_read_b64_tr_b16 v[232:233],v253 offset:17088
v_add_f32 v246,v246,v251
v_mfma_f32_16x16x32_bf16 a[36:39],v[216:219],v[180:183],a[36:39]
ds_read_b64_tr_b16 v[234:235],v253 offset:17600
v_cvt_pk_bf16_f32 v169,v250,v251
v_mfma_f32_16x16x32_bf16 a[40:43],v[216:219],v[184:187],a[40:43]
ds_read_b64_tr_b16 v[236:237],v253 offset:17120
ds_read_b64_tr_b16 v[238:239],v253 offset:17632
v_mfma_f32_16x16x32_bf16 a[48:51],v[220:223],v[176:179],a[48:51]
v_exp_f32 v249,v145
v_mfma_f32_16x16x32_bf16 a[52:55],v[220:223],v[180:183],a[52:55]
v_exp_f32 v250,v146
v_mfma_f32_16x16x32_bf16 a[56:59],v[220:223],v[184:187],a[56:59]
v_exp_f32 v251,v147
v_add_f32 v244,v244,v248
s_waitcnt lgkmcnt(4)
v_mfma_f32_16x16x32_bf16 a[64:67],v[224:227],v[176:179],a[64:67]
ds_read_b64_tr_b16 v[208:209],v253 offset:17152
v_add_f32 v244,v244,v249
v_mfma_f32_16x16x32_bf16 a[68:71],v[224:227],v[180:183],a[68:71]
ds_read_b64_tr_b16 v[210:211],v253 offset:17664
v_cvt_pk_bf16_f32 v162,v248,v249
v_mfma_f32_16x16x32_bf16 a[72:75],v[224:227],v[184:187],a[72:75]
ds_read_b64_tr_b16 v[212:213],v253 offset:17184
v_add_f32 v244,v244,v250
ds_read_b64_tr_b16 v[214:215],v253 offset:17696
v_add_f32 v244,v244,v251
v_mfma_f32_16x16x32_bf16 a[80:83],v[228:231],v[176:179],a[80:83]
v_exp_f32 v248,v148
v_mfma_f32_16x16x32_bf16 a[84:87],v[228:231],v[180:183],a[84:87]
v_exp_f32 v249,v149
v_mfma_f32_16x16x32_bf16 a[88:91],v[228:231],v[184:187],a[88:91]
v_cvt_pk_bf16_f32 v163,v250,v251
v_add_f32 v245,v245,v248
s_waitcnt lgkmcnt(4)
v_mfma_f32_16x16x32_bf16 a[96:99],v[232:235],v[176:179],a[96:99]
ds_read_b64_tr_b16 v[216:217],v253 offset:17216
v_add_f32 v245,v245,v249
v_mfma_f32_16x16x32_bf16 a[100:103],v[232:235],v[180:183],a[100:103]
ds_read_b64_tr_b16 v[218:219],v253 offset:17728
v_cvt_pk_bf16_f32 v166,v248,v249
v_mfma_f32_16x16x32_bf16 a[104:107],v[232:235],v[184:187],a[104:107]
ds_read_b64_tr_b16 v[220:221],v253 offset:17248
ds_read_b64_tr_b16 v[222:223],v253 offset:17760
v_mfma_f32_16x16x32_bf16 a[112:115],v[236:239],v[176:179],a[112:115]
v_exp_f32 v250,v150
v_mfma_f32_16x16x32_bf16 a[116:119],v[236:239],v[180:183],a[116:119]
v_exp_f32 v251,v151
v_mfma_f32_16x16x32_bf16 a[120:123],v[236:239],v[184:187],a[120:123]
v_exp_f32 v248,v152
v_add_f32 v245,v245,v250
s_waitcnt lgkmcnt(4)
v_mfma_f32_16x16x32_bf16 a[128:131],v[208:211],v[176:179],a[128:131]
ds_read_b64_tr_b16 v[224:225],v253 offset:17280
v_add_f32 v245,v245,v251
v_mfma_f32_16x16x32_bf16 a[132:135],v[208:211],v[180:183],a[132:135]
ds_read_b64_tr_b16 v[226:227],v253 offset:17792
v_cvt_pk_bf16_f32 v167,v250,v251
v_mfma_f32_16x16x32_bf16 a[136:139],v[208:211],v[184:187],a[136:139]
ds_read_b64_tr_b16 v[228:229],v253 offset:17312
ds_read_b64_tr_b16 v[230:231],v253 offset:17824
v_mfma_f32_16x16x32_bf16 a[144:147],v[212:215],v[176:179],a[144:147]
v_exp_f32 v249,v153
v_mfma_f32_16x16x32_bf16 a[148:151],v[212:215],v[180:183],a[148:151]
v_exp_f32 v250,v154
v_mfma_f32_16x16x32_bf16 a[152:155],v[212:215],v[184:187],a[152:155]
v_exp_f32 v251,v155
v_add_f32 v246,v246,v248
s_waitcnt lgkmcnt(4)
v_mfma_f32_16x16x32_bf16 a[160:163],v[216:219],v[176:179],a[160:163]
ds_read_b64_tr_b16 v[232:233],v253 offset:17344
v_add_f32 v246,v246,v249
v_mfma_f32_16x16x32_bf16 a[164:167],v[216:219],v[180:183],a[164:167]
ds_read_b64_tr_b16 v[234:235],v253 offset:17856
v_cvt_pk_bf16_f32 v170,v248,v249
v_mfma_f32_16x16x32_bf16 a[168:171],v[216:219],v[184:187],a[168:171]
ds_read_b64_tr_b16 v[236:237],v253 offset:17376
v_add_f32 v246,v246,v250
ds_read_b64_tr_b16 v[238:239],v253 offset:17888
v_add_f32 v246,v246,v251
v_mfma_f32_16x16x32_bf16 a[176:179],v[220:223],v[176:179],a[176:179]
v_add_u32 v253,s33,v253
s_sub_u32 s33,0,s33
v_mfma_f32_16x16x32_bf16 a[180:183],v[220:223],v[180:183],a[180:183]
v_cvt_pk_bf16_f32 v171,v250,v251
v_max3_f32 v248,v244,v245,v246
v_mfma_f32_16x16x32_bf16 a[184:187],v[220:223],v[184:187],a[184:187]
v_cmp_lt_f32 vcc,0x49800000,v248
s_waitcnt lgkmcnt(4)
v_mfma_f32_16x16x32_bf16 a[192:195],v[224:227],v[176:179],a[192:195]
v_mfma_f32_16x16x32_bf16 a[196:199],v[224:227],v[180:183],a[196:199]
s_waitcnt vmcnt(21) lgkmcnt(0)
s_barrier
v_mfma_f32_16x16x32_bf16 a[200:203],v[224:227],v[184:187],a[200:203]
ds_read_b128 v[208:211],v252 offset:0
v_mfma_f32_16x16x32_bf16 a[208:211],v[228:231],v[176:179],a[208:211]
ds_read_b128 v[212:215],v252 offset:64
v_mfma_f32_16x16x32_bf16 a[212:215],v[228:231],v[180:183],a[212:215]
v_mfma_f32_16x16x32_bf16 a[216:219],v[228:231],v[184:187],a[216:219]
v_mfma_f32_16x16x32_bf16 a[224:227],v[232:235],v[176:179],a[224:227]
ds_read_b128 v[216:219],v252 offset:128
v_mfma_f32_16x16x32_bf16 a[228:231],v[232:235],v[180:183],a[228:231]
v_mfma_f32_16x16x32_bf16 a[232:235],v[232:235],v[184:187],a[232:235]
ds_read_b128 v[220:223],v252 offset:192
v_mfma_f32_16x16x32_bf16 a[240:243],v[236:239],v[176:179],a[240:243]
v_mfma_f32_16x16x32_bf16 a[244:247],v[236:239],v[180:183],a[244:247]
v_mfma_f32_16x16x32_bf16 a[248:251],v[236:239],v[184:187],a[248:251]
s_waitcnt lgkmcnt(2)
s_cbranch_vccnz M_stub8
M_back8:
v_mfma_f32_16x16x32_bf16 v[128:131],v[208:211],v[0:3],v[192:195]
ds_read_b128 v[224:227],v252 offset:256
s_add_u32 m0,s29,50688
v_mfma_f32_16x16x32_bf16 v[132:135],v[208:211],v[4:7],v[196:199]
buffer_load_dwordx4 v254,s[16:19],s32 offen offset:0 lds
s_add_u32 m0,m0,0x000000a0
v_mfma_f32_16x16x32_bf16 v[136:139],v[208:211],v[8:11],v[200:203]
ds_read_b128 v[228:231],v252 offset:320
v_add_f32 v240,v240,v244
v_add_f32 v241,v241,v245
v_add_f32 v242,v242,v246
v_mfma_f32_16x16x32_bf16 v[128:131],v[212:215],v[16:19],v[128:131]
v_mbcnt_lo_u32_b32 v255,-1,0
v_mbcnt_hi_u32_b32 v255,-1,v255
v_mfma_f32_16x16x32_bf16 v[132:135],v[212:215],v[20:23],v[132:135]
buffer_load_dwordx4 v254,s[16:19],s32 offen offset:896 lds
s_add_u32 m0,m0,0x000000a0
v_mfma_f32_16x16x32_bf16 v[136:139],v[212:215],v[24:27],v[136:139]
v_lshlrev_b32 v255,4,v255
s_waitcnt lgkmcnt(2)
v_mfma_f32_16x16x32_bf16 v[128:131],v[216:219],v[32:35],v[128:131]
ds_read_b128 v[232:235],v252 offset:384
v_mfma_f32_16x16x32_bf16 v[132:135],v[216:219],v[36:39],v[132:135]
buffer_load_dwordx4 v254,s[16:19],s32 offen offset:1792 lds
s_add_u32 m0,m0,0x000000a0
v_mfma_f32_16x16x32_bf16 v[136:139],v[216:219],v[40:43],v[136:139]
ds_read_b128 v[236:239],v252 offset:448
v_mfma_f32_16x16x32_bf16 v[128:131],v[220:223],v[48:51],v[128:131]
v_mfma_f32_16x16x32_bf16 v[132:135],v[220:223],v[52:55],v[132:135]
buffer_load_dwordx4 v254,s[16:19],s32 offen offset:2688 lds
s_add_u32 s32,s32,0xfffac080
v_mfma_f32_16x16x32_bf16 v[136:139],v[220:223],v[56:59],v[136:139]
s_add_u32 m0,s29,84480
s_waitcnt lgkmcnt(2)
v_mfma_f32_16x16x32_bf16 v[128:131],v[224:227],v[64:67],v[128:131]
ds_read_b128 v[208:211],v252 offset:512
v_mfma_f32_16x16x32_bf16 v[132:135],v[224:227],v[68:71],v[132:135]
buffer_load_dwordx4 v254,s[16:19],s32 offen offset:0 lds
s_add_u32 m0,m0,0x000000a0
v_mfma_f32_16x16x32_bf16 v[136:139],v[224:227],v[72:75],v[136:139]
ds_read_b128 v[212:215],v252 offset:576
v_mfma_f32_16x16x32_bf16 v[128:131],v[228:231],v[80:83],v[128:131]
v_mfma_f32_16x16x32_bf16 v[132:135],v[228:231],v[84:87],v[132:135]
buffer_load_dwordx4 v254,s[16:19],s32 offen offset:896 lds
s_add_u32 m0,m0,0x000000a0
v_mfma_f32_16x16x32_bf16 v[136:139],v[228:231],v[88:91],v[136:139]
s_waitcnt lgkmcnt(2)
v_mfma_f32_16x16x32_bf16 v[128:131],v[232:235],v[96:99],v[128:131]
ds_read_b128 v[216:219],v252 offset:640
v_mfma_f32_16x16x32_bf16 v[132:135],v[232:235],v[100:103],v[132:135]
buffer_load_dwordx4 v254,s[16:19],s32 offen offset:1792 lds
s_add_u32 m0,m0,0x000000a0
v_mfma_f32_16x16x32_bf16 v[136:139],v[232:235],v[104:107],v[136:139]
ds_read_b128 v[220:223],v252 offset:704
v_mfma_f32_16x16x32_bf16 v[128:131],v[236:239],v[112:115],v[128:131]
v_mfma_f32_16x16x32_bf16 v[132:135],v[236:239],v[116:119],v[132:135]
buffer_load_dwordx4 v254,s[16:19],s32 offen offset:2688 lds
s_add_u32 s32,s32,0x0001c000
v_mfma_f32_16x16x32_bf16 v[136:139],v[236:239],v[120:123],v[136:139]
s_waitcnt lgkmcnt(2)
v_mfma_f32_16x16x32_bf16 v[144:147],v[208:211],v[0:3],v[192:195]
ds_read_b128 v[224:227],v252 offset:768
v_mfma_f32_16x16x32_bf16 v[148:151],v[208:211],v[4:7],v[196:199]
v_mfma_f32_16x16x32_bf16 v[152:155],v[208:211],v[8:11],v[200:203]
ds_read_b128 v[228:231],v252 offset:832
v_exp_f32 v248,v128
v_mfma_f32_16x16x32_bf16 v[144:147],v[212:215],v[16:19],v[144:147]
v_exp_f32 v249,v129
v_mfma_f32_16x16x32_bf16 v[148:151],v[212:215],v[20:23],v[148:151]
v_exp_f32 v250,v130
v_mfma_f32_16x16x32_bf16 v[152:155],v[212:215],v[24:27],v[152:155]
v_exp_f32 v251,v131
v_add_f32 v244,v248,v249
s_waitcnt lgkmcnt(2)
v_mfma_f32_16x16x32_bf16 v[144:147],v[216:219],v[32:35],v[144:147]
ds_read_b128 v[232:235],v252 offset:896
v_cvt_pk_bf16_f32 v176,v248,v249
v_mfma_f32_16x16x32_bf16 v[148:151],v[216:219],v[36:39],v[148:151]
v_exp_f32 v248,v132
v_mfma_f32_16x16x32_bf16 v[152:155],v[216:219],v[40:43],v[152:155]
ds_read_b128 v[236:239],v252 offset:960
v_add_f32 v244,v244,v250
v_exp_f32 v249,v133
v_mfma_f32_16x16x32_bf16 v[144:147],v[220:223],v[48:51],v[144:147]
v_add_f32 v244,v244,v251
v_cvt_pk_bf16_f32 v177,v250,v251
v_mfma_f32_16x16x32_bf16 v[148:151],v[220:223],v[52:55],v[148:151]
v_exp_f32 v250,v134
v_mfma_f32_16x16x32_bf16 v[152:155],v[220:223],v[56:59],v[152:155]
v_exp_f32 v251,v135
v_add_f32 v245,v248,v249
s_waitcnt lgkmcnt(2)
v_mfma_f32_16x16x32_bf16 v[144:147],v[224:227],v[64:67],v[144:147]
ds_read_b64_tr_b16 v[208:209],v253 offset:0
v_cvt_pk_bf16_f32 v180,v248,v249
v_mfma_f32_16x16x32_bf16 v[148:151],v[224:227],v[68:71],v[148:151]
ds_read_b64_tr_b16 v[210:211],v253 offset:512
v_add_f32 v245,v245,v250
v_mfma_f32_16x16x32_bf16 v[152:155],v[224:227],v[72:75],v[152:155]
ds_read_b64_tr_b16 v[212:213],v253 offset:32
v_add_f32 v245,v245,v251
ds_read_b64_tr_b16 v[214:215],v253 offset:544
v_cvt_pk_bf16_f32 v181,v250,v251
v_mfma_f32_16x16x32_bf16 v[144:147],v[228:231],v[80:83],v[144:147]
v_exp_f32 v248,v136
v_mfma_f32_16x16x32_bf16 v[148:151],v[228:231],v[84:87],v[148:151]
v_exp_f32 v249,v137
v_mfma_f32_16x16x32_bf16 v[152:155],v[228:231],v[88:91],v[152:155]
v_exp_f32 v250,v138
v_add_f32 v246,v248,v249
s_waitcnt lgkmcnt(4)
v_mfma_f32_16x16x32_bf16 v[144:147],v[232:235],v[96:99],v[144:147]
ds_read_b64_tr_b16 v[216:217],v253 offset:64
v_cvt_pk_bf16_f32 v184,v248,v249
v_mfma_f32_16x16x32_bf16 v[148:151],v[232:235],v[100:103],v[148:151]
ds_read_b64_tr_b16 v[218:219],v253 offset:576
v_mfma_f32_16x16x32_bf16 v[152:155],v[232:235],v[104:107],v[152:155]
ds_read_b64_tr_b16 v[220:221],v253 offset:96
ds_read_b64_tr_b16 v[222:223],v253 offset:608
v_mfma_f32_16x16x32_bf16 v[144:147],v[236:239],v[112:115],v[144:147]
v_exp_f32 v251,v139
v_mfma_f32_16x16x32_bf16 v[148:151],v[236:239],v[116:119],v[148:151]
v_add_f32 v246,v246,v250
v_add_f32 v246,v246,v251
v_mfma_f32_16x16x32_bf16 v[152:155],v[236:239],v[120:123],v[152:155]
v_cvt_pk_bf16_f32 v185,v250,v251
s_waitcnt lgkmcnt(4)
v_mfma_f32_16x16x32_bf16 a[0:3],v[208:211],v[160:163],a[0:3]
ds_read_b64_tr_b16 v[224:225],v253 offset:128
v_mfma_f32_16x16x32_bf16 a[4:7],v[208:211],v[164:167],a[4:7]
ds_read_b64_tr_b16 v[226:227],v253 offset:640
v_mfma_f32_16x16x32_bf16 a[8:11],v[208:211],v[168:171],a[8:11]
ds_read_b64_tr_b16 v[228:229],v253 offset:160
ds_read_b64_tr_b16 v[230:231],v253 offset:672
buffer_load_dwordx4 v[0:3],v255,s[20:23],s62 offen offset:0
v_mfma_f32_16x16x32_bf16 a[16:19],v[212:215],v[160:163],a[16:19]
v_exp_f32 v248,v144
v_mfma_f32_16x16x32_bf16 a[20:23],v[212:215],v[164:167],a[20:23]
v_exp_f32 v249,v145
v_mfma_f32_16x16x32_bf16 a[24:27],v[212:215],v[168:171],a[24:27]
v_exp_f32 v250,v146
v_add_f32 v244,v244,v248
s_waitcnt lgkmcnt(4)
v_mfma_f32_16x16x32_bf16 a[32:35],v[216:219],v[160:163],a[32:35]
ds_read_b64_tr_b16 v[232:233],v253 offset:192
v_add_f32 v244,v244,v249
v_mfma_f32_16x16x32_bf16 a[36:39],v[216:219],v[164:167],a[36:39]
ds_read_b64_tr_b16 v[234:235],v253 offset:704
v_cvt_pk_bf16_f32 v178,v248,v249
v_mfma_f32_16x16x32_bf16 a[40:43],v[216:219],v[168:171],a[40:43]
ds_read_b64_tr_b16 v[236:237],v253 offset:224
ds_read_b64_tr_b16 v[238:239],v253 offset:736
v_mfma_f32_16x16x32_bf16 a[48:51],v[220:223],v[160:163],a[48:51]
v_exp_f32 v251,v147
v_mfma_f32_16x16x32_bf16 a[52:55],v[220:223],v[164:167],a[52:55]
v_exp_f32 v248,v148
v_mfma_f32_16x16x32_bf16 a[56:59],v[220:223],v[168:171],a[56:59]
v_exp_f32 v249,v149
v_add_f32 v244,v244,v250
s_waitcnt lgkmcnt(4)
v_mfma_f32_16x16x32_bf16 a[64:67],v[224:227],v[160:163],a[64:67]
ds_read_b64_tr_b16 v[208:209],v253 offset:256
v_add_f32 v244,v244,v251
v_mfma_f32_16x16x32_bf16 a[68:71],v[224:227],v[164:167],a[68:71]
ds_read_b64_tr_b16 v[210:211],v253 offset:768
v_cvt_pk_bf16_f32 v179,v250,v251
v_mfma_f32_16x16x32_bf16 a[72:75],v[224:227],v[168:171],a[72:75]
ds_read_b64_tr_b16 v[212:213],v253 offset:288
v_add_f32 v245,v245,v248
ds_read_b64_tr_b16 v[214:215],v253 offset:800
v_add_f32 v245,v245,v249
v_mfma_f32_16x16x32_bf16 a[80:83],v[228:231],v[160:163],a[80:83]
v_exp_f32 v250,v150
v_mfma_f32_16x16x32_bf16 a[84:87],v[228:231],v[164:167],a[84:87]
v_exp_f32 v251,v151
v_mfma_f32_16x16x32_bf16 a[88:91],v[228:231],v[168:171],a[88:91]
v_cvt_pk_bf16_f32 v182,v248,v249
v_add_f32 v245,v245,v250
s_waitcnt lgkmcnt(4)
v_mfma_f32_16x16x32_bf16 a[96:99],v[232:235],v[160:163],a[96:99]
ds_read_b64_tr_b16 v[216:217],v253 offset:320
v_add_f32 v245,v245,v251
v_mfma_f32_16x16x32_bf16 a[100:103],v[232:235],v[164:167],a[100:103]
ds_read_b64_tr_b16 v[218:219],v253 offset:832
v_cvt_pk_bf16_f32 v183,v250,v251
v_mfma_f32_16x16x32_bf16 a[104:107],v[232:235],v[168:171],a[104:107]
ds_read_b64_tr_b16 v[220:221],v253 offset:352
ds_read_b64_tr_b16 v[222:223],v253 offset:864
v_mfma_f32_16x16x32_bf16 a[112:115],v[236:239],v[160:163],a[112:115]
v_exp_f32 v248,v152
v_mfma_f32_16x16x32_bf16 a[116:119],v[236:239],v[164:167],a[116:119]
v_exp_f32 v249,v153
v_mfma_f32_16x16x32_bf16 a[120:123],v[236:239],v[168:171],a[120:123]
v_exp_f32 v250,v154
v_add_f32 v246,v246,v248
s_waitcnt lgkmcnt(4)
v_mfma_f32_16x16x32_bf16 a[128:131],v[208:211],v[160:163],a[128:131]
ds_read_b64_tr_b16 v[224:225],v253 offset:384
v_add_f32 v246,v246,v249
v_mfma_f32_16x16x32_bf16 a[132:135],v[208:211],v[164:167],a[132:135]
ds_read_b64_tr_b16 v[226:227],v253 offset:896
v_cvt_pk_bf16_f32 v186,v248,v249
v_mfma_f32_16x16x32_bf16 a[136:139],v[208:211],v[168:171],a[136:139]
ds_read_b64_tr_b16 v[228:229],v253 offset:416
ds_read_b64_tr_b16 v[230:231],v253 offset:928
v_mfma_f32_16x16x32_bf16 a[144:147],v[212:215],v[160:163],a[144:147]
v_exp_f32 v251,v155
v_mfma_f32_16x16x32_bf16 a[148:151],v[212:215],v[164:167],a[148:151]
v_add_f32 v246,v246,v250
v_add_f32 v246,v246,v251
v_mfma_f32_16x16x32_bf16 a[152:155],v[212:215],v[168:171],a[152:155]
v_cvt_pk_bf16_f32 v187,v250,v251
v_max3_f32 v248,v244,v245,v246
v_cmp_lt_f32 vcc,0x49800000,v248
s_waitcnt lgkmcnt(4)
v_mfma_f32_16x16x32_bf16 a[160:163],v[216:219],v[160:163],a[160:163]
ds_read_b64_tr_b16 v[232:233],v253 offset:448
v_mfma_f32_16x16x32_bf16 a[164:167],v[216:219],v[164:167],a[164:167]
ds_read_b64_tr_b16 v[234:235],v253 offset:960
v_mfma_f32_16x16x32_bf16 a[168:171],v[216:219],v[168:171],a[168:171]
ds_read_b64_tr_b16 v[236:237],v253 offset:480
ds_read_b64_tr_b16 v[238:239],v253 offset:992
v_mfma_f32_16x16x32_bf16 a[176:179],v[220:223],v[160:163],a[176:179]
v_mfma_f32_16x16x32_bf16 a[180:183],v[220:223],v[164:167],a[180:183]
v_mfma_f32_16x16x32_bf16 a[184:187],v[220:223],v[168:171],a[184:187]
s_waitcnt lgkmcnt(4)
v_mfma_f32_16x16x32_bf16 a[192:195],v[224:227],v[160:163],a[192:195]
v_mfma_f32_16x16x32_bf16 a[196:199],v[224:227],v[164:167],a[196:199]
s_waitcnt vmcnt(26) lgkmcnt(0)
s_barrier
v_mfma_f32_16x16x32_bf16 a[200:203],v[224:227],v[168:171],a[200:203]
ds_read_b64_tr_b16 v[208:209],v253 offset:16896
ds_read_b64_tr_b16 v[210:211],v253 offset:17408
v_mfma_f32_16x16x32_bf16 a[208:211],v[228:231],v[160:163],a[208:211]
ds_read_b64_tr_b16 v[212:213],v253 offset:16928
v_mfma_f32_16x16x32_bf16 a[212:215],v[228:231],v[164:167],a[212:215]
ds_read_b64_tr_b16 v[214:215],v253 offset:17440
v_mfma_f32_16x16x32_bf16 a[216:219],v[228:231],v[168:171],a[216:219]
v_mfma_f32_16x16x32_bf16 a[224:227],v[232:235],v[160:163],a[224:227]
ds_read_b64_tr_b16 v[216:217],v253 offset:16960
v_mfma_f32_16x16x32_bf16 a[228:231],v[232:235],v[164:167],a[228:231]
ds_read_b64_tr_b16 v[218:219],v253 offset:17472
v_mfma_f32_16x16x32_bf16 a[232:235],v[232:235],v[168:171],a[232:235]
ds_read_b64_tr_b16 v[220:221],v253 offset:16992
ds_read_b64_tr_b16 v[222:223],v253 offset:17504
v_mfma_f32_16x16x32_bf16 a[240:243],v[236:239],v[160:163],a[240:243]
v_mfma_f32_16x16x32_bf16 a[244:247],v[236:239],v[164:167],a[244:247]
v_mfma_f32_16x16x32_bf16 a[248:251],v[236:239],v[168:171],a[248:251]
s_waitcnt lgkmcnt(4)
s_cbranch_vccnz M_stub9
M_back9:
v_mfma_f32_16x16x32_bf16 a[0:3],v[208:211],v[176:179],a[0:3]
ds_read_b64_tr_b16 v[224:225],v253 offset:17024
s_add_u32 m0,s29,0
v_mfma_f32_16x16x32_bf16 a[4:7],v[208:211],v[180:183],a[4:7]
ds_read_b64_tr_b16 v[226:227],v253 offset:17536
buffer_load_dwordx4 v254,s[16:19],s32 offen offset:0 lds
v_mfma_f32_16x16x32_bf16 a[8:11],v[208:211],v[184:187],a[8:11]
ds_read_b64_tr_b16 v[228:229],v253 offset:17056
s_add_u32 m0,m0,0x000000a0
ds_read_b64_tr_b16 v[230:231],v253 offset:17568
v_add_f32 v240,v240,v244
v_mfma_f32_16x16x32_bf16 a[16:19],v[212:215],v[176:179],a[16:19]
v_add_f32 v241,v241,v245
v_add_f32 v242,v242,v246
v_mfma_f32_16x16x32_bf16 a[20:23],v[212:215],v[180:183],a[20:23]
buffer_load_dwordx4 v254,s[16:19],s32 offen offset:896 lds
s_add_u32 m0,m0,0x000000a0
v_mfma_f32_16x16x32_bf16 a[24:27],v[212:215],v[184:187],a[24:27]
v_mov_b32 v244,v240
v_mov_b32 v245,v241
v_mov_b32 v246,v242
s_waitcnt lgkmcnt(4)
v_mbcnt_lo_u32_b32 v248,-1,0
v_mbcnt_hi_u32_b32 v248,-1,v248
v_lshlrev_b32 v248,4,v248
v_mfma_f32_16x16x32_bf16 a[32:35],v[216:219],v[176:179],a[32:35]
ds_read_b64_tr_b16 v[232:233],v253 offset:17088
v_permlane32_swap_b32 v244,v240
v_mfma_f32_16x16x32_bf16 a[36:39],v[216:219],v[180:183],a[36:39]
ds_read_b64_tr_b16 v[234:235],v253 offset:17600
buffer_load_dwordx4 v254,s[16:19],s32 offen offset:1792 lds
v_mfma_f32_16x16x32_bf16 a[40:43],v[216:219],v[184:187],a[40:43]
ds_read_b64_tr_b16 v[236:237],v253 offset:17120
s_add_u32 m0,m0,0x000000a0
ds_read_b64_tr_b16 v[238:239],v253 offset:17632
v_permlane32_swap_b32 v245,v241
v_mfma_f32_16x16x32_bf16 a[48:51],v[220:223],v[176:179],a[48:51]
v_permlane32_swap_b32 v246,v242
v_add_f32 v240,v244,v240
v_mfma_f32_16x16x32_bf16 a[52:55],v[220:223],v[180:183],a[52:55]
buffer_load_dwordx4 v254,s[16:19],s32 offen offset:2688 lds
s_add_u32 s32,s32,0x0001c000
v_mfma_f32_16x16x32_bf16 a[56:59],v[220:223],v[184:187],a[56:59]
s_add_u32 m0,s29,101376
v_add_f32 v241,v245,v241
v_add_f32 v242,v246,v242
s_waitcnt lgkmcnt(4)
v_mfma_f32_16x16x32_bf16 a[64:67],v[224:227],v[176:179],a[64:67]
ds_read_b64_tr_b16 v[208:209],v253 offset:17152
v_mov_b32 v244,v240
v_mfma_f32_16x16x32_bf16 a[68:71],v[224:227],v[180:183],a[68:71]
ds_read_b64_tr_b16 v[210:211],v253 offset:17664
buffer_load_dwordx4 v254,s[16:19],s32 offen offset:0 lds
v_mfma_f32_16x16x32_bf16 a[72:75],v[224:227],v[184:187],a[72:75]
ds_read_b64_tr_b16 v[212:213],v253 offset:17184
s_add_u32 m0,m0,0x000000a0
ds_read_b64_tr_b16 v[214:215],v253 offset:17696
v_mov_b32 v245,v241
v_mbcnt_lo_u32_b32 v255,-1,0
v_mbcnt_hi_u32_b32 v255,-1,v255
v_bfe_u32 v249,v255,2,2
v_mul_u32_u24 v249,1056,v249
v_lshrrev_b32 v250,4,v255
v_lshl_add_u32 v249,v250,7,v249
v_and_b32 v255,3,v255
v_lshl_add_u32 v255,v255,3,v249
v_add_u32 v255,50688,v255
v_subrev_u32 v252,50688,v255
s_mul_i32 s58,s28,7168
s_add_u32 s58,s58,135168
v_add_u32 v251,s58,v248
v_mfma_f32_16x16x32_bf16 a[80:83],v[228:231],v[176:179],a[80:83]
v_mov_b32 v246,v242
v_permlane16_swap_b32 v244,v240
v_mfma_f32_16x16x32_bf16 a[84:87],v[228:231],v[180:183],a[84:87]
buffer_load_dwordx4 v254,s[16:19],s32 offen offset:896 lds
s_add_u32 m0,m0,0x000000a0
v_mfma_f32_16x16x32_bf16 a[88:91],v[228:231],v[184:187],a[88:91]
v_permlane16_swap_b32 v245,v241
v_permlane16_swap_b32 v246,v242
v_add_f32 v240,v244,v240
s_waitcnt lgkmcnt(4)
v_mfma_f32_16x16x32_bf16 a[96:99],v[232:235],v[176:179],a[96:99]
ds_read_b64_tr_b16 v[216:217],v253 offset:17216
v_add_f32 v241,v245,v241
v_mfma_f32_16x16x32_bf16 a[100:103],v[232:235],v[180:183],a[100:103]
ds_read_b64_tr_b16 v[218:219],v253 offset:17728
buffer_load_dwordx4 v254,s[16:19],s32 offen offset:1792 lds
v_mfma_f32_16x16x32_bf16 a[104:107],v[232:235],v[184:187],a[104:107]
ds_read_b64_tr_b16 v[220:221],v253 offset:17248
s_add_u32 m0,m0,0x000000a0
ds_read_b64_tr_b16 v[222:223],v253 offset:17760
v_add_f32 v242,v246,v242
v_mfma_f32_16x16x32_bf16 a[112:115],v[236:239],v[176:179],a[112:115]
v_rcp_f32 v192,v240
v_mfma_f32_16x16x32_bf16 a[116:119],v[236:239],v[180:183],a[116:119]
buffer_load_dwordx4 v254,s[16:19],s32 offen offset:2688 lds
s_add_u32 s32,s32,0x0001c000
v_mfma_f32_16x16x32_bf16 a[120:123],v[236:239],v[184:187],a[120:123]
v_rcp_f32 v194,v241
s_lshl_b32 s58,s41,4
s_waitcnt lgkmcnt(4)
v_mfma_f32_16x16x32_bf16 a[128:131],v[208:211],v[176:179],a[128:131]
ds_read_b64_tr_b16 v[224:225],v253 offset:17280
s_add_u32 s58,s58,s40
v_mfma_f32_16x16x32_bf16 a[132:135],v[208:211],v[180:183],a[132:135]
ds_read_b64_tr_b16 v[226:227],v253 offset:17792
s_lshl_b32 s60,s58,3
v_mfma_f32_16x16x32_bf16 a[136:139],v[208:211],v[184:187],a[136:139]
ds_read_b64_tr_b16 v[228:229],v253 offset:17312
buffer_load_dwordx4 v[4:7],v248,s[20:23],s62 offen offset:1024
ds_read_b64_tr_b16 v[230:231],v253 offset:17824
buffer_load_dwordx4 v[8:11],v248,s[20:23],s62 offen offset:3072
v_mfma_f32_16x16x32_bf16 a[144:147],v[212:215],v[176:179],a[144:147]
v_rcp_f32 v196,v242
v_mfma_f32_16x16x32_bf16 a[148:151],v[212:215],v[180:183],a[148:151]
s_add_u32 s0,s54,s60
s_addc_u32 s1,s55,0
v_mfma_f32_16x16x32_bf16 a[152:155],v[212:215],v[184:187],a[152:155]
s_mov_b32 s3,0x20000
s_lshl_b32 s60,s58,10
s_add_u32 s60,s60,58851328
s_waitcnt lgkmcnt(4)
v_mfma_f32_16x16x32_bf16 a[160:163],v[216:219],v[176:179],a[160:163]
ds_read_b64_tr_b16 v[232:233],v253 offset:17344
buffer_load_dwordx4 v[12:15],v248,s[20:23],s63 offen offset:3072
v_mfma_f32_16x16x32_bf16 a[164:167],v[216:219],v[180:183],a[164:167]
ds_read_b64_tr_b16 v[234:235],v253 offset:17856
v_mfma_f32_16x16x32_bf16 a[168:171],v[216:219],v[184:187],a[168:171]
ds_read_b64_tr_b16 v[236:237],v253 offset:17376
ds_read_b64_tr_b16 v[238:239],v253 offset:17888
v_mfma_f32_16x16x32_bf16 a[176:179],v[220:223],v[176:179],a[176:179]
v_add_u32 v253,50688,v255
v_mfma_f32_16x16x32_bf16 a[180:183],v[220:223],v[180:183],a[180:183]
s_add_u32 s12,s56,s60
s_addc_u32 s13,s57,0
v_mfma_f32_16x16x32_bf16 a[184:187],v[220:223],v[184:187],a[184:187]
s_lshl_b32 s60,s39,4
s_waitcnt lgkmcnt(4)
v_mfma_f32_16x16x32_bf16 a[192:195],v[224:227],v[176:179],a[192:195]
s_add_u32 s24,s12,s60
s_addc_u32 s25,s13,0
v_mfma_f32_16x16x32_bf16 a[196:199],v[224:227],v[180:183],a[196:199]
s_waitcnt vmcnt(16) lgkmcnt(0)
s_barrier
v_mfma_f32_16x16x32_bf16 a[200:203],v[224:227],v[184:187],a[200:203]
ds_read_b64_tr_b16 v[208:209],v252 offset:16896
s_add_u32 m0,s29,118272
ds_read_b64_tr_b16 v[210:211],v252 offset:17408
buffer_load_dwordx4 v254,s[16:19],s32 offen offset:0 lds
v_mfma_f32_16x16x32_bf16 a[208:211],v[228:231],v[176:179],a[208:211]
ds_read_b64_tr_b16 v[212:213],v252 offset:16928
s_add_u32 m0,m0,0x000000a0
v_mfma_f32_16x16x32_bf16 a[212:215],v[228:231],v[180:183],a[212:215]
ds_read_b64_tr_b16 v[214:215],v252 offset:17440
buffer_load_dwordx4 v254,s[16:19],s32 offen offset:896 lds
v_mfma_f32_16x16x32_bf16 a[216:219],v[228:231],v[184:187],a[216:219]
s_add_u32 m0,m0,0x000000a0
buffer_load_dwordx4 v[16:19],v248,s[20:23],s64 offen offset:3072
buffer_load_dwordx4 v254,s[16:19],s32 offen offset:1792 lds
s_add_u32 m0,m0,0x000000a0
v_mfma_f32_16x16x32_bf16 a[224:227],v[232:235],v[176:179],a[224:227]
ds_read_b64_tr_b16 v[216:217],v252 offset:21120
v_mfma_f32_16x16x32_bf16 a[228:231],v[232:235],v[180:183],a[228:231]
ds_read_b64_tr_b16 v[218:219],v252 offset:21632
buffer_load_dwordx4 v254,s[16:19],s32 offen offset:2688 lds
v_mfma_f32_16x16x32_bf16 a[232:235],v[232:235],v[184:187],a[232:235]
ds_read_b64_tr_b16 v[220:221],v252 offset:21152
s_add_u32 s32,s32,0xfffac080
ds_read_b64_tr_b16 v[222:223],v252 offset:21664
v_mfma_f32_16x16x32_bf16 a[240:243],v[236:239],v[176:179],a[240:243]
s_cmp_eq_u32 s28,0
s_cselect_b32 s26,4,0
s_cselect_b32 s2,4,0
s_cselect_b32 s33,8,0
v_mfma_f32_16x16x32_bf16 a[244:247],v[236:239],v[180:183],a[244:247]
s_mov_b32 s14,1024
v_mfma_f32_16x16x32_bf16 a[248:251],v[236:239],v[184:187],a[248:251]
s_cmp_lg_u32 s66,0
s_cselect_b32 s68,-1,0
s_and_b32 s59,s39,1
s_mul_i32 s58,s58,1835008
s_mul_i32 s60,s28,57344
s_add_u32 s58,s58,s60
s_add_u32 s58,s58,s62
s_lshl_b32 s60,s59,10
s_add_u32 s58,s58,s60
s_add_u32 s4,s56,s58
s_addc_u32 s5,s57,0
s_sub_u32 s4,s4,2048
s_subb_u32 s5,s5,0
s_mov_b32 s6,0
s_mul_i32 s58,s40,240
s_lshl_b32 s60,s28,6
s_add_u32 s58,s58,s60
s_mul_i32 s58,s58,1792
s_lshl_b32 s60,s62,1
s_add_u32 s58,s58,s60
s_mul_i32 s60,s41,896
s_add_u32 s58,s58,s60
s_lshl_b32 s60,s59,6
s_add_u32 s58,s58,s60
s_add_u32 s8,s52,s58
s_addc_u32 s9,s53,0
s_sub_u32 s8,s8,256
s_subb_u32 s9,s9,0
s_mov_b32 s10,0
s_add_u32 s60,s39,1
s_and_b32 s60,s60,7
s_mul_i32 s93,s60,229376
s_add_u32 s60,s39,2
s_and_b32 s60,s60,7
s_mul_i32 s94,s60,229376
s_add_u32 s60,s39,3
s_and_b32 s60,s60,7
s_mul_i32 s95,s60,229376
s_add_u32 s60,s39,4
s_and_b32 s60,s60,7
s_mul_i32 s96,s60,229376
s_add_u32 s60,s39,5
s_and_b32 s60,s60,7
s_mul_i32 s97,s60,229376
s_add_u32 s60,s39,6
s_and_b32 s60,s60,7
s_mul_i32 s98,s60,229376
s_add_u32 s60,s39,7
s_and_b32 s60,s60,7
s_mul_i32 s99,s60,229376
v_mbcnt_lo_u32_b32 v139,-1,0
v_mbcnt_hi_u32_b32 v139,-1,v139
v_and_b32 v136,15,v139
v_add_u32 v138,4,v136
v_lshrrev_b32 v137,3,v138
v_and_b32 v137,1,v137
v_lshrrev_b32 v138,4,v138
v_lshlrev_b32 v138,3,v138
v_sub_u32 v138,v136,v138
v_lshl_add_u32 v138,v137,2,v138
v_mul_u32_u24 v138,1792,v138
v_lshrrev_b32 v136,4,v139
v_lshl_add_u32 v138,v136,4,v138
v_and_b32 v142,7,v139
v_lshlrev_b32 v142,4,v142
v_mov_b32 v143,0
v_mov_b32 v139,0
v_mov_b32 v141,1
buffer_store_dword v139,v248,s[24:27],0 offen sc1
s_and_b32 s58,s39,1
s_lshl_b32 s58,s58,10
v_add_u32 v249,s58,v248
v_xor_b32 v250,1024,v249
v_accvgpr_read_b32 v144,a0
v_accvgpr_read_b32 v145,a1
v_accvgpr_read_b32 v146,a2
v_accvgpr_read_b32 v147,a3
v_accvgpr_read_b32 v148,a16
v_accvgpr_read_b32 v149,a17
v_accvgpr_read_b32 v150,a18
v_accvgpr_read_b32 v151,a19
v_pk_mul_f32 v[144:145],v[144:145],v[192:193] op_sel_hi:[1,0]
v_pk_mul_f32 v[146:147],v[146:147],v[192:193] op_sel_hi:[1,0]
v_pk_mul_f32 v[148:149],v[148:149],v[192:193] op_sel_hi:[1,0]
v_pk_mul_f32 v[150:151],v[150:151],v[192:193] op_sel_hi:[1,0]
v_cvt_pk_bf16_f32 v20,v144,v145
v_cvt_pk_bf16_f32 v21,v146,v147
v_cvt_pk_bf16_f32 v22,v148,v149
v_cvt_pk_bf16_f32 v23,v150,v151
v_accvgpr_read_b32 v152,a4
v_accvgpr_read_b32 v153,a5
v_accvgpr_read_b32 v154,a6
v_accvgpr_read_b32 v155,a7
v_accvgpr_read_b32 v156,a20
v_accvgpr_read_b32 v157,a21
v_accvgpr_read_b32 v158,a22
v_accvgpr_read_b32 v159,a23
v_pk_mul_f32 v[152:153],v[152:153],v[194:195] op_sel_hi:[1,0]
v_pk_mul_f32 v[154:155],v[154:155],v[194:195] op_sel_hi:[1,0]
v_pk_mul_f32 v[156:157],v[156:157],v[194:195] op_sel_hi:[1,0]
v_pk_mul_f32 v[158:159],v[158:159],v[194:195] op_sel_hi:[1,0]
v_cvt_pk_bf16_f32 v24,v152,v153
v_cvt_pk_bf16_f32 v25,v154,v155
v_cvt_pk_bf16_f32 v26,v156,v157
v_cvt_pk_bf16_f32 v27,v158,v159
v_accvgpr_read_b32 v160,a8
v_accvgpr_read_b32 v161,a9
v_accvgpr_read_b32 v162,a10
v_accvgpr_read_b32 v163,a11
v_accvgpr_read_b32 v164,a24
v_accvgpr_read_b32 v165,a25
v_accvgpr_read_b32 v166,a26
v_accvgpr_read_b32 v167,a27
v_pk_mul_f32 v[160:161],v[160:161],v[196:197] op_sel_hi:[1,0]
v_pk_mul_f32 v[162:163],v[162:163],v[196:197] op_sel_hi:[1,0]
v_pk_mul_f32 v[164:165],v[164:165],v[196:197] op_sel_hi:[1,0]
v_pk_mul_f32 v[166:167],v[166:167],v[196:197] op_sel_hi:[1,0]
v_cvt_pk_bf16_f32 v28,v160,v161
v_cvt_pk_bf16_f32 v29,v162,v163
v_cvt_pk_bf16_f32 v30,v164,v165
v_cvt_pk_bf16_f32 v31,v166,v167
s_add_u32 s60,s62,4096
buffer_load_dwordx4 a[0:3],v248,s[20:23],s60 offen offset:0
v_accvgpr_read_b32 v168,a32
v_accvgpr_read_b32 v169,a33
v_accvgpr_read_b32 v170,a34
v_accvgpr_read_b32 v171,a35
v_accvgpr_read_b32 v172,a48
v_accvgpr_read_b32 v173,a49
v_accvgpr_read_b32 v174,a50
v_accvgpr_read_b32 v175,a51
v_pk_mul_f32 v[168:169],v[168:169],v[192:193] op_sel_hi:[1,0]
v_pk_mul_f32 v[170:171],v[170:171],v[192:193] op_sel_hi:[1,0]
v_pk_mul_f32 v[172:173],v[172:173],v[192:193] op_sel_hi:[1,0]
v_pk_mul_f32 v[174:175],v[174:175],v[192:193] op_sel_hi:[1,0]
v_cvt_pk_bf16_f32 v32,v168,v169
v_cvt_pk_bf16_f32 v33,v170,v171
v_cvt_pk_bf16_f32 v34,v172,v173
v_cvt_pk_bf16_f32 v35,v174,v175
v_accvgpr_read_b32 v144,a36
v_accvgpr_read_b32 v145,a37
v_accvgpr_read_b32 v146,a38
v_accvgpr_read_b32 v147,a39
v_accvgpr_read_b32 v148,a52
v_accvgpr_read_b32 v149,a53
v_accvgpr_read_b32 v150,a54
v_accvgpr_read_b32 v151,a55
v_pk_mul_f32 v[144:145],v[144:145],v[194:195] op_sel_hi:[1,0]
v_pk_mul_f32 v[146:147],v[146:147],v[194:195] op_sel_hi:[1,0]
v_pk_mul_f32 v[148:149],v[148:149],v[194:195] op_sel_hi:[1,0]
v_pk_mul_f32 v[150:151],v[150:151],v[194:195] op_sel_hi:[1,0]
v_cvt_pk_bf16_f32 v36,v144,v145
v_cvt_pk_bf16_f32 v37,v146,v147
v_cvt_pk_bf16_f32 v38,v148,v149
v_cvt_pk_bf16_f32 v39,v150,v151
v_accvgpr_read_b32 v152,a40
v_accvgpr_read_b32 v153,a41
v_accvgpr_read_b32 v154,a42
v_accvgpr_read_b32 v155,a43
v_accvgpr_read_b32 v156,a56
v_accvgpr_read_b32 v157,a57
v_accvgpr_read_b32 v158,a58
v_accvgpr_read_b32 v159,a59
v_pk_mul_f32 v[152:153],v[152:153],v[196:197] op_sel_hi:[1,0]
v_pk_mul_f32 v[154:155],v[154:155],v[196:197] op_sel_hi:[1,0]
v_pk_mul_f32 v[156:157],v[156:157],v[196:197] op_sel_hi:[1,0]
v_pk_mul_f32 v[158:159],v[158:159],v[196:197] op_sel_hi:[1,0]
v_cvt_pk_bf16_f32 v40,v152,v153
v_cvt_pk_bf16_f32 v41,v154,v155
v_cvt_pk_bf16_f32 v42,v156,v157
v_cvt_pk_bf16_f32 v43,v158,v159
s_add_u32 s60,s63,4096
buffer_load_dwordx4 a[4:7],v248,s[20:23],s60 offen offset:0
v_accvgpr_read_b32 v160,a64
v_accvgpr_read_b32 v161,a65
v_accvgpr_read_b32 v162,a66
v_accvgpr_read_b32 v163,a67
v_accvgpr_read_b32 v164,a80
v_accvgpr_read_b32 v165,a81
v_accvgpr_read_b32 v166,a82
v_accvgpr_read_b32 v167,a83
v_pk_mul_f32 v[160:161],v[160:161],v[192:193] op_sel_hi:[1,0]
v_pk_mul_f32 v[162:163],v[162:163],v[192:193] op_sel_hi:[1,0]
v_pk_mul_f32 v[164:165],v[164:165],v[192:193] op_sel_hi:[1,0]
v_pk_mul_f32 v[166:167],v[166:167],v[192:193] op_sel_hi:[1,0]
v_cvt_pk_bf16_f32 v44,v160,v161
v_cvt_pk_bf16_f32 v45,v162,v163
v_cvt_pk_bf16_f32 v46,v164,v165
v_cvt_pk_bf16_f32 v47,v166,v167
v_accvgpr_read_b32 v168,a68
v_accvgpr_read_b32 v169,a69
v_accvgpr_read_b32 v170,a70
v_accvgpr_read_b32 v171,a71
v_accvgpr_read_b32 v172,a84
v_accvgpr_read_b32 v173,a85
v_accvgpr_read_b32 v174,a86
v_accvgpr_read_b32 v175,a87
v_pk_mul_f32 v[168:169],v[168:169],v[194:195] op_sel_hi:[1,0]
v_pk_mul_f32 v[170:171],v[170:171],v[194:195] op_sel_hi:[1,0]
v_pk_mul_f32 v[172:173],v[172:173],v[194:195] op_sel_hi:[1,0]
v_pk_mul_f32 v[174:175],v[174:175],v[194:195] op_sel_hi:[1,0]
v_cvt_pk_bf16_f32 v48,v168,v169
v_cvt_pk_bf16_f32 v49,v170,v171
v_cvt_pk_bf16_f32 v50,v172,v173
v_cvt_pk_bf16_f32 v51,v174,v175
v_accvgpr_read_b32 v144,a72
v_accvgpr_read_b32 v145,a73
v_accvgpr_read_b32 v146,a74
v_accvgpr_read_b32 v147,a75
v_accvgpr_read_b32 v148,a88
v_accvgpr_read_b32 v149,a89
v_accvgpr_read_b32 v150,a90
v_accvgpr_read_b32 v151,a91
v_pk_mul_f32 v[144:145],v[144:145],v[196:197] op_sel_hi:[1,0]
v_pk_mul_f32 v[146:147],v[146:147],v[196:197] op_sel_hi:[1,0]
v_pk_mul_f32 v[148:149],v[148:149],v[196:197] op_sel_hi:[1,0]
v_pk_mul_f32 v[150:151],v[150:151],v[196:197] op_sel_hi:[1,0]
v_cvt_pk_bf16_f32 v52,v144,v145
v_cvt_pk_bf16_f32 v53,v146,v147
v_cvt_pk_bf16_f32 v54,v148,v149
v_cvt_pk_bf16_f32 v55,v150,v151
s_add_u32 s60,s64,4096
buffer_load_dwordx4 a[8:11],v248,s[20:23],s60 offen offset:0
v_accvgpr_read_b32 v152,a96
v_accvgpr_read_b32 v153,a97
v_accvgpr_read_b32 v154,a98
v_accvgpr_read_b32 v155,a99
v_accvgpr_read_b32 v156,a112
v_accvgpr_read_b32 v157,a113
v_accvgpr_read_b32 v158,a114
v_accvgpr_read_b32 v159,a115
v_pk_mul_f32 v[152:153],v[152:153],v[192:193] op_sel_hi:[1,0]
v_pk_mul_f32 v[154:155],v[154:155],v[192:193] op_sel_hi:[1,0]
v_pk_mul_f32 v[156:157],v[156:157],v[192:193] op_sel_hi:[1,0]
v_pk_mul_f32 v[158:159],v[158:159],v[192:193] op_sel_hi:[1,0]
v_cvt_pk_bf16_f32 v56,v152,v153
v_cvt_pk_bf16_f32 v57,v154,v155
v_cvt_pk_bf16_f32 v58,v156,v157
v_cvt_pk_bf16_f32 v59,v158,v159
v_accvgpr_read_b32 v160,a100
v_accvgpr_read_b32 v161,a101
v_accvgpr_read_b32 v162,a102
v_accvgpr_read_b32 v163,a103
v_accvgpr_read_b32 v164,a116
v_accvgpr_read_b32 v165,a117
v_accvgpr_read_b32 v166,a118
v_accvgpr_read_b32 v167,a119
v_pk_mul_f32 v[160:161],v[160:161],v[194:195] op_sel_hi:[1,0]
v_pk_mul_f32 v[162:163],v[162:163],v[194:195] op_sel_hi:[1,0]
v_pk_mul_f32 v[164:165],v[164:165],v[194:195] op_sel_hi:[1,0]
v_pk_mul_f32 v[166:167],v[166:167],v[194:195] op_sel_hi:[1,0]
v_cvt_pk_bf16_f32 v60,v160,v161
v_cvt_pk_bf16_f32 v61,v162,v163
v_cvt_pk_bf16_f32 v62,v164,v165
v_cvt_pk_bf16_f32 v63,v166,v167
v_accvgpr_read_b32 v168,a104
v_accvgpr_read_b32 v169,a105
v_accvgpr_read_b32 v170,a106
v_accvgpr_read_b32 v171,a107
v_accvgpr_read_b32 v172,a120
v_accvgpr_read_b32 v173,a121
v_accvgpr_read_b32 v174,a122
v_accvgpr_read_b32 v175,a123
v_pk_mul_f32 v[168:169],v[168:169],v[196:197] op_sel_hi:[1,0]
v_pk_mul_f32 v[170:171],v[170:171],v[196:197] op_sel_hi:[1,0]
v_pk_mul_f32 v[172:173],v[172:173],v[196:197] op_sel_hi:[1,0]
v_pk_mul_f32 v[174:175],v[174:175],v[196:197] op_sel_hi:[1,0]
v_cvt_pk_bf16_f32 v64,v168,v169
v_cvt_pk_bf16_f32 v65,v170,v171
v_cvt_pk_bf16_f32 v66,v172,v173
v_cvt_pk_bf16_f32 v67,v174,v175
s_add_u32 s60,s62,4096
buffer_load_dwordx4 a[32:35],v248,s[20:23],s60 offen offset:1024
v_accvgpr_read_b32 v144,a128
v_accvgpr_read_b32 v145,a129
v_accvgpr_read_b32 v146,a130
v_accvgpr_read_b32 v147,a131
v_accvgpr_read_b32 v148,a144
v_accvgpr_read_b32 v149,a145
v_accvgpr_read_b32 v150,a146
v_accvgpr_read_b32 v151,a147
v_pk_mul_f32 v[144:145],v[144:145],v[192:193] op_sel_hi:[1,0]
v_pk_mul_f32 v[146:147],v[146:147],v[192:193] op_sel_hi:[1,0]
v_pk_mul_f32 v[148:149],v[148:149],v[192:193] op_sel_hi:[1,0]
v_pk_mul_f32 v[150:151],v[150:151],v[192:193] op_sel_hi:[1,0]
v_cvt_pk_bf16_f32 v68,v144,v145
v_cvt_pk_bf16_f32 v69,v146,v147
v_cvt_pk_bf16_f32 v70,v148,v149
v_cvt_pk_bf16_f32 v71,v150,v151
v_accvgpr_read_b32 v152,a132
v_accvgpr_read_b32 v153,a133
v_accvgpr_read_b32 v154,a134
v_accvgpr_read_b32 v155,a135
v_accvgpr_read_b32 v156,a148
v_accvgpr_read_b32 v157,a149
v_accvgpr_read_b32 v158,a150
v_accvgpr_read_b32 v159,a151
v_pk_mul_f32 v[152:153],v[152:153],v[194:195] op_sel_hi:[1,0]
v_pk_mul_f32 v[154:155],v[154:155],v[194:195] op_sel_hi:[1,0]
v_pk_mul_f32 v[156:157],v[156:157],v[194:195] op_sel_hi:[1,0]
v_pk_mul_f32 v[158:159],v[158:159],v[194:195] op_sel_hi:[1,0]
v_cvt_pk_bf16_f32 v72,v152,v153
v_cvt_pk_bf16_f32 v73,v154,v155
v_cvt_pk_bf16_f32 v74,v156,v157
v_cvt_pk_bf16_f32 v75,v158,v159
v_accvgpr_read_b32 v160,a136
v_accvgpr_read_b32 v161,a137
v_accvgpr_read_b32 v162,a138
v_accvgpr_read_b32 v163,a139
v_accvgpr_read_b32 v164,a152
v_accvgpr_read_b32 v165,a153
v_accvgpr_read_b32 v166,a154
v_accvgpr_read_b32 v167,a155
v_pk_mul_f32 v[160:161],v[160:161],v[196:197] op_sel_hi:[1,0]
v_pk_mul_f32 v[162:163],v[162:163],v[196:197] op_sel_hi:[1,0]
v_pk_mul_f32 v[164:165],v[164:165],v[196:197] op_sel_hi:[1,0]
v_pk_mul_f32 v[166:167],v[166:167],v[196:197] op_sel_hi:[1,0]
v_cvt_pk_bf16_f32 v76,v160,v161
v_cvt_pk_bf16_f32 v77,v162,v163
v_cvt_pk_bf16_f32 v78,v164,v165
v_cvt_pk_bf16_f32 v79,v166,v167
s_add_u32 s60,s63,4096
buffer_load_dwordx4 a[36:39],v248,s[20:23],s60 offen offset:1024
v_accvgpr_read_b32 v168,a160
v_accvgpr_read_b32 v169,a161
v_accvgpr_read_b32 v170,a162
v_accvgpr_read_b32 v171,a163
v_accvgpr_read_b32 v172,a176
v_accvgpr_read_b32 v173,a177
v_accvgpr_read_b32 v174,a178
v_accvgpr_read_b32 v175,a179
v_pk_mul_f32 v[168:169],v[168:169],v[192:193] op_sel_hi:[1,0]
v_pk_mul_f32 v[170:171],v[170:171],v[192:193] op_sel_hi:[1,0]
v_pk_mul_f32 v[172:173],v[172:173],v[192:193] op_sel_hi:[1,0]
v_pk_mul_f32 v[174:175],v[174:175],v[192:193] op_sel_hi:[1,0]
v_cvt_pk_bf16_f32 v80,v168,v169
v_cvt_pk_bf16_f32 v81,v170,v171
v_cvt_pk_bf16_f32 v82,v172,v173
v_cvt_pk_bf16_f32 v83,v174,v175
v_accvgpr_read_b32 v144,a164
v_accvgpr_read_b32 v145,a165
v_accvgpr_read_b32 v146,a166
v_accvgpr_read_b32 v147,a167
v_accvgpr_read_b32 v148,a180
v_accvgpr_read_b32 v149,a181
v_accvgpr_read_b32 v150,a182
v_accvgpr_read_b32 v151,a183
v_pk_mul_f32 v[144:145],v[144:145],v[194:195] op_sel_hi:[1,0]
v_pk_mul_f32 v[146:147],v[146:147],v[194:195] op_sel_hi:[1,0]
v_pk_mul_f32 v[148:149],v[148:149],v[194:195] op_sel_hi:[1,0]
v_pk_mul_f32 v[150:151],v[150:151],v[194:195] op_sel_hi:[1,0]
v_cvt_pk_bf16_f32 v84,v144,v145
v_cvt_pk_bf16_f32 v85,v146,v147
v_cvt_pk_bf16_f32 v86,v148,v149
v_cvt_pk_bf16_f32 v87,v150,v151
v_accvgpr_read_b32 v152,a168
v_accvgpr_read_b32 v153,a169
v_accvgpr_read_b32 v154,a170
v_accvgpr_read_b32 v155,a171
v_accvgpr_read_b32 v156,a184
v_accvgpr_read_b32 v157,a185
v_accvgpr_read_b32 v158,a186
v_accvgpr_read_b32 v159,a187
v_pk_mul_f32 v[152:153],v[152:153],v[196:197] op_sel_hi:[1,0]
v_pk_mul_f32 v[154:155],v[154:155],v[196:197] op_sel_hi:[1,0]
v_pk_mul_f32 v[156:157],v[156:157],v[196:197] op_sel_hi:[1,0]
v_pk_mul_f32 v[158:159],v[158:159],v[196:197] op_sel_hi:[1,0]
v_cvt_pk_bf16_f32 v88,v152,v153
v_cvt_pk_bf16_f32 v89,v154,v155
v_cvt_pk_bf16_f32 v90,v156,v157
v_cvt_pk_bf16_f32 v91,v158,v159
s_add_u32 s60,s64,4096
buffer_load_dwordx4 a[40:43],v248,s[20:23],s60 offen offset:1024
ds_read_b128 a[128:131],v251 offset:0
v_accvgpr_read_b32 v160,a192
v_accvgpr_read_b32 v161,a193
v_accvgpr_read_b32 v162,a194
v_accvgpr_read_b32 v163,a195
v_accvgpr_read_b32 v164,a208
v_accvgpr_read_b32 v165,a209
v_accvgpr_read_b32 v166,a210
v_accvgpr_read_b32 v167,a211
v_pk_mul_f32 v[160:161],v[160:161],v[192:193] op_sel_hi:[1,0]
v_pk_mul_f32 v[162:163],v[162:163],v[192:193] op_sel_hi:[1,0]
v_pk_mul_f32 v[164:165],v[164:165],v[192:193] op_sel_hi:[1,0]
v_pk_mul_f32 v[166:167],v[166:167],v[192:193] op_sel_hi:[1,0]
v_cvt_pk_bf16_f32 v92,v160,v161
v_cvt_pk_bf16_f32 v93,v162,v163
v_cvt_pk_bf16_f32 v94,v164,v165
v_cvt_pk_bf16_f32 v95,v166,v167
ds_read_b128 a[132:135],v251 offset:1024
v_accvgpr_read_b32 v168,a196
v_accvgpr_read_b32 v169,a197
v_accvgpr_read_b32 v170,a198
v_accvgpr_read_b32 v171,a199
v_accvgpr_read_b32 v172,a212
v_accvgpr_read_b32 v173,a213
v_accvgpr_read_b32 v174,a214
v_accvgpr_read_b32 v175,a215
v_pk_mul_f32 v[168:169],v[168:169],v[194:195] op_sel_hi:[1,0]
v_pk_mul_f32 v[170:171],v[170:171],v[194:195] op_sel_hi:[1,0]
v_pk_mul_f32 v[172:173],v[172:173],v[194:195] op_sel_hi:[1,0]
v_pk_mul_f32 v[174:175],v[174:175],v[194:195] op_sel_hi:[1,0]
v_cvt_pk_bf16_f32 v96,v168,v169
v_cvt_pk_bf16_f32 v97,v170,v171
v_cvt_pk_bf16_f32 v98,v172,v173
v_cvt_pk_bf16_f32 v99,v174,v175
ds_read_b128 a[136:139],v251 offset:2048
v_accvgpr_read_b32 v144,a200
v_accvgpr_read_b32 v145,a201
v_accvgpr_read_b32 v146,a202
v_accvgpr_read_b32 v147,a203
v_accvgpr_read_b32 v148,a216
v_accvgpr_read_b32 v149,a217
v_accvgpr_read_b32 v150,a218
v_accvgpr_read_b32 v151,a219
v_pk_mul_f32 v[144:145],v[144:145],v[196:197] op_sel_hi:[1,0]
v_pk_mul_f32 v[146:147],v[146:147],v[196:197] op_sel_hi:[1,0]
v_pk_mul_f32 v[148:149],v[148:149],v[196:197] op_sel_hi:[1,0]
v_pk_mul_f32 v[150:151],v[150:151],v[196:197] op_sel_hi:[1,0]
v_cvt_pk_bf16_f32 v100,v144,v145
v_cvt_pk_bf16_f32 v101,v146,v147
v_cvt_pk_bf16_f32 v102,v148,v149
v_cvt_pk_bf16_f32 v103,v150,v151
s_add_u32 s60,s62,4096
buffer_load_dwordx4 a[64:67],v248,s[20:23],s60 offen offset:2048
ds_read_b128 a[160:163],v251 offset:3072
v_accvgpr_read_b32 v152,a224
v_accvgpr_read_b32 v153,a225
v_accvgpr_read_b32 v154,a226
v_accvgpr_read_b32 v155,a227
v_accvgpr_read_b32 v156,a240
v_accvgpr_read_b32 v157,a241
v_accvgpr_read_b32 v158,a242
v_accvgpr_read_b32 v159,a243
v_pk_mul_f32 v[152:153],v[152:153],v[192:193] op_sel_hi:[1,0]
v_pk_mul_f32 v[154:155],v[154:155],v[192:193] op_sel_hi:[1,0]
v_pk_mul_f32 v[156:157],v[156:157],v[192:193] op_sel_hi:[1,0]
v_pk_mul_f32 v[158:159],v[158:159],v[192:193] op_sel_hi:[1,0]
v_cvt_pk_bf16_f32 v104,v152,v153
v_cvt_pk_bf16_f32 v105,v154,v155
v_cvt_pk_bf16_f32 v106,v156,v157
v_cvt_pk_bf16_f32 v107,v158,v159
ds_read_b128 a[164:167],v251 offset:4096
v_accvgpr_read_b32 v160,a228
v_accvgpr_read_b32 v161,a229
v_accvgpr_read_b32 v162,a230
v_accvgpr_read_b32 v163,a231
v_accvgpr_read_b32 v164,a244
v_accvgpr_read_b32 v165,a245
v_accvgpr_read_b32 v166,a246
v_accvgpr_read_b32 v167,a247
v_pk_mul_f32 v[160:161],v[160:161],v[194:195] op_sel_hi:[1,0]
v_pk_mul_f32 v[162:163],v[162:163],v[194:195] op_sel_hi:[1,0]
v_pk_mul_f32 v[164:165],v[164:165],v[194:195] op_sel_hi:[1,0]
v_pk_mul_f32 v[166:167],v[166:167],v[194:195] op_sel_hi:[1,0]
v_cvt_pk_bf16_f32 v108,v160,v161
v_cvt_pk_bf16_f32 v109,v162,v163
v_cvt_pk_bf16_f32 v110,v164,v165
v_cvt_pk_bf16_f32 v111,v166,v167
ds_read_b128 a[168:171],v251 offset:5120
v_accvgpr_read_b32 v168,a232
v_accvgpr_read_b32 v169,a233
v_accvgpr_read_b32 v170,a234
v_accvgpr_read_b32 v171,a235
v_accvgpr_read_b32 v172,a248
v_accvgpr_read_b32 v173,a249
v_accvgpr_read_b32 v174,a250
v_accvgpr_read_b32 v175,a251
v_pk_mul_f32 v[168:169],v[168:169],v[196:197] op_sel_hi:[1,0]
v_pk_mul_f32 v[170:171],v[170:171],v[196:197] op_sel_hi:[1,0]
v_pk_mul_f32 v[172:173],v[172:173],v[196:197] op_sel_hi:[1,0]
v_pk_mul_f32 v[174:175],v[174:175],v[196:197] op_sel_hi:[1,0]
v_cvt_pk_bf16_f32 v112,v168,v169
v_cvt_pk_bf16_f32 v113,v170,v171
v_cvt_pk_bf16_f32 v114,v172,v173
v_cvt_pk_bf16_f32 v115,v174,v175
s_add_u32 s60,s63,4096
buffer_load_dwordx4 a[68:71],v248,s[20:23],s60 offen offset:2048
ds_read_b128 a[192:195],v251 offset:6144
s_mov_b32 s36,3
s_mov_b32 s67,0
s_waitcnt lgkmcnt(11)
v_mfma_f32_16x16x32_bf16 a[16:19],v[208:211],v[20:23],0
ds_read_b64_tr_b16 v[224:225],v252 offset:25344
s_add_u32 s60,s64,4096
v_mfma_f32_16x16x32_bf16 a[20:23],v[208:211],v[24:27],0
ds_read_b64_tr_b16 v[226:227],v252 offset:25856
buffer_load_dwordx4 a[72:75],v248,s[20:23],s60 offen offset:2048
v_mfma_f32_16x16x32_bf16 a[24:27],v[208:211],v[28:31],0
ds_read_b64_tr_b16 v[228:229],v252 offset:25376
s_add_u32 s60,s62,4096
ds_read_b64_tr_b16 v[230:231],v252 offset:25888
v_mfma_f32_16x16x32_bf16 a[48:51],v[212:215],v[20:23],0
v_mfma_f32_16x16x32_bf16 a[52:55],v[212:215],v[24:27],0
v_mfma_f32_16x16x32_bf16 a[56:59],v[212:215],v[28:31],0
buffer_load_dwordx4 a[96:99],v248,s[20:23],s60 offen offset:3072
s_waitcnt lgkmcnt(11)
v_mfma_f32_16x16x32_bf16 a[16:19],v[216:219],v[32:35],a[16:19]
ds_read_b64_tr_b16 v[232:233],v252 offset:29568
s_add_u32 s60,s63,4096
v_mfma_f32_16x16x32_bf16 a[20:23],v[216:219],v[36:39],a[20:23]
ds_read_b64_tr_b16 v[234:235],v252 offset:30080
v_mfma_f32_16x16x32_bf16 a[24:27],v[216:219],v[40:43],a[24:27]
ds_read_b64_tr_b16 v[236:237],v252 offset:29600
ds_read_b64_tr_b16 v[238:239],v252 offset:30112
v_mfma_f32_16x16x32_bf16 a[48:51],v[220:223],v[32:35],a[48:51]
v_mfma_f32_16x16x32_bf16 a[52:55],v[220:223],v[36:39],a[52:55]
buffer_load_dwordx4 a[100:103],v248,s[20:23],s60 offen offset:3072
s_add_u32 s60,s64,4096
v_mfma_f32_16x16x32_bf16 a[56:59],v[220:223],v[40:43],a[56:59]
s_waitcnt lgkmcnt(4)
v_mfma_f32_16x16x32_bf16 a[16:19],v[224:227],v[44:47],a[16:19]
ds_read_b64_tr_b16 v[208:209],v252 offset:33792
v_mfma_f32_16x16x32_bf16 a[20:23],v[224:227],v[48:51],a[20:23]
ds_read_b64_tr_b16 v[210:211],v252 offset:34304
v_mfma_f32_16x16x32_bf16 a[24:27],v[224:227],v[52:55],a[24:27]
ds_read_b64_tr_b16 v[212:213],v252 offset:33824
ds_read_b64_tr_b16 v[214:215],v252 offset:34336
buffer_load_dwordx4 a[104:107],v248,s[20:23],s60 offen offset:3072
v_mfma_f32_16x16x32_bf16 a[48:51],v[228:231],v[44:47],a[48:51]
v_mfma_f32_16x16x32_bf16 a[52:55],v[228:231],v[48:51],a[52:55]
v_mfma_f32_16x16x32_bf16 a[56:59],v[228:231],v[52:55],a[56:59]
s_waitcnt lgkmcnt(4)
v_mfma_f32_16x16x32_bf16 a[16:19],v[232:235],v[56:59],a[16:19]
ds_read_b64_tr_b16 v[216:217],v252 offset:38016
v_mfma_f32_16x16x32_bf16 a[20:23],v[232:235],v[60:63],a[20:23]
ds_read_b64_tr_b16 v[218:219],v252 offset:38528
v_mfma_f32_16x16x32_bf16 a[24:27],v[232:235],v[64:67],a[24:27]
ds_read_b64_tr_b16 v[220:221],v252 offset:38048
ds_read_b64_tr_b16 v[222:223],v252 offset:38560
v_mfma_f32_16x16x32_bf16 a[48:51],v[236:239],v[56:59],a[48:51]
v_mfma_f32_16x16x32_bf16 a[52:55],v[236:239],v[60:63],a[52:55]
v_mfma_f32_16x16x32_bf16 a[56:59],v[236:239],v[64:67],a[56:59]
s_waitcnt lgkmcnt(4)
v_mfma_f32_16x16x32_bf16 a[16:19],v[208:211],v[68:71],a[16:19]
ds_read_b64_tr_b16 v[224:225],v252 offset:42240
v_mfma_f32_16x16x32_bf16 a[20:23],v[208:211],v[72:75],a[20:23]
ds_read_b64_tr_b16 v[226:227],v252 offset:42752
v_mfma_f32_16x16x32_bf16 a[24:27],v[208:211],v[76:79],a[24:27]
ds_read_b64_tr_b16 v[228:229],v252 offset:42272
ds_read_b64_tr_b16 v[230:231],v252 offset:42784
v_mfma_f32_16x16x32_bf16 a[48:51],v[212:215],v[68:71],a[48:51]
v_mfma_f32_16x16x32_bf16 a[52:55],v[212:215],v[72:75],a[52:55]
v_mfma_f32_16x16x32_bf16 a[56:59],v[212:215],v[76:79],a[56:59]
s_waitcnt lgkmcnt(4)
v_mfma_f32_16x16x32_bf16 a[16:19],v[216:219],v[80:83],a[16:19]
ds_read_b64_tr_b16 v[232:233],v252 offset:46464
v_mfma_f32_16x16x32_bf16 a[20:23],v[216:219],v[84:87],a[20:23]
ds_read_b64_tr_b16 v[234:235],v252 offset:46976
v_mfma_f32_16x16x32_bf16 a[24:27],v[216:219],v[88:91],a[24:27]
ds_read_b64_tr_b16 v[236:237],v252 offset:46496
ds_read_b64_tr_b16 v[238:239],v252 offset:47008
v_mfma_f32_16x16x32_bf16 a[48:51],v[220:223],v[80:83],a[48:51]
v_mfma_f32_16x16x32_bf16 a[52:55],v[220:223],v[84:87],a[52:55]
v_mfma_f32_16x16x32_bf16 a[56:59],v[220:223],v[88:91],a[56:59]
s_waitcnt lgkmcnt(4)
v_mfma_f32_16x16x32_bf16 a[16:19],v[224:227],v[92:95],a[16:19]
ds_read_b64_tr_b16 v[208:209],v255 offset:16896
v_mfma_f32_16x16x32_bf16 a[20:23],v[224:227],v[96:99],a[20:23]
ds_read_b64_tr_b16 v[210:211],v255 offset:17408
v_mfma_f32_16x16x32_bf16 a[24:27],v[224:227],v[100:103],a[24:27]
ds_read_b64_tr_b16 v[212:213],v255 offset:16928
ds_read_b64_tr_b16 v[214:215],v255 offset:17440
v_mfma_f32_16x16x32_bf16 a[48:51],v[228:231],v[92:95],a[48:51]
v_mfma_f32_16x16x32_bf16 a[52:55],v[228:231],v[96:99],a[52:55]
v_mfma_f32_16x16x32_bf16 a[56:59],v[228:231],v[100:103],a[56:59]
s_waitcnt lgkmcnt(4)
v_mfma_f32_16x16x32_bf16 a[16:19],v[232:235],v[104:107],a[16:19]
ds_read_b64_tr_b16 v[216:217],v255 offset:21120
v_mfma_f32_16x16x32_bf16 a[20:23],v[232:235],v[108:111],a[20:23]
ds_read_b64_tr_b16 v[218:219],v255 offset:21632
v_mfma_f32_16x16x32_bf16 a[24:27],v[232:235],v[112:115],a[24:27]
ds_read_b64_tr_b16 v[220:221],v255 offset:21152
ds_read_b64_tr_b16 v[222:223],v255 offset:21664
v_mfma_f32_16x16x32_bf16 a[48:51],v[236:239],v[104:107],a[48:51]
v_mfma_f32_16x16x32_bf16 a[52:55],v[236:239],v[108:111],a[52:55]
v_mfma_f32_16x16x32_bf16 a[56:59],v[236:239],v[112:115],a[56:59]
s_waitcnt vmcnt(29) lgkmcnt(4)
v_mfma_f32_16x16x32_bf16 a[16:19],v[208:211],v[0:3],a[16:19]
ds_read_b64_tr_b16 v[224:225],v255 offset:25344
v_mfma_f32_16x16x32_bf16 a[20:23],v[208:211],a[160:163],a[20:23]
ds_read_b64_tr_b16 v[226:227],v255 offset:25856
v_mfma_f32_16x16x32_bf16 a[24:27],v[208:211],a[164:167],a[24:27]
ds_read_b64_tr_b16 v[228:229],v255 offset:25376
ds_read_b64_tr_b16 v[230:231],v255 offset:25888
v_mfma_f32_16x16x32_bf16 a[48:51],v[212:215],v[0:3],a[48:51]
v_mfma_f32_16x16x32_bf16 a[52:55],v[212:215],a[160:163],a[52:55]
v_mfma_f32_16x16x32_bf16 a[56:59],v[212:215],a[164:167],a[56:59]
s_waitcnt vmcnt(20) lgkmcnt(4)
v_mfma_f32_16x16x32_bf16 a[16:19],v[216:219],v[4:7],a[16:19]
ds_read_b64_tr_b16 v[232:233],v255 offset:29568
v_mfma_f32_16x16x32_bf16 a[20:23],v[216:219],a[168:171],a[20:23]
ds_read_b64_tr_b16 v[234:235],v255 offset:30080
v_mfma_f32_16x16x32_bf16 a[24:27],v[216:219],a[192:195],a[24:27]
ds_read_b64_tr_b16 v[236:237],v255 offset:29600
ds_read_b64_tr_b16 v[238:239],v255 offset:30112
v_mfma_f32_16x16x32_bf16 a[48:51],v[220:223],v[4:7],a[48:51]
v_mfma_f32_16x16x32_bf16 a[52:55],v[220:223],a[168:171],a[52:55]
v_mfma_f32_16x16x32_bf16 a[56:59],v[220:223],a[192:195],a[56:59]
s_waitcnt vmcnt(63) lgkmcnt(4)
v_mfma_f32_16x16x32_bf16 a[16:19],v[224:227],a[128:131],a[16:19]
ds_read_b64_tr_b16 v[208:209],v255 offset:0
v_mfma_f32_16x16x32_bf16 a[20:23],v[224:227],a[132:135],a[20:23]
ds_read_b64_tr_b16 v[210:211],v255 offset:512
v_mfma_f32_16x16x32_bf16 a[24:27],v[224:227],a[136:139],a[24:27]
ds_read_b64_tr_b16 v[212:213],v255 offset:32
ds_read_b64_tr_b16 v[214:215],v255 offset:544
v_mfma_f32_16x16x32_bf16 a[48:51],v[228:231],a[128:131],a[48:51]
v_mfma_f32_16x16x32_bf16 a[52:55],v[228:231],a[132:135],a[52:55]
v_mfma_f32_16x16x32_bf16 a[56:59],v[228:231],a[136:139],a[56:59]
s_waitcnt vmcnt(15) lgkmcnt(4)
v_mfma_f32_16x16x32_bf16 a[16:19],v[232:235],v[8:11],a[16:19]
ds_read_b64_tr_b16 v[216:217],v255 offset:4224
v_mfma_f32_16x16x32_bf16 a[20:23],v[232:235],v[12:15],a[20:23]
ds_read_b64_tr_b16 v[218:219],v255 offset:4736
v_mfma_f32_16x16x32_bf16 a[24:27],v[232:235],v[16:19],a[24:27]
ds_read_b64_tr_b16 v[220:221],v255 offset:4256
ds_read_b64_tr_b16 v[222:223],v255 offset:4768
v_mfma_f32_16x16x32_bf16 a[48:51],v[236:239],v[8:11],a[48:51]
v_mfma_f32_16x16x32_bf16 a[52:55],v[236:239],v[12:15],a[52:55]
v_mfma_f32_16x16x32_bf16 a[56:59],v[236:239],v[16:19],a[56:59]
s_waitcnt vmcnt(9) lgkmcnt(4)
v_mfma_f32_16x16x32_bf16 a[16:19],v[208:211],a[0:3],a[16:19]
ds_read_b64_tr_b16 v[224:225],v255 offset:8448
v_mfma_f32_16x16x32_bf16 a[20:23],v[208:211],a[4:7],a[20:23]
ds_read_b64_tr_b16 v[226:227],v255 offset:8960
v_mfma_f32_16x16x32_bf16 a[24:27],v[208:211],a[8:11],a[24:27]
ds_read_b64_tr_b16 v[228:229],v255 offset:8480
ds_read_b64_tr_b16 v[230:231],v255 offset:8992
v_mfma_f32_16x16x32_bf16 a[48:51],v[212:215],a[0:3],a[48:51]
v_mfma_f32_16x16x32_bf16 a[52:55],v[212:215],a[4:7],a[52:55]
v_mfma_f32_16x16x32_bf16 a[56:59],v[212:215],a[8:11],a[56:59]
s_waitcnt vmcnt(6) lgkmcnt(4)
v_mfma_f32_16x16x32_bf16 a[16:19],v[216:219],a[32:35],a[16:19]
ds_read_b64_tr_b16 v[232:233],v255 offset:12672
v_mfma_f32_16x16x32_bf16 a[20:23],v[216:219],a[36:39],a[20:23]
ds_read_b64_tr_b16 v[234:235],v255 offset:13184
v_mfma_f32_16x16x32_bf16 a[24:27],v[216:219],a[40:43],a[24:27]
ds_read_b64_tr_b16 v[236:237],v255 offset:12704
ds_read_b64_tr_b16 v[238:239],v255 offset:13216
v_mfma_f32_16x16x32_bf16 a[48:51],v[220:223],a[32:35],a[48:51]
v_mfma_f32_16x16x32_bf16 a[52:55],v[220:223],a[36:39],a[52:55]
v_mfma_f32_16x16x32_bf16 a[56:59],v[220:223],a[40:43],a[56:59]
s_waitcnt vmcnt(3) lgkmcnt(4)
v_mfma_f32_16x16x32_bf16 a[16:19],v[224:227],a[64:67],a[16:19]
ds_read_b64_tr_b16 v[208:209],v252 offset:16960
v_mfma_f32_16x16x32_bf16 a[20:23],v[224:227],a[68:71],a[20:23]
ds_read_b64_tr_b16 v[210:211],v252 offset:17472
v_mfma_f32_16x16x32_bf16 a[24:27],v[224:227],a[72:75],a[24:27]
ds_read_b64_tr_b16 v[212:213],v252 offset:16992
ds_read_b64_tr_b16 v[214:215],v252 offset:17504
v_mfma_f32_16x16x32_bf16 a[48:51],v[228:231],a[64:67],a[48:51]
v_mfma_f32_16x16x32_bf16 a[52:55],v[228:231],a[68:71],a[52:55]
v_mfma_f32_16x16x32_bf16 a[56:59],v[228:231],a[72:75],a[56:59]
s_waitcnt vmcnt(0) lgkmcnt(4)
v_mfma_f32_16x16x32_bf16 a[16:19],v[232:235],a[96:99],a[16:19]
ds_read_b64_tr_b16 v[216:217],v252 offset:21184
v_mfma_f32_16x16x32_bf16 a[20:23],v[232:235],a[100:103],a[20:23]
ds_read_b64_tr_b16 v[218:219],v252 offset:21696
v_mfma_f32_16x16x32_bf16 a[24:27],v[232:235],a[104:107],a[24:27]
ds_read_b64_tr_b16 v[220:221],v252 offset:21216
ds_read_b64_tr_b16 v[222:223],v252 offset:21728
v_mfma_f32_16x16x32_bf16 a[48:51],v[236:239],a[96:99],a[48:51]
v_mfma_f32_16x16x32_bf16 a[52:55],v[236:239],a[100:103],a[52:55]
v_mfma_f32_16x16x32_bf16 a[56:59],v[236:239],a[104:107],a[56:59]
s_waitcnt lgkmcnt(4)
v_mfma_f32_16x16x32_bf16 a[80:83],v[208:211],v[20:23],0
ds_read_b64_tr_b16 v[224:225],v252 offset:25408
v_mfma_f32_16x16x32_bf16 a[84:87],v[208:211],v[24:27],0
ds_read_b64_tr_b16 v[226:227],v252 offset:25920
v_mfma_f32_16x16x32_bf16 a[88:91],v[208:211],v[28:31],0
ds_read_b64_tr_b16 v[228:229],v252 offset:25440
ds_read_b64_tr_b16 v[230:231],v252 offset:25952
v_mfma_f32_16x16x32_bf16 a[112:115],v[212:215],v[20:23],0
v_mov_b32 v164,v156
v_mov_b32 v165,v157
v_mfma_f32_16x16x32_bf16 a[116:119],v[212:215],v[24:27],0
v_mov_b32 v166,v158
v_mov_b32 v167,v159
v_mfma_f32_16x16x32_bf16 a[120:123],v[212:215],v[28:31],0
v_accvgpr_read_b32 v128,a16
v_accvgpr_read_b32 v129,a17
v_accvgpr_read_b32 v130,a18
s_waitcnt lgkmcnt(4)
v_mfma_f32_16x16x32_bf16 a[80:83],v[216:219],v[32:35],a[80:83]
ds_read_b64_tr_b16 v[232:233],v252 offset:29632
v_accvgpr_read_b32 v131,a19
v_mfma_f32_16x16x32_bf16 a[84:87],v[216:219],v[36:39],a[84:87]
ds_read_b64_tr_b16 v[234:235],v252 offset:30144
v_accvgpr_read_b32 v132,a48
v_mfma_f32_16x16x32_bf16 a[88:91],v[216:219],v[40:43],a[88:91]
ds_read_b64_tr_b16 v[236:237],v252 offset:29664
v_accvgpr_read_b32 v133,a49
ds_read_b64_tr_b16 v[238:239],v252 offset:30176
v_accvgpr_read_b32 v134,a50
v_mfma_f32_16x16x32_bf16 a[112:115],v[220:223],v[32:35],a[112:115]
v_accvgpr_read_b32 v135,a51
v_cvt_pk_bf16_f32 v156,v128,v129
v_mfma_f32_16x16x32_bf16 a[116:119],v[220:223],v[36:39],a[116:119]
v_cvt_pk_bf16_f32 v157,v130,v131
v_cvt_pk_bf16_f32 v158,v132,v133
v_mfma_f32_16x16x32_bf16 a[120:123],v[220:223],v[40:43],a[120:123]
v_cvt_pk_bf16_f32 v159,v134,v135
buffer_store_dwordx4 v[156:159],v249,s[20:23],s66 offen sc1
v_accvgpr_read_b32 v128,a20
s_waitcnt lgkmcnt(4)
v_mfma_f32_16x16x32_bf16 a[80:83],v[224:227],v[44:47],a[80:83]
ds_read_b64_tr_b16 v[208:209],v252 offset:33856
v_accvgpr_read_b32 v129,a21
v_mfma_f32_16x16x32_bf16 a[84:87],v[224:227],v[48:51],a[84:87]
ds_read_b64_tr_b16 v[210:211],v252 offset:34368
v_accvgpr_read_b32 v130,a22
v_mfma_f32_16x16x32_bf16 a[88:91],v[224:227],v[52:55],a[88:91]
ds_read_b64_tr_b16 v[212:213],v252 offset:33888
v_accvgpr_read_b32 v131,a23
ds_read_b64_tr_b16 v[214:215],v252 offset:34400
v_accvgpr_read_b32 v132,a52
v_mfma_f32_16x16x32_bf16 a[112:115],v[228:231],v[44:47],a[112:115]
v_accvgpr_read_b32 v133,a53
v_accvgpr_read_b32 v134,a54
v_mfma_f32_16x16x32_bf16 a[116:119],v[228:231],v[48:51],a[116:119]
v_accvgpr_read_b32 v135,a55
v_cvt_pk_bf16_f32 v148,v128,v129
v_mfma_f32_16x16x32_bf16 a[120:123],v[228:231],v[52:55],a[120:123]
v_cvt_pk_bf16_f32 v149,v130,v131
v_cvt_pk_bf16_f32 v150,v132,v133
v_cvt_pk_bf16_f32 v151,v134,v135
s_waitcnt lgkmcnt(4)
v_mfma_f32_16x16x32_bf16 a[80:83],v[232:235],v[56:59],a[80:83]
ds_read_b64_tr_b16 v[216:217],v252 offset:38080
v_mfma_f32_16x16x32_bf16 a[84:87],v[232:235],v[60:63],a[84:87]
ds_read_b64_tr_b16 v[218:219],v252 offset:38592
v_mfma_f32_16x16x32_bf16 a[88:91],v[232:235],v[64:67],a[88:91]
ds_read_b64_tr_b16 v[220:221],v252 offset:38112
ds_read_b64_tr_b16 v[222:223],v252 offset:38624
v_mfma_f32_16x16x32_bf16 a[112:115],v[236:239],v[56:59],a[112:115]
v_mfma_f32_16x16x32_bf16 a[116:119],v[236:239],v[60:63],a[116:119]
v_mfma_f32_16x16x32_bf16 a[120:123],v[236:239],v[64:67],a[120:123]
s_waitcnt lgkmcnt(4)
v_mfma_f32_16x16x32_bf16 a[80:83],v[208:211],v[68:71],a[80:83]
ds_read_b64_tr_b16 v[224:225],v252 offset:42304
v_mfma_f32_16x16x32_bf16 a[84:87],v[208:211],v[72:75],a[84:87]
ds_read_b64_tr_b16 v[226:227],v252 offset:42816
v_mfma_f32_16x16x32_bf16 a[88:91],v[208:211],v[76:79],a[88:91]
ds_read_b64_tr_b16 v[228:229],v252 offset:42336
buffer_store_dwordx4 v[148:151],v249,s[20:23],s63 offen sc1
ds_read_b64_tr_b16 v[230:231],v252 offset:42848
v_accvgpr_read_b32 v128,a24
v_mfma_f32_16x16x32_bf16 a[112:115],v[212:215],v[68:71],a[112:115]
v_accvgpr_read_b32 v129,a25
v_accvgpr_read_b32 v130,a26
v_mfma_f32_16x16x32_bf16 a[116:119],v[212:215],v[72:75],a[116:119]
v_accvgpr_read_b32 v131,a27
v_accvgpr_read_b32 v132,a56
v_mfma_f32_16x16x32_bf16 a[120:123],v[212:215],v[76:79],a[120:123]
v_accvgpr_read_b32 v133,a57
v_accvgpr_read_b32 v134,a58
v_accvgpr_read_b32 v135,a59
s_waitcnt lgkmcnt(4)
v_mfma_f32_16x16x32_bf16 a[80:83],v[216:219],v[80:83],a[80:83]
ds_read_b64_tr_b16 v[232:233],v252 offset:46528
v_cvt_pk_bf16_f32 v144,v128,v129
v_mfma_f32_16x16x32_bf16 a[84:87],v[216:219],v[84:87],a[84:87]
ds_read_b64_tr_b16 v[234:235],v252 offset:47040
v_cvt_pk_bf16_f32 v145,v130,v131
v_mfma_f32_16x16x32_bf16 a[88:91],v[216:219],v[88:91],a[88:91]
ds_read_b64_tr_b16 v[236:237],v252 offset:46560
v_cvt_pk_bf16_f32 v146,v132,v133
ds_read_b64_tr_b16 v[238:239],v252 offset:47072
v_cvt_pk_bf16_f32 v147,v134,v135
v_mfma_f32_16x16x32_bf16 a[112:115],v[220:223],v[80:83],a[112:115]
v_mfma_f32_16x16x32_bf16 a[116:119],v[220:223],v[84:87],a[116:119]
v_mfma_f32_16x16x32_bf16 a[120:123],v[220:223],v[88:91],a[120:123]
s_waitcnt lgkmcnt(4)
v_mfma_f32_16x16x32_bf16 a[80:83],v[224:227],v[92:95],a[80:83]
ds_read_b64_tr_b16 v[208:209],v255 offset:16960
v_mfma_f32_16x16x32_bf16 a[84:87],v[224:227],v[96:99],a[84:87]
ds_read_b64_tr_b16 v[210:211],v255 offset:17472
v_mfma_f32_16x16x32_bf16 a[88:91],v[224:227],v[100:103],a[88:91]
ds_read_b64_tr_b16 v[212:213],v255 offset:16992
ds_read_b64_tr_b16 v[214:215],v255 offset:17504
v_mfma_f32_16x16x32_bf16 a[112:115],v[228:231],v[92:95],a[112:115]
v_mfma_f32_16x16x32_bf16 a[116:119],v[228:231],v[96:99],a[116:119]
v_mfma_f32_16x16x32_bf16 a[120:123],v[228:231],v[100:103],a[120:123]
buffer_store_dwordx4 v[144:147],v249,s[20:23],s64 offen sc1
s_waitcnt lgkmcnt(4)
v_mfma_f32_16x16x32_bf16 a[80:83],v[232:235],v[104:107],a[80:83]
ds_read_b64_tr_b16 v[216:217],v255 offset:21184
v_mfma_f32_16x16x32_bf16 a[84:87],v[232:235],v[108:111],a[84:87]
ds_read_b64_tr_b16 v[218:219],v255 offset:21696
v_mfma_f32_16x16x32_bf16 a[88:91],v[232:235],v[112:115],a[88:91]
ds_read_b64_tr_b16 v[220:221],v255 offset:21216
ds_read_b64_tr_b16 v[222:223],v255 offset:21728
v_mfma_f32_16x16x32_bf16 a[112:115],v[236:239],v[104:107],a[112:115]
v_mfma_f32_16x16x32_bf16 a[116:119],v[236:239],v[108:111],a[116:119]
v_mfma_f32_16x16x32_bf16 a[120:123],v[236:239],v[112:115],a[120:123]
s_waitcnt lgkmcnt(4)
v_mfma_f32_16x16x32_bf16 a[80:83],v[208:211],v[0:3],a[80:83]
ds_read_b64_tr_b16 v[224:225],v255 offset:25408
v_mfma_f32_16x16x32_bf16 a[84:87],v[208:211],a[160:163],a[84:87]
ds_read_b64_tr_b16 v[226:227],v255 offset:25920
v_mfma_f32_16x16x32_bf16 a[88:91],v[208:211],a[164:167],a[88:91]
ds_read_b64_tr_b16 v[228:229],v255 offset:25440
ds_read_b64_tr_b16 v[230:231],v255 offset:25952
v_mfma_f32_16x16x32_bf16 a[112:115],v[212:215],v[0:3],a[112:115]
v_mfma_f32_16x16x32_bf16 a[116:119],v[212:215],a[160:163],a[116:119]
v_mfma_f32_16x16x32_bf16 a[120:123],v[212:215],a[164:167],a[120:123]
s_waitcnt lgkmcnt(4)
v_mfma_f32_16x16x32_bf16 a[80:83],v[216:219],v[4:7],a[80:83]
ds_read_b64_tr_b16 v[232:233],v255 offset:29632
v_mfma_f32_16x16x32_bf16 a[84:87],v[216:219],a[168:171],a[84:87]
ds_read_b64_tr_b16 v[234:235],v255 offset:30144
v_mfma_f32_16x16x32_bf16 a[88:91],v[216:219],a[192:195],a[88:91]
ds_read_b64_tr_b16 v[236:237],v255 offset:29664
ds_read_b64_tr_b16 v[238:239],v255 offset:30176
v_mfma_f32_16x16x32_bf16 a[112:115],v[220:223],v[4:7],a[112:115]
v_mfma_f32_16x16x32_bf16 a[116:119],v[220:223],a[168:171],a[116:119]
v_mfma_f32_16x16x32_bf16 a[120:123],v[220:223],a[192:195],a[120:123]
s_waitcnt lgkmcnt(4)
v_mfma_f32_16x16x32_bf16 a[80:83],v[224:227],a[128:131],a[80:83]
ds_read_b64_tr_b16 v[208:209],v255 offset:64
v_mfma_f32_16x16x32_bf16 a[84:87],v[224:227],a[132:135],a[84:87]
ds_read_b64_tr_b16 v[210:211],v255 offset:576
v_mfma_f32_16x16x32_bf16 a[88:91],v[224:227],a[136:139],a[88:91]
ds_read_b64_tr_b16 v[212:213],v255 offset:96
ds_read_b64_tr_b16 v[214:215],v255 offset:608
v_mfma_f32_16x16x32_bf16 a[112:115],v[228:231],a[128:131],a[112:115]
v_mfma_f32_16x16x32_bf16 a[116:119],v[228:231],a[132:135],a[116:119]
v_mfma_f32_16x16x32_bf16 a[120:123],v[228:231],a[136:139],a[120:123]
s_waitcnt lgkmcnt(4)
v_mfma_f32_16x16x32_bf16 a[80:83],v[232:235],v[8:11],a[80:83]
ds_read_b64_tr_b16 v[216:217],v255 offset:4288
v_mfma_f32_16x16x32_bf16 a[84:87],v[232:235],v[12:15],a[84:87]
ds_read_b64_tr_b16 v[218:219],v255 offset:4800
v_mfma_f32_16x16x32_bf16 a[88:91],v[232:235],v[16:19],a[88:91]
ds_read_b64_tr_b16 v[220:221],v255 offset:4320
ds_read_b64_tr_b16 v[222:223],v255 offset:4832
v_mfma_f32_16x16x32_bf16 a[112:115],v[236:239],v[8:11],a[112:115]
v_mfma_f32_16x16x32_bf16 a[116:119],v[236:239],v[12:15],a[116:119]
v_mfma_f32_16x16x32_bf16 a[120:123],v[236:239],v[16:19],a[120:123]
s_waitcnt lgkmcnt(4)
v_mfma_f32_16x16x32_bf16 a[80:83],v[208:211],a[0:3],a[80:83]
ds_read_b64_tr_b16 v[224:225],v255 offset:8512
v_mfma_f32_16x16x32_bf16 a[84:87],v[208:211],a[4:7],a[84:87]
ds_read_b64_tr_b16 v[226:227],v255 offset:9024
v_mfma_f32_16x16x32_bf16 a[88:91],v[208:211],a[8:11],a[88:91]
ds_read_b64_tr_b16 v[228:229],v255 offset:8544
ds_read_b64_tr_b16 v[230:231],v255 offset:9056
v_mfma_f32_16x16x32_bf16 a[112:115],v[212:215],a[0:3],a[112:115]
v_mfma_f32_16x16x32_bf16 a[116:119],v[212:215],a[4:7],a[116:119]
v_mfma_f32_16x16x32_bf16 a[120:123],v[212:215],a[8:11],a[120:123]
s_waitcnt lgkmcnt(4)
v_mfma_f32_16x16x32_bf16 a[80:83],v[216:219],a[32:35],a[80:83]
ds_read_b64_tr_b16 v[232:233],v255 offset:12736
v_mfma_f32_16x16x32_bf16 a[84:87],v[216:219],a[36:39],a[84:87]
ds_read_b64_tr_b16 v[234:235],v255 offset:13248
v_mfma_f32_16x16x32_bf16 a[88:91],v[216:219],a[40:43],a[88:91]
ds_read_b64_tr_b16 v[236:237],v255 offset:12768
ds_read_b64_tr_b16 v[238:239],v255 offset:13280
v_mfma_f32_16x16x32_bf16 a[112:115],v[220:223],a[32:35],a[112:115]
v_mfma_f32_16x16x32_bf16 a[116:119],v[220:223],a[36:39],a[116:119]
v_mfma_f32_16x16x32_bf16 a[120:123],v[220:223],a[40:43],a[120:123]
s_waitcnt lgkmcnt(4)
v_mfma_f32_16x16x32_bf16 a[80:83],v[224:227],a[64:67],a[80:83]
v_mfma_f32_16x16x32_bf16 a[84:87],v[224:227],a[68:71],a[84:87]
s_waitcnt vmcnt(63) lgkmcnt(0)
s_barrier
v_mfma_f32_16x16x32_bf16 a[88:91],v[224:227],a[72:75],a[88:91]
ds_read_b64_tr_b16 v[208:209],v255 offset:33792
buffer_atomic_add v141,v248,s[0:3],0 offen sc1
ds_read_b64_tr_b16 v[210:211],v255 offset:34304
v_mfma_f32_16x16x32_bf16 a[112:115],v[228:231],a[64:67],a[112:115]
ds_read_b64_tr_b16 v[212:213],v255 offset:33824
v_mfma_f32_16x16x32_bf16 a[116:119],v[228:231],a[68:71],a[116:119]
ds_read_b64_tr_b16 v[214:215],v255 offset:34336
v_mfma_f32_16x16x32_bf16 a[120:123],v[228:231],a[72:75],a[120:123]
v_mfma_f32_16x16x32_bf16 a[80:83],v[232:235],a[96:99],a[80:83]
ds_read_b64_tr_b16 v[216:217],v255 offset:38016
v_mfma_f32_16x16x32_bf16 a[84:87],v[232:235],a[100:103],a[84:87]
ds_read_b64_tr_b16 v[218:219],v255 offset:38528
v_mfma_f32_16x16x32_bf16 a[88:91],v[232:235],a[104:107],a[88:91]
ds_read_b64_tr_b16 v[220:221],v255 offset:38048
ds_read_b64_tr_b16 v[222:223],v255 offset:38560
v_mfma_f32_16x16x32_bf16 a[112:115],v[236:239],a[96:99],a[112:115]
v_mfma_f32_16x16x32_bf16 a[116:119],v[236:239],a[100:103],a[116:119]
v_mfma_f32_16x16x32_bf16 a[120:123],v[236:239],a[104:107],a[120:123]
s_waitcnt lgkmcnt(4)
.p2alignl 6, 0xbf800000
M_ploop:
v_mfma_f32_16x16x32_bf16 a[16:19],v[208:211],v[20:23],0
ds_read_b64_tr_b16 v[224:225],v255 offset:42240
v_mfma_f32_16x16x32_bf16 a[20:23],v[208:211],v[24:27],0
ds_read_b64_tr_b16 v[226:227],v255 offset:42752
v_mfma_f32_16x16x32_bf16 a[24:27],v[208:211],v[28:31],0
ds_read_b64_tr_b16 v[228:229],v255 offset:42272
ds_read_b64_tr_b16 v[230:231],v255 offset:42784
s_cmp_lg_u32 s36,3
s_cselect_b32 s58,s68,0
s_and_b32 s10,s58,26944
v_mfma_f32_16x16x32_bf16 a[48:51],v[212:215],v[20:23],0
s_add_u32 m0,s29,16896
v_accvgpr_read_b32 v128,a80
v_mfma_f32_16x16x32_bf16 a[52:55],v[212:215],v[24:27],0
buffer_load_dwordx4 v254,s[16:19],s32 offen offset:0 lds
s_add_u32 m0,m0,0x000000a0
v_mfma_f32_16x16x32_bf16 a[56:59],v[212:215],v[28:31],0
v_accvgpr_read_b32 v129,a81
v_accvgpr_read_b32 v130,a82
v_accvgpr_read_b32 v131,a83
s_waitcnt lgkmcnt(4)
v_mfma_f32_16x16x32_bf16 a[16:19],v[216:219],v[32:35],a[16:19]
ds_read_b64_tr_b16 v[232:233],v255 offset:46464
v_accvgpr_read_b32 v132,a112
v_mfma_f32_16x16x32_bf16 a[20:23],v[216:219],v[36:39],a[20:23]
ds_read_b64_tr_b16 v[234:235],v255 offset:46976
buffer_load_dwordx4 v254,s[16:19],s32 offen offset:896 lds
v_mfma_f32_16x16x32_bf16 a[24:27],v[216:219],v[40:43],a[24:27]
ds_read_b64_tr_b16 v[236:237],v255 offset:46496
s_add_u32 m0,m0,0x000000a0
ds_read_b64_tr_b16 v[238:239],v255 offset:47008
v_accvgpr_read_b32 v133,a113
v_mfma_f32_16x16x32_bf16 a[48:51],v[220:223],v[32:35],a[48:51]
v_accvgpr_read_b32 v134,a114
v_accvgpr_read_b32 v135,a115
v_mfma_f32_16x16x32_bf16 a[52:55],v[220:223],v[36:39],a[52:55]
v_cvt_pk_bf16_f32 v144,v128,v129
v_cvt_pk_bf16_f32 v145,v130,v131
v_mfma_f32_16x16x32_bf16 a[56:59],v[220:223],v[40:43],a[56:59]
v_cvt_pk_bf16_f32 v146,v132,v133
v_cvt_pk_bf16_f32 v147,v134,v135
buffer_load_dwordx4 v254,s[16:19],s32 offen offset:1792 lds
s_waitcnt lgkmcnt(4)
v_mfma_f32_16x16x32_bf16 a[16:19],v[224:227],v[44:47],a[16:19]
ds_read_b64_tr_b16 v[208:209],v252 offset:0
s_add_u32 m0,m0,0x000000a0
v_mfma_f32_16x16x32_bf16 a[20:23],v[224:227],v[48:51],a[20:23]
ds_read_b64_tr_b16 v[210:211],v252 offset:512
v_lshlrev_b32 v240,16,v164
v_mfma_f32_16x16x32_bf16 a[24:27],v[224:227],v[52:55],a[24:27]
ds_read_b64_tr_b16 v[212:213],v252 offset:32
buffer_store_dwordx4 v[144:147],v250,s[20:23],s62 offen sc1
ds_read_b64_tr_b16 v[214:215],v252 offset:544
v_accvgpr_read_b32 v128,a84
v_mfma_f32_16x16x32_bf16 a[48:51],v[228:231],v[44:47],a[48:51]
v_accvgpr_read_b32 v129,a85
v_accvgpr_read_b32 v130,a86
v_mfma_f32_16x16x32_bf16 a[52:55],v[228:231],v[48:51],a[52:55]
buffer_load_dwordx4 v254,s[16:19],s32 offen offset:2688 lds
s_add_u32 s32,s32,0x0001c000
v_mfma_f32_16x16x32_bf16 a[56:59],v[228:231],v[52:55],a[56:59]
s_add_u32 m0,s29,33792
v_accvgpr_read_b32 v131,a87
v_accvgpr_read_b32 v132,a116
s_waitcnt lgkmcnt(4)
v_mfma_f32_16x16x32_bf16 a[16:19],v[232:235],v[56:59],a[16:19]
ds_read_b64_tr_b16 v[216:217],v252 offset:4224
v_accvgpr_read_b32 v133,a117
v_mfma_f32_16x16x32_bf16 a[20:23],v[232:235],v[60:63],a[20:23]
ds_read_b64_tr_b16 v[218:219],v252 offset:4736
v_accvgpr_read_b32 v134,a118
v_mfma_f32_16x16x32_bf16 a[24:27],v[232:235],v[64:67],a[24:27]
ds_read_b64_tr_b16 v[220:221],v252 offset:4256
v_accvgpr_read_b32 v135,a119
ds_read_b64_tr_b16 v[222:223],v252 offset:4768
buffer_load_dwordx4 v254,s[16:19],s32 offen offset:0 lds
v_mfma_f32_16x16x32_bf16 a[48:51],v[236:239],v[56:59],a[48:51]
s_add_u32 m0,m0,0x000000a0
v_cvt_pk_bf16_f32 v148,v128,v129
v_mfma_f32_16x16x32_bf16 a[52:55],v[236:239],v[60:63],a[52:55]
v_cvt_pk_bf16_f32 v149,v130,v131
v_cvt_pk_bf16_f32 v150,v132,v133
v_mfma_f32_16x16x32_bf16 a[56:59],v[236:239],v[64:67],a[56:59]
v_cvt_pk_bf16_f32 v151,v134,v135
v_and_b32 v241,0xffff0000,v164
v_lshlrev_b32 v242,16,v165
s_waitcnt lgkmcnt(4)
v_mfma_f32_16x16x32_bf16 a[16:19],v[208:211],v[68:71],a[16:19]
ds_read_b64_tr_b16 v[224:225],v252 offset:8448
v_and_b32 v243,0xffff0000,v165
v_mfma_f32_16x16x32_bf16 a[20:23],v[208:211],v[72:75],a[20:23]
ds_read_b64_tr_b16 v[226:227],v252 offset:8960
buffer_load_dwordx4 v254,s[16:19],s32 offen offset:896 lds
v_mfma_f32_16x16x32_bf16 a[24:27],v[208:211],v[76:79],a[24:27]
ds_read_b64_tr_b16 v[228:229],v252 offset:8480
s_add_u32 m0,m0,0x000000a0
ds_read_b64_tr_b16 v[230:231],v252 offset:8992
v_lshlrev_b32 v244,16,v166
v_mfma_f32_16x16x32_bf16 a[48:51],v[212:215],v[68:71],a[48:51]
v_and_b32 v245,0xffff0000,v166
v_lshlrev_b32 v246,16,v167
v_mfma_f32_16x16x32_bf16 a[52:55],v[212:215],v[72:75],a[52:55]
v_and_b32 v247,0xffff0000,v167
s_waitcnt vmcnt(16)
v_mfma_f32_16x16x32_bf16 a[56:59],v[212:215],v[76:79],a[56:59]
v_lshlrev_b32 v136,16,v176
v_and_b32 v176,0xffff0000,v176
buffer_load_dwordx4 v254,s[16:19],s32 offen offset:1792 lds
s_waitcnt lgkmcnt(4)
v_mfma_f32_16x16x32_bf16 a[16:19],v[216:219],v[80:83],a[16:19]
ds_read_b64_tr_b16 v[232:233],v252 offset:12672
s_add_u32 m0,m0,0x000000a0
v_mfma_f32_16x16x32_bf16 a[20:23],v[216:219],v[84:87],a[20:23]
ds_read_b64_tr_b16 v[234:235],v252 offset:13184
v_add_f32 v240,v240,v136
v_mfma_f32_16x16x32_bf16 a[24:27],v[216:219],v[88:91],a[24:27]
ds_read_b64_tr_b16 v[236:237],v252 offset:12704
v_add_f32 v241,v241,v176
ds_read_b64_tr_b16 v[238:239],v252 offset:13216
v_lshlrev_b32 v136,16,v177
v_mfma_f32_16x16x32_bf16 a[48:51],v[220:223],v[80:83],a[48:51]
buffer_store_dwordx4 v[148:151],v250,s[20:23],s63 offen sc1
v_accvgpr_read_b32 v128,a88
v_mfma_f32_16x16x32_bf16 a[52:55],v[220:223],v[84:87],a[52:55]
buffer_load_dwordx4 v254,s[16:19],s32 offen offset:2688 lds
s_add_u32 s32,s32,0x0001c000
v_mfma_f32_16x16x32_bf16 a[56:59],v[220:223],v[88:91],a[56:59]
s_add_u32 m0,s29,67584
v_accvgpr_read_b32 v129,a89
v_accvgpr_read_b32 v130,a90
s_waitcnt lgkmcnt(4)
v_mfma_f32_16x16x32_bf16 a[16:19],v[224:227],v[92:95],a[16:19]
ds_read_b64_tr_b16 v[208:209],v253 offset:0
v_accvgpr_read_b32 v131,a91
v_mfma_f32_16x16x32_bf16 a[20:23],v[224:227],v[96:99],a[20:23]
ds_read_b64_tr_b16 v[210:211],v253 offset:512
v_accvgpr_read_b32 v132,a120
v_mfma_f32_16x16x32_bf16 a[24:27],v[224:227],v[100:103],a[24:27]
ds_read_b64_tr_b16 v[212:213],v253 offset:32
v_accvgpr_read_b32 v133,a121
ds_read_b64_tr_b16 v[214:215],v253 offset:544
buffer_load_dwordx4 v254,s[16:19],s32 offen offset:0 lds
v_mfma_f32_16x16x32_bf16 a[48:51],v[228:231],v[92:95],a[48:51]
s_add_u32 m0,m0,0x000000a0
v_accvgpr_read_b32 v134,a122
v_mfma_f32_16x16x32_bf16 a[52:55],v[228:231],v[96:99],a[52:55]
v_accvgpr_read_b32 v135,a123
v_cvt_pk_bf16_f32 v144,v128,v129
v_mfma_f32_16x16x32_bf16 a[56:59],v[228:231],v[100:103],a[56:59]
v_cvt_pk_bf16_f32 v145,v130,v131
v_cvt_pk_bf16_f32 v146,v132,v133
v_cvt_pk_bf16_f32 v147,v134,v135
s_waitcnt lgkmcnt(4)
v_mfma_f32_16x16x32_bf16 a[16:19],v[232:235],v[104:107],a[16:19]
ds_read_b64_tr_b16 v[216:217],v253 offset:4224
v_and_b32 v177,0xffff0000,v177
v_mfma_f32_16x16x32_bf16 a[20:23],v[232:235],v[108:111],a[20:23]
ds_read_b64_tr_b16 v[218:219],v253 offset:4736
buffer_load_dwordx4 v254,s[16:19],s32 offen offset:896 lds
v_mfma_f32_16x16x32_bf16 a[24:27],v[232:235],v[112:115],a[24:27]
ds_read_b64_tr_b16 v[220:221],v253 offset:4256
s_add_u32 m0,m0,0x000000a0
ds_read_b64_tr_b16 v[222:223],v253 offset:4768
v_add_f32 v242,v242,v136
v_mfma_f32_16x16x32_bf16 a[48:51],v[236:239],v[104:107],a[48:51]
v_add_f32 v243,v243,v177
v_lshlrev_b32 v136,16,v178
v_mfma_f32_16x16x32_bf16 a[52:55],v[236:239],v[108:111],a[52:55]
v_and_b32 v178,0xffff0000,v178
v_add_f32 v244,v244,v136
v_mfma_f32_16x16x32_bf16 a[56:59],v[236:239],v[112:115],a[56:59]
v_add_f32 v245,v245,v178
v_lshlrev_b32 v136,16,v179
buffer_load_dwordx4 v254,s[16:19],s32 offen offset:1792 lds
s_waitcnt lgkmcnt(4)
v_mfma_f32_16x16x32_bf16 a[16:19],v[208:211],v[0:3],a[16:19]
ds_read_b64_tr_b16 v[224:225],v253 offset:8448
s_add_u32 m0,m0,0x000000a0
v_mfma_f32_16x16x32_bf16 a[20:23],v[208:211],a[160:163],a[20:23]
ds_read_b64_tr_b16 v[226:227],v253 offset:8960
v_and_b32 v179,0xffff0000,v179
v_mfma_f32_16x16x32_bf16 a[24:27],v[208:211],a[164:167],a[24:27]
ds_read_b64_tr_b16 v[228:229],v253 offset:8480
v_add_f32 v246,v246,v136
ds_read_b64_tr_b16 v[230:231],v253 offset:8992
v_add_f32 v247,v247,v179
v_mfma_f32_16x16x32_bf16 a[48:51],v[212:215],v[0:3],a[48:51]
v_lshlrev_b32 v136,16,v180
v_and_b32 v180,0xffff0000,v180
v_mfma_f32_16x16x32_bf16 a[52:55],v[212:215],a[160:163],a[52:55]
buffer_load_dwordx4 v254,s[16:19],s32 offen offset:2688 lds
s_add_u32 s32,s32,0x0001c000
v_mfma_f32_16x16x32_bf16 a[56:59],v[212:215],a[164:167],a[56:59]
s_add_u32 m0,s29,50688
buffer_store_dwordx4 v[144:147],v250,s[20:23],s64 offen sc1
v_add_f32 v240,v240,v136
s_waitcnt lgkmcnt(4)
v_mfma_f32_16x16x32_bf16 a[16:19],v[216:219],v[4:7],a[16:19]
ds_read_b64_tr_b16 v[232:233],v253 offset:12672
v_add_f32 v241,v241,v180
v_mfma_f32_16x16x32_bf16 a[20:23],v[216:219],a[168:171],a[20:23]
ds_read_b64_tr_b16 v[234:235],v253 offset:13184
v_lshlrev_b32 v136,16,v181
v_mfma_f32_16x16x32_bf16 a[24:27],v[216:219],a[192:195],a[24:27]
ds_read_b64_tr_b16 v[236:237],v253 offset:12704
v_and_b32 v181,0xffff0000,v181
ds_read_b64_tr_b16 v[238:239],v253 offset:13216
buffer_load_dwordx4 v254,s[16:19],s32 offen offset:0 lds
v_mfma_f32_16x16x32_bf16 a[48:51],v[220:223],v[4:7],a[48:51]
s_add_u32 m0,m0,0x000000a0
v_add_f32 v242,v242,v136
v_mfma_f32_16x16x32_bf16 a[52:55],v[220:223],a[168:171],a[52:55]
s_add_u32 s20,s20,2048
s_addc_u32 s21,s21,0
v_mfma_f32_16x16x32_bf16 a[56:59],v[220:223],a[192:195],a[56:59]
s_sub_u32 s22,s22,2048
v_add_f32 v243,v243,v181
v_lshlrev_b32 v136,16,v182
s_waitcnt lgkmcnt(4)
v_mfma_f32_16x16x32_bf16 a[16:19],v[224:227],a[128:131],a[16:19]
ds_read_b64_tr_b16 v[208:209],v253 offset:16896
v_and_b32 v182,0xffff0000,v182
v_mfma_f32_16x16x32_bf16 a[20:23],v[224:227],a[132:135],a[20:23]
ds_read_b64_tr_b16 v[210:211],v253 offset:17408
buffer_load_dwordx4 v254,s[16:19],s32 offen offset:896 lds
v_mfma_f32_16x16x32_bf16 a[24:27],v[224:227],a[136:139],a[24:27]
ds_read_b64_tr_b16 v[212:213],v253 offset:16928
s_add_u32 m0,m0,0x000000a0
ds_read_b64_tr_b16 v[214:215],v253 offset:17440
v_add_f32 v244,v244,v136
v_mfma_f32_16x16x32_bf16 a[48:51],v[228:231],a[128:131],a[48:51]
buffer_load_dword v137,v142,s[12:15],0 offen sc1
v_add_f32 v245,v245,v182
v_mfma_f32_16x16x32_bf16 a[52:55],v[228:231],a[132:135],a[52:55]
v_lshlrev_b32 v136,16,v183
v_and_b32 v183,0xffff0000,v183
v_mfma_f32_16x16x32_bf16 a[56:59],v[228:231],a[136:139],a[56:59]
v_add_f32 v246,v246,v136
v_add_f32 v247,v247,v183
buffer_load_dwordx4 v254,s[16:19],s32 offen offset:1792 lds
s_waitcnt lgkmcnt(4)
v_mfma_f32_16x16x32_bf16 a[16:19],v[232:235],v[8:11],a[16:19]
ds_read_b64_tr_b16 v[216:217],v253 offset:21120
s_add_u32 m0,m0,0x000000a0
v_mfma_f32_16x16x32_bf16 a[20:23],v[232:235],v[12:15],a[20:23]
ds_read_b64_tr_b16 v[218:219],v253 offset:21632
s_waitcnt vmcnt(25)
v_mfma_f32_16x16x32_bf16 a[24:27],v[232:235],v[16:19],a[24:27]
ds_read_b64_tr_b16 v[220:221],v253 offset:21152
v_lshlrev_b32 v136,16,v184
ds_read_b64_tr_b16 v[222:223],v253 offset:21664
v_and_b32 v184,0xffff0000,v184
v_mfma_f32_16x16x32_bf16 a[48:51],v[236:239],v[8:11],a[48:51]
v_add_f32 v240,v240,v136
v_add_f32 v241,v241,v184
v_mfma_f32_16x16x32_bf16 a[52:55],v[236:239],v[12:15],a[52:55]
buffer_load_dwordx4 v254,s[16:19],s32 offen offset:2688 lds
s_add_u32 s32,s32,0xfffac080
v_mfma_f32_16x16x32_bf16 a[56:59],v[236:239],v[16:19],a[56:59]
v_lshlrev_b32 v136,16,v185
v_and_b32 v185,0xffff0000,v185
v_add_f32 v242,v242,v136
s_waitcnt lgkmcnt(4)
v_mfma_f32_16x16x32_bf16 a[16:19],v[208:211],a[0:3],a[16:19]
ds_read_b64_tr_b16 v[224:225],v253 offset:25344
v_add_f32 v243,v243,v185
v_mfma_f32_16x16x32_bf16 a[20:23],v[208:211],a[4:7],a[20:23]
ds_read_b64_tr_b16 v[226:227],v253 offset:25856
v_lshlrev_b32 v136,16,v186
v_mfma_f32_16x16x32_bf16 a[24:27],v[208:211],a[8:11],a[24:27]
ds_read_b64_tr_b16 v[228:229],v253 offset:25376
v_and_b32 v186,0xffff0000,v186
ds_read_b64_tr_b16 v[230:231],v253 offset:25888
v_add_f32 v244,v244,v136
v_mfma_f32_16x16x32_bf16 a[48:51],v[212:215],a[0:3],a[48:51]
buffer_load_dword v140,v139,s[0:3],0 offen sc1
v_add_f32 v245,v245,v186
v_mfma_f32_16x16x32_bf16 a[52:55],v[212:215],a[4:7],a[52:55]
v_lshlrev_b32 v136,16,v187
v_and_b32 v187,0xffff0000,v187
v_mfma_f32_16x16x32_bf16 a[56:59],v[212:215],a[8:11],a[56:59]
v_add_f32 v246,v246,v136
v_add_f32 v247,v247,v187
v_lshlrev_b32 v136,16,v188
s_waitcnt lgkmcnt(4)
v_mfma_f32_16x16x32_bf16 a[16:19],v[216:219],a[32:35],a[16:19]
ds_read_b64_tr_b16 v[232:233],v253 offset:29568
v_and_b32 v188,0xffff0000,v188
v_mfma_f32_16x16x32_bf16 a[20:23],v[216:219],a[36:39],a[20:23]
ds_read_b64_tr_b16 v[234:235],v253 offset:30080
v_add_f32 v240,v240,v136
v_mfma_f32_16x16x32_bf16 a[24:27],v[216:219],a[40:43],a[24:27]
ds_read_b64_tr_b16 v[236:237],v253 offset:29600
v_add_f32 v241,v241,v188
ds_read_b64_tr_b16 v[238:239],v253 offset:30112
v_lshlrev_b32 v136,16,v189
v_mfma_f32_16x16x32_bf16 a[48:51],v[220:223],a[32:35],a[48:51]
v_and_b32 v189,0xffff0000,v189
v_add_f32 v242,v242,v136
v_mfma_f32_16x16x32_bf16 a[52:55],v[220:223],a[36:39],a[52:55]
v_add_f32 v243,v243,v189
v_lshlrev_b32 v136,16,v190
v_mfma_f32_16x16x32_bf16 a[56:59],v[220:223],a[40:43],a[56:59]
v_and_b32 v190,0xffff0000,v190
v_add_f32 v244,v244,v136
v_add_f32 v245,v245,v190
s_waitcnt lgkmcnt(4)
v_mfma_f32_16x16x32_bf16 a[16:19],v[224:227],a[64:67],a[16:19]
ds_read_b64_tr_b16 v[208:209],v255 offset:33856
v_lshlrev_b32 v136,16,v191
v_mfma_f32_16x16x32_bf16 a[20:23],v[224:227],a[68:71],a[20:23]
ds_read_b64_tr_b16 v[210:211],v255 offset:34368
v_and_b32 v191,0xffff0000,v191
v_mfma_f32_16x16x32_bf16 a[24:27],v[224:227],a[72:75],a[24:27]
ds_read_b64_tr_b16 v[212:213],v255 offset:33888
v_add_f32 v246,v246,v136
ds_read_b64_tr_b16 v[214:215],v255 offset:34400
v_add_f32 v247,v247,v191
v_mfma_f32_16x16x32_bf16 a[48:51],v[228:231],a[64:67],a[48:51]
s_waitcnt vmcnt(23)
v_lshlrev_b32 v136,16,v192
v_mfma_f32_16x16x32_bf16 a[52:55],v[228:231],a[68:71],a[52:55]
v_and_b32 v192,0xffff0000,v192
v_add_f32 v240,v240,v136
v_mfma_f32_16x16x32_bf16 a[56:59],v[228:231],a[72:75],a[56:59]
v_add_f32 v241,v241,v192
v_lshlrev_b32 v136,16,v193
v_and_b32 v193,0xffff0000,v193
s_waitcnt lgkmcnt(4)
v_mfma_f32_16x16x32_bf16 a[16:19],v[232:235],a[96:99],a[16:19]
ds_read_b64_tr_b16 v[216:217],v255 offset:38080
v_add_f32 v242,v242,v136
v_mfma_f32_16x16x32_bf16 a[20:23],v[232:235],a[100:103],a[20:23]
ds_read_b64_tr_b16 v[218:219],v255 offset:38592
v_add_f32 v243,v243,v193
v_mfma_f32_16x16x32_bf16 a[24:27],v[232:235],a[104:107],a[24:27]
ds_read_b64_tr_b16 v[220:221],v255 offset:38112
v_lshlrev_b32 v136,16,v194
ds_read_b64_tr_b16 v[222:223],v255 offset:38624
v_and_b32 v194,0xffff0000,v194
v_mfma_f32_16x16x32_bf16 a[48:51],v[236:239],a[96:99],a[48:51]
v_add_f32 v244,v244,v136
v_add_f32 v245,v245,v194
v_mfma_f32_16x16x32_bf16 a[52:55],v[236:239],a[100:103],a[52:55]
v_lshlrev_b32 v136,16,v195
v_and_b32 v195,0xffff0000,v195
v_mfma_f32_16x16x32_bf16 a[56:59],v[236:239],a[104:107],a[56:59]
v_add_f32 v246,v246,v136
v_add_f32 v247,v247,v195
v_lshlrev_b32 v136,16,v196
s_waitcnt lgkmcnt(4)
v_mfma_f32_16x16x32_bf16 a[80:83],v[208:211],v[20:23],0
ds_read_b64_tr_b16 v[224:225],v255 offset:42304
v_and_b32 v196,0xffff0000,v196
v_mfma_f32_16x16x32_bf16 a[84:87],v[208:211],v[24:27],0
ds_read_b64_tr_b16 v[226:227],v255 offset:42816
v_add_f32 v240,v240,v136
v_mfma_f32_16x16x32_bf16 a[88:91],v[208:211],v[28:31],0
ds_read_b64_tr_b16 v[228:229],v255 offset:42336
v_add_f32 v241,v241,v196
ds_read_b64_tr_b16 v[230:231],v255 offset:42848
v_lshlrev_b32 v136,16,v197
v_mfma_f32_16x16x32_bf16 a[112:115],v[212:215],v[20:23],0
v_mov_b32 v164,v160
v_mov_b32 v165,v161
v_mfma_f32_16x16x32_bf16 a[116:119],v[212:215],v[24:27],0
v_mov_b32 v166,v162
v_mov_b32 v167,v163
v_mfma_f32_16x16x32_bf16 a[120:123],v[212:215],v[28:31],0
v_accvgpr_read_b32 v128,a16
v_accvgpr_read_b32 v129,a17
v_accvgpr_read_b32 v130,a18
s_waitcnt lgkmcnt(4)
v_mfma_f32_16x16x32_bf16 a[80:83],v[216:219],v[32:35],a[80:83]
ds_read_b64_tr_b16 v[232:233],v255 offset:46528
v_accvgpr_read_b32 v131,a19
v_mfma_f32_16x16x32_bf16 a[84:87],v[216:219],v[36:39],a[84:87]
ds_read_b64_tr_b16 v[234:235],v255 offset:47040
v_accvgpr_read_b32 v132,a48
v_mfma_f32_16x16x32_bf16 a[88:91],v[216:219],v[40:43],a[88:91]
ds_read_b64_tr_b16 v[236:237],v255 offset:46560
v_accvgpr_read_b32 v133,a49
ds_read_b64_tr_b16 v[238:239],v255 offset:47072
v_accvgpr_read_b32 v134,a50
v_mfma_f32_16x16x32_bf16 a[112:115],v[220:223],v[32:35],a[112:115]
v_accvgpr_read_b32 v135,a51
v_cvt_pk_bf16_f32 v160,v128,v129
v_mfma_f32_16x16x32_bf16 a[116:119],v[220:223],v[36:39],a[116:119]
v_cvt_pk_bf16_f32 v161,v130,v131
v_cvt_pk_bf16_f32 v162,v132,v133
v_mfma_f32_16x16x32_bf16 a[120:123],v[220:223],v[40:43],a[120:123]
v_cvt_pk_bf16_f32 v163,v134,v135
buffer_store_dwordx4 v[160:163],v249,s[20:23],s66 offen sc1
v_accvgpr_read_b32 v128,a20
s_waitcnt lgkmcnt(4)
v_mfma_f32_16x16x32_bf16 a[80:83],v[224:227],v[44:47],a[80:83]
ds_read_b64_tr_b16 v[208:209],v252 offset:64
v_accvgpr_read_b32 v129,a21
v_mfma_f32_16x16x32_bf16 a[84:87],v[224:227],v[48:51],a[84:87]
ds_read_b64_tr_b16 v[210:211],v252 offset:576
v_accvgpr_read_b32 v130,a22
v_mfma_f32_16x16x32_bf16 a[88:91],v[224:227],v[52:55],a[88:91]
ds_read_b64_tr_b16 v[212:213],v252 offset:96
v_accvgpr_read_b32 v131,a23
ds_read_b64_tr_b16 v[214:215],v252 offset:608
v_accvgpr_read_b32 v132,a52
v_mfma_f32_16x16x32_bf16 a[112:115],v[228:231],v[44:47],a[112:115]
s_waitcnt vmcnt(4)
v_accvgpr_read_b32 v133,a53
v_mfma_f32_16x16x32_bf16 a[116:119],v[228:231],v[48:51],a[116:119]
v_cmp_gt_u32 vcc,s67,v137
s_cbranch_vccnz M_stub10
M_back10:
v_mfma_f32_16x16x32_bf16 a[120:123],v[228:231],v[52:55],a[120:123]
buffer_load_dwordx4 v[176:179],v248,s[4:7],s93 offen sc1
v_accvgpr_read_b32 v134,a54
v_accvgpr_read_b32 v135,a55
s_waitcnt lgkmcnt(4)
v_mfma_f32_16x16x32_bf16 a[80:83],v[232:235],v[56:59],a[80:83]
ds_read_b64_tr_b16 v[216:217],v252 offset:4288
v_cvt_pk_bf16_f32 v148,v128,v129
v_mfma_f32_16x16x32_bf16 a[84:87],v[232:235],v[60:63],a[84:87]
ds_read_b64_tr_b16 v[218:219],v252 offset:4800
v_cvt_pk_bf16_f32 v149,v130,v131
v_mfma_f32_16x16x32_bf16 a[88:91],v[232:235],v[64:67],a[88:91]
ds_read_b64_tr_b16 v[220:221],v252 offset:4320
v_cvt_pk_bf16_f32 v150,v132,v133
ds_read_b64_tr_b16 v[222:223],v252 offset:4832
v_cvt_pk_bf16_f32 v151,v134,v135
v_mfma_f32_16x16x32_bf16 a[112:115],v[236:239],v[56:59],a[112:115]
v_and_b32 v197,0xffff0000,v197
v_add_f32 v242,v242,v136
v_mfma_f32_16x16x32_bf16 a[116:119],v[236:239],v[60:63],a[116:119]
v_add_f32 v243,v243,v197
v_lshlrev_b32 v136,16,v198
v_mfma_f32_16x16x32_bf16 a[120:123],v[236:239],v[64:67],a[120:123]
v_and_b32 v198,0xffff0000,v198
v_add_f32 v244,v244,v136
buffer_load_dwordx4 v[180:183],v248,s[4:7],s94 offen sc1
s_waitcnt lgkmcnt(4)
v_mfma_f32_16x16x32_bf16 a[80:83],v[208:211],v[68:71],a[80:83]
ds_read_b64_tr_b16 v[224:225],v252 offset:8512
v_add_f32 v245,v245,v198
v_mfma_f32_16x16x32_bf16 a[84:87],v[208:211],v[72:75],a[84:87]
ds_read_b64_tr_b16 v[226:227],v252 offset:9024
v_lshlrev_b32 v136,16,v199
v_mfma_f32_16x16x32_bf16 a[88:91],v[208:211],v[76:79],a[88:91]
ds_read_b64_tr_b16 v[228:229],v252 offset:8544
buffer_store_dwordx4 v[148:151],v249,s[20:23],s63 offen sc1
ds_read_b64_tr_b16 v[230:231],v252 offset:9056
v_accvgpr_read_b32 v128,a24
v_mfma_f32_16x16x32_bf16 a[112:115],v[212:215],v[68:71],a[112:115]
v_accvgpr_read_b32 v129,a25
v_accvgpr_read_b32 v130,a26
v_mfma_f32_16x16x32_bf16 a[116:119],v[212:215],v[72:75],a[116:119]
v_accvgpr_read_b32 v131,a27
v_accvgpr_read_b32 v132,a56
v_mfma_f32_16x16x32_bf16 a[120:123],v[212:215],v[76:79],a[120:123]
v_accvgpr_read_b32 v133,a57
v_accvgpr_read_b32 v134,a58
v_accvgpr_read_b32 v135,a59
s_waitcnt lgkmcnt(4)
v_mfma_f32_16x16x32_bf16 a[80:83],v[216:219],v[80:83],a[80:83]
ds_read_b64_tr_b16 v[232:233],v252 offset:12736
buffer_load_dwordx4 v[184:187],v248,s[4:7],s95 offen sc1
v_mfma_f32_16x16x32_bf16 a[84:87],v[216:219],v[84:87],a[84:87]
ds_read_b64_tr_b16 v[234:235],v252 offset:13248
v_cvt_pk_bf16_f32 v144,v128,v129
v_mfma_f32_16x16x32_bf16 a[88:91],v[216:219],v[88:91],a[88:91]
ds_read_b64_tr_b16 v[236:237],v252 offset:12768
v_cvt_pk_bf16_f32 v145,v130,v131
ds_read_b64_tr_b16 v[238:239],v252 offset:13280
v_cvt_pk_bf16_f32 v146,v132,v133
v_mfma_f32_16x16x32_bf16 a[112:115],v[220:223],v[80:83],a[112:115]
v_cvt_pk_bf16_f32 v147,v134,v135
v_and_b32 v199,0xffff0000,v199
v_mfma_f32_16x16x32_bf16 a[116:119],v[220:223],v[84:87],a[116:119]
v_add_f32 v246,v246,v136
v_add_f32 v247,v247,v199
v_mfma_f32_16x16x32_bf16 a[120:123],v[220:223],v[88:91],a[120:123]
s_waitcnt vmcnt(63)
v_lshlrev_b32 v136,16,v200
v_and_b32 v200,0xffff0000,v200
s_waitcnt lgkmcnt(4)
v_mfma_f32_16x16x32_bf16 a[80:83],v[224:227],v[92:95],a[80:83]
ds_read_b64_tr_b16 v[208:209],v253 offset:64
v_add_f32 v240,v240,v136
v_mfma_f32_16x16x32_bf16 a[84:87],v[224:227],v[96:99],a[84:87]
ds_read_b64_tr_b16 v[210:211],v253 offset:576
buffer_load_dwordx4 v[188:191],v248,s[4:7],s96 offen sc1
v_mfma_f32_16x16x32_bf16 a[88:91],v[224:227],v[100:103],a[88:91]
ds_read_b64_tr_b16 v[212:213],v253 offset:96
v_add_f32 v241,v241,v200
ds_read_b64_tr_b16 v[214:215],v253 offset:608
v_lshlrev_b32 v136,16,v201
v_mfma_f32_16x16x32_bf16 a[112:115],v[228:231],v[92:95],a[112:115]
v_and_b32 v201,0xffff0000,v201
v_add_f32 v242,v242,v136
v_mfma_f32_16x16x32_bf16 a[116:119],v[228:231],v[96:99],a[116:119]
v_add_f32 v243,v243,v201
v_lshlrev_b32 v136,16,v202
v_mfma_f32_16x16x32_bf16 a[120:123],v[228:231],v[100:103],a[120:123]
buffer_store_dwordx4 v[144:147],v249,s[20:23],s64 offen sc1
v_and_b32 v202,0xffff0000,v202
v_add_f32 v244,v244,v136
s_waitcnt lgkmcnt(4)
v_mfma_f32_16x16x32_bf16 a[80:83],v[232:235],v[104:107],a[80:83]
ds_read_b64_tr_b16 v[216:217],v253 offset:4288
v_add_f32 v245,v245,v202
v_mfma_f32_16x16x32_bf16 a[84:87],v[232:235],v[108:111],a[84:87]
ds_read_b64_tr_b16 v[218:219],v253 offset:4800
v_lshlrev_b32 v136,16,v203
v_mfma_f32_16x16x32_bf16 a[88:91],v[232:235],v[112:115],a[88:91]
ds_read_b64_tr_b16 v[220:221],v253 offset:4320
buffer_load_dwordx4 v[192:195],v248,s[4:7],s97 offen sc1
ds_read_b64_tr_b16 v[222:223],v253 offset:4832
v_and_b32 v203,0xffff0000,v203
v_mfma_f32_16x16x32_bf16 a[112:115],v[236:239],v[104:107],a[112:115]
v_add_f32 v246,v246,v136
v_add_f32 v247,v247,v203
v_mfma_f32_16x16x32_bf16 a[116:119],v[236:239],v[108:111],a[116:119]
v_cvt_pk_bf16_f32 v152,v240,v241
v_cvt_pk_bf16_f32 v153,v242,v243
v_mfma_f32_16x16x32_bf16 a[120:123],v[236:239],v[112:115],a[120:123]
v_cvt_pk_bf16_f32 v154,v244,v245
v_cvt_pk_bf16_f32 v155,v246,v247
s_nop 0
v_permlane32_swap_b32 v152,v154
s_waitcnt lgkmcnt(4)
v_mfma_f32_16x16x32_bf16 a[80:83],v[208:211],v[0:3],a[80:83]
ds_read_b64_tr_b16 v[224:225],v253 offset:8512
v_permlane32_swap_b32 v153,v155
v_mfma_f32_16x16x32_bf16 a[84:87],v[208:211],a[160:163],a[84:87]
ds_read_b64_tr_b16 v[226:227],v253 offset:9024
v_permlane16_swap_b32 v152,v154
v_mfma_f32_16x16x32_bf16 a[88:91],v[208:211],a[164:167],a[88:91]
ds_read_b64_tr_b16 v[228:229],v253 offset:8544
v_permlane16_swap_b32 v153,v155
ds_read_b64_tr_b16 v[230:231],v253 offset:9056
buffer_load_dwordx4 v[196:199],v248,s[4:7],s98 offen sc1
v_mfma_f32_16x16x32_bf16 a[112:115],v[212:215],v[0:3],a[112:115]
buffer_store_dwordx4 v[152:155],v138,s[8:11],0 offen sc1
v_mfma_f32_16x16x32_bf16 a[116:119],v[212:215],a[160:163],a[116:119]
s_add_u32 s8,s8,128
s_addc_u32 s9,s9,0
v_mfma_f32_16x16x32_bf16 a[120:123],v[212:215],a[164:167],a[120:123]
s_waitcnt lgkmcnt(4)
v_mfma_f32_16x16x32_bf16 a[80:83],v[216:219],v[4:7],a[80:83]
ds_read_b64_tr_b16 v[232:233],v253 offset:12736
v_mfma_f32_16x16x32_bf16 a[84:87],v[216:219],a[168:171],a[84:87]
ds_read_b64_tr_b16 v[234:235],v253 offset:13248
v_mfma_f32_16x16x32_bf16 a[88:91],v[216:219],a[192:195],a[88:91]
ds_read_b64_tr_b16 v[236:237],v253 offset:12768
ds_read_b64_tr_b16 v[238:239],v253 offset:13280
v_mfma_f32_16x16x32_bf16 a[112:115],v[220:223],v[4:7],a[112:115]
buffer_load_dwordx4 v[200:203],v248,s[4:7],s99 offen sc1
v_mfma_f32_16x16x32_bf16 a[116:119],v[220:223],a[168:171],a[116:119]
s_add_u32 s4,s4,2048
s_addc_u32 s5,s5,0
v_mfma_f32_16x16x32_bf16 a[120:123],v[220:223],a[192:195],a[120:123]
s_waitcnt lgkmcnt(4)
v_mfma_f32_16x16x32_bf16 a[80:83],v[224:227],a[128:131],a[80:83]
ds_read_b64_tr_b16 v[208:209],v253 offset:16960
v_mfma_f32_16x16x32_bf16 a[84:87],v[224:227],a[132:135],a[84:87]
ds_read_b64_tr_b16 v[210:211],v253 offset:17472
v_mfma_f32_16x16x32_bf16 a[88:91],v[224:227],a[136:139],a[88:91]
ds_read_b64_tr_b16 v[212:213],v253 offset:16992
ds_read_b64_tr_b16 v[214:215],v253 offset:17504
v_mfma_f32_16x16x32_bf16 a[112:115],v[228:231],a[128:131],a[112:115]
v_mfma_f32_16x16x32_bf16 a[116:119],v[228:231],a[132:135],a[116:119]
v_mfma_f32_16x16x32_bf16 a[120:123],v[228:231],a[136:139],a[120:123]
s_waitcnt lgkmcnt(4)
v_mfma_f32_16x16x32_bf16 a[80:83],v[232:235],v[8:11],a[80:83]
ds_read_b64_tr_b16 v[216:217],v253 offset:21184
v_mfma_f32_16x16x32_bf16 a[84:87],v[232:235],v[12:15],a[84:87]
ds_read_b64_tr_b16 v[218:219],v253 offset:21696
v_mfma_f32_16x16x32_bf16 a[88:91],v[232:235],v[16:19],a[88:91]
ds_read_b64_tr_b16 v[220:221],v253 offset:21216
ds_read_b64_tr_b16 v[222:223],v253 offset:21728
v_mfma_f32_16x16x32_bf16 a[112:115],v[236:239],v[8:11],a[112:115]
v_mfma_f32_16x16x32_bf16 a[116:119],v[236:239],v[12:15],a[116:119]
v_mfma_f32_16x16x32_bf16 a[120:123],v[236:239],v[16:19],a[120:123]
s_waitcnt lgkmcnt(4)
v_mfma_f32_16x16x32_bf16 a[80:83],v[208:211],a[0:3],a[80:83]
ds_read_b64_tr_b16 v[224:225],v253 offset:25408
v_mfma_f32_16x16x32_bf16 a[84:87],v[208:211],a[4:7],a[84:87]
ds_read_b64_tr_b16 v[226:227],v253 offset:25920
v_mfma_f32_16x16x32_bf16 a[88:91],v[208:211],a[8:11],a[88:91]
ds_read_b64_tr_b16 v[228:229],v253 offset:25440
ds_read_b64_tr_b16 v[230:231],v253 offset:25952
v_mfma_f32_16x16x32_bf16 a[112:115],v[212:215],a[0:3],a[112:115]
v_mfma_f32_16x16x32_bf16 a[116:119],v[212:215],a[4:7],a[116:119]
v_mfma_f32_16x16x32_bf16 a[120:123],v[212:215],a[8:11],a[120:123]
s_waitcnt lgkmcnt(4)
v_mfma_f32_16x16x32_bf16 a[80:83],v[216:219],a[32:35],a[80:83]
ds_read_b64_tr_b16 v[232:233],v253 offset:29632
v_mfma_f32_16x16x32_bf16 a[84:87],v[216:219],a[36:39],a[84:87]
ds_read_b64_tr_b16 v[234:235],v253 offset:30144
v_mfma_f32_16x16x32_bf16 a[88:91],v[216:219],a[40:43],a[88:91]
ds_read_b64_tr_b16 v[236:237],v253 offset:29664
ds_read_b64_tr_b16 v[238:239],v253 offset:30176
v_mfma_f32_16x16x32_bf16 a[112:115],v[220:223],a[32:35],a[112:115]
v_mfma_f32_16x16x32_bf16 a[116:119],v[220:223],a[36:39],a[116:119]
v_mfma_f32_16x16x32_bf16 a[120:123],v[220:223],a[40:43],a[120:123]
s_waitcnt vmcnt(11) lgkmcnt(4)
v_mfma_f32_16x16x32_bf16 a[80:83],v[224:227],a[64:67],a[80:83]
v_cmp_gt_u32 vcc,s33,v140
s_cbranch_vccnz M_stub11
M_back11:
v_mfma_f32_16x16x32_bf16 a[84:87],v[224:227],a[68:71],a[84:87]
s_waitcnt vmcnt(63) lgkmcnt(0)
s_barrier
v_mfma_f32_16x16x32_bf16 a[88:91],v[224:227],a[72:75],a[88:91]
ds_read_b64_tr_b16 v[208:209],v252 offset:16896
v_add_u32 v143,1,v143
ds_read_b64_tr_b16 v[210:211],v252 offset:17408
buffer_store_dword v143,v248,s[24:27],0 offen sc1
v_mfma_f32_16x16x32_bf16 a[112:115],v[228:231],a[64:67],a[112:115]
ds_read_b64_tr_b16 v[212:213],v252 offset:16928
s_add_u32 s67,s67,1
v_mfma_f32_16x16x32_bf16 a[116:119],v[228:231],a[68:71],a[116:119]
ds_read_b64_tr_b16 v[214:215],v252 offset:17440
s_mov_b32 s2,0
v_mfma_f32_16x16x32_bf16 a[120:123],v[228:231],a[72:75],a[120:123]
s_mov_b32 s33,0
v_mfma_f32_16x16x32_bf16 a[80:83],v[232:235],a[96:99],a[80:83]
ds_read_b64_tr_b16 v[216:217],v252 offset:21120
v_mfma_f32_16x16x32_bf16 a[84:87],v[232:235],a[100:103],a[84:87]
ds_read_b64_tr_b16 v[218:219],v252 offset:21632
v_mfma_f32_16x16x32_bf16 a[88:91],v[232:235],a[104:107],a[88:91]
ds_read_b64_tr_b16 v[220:221],v252 offset:21152
ds_read_b64_tr_b16 v[222:223],v252 offset:21664
v_mfma_f32_16x16x32_bf16 a[112:115],v[236:239],a[96:99],a[112:115]
v_mfma_f32_16x16x32_bf16 a[116:119],v[236:239],a[100:103],a[116:119]
v_mfma_f32_16x16x32_bf16 a[120:123],v[236:239],a[104:107],a[120:123]
s_cmp_eq_u32 s36,1
s_waitcnt lgkmcnt(4)
s_cbranch_scc1 M_plast
v_mfma_f32_16x16x32_bf16 a[16:19],v[208:211],v[20:23],0
ds_read_b64_tr_b16 v[224:225],v252 offset:25344
s_and_b32 s6,s68,1606656
v_mfma_f32_16x16x32_bf16 a[20:23],v[208:211],v[24:27],0
ds_read_b64_tr_b16 v[226:227],v252 offset:25856
v_mfma_f32_16x16x32_bf16 a[24:27],v[208:211],v[28:31],0
ds_read_b64_tr_b16 v[228:229],v252 offset:25376
s_add_u32 m0,s29,84480
ds_read_b64_tr_b16 v[230:231],v252 offset:25888
buffer_load_dwordx4 v254,s[16:19],s32 offen offset:0 lds
v_mfma_f32_16x16x32_bf16 a[48:51],v[212:215],v[20:23],0
s_add_u32 m0,m0,0x000000a0
v_accvgpr_read_b32 v128,a80
v_mfma_f32_16x16x32_bf16 a[52:55],v[212:215],v[24:27],0
v_accvgpr_read_b32 v129,a81
v_accvgpr_read_b32 v130,a82
v_mfma_f32_16x16x32_bf16 a[56:59],v[212:215],v[28:31],0
v_accvgpr_read_b32 v131,a83
v_accvgpr_read_b32 v132,a112
v_accvgpr_read_b32 v133,a113
s_waitcnt lgkmcnt(4)
v_mfma_f32_16x16x32_bf16 a[16:19],v[216:219],v[32:35],a[16:19]
ds_read_b64_tr_b16 v[232:233],v252 offset:29568
v_accvgpr_read_b32 v134,a114
v_mfma_f32_16x16x32_bf16 a[20:23],v[216:219],v[36:39],a[20:23]
ds_read_b64_tr_b16 v[234:235],v252 offset:30080
buffer_load_dwordx4 v254,s[16:19],s32 offen offset:896 lds
v_mfma_f32_16x16x32_bf16 a[24:27],v[216:219],v[40:43],a[24:27]
ds_read_b64_tr_b16 v[236:237],v252 offset:29600
s_add_u32 m0,m0,0x000000a0
ds_read_b64_tr_b16 v[238:239],v252 offset:30112
v_accvgpr_read_b32 v135,a115
v_mfma_f32_16x16x32_bf16 a[48:51],v[220:223],v[32:35],a[48:51]
v_cvt_pk_bf16_f32 v144,v128,v129
v_cvt_pk_bf16_f32 v145,v130,v131
v_mfma_f32_16x16x32_bf16 a[52:55],v[220:223],v[36:39],a[52:55]
v_cvt_pk_bf16_f32 v146,v132,v133
v_cvt_pk_bf16_f32 v147,v134,v135
v_mfma_f32_16x16x32_bf16 a[56:59],v[220:223],v[40:43],a[56:59]
v_lshlrev_b32 v240,16,v164
v_and_b32 v241,0xffff0000,v164
buffer_load_dwordx4 v254,s[16:19],s32 offen offset:1792 lds
s_waitcnt lgkmcnt(4)
v_mfma_f32_16x16x32_bf16 a[16:19],v[224:227],v[44:47],a[16:19]
ds_read_b64_tr_b16 v[208:209],v252 offset:33792
s_add_u32 m0,m0,0x000000a0
v_mfma_f32_16x16x32_bf16 a[20:23],v[224:227],v[48:51],a[20:23]
ds_read_b64_tr_b16 v[210:211],v252 offset:34304
v_lshlrev_b32 v242,16,v165
v_mfma_f32_16x16x32_bf16 a[24:27],v[224:227],v[52:55],a[24:27]
ds_read_b64_tr_b16 v[212:213],v252 offset:33824
buffer_store_dwordx4 v[144:147],v250,s[20:23],s62 offen sc1
ds_read_b64_tr_b16 v[214:215],v252 offset:34336
v_accvgpr_read_b32 v128,a84
v_mfma_f32_16x16x32_bf16 a[48:51],v[228:231],v[44:47],a[48:51]
v_accvgpr_read_b32 v129,a85
v_accvgpr_read_b32 v130,a86
v_mfma_f32_16x16x32_bf16 a[52:55],v[228:231],v[48:51],a[52:55]
buffer_load_dwordx4 v254,s[16:19],s32 offen offset:2688 lds
s_add_u32 s32,s32,0x0001c000
v_mfma_f32_16x16x32_bf16 a[56:59],v[228:231],v[52:55],a[56:59]
s_add_u32 m0,s29,0
v_accvgpr_read_b32 v131,a87
v_accvgpr_read_b32 v132,a116
s_waitcnt lgkmcnt(4)
v_mfma_f32_16x16x32_bf16 a[16:19],v[232:235],v[56:59],a[16:19]
ds_read_b64_tr_b16 v[216:217],v252 offset:38016
v_accvgpr_read_b32 v133,a117
v_mfma_f32_16x16x32_bf16 a[20:23],v[232:235],v[60:63],a[20:23]
ds_read_b64_tr_b16 v[218:219],v252 offset:38528
v_accvgpr_read_b32 v134,a118
v_mfma_f32_16x16x32_bf16 a[24:27],v[232:235],v[64:67],a[24:27]
ds_read_b64_tr_b16 v[220:221],v252 offset:38048
v_accvgpr_read_b32 v135,a119
ds_read_b64_tr_b16 v[222:223],v252 offset:38560
buffer_load_dwordx4 v254,s[16:19],s32 offen offset:0 lds
v_mfma_f32_16x16x32_bf16 a[48:51],v[236:239],v[56:59],a[48:51]
s_add_u32 m0,m0,0x000000a0
v_cvt_pk_bf16_f32 v148,v128,v129
v_mfma_f32_16x16x32_bf16 a[52:55],v[236:239],v[60:63],a[52:55]
v_cvt_pk_bf16_f32 v149,v130,v131
v_cvt_pk_bf16_f32 v150,v132,v133
v_mfma_f32_16x16x32_bf16 a[56:59],v[236:239],v[64:67],a[56:59]
v_cvt_pk_bf16_f32 v151,v134,v135
v_and_b32 v243,0xffff0000,v165
v_lshlrev_b32 v244,16,v166
s_waitcnt lgkmcnt(4)
v_mfma_f32_16x16x32_bf16 a[16:19],v[208:211],v[68:71],a[16:19]
ds_read_b64_tr_b16 v[224:225],v252 offset:42240
v_and_b32 v245,0xffff0000,v166
v_mfma_f32_16x16x32_bf16 a[20:23],v[208:211],v[72:75],a[20:23]
ds_read_b64_tr_b16 v[226:227],v252 offset:42752
buffer_load_dwordx4 v254,s[16:19],s32 offen offset:896 lds
v_mfma_f32_16x16x32_bf16 a[24:27],v[208:211],v[76:79],a[24:27]
ds_read_b64_tr_b16 v[228:229],v252 offset:42272
s_add_u32 m0,m0,0x000000a0
ds_read_b64_tr_b16 v[230:231],v252 offset:42784
v_lshlrev_b32 v246,16,v167
v_mfma_f32_16x16x32_bf16 a[48:51],v[212:215],v[68:71],a[48:51]
v_and_b32 v247,0xffff0000,v167
s_waitcnt vmcnt(16)
v_mfma_f32_16x16x32_bf16 a[52:55],v[212:215],v[72:75],a[52:55]
v_lshlrev_b32 v136,16,v176
v_and_b32 v176,0xffff0000,v176
v_mfma_f32_16x16x32_bf16 a[56:59],v[212:215],v[76:79],a[56:59]
v_add_f32 v240,v240,v136
v_add_f32 v241,v241,v176
buffer_load_dwordx4 v254,s[16:19],s32 offen offset:1792 lds
s_waitcnt lgkmcnt(4)
v_mfma_f32_16x16x32_bf16 a[16:19],v[216:219],v[80:83],a[16:19]
ds_read_b64_tr_b16 v[232:233],v252 offset:46464
s_add_u32 m0,m0,0x000000a0
v_mfma_f32_16x16x32_bf16 a[20:23],v[216:219],v[84:87],a[20:23]
ds_read_b64_tr_b16 v[234:235],v252 offset:46976
v_lshlrev_b32 v136,16,v177
v_mfma_f32_16x16x32_bf16 a[24:27],v[216:219],v[88:91],a[24:27]
ds_read_b64_tr_b16 v[236:237],v252 offset:46496
v_and_b32 v177,0xffff0000,v177
ds_read_b64_tr_b16 v[238:239],v252 offset:47008
v_add_f32 v242,v242,v136
v_mfma_f32_16x16x32_bf16 a[48:51],v[220:223],v[80:83],a[48:51]
buffer_store_dwordx4 v[148:151],v250,s[20:23],s63 offen sc1
v_accvgpr_read_b32 v128,a88
v_mfma_f32_16x16x32_bf16 a[52:55],v[220:223],v[84:87],a[52:55]
buffer_load_dwordx4 v254,s[16:19],s32 offen offset:2688 lds
s_add_u32 s32,s32,0x0001c000
v_mfma_f32_16x16x32_bf16 a[56:59],v[220:223],v[88:91],a[56:59]
s_add_u32 m0,s29,101376
v_accvgpr_read_b32 v129,a89
v_accvgpr_read_b32 v130,a90
s_waitcnt lgkmcnt(4)
v_mfma_f32_16x16x32_bf16 a[16:19],v[224:227],v[92:95],a[16:19]
ds_read_b64_tr_b16 v[208:209],v255 offset:16896
v_accvgpr_read_b32 v131,a91
v_mfma_f32_16x16x32_bf16 a[20:23],v[224:227],v[96:99],a[20:23]
ds_read_b64_tr_b16 v[210:211],v255 offset:17408
v_accvgpr_read_b32 v132,a120
v_mfma_f32_16x16x32_bf16 a[24:27],v[224:227],v[100:103],a[24:27]
ds_read_b64_tr_b16 v[212:213],v255 offset:16928
v_accvgpr_read_b32 v133,a121
ds_read_b64_tr_b16 v[214:215],v255 offset:17440
buffer_load_dwordx4 v254,s[16:19],s32 offen offset:0 lds
v_mfma_f32_16x16x32_bf16 a[48:51],v[228:231],v[92:95],a[48:51]
s_add_u32 m0,m0,0x000000a0
v_accvgpr_read_b32 v134,a122
v_mfma_f32_16x16x32_bf16 a[52:55],v[228:231],v[96:99],a[52:55]
v_accvgpr_read_b32 v135,a123
v_cvt_pk_bf16_f32 v144,v128,v129
v_mfma_f32_16x16x32_bf16 a[56:59],v[228:231],v[100:103],a[56:59]
v_cvt_pk_bf16_f32 v145,v130,v131
v_cvt_pk_bf16_f32 v146,v132,v133
v_cvt_pk_bf16_f32 v147,v134,v135
s_waitcnt lgkmcnt(4)
v_mfma_f32_16x16x32_bf16 a[16:19],v[232:235],v[104:107],a[16:19]
ds_read_b64_tr_b16 v[216:217],v255 offset:21120
v_add_f32 v243,v243,v177
v_mfma_f32_16x16x32_bf16 a[20:23],v[232:235],v[108:111],a[20:23]
ds_read_b64_tr_b16 v[218:219],v255 offset:21632
buffer_load_dwordx4 v254,s[16:19],s32 offen offset:896 lds
v_mfma_f32_16x16x32_bf16 a[24:27],v[232:235],v[112:115],a[24:27]
ds_read_b64_tr_b16 v[220:221],v255 offset:21152
s_add_u32 m0,m0,0x000000a0
ds_read_b64_tr_b16 v[222:223],v255 offset:21664
v_lshlrev_b32 v136,16,v178
v_mfma_f32_16x16x32_bf16 a[48:51],v[236:239],v[104:107],a[48:51]
v_and_b32 v178,0xffff0000,v178
v_add_f32 v244,v244,v136
v_mfma_f32_16x16x32_bf16 a[52:55],v[236:239],v[108:111],a[52:55]
v_add_f32 v245,v245,v178
v_lshlrev_b32 v136,16,v179
v_mfma_f32_16x16x32_bf16 a[56:59],v[236:239],v[112:115],a[56:59]
v_and_b32 v179,0xffff0000,v179
v_add_f32 v246,v246,v136
buffer_load_dwordx4 v254,s[16:19],s32 offen offset:1792 lds
s_waitcnt lgkmcnt(4)
v_mfma_f32_16x16x32_bf16 a[16:19],v[208:211],v[0:3],a[16:19]
ds_read_b64_tr_b16 v[224:225],v255 offset:25344
s_add_u32 m0,m0,0x000000a0
v_mfma_f32_16x16x32_bf16 a[20:23],v[208:211],a[160:163],a[20:23]
ds_read_b64_tr_b16 v[226:227],v255 offset:25856
v_add_f32 v247,v247,v179
v_mfma_f32_16x16x32_bf16 a[24:27],v[208:211],a[164:167],a[24:27]
ds_read_b64_tr_b16 v[228:229],v255 offset:25376
v_lshlrev_b32 v136,16,v180
ds_read_b64_tr_b16 v[230:231],v255 offset:25888
v_and_b32 v180,0xffff0000,v180
v_mfma_f32_16x16x32_bf16 a[48:51],v[212:215],v[0:3],a[48:51]
v_add_f32 v240,v240,v136
v_add_f32 v241,v241,v180
v_mfma_f32_16x16x32_bf16 a[52:55],v[212:215],a[160:163],a[52:55]
buffer_load_dwordx4 v254,s[16:19],s32 offen offset:2688 lds
s_add_u32 s32,s32,0x0001c000
v_mfma_f32_16x16x32_bf16 a[56:59],v[212:215],a[164:167],a[56:59]
s_add_u32 m0,s29,118272
buffer_store_dwordx4 v[144:147],v250,s[20:23],s64 offen sc1
v_lshlrev_b32 v136,16,v181
s_waitcnt lgkmcnt(4)
v_mfma_f32_16x16x32_bf16 a[16:19],v[216:219],v[4:7],a[16:19]
ds_read_b64_tr_b16 v[232:233],v255 offset:29568
v_and_b32 v181,0xffff0000,v181
v_mfma_f32_16x16x32_bf16 a[20:23],v[216:219],a[168:171],a[20:23]
ds_read_b64_tr_b16 v[234:235],v255 offset:30080
v_add_f32 v242,v242,v136
v_mfma_f32_16x16x32_bf16 a[24:27],v[216:219],a[192:195],a[24:27]
ds_read_b64_tr_b16 v[236:237],v255 offset:29600
v_add_f32 v243,v243,v181
ds_read_b64_tr_b16 v[238:239],v255 offset:30112
buffer_load_dwordx4 v254,s[16:19],s32 offen offset:0 lds
v_mfma_f32_16x16x32_bf16 a[48:51],v[220:223],v[4:7],a[48:51]
s_add_u32 m0,m0,0x000000a0
v_lshlrev_b32 v136,16,v182
v_mfma_f32_16x16x32_bf16 a[52:55],v[220:223],a[168:171],a[52:55]
s_add_u32 s20,s20,2048
s_addc_u32 s21,s21,0
v_mfma_f32_16x16x32_bf16 a[56:59],v[220:223],a[192:195],a[56:59]
s_sub_u32 s22,s22,2048
v_and_b32 v182,0xffff0000,v182
v_add_f32 v244,v244,v136
s_waitcnt lgkmcnt(4)
v_mfma_f32_16x16x32_bf16 a[16:19],v[224:227],a[128:131],a[16:19]
ds_read_b64_tr_b16 v[208:209],v255 offset:0
v_add_f32 v245,v245,v182
v_mfma_f32_16x16x32_bf16 a[20:23],v[224:227],a[132:135],a[20:23]
ds_read_b64_tr_b16 v[210:211],v255 offset:512
buffer_load_dwordx4 v254,s[16:19],s32 offen offset:896 lds
v_mfma_f32_16x16x32_bf16 a[24:27],v[224:227],a[136:139],a[24:27]
ds_read_b64_tr_b16 v[212:213],v255 offset:32
s_add_u32 m0,m0,0x000000a0
ds_read_b64_tr_b16 v[214:215],v255 offset:544
v_lshlrev_b32 v136,16,v183
v_mfma_f32_16x16x32_bf16 a[48:51],v[228:231],a[128:131],a[48:51]
buffer_load_dword v137,v142,s[12:15],0 offen sc1
v_and_b32 v183,0xffff0000,v183
v_mfma_f32_16x16x32_bf16 a[52:55],v[228:231],a[132:135],a[52:55]
v_add_f32 v246,v246,v136
v_add_f32 v247,v247,v183
v_mfma_f32_16x16x32_bf16 a[56:59],v[228:231],a[136:139],a[56:59]
s_waitcnt vmcnt(24)
v_lshlrev_b32 v136,16,v184
buffer_load_dwordx4 v254,s[16:19],s32 offen offset:1792 lds
s_waitcnt lgkmcnt(4)
v_mfma_f32_16x16x32_bf16 a[16:19],v[232:235],v[8:11],a[16:19]
ds_read_b64_tr_b16 v[216:217],v255 offset:4224
s_add_u32 m0,m0,0x000000a0
v_mfma_f32_16x16x32_bf16 a[20:23],v[232:235],v[12:15],a[20:23]
ds_read_b64_tr_b16 v[218:219],v255 offset:4736
v_and_b32 v184,0xffff0000,v184
v_mfma_f32_16x16x32_bf16 a[24:27],v[232:235],v[16:19],a[24:27]
ds_read_b64_tr_b16 v[220:221],v255 offset:4256
v_add_f32 v240,v240,v136
ds_read_b64_tr_b16 v[222:223],v255 offset:4768
v_add_f32 v241,v241,v184
v_mfma_f32_16x16x32_bf16 a[48:51],v[236:239],v[8:11],a[48:51]
v_lshlrev_b32 v136,16,v185
v_and_b32 v185,0xffff0000,v185
v_mfma_f32_16x16x32_bf16 a[52:55],v[236:239],v[12:15],a[52:55]
buffer_load_dwordx4 v254,s[16:19],s32 offen offset:2688 lds
s_add_u32 s32,s32,0xfffac080
v_mfma_f32_16x16x32_bf16 a[56:59],v[236:239],v[16:19],a[56:59]
v_add_f32 v242,v242,v136
v_add_f32 v243,v243,v185
v_lshlrev_b32 v136,16,v186
s_waitcnt lgkmcnt(4)
v_mfma_f32_16x16x32_bf16 a[16:19],v[208:211],a[0:3],a[16:19]
ds_read_b64_tr_b16 v[224:225],v255 offset:8448
v_and_b32 v186,0xffff0000,v186
v_mfma_f32_16x16x32_bf16 a[20:23],v[208:211],a[4:7],a[20:23]
ds_read_b64_tr_b16 v[226:227],v255 offset:8960
v_add_f32 v244,v244,v136
v_mfma_f32_16x16x32_bf16 a[24:27],v[208:211],a[8:11],a[24:27]
ds_read_b64_tr_b16 v[228:229],v255 offset:8480
v_add_f32 v245,v245,v186
ds_read_b64_tr_b16 v[230:231],v255 offset:8992
v_lshlrev_b32 v136,16,v187
v_mfma_f32_16x16x32_bf16 a[48:51],v[212:215],a[0:3],a[48:51]
v_and_b32 v187,0xffff0000,v187
v_add_f32 v246,v246,v136
v_mfma_f32_16x16x32_bf16 a[52:55],v[212:215],a[4:7],a[52:55]
v_add_f32 v247,v247,v187
v_lshlrev_b32 v136,16,v188
v_mfma_f32_16x16x32_bf16 a[56:59],v[212:215],a[8:11],a[56:59]
v_and_b32 v188,0xffff0000,v188
v_add_f32 v240,v240,v136
v_add_f32 v241,v241,v188
s_waitcnt lgkmcnt(4)
v_mfma_f32_16x16x32_bf16 a[16:19],v[216:219],a[32:35],a[16:19]
ds_read_b64_tr_b16 v[232:233],v255 offset:12672
v_lshlrev_b32 v136,16,v189
v_mfma_f32_16x16x32_bf16 a[20:23],v[216:219],a[36:39],a[20:23]
ds_read_b64_tr_b16 v[234:235],v255 offset:13184
v_and_b32 v189,0xffff0000,v189
v_mfma_f32_16x16x32_bf16 a[24:27],v[216:219],a[40:43],a[24:27]
ds_read_b64_tr_b16 v[236:237],v255 offset:12704
v_add_f32 v242,v242,v136
ds_read_b64_tr_b16 v[238:239],v255 offset:13216
v_add_f32 v243,v243,v189
v_mfma_f32_16x16x32_bf16 a[48:51],v[220:223],a[32:35],a[48:51]
v_lshlrev_b32 v136,16,v190
v_and_b32 v190,0xffff0000,v190
v_mfma_f32_16x16x32_bf16 a[52:55],v[220:223],a[36:39],a[52:55]
v_add_f32 v244,v244,v136
v_add_f32 v245,v245,v190
v_mfma_f32_16x16x32_bf16 a[56:59],v[220:223],a[40:43],a[56:59]
v_lshlrev_b32 v136,16,v191
v_and_b32 v191,0xffff0000,v191
v_add_f32 v246,v246,v136
s_waitcnt lgkmcnt(4)
v_mfma_f32_16x16x32_bf16 a[16:19],v[224:227],a[64:67],a[16:19]
ds_read_b64_tr_b16 v[208:209],v252 offset:16960
v_add_f32 v247,v247,v191
v_mfma_f32_16x16x32_bf16 a[20:23],v[224:227],a[68:71],a[20:23]
ds_read_b64_tr_b16 v[210:211],v252 offset:17472
s_waitcnt vmcnt(23)
v_mfma_f32_16x16x32_bf16 a[24:27],v[224:227],a[72:75],a[24:27]
ds_read_b64_tr_b16 v[212:213],v252 offset:16992
v_lshlrev_b32 v136,16,v192
ds_read_b64_tr_b16 v[214:215],v252 offset:17504
v_and_b32 v192,0xffff0000,v192
v_mfma_f32_16x16x32_bf16 a[48:51],v[228:231],a[64:67],a[48:51]
v_add_f32 v240,v240,v136
v_add_f32 v241,v241,v192
v_mfma_f32_16x16x32_bf16 a[52:55],v[228:231],a[68:71],a[52:55]
v_lshlrev_b32 v136,16,v193
v_and_b32 v193,0xffff0000,v193
v_mfma_f32_16x16x32_bf16 a[56:59],v[228:231],a[72:75],a[56:59]
v_add_f32 v242,v242,v136
v_add_f32 v243,v243,v193
v_lshlrev_b32 v136,16,v194
s_waitcnt lgkmcnt(4)
v_mfma_f32_16x16x32_bf16 a[16:19],v[232:235],a[96:99],a[16:19]
ds_read_b64_tr_b16 v[216:217],v252 offset:21184
v_and_b32 v194,0xffff0000,v194
v_mfma_f32_16x16x32_bf16 a[20:23],v[232:235],a[100:103],a[20:23]
ds_read_b64_tr_b16 v[218:219],v252 offset:21696
v_add_f32 v244,v244,v136
v_mfma_f32_16x16x32_bf16 a[24:27],v[232:235],a[104:107],a[24:27]
ds_read_b64_tr_b16 v[220:221],v252 offset:21216
v_add_f32 v245,v245,v194
ds_read_b64_tr_b16 v[222:223],v252 offset:21728
v_lshlrev_b32 v136,16,v195
v_mfma_f32_16x16x32_bf16 a[48:51],v[236:239],a[96:99],a[48:51]
v_and_b32 v195,0xffff0000,v195
v_add_f32 v246,v246,v136
v_mfma_f32_16x16x32_bf16 a[52:55],v[236:239],a[100:103],a[52:55]
v_add_f32 v247,v247,v195
v_lshlrev_b32 v136,16,v196
v_mfma_f32_16x16x32_bf16 a[56:59],v[236:239],a[104:107],a[56:59]
v_and_b32 v196,0xffff0000,v196
v_add_f32 v240,v240,v136
v_add_f32 v241,v241,v196
s_waitcnt lgkmcnt(4)
v_mfma_f32_16x16x32_bf16 a[80:83],v[208:211],v[20:23],0
ds_read_b64_tr_b16 v[224:225],v252 offset:25408
v_lshlrev_b32 v136,16,v197
v_mfma_f32_16x16x32_bf16 a[84:87],v[208:211],v[24:27],0
ds_read_b64_tr_b16 v[226:227],v252 offset:25920
v_and_b32 v197,0xffff0000,v197
v_mfma_f32_16x16x32_bf16 a[88:91],v[208:211],v[28:31],0
ds_read_b64_tr_b16 v[228:229],v252 offset:25440
v_add_f32 v242,v242,v136
ds_read_b64_tr_b16 v[230:231],v252 offset:25952
v_add_f32 v243,v243,v197
v_mfma_f32_16x16x32_bf16 a[112:115],v[212:215],v[20:23],0
v_mov_b32 v164,v156
v_mov_b32 v165,v157
v_mfma_f32_16x16x32_bf16 a[116:119],v[212:215],v[24:27],0
v_mov_b32 v166,v158
v_mov_b32 v167,v159
v_mfma_f32_16x16x32_bf16 a[120:123],v[212:215],v[28:31],0
v_accvgpr_read_b32 v128,a16
v_accvgpr_read_b32 v129,a17
v_accvgpr_read_b32 v130,a18
s_waitcnt lgkmcnt(4)
v_mfma_f32_16x16x32_bf16 a[80:83],v[216:219],v[32:35],a[80:83]
ds_read_b64_tr_b16 v[232:233],v252 offset:29632
v_accvgpr_read_b32 v131,a19
v_mfma_f32_16x16x32_bf16 a[84:87],v[216:219],v[36:39],a[84:87]
ds_read_b64_tr_b16 v[234:235],v252 offset:30144
v_accvgpr_read_b32 v132,a48
v_mfma_f32_16x16x32_bf16 a[88:91],v[216:219],v[40:43],a[88:91]
ds_read_b64_tr_b16 v[236:237],v252 offset:29664
v_accvgpr_read_b32 v133,a49
ds_read_b64_tr_b16 v[238:239],v252 offset:30176
v_accvgpr_read_b32 v134,a50
v_mfma_f32_16x16x32_bf16 a[112:115],v[220:223],v[32:35],a[112:115]
v_accvgpr_read_b32 v135,a51
v_cvt_pk_bf16_f32 v156,v128,v129
v_mfma_f32_16x16x32_bf16 a[116:119],v[220:223],v[36:39],a[116:119]
v_cvt_pk_bf16_f32 v157,v130,v131
v_cvt_pk_bf16_f32 v158,v132,v133
v_mfma_f32_16x16x32_bf16 a[120:123],v[220:223],v[40:43],a[120:123]
v_cvt_pk_bf16_f32 v159,v134,v135
buffer_store_dwordx4 v[156:159],v249,s[20:23],s66 offen sc1
v_accvgpr_read_b32 v128,a20
s_waitcnt lgkmcnt(4)
v_mfma_f32_16x16x32_bf16 a[80:83],v[224:227],v[44:47],a[80:83]
ds_read_b64_tr_b16 v[208:209],v252 offset:33856
v_accvgpr_read_b32 v129,a21
v_mfma_f32_16x16x32_bf16 a[84:87],v[224:227],v[48:51],a[84:87]
ds_read_b64_tr_b16 v[210:211],v252 offset:34368
v_accvgpr_read_b32 v130,a22
v_mfma_f32_16x16x32_bf16 a[88:91],v[224:227],v[52:55],a[88:91]
ds_read_b64_tr_b16 v[212:213],v252 offset:33888
v_accvgpr_read_b32 v131,a23
ds_read_b64_tr_b16 v[214:215],v252 offset:34400
v_accvgpr_read_b32 v132,a52
v_mfma_f32_16x16x32_bf16 a[112:115],v[228:231],v[44:47],a[112:115]
s_waitcnt vmcnt(3)
v_accvgpr_read_b32 v133,a53
v_mfma_f32_16x16x32_bf16 a[116:119],v[228:231],v[48:51],a[116:119]
v_cmp_gt_u32 vcc,s67,v137
s_cbranch_vccnz M_stub12
M_back12:
v_mfma_f32_16x16x32_bf16 a[120:123],v[228:231],v[52:55],a[120:123]
buffer_load_dwordx4 v[176:179],v248,s[4:7],s93 offen sc1
v_accvgpr_read_b32 v134,a54
v_accvgpr_read_b32 v135,a55
s_waitcnt lgkmcnt(4)
v_mfma_f32_16x16x32_bf16 a[80:83],v[232:235],v[56:59],a[80:83]
ds_read_b64_tr_b16 v[216:217],v252 offset:38080
v_cvt_pk_bf16_f32 v148,v128,v129
v_mfma_f32_16x16x32_bf16 a[84:87],v[232:235],v[60:63],a[84:87]
ds_read_b64_tr_b16 v[218:219],v252 offset:38592
v_cvt_pk_bf16_f32 v149,v130,v131
v_mfma_f32_16x16x32_bf16 a[88:91],v[232:235],v[64:67],a[88:91]
ds_read_b64_tr_b16 v[220:221],v252 offset:38112
v_cvt_pk_bf16_f32 v150,v132,v133
ds_read_b64_tr_b16 v[222:223],v252 offset:38624
v_cvt_pk_bf16_f32 v151,v134,v135
v_mfma_f32_16x16x32_bf16 a[112:115],v[236:239],v[56:59],a[112:115]
v_lshlrev_b32 v136,16,v198
v_and_b32 v198,0xffff0000,v198
v_mfma_f32_16x16x32_bf16 a[116:119],v[236:239],v[60:63],a[116:119]
v_add_f32 v244,v244,v136
v_add_f32 v245,v245,v198
v_mfma_f32_16x16x32_bf16 a[120:123],v[236:239],v[64:67],a[120:123]
v_lshlrev_b32 v136,16,v199
v_and_b32 v199,0xffff0000,v199
buffer_load_dwordx4 v[180:183],v248,s[4:7],s94 offen sc1
s_waitcnt lgkmcnt(4)
v_mfma_f32_16x16x32_bf16 a[80:83],v[208:211],v[68:71],a[80:83]
ds_read_b64_tr_b16 v[224:225],v252 offset:42304
v_add_f32 v246,v246,v136
v_mfma_f32_16x16x32_bf16 a[84:87],v[208:211],v[72:75],a[84:87]
ds_read_b64_tr_b16 v[226:227],v252 offset:42816
v_add_f32 v247,v247,v199
v_mfma_f32_16x16x32_bf16 a[88:91],v[208:211],v[76:79],a[88:91]
ds_read_b64_tr_b16 v[228:229],v252 offset:42336
buffer_store_dwordx4 v[148:151],v249,s[20:23],s63 offen sc1
ds_read_b64_tr_b16 v[230:231],v252 offset:42848
v_accvgpr_read_b32 v128,a24
v_mfma_f32_16x16x32_bf16 a[112:115],v[212:215],v[68:71],a[112:115]
v_accvgpr_read_b32 v129,a25
v_accvgpr_read_b32 v130,a26
v_mfma_f32_16x16x32_bf16 a[116:119],v[212:215],v[72:75],a[116:119]
v_accvgpr_read_b32 v131,a27
v_accvgpr_read_b32 v132,a56
v_mfma_f32_16x16x32_bf16 a[120:123],v[212:215],v[76:79],a[120:123]
v_accvgpr_read_b32 v133,a57
v_accvgpr_read_b32 v134,a58
v_accvgpr_read_b32 v135,a59
s_waitcnt lgkmcnt(4)
v_mfma_f32_16x16x32_bf16 a[80:83],v[216:219],v[80:83],a[80:83]
ds_read_b64_tr_b16 v[232:233],v252 offset:46528
buffer_load_dwordx4 v[184:187],v248,s[4:7],s95 offen sc1
v_mfma_f32_16x16x32_bf16 a[84:87],v[216:219],v[84:87],a[84:87]
ds_read_b64_tr_b16 v[234:235],v252 offset:47040
v_cvt_pk_bf16_f32 v144,v128,v129
v_mfma_f32_16x16x32_bf16 a[88:91],v[216:219],v[88:91],a[88:91]
ds_read_b64_tr_b16 v[236:237],v252 offset:46560
v_cvt_pk_bf16_f32 v145,v130,v131
ds_read_b64_tr_b16 v[238:239],v252 offset:47072
v_cvt_pk_bf16_f32 v146,v132,v133
v_mfma_f32_16x16x32_bf16 a[112:115],v[220:223],v[80:83],a[112:115]
v_cvt_pk_bf16_f32 v147,v134,v135
s_waitcnt vmcnt(63)
v_mfma_f32_16x16x32_bf16 a[116:119],v[220:223],v[84:87],a[116:119]
v_lshlrev_b32 v136,16,v200
v_and_b32 v200,0xffff0000,v200
v_mfma_f32_16x16x32_bf16 a[120:123],v[220:223],v[88:91],a[120:123]
v_add_f32 v240,v240,v136
v_add_f32 v241,v241,v200
v_lshlrev_b32 v136,16,v201
s_waitcnt lgkmcnt(4)
v_mfma_f32_16x16x32_bf16 a[80:83],v[224:227],v[92:95],a[80:83]
ds_read_b64_tr_b16 v[208:209],v255 offset:16960
v_and_b32 v201,0xffff0000,v201
v_mfma_f32_16x16x32_bf16 a[84:87],v[224:227],v[96:99],a[84:87]
ds_read_b64_tr_b16 v[210:211],v255 offset:17472
buffer_load_dwordx4 v[188:191],v248,s[4:7],s96 offen sc1
v_mfma_f32_16x16x32_bf16 a[88:91],v[224:227],v[100:103],a[88:91]
ds_read_b64_tr_b16 v[212:213],v255 offset:16992
v_add_f32 v242,v242,v136
ds_read_b64_tr_b16 v[214:215],v255 offset:17504
v_add_f32 v243,v243,v201
v_mfma_f32_16x16x32_bf16 a[112:115],v[228:231],v[92:95],a[112:115]
v_lshlrev_b32 v136,16,v202
v_and_b32 v202,0xffff0000,v202
v_mfma_f32_16x16x32_bf16 a[116:119],v[228:231],v[96:99],a[116:119]
v_add_f32 v244,v244,v136
v_add_f32 v245,v245,v202
v_mfma_f32_16x16x32_bf16 a[120:123],v[228:231],v[100:103],a[120:123]
buffer_store_dwordx4 v[144:147],v249,s[20:23],s64 offen sc1
v_lshlrev_b32 v136,16,v203
v_and_b32 v203,0xffff0000,v203
s_waitcnt lgkmcnt(4)
v_mfma_f32_16x16x32_bf16 a[80:83],v[232:235],v[104:107],a[80:83]
ds_read_b64_tr_b16 v[216:217],v255 offset:21184
v_add_f32 v246,v246,v136
v_mfma_f32_16x16x32_bf16 a[84:87],v[232:235],v[108:111],a[84:87]
ds_read_b64_tr_b16 v[218:219],v255 offset:21696
v_add_f32 v247,v247,v203
v_mfma_f32_16x16x32_bf16 a[88:91],v[232:235],v[112:115],a[88:91]
ds_read_b64_tr_b16 v[220:221],v255 offset:21216
buffer_load_dwordx4 v[192:195],v248,s[4:7],s97 offen sc1
ds_read_b64_tr_b16 v[222:223],v255 offset:21728
v_cvt_pk_bf16_f32 v152,v240,v241
v_mfma_f32_16x16x32_bf16 a[112:115],v[236:239],v[104:107],a[112:115]
v_cvt_pk_bf16_f32 v153,v242,v243
v_cvt_pk_bf16_f32 v154,v244,v245
v_mfma_f32_16x16x32_bf16 a[116:119],v[236:239],v[108:111],a[116:119]
v_cvt_pk_bf16_f32 v155,v246,v247
v_mfma_f32_16x16x32_bf16 a[120:123],v[236:239],v[112:115],a[120:123]
v_permlane32_swap_b32 v152,v154
v_permlane32_swap_b32 v153,v155
s_nop 0
v_permlane16_swap_b32 v152,v154
s_waitcnt lgkmcnt(4)
v_mfma_f32_16x16x32_bf16 a[80:83],v[208:211],v[0:3],a[80:83]
ds_read_b64_tr_b16 v[224:225],v255 offset:25408
v_permlane16_swap_b32 v153,v155
v_mfma_f32_16x16x32_bf16 a[84:87],v[208:211],a[160:163],a[84:87]
ds_read_b64_tr_b16 v[226:227],v255 offset:25920
buffer_store_dwordx4 v[152:155],v138,s[8:11],0 offen sc1
v_mfma_f32_16x16x32_bf16 a[88:91],v[208:211],a[164:167],a[88:91]
ds_read_b64_tr_b16 v[228:229],v255 offset:25440
ds_read_b64_tr_b16 v[230:231],v255 offset:25952
buffer_load_dwordx4 v[196:199],v248,s[4:7],s98 offen sc1
v_mfma_f32_16x16x32_bf16 a[112:115],v[212:215],v[0:3],a[112:115]
s_add_u32 s8,s8,128
s_addc_u32 s9,s9,0
v_mfma_f32_16x16x32_bf16 a[116:119],v[212:215],a[160:163],a[116:119]
v_mfma_f32_16x16x32_bf16 a[120:123],v[212:215],a[164:167],a[120:123]
s_waitcnt lgkmcnt(4)
v_mfma_f32_16x16x32_bf16 a[80:83],v[216:219],v[4:7],a[80:83]
ds_read_b64_tr_b16 v[232:233],v255 offset:29632
v_mfma_f32_16x16x32_bf16 a[84:87],v[216:219],a[168:171],a[84:87]
ds_read_b64_tr_b16 v[234:235],v255 offset:30144
v_mfma_f32_16x16x32_bf16 a[88:91],v[216:219],a[192:195],a[88:91]
ds_read_b64_tr_b16 v[236:237],v255 offset:29664
ds_read_b64_tr_b16 v[238:239],v255 offset:30176
v_mfma_f32_16x16x32_bf16 a[112:115],v[220:223],v[4:7],a[112:115]
buffer_load_dwordx4 v[200:203],v248,s[4:7],s99 offen sc1
v_mfma_f32_16x16x32_bf16 a[116:119],v[220:223],a[168:171],a[116:119]
s_add_u32 s4,s4,2048
s_addc_u32 s5,s5,0
v_mfma_f32_16x16x32_bf16 a[120:123],v[220:223],a[192:195],a[120:123]
s_waitcnt lgkmcnt(4)
v_mfma_f32_16x16x32_bf16 a[80:83],v[224:227],a[128:131],a[80:83]
ds_read_b64_tr_b16 v[208:209],v255 offset:64
v_mfma_f32_16x16x32_bf16 a[84:87],v[224:227],a[132:135],a[84:87]
ds_read_b64_tr_b16 v[210:211],v255 offset:576
v_mfma_f32_16x16x32_bf16 a[88:91],v[224:227],a[136:139],a[88:91]
ds_read_b64_tr_b16 v[212:213],v255 offset:96
ds_read_b64_tr_b16 v[214:215],v255 offset:608
v_mfma_f32_16x16x32_bf16 a[112:115],v[228:231],a[128:131],a[112:115]
v_mfma_f32_16x16x32_bf16 a[116:119],v[228:231],a[132:135],a[116:119]
v_mfma_f32_16x16x32_bf16 a[120:123],v[228:231],a[136:139],a[120:123]
s_waitcnt lgkmcnt(4)
v_mfma_f32_16x16x32_bf16 a[80:83],v[232:235],v[8:11],a[80:83]
ds_read_b64_tr_b16 v[216:217],v255 offset:4288
v_mfma_f32_16x16x32_bf16 a[84:87],v[232:235],v[12:15],a[84:87]
ds_read_b64_tr_b16 v[218:219],v255 offset:4800
v_mfma_f32_16x16x32_bf16 a[88:91],v[232:235],v[16:19],a[88:91]
ds_read_b64_tr_b16 v[220:221],v255 offset:4320
ds_read_b64_tr_b16 v[222:223],v255 offset:4832
v_mfma_f32_16x16x32_bf16 a[112:115],v[236:239],v[8:11],a[112:115]
v_mfma_f32_16x16x32_bf16 a[116:119],v[236:239],v[12:15],a[116:119]
v_mfma_f32_16x16x32_bf16 a[120:123],v[236:239],v[16:19],a[120:123]
s_waitcnt lgkmcnt(4)
v_mfma_f32_16x16x32_bf16 a[80:83],v[208:211],a[0:3],a[80:83]
ds_read_b64_tr_b16 v[224:225],v255 offset:8512
v_mfma_f32_16x16x32_bf16 a[84:87],v[208:211],a[4:7],a[84:87]
ds_read_b64_tr_b16 v[226:227],v255 offset:9024
v_mfma_f32_16x16x32_bf16 a[88:91],v[208:211],a[8:11],a[88:91]
ds_read_b64_tr_b16 v[228:229],v255 offset:8544
ds_read_b64_tr_b16 v[230:231],v255 offset:9056
v_mfma_f32_16x16x32_bf16 a[112:115],v[212:215],a[0:3],a[112:115]
v_mfma_f32_16x16x32_bf16 a[116:119],v[212:215],a[4:7],a[116:119]
v_mfma_f32_16x16x32_bf16 a[120:123],v[212:215],a[8:11],a[120:123]
s_waitcnt lgkmcnt(4)
v_mfma_f32_16x16x32_bf16 a[80:83],v[216:219],a[32:35],a[80:83]
ds_read_b64_tr_b16 v[232:233],v255 offset:12736
v_mfma_f32_16x16x32_bf16 a[84:87],v[216:219],a[36:39],a[84:87]
ds_read_b64_tr_b16 v[234:235],v255 offset:13248
v_mfma_f32_16x16x32_bf16 a[88:91],v[216:219],a[40:43],a[88:91]
ds_read_b64_tr_b16 v[236:237],v255 offset:12768
ds_read_b64_tr_b16 v[238:239],v255 offset:13280
v_mfma_f32_16x16x32_bf16 a[112:115],v[220:223],a[32:35],a[112:115]
v_mfma_f32_16x16x32_bf16 a[116:119],v[220:223],a[36:39],a[116:119]
v_mfma_f32_16x16x32_bf16 a[120:123],v[220:223],a[40:43],a[120:123]
s_waitcnt vmcnt(11) lgkmcnt(4)
v_mfma_f32_16x16x32_bf16 a[80:83],v[224:227],a[64:67],a[80:83]
v_mfma_f32_16x16x32_bf16 a[84:87],v[224:227],a[68:71],a[84:87]
s_waitcnt vmcnt(63) lgkmcnt(0)
s_barrier
v_mfma_f32_16x16x32_bf16 a[88:91],v[224:227],a[72:75],a[88:91]
ds_read_b64_tr_b16 v[208:209],v255 offset:33792
v_add_u32 v143,1,v143
ds_read_b64_tr_b16 v[210:211],v255 offset:34304
buffer_store_dword v143,v248,s[24:27],0 offen sc1
v_mfma_f32_16x16x32_bf16 a[112:115],v[228:231],a[64:67],a[112:115]
ds_read_b64_tr_b16 v[212:213],v255 offset:33824
s_add_u32 s67,s67,1
v_mfma_f32_16x16x32_bf16 a[116:119],v[228:231],a[68:71],a[116:119]
ds_read_b64_tr_b16 v[214:215],v255 offset:34336
s_sub_u32 s36,s36,1
v_mfma_f32_16x16x32_bf16 a[120:123],v[228:231],a[72:75],a[120:123]
v_mfma_f32_16x16x32_bf16 a[80:83],v[232:235],a[96:99],a[80:83]
ds_read_b64_tr_b16 v[216:217],v255 offset:38016
v_mfma_f32_16x16x32_bf16 a[84:87],v[232:235],a[100:103],a[84:87]
ds_read_b64_tr_b16 v[218:219],v255 offset:38528
v_mfma_f32_16x16x32_bf16 a[88:91],v[232:235],a[104:107],a[88:91]
ds_read_b64_tr_b16 v[220:221],v255 offset:38048
ds_read_b64_tr_b16 v[222:223],v255 offset:38560
v_mfma_f32_16x16x32_bf16 a[112:115],v[236:239],a[96:99],a[112:115]
v_mfma_f32_16x16x32_bf16 a[116:119],v[236:239],a[100:103],a[116:119]
v_mfma_f32_16x16x32_bf16 a[120:123],v[236:239],a[104:107],a[120:123]
s_cmp_lg_u32 s36,0
s_waitcnt lgkmcnt(4)
s_cbranch_scc1 M_ploop
M_plast:
v_mfma_f32_16x16x32_bf16 a[16:19],v[208:211],v[20:23],0
ds_read_b64_tr_b16 v[224:225],v252 offset:25344
v_mfma_f32_16x16x32_bf16 a[20:23],v[208:211],v[24:27],0
ds_read_b64_tr_b16 v[226:227],v252 offset:25856
v_mfma_f32_16x16x32_bf16 a[24:27],v[208:211],v[28:31],0
ds_read_b64_tr_b16 v[228:229],v252 offset:25376
ds_read_b64_tr_b16 v[230:231],v252 offset:25888
v_mfma_f32_16x16x32_bf16 a[48:51],v[212:215],v[20:23],0
v_accvgpr_read_b32 v128,a80
v_accvgpr_read_b32 v129,a81
v_mfma_f32_16x16x32_bf16 a[52:55],v[212:215],v[24:27],0
v_accvgpr_read_b32 v130,a82
v_accvgpr_read_b32 v131,a83
v_mfma_f32_16x16x32_bf16 a[56:59],v[212:215],v[28:31],0
v_accvgpr_read_b32 v132,a112
v_accvgpr_read_b32 v133,a113
v_accvgpr_read_b32 v134,a114
s_waitcnt lgkmcnt(4)
v_mfma_f32_16x16x32_bf16 a[16:19],v[216:219],v[32:35],a[16:19]
ds_read_b64_tr_b16 v[232:233],v252 offset:29568
v_accvgpr_read_b32 v135,a115
v_mfma_f32_16x16x32_bf16 a[20:23],v[216:219],v[36:39],a[20:23]
ds_read_b64_tr_b16 v[234:235],v252 offset:30080
v_cvt_pk_bf16_f32 v144,v128,v129
v_mfma_f32_16x16x32_bf16 a[24:27],v[216:219],v[40:43],a[24:27]
ds_read_b64_tr_b16 v[236:237],v252 offset:29600
v_cvt_pk_bf16_f32 v145,v130,v131
ds_read_b64_tr_b16 v[238:239],v252 offset:30112
v_cvt_pk_bf16_f32 v146,v132,v133
v_mfma_f32_16x16x32_bf16 a[48:51],v[220:223],v[32:35],a[48:51]
v_cvt_pk_bf16_f32 v147,v134,v135
buffer_store_dwordx4 v[144:147],v250,s[20:23],s62 offen sc1
v_mfma_f32_16x16x32_bf16 a[52:55],v[220:223],v[36:39],a[52:55]
v_accvgpr_read_b32 v128,a84
v_accvgpr_read_b32 v129,a85
v_mfma_f32_16x16x32_bf16 a[56:59],v[220:223],v[40:43],a[56:59]
v_accvgpr_read_b32 v130,a86
v_accvgpr_read_b32 v131,a87
v_accvgpr_read_b32 v132,a116
s_waitcnt lgkmcnt(4)
v_mfma_f32_16x16x32_bf16 a[16:19],v[224:227],v[44:47],a[16:19]
ds_read_b64_tr_b16 v[208:209],v252 offset:33792
v_accvgpr_read_b32 v133,a117
v_mfma_f32_16x16x32_bf16 a[20:23],v[224:227],v[48:51],a[20:23]
ds_read_b64_tr_b16 v[210:211],v252 offset:34304
v_accvgpr_read_b32 v134,a118
v_mfma_f32_16x16x32_bf16 a[24:27],v[224:227],v[52:55],a[24:27]
ds_read_b64_tr_b16 v[212:213],v252 offset:33824
v_accvgpr_read_b32 v135,a119
ds_read_b64_tr_b16 v[214:215],v252 offset:34336
v_cvt_pk_bf16_f32 v148,v128,v129
v_mfma_f32_16x16x32_bf16 a[48:51],v[228:231],v[44:47],a[48:51]
v_cvt_pk_bf16_f32 v149,v130,v131
v_cvt_pk_bf16_f32 v150,v132,v133
v_mfma_f32_16x16x32_bf16 a[52:55],v[228:231],v[48:51],a[52:55]
v_cvt_pk_bf16_f32 v151,v134,v135
v_lshlrev_b32 v240,16,v164
v_mfma_f32_16x16x32_bf16 a[56:59],v[228:231],v[52:55],a[56:59]
v_and_b32 v241,0xffff0000,v164
v_lshlrev_b32 v242,16,v165
v_and_b32 v243,0xffff0000,v165
s_waitcnt lgkmcnt(4)
v_mfma_f32_16x16x32_bf16 a[16:19],v[232:235],v[56:59],a[16:19]
ds_read_b64_tr_b16 v[216:217],v252 offset:38016
v_lshlrev_b32 v244,16,v166
v_mfma_f32_16x16x32_bf16 a[20:23],v[232:235],v[60:63],a[20:23]
ds_read_b64_tr_b16 v[218:219],v252 offset:38528
v_and_b32 v245,0xffff0000,v166
v_mfma_f32_16x16x32_bf16 a[24:27],v[232:235],v[64:67],a[24:27]
ds_read_b64_tr_b16 v[220:221],v252 offset:38048
v_lshlrev_b32 v246,16,v167
ds_read_b64_tr_b16 v[222:223],v252 offset:38560
v_and_b32 v247,0xffff0000,v167
v_mfma_f32_16x16x32_bf16 a[48:51],v[236:239],v[56:59],a[48:51]
s_waitcnt vmcnt(10)
v_lshlrev_b32 v136,16,v176
v_mfma_f32_16x16x32_bf16 a[52:55],v[236:239],v[60:63],a[52:55]
v_and_b32 v176,0xffff0000,v176
v_add_f32 v240,v240,v136
v_mfma_f32_16x16x32_bf16 a[56:59],v[236:239],v[64:67],a[56:59]
buffer_store_dwordx4 v[148:151],v250,s[20:23],s63 offen sc1
v_accvgpr_read_b32 v128,a88
v_accvgpr_read_b32 v129,a89
s_waitcnt lgkmcnt(4)
v_mfma_f32_16x16x32_bf16 a[16:19],v[208:211],v[68:71],a[16:19]
ds_read_b64_tr_b16 v[224:225],v252 offset:42240
v_accvgpr_read_b32 v130,a90
v_mfma_f32_16x16x32_bf16 a[20:23],v[208:211],v[72:75],a[20:23]
ds_read_b64_tr_b16 v[226:227],v252 offset:42752
v_accvgpr_read_b32 v131,a91
v_mfma_f32_16x16x32_bf16 a[24:27],v[208:211],v[76:79],a[24:27]
ds_read_b64_tr_b16 v[228:229],v252 offset:42272
v_accvgpr_read_b32 v132,a120
ds_read_b64_tr_b16 v[230:231],v252 offset:42784
v_accvgpr_read_b32 v133,a121
v_mfma_f32_16x16x32_bf16 a[48:51],v[212:215],v[68:71],a[48:51]
v_accvgpr_read_b32 v134,a122
v_accvgpr_read_b32 v135,a123
v_mfma_f32_16x16x32_bf16 a[52:55],v[212:215],v[72:75],a[52:55]
v_cvt_pk_bf16_f32 v144,v128,v129
v_cvt_pk_bf16_f32 v145,v130,v131
v_mfma_f32_16x16x32_bf16 a[56:59],v[212:215],v[76:79],a[56:59]
v_cvt_pk_bf16_f32 v146,v132,v133
v_cvt_pk_bf16_f32 v147,v134,v135
v_add_f32 v241,v241,v176
s_waitcnt lgkmcnt(4)
v_mfma_f32_16x16x32_bf16 a[16:19],v[216:219],v[80:83],a[16:19]
ds_read_b64_tr_b16 v[232:233],v252 offset:46464
v_lshlrev_b32 v136,16,v177
v_mfma_f32_16x16x32_bf16 a[20:23],v[216:219],v[84:87],a[20:23]
ds_read_b64_tr_b16 v[234:235],v252 offset:46976
v_and_b32 v177,0xffff0000,v177
v_mfma_f32_16x16x32_bf16 a[24:27],v[216:219],v[88:91],a[24:27]
ds_read_b64_tr_b16 v[236:237],v252 offset:46496
v_add_f32 v242,v242,v136
ds_read_b64_tr_b16 v[238:239],v252 offset:47008
v_add_f32 v243,v243,v177
v_mfma_f32_16x16x32_bf16 a[48:51],v[220:223],v[80:83],a[48:51]
v_lshlrev_b32 v136,16,v178
v_and_b32 v178,0xffff0000,v178
v_mfma_f32_16x16x32_bf16 a[52:55],v[220:223],v[84:87],a[52:55]
v_add_f32 v244,v244,v136
v_add_f32 v245,v245,v178
v_mfma_f32_16x16x32_bf16 a[56:59],v[220:223],v[88:91],a[56:59]
v_lshlrev_b32 v136,16,v179
v_and_b32 v179,0xffff0000,v179
v_add_f32 v246,v246,v136
s_waitcnt lgkmcnt(4)
v_mfma_f32_16x16x32_bf16 a[16:19],v[224:227],v[92:95],a[16:19]
ds_read_b64_tr_b16 v[208:209],v255 offset:16896
v_add_f32 v247,v247,v179
v_mfma_f32_16x16x32_bf16 a[20:23],v[224:227],v[96:99],a[20:23]
ds_read_b64_tr_b16 v[210:211],v255 offset:17408
v_lshlrev_b32 v136,16,v180
v_mfma_f32_16x16x32_bf16 a[24:27],v[224:227],v[100:103],a[24:27]
ds_read_b64_tr_b16 v[212:213],v255 offset:16928
buffer_store_dwordx4 v[144:147],v250,s[20:23],s64 offen sc1
ds_read_b64_tr_b16 v[214:215],v255 offset:17440
v_and_b32 v180,0xffff0000,v180
v_mfma_f32_16x16x32_bf16 a[48:51],v[228:231],v[92:95],a[48:51]
buffer_load_dword v137,v142,s[12:15],0 offen sc1
v_add_f32 v240,v240,v136
v_mfma_f32_16x16x32_bf16 a[52:55],v[228:231],v[96:99],a[52:55]
s_add_u32 s20,s20,2048
s_addc_u32 s21,s21,0
v_mfma_f32_16x16x32_bf16 a[56:59],v[228:231],v[100:103],a[56:59]
s_sub_u32 s22,s22,2048
v_add_f32 v241,v241,v180
v_lshlrev_b32 v136,16,v181
s_waitcnt lgkmcnt(4)
v_mfma_f32_16x16x32_bf16 a[16:19],v[232:235],v[104:107],a[16:19]
ds_read_b64_tr_b16 v[216:217],v255 offset:21120
v_and_b32 v181,0xffff0000,v181
v_mfma_f32_16x16x32_bf16 a[20:23],v[232:235],v[108:111],a[20:23]
ds_read_b64_tr_b16 v[218:219],v255 offset:21632
v_add_f32 v242,v242,v136
v_mfma_f32_16x16x32_bf16 a[24:27],v[232:235],v[112:115],a[24:27]
ds_read_b64_tr_b16 v[220:221],v255 offset:21152
v_add_f32 v243,v243,v181
ds_read_b64_tr_b16 v[222:223],v255 offset:21664
v_lshlrev_b32 v136,16,v182
v_mfma_f32_16x16x32_bf16 a[48:51],v[236:239],v[104:107],a[48:51]
v_and_b32 v182,0xffff0000,v182
v_add_f32 v244,v244,v136
v_mfma_f32_16x16x32_bf16 a[52:55],v[236:239],v[108:111],a[52:55]
v_add_f32 v245,v245,v182
v_lshlrev_b32 v136,16,v183
v_mfma_f32_16x16x32_bf16 a[56:59],v[236:239],v[112:115],a[56:59]
v_and_b32 v183,0xffff0000,v183
v_add_f32 v246,v246,v136
v_add_f32 v247,v247,v183
s_waitcnt lgkmcnt(4)
v_mfma_f32_16x16x32_bf16 a[16:19],v[208:211],v[0:3],a[16:19]
ds_read_b64_tr_b16 v[224:225],v255 offset:25344
s_waitcnt vmcnt(10)
v_mfma_f32_16x16x32_bf16 a[20:23],v[208:211],a[160:163],a[20:23]
ds_read_b64_tr_b16 v[226:227],v255 offset:25856
v_lshlrev_b32 v136,16,v184
v_mfma_f32_16x16x32_bf16 a[24:27],v[208:211],a[164:167],a[24:27]
ds_read_b64_tr_b16 v[228:229],v255 offset:25376
v_and_b32 v184,0xffff0000,v184
ds_read_b64_tr_b16 v[230:231],v255 offset:25888
v_add_f32 v240,v240,v136
v_mfma_f32_16x16x32_bf16 a[48:51],v[212:215],v[0:3],a[48:51]
v_add_f32 v241,v241,v184
v_lshlrev_b32 v136,16,v185
v_mfma_f32_16x16x32_bf16 a[52:55],v[212:215],a[160:163],a[52:55]
v_and_b32 v185,0xffff0000,v185
v_add_f32 v242,v242,v136
v_mfma_f32_16x16x32_bf16 a[56:59],v[212:215],a[164:167],a[56:59]
v_add_f32 v243,v243,v185
v_lshlrev_b32 v136,16,v186
v_and_b32 v186,0xffff0000,v186
s_waitcnt lgkmcnt(4)
v_mfma_f32_16x16x32_bf16 a[16:19],v[216:219],v[4:7],a[16:19]
ds_read_b64_tr_b16 v[232:233],v255 offset:29568
v_add_f32 v244,v244,v136
v_mfma_f32_16x16x32_bf16 a[20:23],v[216:219],a[168:171],a[20:23]
ds_read_b64_tr_b16 v[234:235],v255 offset:30080
v_add_f32 v245,v245,v186
v_mfma_f32_16x16x32_bf16 a[24:27],v[216:219],a[192:195],a[24:27]
ds_read_b64_tr_b16 v[236:237],v255 offset:29600
v_lshlrev_b32 v136,16,v187
ds_read_b64_tr_b16 v[238:239],v255 offset:30112
v_and_b32 v187,0xffff0000,v187
v_mfma_f32_16x16x32_bf16 a[48:51],v[220:223],v[4:7],a[48:51]
v_add_f32 v246,v246,v136
v_add_f32 v247,v247,v187
v_mfma_f32_16x16x32_bf16 a[52:55],v[220:223],a[168:171],a[52:55]
v_lshlrev_b32 v136,16,v188
v_and_b32 v188,0xffff0000,v188
v_mfma_f32_16x16x32_bf16 a[56:59],v[220:223],a[192:195],a[56:59]
v_add_f32 v240,v240,v136
v_add_f32 v241,v241,v188
v_lshlrev_b32 v136,16,v189
s_waitcnt lgkmcnt(4)
v_mfma_f32_16x16x32_bf16 a[16:19],v[224:227],a[128:131],a[16:19]
ds_read_b64_tr_b16 v[208:209],v255 offset:0
v_and_b32 v189,0xffff0000,v189
v_mfma_f32_16x16x32_bf16 a[20:23],v[224:227],a[132:135],a[20:23]
ds_read_b64_tr_b16 v[210:211],v255 offset:512
v_add_f32 v242,v242,v136
v_mfma_f32_16x16x32_bf16 a[24:27],v[224:227],a[136:139],a[24:27]
ds_read_b64_tr_b16 v[212:213],v255 offset:32
v_add_f32 v243,v243,v189
ds_read_b64_tr_b16 v[214:215],v255 offset:544
v_lshlrev_b32 v136,16,v190
v_mfma_f32_16x16x32_bf16 a[48:51],v[228:231],a[128:131],a[48:51]
v_and_b32 v190,0xffff0000,v190
v_add_f32 v244,v244,v136
v_mfma_f32_16x16x32_bf16 a[52:55],v[228:231],a[132:135],a[52:55]
v_add_f32 v245,v245,v190
v_lshlrev_b32 v136,16,v191
v_mfma_f32_16x16x32_bf16 a[56:59],v[228:231],a[136:139],a[56:59]
v_and_b32 v191,0xffff0000,v191
v_add_f32 v246,v246,v136
v_add_f32 v247,v247,v191
s_waitcnt lgkmcnt(4)
v_mfma_f32_16x16x32_bf16 a[16:19],v[232:235],v[8:11],a[16:19]
ds_read_b64_tr_b16 v[216:217],v255 offset:4224
s_waitcnt vmcnt(7)
v_mfma_f32_16x16x32_bf16 a[20:23],v[232:235],v[12:15],a[20:23]
ds_read_b64_tr_b16 v[218:219],v255 offset:4736
v_lshlrev_b32 v136,16,v192
v_mfma_f32_16x16x32_bf16 a[24:27],v[232:235],v[16:19],a[24:27]
ds_read_b64_tr_b16 v[220:221],v255 offset:4256
v_and_b32 v192,0xffff0000,v192
ds_read_b64_tr_b16 v[222:223],v255 offset:4768
v_add_f32 v240,v240,v136
v_mfma_f32_16x16x32_bf16 a[48:51],v[236:239],v[8:11],a[48:51]
v_add_f32 v241,v241,v192
v_lshlrev_b32 v136,16,v193
v_mfma_f32_16x16x32_bf16 a[52:55],v[236:239],v[12:15],a[52:55]
v_and_b32 v193,0xffff0000,v193
v_add_f32 v242,v242,v136
v_mfma_f32_16x16x32_bf16 a[56:59],v[236:239],v[16:19],a[56:59]
v_add_f32 v243,v243,v193
v_lshlrev_b32 v136,16,v194
v_and_b32 v194,0xffff0000,v194
s_waitcnt lgkmcnt(4)
v_mfma_f32_16x16x32_bf16 a[16:19],v[208:211],a[0:3],a[16:19]
ds_read_b64_tr_b16 v[224:225],v255 offset:8448
v_add_f32 v244,v244,v136
v_mfma_f32_16x16x32_bf16 a[20:23],v[208:211],a[4:7],a[20:23]
ds_read_b64_tr_b16 v[226:227],v255 offset:8960
v_add_f32 v245,v245,v194
v_mfma_f32_16x16x32_bf16 a[24:27],v[208:211],a[8:11],a[24:27]
ds_read_b64_tr_b16 v[228:229],v255 offset:8480
v_lshlrev_b32 v136,16,v195
ds_read_b64_tr_b16 v[230:231],v255 offset:8992
v_and_b32 v195,0xffff0000,v195
v_mfma_f32_16x16x32_bf16 a[48:51],v[212:215],a[0:3],a[48:51]
v_add_f32 v246,v246,v136
v_add_f32 v247,v247,v195
v_mfma_f32_16x16x32_bf16 a[52:55],v[212:215],a[4:7],a[52:55]
v_lshlrev_b32 v136,16,v196
v_and_b32 v196,0xffff0000,v196
v_mfma_f32_16x16x32_bf16 a[56:59],v[212:215],a[8:11],a[56:59]
v_add_f32 v240,v240,v136
v_add_f32 v241,v241,v196
v_lshlrev_b32 v136,16,v197
s_waitcnt lgkmcnt(4)
v_mfma_f32_16x16x32_bf16 a[16:19],v[216:219],a[32:35],a[16:19]
ds_read_b64_tr_b16 v[232:233],v255 offset:12672
v_and_b32 v197,0xffff0000,v197
v_mfma_f32_16x16x32_bf16 a[20:23],v[216:219],a[36:39],a[20:23]
ds_read_b64_tr_b16 v[234:235],v255 offset:13184
v_add_f32 v242,v242,v136
v_mfma_f32_16x16x32_bf16 a[24:27],v[216:219],a[40:43],a[24:27]
ds_read_b64_tr_b16 v[236:237],v255 offset:12704
v_add_f32 v243,v243,v197
ds_read_b64_tr_b16 v[238:239],v255 offset:13216
v_lshlrev_b32 v136,16,v198
v_mfma_f32_16x16x32_bf16 a[48:51],v[220:223],a[32:35],a[48:51]
v_and_b32 v198,0xffff0000,v198
v_add_f32 v244,v244,v136
v_mfma_f32_16x16x32_bf16 a[52:55],v[220:223],a[36:39],a[52:55]
v_add_f32 v245,v245,v198
v_lshlrev_b32 v136,16,v199
v_mfma_f32_16x16x32_bf16 a[56:59],v[220:223],a[40:43],a[56:59]
v_and_b32 v199,0xffff0000,v199
v_add_f32 v246,v246,v136
v_add_f32 v247,v247,v199
s_waitcnt lgkmcnt(4)
v_mfma_f32_16x16x32_bf16 a[16:19],v[224:227],a[64:67],a[16:19]
s_waitcnt vmcnt(5)
v_lshlrev_b32 v136,16,v200
v_mfma_f32_16x16x32_bf16 a[20:23],v[224:227],a[68:71],a[20:23]
s_waitcnt vmcnt(1) lgkmcnt(0)
s_barrier
v_mfma_f32_16x16x32_bf16 a[24:27],v[224:227],a[72:75],a[24:27]
ds_read_b64_tr_b16 v[208:209],v252 offset:16960
v_and_b32 v200,0xffff0000,v200
ds_read_b64_tr_b16 v[210:211],v252 offset:17472
v_add_f32 v240,v240,v136
v_mfma_f32_16x16x32_bf16 a[48:51],v[228:231],a[64:67],a[48:51]
s_waitcnt vmcnt(0)
ds_read_b64_tr_b16 v[212:213],v252 offset:16992
v_mfma_f32_16x16x32_bf16 a[52:55],v[228:231],a[68:71],a[52:55]
v_cmp_gt_u32 vcc,s67,v137
s_cbranch_vccnz M_stub13
M_back13:
ds_read_b64_tr_b16 v[214:215],v252 offset:17504
v_mfma_f32_16x16x32_bf16 a[56:59],v[228:231],a[72:75],a[56:59]
buffer_load_dwordx4 v[176:179],v248,s[4:7],s93 offen sc1
v_add_f32 v241,v241,v200
v_lshlrev_b32 v136,16,v201
v_and_b32 v201,0xffff0000,v201
v_add_u32 v143,1,v143
buffer_store_dword v143,v248,s[24:27],0 offen sc1
v_mfma_f32_16x16x32_bf16 a[16:19],v[232:235],a[96:99],a[16:19]
ds_read_b64_tr_b16 v[216:217],v252 offset:21184
v_add_f32 v242,v242,v136
v_mfma_f32_16x16x32_bf16 a[20:23],v[232:235],a[100:103],a[20:23]
ds_read_b64_tr_b16 v[218:219],v252 offset:21696
v_add_f32 v243,v243,v201
v_mfma_f32_16x16x32_bf16 a[24:27],v[232:235],a[104:107],a[24:27]
ds_read_b64_tr_b16 v[220:221],v252 offset:21216
v_lshlrev_b32 v136,16,v202
ds_read_b64_tr_b16 v[222:223],v252 offset:21728
v_and_b32 v202,0xffff0000,v202
v_mfma_f32_16x16x32_bf16 a[48:51],v[236:239],a[96:99],a[48:51]
v_add_f32 v244,v244,v136
v_add_f32 v245,v245,v202
v_mfma_f32_16x16x32_bf16 a[52:55],v[236:239],a[100:103],a[52:55]
v_lshlrev_b32 v136,16,v203
v_and_b32 v203,0xffff0000,v203
v_mfma_f32_16x16x32_bf16 a[56:59],v[236:239],a[104:107],a[56:59]
buffer_load_dwordx4 v[180:183],v248,s[4:7],s94 offen sc1
v_add_f32 v246,v246,v136
v_add_f32 v247,v247,v203
s_waitcnt lgkmcnt(4)
v_mfma_f32_16x16x32_bf16 a[80:83],v[208:211],v[20:23],0
ds_read_b64_tr_b16 v[224:225],v252 offset:25408
v_cvt_pk_bf16_f32 v152,v240,v241
v_mfma_f32_16x16x32_bf16 a[84:87],v[208:211],v[24:27],0
ds_read_b64_tr_b16 v[226:227],v252 offset:25920
v_cvt_pk_bf16_f32 v153,v242,v243
v_mfma_f32_16x16x32_bf16 a[88:91],v[208:211],v[28:31],0
ds_read_b64_tr_b16 v[228:229],v252 offset:25440
v_cvt_pk_bf16_f32 v154,v244,v245
ds_read_b64_tr_b16 v[230:231],v252 offset:25952
v_cvt_pk_bf16_f32 v155,v246,v247
v_mfma_f32_16x16x32_bf16 a[112:115],v[212:215],v[20:23],0
v_mov_b32 v164,v156
v_mov_b32 v165,v157
v_mfma_f32_16x16x32_bf16 a[116:119],v[212:215],v[24:27],0
v_mov_b32 v166,v158
v_mov_b32 v167,v159
v_mfma_f32_16x16x32_bf16 a[120:123],v[212:215],v[28:31],0
buffer_load_dwordx4 v[184:187],v248,s[4:7],s95 offen sc1
v_accvgpr_read_b32 v128,a16
v_accvgpr_read_b32 v129,a17
s_waitcnt lgkmcnt(4)
v_mfma_f32_16x16x32_bf16 a[80:83],v[216:219],v[32:35],a[80:83]
ds_read_b64_tr_b16 v[232:233],v252 offset:29632
v_accvgpr_read_b32 v130,a18
v_mfma_f32_16x16x32_bf16 a[84:87],v[216:219],v[36:39],a[84:87]
ds_read_b64_tr_b16 v[234:235],v252 offset:30144
v_accvgpr_read_b32 v131,a19
v_mfma_f32_16x16x32_bf16 a[88:91],v[216:219],v[40:43],a[88:91]
ds_read_b64_tr_b16 v[236:237],v252 offset:29664
v_accvgpr_read_b32 v132,a48
ds_read_b64_tr_b16 v[238:239],v252 offset:30176
v_accvgpr_read_b32 v133,a49
v_mfma_f32_16x16x32_bf16 a[112:115],v[220:223],v[32:35],a[112:115]
v_accvgpr_read_b32 v134,a50
v_accvgpr_read_b32 v135,a51
v_mfma_f32_16x16x32_bf16 a[116:119],v[220:223],v[36:39],a[116:119]
v_cvt_pk_bf16_f32 v156,v128,v129
v_cvt_pk_bf16_f32 v157,v130,v131
v_mfma_f32_16x16x32_bf16 a[120:123],v[220:223],v[40:43],a[120:123]
buffer_load_dwordx4 v[188:191],v248,s[4:7],s96 offen sc1
v_cvt_pk_bf16_f32 v158,v132,v133
v_cvt_pk_bf16_f32 v159,v134,v135
s_waitcnt lgkmcnt(4)
v_mfma_f32_16x16x32_bf16 a[80:83],v[224:227],v[44:47],a[80:83]
ds_read_b64_tr_b16 v[208:209],v252 offset:33856
buffer_store_dwordx4 v[156:159],v249,s[20:23],s66 offen sc1
v_mfma_f32_16x16x32_bf16 a[84:87],v[224:227],v[48:51],a[84:87]
ds_read_b64_tr_b16 v[210:211],v252 offset:34368
v_accvgpr_read_b32 v128,a20
v_mfma_f32_16x16x32_bf16 a[88:91],v[224:227],v[52:55],a[88:91]
ds_read_b64_tr_b16 v[212:213],v252 offset:33888
v_accvgpr_read_b32 v129,a21
ds_read_b64_tr_b16 v[214:215],v252 offset:34400
v_accvgpr_read_b32 v130,a22
v_mfma_f32_16x16x32_bf16 a[112:115],v[228:231],v[44:47],a[112:115]
v_accvgpr_read_b32 v131,a23
v_accvgpr_read_b32 v132,a52
v_mfma_f32_16x16x32_bf16 a[116:119],v[228:231],v[48:51],a[116:119]
v_accvgpr_read_b32 v133,a53
v_accvgpr_read_b32 v134,a54
v_mfma_f32_16x16x32_bf16 a[120:123],v[228:231],v[52:55],a[120:123]
buffer_load_dwordx4 v[192:195],v248,s[4:7],s97 offen sc1
v_accvgpr_read_b32 v135,a55
v_cvt_pk_bf16_f32 v148,v128,v129
s_waitcnt lgkmcnt(4)
v_mfma_f32_16x16x32_bf16 a[80:83],v[232:235],v[56:59],a[80:83]
ds_read_b64_tr_b16 v[216:217],v252 offset:38080
v_cvt_pk_bf16_f32 v149,v130,v131
v_mfma_f32_16x16x32_bf16 a[84:87],v[232:235],v[60:63],a[84:87]
ds_read_b64_tr_b16 v[218:219],v252 offset:38592
v_cvt_pk_bf16_f32 v150,v132,v133
v_mfma_f32_16x16x32_bf16 a[88:91],v[232:235],v[64:67],a[88:91]
ds_read_b64_tr_b16 v[220:221],v252 offset:38112
v_cvt_pk_bf16_f32 v151,v134,v135
ds_read_b64_tr_b16 v[222:223],v252 offset:38624
v_permlane32_swap_b32 v152,v154
v_mfma_f32_16x16x32_bf16 a[112:115],v[236:239],v[56:59],a[112:115]
v_permlane32_swap_b32 v153,v155
s_add_u32 s67,s67,1
v_mfma_f32_16x16x32_bf16 a[116:119],v[236:239],v[60:63],a[116:119]
v_permlane16_swap_b32 v152,v154
v_permlane16_swap_b32 v153,v155
v_mfma_f32_16x16x32_bf16 a[120:123],v[236:239],v[64:67],a[120:123]
buffer_load_dwordx4 v[196:199],v248,s[4:7],s98 offen sc1
s_waitcnt lgkmcnt(4)
v_mfma_f32_16x16x32_bf16 a[80:83],v[208:211],v[68:71],a[80:83]
ds_read_b64_tr_b16 v[224:225],v252 offset:42304
v_mfma_f32_16x16x32_bf16 a[84:87],v[208:211],v[72:75],a[84:87]
ds_read_b64_tr_b16 v[226:227],v252 offset:42816
v_mfma_f32_16x16x32_bf16 a[88:91],v[208:211],v[76:79],a[88:91]
ds_read_b64_tr_b16 v[228:229],v252 offset:42336
buffer_store_dwordx4 v[148:151],v249,s[20:23],s63 offen sc1
ds_read_b64_tr_b16 v[230:231],v252 offset:42848
v_accvgpr_read_b32 v128,a24
v_mfma_f32_16x16x32_bf16 a[112:115],v[212:215],v[68:71],a[112:115]
v_accvgpr_read_b32 v129,a25
v_accvgpr_read_b32 v130,a26
v_mfma_f32_16x16x32_bf16 a[116:119],v[212:215],v[72:75],a[116:119]
v_accvgpr_read_b32 v131,a27
v_accvgpr_read_b32 v132,a56
v_mfma_f32_16x16x32_bf16 a[120:123],v[212:215],v[76:79],a[120:123]
buffer_load_dwordx4 v[200:203],v248,s[4:7],s99 offen sc1
v_accvgpr_read_b32 v133,a57
v_accvgpr_read_b32 v134,a58
s_waitcnt lgkmcnt(4)
v_mfma_f32_16x16x32_bf16 a[80:83],v[216:219],v[80:83],a[80:83]
ds_read_b64_tr_b16 v[232:233],v252 offset:46528
v_accvgpr_read_b32 v135,a59
v_mfma_f32_16x16x32_bf16 a[84:87],v[216:219],v[84:87],a[84:87]
ds_read_b64_tr_b16 v[234:235],v252 offset:47040
v_cvt_pk_bf16_f32 v144,v128,v129
v_mfma_f32_16x16x32_bf16 a[88:91],v[216:219],v[88:91],a[88:91]
ds_read_b64_tr_b16 v[236:237],v252 offset:46560
v_cvt_pk_bf16_f32 v145,v130,v131
ds_read_b64_tr_b16 v[238:239],v252 offset:47072
v_cvt_pk_bf16_f32 v146,v132,v133
v_mfma_f32_16x16x32_bf16 a[112:115],v[220:223],v[80:83],a[112:115]
s_add_u32 s4,s4,2048
s_addc_u32 s5,s5,0
v_mfma_f32_16x16x32_bf16 a[116:119],v[220:223],v[84:87],a[116:119]
v_cvt_pk_bf16_f32 v147,v134,v135
buffer_store_dwordx4 v[152:155],v138,s[8:11],0 offen sc1
v_mfma_f32_16x16x32_bf16 a[120:123],v[220:223],v[88:91],a[120:123]
s_add_u32 s8,s8,128
s_addc_u32 s9,s9,0
s_waitcnt lgkmcnt(4)
v_mfma_f32_16x16x32_bf16 a[80:83],v[224:227],v[92:95],a[80:83]
ds_read_b64_tr_b16 v[208:209],v255 offset:16960
v_mfma_f32_16x16x32_bf16 a[84:87],v[224:227],v[96:99],a[84:87]
ds_read_b64_tr_b16 v[210:211],v255 offset:17472
v_mfma_f32_16x16x32_bf16 a[88:91],v[224:227],v[100:103],a[88:91]
ds_read_b64_tr_b16 v[212:213],v255 offset:16992
ds_read_b64_tr_b16 v[214:215],v255 offset:17504
v_mfma_f32_16x16x32_bf16 a[112:115],v[228:231],v[92:95],a[112:115]
v_mfma_f32_16x16x32_bf16 a[116:119],v[228:231],v[96:99],a[116:119]
v_mfma_f32_16x16x32_bf16 a[120:123],v[228:231],v[100:103],a[120:123]
buffer_store_dwordx4 v[144:147],v249,s[20:23],s64 offen sc1
s_waitcnt lgkmcnt(4)
v_mfma_f32_16x16x32_bf16 a[80:83],v[232:235],v[104:107],a[80:83]
ds_read_b64_tr_b16 v[216:217],v255 offset:21184
v_mfma_f32_16x16x32_bf16 a[84:87],v[232:235],v[108:111],a[84:87]
ds_read_b64_tr_b16 v[218:219],v255 offset:21696
v_mfma_f32_16x16x32_bf16 a[88:91],v[232:235],v[112:115],a[88:91]
ds_read_b64_tr_b16 v[220:221],v255 offset:21216
ds_read_b64_tr_b16 v[222:223],v255 offset:21728
v_mfma_f32_16x16x32_bf16 a[112:115],v[236:239],v[104:107],a[112:115]
v_mfma_f32_16x16x32_bf16 a[116:119],v[236:239],v[108:111],a[116:119]
v_mfma_f32_16x16x32_bf16 a[120:123],v[236:239],v[112:115],a[120:123]
s_waitcnt lgkmcnt(4)
v_mfma_f32_16x16x32_bf16 a[80:83],v[208:211],v[0:3],a[80:83]
ds_read_b64_tr_b16 v[224:225],v255 offset:25408
v_mfma_f32_16x16x32_bf16 a[84:87],v[208:211],a[160:163],a[84:87]
ds_read_b64_tr_b16 v[226:227],v255 offset:25920
v_mfma_f32_16x16x32_bf16 a[88:91],v[208:211],a[164:167],a[88:91]
ds_read_b64_tr_b16 v[228:229],v255 offset:25440
ds_read_b64_tr_b16 v[230:231],v255 offset:25952
v_mfma_f32_16x16x32_bf16 a[112:115],v[212:215],v[0:3],a[112:115]
buffer_load_dword v137,v142,s[12:15],0 offen sc1
v_mfma_f32_16x16x32_bf16 a[116:119],v[212:215],a[160:163],a[116:119]
v_mfma_f32_16x16x32_bf16 a[120:123],v[212:215],a[164:167],a[120:123]
s_waitcnt lgkmcnt(4)
v_mfma_f32_16x16x32_bf16 a[80:83],v[216:219],v[4:7],a[80:83]
ds_read_b64_tr_b16 v[232:233],v255 offset:29632
v_mfma_f32_16x16x32_bf16 a[84:87],v[216:219],a[168:171],a[84:87]
ds_read_b64_tr_b16 v[234:235],v255 offset:30144
v_mfma_f32_16x16x32_bf16 a[88:91],v[216:219],a[192:195],a[88:91]
ds_read_b64_tr_b16 v[236:237],v255 offset:29664
ds_read_b64_tr_b16 v[238:239],v255 offset:30176
v_mfma_f32_16x16x32_bf16 a[112:115],v[220:223],v[4:7],a[112:115]
v_mfma_f32_16x16x32_bf16 a[116:119],v[220:223],a[168:171],a[116:119]
v_mfma_f32_16x16x32_bf16 a[120:123],v[220:223],a[192:195],a[120:123]
s_waitcnt lgkmcnt(4)
v_mfma_f32_16x16x32_bf16 a[80:83],v[224:227],a[128:131],a[80:83]
ds_read_b64_tr_b16 v[208:209],v255 offset:64
v_mfma_f32_16x16x32_bf16 a[84:87],v[224:227],a[132:135],a[84:87]
ds_read_b64_tr_b16 v[210:211],v255 offset:576
v_mfma_f32_16x16x32_bf16 a[88:91],v[224:227],a[136:139],a[88:91]
ds_read_b64_tr_b16 v[212:213],v255 offset:96
ds_read_b64_tr_b16 v[214:215],v255 offset:608
v_mfma_f32_16x16x32_bf16 a[112:115],v[228:231],a[128:131],a[112:115]
v_mfma_f32_16x16x32_bf16 a[116:119],v[228:231],a[132:135],a[116:119]
v_mfma_f32_16x16x32_bf16 a[120:123],v[228:231],a[136:139],a[120:123]
s_waitcnt lgkmcnt(4)
v_mfma_f32_16x16x32_bf16 a[80:83],v[232:235],v[8:11],a[80:83]
ds_read_b64_tr_b16 v[216:217],v255 offset:4288
v_mfma_f32_16x16x32_bf16 a[84:87],v[232:235],v[12:15],a[84:87]
ds_read_b64_tr_b16 v[218:219],v255 offset:4800
v_mfma_f32_16x16x32_bf16 a[88:91],v[232:235],v[16:19],a[88:91]
ds_read_b64_tr_b16 v[220:221],v255 offset:4320
ds_read_b64_tr_b16 v[222:223],v255 offset:4832
v_mfma_f32_16x16x32_bf16 a[112:115],v[236:239],v[8:11],a[112:115]
v_mfma_f32_16x16x32_bf16 a[116:119],v[236:239],v[12:15],a[116:119]
v_mfma_f32_16x16x32_bf16 a[120:123],v[236:239],v[16:19],a[120:123]
s_waitcnt lgkmcnt(4)
v_mfma_f32_16x16x32_bf16 a[80:83],v[208:211],a[0:3],a[80:83]
ds_read_b64_tr_b16 v[224:225],v255 offset:8512
v_mfma_f32_16x16x32_bf16 a[84:87],v[208:211],a[4:7],a[84:87]
ds_read_b64_tr_b16 v[226:227],v255 offset:9024
v_mfma_f32_16x16x32_bf16 a[88:91],v[208:211],a[8:11],a[88:91]
ds_read_b64_tr_b16 v[228:229],v255 offset:8544
ds_read_b64_tr_b16 v[230:231],v255 offset:9056
v_mfma_f32_16x16x32_bf16 a[112:115],v[212:215],a[0:3],a[112:115]
v_mfma_f32_16x16x32_bf16 a[116:119],v[212:215],a[4:7],a[116:119]
v_mfma_f32_16x16x32_bf16 a[120:123],v[212:215],a[8:11],a[120:123]
s_waitcnt lgkmcnt(4)
v_mfma_f32_16x16x32_bf16 a[80:83],v[216:219],a[32:35],a[80:83]
ds_read_b64_tr_b16 v[232:233],v255 offset:12736
v_mfma_f32_16x16x32_bf16 a[84:87],v[216:219],a[36:39],a[84:87]
ds_read_b64_tr_b16 v[234:235],v255 offset:13248
v_mfma_f32_16x16x32_bf16 a[88:91],v[216:219],a[40:43],a[88:91]
ds_read_b64_tr_b16 v[236:237],v255 offset:12768
ds_read_b64_tr_b16 v[238:239],v255 offset:13280
v_mfma_f32_16x16x32_bf16 a[112:115],v[220:223],a[32:35],a[112:115]
v_mfma_f32_16x16x32_bf16 a[116:119],v[220:223],a[36:39],a[116:119]
v_mfma_f32_16x16x32_bf16 a[120:123],v[220:223],a[40:43],a[120:123]
s_waitcnt lgkmcnt(4)
v_mfma_f32_16x16x32_bf16 a[80:83],v[224:227],a[64:67],a[80:83]
v_mfma_f32_16x16x32_bf16 a[84:87],v[224:227],a[68:71],a[84:87]
v_mfma_f32_16x16x32_bf16 a[88:91],v[224:227],a[72:75],a[88:91]
v_mfma_f32_16x16x32_bf16 a[112:115],v[228:231],a[64:67],a[112:115]
v_mfma_f32_16x16x32_bf16 a[116:119],v[228:231],a[68:71],a[116:119]
v_mfma_f32_16x16x32_bf16 a[120:123],v[228:231],a[72:75],a[120:123]
s_waitcnt lgkmcnt(0)
v_mfma_f32_16x16x32_bf16 a[80:83],v[232:235],a[96:99],a[80:83]
v_mfma_f32_16x16x32_bf16 a[84:87],v[232:235],a[100:103],a[84:87]
v_mfma_f32_16x16x32_bf16 a[88:91],v[232:235],a[104:107],a[88:91]
v_mfma_f32_16x16x32_bf16 a[112:115],v[236:239],a[96:99],a[112:115]
v_mfma_f32_16x16x32_bf16 a[116:119],v[236:239],a[100:103],a[116:119]
v_mfma_f32_16x16x32_bf16 a[120:123],v[236:239],a[104:107],a[120:123]
s_waitcnt vmcnt(0)
v_cmp_gt_u32 vcc,s67,v137
s_cbranch_vccnz M_stub14
M_back14:
s_lshl_b32 s58,s39,4
v_cmp_eq_u32 vcc,s58,v142
v_mov_b32 v136,7
s_nop 0
v_cndmask_b32 v140,0,v136,vcc
v_accvgpr_read_b32 v128,a80
v_accvgpr_read_b32 v129,a81
v_accvgpr_read_b32 v130,a82
v_accvgpr_read_b32 v131,a83
v_accvgpr_read_b32 v132,a112
v_accvgpr_read_b32 v133,a113
v_accvgpr_read_b32 v134,a114
v_accvgpr_read_b32 v135,a115
v_cvt_pk_bf16_f32 v144,v128,v129
v_cvt_pk_bf16_f32 v145,v130,v131
v_cvt_pk_bf16_f32 v146,v132,v133
v_cvt_pk_bf16_f32 v147,v134,v135
buffer_store_dwordx4 v[144:147],v250,s[20:23],s62 offen sc1
v_accvgpr_read_b32 v128,a84
v_accvgpr_read_b32 v129,a85
v_accvgpr_read_b32 v130,a86
v_accvgpr_read_b32 v131,a87
v_accvgpr_read_b32 v132,a116
v_accvgpr_read_b32 v133,a117
v_accvgpr_read_b32 v134,a118
v_accvgpr_read_b32 v135,a119
v_cvt_pk_bf16_f32 v148,v128,v129
v_cvt_pk_bf16_f32 v149,v130,v131
v_cvt_pk_bf16_f32 v150,v132,v133
v_cvt_pk_bf16_f32 v151,v134,v135
buffer_store_dwordx4 v[148:151],v250,s[20:23],s63 offen sc1
v_accvgpr_read_b32 v128,a88
v_accvgpr_read_b32 v129,a89
v_accvgpr_read_b32 v130,a90
v_accvgpr_read_b32 v131,a91
v_accvgpr_read_b32 v132,a120
v_accvgpr_read_b32 v133,a121
v_accvgpr_read_b32 v134,a122
v_accvgpr_read_b32 v135,a123
v_cvt_pk_bf16_f32 v144,v128,v129
v_cvt_pk_bf16_f32 v145,v130,v131
v_cvt_pk_bf16_f32 v146,v132,v133
v_cvt_pk_bf16_f32 v147,v134,v135
buffer_store_dwordx4 v[144:147],v250,s[20:23],s64 offen sc1
buffer_load_dwordx4 v[0:3],v248,s[4:7],s93 offen sc1
buffer_load_dwordx4 v[4:7],v248,s[4:7],s94 offen sc1
buffer_load_dwordx4 v[8:11],v248,s[4:7],s95 offen sc1
buffer_load_dwordx4 v[12:15],v248,s[4:7],s96 offen sc1
buffer_load_dwordx4 v[16:19],v248,s[4:7],s97 offen sc1
buffer_load_dwordx4 v[20:23],v248,s[4:7],s98 offen sc1
buffer_load_dwordx4 v[24:27],v248,s[4:7],s99 offen sc1
s_add_u32 s4,s4,2048
s_addc_u32 s5,s5,0
s_waitcnt vmcnt(63)
v_lshlrev_b32 v240,16,v164
v_and_b32 v241,0xffff0000,v164
v_lshlrev_b32 v242,16,v165
v_and_b32 v243,0xffff0000,v165
v_lshlrev_b32 v244,16,v166
v_and_b32 v245,0xffff0000,v166
v_lshlrev_b32 v246,16,v167
v_and_b32 v247,0xffff0000,v167
v_lshlrev_b32 v128,16,v176
v_and_b32 v129,0xffff0000,v176
v_pk_add_f32 v[240:241],v[240:241],v[128:129]
v_lshlrev_b32 v130,16,v177
v_and_b32 v131,0xffff0000,v177
v_pk_add_f32 v[242:243],v[242:243],v[130:131]
v_lshlrev_b32 v132,16,v178
v_and_b32 v133,0xffff0000,v178
v_pk_add_f32 v[244:245],v[244:245],v[132:133]
v_lshlrev_b32 v134,16,v179
v_and_b32 v135,0xffff0000,v179
v_pk_add_f32 v[246:247],v[246:247],v[134:135]
v_lshlrev_b32 v128,16,v180
v_and_b32 v129,0xffff0000,v180
v_pk_add_f32 v[240:241],v[240:241],v[128:129]
v_lshlrev_b32 v130,16,v181
v_and_b32 v131,0xffff0000,v181
v_pk_add_f32 v[242:243],v[242:243],v[130:131]
v_lshlrev_b32 v132,16,v182
v_and_b32 v133,0xffff0000,v182
v_pk_add_f32 v[244:245],v[244:245],v[132:133]
v_lshlrev_b32 v134,16,v183
v_and_b32 v135,0xffff0000,v183
v_pk_add_f32 v[246:247],v[246:247],v[134:135]
v_lshlrev_b32 v128,16,v184
v_and_b32 v129,0xffff0000,v184
v_pk_add_f32 v[240:241],v[240:241],v[128:129]
v_lshlrev_b32 v130,16,v185
v_and_b32 v131,0xffff0000,v185
v_pk_add_f32 v[242:243],v[242:243],v[130:131]
v_lshlrev_b32 v132,16,v186
v_and_b32 v133,0xffff0000,v186
v_pk_add_f32 v[244:245],v[244:245],v[132:133]
v_lshlrev_b32 v134,16,v187
v_and_b32 v135,0xffff0000,v187
v_pk_add_f32 v[246:247],v[246:247],v[134:135]
v_lshlrev_b32 v128,16,v188
v_and_b32 v129,0xffff0000,v188
v_pk_add_f32 v[240:241],v[240:241],v[128:129]
v_lshlrev_b32 v130,16,v189
v_and_b32 v131,0xffff0000,v189
v_pk_add_f32 v[242:243],v[242:243],v[130:131]
v_lshlrev_b32 v132,16,v190
v_and_b32 v133,0xffff0000,v190
v_pk_add_f32 v[244:245],v[244:245],v[132:133]
v_lshlrev_b32 v134,16,v191
v_and_b32 v135,0xffff0000,v191
v_pk_add_f32 v[246:247],v[246:247],v[134:135]
v_lshlrev_b32 v128,16,v192
v_and_b32 v129,0xffff0000,v192
v_pk_add_f32 v[240:241],v[240:241],v[128:129]
v_lshlrev_b32 v130,16,v193
v_and_b32 v131,0xffff0000,v193
v_pk_add_f32 v[242:243],v[242:243],v[130:131]
v_lshlrev_b32 v132,16,v194
v_and_b32 v133,0xffff0000,v194
v_pk_add_f32 v[244:245],v[244:245],v[132:133]
v_lshlrev_b32 v134,16,v195
v_and_b32 v135,0xffff0000,v195
v_pk_add_f32 v[246:247],v[246:247],v[134:135]
v_lshlrev_b32 v128,16,v196
v_and_b32 v129,0xffff0000,v196
v_pk_add_f32 v[240:241],v[240:241],v[128:129]
v_lshlrev_b32 v130,16,v197
v_and_b32 v131,0xffff0000,v197
v_pk_add_f32 v[242:243],v[242:243],v[130:131]
v_lshlrev_b32 v132,16,v198
v_and_b32 v133,0xffff0000,v198
v_pk_add_f32 v[244:245],v[244:245],v[132:133]
v_lshlrev_b32 v134,16,v199
v_and_b32 v135,0xffff0000,v199
v_pk_add_f32 v[246:247],v[246:247],v[134:135]
v_lshlrev_b32 v128,16,v200
v_and_b32 v129,0xffff0000,v200
v_pk_add_f32 v[240:241],v[240:241],v[128:129]
v_lshlrev_b32 v130,16,v201
v_and_b32 v131,0xffff0000,v201
v_pk_add_f32 v[242:243],v[242:243],v[130:131]
v_lshlrev_b32 v132,16,v202
v_and_b32 v133,0xffff0000,v202
v_pk_add_f32 v[244:245],v[244:245],v[132:133]
v_lshlrev_b32 v134,16,v203
v_and_b32 v135,0xffff0000,v203
v_pk_add_f32 v[246:247],v[246:247],v[134:135]
v_cvt_pk_bf16_f32 v152,v240,v241
v_cvt_pk_bf16_f32 v153,v242,v243
v_cvt_pk_bf16_f32 v154,v244,v245
v_cvt_pk_bf16_f32 v155,v246,v247
s_nop 0
v_permlane32_swap_b32 v152,v154
v_permlane32_swap_b32 v153,v155
s_nop 0
v_permlane16_swap_b32 v152,v154
v_permlane16_swap_b32 v153,v155
s_waitcnt vmcnt(7)
s_barrier
v_add_u32 v143,1,v143
buffer_store_dword v143,v248,s[24:27],0 offen sc1
buffer_store_dwordx4 v[152:155],v138,s[8:11],0 offen sc1
s_add_u32 s8,s8,128
s_addc_u32 s9,s9,0
s_mov_b32 s67,7
s_waitcnt vmcnt(2)
buffer_load_dword v137,v142,s[12:15],0 offen sc1
v_lshlrev_b32 v240,16,v160
v_and_b32 v241,0xffff0000,v160
v_lshlrev_b32 v242,16,v161
v_and_b32 v243,0xffff0000,v161
v_lshlrev_b32 v244,16,v162
v_and_b32 v245,0xffff0000,v162
v_lshlrev_b32 v246,16,v163
v_and_b32 v247,0xffff0000,v163
v_lshlrev_b32 v128,16,v0
v_and_b32 v129,0xffff0000,v0
v_pk_add_f32 v[240:241],v[240:241],v[128:129]
v_lshlrev_b32 v130,16,v1
v_and_b32 v131,0xffff0000,v1
v_pk_add_f32 v[242:243],v[242:243],v[130:131]
v_lshlrev_b32 v132,16,v2
v_and_b32 v133,0xffff0000,v2
v_pk_add_f32 v[244:245],v[244:245],v[132:133]
v_lshlrev_b32 v134,16,v3
v_and_b32 v135,0xffff0000,v3
v_pk_add_f32 v[246:247],v[246:247],v[134:135]
v_lshlrev_b32 v128,16,v4
v_and_b32 v129,0xffff0000,v4
v_pk_add_f32 v[240:241],v[240:241],v[128:129]
v_lshlrev_b32 v130,16,v5
v_and_b32 v131,0xffff0000,v5
v_pk_add_f32 v[242:243],v[242:243],v[130:131]
v_lshlrev_b32 v132,16,v6
v_and_b32 v133,0xffff0000,v6
v_pk_add_f32 v[244:245],v[244:245],v[132:133]
v_lshlrev_b32 v134,16,v7
v_and_b32 v135,0xffff0000,v7
v_pk_add_f32 v[246:247],v[246:247],v[134:135]
v_lshlrev_b32 v128,16,v8
v_and_b32 v129,0xffff0000,v8
v_pk_add_f32 v[240:241],v[240:241],v[128:129]
v_lshlrev_b32 v130,16,v9
v_and_b32 v131,0xffff0000,v9
v_pk_add_f32 v[242:243],v[242:243],v[130:131]
v_lshlrev_b32 v132,16,v10
v_and_b32 v133,0xffff0000,v10
v_pk_add_f32 v[244:245],v[244:245],v[132:133]
v_lshlrev_b32 v134,16,v11
v_and_b32 v135,0xffff0000,v11
v_pk_add_f32 v[246:247],v[246:247],v[134:135]
v_lshlrev_b32 v128,16,v12
v_and_b32 v129,0xffff0000,v12
v_pk_add_f32 v[240:241],v[240:241],v[128:129]
v_lshlrev_b32 v130,16,v13
v_and_b32 v131,0xffff0000,v13
v_pk_add_f32 v[242:243],v[242:243],v[130:131]
v_lshlrev_b32 v132,16,v14
v_and_b32 v133,0xffff0000,v14
v_pk_add_f32 v[244:245],v[244:245],v[132:133]
v_lshlrev_b32 v134,16,v15
v_and_b32 v135,0xffff0000,v15
v_pk_add_f32 v[246:247],v[246:247],v[134:135]
v_lshlrev_b32 v128,16,v16
v_and_b32 v129,0xffff0000,v16
v_pk_add_f32 v[240:241],v[240:241],v[128:129]
v_lshlrev_b32 v130,16,v17
v_and_b32 v131,0xffff0000,v17
v_pk_add_f32 v[242:243],v[242:243],v[130:131]
v_lshlrev_b32 v132,16,v18
v_and_b32 v133,0xffff0000,v18
v_pk_add_f32 v[244:245],v[244:245],v[132:133]
v_lshlrev_b32 v134,16,v19
v_and_b32 v135,0xffff0000,v19
v_pk_add_f32 v[246:247],v[246:247],v[134:135]
v_lshlrev_b32 v128,16,v20
v_and_b32 v129,0xffff0000,v20
v_pk_add_f32 v[240:241],v[240:241],v[128:129]
v_lshlrev_b32 v130,16,v21
v_and_b32 v131,0xffff0000,v21
v_pk_add_f32 v[242:243],v[242:243],v[130:131]
v_lshlrev_b32 v132,16,v22
v_and_b32 v133,0xffff0000,v22
v_pk_add_f32 v[244:245],v[244:245],v[132:133]
v_lshlrev_b32 v134,16,v23
v_and_b32 v135,0xffff0000,v23
v_pk_add_f32 v[246:247],v[246:247],v[134:135]
v_lshlrev_b32 v128,16,v24
v_and_b32 v129,0xffff0000,v24
v_pk_add_f32 v[240:241],v[240:241],v[128:129]
v_lshlrev_b32 v130,16,v25
v_and_b32 v131,0xffff0000,v25
v_pk_add_f32 v[242:243],v[242:243],v[130:131]
v_lshlrev_b32 v132,16,v26
v_and_b32 v133,0xffff0000,v26
v_pk_add_f32 v[244:245],v[244:245],v[132:133]
v_lshlrev_b32 v134,16,v27
v_and_b32 v135,0xffff0000,v27
v_pk_add_f32 v[246:247],v[246:247],v[134:135]
v_cvt_pk_bf16_f32 v168,v240,v241
v_cvt_pk_bf16_f32 v169,v242,v243
v_cvt_pk_bf16_f32 v170,v244,v245
v_cvt_pk_bf16_f32 v171,v246,v247
s_nop 0
v_permlane32_swap_b32 v168,v170
v_permlane32_swap_b32 v169,v171
s_nop 0
v_permlane16_swap_b32 v168,v170
v_permlane16_swap_b32 v169,v171
s_waitcnt vmcnt(0)
v_max_u32 v137,v137,v140
v_cmp_gt_u32 vcc,s67,v137
s_cbranch_vccnz M_stub15
M_back15:
buffer_load_dwordx4 v[32:35],v248,s[4:7],s93 offen sc1
buffer_load_dwordx4 v[36:39],v248,s[4:7],s94 offen sc1
buffer_load_dwordx4 v[40:43],v248,s[4:7],s95 offen sc1
buffer_load_dwordx4 v[44:47],v248,s[4:7],s96 offen sc1
buffer_load_dwordx4 v[48:51],v248,s[4:7],s97 offen sc1
buffer_load_dwordx4 v[52:55],v248,s[4:7],s98 offen sc1
buffer_load_dwordx4 v[56:59],v248,s[4:7],s99 offen sc1
s_add_u32 s4,s4,2048
s_addc_u32 s5,s5,0
buffer_store_dwordx4 v[168:171],v138,s[8:11],0 offen sc1
s_add_u32 s8,s8,128
s_addc_u32 s9,s9,0
v_lshlrev_b32 v240,16,v156
v_and_b32 v241,0xffff0000,v156
v_lshlrev_b32 v242,16,v157
v_and_b32 v243,0xffff0000,v157
v_lshlrev_b32 v244,16,v158
v_and_b32 v245,0xffff0000,v158
v_lshlrev_b32 v246,16,v159
v_and_b32 v247,0xffff0000,v159
s_waitcnt vmcnt(7)
v_lshlrev_b32 v128,16,v32
v_and_b32 v129,0xffff0000,v32
v_pk_add_f32 v[240:241],v[240:241],v[128:129]
v_lshlrev_b32 v130,16,v33
v_and_b32 v131,0xffff0000,v33
v_pk_add_f32 v[242:243],v[242:243],v[130:131]
v_lshlrev_b32 v132,16,v34
v_and_b32 v133,0xffff0000,v34
v_pk_add_f32 v[244:245],v[244:245],v[132:133]
v_lshlrev_b32 v134,16,v35
v_and_b32 v135,0xffff0000,v35
v_pk_add_f32 v[246:247],v[246:247],v[134:135]
s_waitcnt vmcnt(6)
v_lshlrev_b32 v128,16,v36
v_and_b32 v129,0xffff0000,v36
v_pk_add_f32 v[240:241],v[240:241],v[128:129]
v_lshlrev_b32 v130,16,v37
v_and_b32 v131,0xffff0000,v37
v_pk_add_f32 v[242:243],v[242:243],v[130:131]
v_lshlrev_b32 v132,16,v38
v_and_b32 v133,0xffff0000,v38
v_pk_add_f32 v[244:245],v[244:245],v[132:133]
v_lshlrev_b32 v134,16,v39
v_and_b32 v135,0xffff0000,v39
v_pk_add_f32 v[246:247],v[246:247],v[134:135]
s_waitcnt vmcnt(5)
v_lshlrev_b32 v128,16,v40
v_and_b32 v129,0xffff0000,v40
v_pk_add_f32 v[240:241],v[240:241],v[128:129]
v_lshlrev_b32 v130,16,v41
v_and_b32 v131,0xffff0000,v41
v_pk_add_f32 v[242:243],v[242:243],v[130:131]
v_lshlrev_b32 v132,16,v42
v_and_b32 v133,0xffff0000,v42
v_pk_add_f32 v[244:245],v[244:245],v[132:133]
v_lshlrev_b32 v134,16,v43
v_and_b32 v135,0xffff0000,v43
v_pk_add_f32 v[246:247],v[246:247],v[134:135]
s_waitcnt vmcnt(4)
v_lshlrev_b32 v128,16,v44
v_and_b32 v129,0xffff0000,v44
v_pk_add_f32 v[240:241],v[240:241],v[128:129]
v_lshlrev_b32 v130,16,v45
v_and_b32 v131,0xffff0000,v45
v_pk_add_f32 v[242:243],v[242:243],v[130:131]
v_lshlrev_b32 v132,16,v46
v_and_b32 v133,0xffff0000,v46
v_pk_add_f32 v[244:245],v[244:245],v[132:133]
v_lshlrev_b32 v134,16,v47
v_and_b32 v135,0xffff0000,v47
v_pk_add_f32 v[246:247],v[246:247],v[134:135]
s_waitcnt vmcnt(3)
v_lshlrev_b32 v128,16,v48
v_and_b32 v129,0xffff0000,v48
v_pk_add_f32 v[240:241],v[240:241],v[128:129]
v_lshlrev_b32 v130,16,v49
v_and_b32 v131,0xffff0000,v49
v_pk_add_f32 v[242:243],v[242:243],v[130:131]
v_lshlrev_b32 v132,16,v50
v_and_b32 v133,0xffff0000,v50
v_pk_add_f32 v[244:245],v[244:245],v[132:133]
v_lshlrev_b32 v134,16,v51
v_and_b32 v135,0xffff0000,v51
v_pk_add_f32 v[246:247],v[246:247],v[134:135]
s_waitcnt vmcnt(2)
v_lshlrev_b32 v128,16,v52
v_and_b32 v129,0xffff0000,v52
v_pk_add_f32 v[240:241],v[240:241],v[128:129]
v_lshlrev_b32 v130,16,v53
v_and_b32 v131,0xffff0000,v53
v_pk_add_f32 v[242:243],v[242:243],v[130:131]
v_lshlrev_b32 v132,16,v54
v_and_b32 v133,0xffff0000,v54
v_pk_add_f32 v[244:245],v[244:245],v[132:133]
v_lshlrev_b32 v134,16,v55
v_and_b32 v135,0xffff0000,v55
v_pk_add_f32 v[246:247],v[246:247],v[134:135]
s_waitcnt vmcnt(1)
v_lshlrev_b32 v128,16,v56
v_and_b32 v129,0xffff0000,v56
v_pk_add_f32 v[240:241],v[240:241],v[128:129]
v_lshlrev_b32 v130,16,v57
v_and_b32 v131,0xffff0000,v57
v_pk_add_f32 v[242:243],v[242:243],v[130:131]
v_lshlrev_b32 v132,16,v58
v_and_b32 v133,0xffff0000,v58
v_pk_add_f32 v[244:245],v[244:245],v[132:133]
v_lshlrev_b32 v134,16,v59
v_and_b32 v135,0xffff0000,v59
v_pk_add_f32 v[246:247],v[246:247],v[134:135]
v_cvt_pk_bf16_f32 v172,v240,v241
v_cvt_pk_bf16_f32 v173,v242,v243
v_cvt_pk_bf16_f32 v174,v244,v245
v_cvt_pk_bf16_f32 v175,v246,v247
s_nop 0
v_permlane32_swap_b32 v172,v174
v_permlane32_swap_b32 v173,v175
s_nop 0
v_permlane16_swap_b32 v172,v174
v_permlane16_swap_b32 v173,v175
buffer_store_dwordx4 v[172:175],v138,s[8:11],0 offen sc1
s_add_u32 s8,s8,128
s_addc_u32 s9,s9,0
M_end:
s_endpgm
M_stub0:
s_call_b64 s[42:43],M_fb1
s_branch M_back0
M_stub1:
s_call_b64 s[42:43],M_fb0
s_branch M_back1
M_stub2:
s_call_b64 s[42:43],M_fb1
s_branch M_back2
M_stub3:
s_call_b64 s[42:43],M_fb0
s_branch M_back3
M_stub4:
s_call_b64 s[42:43],M_fb1
s_branch M_back4
M_stub5:
s_call_b64 s[42:43],M_fb0
s_branch M_back5
M_stub6:
s_call_b64 s[42:43],M_fb1
s_branch M_back6
M_stub7:
s_call_b64 s[42:43],M_fb1
s_branch M_back7
M_stub8:
s_call_b64 s[42:43],M_fb0
s_branch M_back8
M_stub9:
s_call_b64 s[42:43],M_fb1
s_branch M_back9
M_stub10:
s_mov_b32 s60,s67
s_call_b64 s[42:43],M_spinf
s_branch M_back10
M_stub11:
s_mov_b32 s60,s33
s_call_b64 s[42:43],M_spind
s_branch M_back11
M_stub12:
s_mov_b32 s60,s67
s_call_b64 s[42:43],M_spinf
s_branch M_back12
M_stub13:
s_mov_b32 s60,s67
s_call_b64 s[42:43],M_spinf
s_branch M_back13
M_stub14:
s_mov_b32 s60,s67
s_call_b64 s[42:43],M_spinf
s_branch M_back14
M_stub15:
s_mov_b32 s60,s67
s_call_b64 s[42:43],M_spinf
s_branch M_back15
M_fb0:
s_nop 7
s_nop 7
v_max3_f32 v248,v128,v129,v130
v_max3_f32 v248,v248,v131,v144
v_max3_f32 v248,v248,v145,v146
v_max_f32 v248,v248,v147
v_mov_b32 v249,v248
s_nop 1
v_permlane32_swap_b32 v249,v248
v_max_f32 v248,v249,v248
v_mov_b32 v249,v248
s_nop 1
v_permlane16_swap_b32 v249,v248
v_max_f32 v248,v249,v248
v_max_f32 v248,0,v248
v_sub_f32 v249,0,v248
v_exp_f32 v249,v249
v_sub_f32 v128,v128,v248
v_sub_f32 v129,v129,v248
v_sub_f32 v130,v130,v248
v_sub_f32 v131,v131,v248
v_sub_f32 v144,v144,v248
v_sub_f32 v145,v145,v248
v_sub_f32 v146,v146,v248
v_sub_f32 v147,v147,v248
v_sub_f32 v192,v192,v248
v_sub_f32 v193,v193,v248
v_sub_f32 v194,v194,v248
v_sub_f32 v195,v195,v248
v_mul_f32 v240,v240,v249
v_accvgpr_read_b32 v250,a0
v_accvgpr_read_b32 v251,a1
v_mul_f32 v250,v250,v249
v_mul_f32 v251,v251,v249
v_accvgpr_write_b32 a0,v250
v_accvgpr_write_b32 a1,v251
v_accvgpr_read_b32 v250,a2
v_accvgpr_read_b32 v251,a3
v_mul_f32 v250,v250,v249
v_mul_f32 v251,v251,v249
v_accvgpr_write_b32 a2,v250
v_accvgpr_write_b32 a3,v251
v_accvgpr_read_b32 v250,a16
v_accvgpr_read_b32 v251,a17
v_mul_f32 v250,v250,v249
v_mul_f32 v251,v251,v249
v_accvgpr_write_b32 a16,v250
v_accvgpr_write_b32 a17,v251
v_accvgpr_read_b32 v250,a18
v_accvgpr_read_b32 v251,a19
v_mul_f32 v250,v250,v249
v_mul_f32 v251,v251,v249
v_accvgpr_write_b32 a18,v250
v_accvgpr_write_b32 a19,v251
v_accvgpr_read_b32 v250,a32
v_accvgpr_read_b32 v251,a33
v_mul_f32 v250,v250,v249
v_mul_f32 v251,v251,v249
v_accvgpr_write_b32 a32,v250
v_accvgpr_write_b32 a33,v251
v_accvgpr_read_b32 v250,a34
v_accvgpr_read_b32 v251,a35
v_mul_f32 v250,v250,v249
v_mul_f32 v251,v251,v249
v_accvgpr_write_b32 a34,v250
v_accvgpr_write_b32 a35,v251
v_accvgpr_read_b32 v250,a48
v_accvgpr_read_b32 v251,a49
v_mul_f32 v250,v250,v249
v_mul_f32 v251,v251,v249
v_accvgpr_write_b32 a48,v250
v_accvgpr_write_b32 a49,v251
v_accvgpr_read_b32 v250,a50
v_accvgpr_read_b32 v251,a51
v_mul_f32 v250,v250,v249
v_mul_f32 v251,v251,v249
v_accvgpr_write_b32 a50,v250
v_accvgpr_write_b32 a51,v251
v_accvgpr_read_b32 v250,a64
v_accvgpr_read_b32 v251,a65
v_mul_f32 v250,v250,v249
v_mul_f32 v251,v251,v249
v_accvgpr_write_b32 a64,v250
v_accvgpr_write_b32 a65,v251
v_accvgpr_read_b32 v250,a66
v_accvgpr_read_b32 v251,a67
v_mul_f32 v250,v250,v249
v_mul_f32 v251,v251,v249
v_accvgpr_write_b32 a66,v250
v_accvgpr_write_b32 a67,v251
v_accvgpr_read_b32 v250,a80
v_accvgpr_read_b32 v251,a81
v_mul_f32 v250,v250,v249
v_mul_f32 v251,v251,v249
v_accvgpr_write_b32 a80,v250
v_accvgpr_write_b32 a81,v251
v_accvgpr_read_b32 v250,a82
v_accvgpr_read_b32 v251,a83
v_mul_f32 v250,v250,v249
v_mul_f32 v251,v251,v249
v_accvgpr_write_b32 a82,v250
v_accvgpr_write_b32 a83,v251
v_accvgpr_read_b32 v250,a96
v_accvgpr_read_b32 v251,a97
v_mul_f32 v250,v250,v249
v_mul_f32 v251,v251,v249
v_accvgpr_write_b32 a96,v250
v_accvgpr_write_b32 a97,v251
v_accvgpr_read_b32 v250,a98
v_accvgpr_read_b32 v251,a99
v_mul_f32 v250,v250,v249
v_mul_f32 v251,v251,v249
v_accvgpr_write_b32 a98,v250
v_accvgpr_write_b32 a99,v251
v_accvgpr_read_b32 v250,a112
v_accvgpr_read_b32 v251,a113
v_mul_f32 v250,v250,v249
v_mul_f32 v251,v251,v249
v_accvgpr_write_b32 a112,v250
v_accvgpr_write_b32 a113,v251
v_accvgpr_read_b32 v250,a114
v_accvgpr_read_b32 v251,a115
v_mul_f32 v250,v250,v249
v_mul_f32 v251,v251,v249
v_accvgpr_write_b32 a114,v250
v_accvgpr_write_b32 a115,v251
v_accvgpr_read_b32 v250,a128
v_accvgpr_read_b32 v251,a129
v_mul_f32 v250,v250,v249
v_mul_f32 v251,v251,v249
v_accvgpr_write_b32 a128,v250
v_accvgpr_write_b32 a129,v251
v_accvgpr_read_b32 v250,a130
v_accvgpr_read_b32 v251,a131
v_mul_f32 v250,v250,v249
v_mul_f32 v251,v251,v249
v_accvgpr_write_b32 a130,v250
v_accvgpr_write_b32 a131,v251
v_accvgpr_read_b32 v250,a144
v_accvgpr_read_b32 v251,a145
v_mul_f32 v250,v250,v249
v_mul_f32 v251,v251,v249
v_accvgpr_write_b32 a144,v250
v_accvgpr_write_b32 a145,v251
v_accvgpr_read_b32 v250,a146
v_accvgpr_read_b32 v251,a147
v_mul_f32 v250,v250,v249
v_mul_f32 v251,v251,v249
v_accvgpr_write_b32 a146,v250
v_accvgpr_write_b32 a147,v251
v_accvgpr_read_b32 v250,a160
v_accvgpr_read_b32 v251,a161
v_mul_f32 v250,v250,v249
v_mul_f32 v251,v251,v249
v_accvgpr_write_b32 a160,v250
v_accvgpr_write_b32 a161,v251
v_accvgpr_read_b32 v250,a162
v_accvgpr_read_b32 v251,a163
v_mul_f32 v250,v250,v249
v_mul_f32 v251,v251,v249
v_accvgpr_write_b32 a162,v250
v_accvgpr_write_b32 a163,v251
v_accvgpr_read_b32 v250,a176
v_accvgpr_read_b32 v251,a177
v_mul_f32 v250,v250,v249
v_mul_f32 v251,v251,v249
v_accvgpr_write_b32 a176,v250
v_accvgpr_write_b32 a177,v251
v_accvgpr_read_b32 v250,a178
v_accvgpr_read_b32 v251,a179
v_mul_f32 v250,v250,v249
v_mul_f32 v251,v251,v249
v_accvgpr_write_b32 a178,v250
v_accvgpr_write_b32 a179,v251
v_accvgpr_read_b32 v250,a192
v_accvgpr_read_b32 v251,a193
v_mul_f32 v250,v250,v249
v_mul_f32 v251,v251,v249
v_accvgpr_write_b32 a192,v250
v_accvgpr_write_b32 a193,v251
v_accvgpr_read_b32 v250,a194
v_accvgpr_read_b32 v251,a195
v_mul_f32 v250,v250,v249
v_mul_f32 v251,v251,v249
v_accvgpr_write_b32 a194,v250
v_accvgpr_write_b32 a195,v251
v_accvgpr_read_b32 v250,a208
v_accvgpr_read_b32 v251,a209
v_mul_f32 v250,v250,v249
v_mul_f32 v251,v251,v249
v_accvgpr_write_b32 a208,v250
v_accvgpr_write_b32 a209,v251
v_accvgpr_read_b32 v250,a210
v_accvgpr_read_b32 v251,a211
v_mul_f32 v250,v250,v249
v_mul_f32 v251,v251,v249
v_accvgpr_write_b32 a210,v250
v_accvgpr_write_b32 a211,v251
v_accvgpr_read_b32 v250,a224
v_accvgpr_read_b32 v251,a225
v_mul_f32 v250,v250,v249
v_mul_f32 v251,v251,v249
v_accvgpr_write_b32 a224,v250
v_accvgpr_write_b32 a225,v251
v_accvgpr_read_b32 v250,a226
v_accvgpr_read_b32 v251,a227
v_mul_f32 v250,v250,v249
v_mul_f32 v251,v251,v249
v_accvgpr_write_b32 a226,v250
v_accvgpr_write_b32 a227,v251
v_accvgpr_read_b32 v250,a240
v_accvgpr_read_b32 v251,a241
v_mul_f32 v250,v250,v249
v_mul_f32 v251,v251,v249
v_accvgpr_write_b32 a240,v250
v_accvgpr_write_b32 a241,v251
v_accvgpr_read_b32 v250,a242
v_accvgpr_read_b32 v251,a243
v_mul_f32 v250,v250,v249
v_mul_f32 v251,v251,v249
v_accvgpr_write_b32 a242,v250
v_accvgpr_write_b32 a243,v251
v_exp_f32 v128,v128
v_exp_f32 v129,v129
v_exp_f32 v130,v130
v_exp_f32 v131,v131
v_exp_f32 v144,v144
v_exp_f32 v145,v145
v_exp_f32 v146,v146
v_exp_f32 v147,v147
v_add_f32 v244,v128,v129
v_add_f32 v244,v244,v130
v_add_f32 v244,v244,v131
v_add_f32 v244,v244,v144
v_add_f32 v244,v244,v145
v_add_f32 v244,v244,v146
v_add_f32 v244,v244,v147
v_cvt_pk_bf16_f32 v160,v128,v129
v_cvt_pk_bf16_f32 v161,v130,v131
v_cvt_pk_bf16_f32 v162,v144,v145
v_cvt_pk_bf16_f32 v163,v146,v147
v_max3_f32 v248,v132,v133,v134
v_max3_f32 v248,v248,v135,v148
v_max3_f32 v248,v248,v149,v150
v_max_f32 v248,v248,v151
v_mov_b32 v249,v248
s_nop 1
v_permlane32_swap_b32 v249,v248
v_max_f32 v248,v249,v248
v_mov_b32 v249,v248
s_nop 1
v_permlane16_swap_b32 v249,v248
v_max_f32 v248,v249,v248
v_max_f32 v248,0,v248
v_sub_f32 v249,0,v248
v_exp_f32 v249,v249
v_sub_f32 v132,v132,v248
v_sub_f32 v133,v133,v248
v_sub_f32 v134,v134,v248
v_sub_f32 v135,v135,v248
v_sub_f32 v148,v148,v248
v_sub_f32 v149,v149,v248
v_sub_f32 v150,v150,v248
v_sub_f32 v151,v151,v248
v_sub_f32 v196,v196,v248
v_sub_f32 v197,v197,v248
v_sub_f32 v198,v198,v248
v_sub_f32 v199,v199,v248
v_mul_f32 v241,v241,v249
v_accvgpr_read_b32 v250,a4
v_accvgpr_read_b32 v251,a5
v_mul_f32 v250,v250,v249
v_mul_f32 v251,v251,v249
v_accvgpr_write_b32 a4,v250
v_accvgpr_write_b32 a5,v251
v_accvgpr_read_b32 v250,a6
v_accvgpr_read_b32 v251,a7
v_mul_f32 v250,v250,v249
v_mul_f32 v251,v251,v249
v_accvgpr_write_b32 a6,v250
v_accvgpr_write_b32 a7,v251
v_accvgpr_read_b32 v250,a20
v_accvgpr_read_b32 v251,a21
v_mul_f32 v250,v250,v249
v_mul_f32 v251,v251,v249
v_accvgpr_write_b32 a20,v250
v_accvgpr_write_b32 a21,v251
v_accvgpr_read_b32 v250,a22
v_accvgpr_read_b32 v251,a23
v_mul_f32 v250,v250,v249
v_mul_f32 v251,v251,v249
v_accvgpr_write_b32 a22,v250
v_accvgpr_write_b32 a23,v251
v_accvgpr_read_b32 v250,a36
v_accvgpr_read_b32 v251,a37
v_mul_f32 v250,v250,v249
v_mul_f32 v251,v251,v249
v_accvgpr_write_b32 a36,v250
v_accvgpr_write_b32 a37,v251
v_accvgpr_read_b32 v250,a38
v_accvgpr_read_b32 v251,a39
v_mul_f32 v250,v250,v249
v_mul_f32 v251,v251,v249
v_accvgpr_write_b32 a38,v250
v_accvgpr_write_b32 a39,v251
v_accvgpr_read_b32 v250,a52
v_accvgpr_read_b32 v251,a53
v_mul_f32 v250,v250,v249
v_mul_f32 v251,v251,v249
v_accvgpr_write_b32 a52,v250
v_accvgpr_write_b32 a53,v251
v_accvgpr_read_b32 v250,a54
v_accvgpr_read_b32 v251,a55
v_mul_f32 v250,v250,v249
v_mul_f32 v251,v251,v249
v_accvgpr_write_b32 a54,v250
v_accvgpr_write_b32 a55,v251
v_accvgpr_read_b32 v250,a68
v_accvgpr_read_b32 v251,a69
v_mul_f32 v250,v250,v249
v_mul_f32 v251,v251,v249
v_accvgpr_write_b32 a68,v250
v_accvgpr_write_b32 a69,v251
v_accvgpr_read_b32 v250,a70
v_accvgpr_read_b32 v251,a71
v_mul_f32 v250,v250,v249
v_mul_f32 v251,v251,v249
v_accvgpr_write_b32 a70,v250
v_accvgpr_write_b32 a71,v251
v_accvgpr_read_b32 v250,a84
v_accvgpr_read_b32 v251,a85
v_mul_f32 v250,v250,v249
v_mul_f32 v251,v251,v249
v_accvgpr_write_b32 a84,v250
v_accvgpr_write_b32 a85,v251
v_accvgpr_read_b32 v250,a86
v_accvgpr_read_b32 v251,a87
v_mul_f32 v250,v250,v249
v_mul_f32 v251,v251,v249
v_accvgpr_write_b32 a86,v250
v_accvgpr_write_b32 a87,v251
v_accvgpr_read_b32 v250,a100
v_accvgpr_read_b32 v251,a101
v_mul_f32 v250,v250,v249
v_mul_f32 v251,v251,v249
v_accvgpr_write_b32 a100,v250
v_accvgpr_write_b32 a101,v251
v_accvgpr_read_b32 v250,a102
v_accvgpr_read_b32 v251,a103
v_mul_f32 v250,v250,v249
v_mul_f32 v251,v251,v249
v_accvgpr_write_b32 a102,v250
v_accvgpr_write_b32 a103,v251
v_accvgpr_read_b32 v250,a116
v_accvgpr_read_b32 v251,a117
v_mul_f32 v250,v250,v249
v_mul_f32 v251,v251,v249
v_accvgpr_write_b32 a116,v250
v_accvgpr_write_b32 a117,v251
v_accvgpr_read_b32 v250,a118
v_accvgpr_read_b32 v251,a119
v_mul_f32 v250,v250,v249
v_mul_f32 v251,v251,v249
v_accvgpr_write_b32 a118,v250
v_accvgpr_write_b32 a119,v251
v_accvgpr_read_b32 v250,a132
v_accvgpr_read_b32 v251,a133
v_mul_f32 v250,v250,v249
v_mul_f32 v251,v251,v249
v_accvgpr_write_b32 a132,v250
v_accvgpr_write_b32 a133,v251
v_accvgpr_read_b32 v250,a134
v_accvgpr_read_b32 v251,a135
v_mul_f32 v250,v250,v249
v_mul_f32 v251,v251,v249
v_accvgpr_write_b32 a134,v250
v_accvgpr_write_b32 a135,v251
v_accvgpr_read_b32 v250,a148
v_accvgpr_read_b32 v251,a149
v_mul_f32 v250,v250,v249
v_mul_f32 v251,v251,v249
v_accvgpr_write_b32 a148,v250
v_accvgpr_write_b32 a149,v251
v_accvgpr_read_b32 v250,a150
v_accvgpr_read_b32 v251,a151
v_mul_f32 v250,v250,v249
v_mul_f32 v251,v251,v249
v_accvgpr_write_b32 a150,v250
v_accvgpr_write_b32 a151,v251
v_accvgpr_read_b32 v250,a164
v_accvgpr_read_b32 v251,a165
v_mul_f32 v250,v250,v249
v_mul_f32 v251,v251,v249
v_accvgpr_write_b32 a164,v250
v_accvgpr_write_b32 a165,v251
v_accvgpr_read_b32 v250,a166
v_accvgpr_read_b32 v251,a167
v_mul_f32 v250,v250,v249
v_mul_f32 v251,v251,v249
v_accvgpr_write_b32 a166,v250
v_accvgpr_write_b32 a167,v251
v_accvgpr_read_b32 v250,a180
v_accvgpr_read_b32 v251,a181
v_mul_f32 v250,v250,v249
v_mul_f32 v251,v251,v249
v_accvgpr_write_b32 a180,v250
v_accvgpr_write_b32 a181,v251
v_accvgpr_read_b32 v250,a182
v_accvgpr_read_b32 v251,a183
v_mul_f32 v250,v250,v249
v_mul_f32 v251,v251,v249
v_accvgpr_write_b32 a182,v250
v_accvgpr_write_b32 a183,v251
v_accvgpr_read_b32 v250,a196
v_accvgpr_read_b32 v251,a197
v_mul_f32 v250,v250,v249
v_mul_f32 v251,v251,v249
v_accvgpr_write_b32 a196,v250
v_accvgpr_write_b32 a197,v251
v_accvgpr_read_b32 v250,a198
v_accvgpr_read_b32 v251,a199
v_mul_f32 v250,v250,v249
v_mul_f32 v251,v251,v249
v_accvgpr_write_b32 a198,v250
v_accvgpr_write_b32 a199,v251
v_accvgpr_read_b32 v250,a212
v_accvgpr_read_b32 v251,a213
v_mul_f32 v250,v250,v249
v_mul_f32 v251,v251,v249
v_accvgpr_write_b32 a212,v250
v_accvgpr_write_b32 a213,v251
v_accvgpr_read_b32 v250,a214
v_accvgpr_read_b32 v251,a215
v_mul_f32 v250,v250,v249
v_mul_f32 v251,v251,v249
v_accvgpr_write_b32 a214,v250
v_accvgpr_write_b32 a215,v251
v_accvgpr_read_b32 v250,a228
v_accvgpr_read_b32 v251,a229
v_mul_f32 v250,v250,v249
v_mul_f32 v251,v251,v249
v_accvgpr_write_b32 a228,v250
v_accvgpr_write_b32 a229,v251
v_accvgpr_read_b32 v250,a230
v_accvgpr_read_b32 v251,a231
v_mul_f32 v250,v250,v249
v_mul_f32 v251,v251,v249
v_accvgpr_write_b32 a230,v250
v_accvgpr_write_b32 a231,v251
v_accvgpr_read_b32 v250,a244
v_accvgpr_read_b32 v251,a245
v_mul_f32 v250,v250,v249
v_mul_f32 v251,v251,v249
v_accvgpr_write_b32 a244,v250
v_accvgpr_write_b32 a245,v251
v_accvgpr_read_b32 v250,a246
v_accvgpr_read_b32 v251,a247
v_mul_f32 v250,v250,v249
v_mul_f32 v251,v251,v249
v_accvgpr_write_b32 a246,v250
v_accvgpr_write_b32 a247,v251
v_exp_f32 v132,v132
v_exp_f32 v133,v133
v_exp_f32 v134,v134
v_exp_f32 v135,v135
v_exp_f32 v148,v148
v_exp_f32 v149,v149
v_exp_f32 v150,v150
v_exp_f32 v151,v151
v_add_f32 v245,v132,v133
v_add_f32 v245,v245,v134
v_add_f32 v245,v245,v135
v_add_f32 v245,v245,v148
v_add_f32 v245,v245,v149
v_add_f32 v245,v245,v150
v_add_f32 v245,v245,v151
v_cvt_pk_bf16_f32 v164,v132,v133
v_cvt_pk_bf16_f32 v165,v134,v135
v_cvt_pk_bf16_f32 v166,v148,v149
v_cvt_pk_bf16_f32 v167,v150,v151
v_max3_f32 v248,v136,v137,v138
v_max3_f32 v248,v248,v139,v152
v_max3_f32 v248,v248,v153,v154
v_max_f32 v248,v248,v155
v_mov_b32 v249,v248
s_nop 1
v_permlane32_swap_b32 v249,v248
v_max_f32 v248,v249,v248
v_mov_b32 v249,v248
s_nop 1
v_permlane16_swap_b32 v249,v248
v_max_f32 v248,v249,v248
v_max_f32 v248,0,v248
v_sub_f32 v249,0,v248
v_exp_f32 v249,v249
v_sub_f32 v136,v136,v248
v_sub_f32 v137,v137,v248
v_sub_f32 v138,v138,v248
v_sub_f32 v139,v139,v248
v_sub_f32 v152,v152,v248
v_sub_f32 v153,v153,v248
v_sub_f32 v154,v154,v248
v_sub_f32 v155,v155,v248
v_sub_f32 v200,v200,v248
v_sub_f32 v201,v201,v248
v_sub_f32 v202,v202,v248
v_sub_f32 v203,v203,v248
v_mul_f32 v242,v242,v249
v_accvgpr_read_b32 v250,a8
v_accvgpr_read_b32 v251,a9
v_mul_f32 v250,v250,v249
v_mul_f32 v251,v251,v249
v_accvgpr_write_b32 a8,v250
v_accvgpr_write_b32 a9,v251
v_accvgpr_read_b32 v250,a10
v_accvgpr_read_b32 v251,a11
v_mul_f32 v250,v250,v249
v_mul_f32 v251,v251,v249
v_accvgpr_write_b32 a10,v250
v_accvgpr_write_b32 a11,v251
v_accvgpr_read_b32 v250,a24
v_accvgpr_read_b32 v251,a25
v_mul_f32 v250,v250,v249
v_mul_f32 v251,v251,v249
v_accvgpr_write_b32 a24,v250
v_accvgpr_write_b32 a25,v251
v_accvgpr_read_b32 v250,a26
v_accvgpr_read_b32 v251,a27
v_mul_f32 v250,v250,v249
v_mul_f32 v251,v251,v249
v_accvgpr_write_b32 a26,v250
v_accvgpr_write_b32 a27,v251
v_accvgpr_read_b32 v250,a40
v_accvgpr_read_b32 v251,a41
v_mul_f32 v250,v250,v249
v_mul_f32 v251,v251,v249
v_accvgpr_write_b32 a40,v250
v_accvgpr_write_b32 a41,v251
v_accvgpr_read_b32 v250,a42
v_accvgpr_read_b32 v251,a43
v_mul_f32 v250,v250,v249
v_mul_f32 v251,v251,v249
v_accvgpr_write_b32 a42,v250
v_accvgpr_write_b32 a43,v251
v_accvgpr_read_b32 v250,a56
v_accvgpr_read_b32 v251,a57
v_mul_f32 v250,v250,v249
v_mul_f32 v251,v251,v249
v_accvgpr_write_b32 a56,v250
v_accvgpr_write_b32 a57,v251
v_accvgpr_read_b32 v250,a58
v_accvgpr_read_b32 v251,a59
v_mul_f32 v250,v250,v249
v_mul_f32 v251,v251,v249
v_accvgpr_write_b32 a58,v250
v_accvgpr_write_b32 a59,v251
v_accvgpr_read_b32 v250,a72
v_accvgpr_read_b32 v251,a73
v_mul_f32 v250,v250,v249
v_mul_f32 v251,v251,v249
v_accvgpr_write_b32 a72,v250
v_accvgpr_write_b32 a73,v251
v_accvgpr_read_b32 v250,a74
v_accvgpr_read_b32 v251,a75
v_mul_f32 v250,v250,v249
v_mul_f32 v251,v251,v249
v_accvgpr_write_b32 a74,v250
v_accvgpr_write_b32 a75,v251
v_accvgpr_read_b32 v250,a88
v_accvgpr_read_b32 v251,a89
v_mul_f32 v250,v250,v249
v_mul_f32 v251,v251,v249
v_accvgpr_write_b32 a88,v250
v_accvgpr_write_b32 a89,v251
v_accvgpr_read_b32 v250,a90
v_accvgpr_read_b32 v251,a91
v_mul_f32 v250,v250,v249
v_mul_f32 v251,v251,v249
v_accvgpr_write_b32 a90,v250
v_accvgpr_write_b32 a91,v251
v_accvgpr_read_b32 v250,a104
v_accvgpr_read_b32 v251,a105
v_mul_f32 v250,v250,v249
v_mul_f32 v251,v251,v249
v_accvgpr_write_b32 a104,v250
v_accvgpr_write_b32 a105,v251
v_accvgpr_read_b32 v250,a106
v_accvgpr_read_b32 v251,a107
v_mul_f32 v250,v250,v249
v_mul_f32 v251,v251,v249
v_accvgpr_write_b32 a106,v250
v_accvgpr_write_b32 a107,v251
v_accvgpr_read_b32 v250,a120
v_accvgpr_read_b32 v251,a121
v_mul_f32 v250,v250,v249
v_mul_f32 v251,v251,v249
v_accvgpr_write_b32 a120,v250
v_accvgpr_write_b32 a121,v251
v_accvgpr_read_b32 v250,a122
v_accvgpr_read_b32 v251,a123
v_mul_f32 v250,v250,v249
v_mul_f32 v251,v251,v249
v_accvgpr_write_b32 a122,v250
v_accvgpr_write_b32 a123,v251
v_accvgpr_read_b32 v250,a136
v_accvgpr_read_b32 v251,a137
v_mul_f32 v250,v250,v249
v_mul_f32 v251,v251,v249
v_accvgpr_write_b32 a136,v250
v_accvgpr_write_b32 a137,v251
v_accvgpr_read_b32 v250,a138
v_accvgpr_read_b32 v251,a139
v_mul_f32 v250,v250,v249
v_mul_f32 v251,v251,v249
v_accvgpr_write_b32 a138,v250
v_accvgpr_write_b32 a139,v251
v_accvgpr_read_b32 v250,a152
v_accvgpr_read_b32 v251,a153
v_mul_f32 v250,v250,v249
v_mul_f32 v251,v251,v249
v_accvgpr_write_b32 a152,v250
v_accvgpr_write_b32 a153,v251
v_accvgpr_read_b32 v250,a154
v_accvgpr_read_b32 v251,a155
v_mul_f32 v250,v250,v249
v_mul_f32 v251,v251,v249
v_accvgpr_write_b32 a154,v250
v_accvgpr_write_b32 a155,v251
v_accvgpr_read_b32 v250,a168
v_accvgpr_read_b32 v251,a169
v_mul_f32 v250,v250,v249
v_mul_f32 v251,v251,v249
v_accvgpr_write_b32 a168,v250
v_accvgpr_write_b32 a169,v251
v_accvgpr_read_b32 v250,a170
v_accvgpr_read_b32 v251,a171
v_mul_f32 v250,v250,v249
v_mul_f32 v251,v251,v249
v_accvgpr_write_b32 a170,v250
v_accvgpr_write_b32 a171,v251
v_accvgpr_read_b32 v250,a184
v_accvgpr_read_b32 v251,a185
v_mul_f32 v250,v250,v249
v_mul_f32 v251,v251,v249
v_accvgpr_write_b32 a184,v250
v_accvgpr_write_b32 a185,v251
v_accvgpr_read_b32 v250,a186
v_accvgpr_read_b32 v251,a187
v_mul_f32 v250,v250,v249
v_mul_f32 v251,v251,v249
v_accvgpr_write_b32 a186,v250
v_accvgpr_write_b32 a187,v251
v_accvgpr_read_b32 v250,a200
v_accvgpr_read_b32 v251,a201
v_mul_f32 v250,v250,v249
v_mul_f32 v251,v251,v249
v_accvgpr_write_b32 a200,v250
v_accvgpr_write_b32 a201,v251
v_accvgpr_read_b32 v250,a202
v_accvgpr_read_b32 v251,a203
v_mul_f32 v250,v250,v249
v_mul_f32 v251,v251,v249
v_accvgpr_write_b32 a202,v250
v_accvgpr_write_b32 a203,v251
v_accvgpr_read_b32 v250,a216
v_accvgpr_read_b32 v251,a217
v_mul_f32 v250,v250,v249
v_mul_f32 v251,v251,v249
v_accvgpr_write_b32 a216,v250
v_accvgpr_write_b32 a217,v251
v_accvgpr_read_b32 v250,a218
v_accvgpr_read_b32 v251,a219
v_mul_f32 v250,v250,v249
v_mul_f32 v251,v251,v249
v_accvgpr_write_b32 a218,v250
v_accvgpr_write_b32 a219,v251
v_accvgpr_read_b32 v250,a232
v_accvgpr_read_b32 v251,a233
v_mul_f32 v250,v250,v249
v_mul_f32 v251,v251,v249
v_accvgpr_write_b32 a232,v250
v_accvgpr_write_b32 a233,v251
v_accvgpr_read_b32 v250,a234
v_accvgpr_read_b32 v251,a235
v_mul_f32 v250,v250,v249
v_mul_f32 v251,v251,v249
v_accvgpr_write_b32 a234,v250
v_accvgpr_write_b32 a235,v251
v_accvgpr_read_b32 v250,a248
v_accvgpr_read_b32 v251,a249
v_mul_f32 v250,v250,v249
v_mul_f32 v251,v251,v249
v_accvgpr_write_b32 a248,v250
v_accvgpr_write_b32 a249,v251
v_accvgpr_read_b32 v250,a250
v_accvgpr_read_b32 v251,a251
v_mul_f32 v250,v250,v249
v_mul_f32 v251,v251,v249
v_accvgpr_write_b32 a250,v250
v_accvgpr_write_b32 a251,v251
v_exp_f32 v136,v136
v_exp_f32 v137,v137
v_exp_f32 v138,v138
v_exp_f32 v139,v139
v_exp_f32 v152,v152
v_exp_f32 v153,v153
v_exp_f32 v154,v154
v_exp_f32 v155,v155
v_add_f32 v246,v136,v137
v_add_f32 v246,v246,v138
v_add_f32 v246,v246,v139
v_add_f32 v246,v246,v152
v_add_f32 v246,v246,v153
v_add_f32 v246,v246,v154
v_add_f32 v246,v246,v155
v_cvt_pk_bf16_f32 v168,v136,v137
v_cvt_pk_bf16_f32 v169,v138,v139
v_cvt_pk_bf16_f32 v170,v152,v153
v_cvt_pk_bf16_f32 v171,v154,v155
s_nop 3
s_setpc_b64 s[42:43]
M_fb1:
s_nop 7
s_nop 7
v_max3_f32 v248,v128,v129,v130
v_max3_f32 v248,v248,v131,v144
v_max3_f32 v248,v248,v145,v146
v_max_f32 v248,v248,v147
v_mov_b32 v249,v248
s_nop 1
v_permlane32_swap_b32 v249,v248
v_max_f32 v248,v249,v248
v_mov_b32 v249,v248
s_nop 1
v_permlane16_swap_b32 v249,v248
v_max_f32 v248,v249,v248
v_max_f32 v248,0,v248
v_sub_f32 v249,0,v248
v_exp_f32 v249,v249
v_sub_f32 v128,v128,v248
v_sub_f32 v129,v129,v248
v_sub_f32 v130,v130,v248
v_sub_f32 v131,v131,v248
v_sub_f32 v144,v144,v248
v_sub_f32 v145,v145,v248
v_sub_f32 v146,v146,v248
v_sub_f32 v147,v147,v248
v_sub_f32 v192,v192,v248
v_sub_f32 v193,v193,v248
v_sub_f32 v194,v194,v248
v_sub_f32 v195,v195,v248
v_mul_f32 v240,v240,v249
v_accvgpr_read_b32 v250,a0
v_accvgpr_read_b32 v251,a1
v_mul_f32 v250,v250,v249
v_mul_f32 v251,v251,v249
v_accvgpr_write_b32 a0,v250
v_accvgpr_write_b32 a1,v251
v_accvgpr_read_b32 v250,a2
v_accvgpr_read_b32 v251,a3
v_mul_f32 v250,v250,v249
v_mul_f32 v251,v251,v249
v_accvgpr_write_b32 a2,v250
v_accvgpr_write_b32 a3,v251
v_accvgpr_read_b32 v250,a16
v_accvgpr_read_b32 v251,a17
v_mul_f32 v250,v250,v249
v_mul_f32 v251,v251,v249
v_accvgpr_write_b32 a16,v250
v_accvgpr_write_b32 a17,v251
v_accvgpr_read_b32 v250,a18
v_accvgpr_read_b32 v251,a19
v_mul_f32 v250,v250,v249
v_mul_f32 v251,v251,v249
v_accvgpr_write_b32 a18,v250
v_accvgpr_write_b32 a19,v251
v_accvgpr_read_b32 v250,a32
v_accvgpr_read_b32 v251,a33
v_mul_f32 v250,v250,v249
v_mul_f32 v251,v251,v249
v_accvgpr_write_b32 a32,v250
v_accvgpr_write_b32 a33,v251
v_accvgpr_read_b32 v250,a34
v_accvgpr_read_b32 v251,a35
v_mul_f32 v250,v250,v249
v_mul_f32 v251,v251,v249
v_accvgpr_write_b32 a34,v250
v_accvgpr_write_b32 a35,v251
v_accvgpr_read_b32 v250,a48
v_accvgpr_read_b32 v251,a49
v_mul_f32 v250,v250,v249
v_mul_f32 v251,v251,v249
v_accvgpr_write_b32 a48,v250
v_accvgpr_write_b32 a49,v251
v_accvgpr_read_b32 v250,a50
v_accvgpr_read_b32 v251,a51
v_mul_f32 v250,v250,v249
v_mul_f32 v251,v251,v249
v_accvgpr_write_b32 a50,v250
v_accvgpr_write_b32 a51,v251
v_accvgpr_read_b32 v250,a64
v_accvgpr_read_b32 v251,a65
v_mul_f32 v250,v250,v249
v_mul_f32 v251,v251,v249
v_accvgpr_write_b32 a64,v250
v_accvgpr_write_b32 a65,v251
v_accvgpr_read_b32 v250,a66
v_accvgpr_read_b32 v251,a67
v_mul_f32 v250,v250,v249
v_mul_f32 v251,v251,v249
v_accvgpr_write_b32 a66,v250
v_accvgpr_write_b32 a67,v251
v_accvgpr_read_b32 v250,a80
v_accvgpr_read_b32 v251,a81
v_mul_f32 v250,v250,v249
v_mul_f32 v251,v251,v249
v_accvgpr_write_b32 a80,v250
v_accvgpr_write_b32 a81,v251
v_accvgpr_read_b32 v250,a82
v_accvgpr_read_b32 v251,a83
v_mul_f32 v250,v250,v249
v_mul_f32 v251,v251,v249
v_accvgpr_write_b32 a82,v250
v_accvgpr_write_b32 a83,v251
v_accvgpr_read_b32 v250,a96
v_accvgpr_read_b32 v251,a97
v_mul_f32 v250,v250,v249
v_mul_f32 v251,v251,v249
v_accvgpr_write_b32 a96,v250
v_accvgpr_write_b32 a97,v251
v_accvgpr_read_b32 v250,a98
v_accvgpr_read_b32 v251,a99
v_mul_f32 v250,v250,v249
v_mul_f32 v251,v251,v249
v_accvgpr_write_b32 a98,v250
v_accvgpr_write_b32 a99,v251
v_accvgpr_read_b32 v250,a112
v_accvgpr_read_b32 v251,a113
v_mul_f32 v250,v250,v249
v_mul_f32 v251,v251,v249
v_accvgpr_write_b32 a112,v250
v_accvgpr_write_b32 a113,v251
v_accvgpr_read_b32 v250,a114
v_accvgpr_read_b32 v251,a115
v_mul_f32 v250,v250,v249
v_mul_f32 v251,v251,v249
v_accvgpr_write_b32 a114,v250
v_accvgpr_write_b32 a115,v251
v_accvgpr_read_b32 v250,a128
v_accvgpr_read_b32 v251,a129
v_mul_f32 v250,v250,v249
v_mul_f32 v251,v251,v249
v_accvgpr_write_b32 a128,v250
v_accvgpr_write_b32 a129,v251
v_accvgpr_read_b32 v250,a130
v_accvgpr_read_b32 v251,a131
v_mul_f32 v250,v250,v249
v_mul_f32 v251,v251,v249
v_accvgpr_write_b32 a130,v250
v_accvgpr_write_b32 a131,v251
v_accvgpr_read_b32 v250,a144
v_accvgpr_read_b32 v251,a145
v_mul_f32 v250,v250,v249
v_mul_f32 v251,v251,v249
v_accvgpr_write_b32 a144,v250
v_accvgpr_write_b32 a145,v251
v_accvgpr_read_b32 v250,a146
v_accvgpr_read_b32 v251,a147
v_mul_f32 v250,v250,v249
v_mul_f32 v251,v251,v249
v_accvgpr_write_b32 a146,v250
v_accvgpr_write_b32 a147,v251
v_accvgpr_read_b32 v250,a160
v_accvgpr_read_b32 v251,a161
v_mul_f32 v250,v250,v249
v_mul_f32 v251,v251,v249
v_accvgpr_write_b32 a160,v250
v_accvgpr_write_b32 a161,v251
v_accvgpr_read_b32 v250,a162
v_accvgpr_read_b32 v251,a163
v_mul_f32 v250,v250,v249
v_mul_f32 v251,v251,v249
v_accvgpr_write_b32 a162,v250
v_accvgpr_write_b32 a163,v251
v_accvgpr_read_b32 v250,a176
v_accvgpr_read_b32 v251,a177
v_mul_f32 v250,v250,v249
v_mul_f32 v251,v251,v249
v_accvgpr_write_b32 a176,v250
v_accvgpr_write_b32 a177,v251
v_accvgpr_read_b32 v250,a178
v_accvgpr_read_b32 v251,a179
v_mul_f32 v250,v250,v249
v_mul_f32 v251,v251,v249
v_accvgpr_write_b32 a178,v250
v_accvgpr_write_b32 a179,v251
v_accvgpr_read_b32 v250,a192
v_accvgpr_read_b32 v251,a193
v_mul_f32 v250,v250,v249
v_mul_f32 v251,v251,v249
v_accvgpr_write_b32 a192,v250
v_accvgpr_write_b32 a193,v251
v_accvgpr_read_b32 v250,a194
v_accvgpr_read_b32 v251,a195
v_mul_f32 v250,v250,v249
v_mul_f32 v251,v251,v249
v_accvgpr_write_b32 a194,v250
v_accvgpr_write_b32 a195,v251
v_accvgpr_read_b32 v250,a208
v_accvgpr_read_b32 v251,a209
v_mul_f32 v250,v250,v249
v_mul_f32 v251,v251,v249
v_accvgpr_write_b32 a208,v250
v_accvgpr_write_b32 a209,v251
v_accvgpr_read_b32 v250,a210
v_accvgpr_read_b32 v251,a211
v_mul_f32 v250,v250,v249
v_mul_f32 v251,v251,v249
v_accvgpr_write_b32 a210,v250
v_accvgpr_write_b32 a211,v251
v_accvgpr_read_b32 v250,a224
v_accvgpr_read_b32 v251,a225
v_mul_f32 v250,v250,v249
v_mul_f32 v251,v251,v249
v_accvgpr_write_b32 a224,v250
v_accvgpr_write_b32 a225,v251
v_accvgpr_read_b32 v250,a226
v_accvgpr_read_b32 v251,a227
v_mul_f32 v250,v250,v249
v_mul_f32 v251,v251,v249
v_accvgpr_write_b32 a226,v250
v_accvgpr_write_b32 a227,v251
v_accvgpr_read_b32 v250,a240
v_accvgpr_read_b32 v251,a241
v_mul_f32 v250,v250,v249
v_mul_f32 v251,v251,v249
v_accvgpr_write_b32 a240,v250
v_accvgpr_write_b32 a241,v251
v_accvgpr_read_b32 v250,a242
v_accvgpr_read_b32 v251,a243
v_mul_f32 v250,v250,v249
v_mul_f32 v251,v251,v249
v_accvgpr_write_b32 a242,v250
v_accvgpr_write_b32 a243,v251
v_exp_f32 v128,v128
v_exp_f32 v129,v129
v_exp_f32 v130,v130
v_exp_f32 v131,v131
v_exp_f32 v144,v144
v_exp_f32 v145,v145
v_exp_f32 v146,v146
v_exp_f32 v147,v147
v_add_f32 v244,v128,v129
v_add_f32 v244,v244,v130
v_add_f32 v244,v244,v131
v_add_f32 v244,v244,v144
v_add_f32 v244,v244,v145
v_add_f32 v244,v244,v146
v_add_f32 v244,v244,v147
v_cvt_pk_bf16_f32 v176,v128,v129
v_cvt_pk_bf16_f32 v177,v130,v131
v_cvt_pk_bf16_f32 v178,v144,v145
v_cvt_pk_bf16_f32 v179,v146,v147
v_max3_f32 v248,v132,v133,v134
v_max3_f32 v248,v248,v135,v148
v_max3_f32 v248,v248,v149,v150
v_max_f32 v248,v248,v151
v_mov_b32 v249,v248
s_nop 1
v_permlane32_swap_b32 v249,v248
v_max_f32 v248,v249,v248
v_mov_b32 v249,v248
s_nop 1
v_permlane16_swap_b32 v249,v248
v_max_f32 v248,v249,v248
v_max_f32 v248,0,v248
v_sub_f32 v249,0,v248
v_exp_f32 v249,v249
v_sub_f32 v132,v132,v248
v_sub_f32 v133,v133,v248
v_sub_f32 v134,v134,v248
v_sub_f32 v135,v135,v248
v_sub_f32 v148,v148,v248
v_sub_f32 v149,v149,v248
v_sub_f32 v150,v150,v248
v_sub_f32 v151,v151,v248
v_sub_f32 v196,v196,v248
v_sub_f32 v197,v197,v248
v_sub_f32 v198,v198,v248
v_sub_f32 v199,v199,v248
v_mul_f32 v241,v241,v249
v_accvgpr_read_b32 v250,a4
v_accvgpr_read_b32 v251,a5
v_mul_f32 v250,v250,v249
v_mul_f32 v251,v251,v249
v_accvgpr_write_b32 a4,v250
v_accvgpr_write_b32 a5,v251
v_accvgpr_read_b32 v250,a6
v_accvgpr_read_b32 v251,a7
v_mul_f32 v250,v250,v249
v_mul_f32 v251,v251,v249
v_accvgpr_write_b32 a6,v250
v_accvgpr_write_b32 a7,v251
v_accvgpr_read_b32 v250,a20
v_accvgpr_read_b32 v251,a21
v_mul_f32 v250,v250,v249
v_mul_f32 v251,v251,v249
v_accvgpr_write_b32 a20,v250
v_accvgpr_write_b32 a21,v251
v_accvgpr_read_b32 v250,a22
v_accvgpr_read_b32 v251,a23
v_mul_f32 v250,v250,v249
v_mul_f32 v251,v251,v249
v_accvgpr_write_b32 a22,v250
v_accvgpr_write_b32 a23,v251
v_accvgpr_read_b32 v250,a36
v_accvgpr_read_b32 v251,a37
v_mul_f32 v250,v250,v249
v_mul_f32 v251,v251,v249
v_accvgpr_write_b32 a36,v250
v_accvgpr_write_b32 a37,v251
v_accvgpr_read_b32 v250,a38
v_accvgpr_read_b32 v251,a39
v_mul_f32 v250,v250,v249
v_mul_f32 v251,v251,v249
v_accvgpr_write_b32 a38,v250
v_accvgpr_write_b32 a39,v251
v_accvgpr_read_b32 v250,a52
v_accvgpr_read_b32 v251,a53
v_mul_f32 v250,v250,v249
v_mul_f32 v251,v251,v249
v_accvgpr_write_b32 a52,v250
v_accvgpr_write_b32 a53,v251
v_accvgpr_read_b32 v250,a54
v_accvgpr_read_b32 v251,a55
v_mul_f32 v250,v250,v249
v_mul_f32 v251,v251,v249
v_accvgpr_write_b32 a54,v250
v_accvgpr_write_b32 a55,v251
v_accvgpr_read_b32 v250,a68
v_accvgpr_read_b32 v251,a69
v_mul_f32 v250,v250,v249
v_mul_f32 v251,v251,v249
v_accvgpr_write_b32 a68,v250
v_accvgpr_write_b32 a69,v251
v_accvgpr_read_b32 v250,a70
v_accvgpr_read_b32 v251,a71
v_mul_f32 v250,v250,v249
v_mul_f32 v251,v251,v249
v_accvgpr_write_b32 a70,v250
v_accvgpr_write_b32 a71,v251
v_accvgpr_read_b32 v250,a84
v_accvgpr_read_b32 v251,a85
v_mul_f32 v250,v250,v249
v_mul_f32 v251,v251,v249
v_accvgpr_write_b32 a84,v250
v_accvgpr_write_b32 a85,v251
v_accvgpr_read_b32 v250,a86
v_accvgpr_read_b32 v251,a87
v_mul_f32 v250,v250,v249
v_mul_f32 v251,v251,v249
v_accvgpr_write_b32 a86,v250
v_accvgpr_write_b32 a87,v251
v_accvgpr_read_b32 v250,a100
v_accvgpr_read_b32 v251,a101
v_mul_f32 v250,v250,v249
v_mul_f32 v251,v251,v249
v_accvgpr_write_b32 a100,v250
v_accvgpr_write_b32 a101,v251
v_accvgpr_read_b32 v250,a102
v_accvgpr_read_b32 v251,a103
v_mul_f32 v250,v250,v249
v_mul_f32 v251,v251,v249
v_accvgpr_write_b32 a102,v250
v_accvgpr_write_b32 a103,v251
v_accvgpr_read_b32 v250,a116
v_accvgpr_read_b32 v251,a117
v_mul_f32 v250,v250,v249
v_mul_f32 v251,v251,v249
v_accvgpr_write_b32 a116,v250
v_accvgpr_write_b32 a117,v251
v_accvgpr_read_b32 v250,a118
v_accvgpr_read_b32 v251,a119
v_mul_f32 v250,v250,v249
v_mul_f32 v251,v251,v249
v_accvgpr_write_b32 a118,v250
v_accvgpr_write_b32 a119,v251
v_accvgpr_read_b32 v250,a132
v_accvgpr_read_b32 v251,a133
v_mul_f32 v250,v250,v249
v_mul_f32 v251,v251,v249
v_accvgpr_write_b32 a132,v250
v_accvgpr_write_b32 a133,v251
v_accvgpr_read_b32 v250,a134
v_accvgpr_read_b32 v251,a135
v_mul_f32 v250,v250,v249
v_mul_f32 v251,v251,v249
v_accvgpr_write_b32 a134,v250
v_accvgpr_write_b32 a135,v251
v_accvgpr_read_b32 v250,a148
v_accvgpr_read_b32 v251,a149
v_mul_f32 v250,v250,v249
v_mul_f32 v251,v251,v249
v_accvgpr_write_b32 a148,v250
v_accvgpr_write_b32 a149,v251
v_accvgpr_read_b32 v250,a150
v_accvgpr_read_b32 v251,a151
v_mul_f32 v250,v250,v249
v_mul_f32 v251,v251,v249
v_accvgpr_write_b32 a150,v250
v_accvgpr_write_b32 a151,v251
v_accvgpr_read_b32 v250,a164
v_accvgpr_read_b32 v251,a165
v_mul_f32 v250,v250,v249
v_mul_f32 v251,v251,v249
v_accvgpr_write_b32 a164,v250
v_accvgpr_write_b32 a165,v251
v_accvgpr_read_b32 v250,a166
v_accvgpr_read_b32 v251,a167
v_mul_f32 v250,v250,v249
v_mul_f32 v251,v251,v249
v_accvgpr_write_b32 a166,v250
v_accvgpr_write_b32 a167,v251
v_accvgpr_read_b32 v250,a180
v_accvgpr_read_b32 v251,a181
v_mul_f32 v250,v250,v249
v_mul_f32 v251,v251,v249
v_accvgpr_write_b32 a180,v250
v_accvgpr_write_b32 a181,v251
v_accvgpr_read_b32 v250,a182
v_accvgpr_read_b32 v251,a183
v_mul_f32 v250,v250,v249
v_mul_f32 v251,v251,v249
v_accvgpr_write_b32 a182,v250
v_accvgpr_write_b32 a183,v251
v_accvgpr_read_b32 v250,a196
v_accvgpr_read_b32 v251,a197
v_mul_f32 v250,v250,v249
v_mul_f32 v251,v251,v249
v_accvgpr_write_b32 a196,v250
v_accvgpr_write_b32 a197,v251
v_accvgpr_read_b32 v250,a198
v_accvgpr_read_b32 v251,a199
v_mul_f32 v250,v250,v249
v_mul_f32 v251,v251,v249
v_accvgpr_write_b32 a198,v250
v_accvgpr_write_b32 a199,v251
v_accvgpr_read_b32 v250,a212
v_accvgpr_read_b32 v251,a213
v_mul_f32 v250,v250,v249
v_mul_f32 v251,v251,v249
v_accvgpr_write_b32 a212,v250
v_accvgpr_write_b32 a213,v251
v_accvgpr_read_b32 v250,a214
v_accvgpr_read_b32 v251,a215
v_mul_f32 v250,v250,v249
v_mul_f32 v251,v251,v249
v_accvgpr_write_b32 a214,v250
v_accvgpr_write_b32 a215,v251
v_accvgpr_read_b32 v250,a228
v_accvgpr_read_b32 v251,a229
v_mul_f32 v250,v250,v249
v_mul_f32 v251,v251,v249
v_accvgpr_write_b32 a228,v250
v_accvgpr_write_b32 a229,v251
v_accvgpr_read_b32 v250,a230
v_accvgpr_read_b32 v251,a231
v_mul_f32 v250,v250,v249
v_mul_f32 v251,v251,v249
v_accvgpr_write_b32 a230,v250
v_accvgpr_write_b32 a231,v251
v_accvgpr_read_b32 v250,a244
v_accvgpr_read_b32 v251,a245
v_mul_f32 v250,v250,v249
v_mul_f32 v251,v251,v249
v_accvgpr_write_b32 a244,v250
v_accvgpr_write_b32 a245,v251
v_accvgpr_read_b32 v250,a246
v_accvgpr_read_b32 v251,a247
v_mul_f32 v250,v250,v249
v_mul_f32 v251,v251,v249
v_accvgpr_write_b32 a246,v250
v_accvgpr_write_b32 a247,v251
v_exp_f32 v132,v132
v_exp_f32 v133,v133
v_exp_f32 v134,v134
v_exp_f32 v135,v135
v_exp_f32 v148,v148
v_exp_f32 v149,v149
v_exp_f32 v150,v150
v_exp_f32 v151,v151
v_add_f32 v245,v132,v133
v_add_f32 v245,v245,v134
v_add_f32 v245,v245,v135
v_add_f32 v245,v245,v148
v_add_f32 v245,v245,v149
v_add_f32 v245,v245,v150
v_add_f32 v245,v245,v151
v_cvt_pk_bf16_f32 v180,v132,v133
v_cvt_pk_bf16_f32 v181,v134,v135
v_cvt_pk_bf16_f32 v182,v148,v149
v_cvt_pk_bf16_f32 v183,v150,v151
v_max3_f32 v248,v136,v137,v138
v_max3_f32 v248,v248,v139,v152
v_max3_f32 v248,v248,v153,v154
v_max_f32 v248,v248,v155
v_mov_b32 v249,v248
s_nop 1
v_permlane32_swap_b32 v249,v248
v_max_f32 v248,v249,v248
v_mov_b32 v249,v248
s_nop 1
v_permlane16_swap_b32 v249,v248
v_max_f32 v248,v249,v248
v_max_f32 v248,0,v248
v_sub_f32 v249,0,v248
v_exp_f32 v249,v249
v_sub_f32 v136,v136,v248
v_sub_f32 v137,v137,v248
v_sub_f32 v138,v138,v248
v_sub_f32 v139,v139,v248
v_sub_f32 v152,v152,v248
v_sub_f32 v153,v153,v248
v_sub_f32 v154,v154,v248
v_sub_f32 v155,v155,v248
v_sub_f32 v200,v200,v248
v_sub_f32 v201,v201,v248
v_sub_f32 v202,v202,v248
v_sub_f32 v203,v203,v248
v_mul_f32 v242,v242,v249
v_accvgpr_read_b32 v250,a8
v_accvgpr_read_b32 v251,a9
v_mul_f32 v250,v250,v249
v_mul_f32 v251,v251,v249
v_accvgpr_write_b32 a8,v250
v_accvgpr_write_b32 a9,v251
v_accvgpr_read_b32 v250,a10
v_accvgpr_read_b32 v251,a11
v_mul_f32 v250,v250,v249
v_mul_f32 v251,v251,v249
v_accvgpr_write_b32 a10,v250
v_accvgpr_write_b32 a11,v251
v_accvgpr_read_b32 v250,a24
v_accvgpr_read_b32 v251,a25
v_mul_f32 v250,v250,v249
v_mul_f32 v251,v251,v249
v_accvgpr_write_b32 a24,v250
v_accvgpr_write_b32 a25,v251
v_accvgpr_read_b32 v250,a26
v_accvgpr_read_b32 v251,a27
v_mul_f32 v250,v250,v249
v_mul_f32 v251,v251,v249
v_accvgpr_write_b32 a26,v250
v_accvgpr_write_b32 a27,v251
v_accvgpr_read_b32 v250,a40
v_accvgpr_read_b32 v251,a41
v_mul_f32 v250,v250,v249
v_mul_f32 v251,v251,v249
v_accvgpr_write_b32 a40,v250
v_accvgpr_write_b32 a41,v251
v_accvgpr_read_b32 v250,a42
v_accvgpr_read_b32 v251,a43
v_mul_f32 v250,v250,v249
v_mul_f32 v251,v251,v249
v_accvgpr_write_b32 a42,v250
v_accvgpr_write_b32 a43,v251
v_accvgpr_read_b32 v250,a56
v_accvgpr_read_b32 v251,a57
v_mul_f32 v250,v250,v249
v_mul_f32 v251,v251,v249
v_accvgpr_write_b32 a56,v250
v_accvgpr_write_b32 a57,v251
v_accvgpr_read_b32 v250,a58
v_accvgpr_read_b32 v251,a59
v_mul_f32 v250,v250,v249
v_mul_f32 v251,v251,v249
v_accvgpr_write_b32 a58,v250
v_accvgpr_write_b32 a59,v251
v_accvgpr_read_b32 v250,a72
v_accvgpr_read_b32 v251,a73
v_mul_f32 v250,v250,v249
v_mul_f32 v251,v251,v249
v_accvgpr_write_b32 a72,v250
v_accvgpr_write_b32 a73,v251
v_accvgpr_read_b32 v250,a74
v_accvgpr_read_b32 v251,a75
v_mul_f32 v250,v250,v249
v_mul_f32 v251,v251,v249
v_accvgpr_write_b32 a74,v250
v_accvgpr_write_b32 a75,v251
v_accvgpr_read_b32 v250,a88
v_accvgpr_read_b32 v251,a89
v_mul_f32 v250,v250,v249
v_mul_f32 v251,v251,v249
v_accvgpr_write_b32 a88,v250
v_accvgpr_write_b32 a89,v251
v_accvgpr_read_b32 v250,a90
v_accvgpr_read_b32 v251,a91
v_mul_f32 v250,v250,v249
v_mul_f32 v251,v251,v249
v_accvgpr_write_b32 a90,v250
v_accvgpr_write_b32 a91,v251
v_accvgpr_read_b32 v250,a104
v_accvgpr_read_b32 v251,a105
v_mul_f32 v250,v250,v249
v_mul_f32 v251,v251,v249
v_accvgpr_write_b32 a104,v250
v_accvgpr_write_b32 a105,v251
v_accvgpr_read_b32 v250,a106
v_accvgpr_read_b32 v251,a107
v_mul_f32 v250,v250,v249
v_mul_f32 v251,v251,v249
v_accvgpr_write_b32 a106,v250
v_accvgpr_write_b32 a107,v251
v_accvgpr_read_b32 v250,a120
v_accvgpr_read_b32 v251,a121
v_mul_f32 v250,v250,v249
v_mul_f32 v251,v251,v249
v_accvgpr_write_b32 a120,v250
v_accvgpr_write_b32 a121,v251
v_accvgpr_read_b32 v250,a122
v_accvgpr_read_b32 v251,a123
v_mul_f32 v250,v250,v249
v_mul_f32 v251,v251,v249
v_accvgpr_write_b32 a122,v250
v_accvgpr_write_b32 a123,v251
v_accvgpr_read_b32 v250,a136
v_accvgpr_read_b32 v251,a137
v_mul_f32 v250,v250,v249
v_mul_f32 v251,v251,v249
v_accvgpr_write_b32 a136,v250
v_accvgpr_write_b32 a137,v251
v_accvgpr_read_b32 v250,a138
v_accvgpr_read_b32 v251,a139
v_mul_f32 v250,v250,v249
v_mul_f32 v251,v251,v249
v_accvgpr_write_b32 a138,v250
v_accvgpr_write_b32 a139,v251
v_accvgpr_read_b32 v250,a152
v_accvgpr_read_b32 v251,a153
v_mul_f32 v250,v250,v249
v_mul_f32 v251,v251,v249
v_accvgpr_write_b32 a152,v250
v_accvgpr_write_b32 a153,v251
v_accvgpr_read_b32 v250,a154
v_accvgpr_read_b32 v251,a155
v_mul_f32 v250,v250,v249
v_mul_f32 v251,v251,v249
v_accvgpr_write_b32 a154,v250
v_accvgpr_write_b32 a155,v251
v_accvgpr_read_b32 v250,a168
v_accvgpr_read_b32 v251,a169
v_mul_f32 v250,v250,v249
v_mul_f32 v251,v251,v249
v_accvgpr_write_b32 a168,v250
v_accvgpr_write_b32 a169,v251
v_accvgpr_read_b32 v250,a170
v_accvgpr_read_b32 v251,a171
v_mul_f32 v250,v250,v249
v_mul_f32 v251,v251,v249
v_accvgpr_write_b32 a170,v250
v_accvgpr_write_b32 a171,v251
v_accvgpr_read_b32 v250,a184
v_accvgpr_read_b32 v251,a185
v_mul_f32 v250,v250,v249
v_mul_f32 v251,v251,v249
v_accvgpr_write_b32 a184,v250
v_accvgpr_write_b32 a185,v251
v_accvgpr_read_b32 v250,a186
v_accvgpr_read_b32 v251,a187
v_mul_f32 v250,v250,v249
v_mul_f32 v251,v251,v249
v_accvgpr_write_b32 a186,v250
v_accvgpr_write_b32 a187,v251
v_accvgpr_read_b32 v250,a200
v_accvgpr_read_b32 v251,a201
v_mul_f32 v250,v250,v249
v_mul_f32 v251,v251,v249
v_accvgpr_write_b32 a200,v250
v_accvgpr_write_b32 a201,v251
v_accvgpr_read_b32 v250,a202
v_accvgpr_read_b32 v251,a203
v_mul_f32 v250,v250,v249
v_mul_f32 v251,v251,v249
v_accvgpr_write_b32 a202,v250
v_accvgpr_write_b32 a203,v251
v_accvgpr_read_b32 v250,a216
v_accvgpr_read_b32 v251,a217
v_mul_f32 v250,v250,v249
v_mul_f32 v251,v251,v249
v_accvgpr_write_b32 a216,v250
v_accvgpr_write_b32 a217,v251
v_accvgpr_read_b32 v250,a218
v_accvgpr_read_b32 v251,a219
v_mul_f32 v250,v250,v249
v_mul_f32 v251,v251,v249
v_accvgpr_write_b32 a218,v250
v_accvgpr_write_b32 a219,v251
v_accvgpr_read_b32 v250,a232
v_accvgpr_read_b32 v251,a233
v_mul_f32 v250,v250,v249
v_mul_f32 v251,v251,v249
v_accvgpr_write_b32 a232,v250
v_accvgpr_write_b32 a233,v251
v_accvgpr_read_b32 v250,a234
v_accvgpr_read_b32 v251,a235
v_mul_f32 v250,v250,v249
v_mul_f32 v251,v251,v249
v_accvgpr_write_b32 a234,v250
v_accvgpr_write_b32 a235,v251
v_accvgpr_read_b32 v250,a248
v_accvgpr_read_b32 v251,a249
v_mul_f32 v250,v250,v249
v_mul_f32 v251,v251,v249
v_accvgpr_write_b32 a248,v250
v_accvgpr_write_b32 a249,v251
v_accvgpr_read_b32 v250,a250
v_accvgpr_read_b32 v251,a251
v_mul_f32 v250,v250,v249
v_mul_f32 v251,v251,v249
v_accvgpr_write_b32 a250,v250
v_accvgpr_write_b32 a251,v251
v_exp_f32 v136,v136
v_exp_f32 v137,v137
v_exp_f32 v138,v138
v_exp_f32 v139,v139
v_exp_f32 v152,v152
v_exp_f32 v153,v153
v_exp_f32 v154,v154
v_exp_f32 v155,v155
v_add_f32 v246,v136,v137
v_add_f32 v246,v246,v138
v_add_f32 v246,v246,v139
v_add_f32 v246,v246,v152
v_add_f32 v246,v246,v153
v_add_f32 v246,v246,v154
v_add_f32 v246,v246,v155
v_cvt_pk_bf16_f32 v184,v136,v137
v_cvt_pk_bf16_f32 v185,v138,v139
v_cvt_pk_bf16_f32 v186,v152,v153
v_cvt_pk_bf16_f32 v187,v154,v155
s_nop 3
s_setpc_b64 s[42:43]
M_spinf:
s_mov_b32 s69,0x20000
M_spinf_l:
buffer_load_dword v137,v142,s[12:15],0 offen sc1
s_sub_u32 s69,s69,1
s_waitcnt vmcnt(0)
v_cmp_gt_u32 vcc,s60,v137
s_cbranch_vccz M_spinf_e
s_cmp_lg_u32 s69,0
s_cbranch_scc1 M_spinf_l
M_spinf_e:
s_setpc_b64 s[42:43]
M_spind:
s_mov_b32 s69,0x20000
M_spind_l:
buffer_load_dword v140,v139,s[0:3],0 offen sc1
s_sub_u32 s69,s69,1
s_waitcnt vmcnt(0)
v_cmp_gt_u32 vcc,s60,v140
s_cbranch_vccz M_spind_e
s_cmp_lg_u32 s69,0
s_cbranch_scc1 M_spind_l
M_spind_e:
s_setpc_b64 s[42:43]
.section .rodata,"a"
.p2align 6
.amdhsa_kernel concat_heads__mha_block_cached__mha_block_cached__near_ridge_kernel
  .amdhsa_next_free_vgpr 512
  .amdhsa_next_free_sgpr 102
  .amdhsa_accum_offset 256
  .amdhsa_group_segment_fixed_size 0
  .amdhsa_kernarg_size 104
  .amdhsa_user_sgpr_count 2
  .amdhsa_user_sgpr_kernarg_segment_ptr 1
  .amdhsa_system_sgpr_workgroup_id_x 1
  .amdhsa_float_denorm_mode_32 3
.end_amdhsa_kernel
```
